```python
import torch

def _softmax(x, axis=-1):
    return torch.softmax(x, dim=axis)
def _gelu(x):
    return torch.nn.functional.gelu(x, approximate="tanh")
def _silu(x):
    return torch.nn.functional.silu(x)
def _sigmoid(x):
    return torch.sigmoid(x)
def _layernorm(x, axis=-1, eps=1e-5):
    m = x.mean(dim=axis, keepdim=True)
    v = x.var(dim=axis, keepdim=True, unbiased=False)
    return (x - m) / torch.sqrt(v + eps)
def _scatter_add(tgt, idx, src, axis=0):
    return tgt.clone().index_add_(axis, idx, src)
def _segment_sum(src, seg, n):
    out = torch.zeros((n,) + src.shape[1:], dtype=src.dtype)
    return out.index_add_(0, seg, src)
def _pad(x, pw):
    flat = tuple(v for pair in reversed(pw) for v in pair)
    return torch.nn.functional.pad(x, flat)

kernel_name = 'standalone__gqa_softmax__near_ridge'

def setup_inputs():

    _w = (lambda a: (lambda t: t.to(torch.bfloat16) if t.is_floating_point() else t)(torch.as_tensor(a)))
    B, Hq, Hkv, Sq, Sk, D = 32, 32, 32, 256, 512, 128
    return {
        "q": _w((lambda *s: torch.randn(*s, dtype=torch.bfloat16) * 0.8)(B, Hq, Sq, D)),
        "k": _w((lambda *s: torch.randn(*s, dtype=torch.bfloat16) * 0.8)(B, Hkv, Sk, D)),
        "v": _w((lambda *s: torch.randn(*s, dtype=torch.bfloat16) * 0.05)(B, Hkv, Sk, D)),
    }

def reference(q, k, v):
    B, Hq, Sq, D = q.shape
    Hkv = k.shape[1]
    rep = Hq // Hkv
    k = (lambda x, n, axis: torch.repeat_interleave(x, n, dim=axis))(k, rep, axis=1)
    v = (lambda x, n, axis: torch.repeat_interleave(x, n, dim=axis))(v, rep, axis=1)
    scale = D ** -0.5
    scores = torch.einsum("bhqd,bhkd->bhqk", q, k) * scale
    p = _softmax(scores, axis=-1)
    return torch.einsum("bhqk,bhkd->bhqd", p, v)
```

```asm
; @launch grid=(256,1,1) block=(256,1,1) lds=163840
.amdgcn_target "amdgcn-amd-amdhsa--gfx950"
.text
.globl standalone__gqa_softmax__near_ridge_kernel
.p2align 8
.type standalone__gqa_softmax__near_ridge_kernel,@function
standalone__gqa_softmax__near_ridge_kernel:
s_cmp_ge_u32 s2,256
s_cbranch_scc1 L_end
s_load_dwordx4 s[36:39],s[0:1],0
s_load_dwordx4 s[40:43],s[0:1],16
s_getpc_b64 s[56:57]
L_pc0:
s_and_b32 s57,s57,0xffff
s_mov_b32 s58,L_codeend-L_pc0
s_mov_b32 s59,0x00020000
s_getreg_b32 s35,hwreg(HW_REG_HW_ID,13,2)
s_getreg_b32 s44,hwreg(HW_REG_HW_ID,8,2)
s_lshl_b32 s35,s35,14
s_lshl_b32 s44,s44,12
s_or_b32 s35,s35,s44
s_bitcmp0_b32 s2,0
s_cselect_b32 s44,L_v1-L_v0,0
s_add_u32 s35,s35,s44
v_lshlrev_b32 v26,4,v0
buffer_load_dwordx4 v[32:35],v26,s[56:59],s35 offen
v_and_b32 v23,63,v0
v_lshrrev_b32 v24,6,v0
s_nop 0
v_readfirstlane_b32 s31,v24
v_lshrrev_b32 v25,4,v23
v_lshl_or_b32 v26,v25,2,v24
v_and_b32 v1,15,v23
v_xor_b32 v1,v1,v26
v_lshlrev_b32 v1,4,v1
v_lshl_add_u32 v1,v25,8,v1
v_lshl_add_u32 v1,v24,12,v1
s_lshl_b32 s25,s31,12
s_mov_b32 s21,0
s_mov_b32 s22,0
s_mov_b32 s23,0
s_mov_b32 s28,0
s_mov_b32 s24,0xffff0000
s_and_b32 s33,s2,7
s_lshl_b32 s33,s33,5
s_lshr_b32 s34,s2,3
s_or_b32 s34,s34,s33
s_lshl_b32 s33,s34,18
s_lshl_b32 s34,s34,19
s_mov_b32 s6,0x40000
s_mov_b32 s7,0x00020000
s_mov_b32 s10,0x80000
s_mov_b32 s11,0x00020000
s_mov_b32 s14,0x80000
s_mov_b32 s15,0x00020000
s_mov_b32 s18,0x40000
s_mov_b32 s19,0x00020000
s_waitcnt lgkmcnt(0)
s_add_u32 s4,s36,s33
s_addc_u32 s5,s37,0
s_and_b32 s5,s5,0xffff
s_add_u32 s8,s38,s34
s_addc_u32 s9,s39,0
s_and_b32 s9,s9,0xffff
s_add_u32 s12,s40,s34
s_addc_u32 s13,s41,0
s_and_b32 s13,s13,0xffff
s_add_u32 s16,s42,s33
s_addc_u32 s17,s43,0
s_and_b32 s17,s17,0xffff
s_add_u32 m0,s25,131072
s_nop 0
buffer_load_dwordx4 v1,s[4:7],s23 offen nt lds
buffer_load_dwordx4 v1,s[4:7],s23 offen offset:1024 nt lds
buffer_load_dwordx4 v1,s[4:7],s23 offen offset:2048 nt lds
buffer_load_dwordx4 v1,s[4:7],s23 offen offset:3072 nt lds
s_add_u32 s23,s23,16384
s_add_u32 m0,s25,147456
s_nop 0
buffer_load_dwordx4 v1,s[4:7],s23 offen nt lds
buffer_load_dwordx4 v1,s[4:7],s23 offen offset:1024 nt lds
buffer_load_dwordx4 v1,s[4:7],s23 offen offset:2048 nt lds
buffer_load_dwordx4 v1,s[4:7],s23 offen offset:3072 nt lds
s_add_u32 s23,s23,16384
s_add_u32 m0,s25,98304
s_nop 0
buffer_load_dwordx4 v1,s[4:7],s23 offen nt lds
buffer_load_dwordx4 v1,s[4:7],s23 offen offset:1024 nt lds
buffer_load_dwordx4 v1,s[4:7],s23 offen offset:2048 nt lds
buffer_load_dwordx4 v1,s[4:7],s23 offen offset:3072 nt lds
s_add_u32 s23,s23,16384
s_add_u32 m0,s25,114688
s_nop 0
buffer_load_dwordx4 v1,s[4:7],s23 offen nt lds
buffer_load_dwordx4 v1,s[4:7],s23 offen offset:1024 nt lds
buffer_load_dwordx4 v1,s[4:7],s23 offen offset:2048 nt lds
buffer_load_dwordx4 v1,s[4:7],s23 offen offset:3072 nt lds
s_add_u32 s23,s23,16384
s_add_u32 m0,s25,0
s_nop 0
buffer_load_dwordx4 v1,s[8:11],s21 offen nt lds
buffer_load_dwordx4 v1,s[8:11],s21 offen offset:1024 nt lds
buffer_load_dwordx4 v1,s[8:11],s21 offen offset:2048 nt lds
buffer_load_dwordx4 v1,s[8:11],s21 offen offset:3072 nt lds
s_add_u32 s21,s21,16384
s_add_u32 m0,s25,16384
s_nop 0
buffer_load_dwordx4 v1,s[8:11],s21 offen nt lds
buffer_load_dwordx4 v1,s[8:11],s21 offen offset:1024 nt lds
buffer_load_dwordx4 v1,s[8:11],s21 offen offset:2048 nt lds
buffer_load_dwordx4 v1,s[8:11],s21 offen offset:3072 nt lds
s_add_u32 s21,s21,16384
s_add_u32 m0,s25,65536
s_nop 0
buffer_load_dwordx4 v1,s[12:15],s22 offen nt lds
buffer_load_dwordx4 v1,s[12:15],s22 offen offset:1024 nt lds
buffer_load_dwordx4 v1,s[12:15],s22 offen offset:2048 nt lds
buffer_load_dwordx4 v1,s[12:15],s22 offen offset:3072 nt lds
s_add_u32 s22,s22,16384
s_mov_b32 s30,131072
v_and_b32 v26,3,v23
v_bfe_u32 v27,v23,2,2
v_xor_b32 v28,v25,v26
v_lshlrev_b32 v29,6,v28
v_lshl_add_u32 v29,v26,8,v29
v_lshl_add_u32 v29,v27,12,v29
v_xor_b32 v2,0,v27
v_lshl_add_u32 v2,v2,4,v29
v_xor_b32 v3,1,v27
v_lshl_add_u32 v3,v3,4,v29
v_xor_b32 v4,2,v27
v_lshl_add_u32 v4,v4,4,v29
v_xor_b32 v5,3,v27
v_lshl_add_u32 v5,v5,4,v29
v_lshlrev_b32 v29,10,v24
v_add3_u32 v10,v2,v29,s30
v_add3_u32 v11,v3,v29,s30
v_add3_u32 v12,v4,v29,s30
v_add3_u32 v13,v5,v29,s30
v_lshlrev_b32 v29,4,v28
v_lshl_add_u32 v29,v25,12,v29
v_lshl_add_u32 v29,v27,8,v29
v_add_u32 v29,65536,v29
v_xor_b32 v6,0,v27
v_lshl_add_u32 v6,v6,6,v29
v_xor_b32 v7,1,v27
v_lshl_add_u32 v7,v7,6,v29
v_xor_b32 v8,2,v27
v_lshl_add_u32 v8,v8,6,v29
v_xor_b32 v9,3,v27
v_lshl_add_u32 v9,v9,6,v29
v_lshrrev_b32 v28,1,v24
v_mul_u32_u24 v28,0xc000,v28
v_and_b32 v29,1,v24
v_lshl_add_u32 v28,v29,13,v28
v_add_u32 v28,0x4000,v28
v_and_b32 v29,15,v23
v_mul_u32_u24 v22,0x110,v29
v_lshl_add_u32 v22,v25,4,v22
v_add_u32 v22,v22,v28
v_accvgpr_write_b32 a244,v22
v_mul_u32_u24 v22,0x110,v25
v_lshl_add_u32 v22,v29,4,v22
v_add_u32 v22,v22,v28
v_accvgpr_write_b32 a245,v22
v_lshlrev_b32 v22,4,v23
v_lshl_add_u32 v22,v24,10,v22
v_mov_b32 v29,0x3f803f80
v_accvgpr_write_b32 a240,v29
v_accvgpr_write_b32 a241,v29
v_accvgpr_write_b32 a242,v29
v_accvgpr_write_b32 a243,v29
s_mov_b32 s26,0x3e0293ee
s_mov_b32 s27,0x4b800000
s_mov_b32 s20,4
s_mov_b32 s29,1
v_subrev_u32 v23,32768,v10
v_subrev_u32 v24,32768,v11
v_subrev_u32 v25,32768,v12
v_subrev_u32 v26,32768,v13
s_waitcnt vmcnt(12)
s_barrier
ds_read_b128 a[0:3],v10 offset:0
ds_read_b128 a[4:7],v11 offset:0
ds_read_b128 a[8:11],v12 offset:0
ds_read_b128 a[12:15],v13 offset:0
ds_read_b128 a[16:19],v10 offset:16384
ds_read_b128 a[20:23],v11 offset:16384
ds_read_b128 a[24:27],v12 offset:16384
ds_read_b128 a[28:31],v13 offset:16384
ds_read_b128 a[32:35],v23 offset:0
ds_read_b128 a[36:39],v24 offset:0
ds_read_b128 a[40:43],v25 offset:0
ds_read_b128 a[44:47],v26 offset:0
ds_read_b128 a[48:51],v23 offset:16384
ds_read_b128 a[52:55],v24 offset:16384
ds_read_b128 a[56:59],v25 offset:16384
s_waitcnt lgkmcnt(14)
ds_read_b128 a[60:63],v26 offset:16384
s_waitcnt vmcnt(8)
s_waitcnt lgkmcnt(0)
s_barrier
s_bitcmp0_b32 s2,0
s_cbranch_scc1 L_v1
L_v0:
ds_read_b128 a[96:99],v2 offset:0
ds_read_b128 a[100:103],v3 offset:0
ds_read_b128 a[104:107],v4 offset:0
ds_read_b128 a[108:111],v5 offset:0
ds_read_b128 a[112:115],v2 offset:1024
ds_read_b128 a[116:119],v3 offset:1024
ds_read_b128 a[120:123],v4 offset:1024
ds_read_b128 a[124:127],v5 offset:1024
s_waitcnt lgkmcnt(4)
v_mfma_f32_16x16x32_bf16 v[160:163],a[96:99],a[0:3],0
ds_read_b128 a[128:131],v2 offset:2048
v_mfma_f32_16x16x32_bf16 v[160:163],a[100:103],a[4:7],v[160:163]
v_mfma_f32_16x16x32_bf16 v[160:163],a[104:107],a[8:11],v[160:163]
s_add_u32 m0,s25,32768
v_mfma_f32_16x16x32_bf16 v[160:163],a[108:111],a[12:15],v[160:163]
buffer_load_dwordx4 v1,s[8:11],s21 offen nt lds
v_mfma_f32_16x16x32_bf16 v[168:171],a[108:111],a[28:31],0
ds_read_b128 a[132:135],v3 offset:2048
v_mfma_f32_16x16x32_bf16 v[168:171],a[104:107],a[24:27],v[168:171]
v_mfma_f32_16x16x32_bf16 v[168:171],a[100:103],a[20:23],v[168:171]
v_mfma_f32_16x16x32_bf16 v[168:171],a[96:99],a[16:19],v[168:171]
v_mfma_f32_16x16x32_bf16 v[176:179],a[96:99],a[32:35],0
ds_read_b128 a[136:139],v4 offset:2048
v_mfma_f32_16x16x32_bf16 v[176:179],a[100:103],a[36:39],v[176:179]
v_mfma_f32_16x16x32_bf16 v[176:179],a[104:107],a[40:43],v[176:179]
v_mfma_f32_16x16x32_bf16 v[176:179],a[108:111],a[44:47],v[176:179]
ds_read_b128 a[140:143],v5 offset:2048
v_mfma_f32_16x16x32_bf16 v[184:187],a[108:111],a[60:63],0
v_mfma_f32_16x16x32_bf16 v[184:187],a[104:107],a[56:59],v[184:187]
v_mfma_f32_16x16x32_bf16 v[184:187],a[100:103],a[52:55],v[184:187]
s_waitcnt lgkmcnt(4)
v_mfma_f32_16x16x32_bf16 v[184:187],a[96:99],a[48:51],v[184:187]
ds_read_b128 a[144:147],v2 offset:3072
v_mfma_f32_16x16x32_bf16 v[164:167],a[112:115],a[0:3],0
v_mfma_f32_16x16x32_bf16 v[164:167],a[116:119],a[4:7],v[164:167]
v_mfma_f32_16x16x32_bf16 v[164:167],a[120:123],a[8:11],v[164:167]
v_mfma_f32_16x16x32_bf16 v[164:167],a[124:127],a[12:15],v[164:167]
ds_read_b128 a[148:151],v3 offset:3072
v_mfma_f32_16x16x32_bf16 v[172:175],a[124:127],a[28:31],0
v_mfma_f32_16x16x32_bf16 v[172:175],a[120:123],a[24:27],v[172:175]
v_mfma_f32_16x16x32_bf16 v[172:175],a[116:119],a[20:23],v[172:175]
ds_read_b128 a[152:155],v4 offset:3072
v_mfma_f32_16x16x32_bf16 v[172:175],a[112:115],a[16:19],v[172:175]
buffer_load_dwordx4 v1,s[8:11],s21 offen offset:1024 nt lds
v_mfma_f32_16x16x32_bf16 v[180:183],a[112:115],a[32:35],0
v_mfma_f32_16x16x32_bf16 v[180:183],a[116:119],a[36:39],v[180:183]
v_mfma_f32_16x16x32_bf16 v[180:183],a[120:123],a[40:43],v[180:183]
ds_read_b128 a[156:159],v5 offset:3072
v_mfma_f32_16x16x32_bf16 v[180:183],a[124:127],a[44:47],v[180:183]
v_mfma_f32_16x16x32_bf16 v[188:191],a[124:127],a[60:63],0
v_mfma_f32_16x16x32_bf16 v[188:191],a[120:123],a[56:59],v[188:191]
v_mfma_f32_16x16x32_bf16 v[188:191],a[116:119],a[52:55],v[188:191]
v_mfma_f32_16x16x32_bf16 v[188:191],a[112:115],a[48:51],v[188:191]
s_waitcnt lgkmcnt(4)
v_mfma_f32_16x16x32_bf16 v[192:195],a[128:131],a[0:3],0
v_mfma_f32_16x16x32_bf16 v[192:195],a[132:135],a[4:7],v[192:195]
v_mfma_f32_16x16x32_bf16 v[192:195],a[136:139],a[8:11],v[192:195]
v_mfma_f32_16x16x32_bf16 v[192:195],a[140:143],a[12:15],v[192:195]
buffer_load_dwordx4 v1,s[8:11],s21 offen offset:2048 nt lds
v_max3_f32 v23,v160,v161,v162
v_max3_f32 v24,v168,v169,v170
v_max3_f32 v25,v176,v177,v178
v_max3_f32 v26,v184,v185,v186
v_mfma_f32_16x16x32_bf16 v[200:203],a[140:143],a[28:31],0
v_max3_f32 v23,v23,v163,v164
v_max3_f32 v24,v24,v171,v172
v_mfma_f32_16x16x32_bf16 v[200:203],a[136:139],a[24:27],v[200:203]
v_max3_f32 v25,v25,v179,v180
v_mfma_f32_16x16x32_bf16 v[200:203],a[132:135],a[20:23],v[200:203]
v_max3_f32 v26,v26,v187,v188
v_mfma_f32_16x16x32_bf16 v[200:203],a[128:131],a[16:19],v[200:203]
v_max3_f32 v23,v23,v165,v166
v_max3_f32 v24,v24,v173,v174
v_max3_f32 v25,v25,v181,v182
v_max3_f32 v26,v26,v189,v190
v_mfma_f32_16x16x32_bf16 v[208:211],a[128:131],a[32:35],0
v_max_f32 v23,v23,v167
v_mfma_f32_16x16x32_bf16 v[208:211],a[132:135],a[36:39],v[208:211]
v_max_f32 v24,v24,v175
v_mfma_f32_16x16x32_bf16 v[208:211],a[136:139],a[40:43],v[208:211]
v_max_f32 v25,v25,v183
v_max_f32 v26,v26,v191
v_mfma_f32_16x16x32_bf16 v[208:211],a[140:143],a[44:47],v[208:211]
buffer_load_dwordx4 v1,s[8:11],s21 offen offset:3072 nt lds
v_mov_b32 v27,v23
v_mov_b32 v28,v24
v_mov_b32 v29,v25
v_mov_b32 v30,v26
v_mfma_f32_16x16x32_bf16 v[216:219],a[140:143],a[60:63],0
s_add_u32 s21,s21,16384
v_mfma_f32_16x16x32_bf16 v[216:219],a[136:139],a[56:59],v[216:219]
v_permlane16_swap_b32 v23,v27
v_mfma_f32_16x16x32_bf16 v[216:219],a[132:135],a[52:55],v[216:219]
v_permlane16_swap_b32 v24,v28
v_permlane16_swap_b32 v25,v29
v_mfma_f32_16x16x32_bf16 v[216:219],a[128:131],a[48:51],v[216:219]
s_waitcnt lgkmcnt(0)
v_permlane16_swap_b32 v26,v30
v_max_f32 v23,v23,v27
v_max_f32 v24,v24,v28
v_max_f32 v25,v25,v29
v_mfma_f32_16x16x32_bf16 v[196:199],a[144:147],a[0:3],0
v_max_f32 v26,v26,v30
v_mfma_f32_16x16x32_bf16 v[196:199],a[148:151],a[4:7],v[196:199]
v_mov_b32 v27,v23
v_mfma_f32_16x16x32_bf16 v[196:199],a[152:155],a[8:11],v[196:199]
v_mov_b32 v28,v24
v_mov_b32 v29,v25
v_mfma_f32_16x16x32_bf16 v[196:199],a[156:159],a[12:15],v[196:199]
v_mov_b32 v30,v26
v_permlane32_swap_b32 v23,v27
v_permlane32_swap_b32 v24,v28
v_permlane32_swap_b32 v25,v29
v_mfma_f32_16x16x32_bf16 v[204:207],a[156:159],a[28:31],0
v_permlane32_swap_b32 v26,v30
v_mfma_f32_16x16x32_bf16 v[204:207],a[152:155],a[24:27],v[204:207]
v_max_f32 v23,v23,v27
v_max_f32 v24,v24,v28
v_mfma_f32_16x16x32_bf16 v[204:207],a[148:151],a[20:23],v[204:207]
v_max_f32 v25,v25,v29
v_max_f32 v26,v26,v30
v_mfma_f32_16x16x32_bf16 v[204:207],a[144:147],a[16:19],v[204:207]
v_mul_f32 v18,s26,v23
v_mul_f32 v19,s26,v24
v_mul_f32 v20,s26,v25
v_mul_f32 v21,s26,v26
v_mfma_f32_16x16x32_bf16 v[212:215],a[144:147],a[32:35],0
v_fma_f32 v160,v160,s26,-v18
v_mfma_f32_16x16x32_bf16 v[212:215],a[148:151],a[36:39],v[212:215]
v_exp_f32 v160,v160
v_mfma_f32_16x16x32_bf16 v[212:215],a[152:155],a[40:43],v[212:215]
v_fma_f32 v161,v161,s26,-v18
v_fma_f32 v162,v162,s26,-v18
v_mfma_f32_16x16x32_bf16 v[212:215],a[156:159],a[44:47],v[212:215]
v_exp_f32 v161,v161
v_fma_f32 v163,v163,s26,-v18
v_exp_f32 v162,v162
v_mfma_f32_16x16x32_bf16 v[220:223],a[156:159],a[60:63],0
v_cvt_pk_bf16_f32 v160,v160,v161
v_mfma_f32_16x16x32_bf16 v[220:223],a[152:155],a[56:59],v[220:223]
v_exp_f32 v163,v163
v_mfma_f32_16x16x32_bf16 v[220:223],a[148:151],a[52:55],v[220:223]
v_fma_f32 v164,v164,s26,-v18
v_mfma_f32_16x16x32_bf16 v[220:223],a[144:147],a[48:51],v[220:223]
v_fma_f32 v165,v165,s26,-v18
v_exp_f32 v164,v164
v_cvt_pk_bf16_f32 v161,v162,v163
v_fma_f32 v166,v166,s26,-v18
v_exp_f32 v165,v165
v_fma_f32 v167,v167,s26,-v18
v_exp_f32 v166,v166
v_cvt_pk_bf16_f32 v162,v164,v165
v_fma_f32 v168,v168,s26,-v19
v_fma_f32 v169,v169,s26,-v19
v_exp_f32 v167,v167
v_exp_f32 v168,v168
v_fma_f32 v170,v170,s26,-v19
v_exp_f32 v169,v169
v_cvt_pk_bf16_f32 v163,v166,v167
v_exp_f32 v170,v170
v_fma_f32 v171,v171,s26,-v19
v_cvt_pk_bf16_f32 v168,v168,v169
v_fma_f32 v172,v172,s26,-v19
v_exp_f32 v171,v171
v_fma_f32 v173,v173,s26,-v19
v_exp_f32 v172,v172
v_exp_f32 v173,v173
v_cvt_pk_bf16_f32 v169,v170,v171
v_fma_f32 v174,v174,s26,-v19
v_fma_f32 v175,v175,s26,-v19
v_cvt_pk_bf16_f32 v170,v172,v173
v_exp_f32 v174,v174
v_exp_f32 v175,v175
v_fma_f32 v176,v176,s26,-v20
v_exp_f32 v176,v176
v_fma_f32 v177,v177,s26,-v20
v_cvt_pk_bf16_f32 v171,v174,v175
v_fma_f32 v178,v178,s26,-v20
v_fma_f32 v179,v179,s26,-v20
v_exp_f32 v177,v177
v_exp_f32 v178,v178
v_exp_f32 v179,v179
v_cvt_pk_bf16_f32 v176,v176,v177
v_fma_f32 v180,v180,s26,-v20
v_fma_f32 v181,v181,s26,-v20
v_cvt_pk_bf16_f32 v177,v178,v179
v_exp_f32 v180,v180
v_exp_f32 v181,v181
v_fma_f32 v182,v182,s26,-v20
v_fma_f32 v183,v183,s26,-v20
v_exp_f32 v182,v182
v_exp_f32 v183,v183
v_cvt_pk_bf16_f32 v178,v180,v181
v_fma_f32 v184,v184,s26,-v21
v_fma_f32 v185,v185,s26,-v21
v_cvt_pk_bf16_f32 v179,v182,v183
v_fma_f32 v186,v186,s26,-v21
v_exp_f32 v184,v184
v_exp_f32 v185,v185
v_fma_f32 v187,v187,s26,-v21
v_exp_f32 v186,v186
v_cvt_pk_bf16_f32 v184,v184,v185
v_exp_f32 v187,v187
v_fma_f32 v188,v188,s26,-v21
v_exp_f32 v188,v188
v_fma_f32 v189,v189,s26,-v21
v_cvt_pk_bf16_f32 v185,v186,v187
v_fma_f32 v190,v190,s26,-v21
v_fma_f32 v191,v191,s26,-v21
v_exp_f32 v189,v189
s_nop 0
v_cvt_pk_bf16_f32 v186,v188,v189
v_exp_f32 v190,v190
v_exp_f32 v191,v191
s_nop 0
v_cvt_pk_bf16_f32 v187,v190,v191
v_fma_f32 v192,v192,s26,-v18
v_fma_f32 v193,v193,s26,-v18
v_exp_f32 v192,v192
v_exp_f32 v193,v193
v_fma_f32 v194,v194,s26,-v18
v_fma_f32 v195,v195,s26,-v18
v_exp_f32 v194,v194
v_exp_f32 v195,v195
v_cvt_pk_bf16_f32 v164,v192,v193
v_fma_f32 v200,v200,s26,-v19
v_fma_f32 v201,v201,s26,-v19
v_exp_f32 v200,v200
v_cvt_pk_bf16_f32 v165,v194,v195
v_exp_f32 v201,v201
s_add_u32 m0,s25,81920
s_nop 0
buffer_load_dwordx4 v1,s[12:15],s22 offen nt lds
buffer_load_dwordx4 v1,s[12:15],s22 offen offset:1024 nt lds
buffer_load_dwordx4 v1,s[12:15],s22 offen offset:2048 nt lds
buffer_load_dwordx4 v1,s[12:15],s22 offen offset:3072 nt lds
s_add_u32 s22,s22,16384
s_add_u32 m0,s25,147456
s_nop 0
buffer_load_dwordx4 v1,s[4:7],s23 offen nt lds
buffer_load_dwordx4 v1,s[4:7],s23 offen offset:1024 nt lds
buffer_load_dwordx4 v1,s[4:7],s23 offen offset:2048 nt lds
buffer_load_dwordx4 v1,s[4:7],s23 offen offset:3072 nt lds
s_add_u32 s23,s23,16384
v_cvt_pk_bf16_f32 v172,v200,v201
v_fma_f32 v202,v202,s26,-v19
v_fma_f32 v203,v203,s26,-v19
v_exp_f32 v202,v202
v_exp_f32 v203,v203
s_nop 0
v_cvt_pk_bf16_f32 v173,v202,v203
v_fma_f32 v208,v208,s26,-v20
v_fma_f32 v209,v209,s26,-v20
v_exp_f32 v208,v208
v_exp_f32 v209,v209
s_nop 0
v_cvt_pk_bf16_f32 v180,v208,v209
v_fma_f32 v210,v210,s26,-v20
v_fma_f32 v211,v211,s26,-v20
v_exp_f32 v210,v210
v_exp_f32 v211,v211
s_nop 0
v_cvt_pk_bf16_f32 v181,v210,v211
v_fma_f32 v216,v216,s26,-v21
v_fma_f32 v217,v217,s26,-v21
v_exp_f32 v216,v216
v_exp_f32 v217,v217
s_nop 0
v_cvt_pk_bf16_f32 v188,v216,v217
v_fma_f32 v218,v218,s26,-v21
v_fma_f32 v219,v219,s26,-v21
v_exp_f32 v218,v218
v_exp_f32 v219,v219
s_nop 0
v_cvt_pk_bf16_f32 v189,v218,v219
v_fma_f32 v196,v196,s26,-v18
v_fma_f32 v197,v197,s26,-v18
v_exp_f32 v196,v196
v_exp_f32 v197,v197
v_fma_f32 v198,v198,s26,-v18
v_exp_f32 v198,v198
v_cvt_pk_bf16_f32 v166,v196,v197
v_fma_f32 v199,v199,s26,-v18
v_exp_f32 v199,v199
s_nop 0
v_cvt_pk_bf16_f32 v167,v198,v199
v_fma_f32 v204,v204,s26,-v19
v_fma_f32 v205,v205,s26,-v19
v_exp_f32 v204,v204
v_exp_f32 v205,v205
s_waitcnt vmcnt(16)
s_barrier
ds_read_b128 a[96:99],v2 offset:16384
s_add_u32 m0,s25,49152
s_nop 0
buffer_load_dwordx4 v1,s[8:11],s21 offen nt lds
ds_read_b128 a[100:103],v3 offset:16384
ds_read_b128 a[104:107],v4 offset:16384
buffer_load_dwordx4 v1,s[8:11],s21 offen offset:1024 nt lds
ds_read_b128 a[108:111],v5 offset:16384
ds_read_b128 a[112:115],v2 offset:17408
ds_read_b128 a[116:119],v3 offset:17408
ds_read_b128 a[120:123],v4 offset:17408
buffer_load_dwordx4 v1,s[8:11],s21 offen offset:2048 nt lds
ds_read_b128 a[124:127],v5 offset:17408
s_waitcnt lgkmcnt(4)
v_mfma_f32_16x16x32_bf16 v[224:227],a[96:99],a[0:3],0
ds_read_b128 a[128:131],v2 offset:18432
v_mfma_f32_16x16x32_bf16 v[224:227],a[100:103],a[4:7],v[224:227]
v_mfma_f32_16x16x32_bf16 v[224:227],a[104:107],a[8:11],v[224:227]
v_cvt_pk_bf16_f32 v174,v204,v205
v_mfma_f32_16x16x32_bf16 v[224:227],a[108:111],a[12:15],v[224:227]
buffer_load_dwordx4 v1,s[8:11],s21 offen offset:3072 nt lds
v_fma_f32 v206,v206,s26,-v19
v_fma_f32 v207,v207,s26,-v19
v_mfma_f32_16x16x32_bf16 v[232:235],a[108:111],a[28:31],0
s_add_u32 s21,s21,16384
ds_read_b128 a[132:135],v3 offset:18432
v_mfma_f32_16x16x32_bf16 v[232:235],a[104:107],a[24:27],v[232:235]
v_exp_f32 v206,v206
v_mfma_f32_16x16x32_bf16 v[232:235],a[100:103],a[20:23],v[232:235]
v_exp_f32 v207,v207
v_mfma_f32_16x16x32_bf16 v[232:235],a[96:99],a[16:19],v[232:235]
v_cvt_pk_bf16_f32 v175,v206,v207
v_fma_f32 v224,v224,s26,-v18
v_mfma_f32_16x16x32_bf16 v[240:243],a[96:99],a[32:35],0
ds_read_b128 a[136:139],v4 offset:18432
v_mfma_f32_16x16x32_bf16 v[240:243],a[100:103],a[36:39],v[240:243]
v_exp_f32 v224,v224
v_mfma_f32_16x16x32_bf16 v[240:243],a[104:107],a[40:43],v[240:243]
v_fma_f32 v225,v225,s26,-v18
v_mfma_f32_16x16x32_bf16 v[240:243],a[108:111],a[44:47],v[240:243]
ds_read_b128 a[140:143],v5 offset:18432
v_exp_f32 v225,v225
v_fma_f32 v212,v212,s26,-v20
v_fma_f32 v213,v213,s26,-v20
v_mfma_f32_16x16x32_bf16 v[248:251],a[108:111],a[60:63],0
v_exp_f32 v212,v212
v_mfma_f32_16x16x32_bf16 v[248:251],a[104:107],a[56:59],v[248:251]
v_exp_f32 v213,v213
v_mfma_f32_16x16x32_bf16 v[248:251],a[100:103],a[52:55],v[248:251]
s_waitcnt lgkmcnt(4)
v_mfma_f32_16x16x32_bf16 v[248:251],a[96:99],a[48:51],v[248:251]
ds_read_b128 a[144:147],v2 offset:19456
v_cvt_pk_bf16_f32 v182,v212,v213
v_mfma_f32_16x16x32_bf16 v[228:231],a[112:115],a[0:3],0
v_mfma_f32_16x16x32_bf16 v[228:231],a[116:119],a[4:7],v[228:231]
v_fma_f32 v226,v226,s26,-v18
v_fma_f32 v227,v227,s26,-v18
v_mfma_f32_16x16x32_bf16 v[228:231],a[120:123],a[8:11],v[228:231]
v_exp_f32 v226,v226
v_mfma_f32_16x16x32_bf16 v[228:231],a[124:127],a[12:15],v[228:231]
ds_read_b128 a[148:151],v3 offset:19456
v_fma_f32 v214,v214,s26,-v20
v_exp_f32 v227,v227
v_fma_f32 v215,v215,s26,-v20
v_mfma_f32_16x16x32_bf16 v[236:239],a[124:127],a[28:31],0
v_exp_f32 v214,v214
v_mfma_f32_16x16x32_bf16 v[236:239],a[120:123],a[24:27],v[236:239]
v_exp_f32 v215,v215
v_mfma_f32_16x16x32_bf16 v[236:239],a[116:119],a[20:23],v[236:239]
s_add_u32 m0,s25,98304
ds_read_b128 a[152:155],v4 offset:19456
v_mfma_f32_16x16x32_bf16 v[236:239],a[112:115],a[16:19],v[236:239]
buffer_load_dwordx4 v1,s[12:15],s22 offen nt lds
v_cvt_pk_bf16_f32 v224,v224,v225
v_cvt_pk_bf16_f32 v225,v226,v227
v_mfma_f32_16x16x32_bf16 v[244:247],a[112:115],a[32:35],0
v_cvt_pk_bf16_f32 v183,v214,v215
v_mfma_f32_16x16x32_bf16 v[244:247],a[116:119],a[36:39],v[244:247]
v_mfma_f32_16x16x32_bf16 v[244:247],a[120:123],a[40:43],v[244:247]
ds_read_b128 a[156:159],v5 offset:19456
v_mfma_f32_16x16x32_bf16 v[244:247],a[124:127],a[44:47],v[244:247]
v_fma_f32 v228,v228,s26,-v18
v_fma_f32 v229,v229,s26,-v18
v_fma_f32 v220,v220,s26,-v21
v_fma_f32 v221,v221,s26,-v21
v_mfma_f32_16x16x32_bf16 v[252:255],a[124:127],a[60:63],0
v_exp_f32 v228,v228
v_mfma_f32_16x16x32_bf16 v[252:255],a[120:123],a[56:59],v[252:255]
v_exp_f32 v229,v229
v_mfma_f32_16x16x32_bf16 v[252:255],a[116:119],a[52:55],v[252:255]
v_exp_f32 v220,v220
v_mfma_f32_16x16x32_bf16 v[252:255],a[112:115],a[48:51],v[252:255]
s_waitcnt lgkmcnt(4)
v_exp_f32 v221,v221
v_cvt_pk_bf16_f32 v226,v228,v229
v_mfma_f32_16x16x32_bf16 v[192:195],a[128:131],a[0:3],0
v_cvt_pk_bf16_f32 v190,v220,v221
v_fma_f32 v230,v230,s26,-v18
v_mfma_f32_16x16x32_bf16 v[192:195],a[132:135],a[4:7],v[192:195]
v_exp_f32 v230,v230
v_mfma_f32_16x16x32_bf16 v[192:195],a[136:139],a[8:11],v[192:195]
v_fma_f32 v231,v231,s26,-v18
v_mfma_f32_16x16x32_bf16 v[192:195],a[140:143],a[12:15],v[192:195]
buffer_load_dwordx4 v1,s[12:15],s22 offen offset:1024 nt lds
v_exp_f32 v231,v231
v_fma_f32 v222,v222,s26,-v21
v_fma_f32 v223,v223,s26,-v21
v_mfma_f32_16x16x32_bf16 v[200:203],a[140:143],a[28:31],0
v_exp_f32 v222,v222
v_mfma_f32_16x16x32_bf16 v[200:203],a[136:139],a[24:27],v[200:203]
s_waitcnt vmcnt(18)
s_barrier
ds_read_b64_tr_b16 a[96:97],v8 offset:0
v_mfma_f32_16x16x32_bf16 v[200:203],a[132:135],a[20:23],v[200:203]
ds_read_b64_tr_b16 a[98:99],v8 offset:1024
v_mfma_f32_16x16x32_bf16 v[200:203],a[128:131],a[16:19],v[200:203]
v_exp_f32 v223,v223
v_cvt_pk_bf16_f32 v227,v230,v231
v_mfma_f32_16x16x32_bf16 v[208:211],a[128:131],a[32:35],0
ds_read_b64_tr_b16 a[100:101],v8 offset:2048
v_mfma_f32_16x16x32_bf16 v[208:211],a[132:135],a[36:39],v[208:211]
ds_read_b64_tr_b16 a[102:103],v8 offset:3072
v_cvt_pk_bf16_f32 v191,v222,v223
v_mfma_f32_16x16x32_bf16 v[208:211],a[136:139],a[40:43],v[208:211]
v_fma_f32 v232,v232,s26,-v19
v_mfma_f32_16x16x32_bf16 v[208:211],a[140:143],a[44:47],v[208:211]
buffer_load_dwordx4 v1,s[12:15],s22 offen offset:2048 nt lds
v_fma_f32 v233,v233,s26,-v19
v_exp_f32 v232,v232
v_mfma_f32_16x16x32_bf16 v[216:219],a[140:143],a[60:63],0
ds_read_b64_tr_b16 a[104:105],v8 offset:8
v_mfma_f32_16x16x32_bf16 v[216:219],a[136:139],a[56:59],v[216:219]
ds_read_b64_tr_b16 a[106:107],v8 offset:1032
v_mfma_f32_16x16x32_bf16 v[216:219],a[132:135],a[52:55],v[216:219]
v_exp_f32 v233,v233
v_mfma_f32_16x16x32_bf16 v[216:219],a[128:131],a[48:51],v[216:219]
s_waitcnt lgkmcnt(6)
v_cvt_pk_bf16_f32 v232,v232,v233
v_fma_f32 v234,v234,s26,-v19
v_fma_f32 v235,v235,s26,-v19
v_mfma_f32_16x16x32_bf16 v[196:199],a[144:147],a[0:3],0
ds_read_b64_tr_b16 a[108:109],v8 offset:2056
v_mfma_f32_16x16x32_bf16 v[196:199],a[148:151],a[4:7],v[196:199]
ds_read_b64_tr_b16 a[110:111],v8 offset:3080
v_mfma_f32_16x16x32_bf16 v[196:199],a[152:155],a[8:11],v[196:199]
v_exp_f32 v234,v234
v_mfma_f32_16x16x32_bf16 v[196:199],a[156:159],a[12:15],v[196:199]
ds_read_b64_tr_b16 a[112:113],v9 offset:0
v_exp_f32 v235,v235
v_mfma_f32_16x16x32_bf16 v[204:207],a[156:159],a[28:31],0
ds_read_b64_tr_b16 a[114:115],v9 offset:1024
v_mfma_f32_16x16x32_bf16 v[204:207],a[152:155],a[24:27],v[204:207]
v_mfma_f32_16x16x32_bf16 v[204:207],a[148:151],a[20:23],v[204:207]
v_cvt_pk_bf16_f32 v233,v234,v235
v_mfma_f32_16x16x32_bf16 v[204:207],a[144:147],a[16:19],v[204:207]
ds_read_b64_tr_b16 a[116:117],v9 offset:2048
v_fma_f32 v240,v240,s26,-v20
v_fma_f32 v241,v241,s26,-v20
v_mfma_f32_16x16x32_bf16 v[212:215],a[144:147],a[32:35],0
ds_read_b64_tr_b16 a[118:119],v9 offset:3072
v_mfma_f32_16x16x32_bf16 v[212:215],a[148:151],a[36:39],v[212:215]
v_exp_f32 v240,v240
v_mfma_f32_16x16x32_bf16 v[212:215],a[152:155],a[40:43],v[212:215]
v_exp_f32 v241,v241
v_mfma_f32_16x16x32_bf16 v[212:215],a[156:159],a[44:47],v[212:215]
ds_read_b64_tr_b16 a[120:121],v9 offset:8
v_cvt_pk_bf16_f32 v240,v240,v241
v_fma_f32 v242,v242,s26,-v20
v_mfma_f32_16x16x32_bf16 v[220:223],a[156:159],a[60:63],0
ds_read_b64_tr_b16 a[122:123],v9 offset:1032
v_mfma_f32_16x16x32_bf16 v[220:223],a[152:155],a[56:59],v[220:223]
v_exp_f32 v242,v242
v_mfma_f32_16x16x32_bf16 v[220:223],a[148:151],a[52:55],v[220:223]
ds_read_b64_tr_b16 a[124:125],v9 offset:2056
v_fma_f32 v243,v243,s26,-v20
v_mfma_f32_16x16x32_bf16 v[220:223],a[144:147],a[48:51],v[220:223]
s_waitcnt lgkmcnt(14)
ds_read_b64_tr_b16 a[126:127],v9 offset:3080
v_exp_f32 v243,v243
v_mfma_f32_16x16x32_bf16 a[224:227],a[240:243],v[160:163],0
v_mfma_f32_16x16x32_bf16 a[224:227],a[240:243],v[164:167],a[224:227]
buffer_load_dwordx4 v1,s[12:15],s22 offen offset:3072 nt lds
v_cvt_pk_bf16_f32 v241,v242,v243
v_mfma_f32_16x16x32_bf16 a[228:231],a[240:243],v[168:171],0
s_add_u32 s22,s22,16384
s_waitcnt lgkmcnt(14)
ds_read_b64_tr_b16 a[128:129],v6 offset:0
v_mfma_f32_16x16x32_bf16 a[228:231],a[240:243],v[172:175],a[228:231]
s_waitcnt lgkmcnt(14)
ds_read_b64_tr_b16 a[130:131],v6 offset:1024
v_fma_f32 v248,v248,s26,-v21
v_fma_f32 v249,v249,s26,-v21
v_mfma_f32_16x16x32_bf16 a[232:235],a[240:243],v[176:179],0
v_exp_f32 v248,v248
v_mfma_f32_16x16x32_bf16 a[232:235],a[240:243],v[180:183],a[232:235]
s_waitcnt lgkmcnt(14)
v_exp_f32 v249,v249
v_fma_f32 v250,v250,s26,-v21
v_fma_f32 v251,v251,s26,-v21
v_mfma_f32_16x16x32_bf16 a[236:239],a[240:243],v[184:187],0
ds_read_b64_tr_b16 a[132:133],v6 offset:2048
v_cvt_pk_bf16_f32 v248,v248,v249
v_mfma_f32_16x16x32_bf16 a[236:239],a[240:243],v[188:191],a[236:239]
s_waitcnt lgkmcnt(14)
ds_read_b64_tr_b16 a[134:135],v6 offset:3072
v_exp_f32 v250,v250
v_exp_f32 v251,v251
v_fma_f32 v236,v236,s26,-v19
v_fma_f32 v237,v237,s26,-v19
v_mfma_f32_16x16x32_bf16 a[208:211],a[96:99],v[184:187],0
v_exp_f32 v236,v236
v_mfma_f32_16x16x32_bf16 a[208:211],a[100:103],v[188:191],a[208:211]
s_waitcnt lgkmcnt(14)
ds_read_b64_tr_b16 a[136:137],v6 offset:8
v_cvt_pk_bf16_f32 v249,v250,v251
v_exp_f32 v237,v237
v_fma_f32 v238,v238,s26,-v19
v_fma_f32 v239,v239,s26,-v19
v_fma_f32 v244,v244,s26,-v20
v_fma_f32 v245,v245,s26,-v20
v_fma_f32 v246,v246,s26,-v20
v_fma_f32 v247,v247,s26,-v20
v_mfma_f32_16x16x32_bf16 a[192:195],a[100:103],v[180:183],0
s_add_u32 m0,s25,131072
s_waitcnt lgkmcnt(14)
ds_read_b64_tr_b16 a[138:139],v6 offset:1032
v_mfma_f32_16x16x32_bf16 a[192:195],a[96:99],v[176:179],a[192:195]
buffer_load_dwordx4 v1,s[4:7],s23 offen nt lds
v_cvt_pk_bf16_f32 v234,v236,v237
v_exp_f32 v238,v238
v_exp_f32 v239,v239
v_exp_f32 v244,v244
v_mfma_f32_16x16x32_bf16 a[176:179],a[96:99],v[168:171],0
v_exp_f32 v245,v245
v_mfma_f32_16x16x32_bf16 a[176:179],a[100:103],v[172:175],a[176:179]
s_waitcnt lgkmcnt(14)
ds_read_b64_tr_b16 a[140:141],v6 offset:2056
v_exp_f32 v246,v246
v_exp_f32 v247,v247
v_cvt_pk_bf16_f32 v235,v238,v239
v_cvt_pk_bf16_f32 v242,v244,v245
v_fma_f32 v252,v252,s26,-v21
v_fma_f32 v253,v253,s26,-v21
v_mfma_f32_16x16x32_bf16 a[160:163],a[100:103],v[164:167],0
s_waitcnt lgkmcnt(14)
ds_read_b64_tr_b16 a[142:143],v6 offset:3080
v_cvt_pk_bf16_f32 v243,v246,v247
v_mfma_f32_16x16x32_bf16 a[160:163],a[96:99],v[160:163],a[160:163]
v_exp_f32 v252,v252
v_exp_f32 v253,v253
v_fma_f32 v254,v254,s26,-v21
v_fma_f32 v255,v255,s26,-v21
v_mfma_f32_16x16x32_bf16 a[164:167],a[104:107],v[160:163],0
v_exp_f32 v254,v254
v_mfma_f32_16x16x32_bf16 a[164:167],a[108:111],v[164:167],a[164:167]
s_waitcnt lgkmcnt(14)
ds_read_b64_tr_b16 a[144:145],v7 offset:0
v_exp_f32 v255,v255
v_cvt_pk_bf16_f32 v250,v252,v253
v_mfma_f32_16x16x32_bf16 a[180:183],a[108:111],v[172:175],0
s_waitcnt lgkmcnt(14)
ds_read_b64_tr_b16 a[146:147],v7 offset:1024
v_cvt_pk_bf16_f32 v251,v254,v255
v_mfma_f32_16x16x32_bf16 a[180:183],a[104:107],v[168:171],a[180:183]
buffer_load_dwordx4 v1,s[4:7],s23 offen offset:1024 nt lds
v_mfma_f32_16x16x32_bf16 a[196:199],a[104:107],v[176:179],0
s_waitcnt lgkmcnt(14)
ds_read_b64_tr_b16 a[148:149],v7 offset:2048
v_mfma_f32_16x16x32_bf16 a[196:199],a[108:111],v[180:183],a[196:199]
s_waitcnt lgkmcnt(14)
ds_read_b64_tr_b16 a[150:151],v7 offset:3072
v_mfma_f32_16x16x32_bf16 a[212:215],a[108:111],v[188:191],0
v_mfma_f32_16x16x32_bf16 a[212:215],a[104:107],v[184:187],a[212:215]
v_mfma_f32_16x16x32_bf16 a[216:219],a[112:115],v[184:187],0
s_waitcnt lgkmcnt(14)
ds_read_b64_tr_b16 a[152:153],v7 offset:8
v_mfma_f32_16x16x32_bf16 a[216:219],a[116:119],v[188:191],a[216:219]
s_waitcnt lgkmcnt(14)
ds_read_b64_tr_b16 a[154:155],v7 offset:1032
v_mfma_f32_16x16x32_bf16 a[200:203],a[116:119],v[180:183],0
v_mfma_f32_16x16x32_bf16 a[200:203],a[112:115],v[176:179],a[200:203]
s_waitcnt lgkmcnt(14)
ds_read_b64_tr_b16 a[156:157],v7 offset:2056
v_mfma_f32_16x16x32_bf16 a[184:187],a[112:115],v[168:171],0
s_waitcnt lgkmcnt(14)
ds_read_b64_tr_b16 a[158:159],v7 offset:3080
v_mfma_f32_16x16x32_bf16 a[184:187],a[116:119],v[172:175],a[184:187]
buffer_load_dwordx4 v1,s[4:7],s23 offen offset:2048 nt lds
v_mfma_f32_16x16x32_bf16 a[168:171],a[116:119],v[164:167],0
v_mfma_f32_16x16x32_bf16 a[168:171],a[112:115],v[160:163],a[168:171]
v_mfma_f32_16x16x32_bf16 a[172:175],a[120:123],v[160:163],0
v_mfma_f32_16x16x32_bf16 a[172:175],a[124:127],v[164:167],a[172:175]
v_mfma_f32_16x16x32_bf16 a[188:191],a[124:127],v[172:175],0
v_mfma_f32_16x16x32_bf16 a[188:191],a[120:123],v[168:171],a[188:191]
v_mfma_f32_16x16x32_bf16 a[204:207],a[120:123],v[176:179],0
v_fma_f32 v192,v192,s26,-v18
v_mfma_f32_16x16x32_bf16 a[204:207],a[124:127],v[180:183],a[204:207]
buffer_load_dwordx4 v1,s[4:7],s23 offen offset:3072 nt lds
v_exp_f32 v192,v192
v_mfma_f32_16x16x32_bf16 a[220:223],a[124:127],v[188:191],0
s_add_u32 s23,s23,16384
v_fma_f32 v193,v193,s26,-v18
v_mfma_f32_16x16x32_bf16 a[220:223],a[120:123],v[184:187],a[220:223]
s_waitcnt lgkmcnt(12)
v_exp_f32 v193,v193
v_fma_f32 v194,v194,s26,-v18
v_fma_f32 v195,v195,s26,-v18
v_mfma_f32_16x16x32_bf16 v[80:83],a[128:131],v[184:187],0
v_cvt_pk_bf16_f32 v228,v192,v193
v_mfma_f32_16x16x32_bf16 v[80:83],a[132:135],v[188:191],v[80:83]
v_exp_f32 v194,v194
v_exp_f32 v195,v195
v_mfma_f32_16x16x32_bf16 v[64:67],a[132:135],v[180:183],0
v_cvt_pk_bf16_f32 v229,v194,v195
v_mfma_f32_16x16x32_bf16 v[64:67],a[128:131],v[176:179],v[64:67]
s_waitcnt vmcnt(16)
s_waitcnt lgkmcnt(0)
s_barrier
L_h0_0:
ds_read_b128 a[96:99],v2 offset:32768
v_fma_f32 v196,v196,s26,-v18
v_fma_f32 v197,v197,s26,-v18
v_fma_f32 v198,v198,s26,-v18
v_mfma_f32_16x16x32_bf16 v[48:51],a[128:131],v[168:171],0
s_add_u32 m0,s25,0
v_fma_f32 v199,v199,s26,-v18
v_mfma_f32_16x16x32_bf16 v[48:51],a[132:135],v[172:175],v[48:51]
buffer_load_dwordx4 v1,s[8:11],s21 offen nt lds
v_exp_f32 v196,v196
v_fma_f32 v200,v200,s26,-v19
v_mfma_f32_16x16x32_bf16 v[32:35],a[132:135],v[164:167],0
v_fma_f32 v201,v201,s26,-v19
v_mfma_f32_16x16x32_bf16 v[32:35],a[128:131],v[160:163],v[32:35]
ds_read_b128 a[100:103],v3 offset:32768
v_exp_f32 v197,v197
v_fma_f32 v202,v202,s26,-v19
v_mfma_f32_16x16x32_bf16 v[36:39],a[136:139],v[160:163],0
v_cvt_pk_bf16_f32 v230,v196,v197
v_mfma_f32_16x16x32_bf16 v[36:39],a[140:143],v[164:167],v[36:39]
v_exp_f32 v198,v198
v_exp_f32 v199,v199
v_mfma_f32_16x16x32_bf16 v[52:55],a[140:143],v[172:175],0
ds_read_b128 a[104:107],v4 offset:32768
v_cvt_pk_bf16_f32 v231,v198,v199
v_mfma_f32_16x16x32_bf16 v[52:55],a[136:139],v[168:171],v[52:55]
v_exp_f32 v200,v200
v_exp_f32 v201,v201
v_mfma_f32_16x16x32_bf16 v[68:71],a[136:139],v[176:179],0
v_cvt_pk_bf16_f32 v236,v200,v201
v_mfma_f32_16x16x32_bf16 v[68:71],a[140:143],v[180:183],v[68:71]
buffer_load_dwordx4 v1,s[8:11],s21 offen offset:1024 nt lds
v_exp_f32 v202,v202
v_mfma_f32_16x16x32_bf16 v[84:87],a[140:143],v[188:191],0
ds_read_b128 a[108:111],v5 offset:32768
v_fma_f32 v203,v203,s26,-v19
v_mfma_f32_16x16x32_bf16 v[84:87],a[136:139],v[184:187],v[84:87]
v_exp_f32 v203,v203
v_fma_f32 v204,v204,s26,-v19
v_fma_f32 v205,v205,s26,-v19
v_mfma_f32_16x16x32_bf16 v[88:91],a[144:147],v[184:187],0
v_cvt_pk_bf16_f32 v237,v202,v203
v_mfma_f32_16x16x32_bf16 v[88:91],a[148:151],v[188:191],v[88:91]
v_exp_f32 v204,v204
v_exp_f32 v205,v205
v_mfma_f32_16x16x32_bf16 v[72:75],a[148:151],v[180:183],0
ds_read_b128 a[112:115],v2 offset:33792
v_cvt_pk_bf16_f32 v238,v204,v205
v_mfma_f32_16x16x32_bf16 v[72:75],a[144:147],v[176:179],v[72:75]
v_fma_f32 v206,v206,s26,-v19
v_fma_f32 v207,v207,s26,-v19
v_fma_f32 v208,v208,s26,-v20
v_fma_f32 v209,v209,s26,-v20
v_mfma_f32_16x16x32_bf16 v[56:59],a[144:147],v[168:171],0
v_fma_f32 v210,v210,s26,-v20
v_mfma_f32_16x16x32_bf16 v[56:59],a[148:151],v[172:175],v[56:59]
ds_read_b128 a[116:119],v3 offset:33792
v_exp_f32 v206,v206
v_fma_f32 v211,v211,s26,-v20
v_mfma_f32_16x16x32_bf16 v[40:43],a[148:151],v[164:167],0
v_fma_f32 v212,v212,s26,-v20
v_mfma_f32_16x16x32_bf16 v[40:43],a[144:147],v[160:163],v[40:43]
v_exp_f32 v207,v207
v_exp_f32 v208,v208
v_fma_f32 v213,v213,s26,-v20
v_mfma_f32_16x16x32_bf16 v[44:47],a[152:155],v[160:163],0
v_cvt_pk_bf16_f32 v239,v206,v207
v_mfma_f32_16x16x32_bf16 v[44:47],a[156:159],v[164:167],v[44:47]
ds_read_b128 a[120:123],v4 offset:33792
v_exp_f32 v209,v209
v_fma_f32 v214,v214,s26,-v20
v_mfma_f32_16x16x32_bf16 v[60:63],a[156:159],v[172:175],0
v_cvt_pk_bf16_f32 v244,v208,v209
v_mfma_f32_16x16x32_bf16 v[60:63],a[152:155],v[168:171],v[60:63]
buffer_load_dwordx4 v1,s[8:11],s21 offen offset:2048 nt lds
v_exp_f32 v210,v210
v_mfma_f32_16x16x32_bf16 v[76:79],a[152:155],v[176:179],0
v_fma_f32 v215,v215,s26,-v20
v_mfma_f32_16x16x32_bf16 v[76:79],a[156:159],v[180:183],v[76:79]
ds_read_b128 a[124:127],v5 offset:33792
v_exp_f32 v211,v211
v_fma_f32 v216,v216,s26,-v21
v_mfma_f32_16x16x32_bf16 v[92:95],a[156:159],v[188:191],0
v_cvt_pk_bf16_f32 v245,v210,v211
v_mfma_f32_16x16x32_bf16 v[92:95],a[152:155],v[184:187],v[92:95]
s_waitcnt lgkmcnt(4)
v_exp_f32 v212,v212
v_exp_f32 v213,v213
v_mfma_f32_16x16x32_bf16 v[160:163],a[96:99],a[0:3],0
ds_read_b128 a[128:131],v2 offset:34816
v_cvt_pk_bf16_f32 v246,v212,v213
v_mfma_f32_16x16x32_bf16 v[160:163],a[100:103],a[4:7],v[160:163]
v_fma_f32 v217,v217,s26,-v21
v_mfma_f32_16x16x32_bf16 v[160:163],a[104:107],a[8:11],v[160:163]
v_fma_f32 v218,v218,s26,-v21
v_mfma_f32_16x16x32_bf16 v[160:163],a[108:111],a[12:15],v[160:163]
buffer_load_dwordx4 v1,s[8:11],s21 offen offset:3072 nt lds
v_exp_f32 v214,v214
v_mfma_f32_16x16x32_bf16 v[168:171],a[108:111],a[28:31],0
s_add_u32 s21,s21,16384
ds_read_b128 a[132:135],v3 offset:34816
v_mfma_f32_16x16x32_bf16 v[168:171],a[104:107],a[24:27],v[168:171]
v_fma_f32 v219,v219,s26,-v21
v_mfma_f32_16x16x32_bf16 v[168:171],a[100:103],a[20:23],v[168:171]
v_fma_f32 v220,v220,s26,-v21
v_mfma_f32_16x16x32_bf16 v[168:171],a[96:99],a[16:19],v[168:171]
v_exp_f32 v215,v215
v_exp_f32 v216,v216
v_mfma_f32_16x16x32_bf16 v[176:179],a[96:99],a[32:35],0
ds_read_b128 a[136:139],v4 offset:34816
v_cvt_pk_bf16_f32 v247,v214,v215
v_mfma_f32_16x16x32_bf16 v[176:179],a[100:103],a[36:39],v[176:179]
v_fma_f32 v221,v221,s26,-v21
v_mfma_f32_16x16x32_bf16 v[176:179],a[104:107],a[40:43],v[176:179]
v_fma_f32 v222,v222,s26,-v21
v_mfma_f32_16x16x32_bf16 v[176:179],a[108:111],a[44:47],v[176:179]
ds_read_b128 a[140:143],v5 offset:34816
v_exp_f32 v217,v217
v_fma_f32 v223,v223,s26,-v21
v_mfma_f32_16x16x32_bf16 v[184:187],a[108:111],a[60:63],0
v_cvt_pk_bf16_f32 v252,v216,v217
v_mfma_f32_16x16x32_bf16 v[184:187],a[104:107],a[56:59],v[184:187]
v_mfma_f32_16x16x32_bf16 v[184:187],a[100:103],a[52:55],v[184:187]
s_waitcnt lgkmcnt(4)
v_mfma_f32_16x16x32_bf16 v[184:187],a[96:99],a[48:51],v[184:187]
ds_read_b128 a[144:147],v2 offset:35840
v_exp_f32 v218,v218
v_exp_f32 v219,v219
v_mfma_f32_16x16x32_bf16 v[164:167],a[112:115],a[0:3],0
v_cvt_pk_bf16_f32 v253,v218,v219
v_mfma_f32_16x16x32_bf16 v[164:167],a[116:119],a[4:7],v[164:167]
v_mfma_f32_16x16x32_bf16 v[164:167],a[120:123],a[8:11],v[164:167]
v_mfma_f32_16x16x32_bf16 v[164:167],a[124:127],a[12:15],v[164:167]
ds_read_b128 a[148:151],v3 offset:35840
v_exp_f32 v220,v220
v_mfma_f32_16x16x32_bf16 v[172:175],a[124:127],a[28:31],0
v_mfma_f32_16x16x32_bf16 v[172:175],a[120:123],a[24:27],v[172:175]
v_mfma_f32_16x16x32_bf16 v[172:175],a[116:119],a[20:23],v[172:175]
s_add_u32 m0,s25,114688
ds_read_b128 a[152:155],v4 offset:35840
v_mfma_f32_16x16x32_bf16 v[172:175],a[112:115],a[16:19],v[172:175]
buffer_load_dwordx4 v1,s[12:15],s22 offen nt lds
v_exp_f32 v221,v221
v_mfma_f32_16x16x32_bf16 v[180:183],a[112:115],a[32:35],0
v_cvt_pk_bf16_f32 v254,v220,v221
v_mfma_f32_16x16x32_bf16 v[180:183],a[116:119],a[36:39],v[180:183]
v_mfma_f32_16x16x32_bf16 v[180:183],a[120:123],a[40:43],v[180:183]
ds_read_b128 a[156:159],v5 offset:35840
v_mfma_f32_16x16x32_bf16 v[180:183],a[124:127],a[44:47],v[180:183]
v_exp_f32 v222,v222
v_exp_f32 v223,v223
v_mfma_f32_16x16x32_bf16 v[188:191],a[124:127],a[60:63],0
v_cvt_pk_bf16_f32 v255,v222,v223
v_mfma_f32_16x16x32_bf16 v[188:191],a[120:123],a[56:59],v[188:191]
v_mfma_f32_16x16x32_bf16 v[188:191],a[116:119],a[52:55],v[188:191]
v_mfma_f32_16x16x32_bf16 v[188:191],a[112:115],a[48:51],v[188:191]
s_waitcnt lgkmcnt(4)
v_mfma_f32_16x16x32_bf16 v[192:195],a[128:131],a[0:3],0
v_accvgpr_read_b32 v23,a244
v_mfma_f32_16x16x32_bf16 v[192:195],a[132:135],a[4:7],v[192:195]
v_accvgpr_read_b32 v24,a245
v_mfma_f32_16x16x32_bf16 v[192:195],a[136:139],a[8:11],v[192:195]
v_fma_f32 v160,v160,s26,-v18
v_mfma_f32_16x16x32_bf16 v[192:195],a[140:143],a[12:15],v[192:195]
buffer_load_dwordx4 v1,s[12:15],s22 offen offset:1024 nt lds
v_exp_f32 v160,v160
v_mfma_f32_16x16x32_bf16 v[200:203],a[140:143],a[28:31],0
ds_write_b128 v23,v[96:99] offset:0
v_fma_f32 v161,v161,s26,-v18
v_mfma_f32_16x16x32_bf16 v[200:203],a[136:139],a[24:27],v[200:203]
ds_read_b64_tr_b16 a[96:97],v6 offset:16384
v_fma_f32 v162,v162,s26,-v18
v_mfma_f32_16x16x32_bf16 v[200:203],a[132:135],a[20:23],v[200:203]
ds_read_b64_tr_b16 a[98:99],v6 offset:17408
v_fma_f32 v163,v163,s26,-v18
v_mfma_f32_16x16x32_bf16 v[200:203],a[128:131],a[16:19],v[200:203]
ds_write_b128 v23,v[100:103] offset:64
v_exp_f32 v161,v161
v_fma_f32 v164,v164,s26,-v18
v_mfma_f32_16x16x32_bf16 v[208:211],a[128:131],a[32:35],0
ds_read_b64_tr_b16 a[100:101],v6 offset:18432
v_cvt_pk_bf16_f32 v160,v160,v161
v_mfma_f32_16x16x32_bf16 v[208:211],a[132:135],a[36:39],v[208:211]
ds_read_b64_tr_b16 a[102:103],v6 offset:19456
v_fma_f32 v165,v165,s26,-v18
v_mfma_f32_16x16x32_bf16 v[208:211],a[136:139],a[40:43],v[208:211]
ds_write_b128 v23,v[104:107] offset:128
v_fma_f32 v166,v166,s26,-v18
v_mfma_f32_16x16x32_bf16 v[208:211],a[140:143],a[44:47],v[208:211]
buffer_load_dwordx4 v1,s[12:15],s22 offen offset:2048 nt lds
v_exp_f32 v162,v162
v_mfma_f32_16x16x32_bf16 v[216:219],a[140:143],a[60:63],0
ds_read_b64_tr_b16 a[104:105],v6 offset:16392
v_fma_f32 v167,v167,s26,-v18
v_mfma_f32_16x16x32_bf16 v[216:219],a[136:139],a[56:59],v[216:219]
ds_read_b64_tr_b16 a[106:107],v6 offset:17416
v_fma_f32 v168,v168,s26,-v19
v_mfma_f32_16x16x32_bf16 v[216:219],a[132:135],a[52:55],v[216:219]
ds_write_b128 v23,v[108:111] offset:192
v_fma_f32 v169,v169,s26,-v19
v_mfma_f32_16x16x32_bf16 v[216:219],a[128:131],a[48:51],v[216:219]
s_waitcnt lgkmcnt(10)
ds_read_b128 v[96:99],v24 offset:0
v_exp_f32 v163,v163
v_mfma_f32_16x16x32_bf16 v[196:199],a[144:147],a[0:3],0
ds_read_b64_tr_b16 a[108:109],v6 offset:18440
v_cvt_pk_bf16_f32 v161,v162,v163
v_mfma_f32_16x16x32_bf16 v[196:199],a[148:151],a[4:7],v[196:199]
ds_read_b64_tr_b16 a[110:111],v6 offset:19464
v_fma_f32 v170,v170,s26,-v19
v_mfma_f32_16x16x32_bf16 v[196:199],a[152:155],a[8:11],v[196:199]
ds_read_b128 v[100:103],v24 offset:1088
v_fma_f32 v171,v171,s26,-v19
v_mfma_f32_16x16x32_bf16 v[196:199],a[156:159],a[12:15],v[196:199]
ds_read_b64_tr_b16 a[112:113],v7 offset:16384
v_exp_f32 v164,v164
v_fma_f32 v172,v172,s26,-v19
v_mfma_f32_16x16x32_bf16 v[204:207],a[156:159],a[28:31],0
s_waitcnt lgkmcnt(14)
ds_read_b64_tr_b16 a[114:115],v7 offset:17408
v_fma_f32 v173,v173,s26,-v19
v_mfma_f32_16x16x32_bf16 v[204:207],a[152:155],a[24:27],v[204:207]
s_waitcnt lgkmcnt(14)
ds_read_b128 v[104:107],v24 offset:2176
v_fma_f32 v174,v174,s26,-v19
v_mfma_f32_16x16x32_bf16 v[204:207],a[148:151],a[20:23],v[204:207]
s_waitcnt lgkmcnt(14)
ds_read_b128 v[108:111],v24 offset:3264
v_fma_f32 v175,v175,s26,-v19
v_mfma_f32_16x16x32_bf16 v[204:207],a[144:147],a[16:19],v[204:207]
s_waitcnt lgkmcnt(14)
ds_read_b64_tr_b16 a[116:117],v7 offset:18432
v_exp_f32 v165,v165
v_fma_f32 v176,v176,s26,-v20
v_mfma_f32_16x16x32_bf16 v[212:215],a[144:147],a[32:35],0
s_waitcnt lgkmcnt(14)
ds_read_b64_tr_b16 a[118:119],v7 offset:19456
v_cvt_pk_bf16_f32 v162,v164,v165
v_mfma_f32_16x16x32_bf16 v[212:215],a[148:151],a[36:39],v[212:215]
v_fma_f32 v177,v177,s26,-v20
v_mfma_f32_16x16x32_bf16 v[212:215],a[152:155],a[40:43],v[212:215]
v_fma_f32 v178,v178,s26,-v20
v_mfma_f32_16x16x32_bf16 v[212:215],a[156:159],a[44:47],v[212:215]
s_waitcnt lgkmcnt(14)
ds_read_b64_tr_b16 a[120:121],v7 offset:16392
v_exp_f32 v166,v166
v_exp_f32 v167,v167
v_mfma_f32_16x16x32_bf16 v[220:223],a[156:159],a[60:63],0
s_waitcnt lgkmcnt(14)
ds_read_b64_tr_b16 a[122:123],v7 offset:17416
v_cvt_pk_bf16_f32 v163,v166,v167
v_mfma_f32_16x16x32_bf16 v[220:223],a[152:155],a[56:59],v[220:223]
v_fma_f32 v179,v179,s26,-v20
v_mfma_f32_16x16x32_bf16 v[220:223],a[148:151],a[52:55],v[220:223]
s_waitcnt lgkmcnt(14)
ds_read_b64_tr_b16 a[124:125],v7 offset:18440
v_fma_f32 v180,v180,s26,-v20
v_mfma_f32_16x16x32_bf16 v[220:223],a[144:147],a[48:51],v[220:223]
s_waitcnt lgkmcnt(14)
ds_read_b64_tr_b16 a[126:127],v7 offset:19464
v_exp_f32 v168,v168
v_fma_f32 v181,v181,s26,-v20
v_mfma_f32_16x16x32_bf16 a[224:227],a[240:243],v[224:227],a[224:227]
v_fma_f32 v182,v182,s26,-v20
v_mfma_f32_16x16x32_bf16 a[224:227],a[240:243],v[228:231],a[224:227]
buffer_load_dwordx4 v1,s[12:15],s22 offen offset:3072 nt lds
v_exp_f32 v169,v169
v_mfma_f32_16x16x32_bf16 a[228:231],a[240:243],v[232:235],a[228:231]
s_add_u32 s22,s22,16384
s_waitcnt lgkmcnt(14)
ds_read_b64_tr_b16 a[128:129],v8 offset:16384
v_mfma_f32_16x16x32_bf16 a[228:231],a[240:243],v[236:239],a[228:231]
s_waitcnt lgkmcnt(14)
ds_read_b64_tr_b16 a[130:131],v8 offset:17408
v_cvt_pk_bf16_f32 v168,v168,v169
v_exp_f32 v170,v170
v_mfma_f32_16x16x32_bf16 a[232:235],a[240:243],v[240:243],a[232:235]
v_fma_f32 v183,v183,s26,-v20
v_mfma_f32_16x16x32_bf16 a[232:235],a[240:243],v[244:247],a[232:235]
v_exp_f32 v171,v171
v_exp_f32 v172,v172
v_mfma_f32_16x16x32_bf16 a[236:239],a[240:243],v[248:251],a[236:239]
s_waitcnt lgkmcnt(14)
ds_read_b64_tr_b16 a[132:133],v8 offset:18432
v_cvt_pk_bf16_f32 v169,v170,v171
v_mfma_f32_16x16x32_bf16 a[236:239],a[240:243],v[252:255],a[236:239]
s_waitcnt lgkmcnt(14)
ds_read_b64_tr_b16 a[134:135],v8 offset:19456
v_exp_f32 v173,v173
v_fma_f32 v184,v184,s26,-v21
v_mfma_f32_16x16x32_bf16 v[80:83],a[96:99],v[248:251],v[80:83]
v_cvt_pk_bf16_f32 v170,v172,v173
v_mfma_f32_16x16x32_bf16 v[80:83],a[100:103],v[252:255],v[80:83]
s_waitcnt lgkmcnt(14)
ds_read_b64_tr_b16 a[136:137],v8 offset:16392
v_exp_f32 v174,v174
v_fma_f32 v185,v185,s26,-v21
v_mfma_f32_16x16x32_bf16 v[64:67],a[100:103],v[244:247],v[64:67]
s_add_u32 s30,s24,0
s_add_u32 s32,s24,4096
s_waitcnt lgkmcnt(14)
ds_read_b64_tr_b16 a[138:139],v8 offset:17416
v_mfma_f32_16x16x32_bf16 v[64:67],a[96:99],v[240:243],v[64:67]
buffer_store_dwordx4 v[96:99],v22,s[16:19],s30 offen sc0 sc1
buffer_store_dwordx4 v[100:103],v22,s[16:19],s32 offen sc0 sc1
v_exp_f32 v175,v175
v_mfma_f32_16x16x32_bf16 v[48:51],a[96:99],v[232:235],v[48:51]
v_cvt_pk_bf16_f32 v171,v174,v175
v_mfma_f32_16x16x32_bf16 v[48:51],a[100:103],v[236:239],v[48:51]
s_waitcnt lgkmcnt(14)
ds_read_b64_tr_b16 a[140:141],v8 offset:18440
v_exp_f32 v176,v176
v_fma_f32 v186,v186,s26,-v21
v_mfma_f32_16x16x32_bf16 v[32:35],a[100:103],v[228:231],v[32:35]
s_waitcnt lgkmcnt(14)
ds_read_b64_tr_b16 a[142:143],v8 offset:19464
v_fma_f32 v187,v187,s26,-v21
v_mfma_f32_16x16x32_bf16 v[32:35],a[96:99],v[224:227],v[32:35]
v_exp_f32 v177,v177
v_exp_f32 v178,v178
v_mfma_f32_16x16x32_bf16 v[36:39],a[104:107],v[224:227],v[36:39]
v_cvt_pk_bf16_f32 v176,v176,v177
v_mfma_f32_16x16x32_bf16 v[36:39],a[108:111],v[228:231],v[36:39]
s_waitcnt lgkmcnt(14)
ds_read_b64_tr_b16 a[144:145],v9 offset:16384
v_exp_f32 v179,v179
v_fma_f32 v188,v188,s26,-v21
v_mfma_f32_16x16x32_bf16 v[52:55],a[108:111],v[236:239],v[52:55]
s_waitcnt lgkmcnt(14)
ds_read_b64_tr_b16 a[146:147],v9 offset:17408
v_cvt_pk_bf16_f32 v177,v178,v179
v_mfma_f32_16x16x32_bf16 v[52:55],a[104:107],v[232:235],v[52:55]
v_exp_f32 v180,v180
v_exp_f32 v181,v181
v_mfma_f32_16x16x32_bf16 v[68:71],a[104:107],v[240:243],v[68:71]
s_waitcnt lgkmcnt(14)
ds_read_b64_tr_b16 a[148:149],v9 offset:18432
v_cvt_pk_bf16_f32 v178,v180,v181
v_mfma_f32_16x16x32_bf16 v[68:71],a[108:111],v[244:247],v[68:71]
s_waitcnt lgkmcnt(14)
ds_read_b64_tr_b16 a[150:151],v9 offset:19456
v_exp_f32 v182,v182
v_fma_f32 v189,v189,s26,-v21
v_mfma_f32_16x16x32_bf16 v[84:87],a[108:111],v[252:255],v[84:87]
v_fma_f32 v190,v190,s26,-v21
v_mfma_f32_16x16x32_bf16 v[84:87],a[104:107],v[248:251],v[84:87]
v_exp_f32 v183,v183
v_exp_f32 v184,v184
v_fma_f32 v191,v191,s26,-v21
v_mfma_f32_16x16x32_bf16 v[88:91],a[112:115],v[248:251],v[88:91]
s_waitcnt lgkmcnt(14)
ds_read_b64_tr_b16 a[152:153],v9 offset:16392
v_cvt_pk_bf16_f32 v179,v182,v183
v_mfma_f32_16x16x32_bf16 v[88:91],a[116:119],v[252:255],v[88:91]
s_waitcnt lgkmcnt(14)
ds_read_b64_tr_b16 a[154:155],v9 offset:17416
v_exp_f32 v185,v185
v_mfma_f32_16x16x32_bf16 v[72:75],a[116:119],v[244:247],v[72:75]
v_cvt_pk_bf16_f32 v184,v184,v185
v_mfma_f32_16x16x32_bf16 v[72:75],a[112:115],v[240:243],v[72:75]
s_waitcnt lgkmcnt(14)
ds_read_b64_tr_b16 a[156:157],v9 offset:18440
v_exp_f32 v186,v186
v_mfma_f32_16x16x32_bf16 v[56:59],a[112:115],v[232:235],v[56:59]
s_add_u32 s30,s24,8192
s_add_u32 s32,s24,12288
s_waitcnt lgkmcnt(14)
ds_read_b64_tr_b16 a[158:159],v9 offset:19464
v_mfma_f32_16x16x32_bf16 v[56:59],a[116:119],v[236:239],v[56:59]
buffer_store_dwordx4 v[104:107],v22,s[16:19],s30 offen sc0 sc1
buffer_store_dwordx4 v[108:111],v22,s[16:19],s32 offen sc0 sc1
v_exp_f32 v187,v187
v_mfma_f32_16x16x32_bf16 v[40:43],a[116:119],v[228:231],v[40:43]
v_cvt_pk_bf16_f32 v185,v186,v187
v_mfma_f32_16x16x32_bf16 v[40:43],a[112:115],v[224:227],v[40:43]
v_exp_f32 v188,v188
v_exp_f32 v189,v189
v_mfma_f32_16x16x32_bf16 v[44:47],a[120:123],v[224:227],v[44:47]
v_cvt_pk_bf16_f32 v186,v188,v189
v_mfma_f32_16x16x32_bf16 v[44:47],a[124:127],v[228:231],v[44:47]
v_exp_f32 v190,v190
v_exp_f32 v191,v191
v_mfma_f32_16x16x32_bf16 v[60:63],a[124:127],v[236:239],v[60:63]
v_cvt_pk_bf16_f32 v187,v190,v191
v_mfma_f32_16x16x32_bf16 v[60:63],a[120:123],v[232:235],v[60:63]
v_mfma_f32_16x16x32_bf16 v[76:79],a[120:123],v[240:243],v[76:79]
v_fma_f32 v192,v192,s26,-v18
v_mfma_f32_16x16x32_bf16 v[76:79],a[124:127],v[244:247],v[76:79]
v_exp_f32 v192,v192
v_fma_f32 v193,v193,s26,-v18
v_fma_f32 v194,v194,s26,-v18
v_mfma_f32_16x16x32_bf16 v[92:95],a[124:127],v[252:255],v[92:95]
v_fma_f32 v195,v195,s26,-v18
v_mfma_f32_16x16x32_bf16 v[92:95],a[120:123],v[248:251],v[92:95]
s_waitcnt lgkmcnt(12)
v_exp_f32 v193,v193
v_exp_f32 v194,v194
v_mfma_f32_16x16x32_bf16 a[208:211],a[128:131],v[248:251],a[208:211]
v_cvt_pk_bf16_f32 v164,v192,v193
v_mfma_f32_16x16x32_bf16 a[208:211],a[132:135],v[252:255],a[208:211]
v_exp_f32 v195,v195
v_fma_f32 v196,v196,s26,-v18
v_fma_f32 v197,v197,s26,-v18
v_mfma_f32_16x16x32_bf16 a[192:195],a[132:135],v[244:247],a[192:195]
v_cvt_pk_bf16_f32 v165,v194,v195
v_mfma_f32_16x16x32_bf16 a[192:195],a[128:131],v[240:243],a[192:195]
s_waitcnt vmcnt(16)
s_waitcnt lgkmcnt(0)
s_barrier
ds_read_b128 a[96:99],v2 offset:49152
v_exp_f32 v196,v196
v_fma_f32 v198,v198,s26,-v18
v_mfma_f32_16x16x32_bf16 a[176:179],a[128:131],v[232:235],a[176:179]
s_add_u32 m0,s25,16384
v_fma_f32 v199,v199,s26,-v18
v_mfma_f32_16x16x32_bf16 a[176:179],a[132:135],v[236:239],a[176:179]
buffer_load_dwordx4 v1,s[8:11],s21 offen nt lds
v_exp_f32 v197,v197
v_mfma_f32_16x16x32_bf16 a[160:163],a[132:135],v[228:231],a[160:163]
v_cvt_pk_bf16_f32 v166,v196,v197
v_mfma_f32_16x16x32_bf16 a[160:163],a[128:131],v[224:227],a[160:163]
ds_read_b128 a[100:103],v3 offset:49152
v_exp_f32 v198,v198
v_fma_f32 v200,v200,s26,-v19
v_mfma_f32_16x16x32_bf16 a[164:167],a[136:139],v[224:227],a[164:167]
v_fma_f32 v201,v201,s26,-v19
v_mfma_f32_16x16x32_bf16 a[164:167],a[140:143],v[228:231],a[164:167]
ds_read_b128 a[64:67],v10 offset:16384
v_exp_f32 v199,v199
v_exp_f32 v200,v200
v_mfma_f32_16x16x32_bf16 a[180:183],a[140:143],v[236:239],a[180:183]
ds_read_b128 a[104:107],v4 offset:49152
v_cvt_pk_bf16_f32 v167,v198,v199
v_mfma_f32_16x16x32_bf16 a[180:183],a[136:139],v[232:235],a[180:183]
v_exp_f32 v201,v201
v_fma_f32 v202,v202,s26,-v19
v_fma_f32 v203,v203,s26,-v19
v_mfma_f32_16x16x32_bf16 a[196:199],a[136:139],v[240:243],a[196:199]
v_cvt_pk_bf16_f32 v172,v200,v201
v_mfma_f32_16x16x32_bf16 a[196:199],a[140:143],v[244:247],a[196:199]
buffer_load_dwordx4 v1,s[8:11],s21 offen offset:1024 nt lds
v_exp_f32 v202,v202
v_mfma_f32_16x16x32_bf16 a[212:215],a[140:143],v[252:255],a[212:215]
ds_read_b128 a[108:111],v5 offset:49152
v_fma_f32 v204,v204,s26,-v19
v_mfma_f32_16x16x32_bf16 a[212:215],a[136:139],v[248:251],a[212:215]
v_exp_f32 v203,v203
v_exp_f32 v204,v204
v_mfma_f32_16x16x32_bf16 a[216:219],a[144:147],v[248:251],a[216:219]
v_cvt_pk_bf16_f32 v173,v202,v203
v_mfma_f32_16x16x32_bf16 a[216:219],a[148:151],v[252:255],a[216:219]
v_fma_f32 v205,v205,s26,-v19
v_fma_f32 v206,v206,s26,-v19
v_fma_f32 v207,v207,s26,-v19
v_fma_f32 v208,v208,s26,-v20
v_mfma_f32_16x16x32_bf16 a[200:203],a[148:151],v[244:247],a[200:203]
ds_read_b128 a[112:115],v2 offset:50176
v_fma_f32 v209,v209,s26,-v20
v_mfma_f32_16x16x32_bf16 a[200:203],a[144:147],v[240:243],a[200:203]
v_exp_f32 v205,v205
v_exp_f32 v206,v206
v_mfma_f32_16x16x32_bf16 a[184:187],a[144:147],v[232:235],a[184:187]
v_cvt_pk_bf16_f32 v174,v204,v205
v_mfma_f32_16x16x32_bf16 a[184:187],a[148:151],v[236:239],a[184:187]
ds_read_b128 a[116:119],v3 offset:50176
v_exp_f32 v207,v207
v_fma_f32 v210,v210,s26,-v20
v_mfma_f32_16x16x32_bf16 a[168:171],a[148:151],v[228:231],a[168:171]
ds_read_b128 a[68:71],v11 offset:16384
v_cvt_pk_bf16_f32 v175,v206,v207
v_mfma_f32_16x16x32_bf16 a[168:171],a[144:147],v[224:227],a[168:171]
v_exp_f32 v208,v208
v_exp_f32 v209,v209
v_mfma_f32_16x16x32_bf16 a[172:175],a[152:155],v[224:227],a[172:175]
v_cvt_pk_bf16_f32 v180,v208,v209
v_mfma_f32_16x16x32_bf16 a[172:175],a[156:159],v[228:231],a[172:175]
ds_read_b128 a[120:123],v4 offset:50176
v_fma_f32 v211,v211,s26,-v20
v_exp_f32 v210,v210
v_mfma_f32_16x16x32_bf16 a[188:191],a[156:159],v[236:239],a[188:191]
v_fma_f32 v212,v212,s26,-v20
v_mfma_f32_16x16x32_bf16 a[188:191],a[152:155],v[232:235],a[188:191]
buffer_load_dwordx4 v1,s[8:11],s21 offen offset:2048 nt lds
v_exp_f32 v211,v211
v_mfma_f32_16x16x32_bf16 a[204:207],a[152:155],v[240:243],a[204:207]
v_cvt_pk_bf16_f32 v181,v210,v211
v_mfma_f32_16x16x32_bf16 a[204:207],a[156:159],v[244:247],a[204:207]
ds_read_b128 a[124:127],v5 offset:50176
v_fma_f32 v213,v213,s26,-v20
v_exp_f32 v212,v212
v_mfma_f32_16x16x32_bf16 a[220:223],a[156:159],v[252:255],a[220:223]
v_fma_f32 v214,v214,s26,-v20
v_mfma_f32_16x16x32_bf16 a[220:223],a[152:155],v[248:251],a[220:223]
s_waitcnt lgkmcnt(5)
v_exp_f32 v213,v213
v_exp_f32 v214,v214
v_mfma_f32_16x16x32_bf16 v[224:227],a[96:99],a[0:3],0
ds_read_b128 a[128:131],v2 offset:51200
v_cvt_pk_bf16_f32 v182,v212,v213
v_mfma_f32_16x16x32_bf16 v[224:227],a[100:103],a[4:7],v[224:227]
v_fma_f32 v215,v215,s26,-v20
v_mfma_f32_16x16x32_bf16 v[224:227],a[104:107],a[8:11],v[224:227]
ds_read_b128 a[72:75],v12 offset:16384
v_fma_f32 v216,v216,s26,-v21
v_mfma_f32_16x16x32_bf16 v[224:227],a[108:111],a[12:15],v[224:227]
buffer_load_dwordx4 v1,s[8:11],s21 offen offset:3072 nt lds
v_exp_f32 v215,v215
v_mfma_f32_16x16x32_bf16 v[232:235],a[108:111],a[28:31],0
s_add_u32 s21,s21,16384
ds_read_b128 a[132:135],v3 offset:51200
v_mfma_f32_16x16x32_bf16 v[232:235],a[104:107],a[24:27],v[232:235]
v_cvt_pk_bf16_f32 v183,v214,v215
v_mfma_f32_16x16x32_bf16 v[232:235],a[100:103],a[20:23],v[232:235]
v_fma_f32 v217,v217,s26,-v21
v_mfma_f32_16x16x32_bf16 v[232:235],a[96:99],a[16:19],v[232:235]
v_exp_f32 v216,v216
v_exp_f32 v217,v217
v_fma_f32 v218,v218,s26,-v21
v_mfma_f32_16x16x32_bf16 v[240:243],a[96:99],a[32:35],0
ds_read_b128 a[136:139],v4 offset:51200
v_cvt_pk_bf16_f32 v188,v216,v217
v_mfma_f32_16x16x32_bf16 v[240:243],a[100:103],a[36:39],v[240:243]
v_fma_f32 v219,v219,s26,-v21
v_mfma_f32_16x16x32_bf16 v[240:243],a[104:107],a[40:43],v[240:243]
v_fma_f32 v220,v220,s26,-v21
v_mfma_f32_16x16x32_bf16 v[240:243],a[108:111],a[44:47],v[240:243]
ds_read_b128 a[140:143],v5 offset:51200
v_exp_f32 v218,v218
v_fma_f32 v221,v221,s26,-v21
v_mfma_f32_16x16x32_bf16 v[248:251],a[108:111],a[60:63],0
v_fma_f32 v222,v222,s26,-v21
v_mfma_f32_16x16x32_bf16 v[248:251],a[104:107],a[56:59],v[248:251]
s_waitcnt lgkmcnt(5)
v_fma_f32 v223,v223,s26,-v21
v_mfma_f32_16x16x32_bf16 v[248:251],a[100:103],a[52:55],v[248:251]
ds_read_b128 a[76:79],v13 offset:16384
v_mfma_f32_16x16x32_bf16 v[248:251],a[96:99],a[48:51],v[248:251]
ds_read_b128 a[144:147],v2 offset:52224
v_exp_f32 v219,v219
v_mfma_f32_16x16x32_bf16 v[228:231],a[112:115],a[0:3],0
v_cvt_pk_bf16_f32 v189,v218,v219
v_mfma_f32_16x16x32_bf16 v[228:231],a[116:119],a[4:7],v[228:231]
v_mfma_f32_16x16x32_bf16 v[228:231],a[120:123],a[8:11],v[228:231]
v_mfma_f32_16x16x32_bf16 v[228:231],a[124:127],a[12:15],v[228:231]
ds_read_b128 a[148:151],v3 offset:52224
v_exp_f32 v220,v220
v_mfma_f32_16x16x32_bf16 v[236:239],a[124:127],a[28:31],0
v_mfma_f32_16x16x32_bf16 v[236:239],a[120:123],a[24:27],v[236:239]
v_mfma_f32_16x16x32_bf16 v[236:239],a[116:119],a[20:23],v[236:239]
s_add_u32 m0,s25,65536
ds_read_b128 a[152:155],v4 offset:52224
v_mfma_f32_16x16x32_bf16 v[236:239],a[112:115],a[16:19],v[236:239]
buffer_load_dwordx4 v1,s[12:15],s22 offen nt lds
v_exp_f32 v221,v221
v_mfma_f32_16x16x32_bf16 v[244:247],a[112:115],a[32:35],0
v_cvt_pk_bf16_f32 v190,v220,v221
v_mfma_f32_16x16x32_bf16 v[244:247],a[116:119],a[36:39],v[244:247]
v_mfma_f32_16x16x32_bf16 v[244:247],a[120:123],a[40:43],v[244:247]
ds_read_b128 a[156:159],v5 offset:52224
v_mfma_f32_16x16x32_bf16 v[244:247],a[124:127],a[44:47],v[244:247]
v_exp_f32 v222,v222
v_exp_f32 v223,v223
v_mfma_f32_16x16x32_bf16 v[252:255],a[124:127],a[60:63],0
v_cvt_pk_bf16_f32 v191,v222,v223
v_mfma_f32_16x16x32_bf16 v[252:255],a[120:123],a[56:59],v[252:255]
v_mfma_f32_16x16x32_bf16 v[252:255],a[116:119],a[52:55],v[252:255]
v_mfma_f32_16x16x32_bf16 v[252:255],a[112:115],a[48:51],v[252:255]
s_waitcnt lgkmcnt(5)
v_mfma_f32_16x16x32_bf16 v[192:195],a[128:131],a[0:3],0
v_accvgpr_read_b32 v23,a244
v_mfma_f32_16x16x32_bf16 v[192:195],a[132:135],a[4:7],v[192:195]
v_accvgpr_read_b32 v24,a245
v_mfma_f32_16x16x32_bf16 v[192:195],a[136:139],a[8:11],v[192:195]
v_fma_f32 v224,v224,s26,-v18
v_mfma_f32_16x16x32_bf16 v[192:195],a[140:143],a[12:15],v[192:195]
buffer_load_dwordx4 v1,s[12:15],s22 offen offset:1024 nt lds
v_exp_f32 v224,v224
v_mfma_f32_16x16x32_bf16 v[200:203],a[140:143],a[28:31],0
ds_write_b128 v23,v[112:115] offset:16384
v_fma_f32 v225,v225,s26,-v18
v_mfma_f32_16x16x32_bf16 v[200:203],a[136:139],a[24:27],v[200:203]
ds_read_b64_tr_b16 a[96:97],v6 offset:32768
v_fma_f32 v226,v226,s26,-v18
v_mfma_f32_16x16x32_bf16 v[200:203],a[132:135],a[20:23],v[200:203]
ds_read_b64_tr_b16 a[98:99],v6 offset:33792
v_fma_f32 v227,v227,s26,-v18
v_mfma_f32_16x16x32_bf16 v[200:203],a[128:131],a[16:19],v[200:203]
ds_write_b128 v23,v[116:119] offset:16448
v_exp_f32 v225,v225
v_fma_f32 v228,v228,s26,-v18
v_mfma_f32_16x16x32_bf16 v[208:211],a[128:131],a[32:35],0
ds_read_b64_tr_b16 a[100:101],v6 offset:34816
v_cvt_pk_bf16_f32 v224,v224,v225
v_mfma_f32_16x16x32_bf16 v[208:211],a[132:135],a[36:39],v[208:211]
ds_read_b64_tr_b16 a[102:103],v6 offset:35840
v_fma_f32 v229,v229,s26,-v18
v_mfma_f32_16x16x32_bf16 v[208:211],a[136:139],a[40:43],v[208:211]
ds_write_b128 v23,v[120:123] offset:16512
v_fma_f32 v230,v230,s26,-v18
v_mfma_f32_16x16x32_bf16 v[208:211],a[140:143],a[44:47],v[208:211]
buffer_load_dwordx4 v1,s[12:15],s22 offen offset:2048 nt lds
v_exp_f32 v226,v226
v_mfma_f32_16x16x32_bf16 v[216:219],a[140:143],a[60:63],0
ds_read_b64_tr_b16 a[104:105],v6 offset:32776
v_fma_f32 v231,v231,s26,-v18
v_mfma_f32_16x16x32_bf16 v[216:219],a[136:139],a[56:59],v[216:219]
ds_read_b64_tr_b16 a[106:107],v6 offset:33800
v_fma_f32 v232,v232,s26,-v19
v_mfma_f32_16x16x32_bf16 v[216:219],a[132:135],a[52:55],v[216:219]
ds_write_b128 v23,v[124:127] offset:16576
v_fma_f32 v233,v233,s26,-v19
v_mfma_f32_16x16x32_bf16 v[216:219],a[128:131],a[48:51],v[216:219]
s_waitcnt lgkmcnt(10)
ds_read_b128 v[112:115],v24 offset:16384
v_exp_f32 v227,v227
v_mfma_f32_16x16x32_bf16 v[196:199],a[144:147],a[0:3],0
ds_read_b64_tr_b16 a[108:109],v6 offset:34824
v_cvt_pk_bf16_f32 v225,v226,v227
v_mfma_f32_16x16x32_bf16 v[196:199],a[148:151],a[4:7],v[196:199]
ds_read_b64_tr_b16 a[110:111],v6 offset:35848
v_fma_f32 v234,v234,s26,-v19
v_mfma_f32_16x16x32_bf16 v[196:199],a[152:155],a[8:11],v[196:199]
ds_read_b128 v[116:119],v24 offset:17472
v_fma_f32 v235,v235,s26,-v19
v_mfma_f32_16x16x32_bf16 v[196:199],a[156:159],a[12:15],v[196:199]
ds_read_b64_tr_b16 a[112:113],v7 offset:32768
v_exp_f32 v228,v228
v_fma_f32 v236,v236,s26,-v19
v_mfma_f32_16x16x32_bf16 v[204:207],a[156:159],a[28:31],0
s_waitcnt lgkmcnt(14)
ds_read_b64_tr_b16 a[114:115],v7 offset:33792
v_fma_f32 v237,v237,s26,-v19
v_mfma_f32_16x16x32_bf16 v[204:207],a[152:155],a[24:27],v[204:207]
s_waitcnt lgkmcnt(14)
ds_read_b128 v[120:123],v24 offset:18560
v_fma_f32 v238,v238,s26,-v19
v_mfma_f32_16x16x32_bf16 v[204:207],a[148:151],a[20:23],v[204:207]
s_waitcnt lgkmcnt(14)
ds_read_b128 v[124:127],v24 offset:19648
v_fma_f32 v239,v239,s26,-v19
v_mfma_f32_16x16x32_bf16 v[204:207],a[144:147],a[16:19],v[204:207]
s_waitcnt lgkmcnt(14)
ds_read_b64_tr_b16 a[116:117],v7 offset:34816
v_exp_f32 v229,v229
v_fma_f32 v240,v240,s26,-v20
v_mfma_f32_16x16x32_bf16 v[212:215],a[144:147],a[32:35],0
s_waitcnt lgkmcnt(14)
ds_read_b64_tr_b16 a[118:119],v7 offset:35840
v_cvt_pk_bf16_f32 v226,v228,v229
v_mfma_f32_16x16x32_bf16 v[212:215],a[148:151],a[36:39],v[212:215]
v_fma_f32 v241,v241,s26,-v20
v_mfma_f32_16x16x32_bf16 v[212:215],a[152:155],a[40:43],v[212:215]
v_fma_f32 v242,v242,s26,-v20
v_mfma_f32_16x16x32_bf16 v[212:215],a[156:159],a[44:47],v[212:215]
s_waitcnt lgkmcnt(14)
ds_read_b64_tr_b16 a[120:121],v7 offset:32776
v_exp_f32 v230,v230
v_exp_f32 v231,v231
v_mfma_f32_16x16x32_bf16 v[220:223],a[156:159],a[60:63],0
s_waitcnt lgkmcnt(14)
ds_read_b64_tr_b16 a[122:123],v7 offset:33800
v_cvt_pk_bf16_f32 v227,v230,v231
v_mfma_f32_16x16x32_bf16 v[220:223],a[152:155],a[56:59],v[220:223]
v_fma_f32 v243,v243,s26,-v20
v_mfma_f32_16x16x32_bf16 v[220:223],a[148:151],a[52:55],v[220:223]
s_waitcnt lgkmcnt(14)
ds_read_b64_tr_b16 a[124:125],v7 offset:34824
v_fma_f32 v244,v244,s26,-v20
v_mfma_f32_16x16x32_bf16 v[220:223],a[144:147],a[48:51],v[220:223]
s_waitcnt lgkmcnt(14)
ds_read_b64_tr_b16 a[126:127],v7 offset:35848
v_exp_f32 v232,v232
v_fma_f32 v245,v245,s26,-v20
v_mfma_f32_16x16x32_bf16 a[224:227],a[240:243],v[160:163],a[224:227]
v_fma_f32 v246,v246,s26,-v20
v_mfma_f32_16x16x32_bf16 a[224:227],a[240:243],v[164:167],a[224:227]
buffer_load_dwordx4 v1,s[12:15],s22 offen offset:3072 nt lds
v_exp_f32 v233,v233
v_mfma_f32_16x16x32_bf16 a[228:231],a[240:243],v[168:171],a[228:231]
s_add_u32 s22,s22,16384
s_waitcnt lgkmcnt(14)
ds_read_b64_tr_b16 a[128:129],v8 offset:32768
v_mfma_f32_16x16x32_bf16 a[228:231],a[240:243],v[172:175],a[228:231]
s_waitcnt lgkmcnt(14)
ds_read_b64_tr_b16 a[130:131],v8 offset:33792
v_cvt_pk_bf16_f32 v232,v232,v233
v_exp_f32 v234,v234
v_mfma_f32_16x16x32_bf16 a[232:235],a[240:243],v[176:179],a[232:235]
v_fma_f32 v247,v247,s26,-v20
v_mfma_f32_16x16x32_bf16 a[232:235],a[240:243],v[180:183],a[232:235]
v_exp_f32 v235,v235
v_exp_f32 v236,v236
v_mfma_f32_16x16x32_bf16 a[236:239],a[240:243],v[184:187],a[236:239]
s_waitcnt lgkmcnt(14)
ds_read_b64_tr_b16 a[132:133],v8 offset:34816
v_cvt_pk_bf16_f32 v233,v234,v235
v_mfma_f32_16x16x32_bf16 a[236:239],a[240:243],v[188:191],a[236:239]
s_waitcnt lgkmcnt(14)
ds_read_b64_tr_b16 a[134:135],v8 offset:35840
v_exp_f32 v237,v237
v_fma_f32 v248,v248,s26,-v21
v_mfma_f32_16x16x32_bf16 v[80:83],a[96:99],v[184:187],v[80:83]
v_cvt_pk_bf16_f32 v234,v236,v237
v_mfma_f32_16x16x32_bf16 v[80:83],a[100:103],v[188:191],v[80:83]
s_waitcnt lgkmcnt(14)
ds_read_b64_tr_b16 a[136:137],v8 offset:32776
v_exp_f32 v238,v238
v_fma_f32 v249,v249,s26,-v21
v_mfma_f32_16x16x32_bf16 v[64:67],a[100:103],v[180:183],v[64:67]
s_add_u32 s30,s24,16384
s_add_u32 s32,s24,20480
s_waitcnt lgkmcnt(14)
ds_read_b64_tr_b16 a[138:139],v8 offset:33800
v_mfma_f32_16x16x32_bf16 v[64:67],a[96:99],v[176:179],v[64:67]
buffer_store_dwordx4 v[112:115],v22,s[16:19],s30 offen sc0 sc1
buffer_store_dwordx4 v[116:119],v22,s[16:19],s32 offen sc0 sc1
v_exp_f32 v239,v239
v_mfma_f32_16x16x32_bf16 v[48:51],a[96:99],v[168:171],v[48:51]
v_cvt_pk_bf16_f32 v235,v238,v239
v_mfma_f32_16x16x32_bf16 v[48:51],a[100:103],v[172:175],v[48:51]
s_waitcnt lgkmcnt(14)
ds_read_b64_tr_b16 a[140:141],v8 offset:34824
v_exp_f32 v240,v240
v_fma_f32 v250,v250,s26,-v21
v_mfma_f32_16x16x32_bf16 v[32:35],a[100:103],v[164:167],v[32:35]
s_waitcnt lgkmcnt(14)
ds_read_b64_tr_b16 a[142:143],v8 offset:35848
v_fma_f32 v251,v251,s26,-v21
v_mfma_f32_16x16x32_bf16 v[32:35],a[96:99],v[160:163],v[32:35]
v_exp_f32 v241,v241
v_exp_f32 v242,v242
v_mfma_f32_16x16x32_bf16 v[36:39],a[104:107],v[160:163],v[36:39]
v_cvt_pk_bf16_f32 v240,v240,v241
v_mfma_f32_16x16x32_bf16 v[36:39],a[108:111],v[164:167],v[36:39]
s_waitcnt lgkmcnt(14)
ds_read_b64_tr_b16 a[144:145],v9 offset:32768
v_exp_f32 v243,v243
v_fma_f32 v252,v252,s26,-v21
v_mfma_f32_16x16x32_bf16 v[52:55],a[108:111],v[172:175],v[52:55]
s_waitcnt lgkmcnt(14)
ds_read_b64_tr_b16 a[146:147],v9 offset:33792
v_cvt_pk_bf16_f32 v241,v242,v243
v_mfma_f32_16x16x32_bf16 v[52:55],a[104:107],v[168:171],v[52:55]
v_exp_f32 v244,v244
v_exp_f32 v245,v245
v_mfma_f32_16x16x32_bf16 v[68:71],a[104:107],v[176:179],v[68:71]
s_waitcnt lgkmcnt(14)
ds_read_b64_tr_b16 a[148:149],v9 offset:34816
v_cvt_pk_bf16_f32 v242,v244,v245
v_mfma_f32_16x16x32_bf16 v[68:71],a[108:111],v[180:183],v[68:71]
s_waitcnt lgkmcnt(14)
ds_read_b64_tr_b16 a[150:151],v9 offset:35840
v_exp_f32 v246,v246
v_fma_f32 v253,v253,s26,-v21
v_mfma_f32_16x16x32_bf16 v[84:87],a[108:111],v[188:191],v[84:87]
v_fma_f32 v254,v254,s26,-v21
v_mfma_f32_16x16x32_bf16 v[84:87],a[104:107],v[184:187],v[84:87]
v_exp_f32 v247,v247
v_exp_f32 v248,v248
v_fma_f32 v255,v255,s26,-v21
v_mfma_f32_16x16x32_bf16 v[88:91],a[112:115],v[184:187],v[88:91]
s_waitcnt lgkmcnt(14)
ds_read_b64_tr_b16 a[152:153],v9 offset:32776
v_cvt_pk_bf16_f32 v243,v246,v247
v_mfma_f32_16x16x32_bf16 v[88:91],a[116:119],v[188:191],v[88:91]
s_waitcnt lgkmcnt(14)
ds_read_b64_tr_b16 a[154:155],v9 offset:33800
v_exp_f32 v249,v249
v_mfma_f32_16x16x32_bf16 v[72:75],a[116:119],v[180:183],v[72:75]
v_cvt_pk_bf16_f32 v248,v248,v249
v_mfma_f32_16x16x32_bf16 v[72:75],a[112:115],v[176:179],v[72:75]
s_waitcnt lgkmcnt(14)
ds_read_b64_tr_b16 a[156:157],v9 offset:34824
v_exp_f32 v250,v250
v_mfma_f32_16x16x32_bf16 v[56:59],a[112:115],v[168:171],v[56:59]
s_add_u32 s30,s24,24576
s_add_u32 s32,s24,28672
s_waitcnt lgkmcnt(14)
ds_read_b64_tr_b16 a[158:159],v9 offset:35848
v_mfma_f32_16x16x32_bf16 v[56:59],a[116:119],v[172:175],v[56:59]
buffer_store_dwordx4 v[120:123],v22,s[16:19],s30 offen sc0 sc1
buffer_store_dwordx4 v[124:127],v22,s[16:19],s32 offen sc0 sc1
v_exp_f32 v251,v251
v_mfma_f32_16x16x32_bf16 v[40:43],a[116:119],v[164:167],v[40:43]
v_cvt_pk_bf16_f32 v249,v250,v251
v_mfma_f32_16x16x32_bf16 v[40:43],a[112:115],v[160:163],v[40:43]
v_exp_f32 v252,v252
v_exp_f32 v253,v253
v_mfma_f32_16x16x32_bf16 v[44:47],a[120:123],v[160:163],v[44:47]
v_cvt_pk_bf16_f32 v250,v252,v253
v_mfma_f32_16x16x32_bf16 v[44:47],a[124:127],v[164:167],v[44:47]
v_exp_f32 v254,v254
v_exp_f32 v255,v255
v_mfma_f32_16x16x32_bf16 v[60:63],a[124:127],v[172:175],v[60:63]
v_cvt_pk_bf16_f32 v251,v254,v255
v_mfma_f32_16x16x32_bf16 v[60:63],a[120:123],v[168:171],v[60:63]
v_mfma_f32_16x16x32_bf16 v[76:79],a[120:123],v[176:179],v[76:79]
v_fma_f32 v192,v192,s26,-v18
v_fma_f32 v193,v193,s26,-v18
v_mfma_f32_16x16x32_bf16 v[76:79],a[124:127],v[180:183],v[76:79]
v_exp_f32 v192,v192
v_mfma_f32_16x16x32_bf16 v[92:95],a[124:127],v[188:191],v[92:95]
v_exp_f32 v193,v193
v_mfma_f32_16x16x32_bf16 v[92:95],a[120:123],v[184:187],v[92:95]
s_waitcnt lgkmcnt(12)
v_cvt_pk_bf16_f32 v228,v192,v193
v_fma_f32 v194,v194,s26,-v18
v_fma_f32 v195,v195,s26,-v18
v_mfma_f32_16x16x32_bf16 a[208:211],a[128:131],v[184:187],a[208:211]
v_exp_f32 v194,v194
v_mfma_f32_16x16x32_bf16 a[208:211],a[132:135],v[188:191],a[208:211]
v_exp_f32 v195,v195
v_mfma_f32_16x16x32_bf16 a[192:195],a[132:135],v[180:183],a[192:195]
v_cvt_pk_bf16_f32 v229,v194,v195
v_fma_f32 v196,v196,s26,-v18
v_mfma_f32_16x16x32_bf16 a[192:195],a[128:131],v[176:179],a[192:195]
s_waitcnt vmcnt(16)
s_waitcnt lgkmcnt(0)
s_barrier
ds_read_b128 a[96:99],v2 offset:0
v_exp_f32 v196,v196
v_mfma_f32_16x16x32_bf16 a[176:179],a[128:131],v[168:171],a[176:179]
s_add_u32 m0,s25,32768
v_fma_f32 v197,v197,s26,-v18
v_fma_f32 v198,v198,s26,-v18
v_mfma_f32_16x16x32_bf16 a[176:179],a[132:135],v[172:175],a[176:179]
buffer_load_dwordx4 v1,s[8:11],s21 offen nt lds
v_mfma_f32_16x16x32_bf16 a[160:163],a[132:135],v[164:167],a[160:163]
v_exp_f32 v197,v197
v_mfma_f32_16x16x32_bf16 a[160:163],a[128:131],v[160:163],a[160:163]
ds_read_b128 a[100:103],v3 offset:0
v_cvt_pk_bf16_f32 v230,v196,v197
v_mfma_f32_16x16x32_bf16 a[164:167],a[136:139],v[160:163],a[164:167]
v_exp_f32 v198,v198
v_mfma_f32_16x16x32_bf16 a[164:167],a[140:143],v[164:167],a[164:167]
ds_read_b128 a[80:83],v10 offset:0
v_fma_f32 v199,v199,s26,-v18
v_fma_f32 v200,v200,s26,-v19
v_mfma_f32_16x16x32_bf16 a[180:183],a[140:143],v[172:175],a[180:183]
ds_read_b128 a[104:107],v4 offset:0
v_fma_f32 v201,v201,s26,-v19
v_mfma_f32_16x16x32_bf16 a[180:183],a[136:139],v[168:171],a[180:183]
v_exp_f32 v199,v199
v_mfma_f32_16x16x32_bf16 a[196:199],a[136:139],v[176:179],a[196:199]
v_exp_f32 v200,v200
v_mfma_f32_16x16x32_bf16 a[196:199],a[140:143],v[180:183],a[196:199]
buffer_load_dwordx4 v1,s[8:11],s21 offen offset:1024 nt lds
v_mfma_f32_16x16x32_bf16 a[212:215],a[140:143],v[188:191],a[212:215]
ds_read_b128 a[108:111],v5 offset:0
v_cvt_pk_bf16_f32 v231,v198,v199
v_mfma_f32_16x16x32_bf16 a[212:215],a[136:139],v[184:187],a[212:215]
v_exp_f32 v201,v201
v_fma_f32 v202,v202,s26,-v19
v_mfma_f32_16x16x32_bf16 a[216:219],a[144:147],v[184:187],a[216:219]
v_exp_f32 v202,v202
v_mfma_f32_16x16x32_bf16 a[216:219],a[148:151],v[188:191],a[216:219]
v_cvt_pk_bf16_f32 v236,v200,v201
v_fma_f32 v203,v203,s26,-v19
v_mfma_f32_16x16x32_bf16 a[200:203],a[148:151],v[180:183],a[200:203]
ds_read_b128 a[112:115],v2 offset:1024
v_fma_f32 v204,v204,s26,-v19
v_mfma_f32_16x16x32_bf16 a[200:203],a[144:147],v[176:179],a[200:203]
v_exp_f32 v203,v203
v_fma_f32 v205,v205,s26,-v19
v_mfma_f32_16x16x32_bf16 a[184:187],a[144:147],v[168:171],a[184:187]
v_exp_f32 v204,v204
v_mfma_f32_16x16x32_bf16 a[184:187],a[148:151],v[172:175],a[184:187]
ds_read_b128 a[116:119],v3 offset:1024
v_cvt_pk_bf16_f32 v237,v202,v203
v_mfma_f32_16x16x32_bf16 a[168:171],a[148:151],v[164:167],a[168:171]
ds_read_b128 a[84:87],v11 offset:0
v_fma_f32 v206,v206,s26,-v19
v_mfma_f32_16x16x32_bf16 a[168:171],a[144:147],v[160:163],a[168:171]
v_exp_f32 v205,v205
v_mfma_f32_16x16x32_bf16 a[172:175],a[152:155],v[160:163],a[172:175]
v_exp_f32 v206,v206
v_mfma_f32_16x16x32_bf16 a[172:175],a[156:159],v[164:167],a[172:175]
ds_read_b128 a[120:123],v4 offset:1024
v_cvt_pk_bf16_f32 v238,v204,v205
v_fma_f32 v207,v207,s26,-v19
v_mfma_f32_16x16x32_bf16 a[188:191],a[156:159],v[172:175],a[188:191]
v_exp_f32 v207,v207
v_mfma_f32_16x16x32_bf16 a[188:191],a[152:155],v[168:171],a[188:191]
buffer_load_dwordx4 v1,s[8:11],s21 offen offset:2048 nt lds
v_mfma_f32_16x16x32_bf16 a[204:207],a[152:155],v[176:179],a[204:207]
v_cvt_pk_bf16_f32 v239,v206,v207
v_fma_f32 v208,v208,s26,-v20
v_mfma_f32_16x16x32_bf16 a[204:207],a[156:159],v[180:183],a[204:207]
ds_read_b128 a[124:127],v5 offset:1024
v_exp_f32 v208,v208
v_mfma_f32_16x16x32_bf16 a[220:223],a[156:159],v[188:191],a[220:223]
v_fma_f32 v209,v209,s26,-v20
v_fma_f32 v210,v210,s26,-v20
v_mfma_f32_16x16x32_bf16 a[220:223],a[152:155],v[184:187],a[220:223]
s_waitcnt lgkmcnt(5)
v_exp_f32 v209,v209
v_mfma_f32_16x16x32_bf16 v[160:163],a[96:99],a[0:3],0
ds_read_b128 a[128:131],v2 offset:2048
v_cvt_pk_bf16_f32 v244,v208,v209
v_mfma_f32_16x16x32_bf16 v[160:163],a[100:103],a[4:7],v[160:163]
v_exp_f32 v210,v210
v_mfma_f32_16x16x32_bf16 v[160:163],a[104:107],a[8:11],v[160:163]
ds_read_b128 a[88:91],v12 offset:0
v_fma_f32 v211,v211,s26,-v20
v_mfma_f32_16x16x32_bf16 v[160:163],a[108:111],a[12:15],v[160:163]
buffer_load_dwordx4 v1,s[8:11],s21 offen offset:3072 nt lds
v_mfma_f32_16x16x32_bf16 v[168:171],a[108:111],a[28:31],0
s_add_u32 s21,s21,16384
ds_read_b128 a[132:135],v3 offset:2048
v_mfma_f32_16x16x32_bf16 v[168:171],a[104:107],a[24:27],v[168:171]
v_exp_f32 v211,v211
v_mfma_f32_16x16x32_bf16 v[168:171],a[100:103],a[20:23],v[168:171]
v_cvt_pk_bf16_f32 v245,v210,v211
v_fma_f32 v212,v212,s26,-v20
v_mfma_f32_16x16x32_bf16 v[168:171],a[96:99],a[16:19],v[168:171]
v_fma_f32 v213,v213,s26,-v20
v_exp_f32 v212,v212
v_mfma_f32_16x16x32_bf16 v[176:179],a[96:99],a[32:35],0
ds_read_b128 a[136:139],v4 offset:2048
v_fma_f32 v214,v214,s26,-v20
v_mfma_f32_16x16x32_bf16 v[176:179],a[100:103],a[36:39],v[176:179]
v_exp_f32 v213,v213
v_mfma_f32_16x16x32_bf16 v[176:179],a[104:107],a[40:43],v[176:179]
v_exp_f32 v214,v214
v_mfma_f32_16x16x32_bf16 v[176:179],a[108:111],a[44:47],v[176:179]
ds_read_b128 a[140:143],v5 offset:2048
v_cvt_pk_bf16_f32 v246,v212,v213
v_mfma_f32_16x16x32_bf16 v[184:187],a[108:111],a[60:63],0
v_fma_f32 v215,v215,s26,-v20
v_fma_f32 v216,v216,s26,-v21
v_mfma_f32_16x16x32_bf16 v[184:187],a[104:107],a[56:59],v[184:187]
s_waitcnt lgkmcnt(5)
v_exp_f32 v215,v215
v_mfma_f32_16x16x32_bf16 v[184:187],a[100:103],a[52:55],v[184:187]
ds_read_b128 a[92:95],v13 offset:0
v_cvt_pk_bf16_f32 v247,v214,v215
v_mfma_f32_16x16x32_bf16 v[184:187],a[96:99],a[48:51],v[184:187]
ds_read_b128 a[144:147],v2 offset:3072
v_fma_f32 v217,v217,s26,-v21
v_mfma_f32_16x16x32_bf16 v[164:167],a[112:115],a[0:3],0
v_exp_f32 v216,v216
v_mfma_f32_16x16x32_bf16 v[164:167],a[116:119],a[4:7],v[164:167]
v_exp_f32 v217,v217
v_mfma_f32_16x16x32_bf16 v[164:167],a[120:123],a[8:11],v[164:167]
v_cvt_pk_bf16_f32 v252,v216,v217
v_fma_f32 v218,v218,s26,-v21
v_mfma_f32_16x16x32_bf16 v[164:167],a[124:127],a[12:15],v[164:167]
ds_read_b128 a[148:151],v3 offset:3072
v_exp_f32 v218,v218
v_mfma_f32_16x16x32_bf16 v[172:175],a[124:127],a[28:31],0
v_fma_f32 v219,v219,s26,-v21
v_fma_f32 v220,v220,s26,-v21
v_mfma_f32_16x16x32_bf16 v[172:175],a[120:123],a[24:27],v[172:175]
v_exp_f32 v219,v219
v_mfma_f32_16x16x32_bf16 v[172:175],a[116:119],a[20:23],v[172:175]
s_add_u32 m0,s25,81920
ds_read_b128 a[152:155],v4 offset:3072
v_mfma_f32_16x16x32_bf16 v[172:175],a[112:115],a[16:19],v[172:175]
buffer_load_dwordx4 v1,s[12:15],s22 offen nt lds
v_mfma_f32_16x16x32_bf16 v[180:183],a[112:115],a[32:35],0
v_exp_f32 v220,v220
v_mfma_f32_16x16x32_bf16 v[180:183],a[116:119],a[36:39],v[180:183]
v_cvt_pk_bf16_f32 v253,v218,v219
v_fma_f32 v221,v221,s26,-v21
v_mfma_f32_16x16x32_bf16 v[180:183],a[120:123],a[40:43],v[180:183]
ds_read_b128 a[156:159],v5 offset:3072
v_fma_f32 v222,v222,s26,-v21
v_mfma_f32_16x16x32_bf16 v[180:183],a[124:127],a[44:47],v[180:183]
v_exp_f32 v221,v221
v_fma_f32 v223,v223,s26,-v21
v_mfma_f32_16x16x32_bf16 v[188:191],a[124:127],a[60:63],0
v_exp_f32 v222,v222
v_mfma_f32_16x16x32_bf16 v[188:191],a[120:123],a[56:59],v[188:191]
v_exp_f32 v223,v223
v_mfma_f32_16x16x32_bf16 v[188:191],a[116:119],a[52:55],v[188:191]
v_cvt_pk_bf16_f32 v254,v220,v221
v_cvt_pk_bf16_f32 v255,v222,v223
v_mfma_f32_16x16x32_bf16 v[188:191],a[112:115],a[48:51],v[188:191]
s_waitcnt lgkmcnt(5)
v_mfma_f32_16x16x32_bf16 v[192:195],a[128:131],a[0:3],0
v_accvgpr_read_b32 v23,a244
v_accvgpr_read_b32 v24,a245
v_mfma_f32_16x16x32_bf16 v[192:195],a[132:135],a[4:7],v[192:195]
v_fma_f32 v160,v160,s26,-v18
v_fma_f32 v161,v161,s26,-v18
v_mfma_f32_16x16x32_bf16 v[192:195],a[136:139],a[8:11],v[192:195]
v_exp_f32 v160,v160
v_mfma_f32_16x16x32_bf16 v[192:195],a[140:143],a[12:15],v[192:195]
buffer_load_dwordx4 v1,s[12:15],s22 offen offset:1024 nt lds
v_fma_f32 v162,v162,s26,-v18
v_mfma_f32_16x16x32_bf16 v[200:203],a[140:143],a[28:31],0
ds_write_b128 v23,v[128:131] offset:32768
v_fma_f32 v163,v163,s26,-v18
v_mfma_f32_16x16x32_bf16 v[200:203],a[136:139],a[24:27],v[200:203]
ds_read_b64_tr_b16 a[96:97],v6 offset:49152
v_fma_f32 v164,v164,s26,-v18
v_mfma_f32_16x16x32_bf16 v[200:203],a[132:135],a[20:23],v[200:203]
ds_read_b64_tr_b16 a[98:99],v6 offset:50176
v_fma_f32 v165,v165,s26,-v18
v_mfma_f32_16x16x32_bf16 v[200:203],a[128:131],a[16:19],v[200:203]
ds_write_b128 v23,v[132:135] offset:32832
v_exp_f32 v161,v161
v_fma_f32 v166,v166,s26,-v18
v_mfma_f32_16x16x32_bf16 v[208:211],a[128:131],a[32:35],0
ds_read_b64_tr_b16 a[100:101],v6 offset:51200
v_cvt_pk_bf16_f32 v160,v160,v161
v_mfma_f32_16x16x32_bf16 v[208:211],a[132:135],a[36:39],v[208:211]
ds_read_b64_tr_b16 a[102:103],v6 offset:52224
v_fma_f32 v167,v167,s26,-v18
v_mfma_f32_16x16x32_bf16 v[208:211],a[136:139],a[40:43],v[208:211]
ds_write_b128 v23,v[136:139] offset:32896
v_fma_f32 v168,v168,s26,-v19
v_mfma_f32_16x16x32_bf16 v[208:211],a[140:143],a[44:47],v[208:211]
buffer_load_dwordx4 v1,s[12:15],s22 offen offset:2048 nt lds
v_fma_f32 v169,v169,s26,-v19
v_mfma_f32_16x16x32_bf16 v[216:219],a[140:143],a[60:63],0
ds_read_b64_tr_b16 a[104:105],v6 offset:49160
v_fma_f32 v170,v170,s26,-v19
v_mfma_f32_16x16x32_bf16 v[216:219],a[136:139],a[56:59],v[216:219]
ds_read_b64_tr_b16 a[106:107],v6 offset:50184
v_fma_f32 v171,v171,s26,-v19
v_mfma_f32_16x16x32_bf16 v[216:219],a[132:135],a[52:55],v[216:219]
ds_write_b128 v23,v[140:143] offset:32960
v_fma_f32 v172,v172,s26,-v19
v_mfma_f32_16x16x32_bf16 v[216:219],a[128:131],a[48:51],v[216:219]
s_waitcnt lgkmcnt(10)
ds_read_b128 v[128:131],v24 offset:32768
v_exp_f32 v162,v162
v_mfma_f32_16x16x32_bf16 v[196:199],a[144:147],a[0:3],0
ds_read_b64_tr_b16 a[108:109],v6 offset:51208
v_fma_f32 v173,v173,s26,-v19
v_mfma_f32_16x16x32_bf16 v[196:199],a[148:151],a[4:7],v[196:199]
ds_read_b64_tr_b16 a[110:111],v6 offset:52232
v_fma_f32 v174,v174,s26,-v19
v_mfma_f32_16x16x32_bf16 v[196:199],a[152:155],a[8:11],v[196:199]
ds_read_b128 v[132:135],v24 offset:33856
v_fma_f32 v175,v175,s26,-v19
v_mfma_f32_16x16x32_bf16 v[196:199],a[156:159],a[12:15],v[196:199]
ds_read_b64_tr_b16 a[112:113],v7 offset:49152
v_exp_f32 v163,v163
v_mfma_f32_16x16x32_bf16 v[204:207],a[156:159],a[28:31],0
s_waitcnt lgkmcnt(14)
ds_read_b64_tr_b16 a[114:115],v7 offset:50176
v_cvt_pk_bf16_f32 v161,v162,v163
v_mfma_f32_16x16x32_bf16 v[204:207],a[152:155],a[24:27],v[204:207]
s_waitcnt lgkmcnt(14)
ds_read_b128 v[136:139],v24 offset:34944
v_fma_f32 v176,v176,s26,-v20
v_mfma_f32_16x16x32_bf16 v[204:207],a[148:151],a[20:23],v[204:207]
s_waitcnt lgkmcnt(14)
ds_read_b128 v[140:143],v24 offset:36032
v_fma_f32 v177,v177,s26,-v20
v_mfma_f32_16x16x32_bf16 v[204:207],a[144:147],a[16:19],v[204:207]
s_waitcnt lgkmcnt(14)
ds_read_b64_tr_b16 a[116:117],v7 offset:51200
v_exp_f32 v164,v164
v_fma_f32 v178,v178,s26,-v20
v_mfma_f32_16x16x32_bf16 v[212:215],a[144:147],a[32:35],0
s_waitcnt lgkmcnt(14)
ds_read_b64_tr_b16 a[118:119],v7 offset:52224
v_fma_f32 v179,v179,s26,-v20
v_mfma_f32_16x16x32_bf16 v[212:215],a[148:151],a[36:39],v[212:215]
v_exp_f32 v165,v165
v_mfma_f32_16x16x32_bf16 v[212:215],a[152:155],a[40:43],v[212:215]
v_exp_f32 v166,v166
v_mfma_f32_16x16x32_bf16 v[212:215],a[156:159],a[44:47],v[212:215]
s_waitcnt lgkmcnt(14)
ds_read_b64_tr_b16 a[120:121],v7 offset:49160
v_exp_f32 v167,v167
v_mfma_f32_16x16x32_bf16 v[220:223],a[156:159],a[60:63],0
s_waitcnt lgkmcnt(14)
ds_read_b64_tr_b16 a[122:123],v7 offset:50184
v_cvt_pk_bf16_f32 v162,v164,v165
v_mfma_f32_16x16x32_bf16 v[220:223],a[152:155],a[56:59],v[220:223]
v_exp_f32 v168,v168
v_mfma_f32_16x16x32_bf16 v[220:223],a[148:151],a[52:55],v[220:223]
s_waitcnt lgkmcnt(14)
ds_read_b64_tr_b16 a[124:125],v7 offset:51208
v_cvt_pk_bf16_f32 v163,v166,v167
v_mfma_f32_16x16x32_bf16 v[220:223],a[144:147],a[48:51],v[220:223]
s_waitcnt lgkmcnt(14)
ds_read_b64_tr_b16 a[126:127],v7 offset:52232
v_exp_f32 v169,v169
v_fma_f32 v180,v180,s26,-v20
v_mfma_f32_16x16x32_bf16 a[224:227],a[240:243],v[224:227],a[224:227]
v_exp_f32 v170,v170
v_mfma_f32_16x16x32_bf16 a[224:227],a[240:243],v[228:231],a[224:227]
buffer_load_dwordx4 v1,s[12:15],s22 offen offset:3072 nt lds
v_cvt_pk_bf16_f32 v168,v168,v169
v_mfma_f32_16x16x32_bf16 a[228:231],a[240:243],v[232:235],a[228:231]
s_add_u32 s22,s22,16384
s_waitcnt lgkmcnt(14)
ds_read_b64_tr_b16 a[128:129],v8 offset:49152
v_mfma_f32_16x16x32_bf16 a[228:231],a[240:243],v[236:239],a[228:231]
s_waitcnt lgkmcnt(14)
ds_read_b64_tr_b16 a[130:131],v8 offset:50176
v_exp_f32 v171,v171
v_fma_f32 v181,v181,s26,-v20
v_mfma_f32_16x16x32_bf16 a[232:235],a[240:243],v[240:243],a[232:235]
v_exp_f32 v172,v172
v_mfma_f32_16x16x32_bf16 a[232:235],a[240:243],v[244:247],a[232:235]
v_cvt_pk_bf16_f32 v169,v170,v171
v_exp_f32 v173,v173
v_mfma_f32_16x16x32_bf16 a[236:239],a[240:243],v[248:251],a[236:239]
s_waitcnt lgkmcnt(14)
ds_read_b64_tr_b16 a[132:133],v8 offset:51200
v_cvt_pk_bf16_f32 v170,v172,v173
v_mfma_f32_16x16x32_bf16 a[236:239],a[240:243],v[252:255],a[236:239]
s_waitcnt lgkmcnt(14)
ds_read_b64_tr_b16 a[134:135],v8 offset:52224
v_exp_f32 v174,v174
v_fma_f32 v182,v182,s26,-v20
v_mfma_f32_16x16x32_bf16 v[80:83],a[96:99],v[248:251],v[80:83]
v_exp_f32 v175,v175
v_mfma_f32_16x16x32_bf16 v[80:83],a[100:103],v[252:255],v[80:83]
s_waitcnt lgkmcnt(14)
ds_read_b64_tr_b16 a[136:137],v8 offset:49160
v_exp_f32 v176,v176
v_mfma_f32_16x16x32_bf16 v[64:67],a[100:103],v[244:247],v[64:67]
s_add_u32 m0,s25,147456
s_waitcnt lgkmcnt(14)
ds_read_b64_tr_b16 a[138:139],v8 offset:50184
v_mfma_f32_16x16x32_bf16 v[64:67],a[96:99],v[240:243],v[64:67]
buffer_load_dwordx4 v1,s[4:7],s23 offen nt lds
v_exp_f32 v177,v177
v_mfma_f32_16x16x32_bf16 v[48:51],a[96:99],v[232:235],v[48:51]
v_exp_f32 v178,v178
v_mfma_f32_16x16x32_bf16 v[48:51],a[100:103],v[236:239],v[48:51]
s_waitcnt lgkmcnt(14)
ds_read_b64_tr_b16 a[140:141],v8 offset:51208
v_exp_f32 v179,v179
v_mfma_f32_16x16x32_bf16 v[32:35],a[100:103],v[228:231],v[32:35]
s_waitcnt lgkmcnt(14)
ds_read_b64_tr_b16 a[142:143],v8 offset:52232
v_cvt_pk_bf16_f32 v171,v174,v175
v_mfma_f32_16x16x32_bf16 v[32:35],a[96:99],v[224:227],v[32:35]
v_exp_f32 v180,v180
v_exp_f32 v181,v181
v_mfma_f32_16x16x32_bf16 v[36:39],a[104:107],v[224:227],v[36:39]
v_cvt_pk_bf16_f32 v176,v176,v177
v_cvt_pk_bf16_f32 v177,v178,v179
v_mfma_f32_16x16x32_bf16 v[36:39],a[108:111],v[228:231],v[36:39]
s_waitcnt lgkmcnt(14)
ds_read_b64_tr_b16 a[144:145],v9 offset:49152
v_exp_f32 v182,v182
v_mfma_f32_16x16x32_bf16 v[52:55],a[108:111],v[236:239],v[52:55]
s_waitcnt lgkmcnt(14)
ds_read_b64_tr_b16 a[146:147],v9 offset:50176
v_cvt_pk_bf16_f32 v178,v180,v181
v_mfma_f32_16x16x32_bf16 v[52:55],a[104:107],v[232:235],v[52:55]
buffer_load_dwordx4 v1,s[4:7],s23 offen offset:1024 nt lds
v_fma_f32 v183,v183,s26,-v20
v_fma_f32 v184,v184,s26,-v21
v_mfma_f32_16x16x32_bf16 v[68:71],a[104:107],v[240:243],v[68:71]
s_waitcnt lgkmcnt(14)
ds_read_b64_tr_b16 a[148:149],v9 offset:51200
v_fma_f32 v185,v185,s26,-v21
v_mfma_f32_16x16x32_bf16 v[68:71],a[108:111],v[244:247],v[68:71]
s_waitcnt lgkmcnt(14)
ds_read_b64_tr_b16 a[150:151],v9 offset:52224
v_exp_f32 v183,v183
v_mfma_f32_16x16x32_bf16 v[84:87],a[108:111],v[252:255],v[84:87]
v_exp_f32 v184,v184
v_mfma_f32_16x16x32_bf16 v[84:87],a[104:107],v[248:251],v[84:87]
v_exp_f32 v185,v185
v_cvt_pk_bf16_f32 v179,v182,v183
v_fma_f32 v186,v186,s26,-v21
v_mfma_f32_16x16x32_bf16 v[88:91],a[112:115],v[248:251],v[88:91]
s_waitcnt lgkmcnt(14)
ds_read_b64_tr_b16 a[152:153],v9 offset:49160
v_cvt_pk_bf16_f32 v184,v184,v185
v_mfma_f32_16x16x32_bf16 v[88:91],a[116:119],v[252:255],v[88:91]
s_waitcnt lgkmcnt(14)
ds_read_b64_tr_b16 a[154:155],v9 offset:50184
v_exp_f32 v186,v186
v_mfma_f32_16x16x32_bf16 v[72:75],a[116:119],v[244:247],v[72:75]
v_fma_f32 v187,v187,s26,-v21
v_fma_f32 v188,v188,s26,-v21
v_mfma_f32_16x16x32_bf16 v[72:75],a[112:115],v[240:243],v[72:75]
s_waitcnt lgkmcnt(14)
ds_read_b64_tr_b16 a[156:157],v9 offset:51208
v_exp_f32 v187,v187
v_fma_f32 v189,v189,s26,-v21
v_mfma_f32_16x16x32_bf16 v[56:59],a[112:115],v[232:235],v[56:59]
s_waitcnt lgkmcnt(14)
ds_read_b64_tr_b16 a[158:159],v9 offset:52232
v_cvt_pk_bf16_f32 v185,v186,v187
v_mfma_f32_16x16x32_bf16 v[56:59],a[116:119],v[236:239],v[56:59]
buffer_load_dwordx4 v1,s[4:7],s23 offen offset:2048 nt lds
v_fma_f32 v190,v190,s26,-v21
v_mfma_f32_16x16x32_bf16 v[40:43],a[116:119],v[228:231],v[40:43]
v_exp_f32 v188,v188
v_mfma_f32_16x16x32_bf16 v[40:43],a[112:115],v[224:227],v[40:43]
v_exp_f32 v189,v189
v_exp_f32 v190,v190
v_mfma_f32_16x16x32_bf16 v[44:47],a[120:123],v[224:227],v[44:47]
v_cvt_pk_bf16_f32 v186,v188,v189
v_fma_f32 v191,v191,s26,-v21
v_mfma_f32_16x16x32_bf16 v[44:47],a[124:127],v[228:231],v[44:47]
v_exp_f32 v191,v191
v_mfma_f32_16x16x32_bf16 v[60:63],a[124:127],v[236:239],v[60:63]
v_cvt_pk_bf16_f32 v187,v190,v191
v_mfma_f32_16x16x32_bf16 v[60:63],a[120:123],v[232:235],v[60:63]
v_mfma_f32_16x16x32_bf16 v[76:79],a[120:123],v[240:243],v[76:79]
v_fma_f32 v192,v192,s26,-v18
v_fma_f32 v193,v193,s26,-v18
v_mfma_f32_16x16x32_bf16 v[76:79],a[124:127],v[244:247],v[76:79]
buffer_load_dwordx4 v1,s[4:7],s23 offen offset:3072 nt lds
v_mfma_f32_16x16x32_bf16 v[92:95],a[124:127],v[252:255],v[92:95]
s_add_u32 s23,s23,16384
v_exp_f32 v192,v192
v_mfma_f32_16x16x32_bf16 v[92:95],a[120:123],v[248:251],v[92:95]
s_waitcnt lgkmcnt(12)
v_exp_f32 v193,v193
v_fma_f32 v194,v194,s26,-v18
v_mfma_f32_16x16x32_bf16 a[208:211],a[128:131],v[248:251],a[208:211]
v_exp_f32 v194,v194
v_mfma_f32_16x16x32_bf16 a[208:211],a[132:135],v[252:255],a[208:211]
v_cvt_pk_bf16_f32 v164,v192,v193
v_fma_f32 v195,v195,s26,-v18
v_mfma_f32_16x16x32_bf16 a[192:195],a[132:135],v[244:247],a[192:195]
v_exp_f32 v195,v195
v_mfma_f32_16x16x32_bf16 a[192:195],a[128:131],v[240:243],a[192:195]
s_waitcnt vmcnt(16)
s_waitcnt lgkmcnt(0)
s_barrier
ds_read_b128 a[96:99],v2 offset:16384
v_cvt_pk_bf16_f32 v165,v194,v195
v_mfma_f32_16x16x32_bf16 a[176:179],a[128:131],v[232:235],a[176:179]
s_add_u32 m0,s25,49152
v_fma_f32 v196,v196,s26,-v18
v_fma_f32 v197,v197,s26,-v18
v_mfma_f32_16x16x32_bf16 a[176:179],a[132:135],v[236:239],a[176:179]
buffer_load_dwordx4 v1,s[8:11],s21 offen nt lds
v_fma_f32 v198,v198,s26,-v18
v_mfma_f32_16x16x32_bf16 a[160:163],a[132:135],v[228:231],a[160:163]
v_exp_f32 v196,v196
v_mfma_f32_16x16x32_bf16 a[160:163],a[128:131],v[224:227],a[160:163]
ds_read_b128 a[100:103],v3 offset:16384
v_fma_f32 v199,v199,s26,-v18
v_mfma_f32_16x16x32_bf16 a[164:167],a[136:139],v[224:227],a[164:167]
v_exp_f32 v197,v197
v_mfma_f32_16x16x32_bf16 a[164:167],a[140:143],v[228:231],a[164:167]
v_exp_f32 v198,v198
v_mfma_f32_16x16x32_bf16 a[180:183],a[140:143],v[236:239],a[180:183]
ds_read_b128 a[104:107],v4 offset:16384
v_cvt_pk_bf16_f32 v166,v196,v197
v_mfma_f32_16x16x32_bf16 a[180:183],a[136:139],v[232:235],a[180:183]
v_exp_f32 v199,v199
v_mfma_f32_16x16x32_bf16 a[196:199],a[136:139],v[240:243],a[196:199]
v_cvt_pk_bf16_f32 v167,v198,v199
v_fma_f32 v200,v200,s26,-v19
v_mfma_f32_16x16x32_bf16 a[196:199],a[140:143],v[244:247],a[196:199]
buffer_load_dwordx4 v1,s[8:11],s21 offen offset:1024 nt lds
v_fma_f32 v201,v201,s26,-v19
v_mfma_f32_16x16x32_bf16 a[212:215],a[140:143],v[252:255],a[212:215]
ds_read_b128 a[108:111],v5 offset:16384
v_fma_f32 v202,v202,s26,-v19
v_mfma_f32_16x16x32_bf16 a[212:215],a[136:139],v[248:251],a[212:215]
v_exp_f32 v200,v200
v_mfma_f32_16x16x32_bf16 a[216:219],a[144:147],v[248:251],a[216:219]
v_exp_f32 v201,v201
v_mfma_f32_16x16x32_bf16 a[216:219],a[148:151],v[252:255],a[216:219]
v_exp_f32 v202,v202
v_mfma_f32_16x16x32_bf16 a[200:203],a[148:151],v[244:247],a[200:203]
ds_read_b128 a[112:115],v2 offset:17408
v_cvt_pk_bf16_f32 v172,v200,v201
v_mfma_f32_16x16x32_bf16 a[200:203],a[144:147],v[240:243],a[200:203]
v_fma_f32 v203,v203,s26,-v19
v_fma_f32 v204,v204,s26,-v19
v_fma_f32 v205,v205,s26,-v19
v_mfma_f32_16x16x32_bf16 a[184:187],a[144:147],v[232:235],a[184:187]
v_exp_f32 v203,v203
v_mfma_f32_16x16x32_bf16 a[184:187],a[148:151],v[236:239],a[184:187]
ds_read_b128 a[116:119],v3 offset:17408
v_cvt_pk_bf16_f32 v173,v202,v203
v_mfma_f32_16x16x32_bf16 a[168:171],a[148:151],v[228:231],a[168:171]
v_exp_f32 v204,v204
v_mfma_f32_16x16x32_bf16 a[168:171],a[144:147],v[224:227],a[168:171]
v_exp_f32 v205,v205
v_mfma_f32_16x16x32_bf16 a[172:175],a[152:155],v[224:227],a[172:175]
v_cvt_pk_bf16_f32 v174,v204,v205
v_fma_f32 v206,v206,s26,-v19
v_mfma_f32_16x16x32_bf16 a[172:175],a[156:159],v[228:231],a[172:175]
ds_read_b128 a[120:123],v4 offset:17408
v_exp_f32 v206,v206
v_mfma_f32_16x16x32_bf16 a[188:191],a[156:159],v[236:239],a[188:191]
v_fma_f32 v207,v207,s26,-v19
v_fma_f32 v208,v208,s26,-v20
v_mfma_f32_16x16x32_bf16 a[188:191],a[152:155],v[232:235],a[188:191]
buffer_load_dwordx4 v1,s[8:11],s21 offen offset:2048 nt lds
v_mfma_f32_16x16x32_bf16 a[204:207],a[152:155],v[240:243],a[204:207]
v_exp_f32 v207,v207
v_mfma_f32_16x16x32_bf16 a[204:207],a[156:159],v[244:247],a[204:207]
ds_read_b128 a[124:127],v5 offset:17408
v_cvt_pk_bf16_f32 v175,v206,v207
v_mfma_f32_16x16x32_bf16 a[220:223],a[156:159],v[252:255],a[220:223]
v_exp_f32 v208,v208
v_mfma_f32_16x16x32_bf16 a[220:223],a[152:155],v[248:251],a[220:223]
s_waitcnt lgkmcnt(4)
v_fma_f32 v209,v209,s26,-v20
v_fma_f32 v210,v210,s26,-v20
v_fma_f32 v211,v211,s26,-v20
v_mfma_f32_16x16x32_bf16 v[224:227],a[96:99],a[0:3],0
ds_read_b128 a[128:131],v2 offset:18432
v_fma_f32 v212,v212,s26,-v20
v_mfma_f32_16x16x32_bf16 v[224:227],a[100:103],a[4:7],v[224:227]
v_exp_f32 v209,v209
v_mfma_f32_16x16x32_bf16 v[224:227],a[104:107],a[8:11],v[224:227]
v_exp_f32 v210,v210
v_mfma_f32_16x16x32_bf16 v[224:227],a[108:111],a[12:15],v[224:227]
buffer_load_dwordx4 v1,s[8:11],s21 offen offset:3072 nt lds
v_mfma_f32_16x16x32_bf16 v[232:235],a[108:111],a[28:31],0
s_add_u32 s21,s21,16384
ds_read_b128 a[132:135],v3 offset:18432
v_mfma_f32_16x16x32_bf16 v[232:235],a[104:107],a[24:27],v[232:235]
v_exp_f32 v211,v211
v_mfma_f32_16x16x32_bf16 v[232:235],a[100:103],a[20:23],v[232:235]
v_exp_f32 v212,v212
v_mfma_f32_16x16x32_bf16 v[232:235],a[96:99],a[16:19],v[232:235]
v_cvt_pk_bf16_f32 v180,v208,v209
v_cvt_pk_bf16_f32 v181,v210,v211
v_mfma_f32_16x16x32_bf16 v[240:243],a[96:99],a[32:35],0
ds_read_b128 a[136:139],v4 offset:18432
v_fma_f32 v213,v213,s26,-v20
v_mfma_f32_16x16x32_bf16 v[240:243],a[100:103],a[36:39],v[240:243]
v_exp_f32 v213,v213
v_mfma_f32_16x16x32_bf16 v[240:243],a[104:107],a[40:43],v[240:243]
v_cvt_pk_bf16_f32 v182,v212,v213
v_fma_f32 v214,v214,s26,-v20
v_mfma_f32_16x16x32_bf16 v[240:243],a[108:111],a[44:47],v[240:243]
ds_read_b128 a[140:143],v5 offset:18432
v_fma_f32 v215,v215,s26,-v20
v_mfma_f32_16x16x32_bf16 v[248:251],a[108:111],a[60:63],0
v_exp_f32 v214,v214
v_mfma_f32_16x16x32_bf16 v[248:251],a[104:107],a[56:59],v[248:251]
v_exp_f32 v215,v215
v_mfma_f32_16x16x32_bf16 v[248:251],a[100:103],a[52:55],v[248:251]
s_waitcnt lgkmcnt(4)
v_cvt_pk_bf16_f32 v183,v214,v215
v_fma_f32 v216,v216,s26,-v21
v_mfma_f32_16x16x32_bf16 v[248:251],a[96:99],a[48:51],v[248:251]
ds_read_b128 a[144:147],v2 offset:19456
v_exp_f32 v216,v216
v_mfma_f32_16x16x32_bf16 v[228:231],a[112:115],a[0:3],0
v_fma_f32 v217,v217,s26,-v21
v_fma_f32 v218,v218,s26,-v21
v_mfma_f32_16x16x32_bf16 v[228:231],a[116:119],a[4:7],v[228:231]
v_exp_f32 v217,v217
v_mfma_f32_16x16x32_bf16 v[228:231],a[120:123],a[8:11],v[228:231]
v_exp_f32 v218,v218
v_mfma_f32_16x16x32_bf16 v[228:231],a[124:127],a[12:15],v[228:231]
ds_read_b128 a[148:151],v3 offset:19456
v_cvt_pk_bf16_f32 v188,v216,v217
v_mfma_f32_16x16x32_bf16 v[236:239],a[124:127],a[28:31],0
v_fma_f32 v219,v219,s26,-v21
v_fma_f32 v220,v220,s26,-v21
v_mfma_f32_16x16x32_bf16 v[236:239],a[120:123],a[24:27],v[236:239]
v_exp_f32 v219,v219
v_mfma_f32_16x16x32_bf16 v[236:239],a[116:119],a[20:23],v[236:239]
s_add_u32 m0,s25,98304
ds_read_b128 a[152:155],v4 offset:19456
v_mfma_f32_16x16x32_bf16 v[236:239],a[112:115],a[16:19],v[236:239]
buffer_load_dwordx4 v1,s[12:15],s22 offen nt lds
v_mfma_f32_16x16x32_bf16 v[244:247],a[112:115],a[32:35],0
v_exp_f32 v220,v220
v_mfma_f32_16x16x32_bf16 v[244:247],a[116:119],a[36:39],v[244:247]
v_cvt_pk_bf16_f32 v189,v218,v219
v_fma_f32 v221,v221,s26,-v21
v_mfma_f32_16x16x32_bf16 v[244:247],a[120:123],a[40:43],v[244:247]
ds_read_b128 a[156:159],v5 offset:19456
v_fma_f32 v222,v222,s26,-v21
v_mfma_f32_16x16x32_bf16 v[244:247],a[124:127],a[44:47],v[244:247]
v_exp_f32 v221,v221
v_fma_f32 v223,v223,s26,-v21
v_mfma_f32_16x16x32_bf16 v[252:255],a[124:127],a[60:63],0
v_exp_f32 v222,v222
v_mfma_f32_16x16x32_bf16 v[252:255],a[120:123],a[56:59],v[252:255]
v_exp_f32 v223,v223
v_mfma_f32_16x16x32_bf16 v[252:255],a[116:119],a[52:55],v[252:255]
v_cvt_pk_bf16_f32 v190,v220,v221
v_cvt_pk_bf16_f32 v191,v222,v223
v_mfma_f32_16x16x32_bf16 v[252:255],a[112:115],a[48:51],v[252:255]
s_waitcnt lgkmcnt(4)
v_mfma_f32_16x16x32_bf16 v[192:195],a[128:131],a[0:3],0
v_fma_f32 v224,v224,s26,-v18
v_fma_f32 v225,v225,s26,-v18
v_mfma_f32_16x16x32_bf16 v[192:195],a[132:135],a[4:7],v[192:195]
v_exp_f32 v224,v224
v_mfma_f32_16x16x32_bf16 v[192:195],a[136:139],a[8:11],v[192:195]
v_exp_f32 v225,v225
v_mfma_f32_16x16x32_bf16 v[192:195],a[140:143],a[12:15],v[192:195]
buffer_load_dwordx4 v1,s[12:15],s22 offen offset:1024 nt lds
v_cvt_pk_bf16_f32 v224,v224,v225
v_mfma_f32_16x16x32_bf16 v[200:203],a[140:143],a[28:31],0
v_fma_f32 v226,v226,s26,-v18
v_fma_f32 v227,v227,s26,-v18
v_mfma_f32_16x16x32_bf16 v[200:203],a[136:139],a[24:27],v[200:203]
ds_read_b64_tr_b16 a[96:97],v6 offset:0
v_fma_f32 v228,v228,s26,-v18
v_mfma_f32_16x16x32_bf16 v[200:203],a[132:135],a[20:23],v[200:203]
ds_read_b64_tr_b16 a[98:99],v6 offset:1024
v_fma_f32 v229,v229,s26,-v18
v_mfma_f32_16x16x32_bf16 v[200:203],a[128:131],a[16:19],v[200:203]
v_exp_f32 v226,v226
v_fma_f32 v230,v230,s26,-v18
v_mfma_f32_16x16x32_bf16 v[208:211],a[128:131],a[32:35],0
ds_read_b64_tr_b16 a[100:101],v6 offset:2048
v_fma_f32 v231,v231,s26,-v18
v_mfma_f32_16x16x32_bf16 v[208:211],a[132:135],a[36:39],v[208:211]
ds_read_b64_tr_b16 a[102:103],v6 offset:3072
v_fma_f32 v232,v232,s26,-v19
v_mfma_f32_16x16x32_bf16 v[208:211],a[136:139],a[40:43],v[208:211]
v_exp_f32 v227,v227
v_mfma_f32_16x16x32_bf16 v[208:211],a[140:143],a[44:47],v[208:211]
buffer_load_dwordx4 v1,s[12:15],s22 offen offset:2048 nt lds
v_cvt_pk_bf16_f32 v225,v226,v227
v_mfma_f32_16x16x32_bf16 v[216:219],a[140:143],a[60:63],0
ds_read_b64_tr_b16 a[104:105],v6 offset:8
v_fma_f32 v233,v233,s26,-v19
v_mfma_f32_16x16x32_bf16 v[216:219],a[136:139],a[56:59],v[216:219]
ds_read_b64_tr_b16 a[106:107],v6 offset:1032
v_fma_f32 v234,v234,s26,-v19
v_mfma_f32_16x16x32_bf16 v[216:219],a[132:135],a[52:55],v[216:219]
v_exp_f32 v228,v228
v_mfma_f32_16x16x32_bf16 v[216:219],a[128:131],a[48:51],v[216:219]
s_waitcnt lgkmcnt(6)
v_exp_f32 v229,v229
v_fma_f32 v235,v235,s26,-v19
v_mfma_f32_16x16x32_bf16 v[196:199],a[144:147],a[0:3],0
ds_read_b64_tr_b16 a[108:109],v6 offset:2056
v_cvt_pk_bf16_f32 v226,v228,v229
v_mfma_f32_16x16x32_bf16 v[196:199],a[148:151],a[4:7],v[196:199]
ds_read_b64_tr_b16 a[110:111],v6 offset:3080
v_fma_f32 v236,v236,s26,-v19
v_mfma_f32_16x16x32_bf16 v[196:199],a[152:155],a[8:11],v[196:199]
v_exp_f32 v230,v230
v_mfma_f32_16x16x32_bf16 v[196:199],a[156:159],a[12:15],v[196:199]
ds_read_b64_tr_b16 a[112:113],v7 offset:0
v_exp_f32 v231,v231
v_mfma_f32_16x16x32_bf16 v[204:207],a[156:159],a[28:31],0
ds_read_b64_tr_b16 a[114:115],v7 offset:1024
v_cvt_pk_bf16_f32 v227,v230,v231
v_mfma_f32_16x16x32_bf16 v[204:207],a[152:155],a[24:27],v[204:207]
v_exp_f32 v232,v232
v_mfma_f32_16x16x32_bf16 v[204:207],a[148:151],a[20:23],v[204:207]
v_exp_f32 v233,v233
v_mfma_f32_16x16x32_bf16 v[204:207],a[144:147],a[16:19],v[204:207]
ds_read_b64_tr_b16 a[116:117],v7 offset:2048
v_exp_f32 v234,v234
v_mfma_f32_16x16x32_bf16 v[212:215],a[144:147],a[32:35],0
ds_read_b64_tr_b16 a[118:119],v7 offset:3072
v_cvt_pk_bf16_f32 v232,v232,v233
v_mfma_f32_16x16x32_bf16 v[212:215],a[148:151],a[36:39],v[212:215]
v_exp_f32 v235,v235
v_mfma_f32_16x16x32_bf16 v[212:215],a[152:155],a[40:43],v[212:215]
v_exp_f32 v236,v236
v_mfma_f32_16x16x32_bf16 v[212:215],a[156:159],a[44:47],v[212:215]
ds_read_b64_tr_b16 a[120:121],v7 offset:8
v_cvt_pk_bf16_f32 v233,v234,v235
v_fma_f32 v237,v237,s26,-v19
v_mfma_f32_16x16x32_bf16 v[220:223],a[156:159],a[60:63],0
ds_read_b64_tr_b16 a[122:123],v7 offset:1032
v_fma_f32 v238,v238,s26,-v19
v_mfma_f32_16x16x32_bf16 v[220:223],a[152:155],a[56:59],v[220:223]
v_exp_f32 v237,v237
v_mfma_f32_16x16x32_bf16 v[220:223],a[148:151],a[52:55],v[220:223]
ds_read_b64_tr_b16 a[124:125],v7 offset:2056
v_cvt_pk_bf16_f32 v234,v236,v237
v_mfma_f32_16x16x32_bf16 v[220:223],a[144:147],a[48:51],v[220:223]
s_waitcnt lgkmcnt(14)
ds_read_b64_tr_b16 a[126:127],v7 offset:3080
v_exp_f32 v238,v238
v_mfma_f32_16x16x32_bf16 a[224:227],a[240:243],v[160:163],a[224:227]
v_fma_f32 v239,v239,s26,-v19
v_fma_f32 v240,v240,s26,-v20
v_mfma_f32_16x16x32_bf16 a[224:227],a[240:243],v[164:167],a[224:227]
buffer_load_dwordx4 v1,s[12:15],s22 offen offset:3072 nt lds
v_fma_f32 v241,v241,s26,-v20
v_mfma_f32_16x16x32_bf16 a[228:231],a[240:243],v[168:171],a[228:231]
s_add_u32 s22,s22,16384
s_waitcnt lgkmcnt(14)
ds_read_b64_tr_b16 a[128:129],v8 offset:0
v_mfma_f32_16x16x32_bf16 a[228:231],a[240:243],v[172:175],a[228:231]
s_waitcnt lgkmcnt(14)
ds_read_b64_tr_b16 a[130:131],v8 offset:1024
v_exp_f32 v239,v239
v_mfma_f32_16x16x32_bf16 a[232:235],a[240:243],v[176:179],a[232:235]
v_exp_f32 v240,v240
v_mfma_f32_16x16x32_bf16 a[232:235],a[240:243],v[180:183],a[232:235]
s_waitcnt lgkmcnt(14)
v_cvt_pk_bf16_f32 v235,v238,v239
v_exp_f32 v241,v241
v_mfma_f32_16x16x32_bf16 a[236:239],a[240:243],v[184:187],a[236:239]
ds_read_b64_tr_b16 a[132:133],v8 offset:2048
v_cvt_pk_bf16_f32 v240,v240,v241
v_mfma_f32_16x16x32_bf16 a[236:239],a[240:243],v[188:191],a[236:239]
s_waitcnt lgkmcnt(14)
ds_read_b64_tr_b16 a[134:135],v8 offset:3072
v_fma_f32 v242,v242,s26,-v20
v_fma_f32 v243,v243,s26,-v20
v_mfma_f32_16x16x32_bf16 v[80:83],a[96:99],v[184:187],v[80:83]
v_exp_f32 v242,v242
v_mfma_f32_16x16x32_bf16 v[80:83],a[100:103],v[188:191],v[80:83]
s_waitcnt lgkmcnt(14)
ds_read_b64_tr_b16 a[136:137],v8 offset:8
v_fma_f32 v244,v244,s26,-v20
v_mfma_f32_16x16x32_bf16 v[64:67],a[100:103],v[180:183],v[64:67]
s_add_u32 s30,s24,32768
s_add_u32 s32,s24,36864
s_waitcnt lgkmcnt(14)
ds_read_b64_tr_b16 a[138:139],v8 offset:1032
v_mfma_f32_16x16x32_bf16 v[64:67],a[96:99],v[176:179],v[64:67]
buffer_store_dwordx4 v[128:131],v22,s[16:19],s30 offen sc0 sc1
buffer_store_dwordx4 v[132:135],v22,s[16:19],s32 offen sc0 sc1
v_fma_f32 v245,v245,s26,-v20
v_mfma_f32_16x16x32_bf16 v[48:51],a[96:99],v[168:171],v[48:51]
v_exp_f32 v243,v243
v_mfma_f32_16x16x32_bf16 v[48:51],a[100:103],v[172:175],v[48:51]
s_waitcnt lgkmcnt(14)
ds_read_b64_tr_b16 a[140:141],v8 offset:2056
v_exp_f32 v244,v244
v_mfma_f32_16x16x32_bf16 v[32:35],a[100:103],v[164:167],v[32:35]
s_waitcnt lgkmcnt(14)
ds_read_b64_tr_b16 a[142:143],v8 offset:3080
v_cvt_pk_bf16_f32 v241,v242,v243
v_mfma_f32_16x16x32_bf16 v[32:35],a[96:99],v[160:163],v[32:35]
v_exp_f32 v245,v245
v_fma_f32 v246,v246,s26,-v20
v_mfma_f32_16x16x32_bf16 v[36:39],a[104:107],v[160:163],v[36:39]
v_exp_f32 v246,v246
v_mfma_f32_16x16x32_bf16 v[36:39],a[108:111],v[164:167],v[36:39]
s_waitcnt lgkmcnt(14)
ds_read_b64_tr_b16 a[144:145],v9 offset:0
v_cvt_pk_bf16_f32 v242,v244,v245
v_fma_f32 v247,v247,s26,-v20
v_mfma_f32_16x16x32_bf16 v[52:55],a[108:111],v[172:175],v[52:55]
s_waitcnt lgkmcnt(14)
ds_read_b64_tr_b16 a[146:147],v9 offset:1024
v_fma_f32 v248,v248,s26,-v21
v_mfma_f32_16x16x32_bf16 v[52:55],a[104:107],v[168:171],v[52:55]
v_exp_f32 v247,v247
v_fma_f32 v249,v249,s26,-v21
v_mfma_f32_16x16x32_bf16 v[68:71],a[104:107],v[176:179],v[68:71]
s_waitcnt lgkmcnt(14)
ds_read_b64_tr_b16 a[148:149],v9 offset:2048
v_cvt_pk_bf16_f32 v243,v246,v247
v_mfma_f32_16x16x32_bf16 v[68:71],a[108:111],v[180:183],v[68:71]
s_waitcnt lgkmcnt(14)
ds_read_b64_tr_b16 a[150:151],v9 offset:3072
v_exp_f32 v248,v248
v_mfma_f32_16x16x32_bf16 v[84:87],a[108:111],v[188:191],v[84:87]
v_exp_f32 v249,v249
v_mfma_f32_16x16x32_bf16 v[84:87],a[104:107],v[184:187],v[84:87]
v_cvt_pk_bf16_f32 v248,v248,v249
v_fma_f32 v250,v250,s26,-v21
v_fma_f32 v251,v251,s26,-v21
v_mfma_f32_16x16x32_bf16 v[88:91],a[112:115],v[184:187],v[88:91]
s_waitcnt lgkmcnt(14)
ds_read_b64_tr_b16 a[152:153],v9 offset:8
v_fma_f32 v252,v252,s26,-v21
v_mfma_f32_16x16x32_bf16 v[88:91],a[116:119],v[188:191],v[88:91]
s_waitcnt lgkmcnt(14)
ds_read_b64_tr_b16 a[154:155],v9 offset:1032
v_exp_f32 v250,v250
v_mfma_f32_16x16x32_bf16 v[72:75],a[116:119],v[180:183],v[72:75]
v_exp_f32 v251,v251
v_mfma_f32_16x16x32_bf16 v[72:75],a[112:115],v[176:179],v[72:75]
s_waitcnt lgkmcnt(14)
ds_read_b64_tr_b16 a[156:157],v9 offset:2056
v_exp_f32 v252,v252
v_mfma_f32_16x16x32_bf16 v[56:59],a[112:115],v[168:171],v[56:59]
s_add_u32 s30,s24,40960
s_add_u32 s32,s24,45056
s_waitcnt lgkmcnt(14)
ds_read_b64_tr_b16 a[158:159],v9 offset:3080
v_mfma_f32_16x16x32_bf16 v[56:59],a[116:119],v[172:175],v[56:59]
buffer_store_dwordx4 v[136:139],v22,s[16:19],s30 offen sc0 sc1
buffer_store_dwordx4 v[140:143],v22,s[16:19],s32 offen sc0 sc1
v_cvt_pk_bf16_f32 v249,v250,v251
v_mfma_f32_16x16x32_bf16 v[40:43],a[116:119],v[164:167],v[40:43]
v_fma_f32 v253,v253,s26,-v21
v_fma_f32 v254,v254,s26,-v21
v_mfma_f32_16x16x32_bf16 v[40:43],a[112:115],v[160:163],v[40:43]
v_exp_f32 v253,v253
v_fma_f32 v255,v255,s26,-v21
v_mfma_f32_16x16x32_bf16 v[44:47],a[120:123],v[160:163],v[44:47]
v_exp_f32 v254,v254
v_mfma_f32_16x16x32_bf16 v[44:47],a[124:127],v[164:167],v[44:47]
v_cvt_pk_bf16_f32 v250,v252,v253
v_exp_f32 v255,v255
v_mfma_f32_16x16x32_bf16 v[60:63],a[124:127],v[172:175],v[60:63]
v_cvt_pk_bf16_f32 v251,v254,v255
v_mfma_f32_16x16x32_bf16 v[60:63],a[120:123],v[168:171],v[60:63]
v_mfma_f32_16x16x32_bf16 v[76:79],a[120:123],v[176:179],v[76:79]
v_fma_f32 v192,v192,s26,-v18
v_fma_f32 v193,v193,s26,-v18
v_mfma_f32_16x16x32_bf16 v[76:79],a[124:127],v[180:183],v[76:79]
v_exp_f32 v192,v192
v_mfma_f32_16x16x32_bf16 v[92:95],a[124:127],v[188:191],v[92:95]
v_exp_f32 v193,v193
v_mfma_f32_16x16x32_bf16 v[92:95],a[120:123],v[184:187],v[92:95]
s_waitcnt lgkmcnt(12)
v_cvt_pk_bf16_f32 v228,v192,v193
v_fma_f32 v194,v194,s26,-v18
v_mfma_f32_16x16x32_bf16 a[208:211],a[128:131],v[184:187],a[208:211]
v_exp_f32 v194,v194
v_mfma_f32_16x16x32_bf16 a[208:211],a[132:135],v[188:191],a[208:211]
v_fma_f32 v195,v195,s26,-v18
v_fma_f32 v196,v196,s26,-v18
v_fma_f32 v197,v197,s26,-v18
v_mfma_f32_16x16x32_bf16 a[192:195],a[132:135],v[180:183],a[192:195]
v_exp_f32 v195,v195
v_mfma_f32_16x16x32_bf16 a[192:195],a[128:131],v[176:179],a[192:195]
s_waitcnt vmcnt(16)
s_waitcnt lgkmcnt(0)
s_barrier
ds_read_b128 a[96:99],v2 offset:32768
v_cvt_pk_bf16_f32 v229,v194,v195
v_mfma_f32_16x16x32_bf16 a[176:179],a[128:131],v[168:171],a[176:179]
s_add_u32 m0,s25,0
v_exp_f32 v196,v196
v_mfma_f32_16x16x32_bf16 a[176:179],a[132:135],v[172:175],a[176:179]
buffer_load_dwordx4 v1,s[8:11],s21 offen nt lds
v_mfma_f32_16x16x32_bf16 a[160:163],a[132:135],v[164:167],a[160:163]
v_exp_f32 v197,v197
v_mfma_f32_16x16x32_bf16 a[160:163],a[128:131],v[160:163],a[160:163]
ds_read_b128 a[100:103],v3 offset:32768
v_cvt_pk_bf16_f32 v230,v196,v197
v_mfma_f32_16x16x32_bf16 a[164:167],a[136:139],v[160:163],a[164:167]
v_fma_f32 v198,v198,s26,-v18
v_fma_f32 v199,v199,s26,-v18
v_mfma_f32_16x16x32_bf16 a[164:167],a[140:143],v[164:167],a[164:167]
v_exp_f32 v198,v198
v_fma_f32 v200,v200,s26,-v19
v_mfma_f32_16x16x32_bf16 a[180:183],a[140:143],v[172:175],a[180:183]
ds_read_b128 a[104:107],v4 offset:32768
v_fma_f32 v201,v201,s26,-v19
v_mfma_f32_16x16x32_bf16 a[180:183],a[136:139],v[168:171],a[180:183]
v_exp_f32 v199,v199
v_mfma_f32_16x16x32_bf16 a[196:199],a[136:139],v[176:179],a[196:199]
v_exp_f32 v200,v200
v_mfma_f32_16x16x32_bf16 a[196:199],a[140:143],v[180:183],a[196:199]
buffer_load_dwordx4 v1,s[8:11],s21 offen offset:1024 nt lds
v_mfma_f32_16x16x32_bf16 a[212:215],a[140:143],v[188:191],a[212:215]
ds_read_b128 a[108:111],v5 offset:32768
v_cvt_pk_bf16_f32 v231,v198,v199
v_mfma_f32_16x16x32_bf16 a[212:215],a[136:139],v[184:187],a[212:215]
v_exp_f32 v201,v201
v_mfma_f32_16x16x32_bf16 a[216:219],a[144:147],v[184:187],a[216:219]
v_cvt_pk_bf16_f32 v236,v200,v201
v_fma_f32 v202,v202,s26,-v19
v_mfma_f32_16x16x32_bf16 a[216:219],a[148:151],v[188:191],a[216:219]
v_fma_f32 v203,v203,s26,-v19
v_exp_f32 v202,v202
v_mfma_f32_16x16x32_bf16 a[200:203],a[148:151],v[180:183],a[200:203]
ds_read_b128 a[112:115],v2 offset:33792
v_fma_f32 v204,v204,s26,-v19
v_mfma_f32_16x16x32_bf16 a[200:203],a[144:147],v[176:179],a[200:203]
v_exp_f32 v203,v203
v_mfma_f32_16x16x32_bf16 a[184:187],a[144:147],v[168:171],a[184:187]
v_exp_f32 v204,v204
v_mfma_f32_16x16x32_bf16 a[184:187],a[148:151],v[172:175],a[184:187]
ds_read_b128 a[116:119],v3 offset:33792
v_cvt_pk_bf16_f32 v237,v202,v203
v_mfma_f32_16x16x32_bf16 a[168:171],a[148:151],v[164:167],a[168:171]
v_fma_f32 v205,v205,s26,-v19
v_fma_f32 v206,v206,s26,-v19
v_mfma_f32_16x16x32_bf16 a[168:171],a[144:147],v[160:163],a[168:171]
v_exp_f32 v205,v205
v_mfma_f32_16x16x32_bf16 a[172:175],a[152:155],v[160:163],a[172:175]
v_exp_f32 v206,v206
v_mfma_f32_16x16x32_bf16 a[172:175],a[156:159],v[164:167],a[172:175]
ds_read_b128 a[120:123],v4 offset:33792
v_cvt_pk_bf16_f32 v238,v204,v205
v_mfma_f32_16x16x32_bf16 a[188:191],a[156:159],v[172:175],a[188:191]
v_fma_f32 v207,v207,s26,-v19
v_fma_f32 v208,v208,s26,-v20
v_mfma_f32_16x16x32_bf16 a[188:191],a[152:155],v[168:171],a[188:191]
buffer_load_dwordx4 v1,s[8:11],s21 offen offset:2048 nt lds
v_fma_f32 v209,v209,s26,-v20
v_mfma_f32_16x16x32_bf16 a[204:207],a[152:155],v[176:179],a[204:207]
v_exp_f32 v207,v207
v_mfma_f32_16x16x32_bf16 a[204:207],a[156:159],v[180:183],a[204:207]
ds_read_b128 a[124:127],v5 offset:33792
v_cvt_pk_bf16_f32 v239,v206,v207
v_mfma_f32_16x16x32_bf16 a[220:223],a[156:159],v[188:191],a[220:223]
v_exp_f32 v208,v208
v_mfma_f32_16x16x32_bf16 a[220:223],a[152:155],v[184:187],a[220:223]
s_waitcnt lgkmcnt(4)
v_exp_f32 v209,v209
v_mfma_f32_16x16x32_bf16 v[160:163],a[96:99],a[0:3],0
ds_read_b128 a[128:131],v2 offset:34816
v_cvt_pk_bf16_f32 v244,v208,v209
v_mfma_f32_16x16x32_bf16 v[160:163],a[100:103],a[4:7],v[160:163]
v_fma_f32 v210,v210,s26,-v20
v_fma_f32 v211,v211,s26,-v20
v_mfma_f32_16x16x32_bf16 v[160:163],a[104:107],a[8:11],v[160:163]
v_exp_f32 v210,v210
v_mfma_f32_16x16x32_bf16 v[160:163],a[108:111],a[12:15],v[160:163]
buffer_load_dwordx4 v1,s[8:11],s21 offen offset:3072 nt lds
v_mfma_f32_16x16x32_bf16 v[168:171],a[108:111],a[28:31],0
s_add_u32 s21,s21,16384
ds_read_b128 a[132:135],v3 offset:34816
v_mfma_f32_16x16x32_bf16 v[168:171],a[104:107],a[24:27],v[168:171]
v_exp_f32 v211,v211
v_mfma_f32_16x16x32_bf16 v[168:171],a[100:103],a[20:23],v[168:171]
v_cvt_pk_bf16_f32 v245,v210,v211
v_fma_f32 v212,v212,s26,-v20
v_mfma_f32_16x16x32_bf16 v[168:171],a[96:99],a[16:19],v[168:171]
v_fma_f32 v213,v213,s26,-v20
v_exp_f32 v212,v212
v_mfma_f32_16x16x32_bf16 v[176:179],a[96:99],a[32:35],0
ds_read_b128 a[136:139],v4 offset:34816
v_fma_f32 v214,v214,s26,-v20
v_mfma_f32_16x16x32_bf16 v[176:179],a[100:103],a[36:39],v[176:179]
v_exp_f32 v213,v213
v_mfma_f32_16x16x32_bf16 v[176:179],a[104:107],a[40:43],v[176:179]
v_exp_f32 v214,v214
v_mfma_f32_16x16x32_bf16 v[176:179],a[108:111],a[44:47],v[176:179]
ds_read_b128 a[140:143],v5 offset:34816
v_cvt_pk_bf16_f32 v246,v212,v213
v_mfma_f32_16x16x32_bf16 v[184:187],a[108:111],a[60:63],0
v_fma_f32 v215,v215,s26,-v20
v_fma_f32 v216,v216,s26,-v21
v_mfma_f32_16x16x32_bf16 v[184:187],a[104:107],a[56:59],v[184:187]
v_exp_f32 v215,v215
v_mfma_f32_16x16x32_bf16 v[184:187],a[100:103],a[52:55],v[184:187]
s_waitcnt lgkmcnt(4)
v_exp_f32 v216,v216
v_mfma_f32_16x16x32_bf16 v[184:187],a[96:99],a[48:51],v[184:187]
ds_read_b128 a[144:147],v2 offset:35840
v_cvt_pk_bf16_f32 v247,v214,v215
v_mfma_f32_16x16x32_bf16 v[164:167],a[112:115],a[0:3],0
v_fma_f32 v217,v217,s26,-v21
v_fma_f32 v218,v218,s26,-v21
v_mfma_f32_16x16x32_bf16 v[164:167],a[116:119],a[4:7],v[164:167]
v_exp_f32 v217,v217
v_mfma_f32_16x16x32_bf16 v[164:167],a[120:123],a[8:11],v[164:167]
v_exp_f32 v218,v218
v_mfma_f32_16x16x32_bf16 v[164:167],a[124:127],a[12:15],v[164:167]
ds_read_b128 a[148:151],v3 offset:35840
v_cvt_pk_bf16_f32 v252,v216,v217
v_mfma_f32_16x16x32_bf16 v[172:175],a[124:127],a[28:31],0
v_fma_f32 v219,v219,s26,-v21
v_fma_f32 v220,v220,s26,-v21
v_mfma_f32_16x16x32_bf16 v[172:175],a[120:123],a[24:27],v[172:175]
v_exp_f32 v219,v219
v_mfma_f32_16x16x32_bf16 v[172:175],a[116:119],a[20:23],v[172:175]
s_add_u32 m0,s25,114688
ds_read_b128 a[152:155],v4 offset:35840
v_mfma_f32_16x16x32_bf16 v[172:175],a[112:115],a[16:19],v[172:175]
buffer_load_dwordx4 v1,s[12:15],s22 offen nt lds
v_cvt_pk_bf16_f32 v253,v218,v219
v_mfma_f32_16x16x32_bf16 v[180:183],a[112:115],a[32:35],0
v_exp_f32 v220,v220
v_mfma_f32_16x16x32_bf16 v[180:183],a[116:119],a[36:39],v[180:183]
v_fma_f32 v221,v221,s26,-v21
v_fma_f32 v222,v222,s26,-v21
v_mfma_f32_16x16x32_bf16 v[180:183],a[120:123],a[40:43],v[180:183]
ds_read_b128 a[156:159],v5 offset:35840
v_fma_f32 v223,v223,s26,-v21
v_mfma_f32_16x16x32_bf16 v[180:183],a[124:127],a[44:47],v[180:183]
v_exp_f32 v221,v221
v_mfma_f32_16x16x32_bf16 v[188:191],a[124:127],a[60:63],0
v_exp_f32 v222,v222
v_mfma_f32_16x16x32_bf16 v[188:191],a[120:123],a[56:59],v[188:191]
v_exp_f32 v223,v223
v_mfma_f32_16x16x32_bf16 v[188:191],a[116:119],a[52:55],v[188:191]
v_cvt_pk_bf16_f32 v254,v220,v221
v_cvt_pk_bf16_f32 v255,v222,v223
v_mfma_f32_16x16x32_bf16 v[188:191],a[112:115],a[48:51],v[188:191]
s_waitcnt lgkmcnt(4)
v_mfma_f32_16x16x32_bf16 v[192:195],a[128:131],a[0:3],0
v_fma_f32 v160,v160,s26,-v18
v_fma_f32 v161,v161,s26,-v18
v_mfma_f32_16x16x32_bf16 v[192:195],a[132:135],a[4:7],v[192:195]
v_exp_f32 v160,v160
v_mfma_f32_16x16x32_bf16 v[192:195],a[136:139],a[8:11],v[192:195]
v_exp_f32 v161,v161
v_mfma_f32_16x16x32_bf16 v[192:195],a[140:143],a[12:15],v[192:195]
buffer_load_dwordx4 v1,s[12:15],s22 offen offset:1024 nt lds
v_cvt_pk_bf16_f32 v160,v160,v161
v_mfma_f32_16x16x32_bf16 v[200:203],a[140:143],a[28:31],0
v_fma_f32 v162,v162,s26,-v18
v_fma_f32 v163,v163,s26,-v18
v_mfma_f32_16x16x32_bf16 v[200:203],a[136:139],a[24:27],v[200:203]
ds_read_b64_tr_b16 a[96:97],v6 offset:16384
v_fma_f32 v164,v164,s26,-v18
v_mfma_f32_16x16x32_bf16 v[200:203],a[132:135],a[20:23],v[200:203]
ds_read_b64_tr_b16 a[98:99],v6 offset:17408
v_fma_f32 v165,v165,s26,-v18
v_mfma_f32_16x16x32_bf16 v[200:203],a[128:131],a[16:19],v[200:203]
v_exp_f32 v162,v162
v_fma_f32 v166,v166,s26,-v18
v_mfma_f32_16x16x32_bf16 v[208:211],a[128:131],a[32:35],0
ds_read_b64_tr_b16 a[100:101],v6 offset:18432
v_fma_f32 v167,v167,s26,-v18
v_mfma_f32_16x16x32_bf16 v[208:211],a[132:135],a[36:39],v[208:211]
ds_read_b64_tr_b16 a[102:103],v6 offset:19456
v_fma_f32 v168,v168,s26,-v19
v_mfma_f32_16x16x32_bf16 v[208:211],a[136:139],a[40:43],v[208:211]
v_exp_f32 v163,v163
v_mfma_f32_16x16x32_bf16 v[208:211],a[140:143],a[44:47],v[208:211]
buffer_load_dwordx4 v1,s[12:15],s22 offen offset:2048 nt lds
v_cvt_pk_bf16_f32 v161,v162,v163
v_mfma_f32_16x16x32_bf16 v[216:219],a[140:143],a[60:63],0
ds_read_b64_tr_b16 a[104:105],v6 offset:16392
v_fma_f32 v169,v169,s26,-v19
v_mfma_f32_16x16x32_bf16 v[216:219],a[136:139],a[56:59],v[216:219]
ds_read_b64_tr_b16 a[106:107],v6 offset:17416
v_fma_f32 v170,v170,s26,-v19
v_mfma_f32_16x16x32_bf16 v[216:219],a[132:135],a[52:55],v[216:219]
v_exp_f32 v164,v164
v_mfma_f32_16x16x32_bf16 v[216:219],a[128:131],a[48:51],v[216:219]
s_waitcnt lgkmcnt(6)
v_exp_f32 v165,v165
v_fma_f32 v171,v171,s26,-v19
v_mfma_f32_16x16x32_bf16 v[196:199],a[144:147],a[0:3],0
ds_read_b64_tr_b16 a[108:109],v6 offset:18440
v_cvt_pk_bf16_f32 v162,v164,v165
v_mfma_f32_16x16x32_bf16 v[196:199],a[148:151],a[4:7],v[196:199]
ds_read_b64_tr_b16 a[110:111],v6 offset:19464
v_fma_f32 v172,v172,s26,-v19
v_mfma_f32_16x16x32_bf16 v[196:199],a[152:155],a[8:11],v[196:199]
v_exp_f32 v166,v166
v_mfma_f32_16x16x32_bf16 v[196:199],a[156:159],a[12:15],v[196:199]
ds_read_b64_tr_b16 a[112:113],v7 offset:16384
v_exp_f32 v167,v167
v_mfma_f32_16x16x32_bf16 v[204:207],a[156:159],a[28:31],0
ds_read_b64_tr_b16 a[114:115],v7 offset:17408
v_cvt_pk_bf16_f32 v163,v166,v167
v_mfma_f32_16x16x32_bf16 v[204:207],a[152:155],a[24:27],v[204:207]
v_exp_f32 v168,v168
v_mfma_f32_16x16x32_bf16 v[204:207],a[148:151],a[20:23],v[204:207]
v_exp_f32 v169,v169
v_mfma_f32_16x16x32_bf16 v[204:207],a[144:147],a[16:19],v[204:207]
ds_read_b64_tr_b16 a[116:117],v7 offset:18432
v_exp_f32 v170,v170
v_mfma_f32_16x16x32_bf16 v[212:215],a[144:147],a[32:35],0
ds_read_b64_tr_b16 a[118:119],v7 offset:19456
v_cvt_pk_bf16_f32 v168,v168,v169
v_mfma_f32_16x16x32_bf16 v[212:215],a[148:151],a[36:39],v[212:215]
v_exp_f32 v171,v171
v_mfma_f32_16x16x32_bf16 v[212:215],a[152:155],a[40:43],v[212:215]
v_exp_f32 v172,v172
v_mfma_f32_16x16x32_bf16 v[212:215],a[156:159],a[44:47],v[212:215]
ds_read_b64_tr_b16 a[120:121],v7 offset:16392
v_cvt_pk_bf16_f32 v169,v170,v171
v_fma_f32 v173,v173,s26,-v19
v_mfma_f32_16x16x32_bf16 v[220:223],a[156:159],a[60:63],0
ds_read_b64_tr_b16 a[122:123],v7 offset:17416
v_fma_f32 v174,v174,s26,-v19
v_mfma_f32_16x16x32_bf16 v[220:223],a[152:155],a[56:59],v[220:223]
v_exp_f32 v173,v173
v_mfma_f32_16x16x32_bf16 v[220:223],a[148:151],a[52:55],v[220:223]
ds_read_b64_tr_b16 a[124:125],v7 offset:18440
v_cvt_pk_bf16_f32 v170,v172,v173
v_mfma_f32_16x16x32_bf16 v[220:223],a[144:147],a[48:51],v[220:223]
s_waitcnt lgkmcnt(14)
ds_read_b64_tr_b16 a[126:127],v7 offset:19464
v_exp_f32 v174,v174
v_mfma_f32_16x16x32_bf16 a[224:227],a[240:243],v[224:227],a[224:227]
v_fma_f32 v175,v175,s26,-v19
v_fma_f32 v176,v176,s26,-v20
v_mfma_f32_16x16x32_bf16 a[224:227],a[240:243],v[228:231],a[224:227]
buffer_load_dwordx4 v1,s[12:15],s22 offen offset:3072 nt lds
v_fma_f32 v177,v177,s26,-v20
v_mfma_f32_16x16x32_bf16 a[228:231],a[240:243],v[232:235],a[228:231]
s_add_u32 s22,s22,16384
s_waitcnt lgkmcnt(14)
ds_read_b64_tr_b16 a[128:129],v8 offset:16384
v_mfma_f32_16x16x32_bf16 a[228:231],a[240:243],v[236:239],a[228:231]
s_waitcnt lgkmcnt(14)
ds_read_b64_tr_b16 a[130:131],v8 offset:17408
v_exp_f32 v175,v175
v_mfma_f32_16x16x32_bf16 a[232:235],a[240:243],v[240:243],a[232:235]
v_exp_f32 v176,v176
v_mfma_f32_16x16x32_bf16 a[232:235],a[240:243],v[244:247],a[232:235]
s_waitcnt lgkmcnt(14)
v_cvt_pk_bf16_f32 v171,v174,v175
v_exp_f32 v177,v177
v_mfma_f32_16x16x32_bf16 a[236:239],a[240:243],v[248:251],a[236:239]
ds_read_b64_tr_b16 a[132:133],v8 offset:18432
v_cvt_pk_bf16_f32 v176,v176,v177
v_mfma_f32_16x16x32_bf16 a[236:239],a[240:243],v[252:255],a[236:239]
s_waitcnt lgkmcnt(14)
ds_read_b64_tr_b16 a[134:135],v8 offset:19456
v_fma_f32 v178,v178,s26,-v20
v_fma_f32 v179,v179,s26,-v20
v_mfma_f32_16x16x32_bf16 v[80:83],a[96:99],v[248:251],v[80:83]
v_exp_f32 v178,v178
v_mfma_f32_16x16x32_bf16 v[80:83],a[100:103],v[252:255],v[80:83]
s_waitcnt lgkmcnt(14)
ds_read_b64_tr_b16 a[136:137],v8 offset:16392
v_exp_f32 v179,v179
v_mfma_f32_16x16x32_bf16 v[64:67],a[100:103],v[244:247],v[64:67]
s_add_u32 m0,s25,131072
s_waitcnt lgkmcnt(14)
ds_read_b64_tr_b16 a[138:139],v8 offset:17416
v_mfma_f32_16x16x32_bf16 v[64:67],a[96:99],v[240:243],v[64:67]
buffer_load_dwordx4 v1,s[4:7],s23 offen nt lds
v_cvt_pk_bf16_f32 v177,v178,v179
v_mfma_f32_16x16x32_bf16 v[48:51],a[96:99],v[232:235],v[48:51]
v_fma_f32 v180,v180,s26,-v20
v_fma_f32 v181,v181,s26,-v20
v_mfma_f32_16x16x32_bf16 v[48:51],a[100:103],v[236:239],v[48:51]
s_waitcnt lgkmcnt(14)
ds_read_b64_tr_b16 a[140:141],v8 offset:18440
v_exp_f32 v180,v180
v_mfma_f32_16x16x32_bf16 v[32:35],a[100:103],v[228:231],v[32:35]
s_waitcnt lgkmcnt(14)
ds_read_b64_tr_b16 a[142:143],v8 offset:19464
v_fma_f32 v182,v182,s26,-v20
v_mfma_f32_16x16x32_bf16 v[32:35],a[96:99],v[224:227],v[32:35]
v_exp_f32 v181,v181
v_fma_f32 v183,v183,s26,-v20
v_mfma_f32_16x16x32_bf16 v[36:39],a[104:107],v[224:227],v[36:39]
v_exp_f32 v182,v182
v_mfma_f32_16x16x32_bf16 v[36:39],a[108:111],v[228:231],v[36:39]
s_waitcnt lgkmcnt(14)
ds_read_b64_tr_b16 a[144:145],v9 offset:16384
v_exp_f32 v183,v183
v_mfma_f32_16x16x32_bf16 v[52:55],a[108:111],v[236:239],v[52:55]
s_waitcnt lgkmcnt(14)
ds_read_b64_tr_b16 a[146:147],v9 offset:17408
v_cvt_pk_bf16_f32 v178,v180,v181
v_mfma_f32_16x16x32_bf16 v[52:55],a[104:107],v[232:235],v[52:55]
buffer_load_dwordx4 v1,s[4:7],s23 offen offset:1024 nt lds
v_cvt_pk_bf16_f32 v179,v182,v183
v_mfma_f32_16x16x32_bf16 v[68:71],a[104:107],v[240:243],v[68:71]
s_waitcnt lgkmcnt(14)
ds_read_b64_tr_b16 a[148:149],v9 offset:18432
v_fma_f32 v184,v184,s26,-v21
v_mfma_f32_16x16x32_bf16 v[68:71],a[108:111],v[244:247],v[68:71]
s_waitcnt lgkmcnt(14)
ds_read_b64_tr_b16 a[150:151],v9 offset:19456
v_exp_f32 v184,v184
v_mfma_f32_16x16x32_bf16 v[84:87],a[108:111],v[252:255],v[84:87]
v_fma_f32 v185,v185,s26,-v21
v_fma_f32 v186,v186,s26,-v21
v_mfma_f32_16x16x32_bf16 v[84:87],a[104:107],v[248:251],v[84:87]
v_exp_f32 v185,v185
v_fma_f32 v187,v187,s26,-v21
v_mfma_f32_16x16x32_bf16 v[88:91],a[112:115],v[248:251],v[88:91]
s_waitcnt lgkmcnt(14)
ds_read_b64_tr_b16 a[152:153],v9 offset:16392
v_cvt_pk_bf16_f32 v184,v184,v185
v_mfma_f32_16x16x32_bf16 v[88:91],a[116:119],v[252:255],v[88:91]
s_waitcnt lgkmcnt(14)
ds_read_b64_tr_b16 a[154:155],v9 offset:17416
v_exp_f32 v186,v186
v_mfma_f32_16x16x32_bf16 v[72:75],a[116:119],v[244:247],v[72:75]
v_exp_f32 v187,v187
v_mfma_f32_16x16x32_bf16 v[72:75],a[112:115],v[240:243],v[72:75]
s_waitcnt lgkmcnt(14)
ds_read_b64_tr_b16 a[156:157],v9 offset:18440
v_cvt_pk_bf16_f32 v185,v186,v187
v_fma_f32 v188,v188,s26,-v21
v_mfma_f32_16x16x32_bf16 v[56:59],a[112:115],v[232:235],v[56:59]
s_waitcnt lgkmcnt(14)
ds_read_b64_tr_b16 a[158:159],v9 offset:19464
v_fma_f32 v189,v189,s26,-v21
v_mfma_f32_16x16x32_bf16 v[56:59],a[116:119],v[236:239],v[56:59]
buffer_load_dwordx4 v1,s[4:7],s23 offen offset:2048 nt lds
v_fma_f32 v190,v190,s26,-v21
v_mfma_f32_16x16x32_bf16 v[40:43],a[116:119],v[228:231],v[40:43]
v_exp_f32 v188,v188
v_mfma_f32_16x16x32_bf16 v[40:43],a[112:115],v[224:227],v[40:43]
v_exp_f32 v189,v189
v_fma_f32 v191,v191,s26,-v21
v_mfma_f32_16x16x32_bf16 v[44:47],a[120:123],v[224:227],v[44:47]
v_exp_f32 v190,v190
v_mfma_f32_16x16x32_bf16 v[44:47],a[124:127],v[228:231],v[44:47]
v_cvt_pk_bf16_f32 v186,v188,v189
v_exp_f32 v191,v191
v_mfma_f32_16x16x32_bf16 v[60:63],a[124:127],v[236:239],v[60:63]
v_cvt_pk_bf16_f32 v187,v190,v191
v_mfma_f32_16x16x32_bf16 v[60:63],a[120:123],v[232:235],v[60:63]
v_mfma_f32_16x16x32_bf16 v[76:79],a[120:123],v[240:243],v[76:79]
v_fma_f32 v192,v192,s26,-v18
v_fma_f32 v193,v193,s26,-v18
v_mfma_f32_16x16x32_bf16 v[76:79],a[124:127],v[244:247],v[76:79]
buffer_load_dwordx4 v1,s[4:7],s23 offen offset:3072 nt lds
v_mfma_f32_16x16x32_bf16 v[92:95],a[124:127],v[252:255],v[92:95]
s_add_u32 s23,s23,16384
v_exp_f32 v192,v192
v_mfma_f32_16x16x32_bf16 v[92:95],a[120:123],v[248:251],v[92:95]
s_waitcnt lgkmcnt(12)
v_exp_f32 v193,v193
v_fma_f32 v194,v194,s26,-v18
v_mfma_f32_16x16x32_bf16 a[208:211],a[128:131],v[248:251],a[208:211]
v_exp_f32 v194,v194
v_mfma_f32_16x16x32_bf16 a[208:211],a[132:135],v[252:255],a[208:211]
v_cvt_pk_bf16_f32 v164,v192,v193
v_fma_f32 v195,v195,s26,-v18
v_mfma_f32_16x16x32_bf16 a[192:195],a[132:135],v[244:247],a[192:195]
v_exp_f32 v195,v195
v_mfma_f32_16x16x32_bf16 a[192:195],a[128:131],v[240:243],a[192:195]
s_waitcnt vmcnt(16)
s_waitcnt lgkmcnt(0)
s_barrier
ds_read_b128 a[96:99],v2 offset:49152
v_cvt_pk_bf16_f32 v165,v194,v195
v_mfma_f32_16x16x32_bf16 a[176:179],a[128:131],v[232:235],a[176:179]
s_add_u32 m0,s25,16384
v_fma_f32 v196,v196,s26,-v18
v_fma_f32 v197,v197,s26,-v18
v_mfma_f32_16x16x32_bf16 a[176:179],a[132:135],v[236:239],a[176:179]
buffer_load_dwordx4 v1,s[8:11],s21 offen nt lds
v_fma_f32 v198,v198,s26,-v18
v_mfma_f32_16x16x32_bf16 a[160:163],a[132:135],v[228:231],a[160:163]
v_exp_f32 v196,v196
v_mfma_f32_16x16x32_bf16 a[160:163],a[128:131],v[224:227],a[160:163]
ds_read_b128 a[100:103],v3 offset:49152
v_fma_f32 v199,v199,s26,-v18
v_mfma_f32_16x16x32_bf16 a[164:167],a[136:139],v[224:227],a[164:167]
v_exp_f32 v197,v197
v_mfma_f32_16x16x32_bf16 a[164:167],a[140:143],v[228:231],a[164:167]
v_exp_f32 v198,v198
v_mfma_f32_16x16x32_bf16 a[180:183],a[140:143],v[236:239],a[180:183]
ds_read_b128 a[104:107],v4 offset:49152
v_cvt_pk_bf16_f32 v166,v196,v197
v_mfma_f32_16x16x32_bf16 a[180:183],a[136:139],v[232:235],a[180:183]
v_exp_f32 v199,v199
v_mfma_f32_16x16x32_bf16 a[196:199],a[136:139],v[240:243],a[196:199]
v_cvt_pk_bf16_f32 v167,v198,v199
v_fma_f32 v200,v200,s26,-v19
v_mfma_f32_16x16x32_bf16 a[196:199],a[140:143],v[244:247],a[196:199]
buffer_load_dwordx4 v1,s[8:11],s21 offen offset:1024 nt lds
v_fma_f32 v201,v201,s26,-v19
v_mfma_f32_16x16x32_bf16 a[212:215],a[140:143],v[252:255],a[212:215]
ds_read_b128 a[108:111],v5 offset:49152
v_fma_f32 v202,v202,s26,-v19
v_mfma_f32_16x16x32_bf16 a[212:215],a[136:139],v[248:251],a[212:215]
v_exp_f32 v200,v200
v_mfma_f32_16x16x32_bf16 a[216:219],a[144:147],v[248:251],a[216:219]
v_exp_f32 v201,v201
v_mfma_f32_16x16x32_bf16 a[216:219],a[148:151],v[252:255],a[216:219]
v_exp_f32 v202,v202
v_mfma_f32_16x16x32_bf16 a[200:203],a[148:151],v[244:247],a[200:203]
ds_read_b128 a[112:115],v2 offset:50176
v_cvt_pk_bf16_f32 v172,v200,v201
v_mfma_f32_16x16x32_bf16 a[200:203],a[144:147],v[240:243],a[200:203]
v_fma_f32 v203,v203,s26,-v19
v_fma_f32 v204,v204,s26,-v19
v_fma_f32 v205,v205,s26,-v19
v_mfma_f32_16x16x32_bf16 a[184:187],a[144:147],v[232:235],a[184:187]
v_exp_f32 v203,v203
v_mfma_f32_16x16x32_bf16 a[184:187],a[148:151],v[236:239],a[184:187]
ds_read_b128 a[116:119],v3 offset:50176
v_cvt_pk_bf16_f32 v173,v202,v203
v_mfma_f32_16x16x32_bf16 a[168:171],a[148:151],v[228:231],a[168:171]
v_exp_f32 v204,v204
v_mfma_f32_16x16x32_bf16 a[168:171],a[144:147],v[224:227],a[168:171]
v_exp_f32 v205,v205
v_mfma_f32_16x16x32_bf16 a[172:175],a[152:155],v[224:227],a[172:175]
v_cvt_pk_bf16_f32 v174,v204,v205
v_fma_f32 v206,v206,s26,-v19
v_mfma_f32_16x16x32_bf16 a[172:175],a[156:159],v[228:231],a[172:175]
ds_read_b128 a[120:123],v4 offset:50176
v_exp_f32 v206,v206
v_mfma_f32_16x16x32_bf16 a[188:191],a[156:159],v[236:239],a[188:191]
v_fma_f32 v207,v207,s26,-v19
v_fma_f32 v208,v208,s26,-v20
v_mfma_f32_16x16x32_bf16 a[188:191],a[152:155],v[232:235],a[188:191]
buffer_load_dwordx4 v1,s[8:11],s21 offen offset:2048 nt lds
v_mfma_f32_16x16x32_bf16 a[204:207],a[152:155],v[240:243],a[204:207]
v_exp_f32 v207,v207
v_mfma_f32_16x16x32_bf16 a[204:207],a[156:159],v[244:247],a[204:207]
ds_read_b128 a[124:127],v5 offset:50176
v_cvt_pk_bf16_f32 v175,v206,v207
v_mfma_f32_16x16x32_bf16 a[220:223],a[156:159],v[252:255],a[220:223]
v_exp_f32 v208,v208
v_mfma_f32_16x16x32_bf16 a[220:223],a[152:155],v[248:251],a[220:223]
s_waitcnt lgkmcnt(4)
v_fma_f32 v209,v209,s26,-v20
v_fma_f32 v210,v210,s26,-v20
v_fma_f32 v211,v211,s26,-v20
v_mfma_f32_16x16x32_bf16 v[224:227],a[96:99],a[0:3],0
ds_read_b128 a[128:131],v2 offset:51200
v_fma_f32 v212,v212,s26,-v20
v_mfma_f32_16x16x32_bf16 v[224:227],a[100:103],a[4:7],v[224:227]
v_exp_f32 v209,v209
v_mfma_f32_16x16x32_bf16 v[224:227],a[104:107],a[8:11],v[224:227]
v_exp_f32 v210,v210
v_mfma_f32_16x16x32_bf16 v[224:227],a[108:111],a[12:15],v[224:227]
buffer_load_dwordx4 v1,s[8:11],s21 offen offset:3072 nt lds
v_mfma_f32_16x16x32_bf16 v[232:235],a[108:111],a[28:31],0
s_add_u32 s21,s21,16384
ds_read_b128 a[132:135],v3 offset:51200
v_mfma_f32_16x16x32_bf16 v[232:235],a[104:107],a[24:27],v[232:235]
v_exp_f32 v211,v211
v_mfma_f32_16x16x32_bf16 v[232:235],a[100:103],a[20:23],v[232:235]
v_exp_f32 v212,v212
v_mfma_f32_16x16x32_bf16 v[232:235],a[96:99],a[16:19],v[232:235]
v_cvt_pk_bf16_f32 v180,v208,v209
v_cvt_pk_bf16_f32 v181,v210,v211
v_mfma_f32_16x16x32_bf16 v[240:243],a[96:99],a[32:35],0
ds_read_b128 a[136:139],v4 offset:51200
v_fma_f32 v213,v213,s26,-v20
v_mfma_f32_16x16x32_bf16 v[240:243],a[100:103],a[36:39],v[240:243]
v_exp_f32 v213,v213
v_mfma_f32_16x16x32_bf16 v[240:243],a[104:107],a[40:43],v[240:243]
v_cvt_pk_bf16_f32 v182,v212,v213
v_fma_f32 v214,v214,s26,-v20
v_mfma_f32_16x16x32_bf16 v[240:243],a[108:111],a[44:47],v[240:243]
ds_read_b128 a[140:143],v5 offset:51200
v_fma_f32 v215,v215,s26,-v20
v_mfma_f32_16x16x32_bf16 v[248:251],a[108:111],a[60:63],0
v_exp_f32 v214,v214
v_mfma_f32_16x16x32_bf16 v[248:251],a[104:107],a[56:59],v[248:251]
v_exp_f32 v215,v215
v_mfma_f32_16x16x32_bf16 v[248:251],a[100:103],a[52:55],v[248:251]
s_waitcnt lgkmcnt(4)
v_cvt_pk_bf16_f32 v183,v214,v215
v_fma_f32 v216,v216,s26,-v21
v_mfma_f32_16x16x32_bf16 v[248:251],a[96:99],a[48:51],v[248:251]
ds_read_b128 a[144:147],v2 offset:52224
v_exp_f32 v216,v216
v_mfma_f32_16x16x32_bf16 v[228:231],a[112:115],a[0:3],0
v_fma_f32 v217,v217,s26,-v21
v_fma_f32 v218,v218,s26,-v21
v_mfma_f32_16x16x32_bf16 v[228:231],a[116:119],a[4:7],v[228:231]
v_exp_f32 v217,v217
v_mfma_f32_16x16x32_bf16 v[228:231],a[120:123],a[8:11],v[228:231]
v_exp_f32 v218,v218
v_mfma_f32_16x16x32_bf16 v[228:231],a[124:127],a[12:15],v[228:231]
ds_read_b128 a[148:151],v3 offset:52224
v_cvt_pk_bf16_f32 v188,v216,v217
v_mfma_f32_16x16x32_bf16 v[236:239],a[124:127],a[28:31],0
v_fma_f32 v219,v219,s26,-v21
v_fma_f32 v220,v220,s26,-v21
v_mfma_f32_16x16x32_bf16 v[236:239],a[120:123],a[24:27],v[236:239]
v_exp_f32 v219,v219
v_mfma_f32_16x16x32_bf16 v[236:239],a[116:119],a[20:23],v[236:239]
s_add_u32 m0,s25,65536
ds_read_b128 a[152:155],v4 offset:52224
v_mfma_f32_16x16x32_bf16 v[236:239],a[112:115],a[16:19],v[236:239]
buffer_load_dwordx4 v1,s[12:15],s22 offen nt lds
v_mfma_f32_16x16x32_bf16 v[244:247],a[112:115],a[32:35],0
v_exp_f32 v220,v220
v_mfma_f32_16x16x32_bf16 v[244:247],a[116:119],a[36:39],v[244:247]
v_cvt_pk_bf16_f32 v189,v218,v219
v_fma_f32 v221,v221,s26,-v21
v_mfma_f32_16x16x32_bf16 v[244:247],a[120:123],a[40:43],v[244:247]
ds_read_b128 a[156:159],v5 offset:52224
v_fma_f32 v222,v222,s26,-v21
v_mfma_f32_16x16x32_bf16 v[244:247],a[124:127],a[44:47],v[244:247]
v_exp_f32 v221,v221
v_fma_f32 v223,v223,s26,-v21
v_mfma_f32_16x16x32_bf16 v[252:255],a[124:127],a[60:63],0
v_exp_f32 v222,v222
v_mfma_f32_16x16x32_bf16 v[252:255],a[120:123],a[56:59],v[252:255]
v_exp_f32 v223,v223
v_mfma_f32_16x16x32_bf16 v[252:255],a[116:119],a[52:55],v[252:255]
v_cvt_pk_bf16_f32 v190,v220,v221
v_cvt_pk_bf16_f32 v191,v222,v223
v_mfma_f32_16x16x32_bf16 v[252:255],a[112:115],a[48:51],v[252:255]
s_waitcnt lgkmcnt(4)
v_mfma_f32_16x16x32_bf16 v[192:195],a[128:131],a[0:3],0
v_accvgpr_read_b32 v23,a244
v_accvgpr_read_b32 v24,a245
v_mfma_f32_16x16x32_bf16 v[192:195],a[132:135],a[4:7],v[192:195]
v_fma_f32 v224,v224,s26,-v18
v_fma_f32 v225,v225,s26,-v18
v_mfma_f32_16x16x32_bf16 v[192:195],a[136:139],a[8:11],v[192:195]
v_exp_f32 v224,v224
v_mfma_f32_16x16x32_bf16 v[192:195],a[140:143],a[12:15],v[192:195]
buffer_load_dwordx4 v1,s[12:15],s22 offen offset:1024 nt lds
v_exp_f32 v225,v225
v_mfma_f32_16x16x32_bf16 v[200:203],a[140:143],a[28:31],0
ds_write_b128 v23,v[144:147] offset:16384
v_cvt_pk_bf16_f32 v224,v224,v225
v_mfma_f32_16x16x32_bf16 v[200:203],a[136:139],a[24:27],v[200:203]
ds_read_b64_tr_b16 a[96:97],v6 offset:32768
v_fma_f32 v226,v226,s26,-v18
v_mfma_f32_16x16x32_bf16 v[200:203],a[132:135],a[20:23],v[200:203]
ds_read_b64_tr_b16 a[98:99],v6 offset:33792
v_fma_f32 v227,v227,s26,-v18
v_mfma_f32_16x16x32_bf16 v[200:203],a[128:131],a[16:19],v[200:203]
ds_write_b128 v23,v[148:151] offset:16448
v_exp_f32 v226,v226
v_fma_f32 v228,v228,s26,-v18
v_mfma_f32_16x16x32_bf16 v[208:211],a[128:131],a[32:35],0
ds_read_b64_tr_b16 a[100:101],v6 offset:34816
v_fma_f32 v229,v229,s26,-v18
v_mfma_f32_16x16x32_bf16 v[208:211],a[132:135],a[36:39],v[208:211]
ds_read_b64_tr_b16 a[102:103],v6 offset:35840
v_fma_f32 v230,v230,s26,-v18
v_mfma_f32_16x16x32_bf16 v[208:211],a[136:139],a[40:43],v[208:211]
ds_write_b128 v23,v[152:155] offset:16512
v_fma_f32 v231,v231,s26,-v18
v_mfma_f32_16x16x32_bf16 v[208:211],a[140:143],a[44:47],v[208:211]
buffer_load_dwordx4 v1,s[12:15],s22 offen offset:2048 nt lds
v_exp_f32 v227,v227
v_fma_f32 v232,v232,s26,-v19
v_mfma_f32_16x16x32_bf16 v[216:219],a[140:143],a[60:63],0
ds_read_b64_tr_b16 a[104:105],v6 offset:32776
v_cvt_pk_bf16_f32 v225,v226,v227
v_mfma_f32_16x16x32_bf16 v[216:219],a[136:139],a[56:59],v[216:219]
ds_read_b64_tr_b16 a[106:107],v6 offset:33800
v_fma_f32 v233,v233,s26,-v19
v_mfma_f32_16x16x32_bf16 v[216:219],a[132:135],a[52:55],v[216:219]
ds_write_b128 v23,v[156:159] offset:16576
v_fma_f32 v234,v234,s26,-v19
v_mfma_f32_16x16x32_bf16 v[216:219],a[128:131],a[48:51],v[216:219]
s_waitcnt lgkmcnt(10)
ds_read_b128 v[144:147],v24 offset:16384
v_exp_f32 v228,v228
v_mfma_f32_16x16x32_bf16 v[196:199],a[144:147],a[0:3],0
ds_read_b64_tr_b16 a[108:109],v6 offset:34824
v_fma_f32 v235,v235,s26,-v19
v_mfma_f32_16x16x32_bf16 v[196:199],a[148:151],a[4:7],v[196:199]
ds_read_b64_tr_b16 a[110:111],v6 offset:35848
v_fma_f32 v236,v236,s26,-v19
v_mfma_f32_16x16x32_bf16 v[196:199],a[152:155],a[8:11],v[196:199]
ds_read_b128 v[148:151],v24 offset:17472
v_fma_f32 v237,v237,s26,-v19
v_mfma_f32_16x16x32_bf16 v[196:199],a[156:159],a[12:15],v[196:199]
ds_read_b64_tr_b16 a[112:113],v7 offset:32768
v_exp_f32 v229,v229
v_fma_f32 v238,v238,s26,-v19
v_mfma_f32_16x16x32_bf16 v[204:207],a[156:159],a[28:31],0
s_waitcnt lgkmcnt(14)
ds_read_b64_tr_b16 a[114:115],v7 offset:33792
v_cvt_pk_bf16_f32 v226,v228,v229
v_mfma_f32_16x16x32_bf16 v[204:207],a[152:155],a[24:27],v[204:207]
s_waitcnt lgkmcnt(14)
ds_read_b128 v[152:155],v24 offset:18560
v_fma_f32 v239,v239,s26,-v19
v_mfma_f32_16x16x32_bf16 v[204:207],a[148:151],a[20:23],v[204:207]
s_waitcnt lgkmcnt(14)
ds_read_b128 v[156:159],v24 offset:19648
v_fma_f32 v240,v240,s26,-v20
v_mfma_f32_16x16x32_bf16 v[204:207],a[144:147],a[16:19],v[204:207]
s_waitcnt lgkmcnt(14)
ds_read_b64_tr_b16 a[116:117],v7 offset:34816
v_exp_f32 v230,v230
v_fma_f32 v241,v241,s26,-v20
v_mfma_f32_16x16x32_bf16 v[212:215],a[144:147],a[32:35],0
s_waitcnt lgkmcnt(14)
ds_read_b64_tr_b16 a[118:119],v7 offset:35840
v_fma_f32 v242,v242,s26,-v20
v_mfma_f32_16x16x32_bf16 v[212:215],a[148:151],a[36:39],v[212:215]
v_exp_f32 v231,v231
v_mfma_f32_16x16x32_bf16 v[212:215],a[152:155],a[40:43],v[212:215]
v_exp_f32 v232,v232
v_mfma_f32_16x16x32_bf16 v[212:215],a[156:159],a[44:47],v[212:215]
s_waitcnt lgkmcnt(14)
ds_read_b64_tr_b16 a[120:121],v7 offset:32776
v_exp_f32 v233,v233
v_exp_f32 v234,v234
v_mfma_f32_16x16x32_bf16 v[220:223],a[156:159],a[60:63],0
s_waitcnt lgkmcnt(14)
ds_read_b64_tr_b16 a[122:123],v7 offset:33800
v_cvt_pk_bf16_f32 v227,v230,v231
v_mfma_f32_16x16x32_bf16 v[220:223],a[152:155],a[56:59],v[220:223]
v_exp_f32 v235,v235
v_mfma_f32_16x16x32_bf16 v[220:223],a[148:151],a[52:55],v[220:223]
s_waitcnt lgkmcnt(14)
ds_read_b64_tr_b16 a[124:125],v7 offset:34824
v_cvt_pk_bf16_f32 v232,v232,v233
v_mfma_f32_16x16x32_bf16 v[220:223],a[144:147],a[48:51],v[220:223]
s_waitcnt lgkmcnt(14)
ds_read_b64_tr_b16 a[126:127],v7 offset:35848
v_cvt_pk_bf16_f32 v233,v234,v235
v_exp_f32 v236,v236
v_mfma_f32_16x16x32_bf16 a[224:227],a[240:243],v[160:163],a[224:227]
v_exp_f32 v237,v237
v_mfma_f32_16x16x32_bf16 a[224:227],a[240:243],v[164:167],a[224:227]
buffer_load_dwordx4 v1,s[12:15],s22 offen offset:3072 nt lds
v_exp_f32 v238,v238
v_mfma_f32_16x16x32_bf16 a[228:231],a[240:243],v[168:171],a[228:231]
s_add_u32 s22,s22,16384
s_waitcnt lgkmcnt(14)
ds_read_b64_tr_b16 a[128:129],v8 offset:32768
v_mfma_f32_16x16x32_bf16 a[228:231],a[240:243],v[172:175],a[228:231]
s_waitcnt lgkmcnt(14)
ds_read_b64_tr_b16 a[130:131],v8 offset:33792
v_cvt_pk_bf16_f32 v234,v236,v237
v_exp_f32 v239,v239
v_mfma_f32_16x16x32_bf16 a[232:235],a[240:243],v[176:179],a[232:235]
s_waitcnt lgkmcnt(14)
ds_read_b128 a[32:35],v10 offset:16384
v_accvgpr_mov_b32 a0,a64
v_mfma_f32_16x16x32_bf16 a[232:235],a[240:243],v[180:183],a[232:235]
v_cvt_pk_bf16_f32 v235,v238,v239
v_exp_f32 v240,v240
v_exp_f32 v241,v241
v_mfma_f32_16x16x32_bf16 a[236:239],a[240:243],v[184:187],a[236:239]
s_waitcnt lgkmcnt(14)
ds_read_b64_tr_b16 a[132:133],v8 offset:34816
v_accvgpr_mov_b32 a1,a65
v_mfma_f32_16x16x32_bf16 a[236:239],a[240:243],v[188:191],a[236:239]
s_waitcnt lgkmcnt(14)
ds_read_b64_tr_b16 a[134:135],v8 offset:35840
v_accvgpr_mov_b32 a2,a66
v_exp_f32 v242,v242
v_mfma_f32_16x16x32_bf16 v[80:83],a[96:99],v[184:187],v[80:83]
s_waitcnt lgkmcnt(14)
ds_read_b128 a[36:39],v11 offset:16384
v_cvt_pk_bf16_f32 v240,v240,v241
v_mfma_f32_16x16x32_bf16 v[80:83],a[100:103],v[188:191],v[80:83]
s_waitcnt lgkmcnt(14)
ds_read_b64_tr_b16 a[136:137],v8 offset:32776
v_accvgpr_mov_b32 a3,a67
v_fma_f32 v243,v243,s26,-v20
v_accvgpr_mov_b32 a4,a68
v_mfma_f32_16x16x32_bf16 v[64:67],a[100:103],v[180:183],v[64:67]
s_add_u32 s30,s24,49152
s_add_u32 s32,s24,53248
s_waitcnt lgkmcnt(14)
ds_read_b64_tr_b16 a[138:139],v8 offset:33800
v_mfma_f32_16x16x32_bf16 v[64:67],a[96:99],v[176:179],v[64:67]
buffer_store_dwordx4 v[144:147],v22,s[16:19],s30 offen sc0 sc1
buffer_store_dwordx4 v[148:151],v22,s[16:19],s32 offen sc0 sc1
v_exp_f32 v243,v243
v_mfma_f32_16x16x32_bf16 v[48:51],a[96:99],v[168:171],v[48:51]
s_waitcnt lgkmcnt(14)
ds_read_b128 a[40:43],v12 offset:16384
v_cvt_pk_bf16_f32 v241,v242,v243
v_mfma_f32_16x16x32_bf16 v[48:51],a[100:103],v[172:175],v[48:51]
s_waitcnt lgkmcnt(14)
ds_read_b64_tr_b16 a[140:141],v8 offset:34824
v_accvgpr_mov_b32 a5,a69
v_fma_f32 v244,v244,s26,-v20
v_fma_f32 v245,v245,s26,-v20
v_mfma_f32_16x16x32_bf16 v[32:35],a[100:103],v[164:167],v[32:35]
s_waitcnt lgkmcnt(14)
ds_read_b64_tr_b16 a[142:143],v8 offset:35848
v_accvgpr_mov_b32 a6,a70
v_mfma_f32_16x16x32_bf16 v[32:35],a[96:99],v[160:163],v[32:35]
v_exp_f32 v244,v244
v_exp_f32 v245,v245
v_accvgpr_mov_b32 a7,a71
v_mfma_f32_16x16x32_bf16 v[36:39],a[104:107],v[160:163],v[36:39]
s_waitcnt lgkmcnt(14)
ds_read_b128 a[44:47],v13 offset:16384
v_cvt_pk_bf16_f32 v242,v244,v245
v_mfma_f32_16x16x32_bf16 v[36:39],a[108:111],v[164:167],v[36:39]
s_waitcnt lgkmcnt(14)
ds_read_b64_tr_b16 a[144:145],v9 offset:32768
v_fma_f32 v246,v246,s26,-v20
v_fma_f32 v247,v247,s26,-v20
v_accvgpr_mov_b32 a8,a72
v_mfma_f32_16x16x32_bf16 v[52:55],a[108:111],v[172:175],v[52:55]
s_waitcnt lgkmcnt(14)
ds_read_b64_tr_b16 a[146:147],v9 offset:33792
v_accvgpr_mov_b32 a9,a73
v_mfma_f32_16x16x32_bf16 v[52:55],a[104:107],v[168:171],v[52:55]
v_exp_f32 v246,v246
v_exp_f32 v247,v247
v_mfma_f32_16x16x32_bf16 v[68:71],a[104:107],v[176:179],v[68:71]
s_waitcnt lgkmcnt(14)
ds_read_b64_tr_b16 a[148:149],v9 offset:34816
v_cvt_pk_bf16_f32 v243,v246,v247
v_mfma_f32_16x16x32_bf16 v[68:71],a[108:111],v[180:183],v[68:71]
s_waitcnt lgkmcnt(14)
ds_read_b64_tr_b16 a[150:151],v9 offset:35840
v_fma_f32 v248,v248,s26,-v21
v_fma_f32 v249,v249,s26,-v21
v_accvgpr_mov_b32 a10,a74
v_mfma_f32_16x16x32_bf16 v[84:87],a[108:111],v[188:191],v[84:87]
v_exp_f32 v248,v248
v_mfma_f32_16x16x32_bf16 v[84:87],a[104:107],v[184:187],v[84:87]
v_exp_f32 v249,v249
v_accvgpr_mov_b32 a11,a75
v_fma_f32 v250,v250,s26,-v21
v_fma_f32 v251,v251,s26,-v21
v_mfma_f32_16x16x32_bf16 v[88:91],a[112:115],v[184:187],v[88:91]
s_waitcnt lgkmcnt(14)
ds_read_b64_tr_b16 a[152:153],v9 offset:32776
v_cvt_pk_bf16_f32 v248,v248,v249
v_mfma_f32_16x16x32_bf16 v[88:91],a[116:119],v[188:191],v[88:91]
s_waitcnt lgkmcnt(14)
ds_read_b64_tr_b16 a[154:155],v9 offset:33800
v_accvgpr_mov_b32 a12,a76
v_exp_f32 v250,v250
v_mfma_f32_16x16x32_bf16 v[72:75],a[116:119],v[180:183],v[72:75]
v_exp_f32 v251,v251
v_mfma_f32_16x16x32_bf16 v[72:75],a[112:115],v[176:179],v[72:75]
s_waitcnt lgkmcnt(14)
ds_read_b64_tr_b16 a[156:157],v9 offset:34824
v_accvgpr_mov_b32 a13,a77
v_cvt_pk_bf16_f32 v249,v250,v251
v_fma_f32 v252,v252,s26,-v21
v_mfma_f32_16x16x32_bf16 v[56:59],a[112:115],v[168:171],v[56:59]
s_add_u32 s30,s24,57344
s_add_u32 s32,s24,61440
s_waitcnt lgkmcnt(14)
ds_read_b64_tr_b16 a[158:159],v9 offset:35848
v_mfma_f32_16x16x32_bf16 v[56:59],a[116:119],v[172:175],v[56:59]
buffer_store_dwordx4 v[152:155],v22,s[16:19],s30 offen sc0 sc1
buffer_store_dwordx4 v[156:159],v22,s[16:19],s32 offen sc0 sc1
v_exp_f32 v252,v252
v_mfma_f32_16x16x32_bf16 v[40:43],a[116:119],v[164:167],v[40:43]
v_fma_f32 v253,v253,s26,-v21
v_accvgpr_mov_b32 a14,a78
v_mfma_f32_16x16x32_bf16 v[40:43],a[112:115],v[160:163],v[40:43]
v_exp_f32 v253,v253
v_accvgpr_mov_b32 a15,a79
v_fma_f32 v254,v254,s26,-v21
v_fma_f32 v255,v255,s26,-v21
v_mfma_f32_16x16x32_bf16 v[44:47],a[120:123],v[160:163],v[44:47]
v_exp_f32 v254,v254
v_mfma_f32_16x16x32_bf16 v[44:47],a[124:127],v[164:167],v[44:47]
v_exp_f32 v255,v255
v_cvt_pk_bf16_f32 v250,v252,v253
v_mfma_f32_16x16x32_bf16 v[60:63],a[124:127],v[172:175],v[60:63]
v_cvt_pk_bf16_f32 v251,v254,v255
v_mfma_f32_16x16x32_bf16 v[60:63],a[120:123],v[168:171],v[60:63]
v_mfma_f32_16x16x32_bf16 v[76:79],a[120:123],v[176:179],v[76:79]
v_accvgpr_mov_b32 a16,a80
v_fma_f32 v192,v192,s26,-v18
v_mfma_f32_16x16x32_bf16 v[76:79],a[124:127],v[180:183],v[76:79]
v_fma_f32 v193,v193,s26,-v18
v_exp_f32 v192,v192
v_mfma_f32_16x16x32_bf16 v[92:95],a[124:127],v[188:191],v[92:95]
v_exp_f32 v193,v193
v_mfma_f32_16x16x32_bf16 v[92:95],a[120:123],v[184:187],v[92:95]
v_accvgpr_mov_b32 a17,a81
v_accvgpr_mov_b32 a18,a82
v_cvt_pk_bf16_f32 v228,v192,v193
v_mfma_f32_16x16x32_bf16 a[208:211],a[128:131],v[184:187],a[208:211]
v_accvgpr_mov_b32 a19,a83
v_fma_f32 v194,v194,s26,-v18
v_mfma_f32_16x16x32_bf16 a[208:211],a[132:135],v[188:191],a[208:211]
v_fma_f32 v195,v195,s26,-v18
v_exp_f32 v194,v194
v_mfma_f32_16x16x32_bf16 a[192:195],a[132:135],v[180:183],a[192:195]
v_exp_f32 v195,v195
v_mfma_f32_16x16x32_bf16 a[192:195],a[128:131],v[176:179],a[192:195]
s_waitcnt vmcnt(12)
s_waitcnt lgkmcnt(0)
s_barrier
s_sub_u32 s20,s20,1
s_cmp_eq_u32 s20,1
s_cbranch_scc1 L_x0_0
ds_read_b128 a[96:99],v2 offset:0
v_accvgpr_mov_b32 a20,a84
v_accvgpr_mov_b32 a21,a85
v_mfma_f32_16x16x32_bf16 a[176:179],a[128:131],v[168:171],a[176:179]
v_cvt_pk_bf16_f32 v229,v194,v195
v_fma_f32 v196,v196,s26,-v18
v_mfma_f32_16x16x32_bf16 a[176:179],a[132:135],v[172:175],a[176:179]
ds_read_b128 a[48:51],v10 offset:0
v_exp_f32 v196,v196
v_mfma_f32_16x16x32_bf16 a[160:163],a[132:135],v[164:167],a[160:163]
v_fma_f32 v197,v197,s26,-v18
v_accvgpr_mov_b32 a22,a86
v_mfma_f32_16x16x32_bf16 a[160:163],a[128:131],v[160:163],a[160:163]
ds_read_b128 a[100:103],v3 offset:0
v_exp_f32 v197,v197
v_mfma_f32_16x16x32_bf16 a[164:167],a[136:139],v[160:163],a[164:167]
v_accvgpr_mov_b32 a23,a87
v_cvt_pk_bf16_f32 v230,v196,v197
v_mfma_f32_16x16x32_bf16 a[164:167],a[140:143],v[164:167],a[164:167]
ds_read_b128 a[52:55],v11 offset:0
v_fma_f32 v198,v198,s26,-v18
v_fma_f32 v199,v199,s26,-v18
v_accvgpr_mov_b32 a24,a88
v_mfma_f32_16x16x32_bf16 a[180:183],a[140:143],v[172:175],a[180:183]
s_add_u32 m0,s25,32768
ds_read_b128 a[104:107],v4 offset:0
v_mfma_f32_16x16x32_bf16 a[180:183],a[136:139],v[168:171],a[180:183]
buffer_load_dwordx4 v1,s[8:11],s21 offen nt lds
v_accvgpr_mov_b32 a25,a89
v_mfma_f32_16x16x32_bf16 a[196:199],a[136:139],v[176:179],a[196:199]
v_exp_f32 v198,v198
v_mfma_f32_16x16x32_bf16 a[196:199],a[140:143],v[180:183],a[196:199]
ds_read_b128 a[56:59],v12 offset:0
v_exp_f32 v199,v199
v_mfma_f32_16x16x32_bf16 a[212:215],a[140:143],v[188:191],a[212:215]
ds_read_b128 a[108:111],v5 offset:0
v_cvt_pk_bf16_f32 v231,v198,v199
v_mfma_f32_16x16x32_bf16 a[212:215],a[136:139],v[184:187],a[212:215]
v_fma_f32 v200,v200,s26,-v19
v_fma_f32 v201,v201,s26,-v19
v_accvgpr_mov_b32 a26,a90
v_mfma_f32_16x16x32_bf16 a[216:219],a[144:147],v[184:187],a[216:219]
v_exp_f32 v200,v200
v_mfma_f32_16x16x32_bf16 a[216:219],a[148:151],v[188:191],a[216:219]
ds_read_b128 a[60:63],v13 offset:0
v_exp_f32 v201,v201
v_mfma_f32_16x16x32_bf16 a[200:203],a[148:151],v[180:183],a[200:203]
ds_read_b128 a[112:115],v2 offset:1024
v_accvgpr_mov_b32 a27,a91
v_mfma_f32_16x16x32_bf16 a[200:203],a[144:147],v[176:179],a[200:203]
buffer_load_dwordx4 v1,s[8:11],s21 offen offset:1024 nt lds
v_cvt_pk_bf16_f32 v236,v200,v201
v_mfma_f32_16x16x32_bf16 a[184:187],a[144:147],v[168:171],a[184:187]
v_fma_f32 v202,v202,s26,-v19
v_fma_f32 v203,v203,s26,-v19
v_mfma_f32_16x16x32_bf16 a[184:187],a[148:151],v[172:175],a[184:187]
ds_read_b128 a[116:119],v3 offset:1024
v_exp_f32 v202,v202
v_mfma_f32_16x16x32_bf16 a[168:171],a[148:151],v[164:167],a[168:171]
v_exp_f32 v203,v203
v_mfma_f32_16x16x32_bf16 a[168:171],a[144:147],v[160:163],a[168:171]
v_accvgpr_mov_b32 a28,a92
v_accvgpr_mov_b32 a29,a93
v_cvt_pk_bf16_f32 v237,v202,v203
v_mfma_f32_16x16x32_bf16 a[172:175],a[152:155],v[160:163],a[172:175]
v_fma_f32 v204,v204,s26,-v19
v_fma_f32 v205,v205,s26,-v19
v_mfma_f32_16x16x32_bf16 a[172:175],a[156:159],v[164:167],a[172:175]
ds_read_b128 a[120:123],v4 offset:1024
v_exp_f32 v204,v204
v_mfma_f32_16x16x32_bf16 a[188:191],a[156:159],v[172:175],a[188:191]
v_exp_f32 v205,v205
v_mfma_f32_16x16x32_bf16 a[188:191],a[152:155],v[168:171],a[188:191]
buffer_load_dwordx4 v1,s[8:11],s21 offen offset:2048 nt lds
v_accvgpr_mov_b32 a30,a94
v_mfma_f32_16x16x32_bf16 a[204:207],a[152:155],v[176:179],a[204:207]
v_accvgpr_mov_b32 a31,a95
v_cvt_pk_bf16_f32 v238,v204,v205
v_mfma_f32_16x16x32_bf16 a[204:207],a[156:159],v[180:183],a[204:207]
ds_read_b128 a[124:127],v5 offset:1024
v_fma_f32 v206,v206,s26,-v19
v_fma_f32 v207,v207,s26,-v19
v_mfma_f32_16x16x32_bf16 a[220:223],a[156:159],v[188:191],a[220:223]
v_exp_f32 v206,v206
v_mfma_f32_16x16x32_bf16 a[220:223],a[152:155],v[184:187],a[220:223]
s_waitcnt lgkmcnt(5)
v_exp_f32 v207,v207
v_fma_f32 v208,v208,s26,-v20
v_mfma_f32_16x16x32_bf16 v[160:163],a[96:99],a[0:3],0
ds_read_b128 a[128:131],v2 offset:2048
v_cvt_pk_bf16_f32 v239,v206,v207
v_mfma_f32_16x16x32_bf16 v[160:163],a[100:103],a[4:7],v[160:163]
v_exp_f32 v208,v208
v_mfma_f32_16x16x32_bf16 v[160:163],a[104:107],a[8:11],v[160:163]
v_fma_f32 v209,v209,s26,-v20
v_fma_f32 v210,v210,s26,-v20
v_mfma_f32_16x16x32_bf16 v[160:163],a[108:111],a[12:15],v[160:163]
buffer_load_dwordx4 v1,s[8:11],s21 offen offset:3072 nt lds
v_fma_f32 v211,v211,s26,-v20
v_mfma_f32_16x16x32_bf16 v[168:171],a[108:111],a[28:31],0
s_add_u32 s21,s21,16384
ds_read_b128 a[132:135],v3 offset:2048
v_mfma_f32_16x16x32_bf16 v[168:171],a[104:107],a[24:27],v[168:171]
v_exp_f32 v209,v209
v_mfma_f32_16x16x32_bf16 v[168:171],a[100:103],a[20:23],v[168:171]
v_exp_f32 v210,v210
v_mfma_f32_16x16x32_bf16 v[168:171],a[96:99],a[16:19],v[168:171]
v_exp_f32 v211,v211
v_cvt_pk_bf16_f32 v244,v208,v209
v_fma_f32 v212,v212,s26,-v20
v_mfma_f32_16x16x32_bf16 v[176:179],a[96:99],a[32:35],0
ds_read_b128 a[136:139],v4 offset:2048
v_cvt_pk_bf16_f32 v245,v210,v211
v_mfma_f32_16x16x32_bf16 v[176:179],a[100:103],a[36:39],v[176:179]
v_exp_f32 v212,v212
v_mfma_f32_16x16x32_bf16 v[176:179],a[104:107],a[40:43],v[176:179]
v_fma_f32 v213,v213,s26,-v20
v_fma_f32 v214,v214,s26,-v20
v_mfma_f32_16x16x32_bf16 v[176:179],a[108:111],a[44:47],v[176:179]
ds_read_b128 a[140:143],v5 offset:2048
v_exp_f32 v213,v213
s_waitcnt lgkmcnt(8)
v_mfma_f32_16x16x32_bf16 v[184:187],a[108:111],a[60:63],0
v_exp_f32 v214,v214
v_mfma_f32_16x16x32_bf16 v[184:187],a[104:107],a[56:59],v[184:187]
v_cvt_pk_bf16_f32 v246,v212,v213
v_fma_f32 v215,v215,s26,-v20
v_mfma_f32_16x16x32_bf16 v[184:187],a[100:103],a[52:55],v[184:187]
s_waitcnt lgkmcnt(4)
v_exp_f32 v215,v215
v_mfma_f32_16x16x32_bf16 v[184:187],a[96:99],a[48:51],v[184:187]
ds_read_b128 a[144:147],v2 offset:3072
v_cvt_pk_bf16_f32 v247,v214,v215
v_fma_f32 v216,v216,s26,-v21
v_mfma_f32_16x16x32_bf16 v[164:167],a[112:115],a[0:3],0
v_exp_f32 v216,v216
v_mfma_f32_16x16x32_bf16 v[164:167],a[116:119],a[4:7],v[164:167]
v_fma_f32 v217,v217,s26,-v21
v_fma_f32 v218,v218,s26,-v21
v_mfma_f32_16x16x32_bf16 v[164:167],a[120:123],a[8:11],v[164:167]
v_exp_f32 v217,v217
v_mfma_f32_16x16x32_bf16 v[164:167],a[124:127],a[12:15],v[164:167]
ds_read_b128 a[148:151],v3 offset:3072
v_exp_f32 v218,v218
v_mfma_f32_16x16x32_bf16 v[172:175],a[124:127],a[28:31],0
v_cvt_pk_bf16_f32 v252,v216,v217
v_fma_f32 v219,v219,s26,-v21
v_mfma_f32_16x16x32_bf16 v[172:175],a[120:123],a[24:27],v[172:175]
v_exp_f32 v219,v219
v_mfma_f32_16x16x32_bf16 v[172:175],a[116:119],a[20:23],v[172:175]
s_add_u32 m0,s25,81920
ds_read_b128 a[152:155],v4 offset:3072
v_mfma_f32_16x16x32_bf16 v[172:175],a[112:115],a[16:19],v[172:175]
buffer_load_dwordx4 v1,s[12:15],s22 offen nt lds
v_cvt_pk_bf16_f32 v253,v218,v219
v_mfma_f32_16x16x32_bf16 v[180:183],a[112:115],a[32:35],0
v_fma_f32 v220,v220,s26,-v21
v_fma_f32 v221,v221,s26,-v21
v_mfma_f32_16x16x32_bf16 v[180:183],a[116:119],a[36:39],v[180:183]
v_exp_f32 v220,v220
v_mfma_f32_16x16x32_bf16 v[180:183],a[120:123],a[40:43],v[180:183]
ds_read_b128 a[156:159],v5 offset:3072
v_fma_f32 v222,v222,s26,-v21
v_mfma_f32_16x16x32_bf16 v[180:183],a[124:127],a[44:47],v[180:183]
v_exp_f32 v221,v221
v_fma_f32 v223,v223,s26,-v21
v_mfma_f32_16x16x32_bf16 v[188:191],a[124:127],a[60:63],0
v_exp_f32 v222,v222
v_mfma_f32_16x16x32_bf16 v[188:191],a[120:123],a[56:59],v[188:191]
v_exp_f32 v223,v223
v_mfma_f32_16x16x32_bf16 v[188:191],a[116:119],a[52:55],v[188:191]
v_cvt_pk_bf16_f32 v254,v220,v221
v_cvt_pk_bf16_f32 v255,v222,v223
v_mfma_f32_16x16x32_bf16 v[188:191],a[112:115],a[48:51],v[188:191]
s_waitcnt lgkmcnt(4)
v_mfma_f32_16x16x32_bf16 v[192:195],a[128:131],a[0:3],0
v_mfma_f32_16x16x32_bf16 v[192:195],a[132:135],a[4:7],v[192:195]
v_mfma_f32_16x16x32_bf16 v[192:195],a[136:139],a[8:11],v[192:195]
v_mfma_f32_16x16x32_bf16 v[192:195],a[140:143],a[12:15],v[192:195]
buffer_load_dwordx4 v1,s[12:15],s22 offen offset:1024 nt lds
v_max3_f32 v23,v160,v161,v162
v_max3_f32 v24,v168,v169,v170
v_max3_f32 v25,v176,v177,v178
v_max3_f32 v26,v184,v185,v186
v_mfma_f32_16x16x32_bf16 v[200:203],a[140:143],a[28:31],0
v_max3_f32 v23,v23,v163,v164
v_max3_f32 v24,v24,v171,v172
v_mfma_f32_16x16x32_bf16 v[200:203],a[136:139],a[24:27],v[200:203]
ds_read_b64_tr_b16 a[96:97],v6 offset:49152
v_max3_f32 v25,v25,v179,v180
v_mfma_f32_16x16x32_bf16 v[200:203],a[132:135],a[20:23],v[200:203]
ds_read_b64_tr_b16 a[98:99],v6 offset:50176
v_max3_f32 v26,v26,v187,v188
v_mfma_f32_16x16x32_bf16 v[200:203],a[128:131],a[16:19],v[200:203]
v_max3_f32 v23,v23,v165,v166
v_max3_f32 v24,v24,v173,v174
v_max3_f32 v25,v25,v181,v182
v_max3_f32 v26,v26,v189,v190
v_mfma_f32_16x16x32_bf16 v[208:211],a[128:131],a[32:35],0
ds_read_b64_tr_b16 a[100:101],v6 offset:51200
v_max_f32 v23,v23,v167
v_mfma_f32_16x16x32_bf16 v[208:211],a[132:135],a[36:39],v[208:211]
ds_read_b64_tr_b16 a[102:103],v6 offset:52224
v_max_f32 v24,v24,v175
v_mfma_f32_16x16x32_bf16 v[208:211],a[136:139],a[40:43],v[208:211]
v_max_f32 v25,v25,v183
v_max_f32 v26,v26,v191
v_mfma_f32_16x16x32_bf16 v[208:211],a[140:143],a[44:47],v[208:211]
buffer_load_dwordx4 v1,s[12:15],s22 offen offset:2048 nt lds
v_mov_b32 v27,v23
v_mov_b32 v28,v24
v_mov_b32 v29,v25
v_mov_b32 v30,v26
v_mfma_f32_16x16x32_bf16 v[216:219],a[140:143],a[60:63],0
ds_read_b64_tr_b16 a[104:105],v6 offset:49160
v_permlane16_swap_b32 v23,v27
v_mfma_f32_16x16x32_bf16 v[216:219],a[136:139],a[56:59],v[216:219]
ds_read_b64_tr_b16 a[106:107],v6 offset:50184
v_permlane16_swap_b32 v24,v28
v_mfma_f32_16x16x32_bf16 v[216:219],a[132:135],a[52:55],v[216:219]
v_permlane16_swap_b32 v25,v29
v_permlane16_swap_b32 v26,v30
v_mfma_f32_16x16x32_bf16 v[216:219],a[128:131],a[48:51],v[216:219]
s_waitcnt lgkmcnt(6)
v_max_f32 v23,v23,v27
v_max_f32 v24,v24,v28
v_max_f32 v25,v25,v29
v_max_f32 v26,v26,v30
v_mfma_f32_16x16x32_bf16 v[196:199],a[144:147],a[0:3],0
ds_read_b64_tr_b16 a[108:109],v6 offset:51208
v_mov_b32 v27,v23
v_mfma_f32_16x16x32_bf16 v[196:199],a[148:151],a[4:7],v[196:199]
ds_read_b64_tr_b16 a[110:111],v6 offset:52232
v_mov_b32 v28,v24
v_mfma_f32_16x16x32_bf16 v[196:199],a[152:155],a[8:11],v[196:199]
v_mov_b32 v29,v25
v_mov_b32 v30,v26
v_mfma_f32_16x16x32_bf16 v[196:199],a[156:159],a[12:15],v[196:199]
ds_read_b64_tr_b16 a[112:113],v7 offset:49152
v_permlane32_swap_b32 v23,v27
v_permlane32_swap_b32 v24,v28
v_permlane32_swap_b32 v25,v29
v_permlane32_swap_b32 v26,v30
v_mfma_f32_16x16x32_bf16 v[204:207],a[156:159],a[28:31],0
ds_read_b64_tr_b16 a[114:115],v7 offset:50176
v_max_f32 v23,v23,v27
v_mfma_f32_16x16x32_bf16 v[204:207],a[152:155],a[24:27],v[204:207]
v_max_f32 v24,v24,v28
v_max_f32 v25,v25,v29
v_mfma_f32_16x16x32_bf16 v[204:207],a[148:151],a[20:23],v[204:207]
v_max_f32 v26,v26,v30
v_mul_f32 v18,s26,v23
v_mfma_f32_16x16x32_bf16 v[204:207],a[144:147],a[16:19],v[204:207]
ds_read_b64_tr_b16 a[116:117],v7 offset:51200
v_mul_f32 v19,s26,v24
v_mul_f32 v20,s26,v25
v_mul_f32 v21,s26,v26
v_mfma_f32_16x16x32_bf16 v[212:215],a[144:147],a[32:35],0
ds_read_b64_tr_b16 a[118:119],v7 offset:52224
v_fma_f32 v160,v160,s26,-v18
v_mfma_f32_16x16x32_bf16 v[212:215],a[148:151],a[36:39],v[212:215]
v_exp_f32 v160,v160
v_mfma_f32_16x16x32_bf16 v[212:215],a[152:155],a[40:43],v[212:215]
v_fma_f32 v161,v161,s26,-v18
v_fma_f32 v162,v162,s26,-v18
v_mfma_f32_16x16x32_bf16 v[212:215],a[156:159],a[44:47],v[212:215]
ds_read_b64_tr_b16 a[120:121],v7 offset:49160
v_exp_f32 v161,v161
v_fma_f32 v163,v163,s26,-v18
v_exp_f32 v162,v162
v_mfma_f32_16x16x32_bf16 v[220:223],a[156:159],a[60:63],0
ds_read_b64_tr_b16 a[122:123],v7 offset:50184
v_cvt_pk_bf16_f32 v160,v160,v161
v_mfma_f32_16x16x32_bf16 v[220:223],a[152:155],a[56:59],v[220:223]
v_exp_f32 v163,v163
v_mfma_f32_16x16x32_bf16 v[220:223],a[148:151],a[52:55],v[220:223]
ds_read_b64_tr_b16 a[124:125],v7 offset:51208
v_fma_f32 v164,v164,s26,-v18
v_mfma_f32_16x16x32_bf16 v[220:223],a[144:147],a[48:51],v[220:223]
s_waitcnt lgkmcnt(14)
ds_read_b64_tr_b16 a[126:127],v7 offset:52232
v_fma_f32 v165,v165,s26,-v18
v_exp_f32 v164,v164
v_cvt_pk_bf16_f32 v161,v162,v163
v_fma_f32 v166,v166,s26,-v18
v_mfma_f32_16x16x32_bf16 a[224:227],a[240:243],v[224:227],a[224:227]
v_exp_f32 v165,v165
v_mfma_f32_16x16x32_bf16 a[224:227],a[240:243],v[228:231],a[224:227]
buffer_load_dwordx4 v1,s[12:15],s22 offen offset:3072 nt lds
v_exp_f32 v166,v166
v_fma_f32 v167,v167,s26,-v18
v_cvt_pk_bf16_f32 v162,v164,v165
v_mfma_f32_16x16x32_bf16 a[228:231],a[240:243],v[232:235],a[228:231]
s_add_u32 s22,s22,16384
s_waitcnt lgkmcnt(14)
ds_read_b64_tr_b16 a[128:129],v8 offset:49152
v_mfma_f32_16x16x32_bf16 a[228:231],a[240:243],v[236:239],a[228:231]
s_waitcnt lgkmcnt(14)
ds_read_b64_tr_b16 a[130:131],v8 offset:50176
v_exp_f32 v167,v167
v_fma_f32 v168,v168,s26,-v19
v_fma_f32 v169,v169,s26,-v19
v_fma_f32 v170,v170,s26,-v19
v_mfma_f32_16x16x32_bf16 a[232:235],a[240:243],v[240:243],a[232:235]
v_exp_f32 v168,v168
v_mfma_f32_16x16x32_bf16 a[232:235],a[240:243],v[244:247],a[232:235]
s_waitcnt lgkmcnt(14)
v_exp_f32 v169,v169
v_exp_f32 v170,v170
v_cvt_pk_bf16_f32 v163,v166,v167
v_fma_f32 v171,v171,s26,-v19
v_mfma_f32_16x16x32_bf16 a[236:239],a[240:243],v[248:251],a[236:239]
ds_read_b64_tr_b16 a[132:133],v8 offset:51200
v_cvt_pk_bf16_f32 v168,v168,v169
v_mfma_f32_16x16x32_bf16 a[236:239],a[240:243],v[252:255],a[236:239]
s_waitcnt lgkmcnt(14)
ds_read_b64_tr_b16 a[134:135],v8 offset:52224
v_exp_f32 v171,v171
v_fma_f32 v172,v172,s26,-v19
v_fma_f32 v173,v173,s26,-v19
v_fma_f32 v174,v174,s26,-v19
v_mfma_f32_16x16x32_bf16 v[80:83],a[96:99],v[248:251],v[80:83]
v_exp_f32 v172,v172
v_mfma_f32_16x16x32_bf16 v[80:83],a[100:103],v[252:255],v[80:83]
s_waitcnt lgkmcnt(14)
ds_read_b64_tr_b16 a[136:137],v8 offset:49160
v_exp_f32 v173,v173
v_exp_f32 v174,v174
v_mfma_f32_16x16x32_bf16 v[64:67],a[100:103],v[244:247],v[64:67]
s_add_u32 m0,s25,147456
s_waitcnt lgkmcnt(14)
ds_read_b64_tr_b16 a[138:139],v8 offset:50184
v_mfma_f32_16x16x32_bf16 v[64:67],a[96:99],v[240:243],v[64:67]
buffer_load_dwordx4 v1,s[4:7],s23 offen nt lds
v_cvt_pk_bf16_f32 v169,v170,v171
v_accvgpr_read_b32 v14,a224
v_fma_f32 v175,v175,s26,-v19
v_cvt_pk_bf16_f32 v170,v172,v173
v_mfma_f32_16x16x32_bf16 v[48:51],a[96:99],v[232:235],v[48:51]
v_exp_f32 v175,v175
v_mfma_f32_16x16x32_bf16 v[48:51],a[100:103],v[236:239],v[48:51]
s_waitcnt lgkmcnt(14)
ds_read_b64_tr_b16 a[140:141],v8 offset:51208
v_accvgpr_read_b32 v15,a228
v_fma_f32 v176,v176,s26,-v20
v_fma_f32 v177,v177,s26,-v20
v_cvt_pk_bf16_f32 v171,v174,v175
v_fma_f32 v178,v178,s26,-v20
v_mfma_f32_16x16x32_bf16 v[32:35],a[100:103],v[228:231],v[32:35]
s_waitcnt lgkmcnt(14)
ds_read_b64_tr_b16 a[142:143],v8 offset:52232
v_accvgpr_read_b32 v16,a232
v_mfma_f32_16x16x32_bf16 v[32:35],a[96:99],v[224:227],v[32:35]
v_exp_f32 v176,v176
v_exp_f32 v177,v177
v_exp_f32 v178,v178
v_mfma_f32_16x16x32_bf16 v[36:39],a[104:107],v[224:227],v[36:39]
v_accvgpr_read_b32 v17,a236
v_fma_f32 v179,v179,s26,-v20
v_mfma_f32_16x16x32_bf16 v[36:39],a[108:111],v[228:231],v[36:39]
s_waitcnt lgkmcnt(14)
ds_read_b64_tr_b16 a[144:145],v9 offset:49152
v_add_f32 v31,v14,v15
v_exp_f32 v179,v179
v_cvt_pk_bf16_f32 v176,v176,v177
v_fma_f32 v180,v180,s26,-v20
v_mfma_f32_16x16x32_bf16 v[52:55],a[108:111],v[236:239],v[52:55]
s_waitcnt lgkmcnt(14)
ds_read_b64_tr_b16 a[146:147],v9 offset:50176
v_add_f32 v31,v31,v16
v_mfma_f32_16x16x32_bf16 v[52:55],a[104:107],v[232:235],v[52:55]
buffer_load_dwordx4 v1,s[4:7],s23 offen offset:1024 nt lds
v_exp_f32 v180,v180
v_fma_f32 v181,v181,s26,-v20
v_cvt_pk_bf16_f32 v177,v178,v179
v_mfma_f32_16x16x32_bf16 v[68:71],a[104:107],v[240:243],v[68:71]
s_waitcnt lgkmcnt(14)
ds_read_b64_tr_b16 a[148:149],v9 offset:51200
v_add_f32 v31,v31,v17
v_mfma_f32_16x16x32_bf16 v[68:71],a[108:111],v[244:247],v[68:71]
s_waitcnt lgkmcnt(14)
ds_read_b64_tr_b16 a[150:151],v9 offset:52224
v_exp_f32 v181,v181
v_cmp_nge_f32 vcc,s27,v31
v_fma_f32 v182,v182,s26,-v20
v_fma_f32 v183,v183,s26,-v20
v_mfma_f32_16x16x32_bf16 v[84:87],a[108:111],v[252:255],v[84:87]
v_rcp_f32 v14,v14
v_mfma_f32_16x16x32_bf16 v[84:87],a[104:107],v[248:251],v[84:87]
v_exp_f32 v182,v182
v_exp_f32 v183,v183
v_rcp_f32 v15,v15
v_mfma_f32_16x16x32_bf16 v[88:91],a[112:115],v[248:251],v[88:91]
s_waitcnt lgkmcnt(14)
ds_read_b64_tr_b16 a[152:153],v9 offset:49160
v_cvt_pk_bf16_f32 v178,v180,v181
v_mfma_f32_16x16x32_bf16 v[88:91],a[116:119],v[252:255],v[88:91]
s_waitcnt lgkmcnt(14)
ds_read_b64_tr_b16 a[154:155],v9 offset:50184
v_fma_f32 v184,v184,s26,-v21
v_rcp_f32 v16,v16
v_fma_f32 v185,v185,s26,-v21
v_cvt_pk_bf16_f32 v179,v182,v183
v_mfma_f32_16x16x32_bf16 v[72:75],a[116:119],v[244:247],v[72:75]
v_exp_f32 v184,v184
v_mfma_f32_16x16x32_bf16 v[72:75],a[112:115],v[240:243],v[72:75]
s_waitcnt lgkmcnt(14)
ds_read_b64_tr_b16 a[156:157],v9 offset:51208
v_exp_f32 v185,v185
v_fma_f32 v186,v186,s26,-v21
v_rcp_f32 v17,v17
v_mfma_f32_16x16x32_bf16 v[56:59],a[112:115],v[232:235],v[56:59]
s_waitcnt lgkmcnt(14)
ds_read_b64_tr_b16 a[158:159],v9 offset:52232
v_fma_f32 v187,v187,s26,-v21
v_mfma_f32_16x16x32_bf16 v[56:59],a[116:119],v[236:239],v[56:59]
buffer_load_dwordx4 v1,s[4:7],s23 offen offset:2048 nt lds
v_exp_f32 v186,v186
v_exp_f32 v187,v187
v_mfma_f32_16x16x32_bf16 v[40:43],a[116:119],v[228:231],v[40:43]
s_cmp_lg_u64 vcc,0
s_cselect_b32 s32,s29,0
s_or_b32 s28,s28,s32
s_lshl_b32 s29,s29,1
v_mfma_f32_16x16x32_bf16 v[40:43],a[112:115],v[224:227],v[40:43]
v_cvt_pk_bf16_f32 v184,v184,v185
v_fma_f32 v188,v188,s26,-v21
v_fma_f32 v189,v189,s26,-v21
v_cvt_pk_bf16_f32 v185,v186,v187
v_fma_f32 v190,v190,s26,-v21
v_fma_f32 v191,v191,s26,-v21
v_mfma_f32_16x16x32_bf16 v[44:47],a[120:123],v[224:227],v[44:47]
v_exp_f32 v188,v188
v_mfma_f32_16x16x32_bf16 v[44:47],a[124:127],v[228:231],v[44:47]
v_exp_f32 v189,v189
v_exp_f32 v190,v190
v_exp_f32 v191,v191
v_mfma_f32_16x16x32_bf16 v[60:63],a[124:127],v[236:239],v[60:63]
v_cvt_pk_bf16_f32 v186,v188,v189
v_cvt_pk_bf16_f32 v187,v190,v191
v_mfma_f32_16x16x32_bf16 v[60:63],a[120:123],v[232:235],v[60:63]
v_mfma_f32_16x16x32_bf16 v[76:79],a[120:123],v[240:243],v[76:79]
v_fma_f32 v192,v192,s26,-v18
v_fma_f32 v193,v193,s26,-v18
v_mfma_f32_16x16x32_bf16 v[76:79],a[124:127],v[244:247],v[76:79]
buffer_load_dwordx4 v1,s[4:7],s23 offen offset:3072 nt lds
v_exp_f32 v192,v192
v_exp_f32 v193,v193
v_fma_f32 v194,v194,s26,-v18
v_fma_f32 v195,v195,s26,-v18
v_mul_f32 v32,v32,v14
v_mfma_f32_16x16x32_bf16 v[92:95],a[124:127],v[252:255],v[92:95]
s_add_u32 s23,s23,16384
v_exp_f32 v194,v194
v_mfma_f32_16x16x32_bf16 v[92:95],a[120:123],v[248:251],v[92:95]
s_waitcnt lgkmcnt(12)
v_exp_f32 v195,v195
v_cvt_pk_bf16_f32 v164,v192,v193
v_mul_f32 v33,v33,v14
v_mul_f32 v34,v34,v14
v_mul_f32 v35,v35,v14
v_fma_f32 v200,v200,s26,-v19
v_fma_f32 v201,v201,s26,-v19
v_mul_f32 v36,v36,v14
v_mul_f32 v37,v37,v14
v_mfma_f32_16x16x32_bf16 a[208:211],a[128:131],v[248:251],a[208:211]
v_exp_f32 v200,v200
v_mfma_f32_16x16x32_bf16 a[208:211],a[132:135],v[252:255],a[208:211]
v_cvt_pk_bf16_f32 v165,v194,v195
v_exp_f32 v201,v201
v_cvt_pk_bf16_f32 v96,v32,v33
v_cvt_pk_bf16_f32 v97,v34,v35
v_mul_f32 v38,v38,v14
v_mul_f32 v39,v39,v14
v_cvt_pk_bf16_f32 v98,v36,v37
v_mul_f32 v40,v40,v14
v_mfma_f32_16x16x32_bf16 a[192:195],a[132:135],v[244:247],a[192:195]
v_mul_f32 v41,v41,v14
v_cvt_pk_bf16_f32 v99,v38,v39
v_mfma_f32_16x16x32_bf16 a[192:195],a[128:131],v[240:243],a[192:195]
s_waitcnt vmcnt(16)
s_waitcnt lgkmcnt(0)
s_barrier
ds_read_b128 a[96:99],v2 offset:16384
v_mul_f32 v42,v42,v14
v_mul_f32 v43,v43,v14
v_cvt_pk_bf16_f32 v172,v200,v201
v_cvt_pk_bf16_f32 v100,v40,v41
v_mul_f32 v44,v44,v14
v_mul_f32 v45,v45,v14
v_fma_f32 v202,v202,s26,-v19
v_fma_f32 v203,v203,s26,-v19
v_mul_f32 v46,v46,v14
v_mfma_f32_16x16x32_bf16 a[176:179],a[128:131],v[232:235],a[176:179]
s_add_u32 m0,s25,49152
v_exp_f32 v202,v202
v_mfma_f32_16x16x32_bf16 a[176:179],a[132:135],v[236:239],a[176:179]
buffer_load_dwordx4 v1,s[8:11],s21 offen nt lds
v_cvt_pk_bf16_f32 v101,v42,v43
v_exp_f32 v203,v203
v_mul_f32 v47,v47,v14
v_cvt_pk_bf16_f32 v102,v44,v45
v_mul_f32 v48,v48,v15
v_mul_f32 v49,v49,v15
v_mfma_f32_16x16x32_bf16 a[160:163],a[132:135],v[228:231],a[160:163]
v_cvt_pk_bf16_f32 v103,v46,v47
v_mul_f32 v50,v50,v15
v_mfma_f32_16x16x32_bf16 a[160:163],a[128:131],v[224:227],a[160:163]
ds_read_b128 a[100:103],v3 offset:16384
v_mul_f32 v51,v51,v15
v_cvt_pk_bf16_f32 v173,v202,v203
v_cvt_pk_bf16_f32 v112,v48,v49
v_mul_f32 v52,v52,v15
v_mul_f32 v53,v53,v15
v_fma_f32 v208,v208,s26,-v20
v_fma_f32 v209,v209,s26,-v20
v_mul_f32 v54,v54,v15
v_mfma_f32_16x16x32_bf16 a[164:167],a[136:139],v[224:227],a[164:167]
v_exp_f32 v208,v208
v_mfma_f32_16x16x32_bf16 a[164:167],a[140:143],v[228:231],a[164:167]
v_exp_f32 v209,v209
v_cvt_pk_bf16_f32 v113,v50,v51
v_mul_f32 v55,v55,v15
v_cvt_pk_bf16_f32 v114,v52,v53
v_mul_f32 v56,v56,v15
v_mul_f32 v57,v57,v15
v_mul_f32 v58,v58,v15
v_mul_f32 v59,v59,v15
v_mul_f32 v60,v60,v15
v_mfma_f32_16x16x32_bf16 a[180:183],a[140:143],v[236:239],a[180:183]
ds_read_b128 a[104:107],v4 offset:16384
v_cvt_pk_bf16_f32 v115,v54,v55
v_mfma_f32_16x16x32_bf16 a[180:183],a[136:139],v[232:235],a[180:183]
v_cvt_pk_bf16_f32 v116,v56,v57
v_mul_f32 v61,v61,v15
v_cvt_pk_bf16_f32 v180,v208,v209
v_cvt_pk_bf16_f32 v117,v58,v59
v_fma_f32 v210,v210,s26,-v20
v_fma_f32 v211,v211,s26,-v20
v_mul_f32 v62,v62,v15
v_mul_f32 v63,v63,v15
v_mul_f32 v64,v64,v16
v_mfma_f32_16x16x32_bf16 a[196:199],a[136:139],v[240:243],a[196:199]
v_exp_f32 v210,v210
v_mfma_f32_16x16x32_bf16 a[196:199],a[140:143],v[244:247],a[196:199]
buffer_load_dwordx4 v1,s[8:11],s21 offen offset:1024 nt lds
v_cvt_pk_bf16_f32 v118,v60,v61
v_exp_f32 v211,v211
v_mul_f32 v65,v65,v16
v_cvt_pk_bf16_f32 v119,v62,v63
v_mul_f32 v66,v66,v16
v_mul_f32 v67,v67,v16
v_mfma_f32_16x16x32_bf16 a[212:215],a[140:143],v[252:255],a[212:215]
ds_read_b128 a[108:111],v5 offset:16384
v_cvt_pk_bf16_f32 v128,v64,v65
v_mfma_f32_16x16x32_bf16 a[212:215],a[136:139],v[248:251],a[212:215]
v_mul_f32 v68,v68,v16
v_mul_f32 v69,v69,v16
v_cvt_pk_bf16_f32 v181,v210,v211
v_cvt_pk_bf16_f32 v129,v66,v67
v_mul_f32 v70,v70,v16
v_mul_f32 v71,v71,v16
v_fma_f32 v216,v216,s26,-v21
v_fma_f32 v217,v217,s26,-v21
v_mul_f32 v72,v72,v16
v_mul_f32 v73,v73,v16
v_mfma_f32_16x16x32_bf16 a[216:219],a[144:147],v[248:251],a[216:219]
v_exp_f32 v216,v216
v_mfma_f32_16x16x32_bf16 a[216:219],a[148:151],v[252:255],a[216:219]
v_cvt_pk_bf16_f32 v130,v68,v69
v_exp_f32 v217,v217
v_cvt_pk_bf16_f32 v131,v70,v71
v_mul_f32 v74,v74,v16
v_mul_f32 v75,v75,v16
v_cvt_pk_bf16_f32 v132,v72,v73
v_mul_f32 v76,v76,v16
v_mul_f32 v77,v77,v16
v_mfma_f32_16x16x32_bf16 a[200:203],a[148:151],v[244:247],a[200:203]
ds_read_b128 a[112:115],v2 offset:17408
v_cvt_pk_bf16_f32 v133,v74,v75
v_mfma_f32_16x16x32_bf16 a[200:203],a[144:147],v[240:243],a[200:203]
v_cvt_pk_bf16_f32 v188,v216,v217
v_mul_f32 v78,v78,v16
v_mul_f32 v79,v79,v16
v_fma_f32 v218,v218,s26,-v21
v_fma_f32 v219,v219,s26,-v21
v_cvt_pk_bf16_f32 v134,v76,v77
v_mul_f32 v80,v80,v17
v_mul_f32 v81,v81,v17
v_mul_f32 v82,v82,v17
v_mul_f32 v83,v83,v17
v_mfma_f32_16x16x32_bf16 a[184:187],a[144:147],v[232:235],a[184:187]
v_exp_f32 v218,v218
v_mfma_f32_16x16x32_bf16 a[184:187],a[148:151],v[236:239],a[184:187]
ds_read_b128 a[116:119],v3 offset:17408
v_exp_f32 v219,v219
v_cvt_pk_bf16_f32 v135,v78,v79
v_cvt_pk_bf16_f32 v144,v80,v81
v_mul_f32 v84,v84,v17
v_mul_f32 v85,v85,v17
v_cvt_pk_bf16_f32 v145,v82,v83
v_mul_f32 v86,v86,v17
v_mfma_f32_16x16x32_bf16 a[168:171],a[148:151],v[228:231],a[168:171]
v_mul_f32 v87,v87,v17
v_cvt_pk_bf16_f32 v189,v218,v219
v_mfma_f32_16x16x32_bf16 a[168:171],a[144:147],v[224:227],a[168:171]
v_cvt_pk_bf16_f32 v146,v84,v85
v_mul_f32 v88,v88,v17
v_mul_f32 v89,v89,v17
v_fma_f32 v196,v196,s26,-v18
v_fma_f32 v197,v197,s26,-v18
v_cvt_pk_bf16_f32 v147,v86,v87
v_mul_f32 v90,v90,v17
v_mul_f32 v91,v91,v17
v_mul_f32 v92,v92,v17
v_mfma_f32_16x16x32_bf16 a[172:175],a[152:155],v[224:227],a[172:175]
v_exp_f32 v196,v196
v_mfma_f32_16x16x32_bf16 a[172:175],a[156:159],v[228:231],a[172:175]
ds_read_b128 a[120:123],v4 offset:17408
v_cvt_pk_bf16_f32 v148,v88,v89
v_exp_f32 v197,v197
v_mul_f32 v93,v93,v17
v_cvt_pk_bf16_f32 v149,v90,v91
v_mul_f32 v94,v94,v17
v_mul_f32 v95,v95,v17
v_accvgpr_read_b32 v32,a160
v_fma_f32 v198,v198,s26,-v18
v_mfma_f32_16x16x32_bf16 a[188:191],a[156:159],v[236:239],a[188:191]
v_exp_f32 v198,v198
v_mfma_f32_16x16x32_bf16 a[188:191],a[152:155],v[232:235],a[188:191]
buffer_load_dwordx4 v1,s[8:11],s21 offen offset:2048 nt lds
v_cvt_pk_bf16_f32 v166,v196,v197
v_cvt_pk_bf16_f32 v150,v92,v93
v_fma_f32 v199,v199,s26,-v18
v_accvgpr_read_b32 v33,a161
v_cvt_pk_bf16_f32 v151,v94,v95
v_accvgpr_read_b32 v34,a162
v_accvgpr_read_b32 v35,a163
v_mfma_f32_16x16x32_bf16 a[204:207],a[152:155],v[240:243],a[204:207]
v_exp_f32 v199,v199
v_mfma_f32_16x16x32_bf16 a[204:207],a[156:159],v[244:247],a[204:207]
ds_read_b128 a[124:127],v5 offset:17408
v_mul_f32 v32,v32,v14
v_mul_f32 v33,v33,v14
v_accvgpr_read_b32 v36,a164
v_accvgpr_read_b32 v37,a165
v_mul_f32 v34,v34,v14
v_mul_f32 v35,v35,v14
v_cvt_pk_bf16_f32 v167,v198,v199
v_accvgpr_read_b32 v38,a166
v_fma_f32 v204,v204,s26,-v19
v_mfma_f32_16x16x32_bf16 a[220:223],a[156:159],v[252:255],a[220:223]
v_exp_f32 v204,v204
v_mfma_f32_16x16x32_bf16 a[220:223],a[152:155],v[248:251],a[220:223]
s_waitcnt lgkmcnt(4)
v_cvt_pk_bf16_f32 v104,v32,v33
v_fma_f32 v205,v205,s26,-v19
v_accvgpr_read_b32 v39,a167
v_mul_f32 v36,v36,v14
v_mul_f32 v37,v37,v14
v_cvt_pk_bf16_f32 v105,v34,v35
v_accvgpr_read_b32 v40,a168
v_accvgpr_read_b32 v41,a169
v_mul_f32 v38,v38,v14
v_mfma_f32_16x16x32_bf16 v[224:227],a[96:99],a[0:3],0
ds_read_b128 a[128:131],v2 offset:18432
v_mul_f32 v39,v39,v14
v_mfma_f32_16x16x32_bf16 v[224:227],a[100:103],a[4:7],v[224:227]
v_exp_f32 v205,v205
v_mfma_f32_16x16x32_bf16 v[224:227],a[104:107],a[8:11],v[224:227]
v_cvt_pk_bf16_f32 v106,v36,v37
v_accvgpr_read_b32 v42,a170
v_mfma_f32_16x16x32_bf16 v[224:227],a[108:111],a[12:15],v[224:227]
buffer_load_dwordx4 v1,s[8:11],s21 offen offset:3072 nt lds
v_cvt_pk_bf16_f32 v174,v204,v205
v_accvgpr_read_b32 v43,a171
v_mul_f32 v40,v40,v14
v_mul_f32 v41,v41,v14
v_cvt_pk_bf16_f32 v107,v38,v39
v_fma_f32 v206,v206,s26,-v19
v_fma_f32 v207,v207,s26,-v19
v_mfma_f32_16x16x32_bf16 v[232:235],a[108:111],a[28:31],0
s_add_u32 s21,s21,16384
ds_read_b128 a[132:135],v3 offset:18432
v_mfma_f32_16x16x32_bf16 v[232:235],a[104:107],a[24:27],v[232:235]
v_exp_f32 v206,v206
v_mfma_f32_16x16x32_bf16 v[232:235],a[100:103],a[20:23],v[232:235]
v_exp_f32 v207,v207
v_mfma_f32_16x16x32_bf16 v[232:235],a[96:99],a[16:19],v[232:235]
v_accvgpr_read_b32 v44,a172
v_accvgpr_read_b32 v45,a173
v_mul_f32 v42,v42,v14
v_mul_f32 v43,v43,v14
v_cvt_pk_bf16_f32 v108,v40,v41
v_accvgpr_read_b32 v46,a174
v_accvgpr_read_b32 v47,a175
v_accvgpr_read_b32 v48,a176
v_cvt_pk_bf16_f32 v175,v206,v207
v_fma_f32 v224,v224,s26,-v18
v_mfma_f32_16x16x32_bf16 v[240:243],a[96:99],a[32:35],0
ds_read_b128 a[136:139],v4 offset:18432
v_mul_f32 v44,v44,v14
v_mfma_f32_16x16x32_bf16 v[240:243],a[100:103],a[36:39],v[240:243]
v_exp_f32 v224,v224
v_mfma_f32_16x16x32_bf16 v[240:243],a[104:107],a[40:43],v[240:243]
v_mul_f32 v45,v45,v14
v_cvt_pk_bf16_f32 v109,v42,v43
v_mfma_f32_16x16x32_bf16 v[240:243],a[108:111],a[44:47],v[240:243]
ds_read_b128 a[140:143],v5 offset:18432
v_fma_f32 v225,v225,s26,-v18
v_accvgpr_read_b32 v49,a177
v_fma_f32 v212,v212,s26,-v20
v_fma_f32 v213,v213,s26,-v20
v_mul_f32 v46,v46,v14
v_mul_f32 v47,v47,v14
v_cvt_pk_bf16_f32 v110,v44,v45
v_accvgpr_read_b32 v50,a178
v_mfma_f32_16x16x32_bf16 v[248:251],a[108:111],a[60:63],0
v_exp_f32 v225,v225
v_mfma_f32_16x16x32_bf16 v[248:251],a[104:107],a[56:59],v[248:251]
v_exp_f32 v212,v212
v_mfma_f32_16x16x32_bf16 v[248:251],a[100:103],a[52:55],v[248:251]
s_waitcnt lgkmcnt(4)
v_exp_f32 v213,v213
v_mfma_f32_16x16x32_bf16 v[248:251],a[96:99],a[48:51],v[248:251]
ds_read_b128 a[144:147],v2 offset:19456
v_accvgpr_read_b32 v51,a179
v_mul_f32 v48,v48,v15
v_mul_f32 v49,v49,v15
v_cvt_pk_bf16_f32 v111,v46,v47
v_accvgpr_read_b32 v52,a180
v_accvgpr_read_b32 v53,a181
v_mul_f32 v50,v50,v15
v_cvt_pk_bf16_f32 v182,v212,v213
v_mfma_f32_16x16x32_bf16 v[228:231],a[112:115],a[0:3],0
v_mul_f32 v51,v51,v15
v_cvt_pk_bf16_f32 v120,v48,v49
v_mfma_f32_16x16x32_bf16 v[228:231],a[116:119],a[4:7],v[228:231]
v_accvgpr_read_b32 v54,a182
v_fma_f32 v226,v226,s26,-v18
v_mfma_f32_16x16x32_bf16 v[228:231],a[120:123],a[8:11],v[228:231]
v_exp_f32 v226,v226
v_mfma_f32_16x16x32_bf16 v[228:231],a[124:127],a[12:15],v[228:231]
ds_read_b128 a[148:151],v3 offset:19456
v_fma_f32 v227,v227,s26,-v18
v_fma_f32 v214,v214,s26,-v20
v_fma_f32 v215,v215,s26,-v20
v_accvgpr_read_b32 v55,a183
v_mul_f32 v52,v52,v15
v_mul_f32 v53,v53,v15
v_cvt_pk_bf16_f32 v121,v50,v51
v_accvgpr_read_b32 v56,a184
v_accvgpr_read_b32 v57,a185
v_mfma_f32_16x16x32_bf16 v[236:239],a[124:127],a[28:31],0
v_exp_f32 v227,v227
v_mfma_f32_16x16x32_bf16 v[236:239],a[120:123],a[24:27],v[236:239]
v_exp_f32 v214,v214
v_mfma_f32_16x16x32_bf16 v[236:239],a[116:119],a[20:23],v[236:239]
s_add_u32 m0,s25,98304
ds_read_b128 a[152:155],v4 offset:19456
v_mfma_f32_16x16x32_bf16 v[236:239],a[112:115],a[16:19],v[236:239]
buffer_load_dwordx4 v1,s[12:15],s22 offen nt lds
v_cvt_pk_bf16_f32 v224,v224,v225
v_exp_f32 v215,v215
v_mul_f32 v54,v54,v15
v_mul_f32 v55,v55,v15
v_cvt_pk_bf16_f32 v122,v52,v53
v_accvgpr_read_b32 v58,a186
v_mfma_f32_16x16x32_bf16 v[244:247],a[112:115],a[32:35],0
v_cvt_pk_bf16_f32 v225,v226,v227
v_accvgpr_read_b32 v59,a187
v_mfma_f32_16x16x32_bf16 v[244:247],a[116:119],a[36:39],v[244:247]
v_cvt_pk_bf16_f32 v183,v214,v215
v_mul_f32 v56,v56,v15
v_mfma_f32_16x16x32_bf16 v[244:247],a[120:123],a[40:43],v[244:247]
ds_read_b128 a[156:159],v5 offset:19456
v_mul_f32 v57,v57,v15
v_mfma_f32_16x16x32_bf16 v[244:247],a[124:127],a[44:47],v[244:247]
v_cvt_pk_bf16_f32 v123,v54,v55
v_fma_f32 v228,v228,s26,-v18
v_fma_f32 v229,v229,s26,-v18
v_accvgpr_read_b32 v60,a188
v_fma_f32 v220,v220,s26,-v21
v_fma_f32 v221,v221,s26,-v21
v_accvgpr_read_b32 v61,a189
v_mul_f32 v58,v58,v15
v_mul_f32 v59,v59,v15
v_cvt_pk_bf16_f32 v124,v56,v57
v_mfma_f32_16x16x32_bf16 v[252:255],a[124:127],a[60:63],0
v_exp_f32 v228,v228
v_mfma_f32_16x16x32_bf16 v[252:255],a[120:123],a[56:59],v[252:255]
v_exp_f32 v229,v229
v_mfma_f32_16x16x32_bf16 v[252:255],a[116:119],a[52:55],v[252:255]
v_exp_f32 v220,v220
v_mfma_f32_16x16x32_bf16 v[252:255],a[112:115],a[48:51],v[252:255]
s_waitcnt lgkmcnt(4)
v_accvgpr_read_b32 v62,a190
v_exp_f32 v221,v221
v_accvgpr_read_b32 v63,a191
v_mul_f32 v60,v60,v15
v_mul_f32 v61,v61,v15
v_cvt_pk_bf16_f32 v125,v58,v59
v_cvt_pk_bf16_f32 v226,v228,v229
v_accvgpr_read_b32 v64,a192
v_mfma_f32_16x16x32_bf16 v[192:195],a[128:131],a[0:3],0
v_cvt_pk_bf16_f32 v190,v220,v221
v_fma_f32 v230,v230,s26,-v18
v_mfma_f32_16x16x32_bf16 v[192:195],a[132:135],a[4:7],v[192:195]
v_exp_f32 v230,v230
v_mfma_f32_16x16x32_bf16 v[192:195],a[136:139],a[8:11],v[192:195]
v_fma_f32 v231,v231,s26,-v18
v_accvgpr_read_b32 v65,a193
v_mfma_f32_16x16x32_bf16 v[192:195],a[140:143],a[12:15],v[192:195]
buffer_load_dwordx4 v1,s[12:15],s22 offen offset:1024 nt lds
v_mul_f32 v62,v62,v15
v_exp_f32 v231,v231
v_mul_f32 v63,v63,v15
v_cvt_pk_bf16_f32 v126,v60,v61
v_fma_f32 v222,v222,s26,-v21
v_fma_f32 v223,v223,s26,-v21
v_mfma_f32_16x16x32_bf16 v[200:203],a[140:143],a[28:31],0
v_exp_f32 v222,v222
v_mfma_f32_16x16x32_bf16 v[200:203],a[136:139],a[24:27],v[200:203]
ds_read_b64_tr_b16 a[96:97],v8 offset:0
v_accvgpr_read_b32 v66,a194
v_mfma_f32_16x16x32_bf16 v[200:203],a[132:135],a[20:23],v[200:203]
ds_read_b64_tr_b16 a[98:99],v8 offset:1024
v_accvgpr_read_b32 v67,a195
v_mfma_f32_16x16x32_bf16 v[200:203],a[128:131],a[16:19],v[200:203]
v_exp_f32 v223,v223
v_mul_f32 v64,v64,v16
v_mul_f32 v65,v65,v16
v_cvt_pk_bf16_f32 v127,v62,v63
v_accvgpr_read_b32 v68,a196
v_accvgpr_read_b32 v69,a197
v_mul_f32 v66,v66,v16
v_mul_f32 v67,v67,v16
v_cvt_pk_bf16_f32 v227,v230,v231
v_mfma_f32_16x16x32_bf16 v[208:211],a[128:131],a[32:35],0
ds_read_b64_tr_b16 a[100:101],v8 offset:2048
v_cvt_pk_bf16_f32 v136,v64,v65
v_mfma_f32_16x16x32_bf16 v[208:211],a[132:135],a[36:39],v[208:211]
ds_read_b64_tr_b16 a[102:103],v8 offset:3072
v_cvt_pk_bf16_f32 v191,v222,v223
v_mfma_f32_16x16x32_bf16 v[208:211],a[136:139],a[40:43],v[208:211]
v_accvgpr_read_b32 v70,a198
v_fma_f32 v232,v232,s26,-v19
v_mfma_f32_16x16x32_bf16 v[208:211],a[140:143],a[44:47],v[208:211]
buffer_load_dwordx4 v1,s[12:15],s22 offen offset:2048 nt lds
v_fma_f32 v233,v233,s26,-v19
v_exp_f32 v232,v232
v_accvgpr_read_b32 v71,a199
v_mul_f32 v68,v68,v16
v_mul_f32 v69,v69,v16
v_cvt_pk_bf16_f32 v137,v66,v67
v_mfma_f32_16x16x32_bf16 v[216:219],a[140:143],a[60:63],0
ds_read_b64_tr_b16 a[104:105],v8 offset:8
v_accvgpr_read_b32 v72,a200
v_mfma_f32_16x16x32_bf16 v[216:219],a[136:139],a[56:59],v[216:219]
ds_read_b64_tr_b16 a[106:107],v8 offset:1032
v_accvgpr_read_b32 v73,a201
v_mfma_f32_16x16x32_bf16 v[216:219],a[132:135],a[52:55],v[216:219]
v_exp_f32 v233,v233
v_mfma_f32_16x16x32_bf16 v[216:219],a[128:131],a[48:51],v[216:219]
s_waitcnt lgkmcnt(6)
v_mul_f32 v70,v70,v16
v_mul_f32 v71,v71,v16
v_cvt_pk_bf16_f32 v138,v68,v69
v_accvgpr_read_b32 v74,a202
v_cvt_pk_bf16_f32 v232,v232,v233
v_accvgpr_read_b32 v75,a203
v_mul_f32 v72,v72,v16
v_mul_f32 v73,v73,v16
v_fma_f32 v234,v234,s26,-v19
v_fma_f32 v235,v235,s26,-v19
v_mfma_f32_16x16x32_bf16 v[196:199],a[144:147],a[0:3],0
ds_read_b64_tr_b16 a[108:109],v8 offset:2056
v_cvt_pk_bf16_f32 v139,v70,v71
v_mfma_f32_16x16x32_bf16 v[196:199],a[148:151],a[4:7],v[196:199]
ds_read_b64_tr_b16 a[110:111],v8 offset:3080
v_accvgpr_read_b32 v76,a204
v_mfma_f32_16x16x32_bf16 v[196:199],a[152:155],a[8:11],v[196:199]
v_exp_f32 v234,v234
v_mfma_f32_16x16x32_bf16 v[196:199],a[156:159],a[12:15],v[196:199]
ds_read_b64_tr_b16 a[112:113],v9 offset:0
v_exp_f32 v235,v235
v_accvgpr_read_b32 v77,a205
v_mul_f32 v74,v74,v16
v_mul_f32 v75,v75,v16
v_cvt_pk_bf16_f32 v140,v72,v73
v_accvgpr_read_b32 v78,a206
v_accvgpr_read_b32 v79,a207
v_mfma_f32_16x16x32_bf16 v[204:207],a[156:159],a[28:31],0
ds_read_b64_tr_b16 a[114:115],v9 offset:1024
v_mul_f32 v76,v76,v16
v_mfma_f32_16x16x32_bf16 v[204:207],a[152:155],a[24:27],v[204:207]
v_mul_f32 v77,v77,v16
v_cvt_pk_bf16_f32 v141,v74,v75
v_mfma_f32_16x16x32_bf16 v[204:207],a[148:151],a[20:23],v[204:207]
v_accvgpr_read_b32 v80,a208
v_cvt_pk_bf16_f32 v233,v234,v235
v_mfma_f32_16x16x32_bf16 v[204:207],a[144:147],a[16:19],v[204:207]
ds_read_b64_tr_b16 a[116:117],v9 offset:2048
v_accvgpr_read_b32 v81,a209
v_fma_f32 v240,v240,s26,-v20
v_fma_f32 v241,v241,s26,-v20
v_mul_f32 v78,v78,v16
v_mul_f32 v79,v79,v16
v_cvt_pk_bf16_f32 v142,v76,v77
v_accvgpr_read_b32 v82,a210
v_accvgpr_read_b32 v83,a211
v_mfma_f32_16x16x32_bf16 v[212:215],a[144:147],a[32:35],0
ds_read_b64_tr_b16 a[118:119],v9 offset:3072
v_mul_f32 v80,v80,v17
v_mfma_f32_16x16x32_bf16 v[212:215],a[148:151],a[36:39],v[212:215]
v_exp_f32 v240,v240
v_mfma_f32_16x16x32_bf16 v[212:215],a[152:155],a[40:43],v[212:215]
v_exp_f32 v241,v241
v_mfma_f32_16x16x32_bf16 v[212:215],a[156:159],a[44:47],v[212:215]
ds_read_b64_tr_b16 a[120:121],v9 offset:8
v_mul_f32 v81,v81,v17
v_cvt_pk_bf16_f32 v143,v78,v79
v_accvgpr_read_b32 v84,a212
v_accvgpr_read_b32 v85,a213
v_mul_f32 v82,v82,v17
v_mul_f32 v83,v83,v17
v_cvt_pk_bf16_f32 v240,v240,v241
v_accvgpr_read_b32 v86,a214
v_fma_f32 v242,v242,s26,-v20
v_mfma_f32_16x16x32_bf16 v[220:223],a[156:159],a[60:63],0
ds_read_b64_tr_b16 a[122:123],v9 offset:1032
v_cvt_pk_bf16_f32 v152,v80,v81
v_mfma_f32_16x16x32_bf16 v[220:223],a[152:155],a[56:59],v[220:223]
v_exp_f32 v242,v242
v_mfma_f32_16x16x32_bf16 v[220:223],a[148:151],a[52:55],v[220:223]
ds_read_b64_tr_b16 a[124:125],v9 offset:2056
v_fma_f32 v243,v243,s26,-v20
v_mfma_f32_16x16x32_bf16 v[220:223],a[144:147],a[48:51],v[220:223]
s_waitcnt lgkmcnt(14)
ds_read_b64_tr_b16 a[126:127],v9 offset:3080
v_exp_f32 v243,v243
v_accvgpr_read_b32 v87,a215
v_mul_f32 v84,v84,v17
v_mul_f32 v85,v85,v17
v_cvt_pk_bf16_f32 v153,v82,v83
v_accvgpr_read_b32 v88,a216
v_accvgpr_read_b32 v89,a217
v_mfma_f32_16x16x32_bf16 a[224:227],a[240:243],v[160:163],0
v_mul_f32 v86,v86,v17
v_mul_f32 v87,v87,v17
v_mfma_f32_16x16x32_bf16 a[224:227],a[240:243],v[164:167],a[224:227]
buffer_load_dwordx4 v1,s[12:15],s22 offen offset:3072 nt lds
v_cvt_pk_bf16_f32 v154,v84,v85
v_accvgpr_read_b32 v90,a218
v_accvgpr_read_b32 v91,a219
v_cvt_pk_bf16_f32 v241,v242,v243
v_mul_f32 v88,v88,v17
v_mul_f32 v89,v89,v17
v_cvt_pk_bf16_f32 v155,v86,v87
v_mfma_f32_16x16x32_bf16 a[228:231],a[240:243],v[168:171],0
s_add_u32 s22,s22,16384
s_waitcnt lgkmcnt(14)
ds_read_b64_tr_b16 a[128:129],v6 offset:0
v_mfma_f32_16x16x32_bf16 a[228:231],a[240:243],v[172:175],a[228:231]
s_waitcnt lgkmcnt(14)
ds_read_b64_tr_b16 a[130:131],v6 offset:1024
v_fma_f32 v248,v248,s26,-v21
v_fma_f32 v249,v249,s26,-v21
v_accvgpr_read_b32 v92,a220
v_accvgpr_read_b32 v93,a221
v_mul_f32 v90,v90,v17
v_mul_f32 v91,v91,v17
v_cvt_pk_bf16_f32 v156,v88,v89
v_accvgpr_read_b32 v94,a222
v_accvgpr_read_b32 v95,a223
v_mfma_f32_16x16x32_bf16 a[232:235],a[240:243],v[176:179],0
v_exp_f32 v248,v248
v_mfma_f32_16x16x32_bf16 a[232:235],a[240:243],v[180:183],a[232:235]
s_waitcnt lgkmcnt(14)
v_exp_f32 v249,v249
v_mul_f32 v92,v92,v17
v_mul_f32 v93,v93,v17
v_cvt_pk_bf16_f32 v157,v90,v91
v_mul_f32 v94,v94,v17
v_mul_f32 v95,v95,v17
v_fma_f32 v250,v250,s26,-v21
v_fma_f32 v251,v251,s26,-v21
v_mfma_f32_16x16x32_bf16 a[236:239],a[240:243],v[184:187],0
ds_read_b64_tr_b16 a[132:133],v6 offset:2048
v_cvt_pk_bf16_f32 v248,v248,v249
v_mfma_f32_16x16x32_bf16 a[236:239],a[240:243],v[188:191],a[236:239]
s_waitcnt lgkmcnt(14)
ds_read_b64_tr_b16 a[134:135],v6 offset:3072
v_cvt_pk_bf16_f32 v158,v92,v93
v_exp_f32 v250,v250
v_exp_f32 v251,v251
v_cvt_pk_bf16_f32 v159,v94,v95
v_fma_f32 v236,v236,s26,-v19
v_fma_f32 v237,v237,s26,-v19
v_fma_f32 v238,v238,s26,-v19
v_mfma_f32_16x16x32_bf16 a[208:211],a[96:99],v[184:187],0
v_exp_f32 v236,v236
v_mfma_f32_16x16x32_bf16 a[208:211],a[100:103],v[188:191],a[208:211]
s_waitcnt lgkmcnt(14)
ds_read_b64_tr_b16 a[136:137],v6 offset:8
v_exp_f32 v237,v237
v_exp_f32 v238,v238
v_cvt_pk_bf16_f32 v249,v250,v251
v_fma_f32 v239,v239,s26,-v19
v_fma_f32 v244,v244,s26,-v20
v_fma_f32 v245,v245,s26,-v20
v_mfma_f32_16x16x32_bf16 a[192:195],a[100:103],v[180:183],0
s_add_u32 m0,s25,131072
s_waitcnt lgkmcnt(14)
ds_read_b64_tr_b16 a[138:139],v6 offset:1032
v_mfma_f32_16x16x32_bf16 a[192:195],a[96:99],v[176:179],a[192:195]
buffer_load_dwordx4 v1,s[4:7],s23 offen nt lds
v_cvt_pk_bf16_f32 v234,v236,v237
v_exp_f32 v239,v239
v_exp_f32 v244,v244
v_exp_f32 v245,v245
v_mfma_f32_16x16x32_bf16 a[176:179],a[96:99],v[168:171],0
v_cvt_pk_bf16_f32 v235,v238,v239
v_cvt_pk_bf16_f32 v242,v244,v245
v_mfma_f32_16x16x32_bf16 a[176:179],a[100:103],v[172:175],a[176:179]
s_waitcnt lgkmcnt(14)
ds_read_b64_tr_b16 a[140:141],v6 offset:2056
v_fma_f32 v246,v246,s26,-v20
v_fma_f32 v247,v247,s26,-v20
v_fma_f32 v252,v252,s26,-v21
v_fma_f32 v253,v253,s26,-v21
v_fma_f32 v254,v254,s26,-v21
v_fma_f32 v255,v255,s26,-v21
v_mfma_f32_16x16x32_bf16 a[160:163],a[100:103],v[164:167],0
s_waitcnt lgkmcnt(14)
ds_read_b64_tr_b16 a[142:143],v6 offset:3080
v_mfma_f32_16x16x32_bf16 a[160:163],a[96:99],v[160:163],a[160:163]
v_exp_f32 v246,v246
v_exp_f32 v247,v247
v_exp_f32 v252,v252
v_exp_f32 v253,v253
v_mfma_f32_16x16x32_bf16 a[164:167],a[104:107],v[160:163],0
v_exp_f32 v254,v254
v_mfma_f32_16x16x32_bf16 a[164:167],a[108:111],v[164:167],a[164:167]
s_waitcnt lgkmcnt(14)
ds_read_b64_tr_b16 a[144:145],v7 offset:0
v_cvt_pk_bf16_f32 v243,v246,v247
v_exp_f32 v255,v255
v_cvt_pk_bf16_f32 v250,v252,v253
v_mfma_f32_16x16x32_bf16 a[180:183],a[108:111],v[172:175],0
s_waitcnt lgkmcnt(14)
ds_read_b64_tr_b16 a[146:147],v7 offset:1024
v_cvt_pk_bf16_f32 v251,v254,v255
v_mfma_f32_16x16x32_bf16 a[180:183],a[104:107],v[168:171],a[180:183]
buffer_load_dwordx4 v1,s[4:7],s23 offen offset:1024 nt lds
v_mfma_f32_16x16x32_bf16 a[196:199],a[104:107],v[176:179],0
s_waitcnt lgkmcnt(14)
ds_read_b64_tr_b16 a[148:149],v7 offset:2048
v_mfma_f32_16x16x32_bf16 a[196:199],a[108:111],v[180:183],a[196:199]
s_waitcnt lgkmcnt(14)
ds_read_b64_tr_b16 a[150:151],v7 offset:3072
v_mfma_f32_16x16x32_bf16 a[212:215],a[108:111],v[188:191],0
v_mfma_f32_16x16x32_bf16 a[212:215],a[104:107],v[184:187],a[212:215]
v_mfma_f32_16x16x32_bf16 a[216:219],a[112:115],v[184:187],0
s_waitcnt lgkmcnt(14)
ds_read_b64_tr_b16 a[152:153],v7 offset:8
v_mfma_f32_16x16x32_bf16 a[216:219],a[116:119],v[188:191],a[216:219]
s_waitcnt lgkmcnt(14)
ds_read_b64_tr_b16 a[154:155],v7 offset:1032
v_mfma_f32_16x16x32_bf16 a[200:203],a[116:119],v[180:183],0
v_mfma_f32_16x16x32_bf16 a[200:203],a[112:115],v[176:179],a[200:203]
s_waitcnt lgkmcnt(14)
ds_read_b64_tr_b16 a[156:157],v7 offset:2056
v_mfma_f32_16x16x32_bf16 a[184:187],a[112:115],v[168:171],0
s_waitcnt lgkmcnt(14)
ds_read_b64_tr_b16 a[158:159],v7 offset:3080
v_mfma_f32_16x16x32_bf16 a[184:187],a[116:119],v[172:175],a[184:187]
buffer_load_dwordx4 v1,s[4:7],s23 offen offset:2048 nt lds
v_mfma_f32_16x16x32_bf16 a[168:171],a[116:119],v[164:167],0
v_mfma_f32_16x16x32_bf16 a[168:171],a[112:115],v[160:163],a[168:171]
v_mfma_f32_16x16x32_bf16 a[172:175],a[120:123],v[160:163],0
v_mfma_f32_16x16x32_bf16 a[172:175],a[124:127],v[164:167],a[172:175]
v_mfma_f32_16x16x32_bf16 a[188:191],a[124:127],v[172:175],0
v_mfma_f32_16x16x32_bf16 a[188:191],a[120:123],v[168:171],a[188:191]
s_xor_b32 s24,s24,0xffff0000
v_mfma_f32_16x16x32_bf16 a[204:207],a[120:123],v[176:179],0
v_fma_f32 v192,v192,s26,-v18
v_mfma_f32_16x16x32_bf16 a[204:207],a[124:127],v[180:183],a[204:207]
buffer_load_dwordx4 v1,s[4:7],s23 offen offset:3072 nt lds
v_exp_f32 v192,v192
v_mfma_f32_16x16x32_bf16 a[220:223],a[124:127],v[188:191],0
s_add_u32 s23,s23,16384
v_fma_f32 v193,v193,s26,-v18
v_mfma_f32_16x16x32_bf16 a[220:223],a[120:123],v[184:187],a[220:223]
s_waitcnt lgkmcnt(12)
v_exp_f32 v193,v193
v_fma_f32 v194,v194,s26,-v18
v_fma_f32 v195,v195,s26,-v18
v_mfma_f32_16x16x32_bf16 v[80:83],a[128:131],v[184:187],0
v_cvt_pk_bf16_f32 v228,v192,v193
v_mfma_f32_16x16x32_bf16 v[80:83],a[132:135],v[188:191],v[80:83]
v_exp_f32 v194,v194
v_exp_f32 v195,v195
v_mfma_f32_16x16x32_bf16 v[64:67],a[132:135],v[180:183],0
v_cvt_pk_bf16_f32 v229,v194,v195
v_mfma_f32_16x16x32_bf16 v[64:67],a[128:131],v[176:179],v[64:67]
s_waitcnt vmcnt(16)
s_waitcnt lgkmcnt(0)
s_barrier
s_branch L_h0_0
L_x0_0:
ds_read_b128 a[96:99],v2 offset:0
v_accvgpr_mov_b32 a20,a84
v_accvgpr_mov_b32 a21,a85
v_mfma_f32_16x16x32_bf16 a[176:179],a[128:131],v[168:171],a[176:179]
v_cvt_pk_bf16_f32 v229,v194,v195
v_fma_f32 v196,v196,s26,-v18
v_mfma_f32_16x16x32_bf16 a[176:179],a[132:135],v[172:175],a[176:179]
ds_read_b128 a[48:51],v10 offset:0
v_exp_f32 v196,v196
v_mfma_f32_16x16x32_bf16 a[160:163],a[132:135],v[164:167],a[160:163]
v_fma_f32 v197,v197,s26,-v18
v_accvgpr_mov_b32 a22,a86
v_mfma_f32_16x16x32_bf16 a[160:163],a[128:131],v[160:163],a[160:163]
ds_read_b128 a[100:103],v3 offset:0
v_exp_f32 v197,v197
v_mfma_f32_16x16x32_bf16 a[164:167],a[136:139],v[160:163],a[164:167]
v_accvgpr_mov_b32 a23,a87
v_cvt_pk_bf16_f32 v230,v196,v197
v_mfma_f32_16x16x32_bf16 a[164:167],a[140:143],v[164:167],a[164:167]
ds_read_b128 a[52:55],v11 offset:0
v_fma_f32 v198,v198,s26,-v18
v_fma_f32 v199,v199,s26,-v18
v_accvgpr_mov_b32 a24,a88
v_mfma_f32_16x16x32_bf16 a[180:183],a[140:143],v[172:175],a[180:183]
s_add_u32 m0,s25,32768
ds_read_b128 a[104:107],v4 offset:0
v_mfma_f32_16x16x32_bf16 a[180:183],a[136:139],v[168:171],a[180:183]
buffer_load_dwordx4 v1,s[8:11],s21 offen nt lds
v_accvgpr_mov_b32 a25,a89
v_mfma_f32_16x16x32_bf16 a[196:199],a[136:139],v[176:179],a[196:199]
v_exp_f32 v198,v198
v_mfma_f32_16x16x32_bf16 a[196:199],a[140:143],v[180:183],a[196:199]
ds_read_b128 a[56:59],v12 offset:0
v_exp_f32 v199,v199
v_mfma_f32_16x16x32_bf16 a[212:215],a[140:143],v[188:191],a[212:215]
ds_read_b128 a[108:111],v5 offset:0
v_cvt_pk_bf16_f32 v231,v198,v199
v_mfma_f32_16x16x32_bf16 a[212:215],a[136:139],v[184:187],a[212:215]
v_fma_f32 v200,v200,s26,-v19
v_fma_f32 v201,v201,s26,-v19
v_accvgpr_mov_b32 a26,a90
v_mfma_f32_16x16x32_bf16 a[216:219],a[144:147],v[184:187],a[216:219]
v_exp_f32 v200,v200
v_mfma_f32_16x16x32_bf16 a[216:219],a[148:151],v[188:191],a[216:219]
ds_read_b128 a[60:63],v13 offset:0
v_exp_f32 v201,v201
v_mfma_f32_16x16x32_bf16 a[200:203],a[148:151],v[180:183],a[200:203]
ds_read_b128 a[112:115],v2 offset:1024
v_accvgpr_mov_b32 a27,a91
v_mfma_f32_16x16x32_bf16 a[200:203],a[144:147],v[176:179],a[200:203]
buffer_load_dwordx4 v1,s[8:11],s21 offen offset:1024 nt lds
v_cvt_pk_bf16_f32 v236,v200,v201
v_mfma_f32_16x16x32_bf16 a[184:187],a[144:147],v[168:171],a[184:187]
v_fma_f32 v202,v202,s26,-v19
v_fma_f32 v203,v203,s26,-v19
v_mfma_f32_16x16x32_bf16 a[184:187],a[148:151],v[172:175],a[184:187]
ds_read_b128 a[116:119],v3 offset:1024
v_exp_f32 v202,v202
v_mfma_f32_16x16x32_bf16 a[168:171],a[148:151],v[164:167],a[168:171]
v_exp_f32 v203,v203
v_mfma_f32_16x16x32_bf16 a[168:171],a[144:147],v[160:163],a[168:171]
v_accvgpr_mov_b32 a28,a92
v_accvgpr_mov_b32 a29,a93
v_cvt_pk_bf16_f32 v237,v202,v203
v_mfma_f32_16x16x32_bf16 a[172:175],a[152:155],v[160:163],a[172:175]
v_fma_f32 v204,v204,s26,-v19
v_fma_f32 v205,v205,s26,-v19
v_mfma_f32_16x16x32_bf16 a[172:175],a[156:159],v[164:167],a[172:175]
ds_read_b128 a[120:123],v4 offset:1024
v_exp_f32 v204,v204
v_mfma_f32_16x16x32_bf16 a[188:191],a[156:159],v[172:175],a[188:191]
v_exp_f32 v205,v205
v_mfma_f32_16x16x32_bf16 a[188:191],a[152:155],v[168:171],a[188:191]
buffer_load_dwordx4 v1,s[8:11],s21 offen offset:2048 nt lds
v_accvgpr_mov_b32 a30,a94
v_mfma_f32_16x16x32_bf16 a[204:207],a[152:155],v[176:179],a[204:207]
v_accvgpr_mov_b32 a31,a95
v_cvt_pk_bf16_f32 v238,v204,v205
v_mfma_f32_16x16x32_bf16 a[204:207],a[156:159],v[180:183],a[204:207]
ds_read_b128 a[124:127],v5 offset:1024
v_fma_f32 v206,v206,s26,-v19
v_fma_f32 v207,v207,s26,-v19
v_mfma_f32_16x16x32_bf16 a[220:223],a[156:159],v[188:191],a[220:223]
v_exp_f32 v206,v206
v_mfma_f32_16x16x32_bf16 a[220:223],a[152:155],v[184:187],a[220:223]
s_waitcnt lgkmcnt(5)
v_exp_f32 v207,v207
v_fma_f32 v208,v208,s26,-v20
v_mfma_f32_16x16x32_bf16 v[160:163],a[96:99],a[0:3],0
ds_read_b128 a[128:131],v2 offset:2048
v_cvt_pk_bf16_f32 v239,v206,v207
v_mfma_f32_16x16x32_bf16 v[160:163],a[100:103],a[4:7],v[160:163]
v_exp_f32 v208,v208
v_mfma_f32_16x16x32_bf16 v[160:163],a[104:107],a[8:11],v[160:163]
v_fma_f32 v209,v209,s26,-v20
v_fma_f32 v210,v210,s26,-v20
v_mfma_f32_16x16x32_bf16 v[160:163],a[108:111],a[12:15],v[160:163]
buffer_load_dwordx4 v1,s[8:11],s21 offen offset:3072 nt lds
v_fma_f32 v211,v211,s26,-v20
v_mfma_f32_16x16x32_bf16 v[168:171],a[108:111],a[28:31],0
s_add_u32 s21,s21,16384
ds_read_b128 a[132:135],v3 offset:2048
v_mfma_f32_16x16x32_bf16 v[168:171],a[104:107],a[24:27],v[168:171]
v_exp_f32 v209,v209
v_mfma_f32_16x16x32_bf16 v[168:171],a[100:103],a[20:23],v[168:171]
v_exp_f32 v210,v210
v_mfma_f32_16x16x32_bf16 v[168:171],a[96:99],a[16:19],v[168:171]
v_exp_f32 v211,v211
v_cvt_pk_bf16_f32 v244,v208,v209
v_fma_f32 v212,v212,s26,-v20
v_mfma_f32_16x16x32_bf16 v[176:179],a[96:99],a[32:35],0
ds_read_b128 a[136:139],v4 offset:2048
v_cvt_pk_bf16_f32 v245,v210,v211
v_mfma_f32_16x16x32_bf16 v[176:179],a[100:103],a[36:39],v[176:179]
v_exp_f32 v212,v212
v_mfma_f32_16x16x32_bf16 v[176:179],a[104:107],a[40:43],v[176:179]
v_fma_f32 v213,v213,s26,-v20
v_fma_f32 v214,v214,s26,-v20
v_mfma_f32_16x16x32_bf16 v[176:179],a[108:111],a[44:47],v[176:179]
ds_read_b128 a[140:143],v5 offset:2048
v_exp_f32 v213,v213
s_waitcnt lgkmcnt(8)
v_mfma_f32_16x16x32_bf16 v[184:187],a[108:111],a[60:63],0
v_exp_f32 v214,v214
v_mfma_f32_16x16x32_bf16 v[184:187],a[104:107],a[56:59],v[184:187]
v_cvt_pk_bf16_f32 v246,v212,v213
v_fma_f32 v215,v215,s26,-v20
v_mfma_f32_16x16x32_bf16 v[184:187],a[100:103],a[52:55],v[184:187]
s_waitcnt lgkmcnt(4)
v_exp_f32 v215,v215
v_mfma_f32_16x16x32_bf16 v[184:187],a[96:99],a[48:51],v[184:187]
ds_read_b128 a[144:147],v2 offset:3072
v_cvt_pk_bf16_f32 v247,v214,v215
v_fma_f32 v216,v216,s26,-v21
v_mfma_f32_16x16x32_bf16 v[164:167],a[112:115],a[0:3],0
v_exp_f32 v216,v216
v_mfma_f32_16x16x32_bf16 v[164:167],a[116:119],a[4:7],v[164:167]
v_fma_f32 v217,v217,s26,-v21
v_fma_f32 v218,v218,s26,-v21
v_mfma_f32_16x16x32_bf16 v[164:167],a[120:123],a[8:11],v[164:167]
v_exp_f32 v217,v217
v_mfma_f32_16x16x32_bf16 v[164:167],a[124:127],a[12:15],v[164:167]
ds_read_b128 a[148:151],v3 offset:3072
v_exp_f32 v218,v218
v_mfma_f32_16x16x32_bf16 v[172:175],a[124:127],a[28:31],0
v_cvt_pk_bf16_f32 v252,v216,v217
v_fma_f32 v219,v219,s26,-v21
v_mfma_f32_16x16x32_bf16 v[172:175],a[120:123],a[24:27],v[172:175]
v_exp_f32 v219,v219
v_mfma_f32_16x16x32_bf16 v[172:175],a[116:119],a[20:23],v[172:175]
s_add_u32 m0,s25,81920
ds_read_b128 a[152:155],v4 offset:3072
v_mfma_f32_16x16x32_bf16 v[172:175],a[112:115],a[16:19],v[172:175]
buffer_load_dwordx4 v1,s[12:15],s22 offen nt lds
v_cvt_pk_bf16_f32 v253,v218,v219
v_mfma_f32_16x16x32_bf16 v[180:183],a[112:115],a[32:35],0
v_fma_f32 v220,v220,s26,-v21
v_fma_f32 v221,v221,s26,-v21
v_mfma_f32_16x16x32_bf16 v[180:183],a[116:119],a[36:39],v[180:183]
v_exp_f32 v220,v220
v_mfma_f32_16x16x32_bf16 v[180:183],a[120:123],a[40:43],v[180:183]
ds_read_b128 a[156:159],v5 offset:3072
v_fma_f32 v222,v222,s26,-v21
v_mfma_f32_16x16x32_bf16 v[180:183],a[124:127],a[44:47],v[180:183]
v_exp_f32 v221,v221
v_fma_f32 v223,v223,s26,-v21
v_mfma_f32_16x16x32_bf16 v[188:191],a[124:127],a[60:63],0
v_exp_f32 v222,v222
v_mfma_f32_16x16x32_bf16 v[188:191],a[120:123],a[56:59],v[188:191]
v_exp_f32 v223,v223
v_mfma_f32_16x16x32_bf16 v[188:191],a[116:119],a[52:55],v[188:191]
v_cvt_pk_bf16_f32 v254,v220,v221
v_cvt_pk_bf16_f32 v255,v222,v223
v_mfma_f32_16x16x32_bf16 v[188:191],a[112:115],a[48:51],v[188:191]
s_waitcnt lgkmcnt(4)
v_mfma_f32_16x16x32_bf16 v[192:195],a[128:131],a[0:3],0
ds_write_b128 v10,v[128:131] offset:16384
v_accvgpr_write_b32 a64,v96
v_mfma_f32_16x16x32_bf16 v[192:195],a[132:135],a[4:7],v[192:195]
v_accvgpr_write_b32 a65,v97
v_accvgpr_write_b32 a66,v98
v_mfma_f32_16x16x32_bf16 v[192:195],a[136:139],a[8:11],v[192:195]
v_accvgpr_write_b32 a67,v99
v_accvgpr_write_b32 a68,v100
v_mfma_f32_16x16x32_bf16 v[192:195],a[140:143],a[12:15],v[192:195]
buffer_load_dwordx4 v1,s[12:15],s22 offen offset:1024 nt lds
v_max3_f32 v23,v160,v161,v162
v_max3_f32 v24,v168,v169,v170
v_max3_f32 v25,v176,v177,v178
v_max3_f32 v26,v184,v185,v186
v_accvgpr_write_b32 a69,v101
v_mfma_f32_16x16x32_bf16 v[200:203],a[140:143],a[28:31],0
ds_write_b128 v11,v[132:135] offset:16384
v_max3_f32 v23,v23,v163,v164
v_mfma_f32_16x16x32_bf16 v[200:203],a[136:139],a[24:27],v[200:203]
ds_read_b64_tr_b16 a[96:97],v6 offset:49152
v_max3_f32 v24,v24,v171,v172
v_mfma_f32_16x16x32_bf16 v[200:203],a[132:135],a[20:23],v[200:203]
ds_read_b64_tr_b16 a[98:99],v6 offset:50176
v_max3_f32 v25,v25,v179,v180
v_mfma_f32_16x16x32_bf16 v[200:203],a[128:131],a[16:19],v[200:203]
ds_write_b128 v12,v[136:139] offset:16384
v_max3_f32 v26,v26,v187,v188
v_max3_f32 v23,v23,v165,v166
v_max3_f32 v24,v24,v173,v174
v_max3_f32 v25,v25,v181,v182
v_accvgpr_write_b32 a70,v102
v_accvgpr_write_b32 a71,v103
v_mfma_f32_16x16x32_bf16 v[208:211],a[128:131],a[32:35],0
ds_read_b64_tr_b16 a[100:101],v6 offset:51200
v_max3_f32 v26,v26,v189,v190
v_mfma_f32_16x16x32_bf16 v[208:211],a[132:135],a[36:39],v[208:211]
ds_read_b64_tr_b16 a[102:103],v6 offset:52224
v_max_f32 v23,v23,v167
v_mfma_f32_16x16x32_bf16 v[208:211],a[136:139],a[40:43],v[208:211]
ds_write_b128 v13,v[140:143] offset:16384
v_max_f32 v24,v24,v175
v_mfma_f32_16x16x32_bf16 v[208:211],a[140:143],a[44:47],v[208:211]
buffer_load_dwordx4 v1,s[12:15],s22 offen offset:2048 nt lds
v_max_f32 v25,v25,v183
v_max_f32 v26,v26,v191
v_mov_b32 v27,v23
v_mov_b32 v28,v24
v_accvgpr_write_b32 a72,v104
v_mfma_f32_16x16x32_bf16 v[216:219],a[140:143],a[60:63],0
ds_read_b64_tr_b16 a[104:105],v6 offset:49160
v_mov_b32 v29,v25
v_mfma_f32_16x16x32_bf16 v[216:219],a[136:139],a[56:59],v[216:219]
ds_read_b64_tr_b16 a[106:107],v6 offset:50184
v_mov_b32 v30,v26
v_mfma_f32_16x16x32_bf16 v[216:219],a[132:135],a[52:55],v[216:219]
ds_write_b128 v10,v[144:147] offset:0
v_permlane16_swap_b32 v23,v27
v_mfma_f32_16x16x32_bf16 v[216:219],a[128:131],a[48:51],v[216:219]
s_waitcnt lgkmcnt(11)
v_permlane16_swap_b32 v24,v28
v_permlane16_swap_b32 v25,v29
v_permlane16_swap_b32 v26,v30
v_max_f32 v23,v23,v27
v_accvgpr_write_b32 a73,v105
v_accvgpr_write_b32 a74,v106
v_mfma_f32_16x16x32_bf16 v[196:199],a[144:147],a[0:3],0
ds_read_b64_tr_b16 a[108:109],v6 offset:51208
v_max_f32 v24,v24,v28
v_mfma_f32_16x16x32_bf16 v[196:199],a[148:151],a[4:7],v[196:199]
ds_read_b64_tr_b16 a[110:111],v6 offset:52232
v_max_f32 v25,v25,v29
v_mfma_f32_16x16x32_bf16 v[196:199],a[152:155],a[8:11],v[196:199]
ds_write_b128 v11,v[148:151] offset:0
v_max_f32 v26,v26,v30
v_mfma_f32_16x16x32_bf16 v[196:199],a[156:159],a[12:15],v[196:199]
ds_read_b64_tr_b16 a[112:113],v7 offset:49152
v_mov_b32 v27,v23
v_mov_b32 v28,v24
v_mov_b32 v29,v25
v_mov_b32 v30,v26
v_accvgpr_write_b32 a75,v107
v_accvgpr_write_b32 a76,v108
v_mfma_f32_16x16x32_bf16 v[204:207],a[156:159],a[28:31],0
s_waitcnt lgkmcnt(14)
ds_read_b64_tr_b16 a[114:115],v7 offset:50176
v_permlane32_swap_b32 v23,v27
v_mfma_f32_16x16x32_bf16 v[204:207],a[152:155],a[24:27],v[204:207]
s_waitcnt lgkmcnt(14)
ds_write_b128 v12,v[152:155] offset:0
v_permlane32_swap_b32 v24,v28
v_mfma_f32_16x16x32_bf16 v[204:207],a[148:151],a[20:23],v[204:207]
v_permlane32_swap_b32 v25,v29
v_permlane32_swap_b32 v26,v30
v_mfma_f32_16x16x32_bf16 v[204:207],a[144:147],a[16:19],v[204:207]
s_waitcnt lgkmcnt(14)
ds_read_b64_tr_b16 a[116:117],v7 offset:51200
v_max_f32 v23,v23,v27
v_max_f32 v24,v24,v28
v_max_f32 v25,v25,v29
v_max_f32 v26,v26,v30
v_accvgpr_write_b32 a77,v109
v_accvgpr_write_b32 a78,v110
v_mfma_f32_16x16x32_bf16 v[212:215],a[144:147],a[32:35],0
s_waitcnt lgkmcnt(14)
ds_read_b64_tr_b16 a[118:119],v7 offset:52224
v_mul_f32 v18,s26,v23
v_mfma_f32_16x16x32_bf16 v[212:215],a[148:151],a[36:39],v[212:215]
s_waitcnt lgkmcnt(14)
ds_write_b128 v13,v[156:159] offset:0
v_mul_f32 v19,s26,v24
v_mfma_f32_16x16x32_bf16 v[212:215],a[152:155],a[40:43],v[212:215]
v_mul_f32 v20,s26,v25
v_mul_f32 v21,s26,v26
v_mfma_f32_16x16x32_bf16 v[212:215],a[156:159],a[44:47],v[212:215]
s_waitcnt lgkmcnt(14)
ds_read_b64_tr_b16 a[120:121],v7 offset:49160
v_fma_f32 v160,v160,s26,-v18
v_fma_f32 v161,v161,s26,-v18
v_fma_f32 v162,v162,s26,-v18
v_fma_f32 v163,v163,s26,-v18
v_fma_f32 v164,v164,s26,-v18
v_fma_f32 v165,v165,s26,-v18
v_mfma_f32_16x16x32_bf16 v[220:223],a[156:159],a[60:63],0
s_waitcnt lgkmcnt(14)
ds_read_b64_tr_b16 a[122:123],v7 offset:50184
v_fma_f32 v166,v166,s26,-v18
v_mfma_f32_16x16x32_bf16 v[220:223],a[152:155],a[56:59],v[220:223]
v_exp_f32 v160,v160
v_mfma_f32_16x16x32_bf16 v[220:223],a[148:151],a[52:55],v[220:223]
s_waitcnt lgkmcnt(14)
ds_read_b64_tr_b16 a[124:125],v7 offset:51208
v_fma_f32 v167,v167,s26,-v18
v_mfma_f32_16x16x32_bf16 v[220:223],a[144:147],a[48:51],v[220:223]
s_waitcnt lgkmcnt(14)
ds_read_b64_tr_b16 a[126:127],v7 offset:52232
v_exp_f32 v161,v161
v_exp_f32 v162,v162
v_exp_f32 v163,v163
v_mfma_f32_16x16x32_bf16 a[224:227],a[240:243],v[224:227],a[224:227]
v_exp_f32 v164,v164
v_mfma_f32_16x16x32_bf16 a[224:227],a[240:243],v[228:231],a[224:227]
buffer_load_dwordx4 v1,s[12:15],s22 offen offset:3072 nt lds
v_cvt_pk_bf16_f32 v160,v160,v161
v_exp_f32 v165,v165
v_exp_f32 v166,v166
v_mfma_f32_16x16x32_bf16 a[228:231],a[240:243],v[232:235],a[228:231]
s_add_u32 s22,s22,16384
s_waitcnt lgkmcnt(14)
ds_read_b64_tr_b16 a[128:129],v8 offset:49152
v_mfma_f32_16x16x32_bf16 a[228:231],a[240:243],v[236:239],a[228:231]
s_waitcnt lgkmcnt(14)
ds_read_b64_tr_b16 a[130:131],v8 offset:50176
v_cvt_pk_bf16_f32 v161,v162,v163
v_exp_f32 v167,v167
v_cvt_pk_bf16_f32 v162,v164,v165
v_fma_f32 v168,v168,s26,-v19
v_mfma_f32_16x16x32_bf16 a[232:235],a[240:243],v[240:243],a[232:235]
v_exp_f32 v168,v168
v_mfma_f32_16x16x32_bf16 a[232:235],a[240:243],v[244:247],a[232:235]
v_fma_f32 v169,v169,s26,-v19
v_cvt_pk_bf16_f32 v163,v166,v167
v_accvgpr_write_b32 a79,v111
v_fma_f32 v170,v170,s26,-v19
v_fma_f32 v171,v171,s26,-v19
v_accvgpr_write_b32 a80,v112
v_fma_f32 v172,v172,s26,-v19
v_mfma_f32_16x16x32_bf16 a[236:239],a[240:243],v[248:251],a[236:239]
s_waitcnt lgkmcnt(14)
ds_read_b64_tr_b16 a[132:133],v8 offset:51200
v_fma_f32 v173,v173,s26,-v19
v_mfma_f32_16x16x32_bf16 a[236:239],a[240:243],v[252:255],a[236:239]
s_waitcnt lgkmcnt(14)
ds_read_b64_tr_b16 a[134:135],v8 offset:52224
v_exp_f32 v169,v169
v_exp_f32 v170,v170
v_exp_f32 v171,v171
v_mfma_f32_16x16x32_bf16 v[80:83],a[96:99],v[248:251],v[80:83]
v_exp_f32 v172,v172
v_mfma_f32_16x16x32_bf16 v[80:83],a[100:103],v[252:255],v[80:83]
s_waitcnt lgkmcnt(14)
ds_read_b64_tr_b16 a[136:137],v8 offset:49160
v_exp_f32 v173,v173
v_cvt_pk_bf16_f32 v168,v168,v169
v_accvgpr_write_b32 a81,v113
v_cvt_pk_bf16_f32 v169,v170,v171
v_accvgpr_write_b32 a82,v114
v_mfma_f32_16x16x32_bf16 v[64:67],a[100:103],v[244:247],v[64:67]
s_waitcnt lgkmcnt(14)
ds_read_b64_tr_b16 a[138:139],v8 offset:50184
v_accvgpr_read_b32 v14,a224
v_mfma_f32_16x16x32_bf16 v[64:67],a[96:99],v[240:243],v[64:67]
v_fma_f32 v174,v174,s26,-v19
v_fma_f32 v175,v175,s26,-v19
v_accvgpr_read_b32 v15,a228
v_cvt_pk_bf16_f32 v170,v172,v173
v_accvgpr_write_b32 a83,v115
v_fma_f32 v176,v176,s26,-v20
v_fma_f32 v177,v177,s26,-v20
v_mfma_f32_16x16x32_bf16 v[48:51],a[96:99],v[232:235],v[48:51]
v_exp_f32 v174,v174
v_mfma_f32_16x16x32_bf16 v[48:51],a[100:103],v[236:239],v[48:51]
s_waitcnt lgkmcnt(14)
ds_read_b64_tr_b16 a[140:141],v8 offset:51208
v_exp_f32 v175,v175
v_exp_f32 v176,v176
v_exp_f32 v177,v177
v_mfma_f32_16x16x32_bf16 v[32:35],a[100:103],v[228:231],v[32:35]
s_waitcnt lgkmcnt(14)
ds_read_b64_tr_b16 a[142:143],v8 offset:52232
v_accvgpr_read_b32 v16,a232
v_mfma_f32_16x16x32_bf16 v[32:35],a[96:99],v[224:227],v[32:35]
v_accvgpr_write_b32 a84,v116
v_cvt_pk_bf16_f32 v171,v174,v175
v_accvgpr_read_b32 v17,a236
v_accvgpr_write_b32 a85,v117
v_fma_f32 v178,v178,s26,-v20
v_fma_f32 v179,v179,s26,-v20
v_cvt_pk_bf16_f32 v176,v176,v177
v_mfma_f32_16x16x32_bf16 v[36:39],a[104:107],v[224:227],v[36:39]
v_exp_f32 v178,v178
v_mfma_f32_16x16x32_bf16 v[36:39],a[108:111],v[228:231],v[36:39]
s_waitcnt lgkmcnt(14)
ds_read_b64_tr_b16 a[144:145],v9 offset:49152
v_add_f32 v31,v14,v15
v_exp_f32 v179,v179
v_accvgpr_write_b32 a86,v118
v_fma_f32 v180,v180,s26,-v20
v_mfma_f32_16x16x32_bf16 v[52:55],a[108:111],v[236:239],v[52:55]
s_waitcnt lgkmcnt(14)
ds_read_b64_tr_b16 a[146:147],v9 offset:50176
v_add_f32 v31,v31,v16
v_mfma_f32_16x16x32_bf16 v[52:55],a[104:107],v[232:235],v[52:55]
v_fma_f32 v181,v181,s26,-v20
v_exp_f32 v180,v180
v_accvgpr_write_b32 a87,v119
v_cvt_pk_bf16_f32 v177,v178,v179
v_add_f32 v31,v31,v17
v_accvgpr_write_b32 a88,v120
v_mfma_f32_16x16x32_bf16 v[68:71],a[104:107],v[240:243],v[68:71]
s_waitcnt lgkmcnt(14)
ds_read_b64_tr_b16 a[148:149],v9 offset:51200
v_cmp_nge_f32 vcc,s27,v31
v_mfma_f32_16x16x32_bf16 v[68:71],a[108:111],v[244:247],v[68:71]
s_waitcnt lgkmcnt(14)
ds_read_b64_tr_b16 a[150:151],v9 offset:52224
v_exp_f32 v181,v181
v_rcp_f32 v14,v14
v_fma_f32 v182,v182,s26,-v20
v_fma_f32 v183,v183,s26,-v20
v_mfma_f32_16x16x32_bf16 v[84:87],a[108:111],v[252:255],v[84:87]
v_exp_f32 v182,v182
v_mfma_f32_16x16x32_bf16 v[84:87],a[104:107],v[248:251],v[84:87]
v_cvt_pk_bf16_f32 v178,v180,v181
v_exp_f32 v183,v183
v_rcp_f32 v15,v15
v_accvgpr_write_b32 a89,v121
v_fma_f32 v184,v184,s26,-v21
v_mfma_f32_16x16x32_bf16 v[88:91],a[112:115],v[248:251],v[88:91]
s_waitcnt lgkmcnt(14)
ds_read_b64_tr_b16 a[152:153],v9 offset:49160
v_fma_f32 v185,v185,s26,-v21
v_mfma_f32_16x16x32_bf16 v[88:91],a[116:119],v[252:255],v[88:91]
s_waitcnt lgkmcnt(14)
ds_read_b64_tr_b16 a[154:155],v9 offset:50184
v_exp_f32 v184,v184
v_exp_f32 v185,v185
v_rcp_f32 v16,v16
v_mfma_f32_16x16x32_bf16 v[72:75],a[116:119],v[244:247],v[72:75]
v_rcp_f32 v17,v17
v_mfma_f32_16x16x32_bf16 v[72:75],a[112:115],v[240:243],v[72:75]
s_waitcnt lgkmcnt(14)
ds_read_b64_tr_b16 a[156:157],v9 offset:51208
s_cmp_lg_u64 vcc,0
s_cselect_b32 s32,s29,0
s_or_b32 s28,s28,s32
s_lshl_b32 s29,s29,1
v_accvgpr_write_b32 a90,v122
v_cvt_pk_bf16_f32 v179,v182,v183
v_accvgpr_write_b32 a91,v123
v_fma_f32 v186,v186,s26,-v21
v_mfma_f32_16x16x32_bf16 v[56:59],a[112:115],v[232:235],v[56:59]
s_waitcnt lgkmcnt(14)
ds_read_b64_tr_b16 a[158:159],v9 offset:52232
v_fma_f32 v187,v187,s26,-v21
v_mfma_f32_16x16x32_bf16 v[56:59],a[116:119],v[236:239],v[56:59]
v_exp_f32 v186,v186
v_exp_f32 v187,v187
v_cvt_pk_bf16_f32 v184,v184,v185
v_accvgpr_write_b32 a92,v124
v_mfma_f32_16x16x32_bf16 v[40:43],a[116:119],v[228:231],v[40:43]
v_fma_f32 v188,v188,s26,-v21
v_fma_f32 v189,v189,s26,-v21
v_mfma_f32_16x16x32_bf16 v[40:43],a[112:115],v[224:227],v[40:43]
v_accvgpr_write_b32 a93,v125
v_exp_f32 v188,v188
v_exp_f32 v189,v189
v_cvt_pk_bf16_f32 v185,v186,v187
v_accvgpr_write_b32 a94,v126
v_mfma_f32_16x16x32_bf16 v[44:47],a[120:123],v[224:227],v[44:47]
v_fma_f32 v190,v190,s26,-v21
v_fma_f32 v191,v191,s26,-v21
v_mfma_f32_16x16x32_bf16 v[44:47],a[124:127],v[228:231],v[44:47]
v_cvt_pk_bf16_f32 v186,v188,v189
v_exp_f32 v190,v190
v_exp_f32 v191,v191
v_accvgpr_write_b32 a95,v127
v_mfma_f32_16x16x32_bf16 v[60:63],a[124:127],v[236:239],v[60:63]
v_cvt_pk_bf16_f32 v187,v190,v191
v_mfma_f32_16x16x32_bf16 v[60:63],a[120:123],v[232:235],v[60:63]
v_mfma_f32_16x16x32_bf16 v[76:79],a[120:123],v[240:243],v[76:79]
v_fma_f32 v192,v192,s26,-v18
v_fma_f32 v193,v193,s26,-v18
v_mfma_f32_16x16x32_bf16 v[76:79],a[124:127],v[244:247],v[76:79]
v_exp_f32 v192,v192
v_exp_f32 v193,v193
v_fma_f32 v194,v194,s26,-v18
v_fma_f32 v195,v195,s26,-v18
v_mul_f32 v32,v32,v14
v_mul_f32 v33,v33,v14
v_mul_f32 v34,v34,v14
v_mul_f32 v35,v35,v14
v_mfma_f32_16x16x32_bf16 v[92:95],a[124:127],v[252:255],v[92:95]
v_exp_f32 v194,v194
v_mfma_f32_16x16x32_bf16 v[92:95],a[120:123],v[248:251],v[92:95]
s_waitcnt lgkmcnt(12)
v_cvt_pk_bf16_f32 v164,v192,v193
v_exp_f32 v195,v195
v_fma_f32 v200,v200,s26,-v19
v_fma_f32 v201,v201,s26,-v19
v_cvt_pk_bf16_f32 v96,v32,v33
v_mul_f32 v36,v36,v14
v_mul_f32 v37,v37,v14
v_cvt_pk_bf16_f32 v97,v34,v35
v_mfma_f32_16x16x32_bf16 a[208:211],a[128:131],v[248:251],a[208:211]
v_exp_f32 v200,v200
v_mfma_f32_16x16x32_bf16 a[208:211],a[132:135],v[252:255],a[208:211]
v_exp_f32 v201,v201
v_cvt_pk_bf16_f32 v165,v194,v195
v_mul_f32 v38,v38,v14
v_mul_f32 v39,v39,v14
v_cvt_pk_bf16_f32 v98,v36,v37
v_mul_f32 v40,v40,v14
v_mul_f32 v41,v41,v14
v_mul_f32 v42,v42,v14
v_mul_f32 v43,v43,v14
v_mfma_f32_16x16x32_bf16 a[192:195],a[132:135],v[244:247],a[192:195]
v_cvt_pk_bf16_f32 v99,v38,v39
v_cvt_pk_bf16_f32 v172,v200,v201
v_mfma_f32_16x16x32_bf16 a[192:195],a[128:131],v[240:243],a[192:195]
s_waitcnt vmcnt(12)
s_waitcnt lgkmcnt(0)
s_barrier
ds_read_b128 a[96:99],v2 offset:16384
v_cvt_pk_bf16_f32 v100,v40,v41
v_mul_f32 v44,v44,v14
v_mul_f32 v45,v45,v14
v_fma_f32 v202,v202,s26,-v19
v_fma_f32 v203,v203,s26,-v19
v_cvt_pk_bf16_f32 v101,v42,v43
v_mul_f32 v46,v46,v14
v_mul_f32 v47,v47,v14
v_mul_f32 v48,v48,v15
v_mfma_f32_16x16x32_bf16 a[176:179],a[128:131],v[232:235],a[176:179]
s_add_u32 m0,s25,49152
v_exp_f32 v202,v202
v_mfma_f32_16x16x32_bf16 a[176:179],a[132:135],v[236:239],a[176:179]
buffer_load_dwordx4 v1,s[8:11],s21 offen nt lds
v_cvt_pk_bf16_f32 v102,v44,v45
v_exp_f32 v203,v203
v_mul_f32 v49,v49,v15
v_cvt_pk_bf16_f32 v103,v46,v47
v_mul_f32 v50,v50,v15
v_mul_f32 v51,v51,v15
v_mfma_f32_16x16x32_bf16 a[160:163],a[132:135],v[228:231],a[160:163]
v_cvt_pk_bf16_f32 v173,v202,v203
v_cvt_pk_bf16_f32 v112,v48,v49
v_mfma_f32_16x16x32_bf16 a[160:163],a[128:131],v[224:227],a[160:163]
ds_read_b128 a[100:103],v3 offset:16384
v_mul_f32 v52,v52,v15
v_mul_f32 v53,v53,v15
v_fma_f32 v208,v208,s26,-v20
v_fma_f32 v209,v209,s26,-v20
v_cvt_pk_bf16_f32 v113,v50,v51
v_mul_f32 v54,v54,v15
v_mul_f32 v55,v55,v15
v_mul_f32 v56,v56,v15
v_mul_f32 v57,v57,v15
v_mfma_f32_16x16x32_bf16 a[164:167],a[136:139],v[224:227],a[164:167]
v_exp_f32 v208,v208
v_mfma_f32_16x16x32_bf16 a[164:167],a[140:143],v[228:231],a[164:167]
buffer_load_dwordx4 v1,s[8:11],s21 offen offset:1024 nt lds
v_exp_f32 v209,v209
v_cvt_pk_bf16_f32 v114,v52,v53
v_cvt_pk_bf16_f32 v115,v54,v55
v_mul_f32 v58,v58,v15
v_mul_f32 v59,v59,v15
v_cvt_pk_bf16_f32 v116,v56,v57
v_mul_f32 v60,v60,v15
v_mfma_f32_16x16x32_bf16 a[180:183],a[140:143],v[236:239],a[180:183]
ds_read_b128 a[104:107],v4 offset:16384
v_mul_f32 v61,v61,v15
v_mfma_f32_16x16x32_bf16 a[180:183],a[136:139],v[232:235],a[180:183]
v_cvt_pk_bf16_f32 v180,v208,v209
v_cvt_pk_bf16_f32 v117,v58,v59
v_fma_f32 v210,v210,s26,-v20
v_fma_f32 v211,v211,s26,-v20
v_mul_f32 v62,v62,v15
v_mul_f32 v63,v63,v15
v_cvt_pk_bf16_f32 v118,v60,v61
v_mul_f32 v64,v64,v16
v_mul_f32 v65,v65,v16
v_mfma_f32_16x16x32_bf16 a[196:199],a[136:139],v[240:243],a[196:199]
v_exp_f32 v210,v210
v_mfma_f32_16x16x32_bf16 a[196:199],a[140:143],v[244:247],a[196:199]
buffer_load_dwordx4 v1,s[8:11],s21 offen offset:2048 nt lds
v_exp_f32 v211,v211
v_cvt_pk_bf16_f32 v119,v62,v63
v_mul_f32 v66,v66,v16
v_mul_f32 v67,v67,v16
v_cvt_pk_bf16_f32 v128,v64,v65
v_mul_f32 v68,v68,v16
v_mul_f32 v69,v69,v16
v_mfma_f32_16x16x32_bf16 a[212:215],a[140:143],v[252:255],a[212:215]
ds_read_b128 a[108:111],v5 offset:16384
v_cvt_pk_bf16_f32 v181,v210,v211
v_mfma_f32_16x16x32_bf16 a[212:215],a[136:139],v[248:251],a[212:215]
v_cvt_pk_bf16_f32 v129,v66,v67
v_mul_f32 v70,v70,v16
v_mul_f32 v71,v71,v16
v_fma_f32 v216,v216,s26,-v21
v_fma_f32 v217,v217,s26,-v21
v_cvt_pk_bf16_f32 v130,v68,v69
v_mul_f32 v72,v72,v16
v_mul_f32 v73,v73,v16
v_mul_f32 v74,v74,v16
v_mul_f32 v75,v75,v16
v_mfma_f32_16x16x32_bf16 a[216:219],a[144:147],v[248:251],a[216:219]
v_exp_f32 v216,v216
v_mfma_f32_16x16x32_bf16 a[216:219],a[148:151],v[252:255],a[216:219]
buffer_load_dwordx4 v1,s[8:11],s21 offen offset:3072 nt lds
v_cvt_pk_bf16_f32 v131,v70,v71
v_exp_f32 v217,v217
v_cvt_pk_bf16_f32 v132,v72,v73
v_mul_f32 v76,v76,v16
v_mul_f32 v77,v77,v16
v_cvt_pk_bf16_f32 v133,v74,v75
v_mfma_f32_16x16x32_bf16 a[200:203],a[148:151],v[244:247],a[200:203]
s_add_u32 s21,s21,16384
ds_read_b128 a[112:115],v2 offset:17408
v_mfma_f32_16x16x32_bf16 a[200:203],a[144:147],v[240:243],a[200:203]
v_cvt_pk_bf16_f32 v188,v216,v217
v_mul_f32 v78,v78,v16
v_mul_f32 v79,v79,v16
v_fma_f32 v218,v218,s26,-v21
v_fma_f32 v219,v219,s26,-v21
v_cvt_pk_bf16_f32 v134,v76,v77
v_mul_f32 v80,v80,v17
v_mul_f32 v81,v81,v17
v_mul_f32 v82,v82,v17
v_mul_f32 v83,v83,v17
v_mfma_f32_16x16x32_bf16 a[184:187],a[144:147],v[232:235],a[184:187]
v_exp_f32 v218,v218
v_mfma_f32_16x16x32_bf16 a[184:187],a[148:151],v[236:239],a[184:187]
ds_read_b128 a[116:119],v3 offset:17408
v_exp_f32 v219,v219
v_cvt_pk_bf16_f32 v135,v78,v79
v_cvt_pk_bf16_f32 v144,v80,v81
v_mul_f32 v84,v84,v17
v_mul_f32 v85,v85,v17
v_cvt_pk_bf16_f32 v145,v82,v83
v_mul_f32 v86,v86,v17
v_mfma_f32_16x16x32_bf16 a[168:171],a[148:151],v[228:231],a[168:171]
v_mul_f32 v87,v87,v17
v_cvt_pk_bf16_f32 v189,v218,v219
v_mfma_f32_16x16x32_bf16 a[168:171],a[144:147],v[224:227],a[168:171]
v_cvt_pk_bf16_f32 v146,v84,v85
v_mul_f32 v88,v88,v17
v_mul_f32 v89,v89,v17
v_fma_f32 v196,v196,s26,-v18
v_fma_f32 v197,v197,s26,-v18
v_cvt_pk_bf16_f32 v147,v86,v87
v_mul_f32 v90,v90,v17
v_mul_f32 v91,v91,v17
v_mul_f32 v92,v92,v17
v_mul_f32 v93,v93,v17
v_mfma_f32_16x16x32_bf16 a[172:175],a[152:155],v[224:227],a[172:175]
v_exp_f32 v196,v196
v_mfma_f32_16x16x32_bf16 a[172:175],a[156:159],v[228:231],a[172:175]
ds_read_b128 a[120:123],v4 offset:17408
v_cvt_pk_bf16_f32 v148,v88,v89
v_exp_f32 v197,v197
v_cvt_pk_bf16_f32 v149,v90,v91
v_mul_f32 v94,v94,v17
v_mul_f32 v95,v95,v17
v_cvt_pk_bf16_f32 v150,v92,v93
v_accvgpr_read_b32 v32,a160
v_fma_f32 v198,v198,s26,-v18
v_mfma_f32_16x16x32_bf16 a[188:191],a[156:159],v[236:239],a[188:191]
s_add_u32 m0,s25,98304
v_exp_f32 v198,v198
v_mfma_f32_16x16x32_bf16 a[188:191],a[152:155],v[232:235],a[188:191]
buffer_load_dwordx4 v1,s[12:15],s22 offen nt lds
v_cvt_pk_bf16_f32 v166,v196,v197
v_fma_f32 v199,v199,s26,-v18
v_accvgpr_read_b32 v33,a161
v_cvt_pk_bf16_f32 v151,v94,v95
v_accvgpr_read_b32 v34,a162
v_accvgpr_read_b32 v35,a163
v_mul_f32 v32,v32,v14
v_mfma_f32_16x16x32_bf16 a[204:207],a[152:155],v[240:243],a[204:207]
v_exp_f32 v199,v199
v_mfma_f32_16x16x32_bf16 a[204:207],a[156:159],v[244:247],a[204:207]
ds_read_b128 a[124:127],v5 offset:17408
v_mul_f32 v33,v33,v14
v_accvgpr_read_b32 v36,a164
v_accvgpr_read_b32 v37,a165
v_mul_f32 v34,v34,v14
v_mul_f32 v35,v35,v14
v_cvt_pk_bf16_f32 v167,v198,v199
v_accvgpr_read_b32 v38,a166
v_fma_f32 v204,v204,s26,-v19
v_fma_f32 v205,v205,s26,-v19
v_mfma_f32_16x16x32_bf16 a[220:223],a[156:159],v[252:255],a[220:223]
v_exp_f32 v204,v204
v_mfma_f32_16x16x32_bf16 a[220:223],a[152:155],v[248:251],a[220:223]
s_waitcnt lgkmcnt(4)
v_exp_f32 v205,v205
v_cvt_pk_bf16_f32 v104,v32,v33
v_accvgpr_read_b32 v39,a167
v_mul_f32 v36,v36,v14
v_mul_f32 v37,v37,v14
v_cvt_pk_bf16_f32 v105,v34,v35
v_accvgpr_read_b32 v40,a168
v_accvgpr_read_b32 v41,a169
v_mul_f32 v38,v38,v14
v_mfma_f32_16x16x32_bf16 v[224:227],a[96:99],a[0:3],0
ds_read_b128 a[128:131],v2 offset:18432
v_mul_f32 v39,v39,v14
v_mfma_f32_16x16x32_bf16 v[224:227],a[100:103],a[4:7],v[224:227]
v_cvt_pk_bf16_f32 v106,v36,v37
v_accvgpr_read_b32 v42,a170
v_mfma_f32_16x16x32_bf16 v[224:227],a[104:107],a[8:11],v[224:227]
v_cvt_pk_bf16_f32 v174,v204,v205
v_accvgpr_read_b32 v43,a171
v_mfma_f32_16x16x32_bf16 v[224:227],a[108:111],a[12:15],v[224:227]
buffer_load_dwordx4 v1,s[12:15],s22 offen offset:1024 nt lds
v_mul_f32 v40,v40,v14
v_mul_f32 v41,v41,v14
v_cvt_pk_bf16_f32 v107,v38,v39
v_fma_f32 v206,v206,s26,-v19
v_fma_f32 v207,v207,s26,-v19
v_accvgpr_read_b32 v44,a172
v_accvgpr_read_b32 v45,a173
v_mfma_f32_16x16x32_bf16 v[232:235],a[108:111],a[28:31],0
ds_read_b128 a[132:135],v3 offset:18432
v_mul_f32 v42,v42,v14
v_mfma_f32_16x16x32_bf16 v[232:235],a[104:107],a[24:27],v[232:235]
v_exp_f32 v206,v206
v_mfma_f32_16x16x32_bf16 v[232:235],a[100:103],a[20:23],v[232:235]
v_exp_f32 v207,v207
v_mfma_f32_16x16x32_bf16 v[232:235],a[96:99],a[16:19],v[232:235]
buffer_load_dwordx4 v1,s[12:15],s22 offen offset:2048 nt lds
v_mul_f32 v43,v43,v14
v_cvt_pk_bf16_f32 v108,v40,v41
v_accvgpr_read_b32 v46,a174
v_accvgpr_read_b32 v47,a175
v_mul_f32 v44,v44,v14
v_mul_f32 v45,v45,v14
v_accvgpr_read_b32 v48,a176
v_cvt_pk_bf16_f32 v175,v206,v207
v_mfma_f32_16x16x32_bf16 v[240:243],a[96:99],a[32:35],0
ds_read_b128 a[136:139],v4 offset:18432
v_cvt_pk_bf16_f32 v109,v42,v43
v_mfma_f32_16x16x32_bf16 v[240:243],a[100:103],a[36:39],v[240:243]
v_fma_f32 v224,v224,s26,-v18
v_fma_f32 v225,v225,s26,-v18
v_mfma_f32_16x16x32_bf16 v[240:243],a[104:107],a[40:43],v[240:243]
v_exp_f32 v224,v224
v_mfma_f32_16x16x32_bf16 v[240:243],a[108:111],a[44:47],v[240:243]
ds_read_b128 a[140:143],v5 offset:18432
v_accvgpr_read_b32 v49,a177
v_exp_f32 v225,v225
v_fma_f32 v212,v212,s26,-v20
v_fma_f32 v213,v213,s26,-v20
v_mul_f32 v46,v46,v14
v_mul_f32 v47,v47,v14
v_cvt_pk_bf16_f32 v110,v44,v45
v_accvgpr_read_b32 v50,a178
v_mfma_f32_16x16x32_bf16 v[248:251],a[108:111],a[60:63],0
v_exp_f32 v212,v212
v_mfma_f32_16x16x32_bf16 v[248:251],a[104:107],a[56:59],v[248:251]
v_exp_f32 v213,v213
v_mfma_f32_16x16x32_bf16 v[248:251],a[100:103],a[52:55],v[248:251]
s_waitcnt lgkmcnt(4)
v_accvgpr_read_b32 v51,a179
v_mul_f32 v48,v48,v15
v_mfma_f32_16x16x32_bf16 v[248:251],a[96:99],a[48:51],v[248:251]
ds_read_b128 a[144:147],v2 offset:19456
v_mul_f32 v49,v49,v15
v_cvt_pk_bf16_f32 v111,v46,v47
v_accvgpr_read_b32 v52,a180
v_accvgpr_read_b32 v53,a181
v_mul_f32 v50,v50,v15
v_mul_f32 v51,v51,v15
v_cvt_pk_bf16_f32 v182,v212,v213
v_accvgpr_read_b32 v54,a182
v_mfma_f32_16x16x32_bf16 v[228:231],a[112:115],a[0:3],0
v_cvt_pk_bf16_f32 v120,v48,v49
v_fma_f32 v226,v226,s26,-v18
v_mfma_f32_16x16x32_bf16 v[228:231],a[116:119],a[4:7],v[228:231]
v_exp_f32 v226,v226
v_mfma_f32_16x16x32_bf16 v[228:231],a[120:123],a[8:11],v[228:231]
v_fma_f32 v227,v227,s26,-v18
v_fma_f32 v214,v214,s26,-v20
v_mfma_f32_16x16x32_bf16 v[228:231],a[124:127],a[12:15],v[228:231]
ds_read_b128 a[148:151],v3 offset:19456
v_fma_f32 v215,v215,s26,-v20
v_exp_f32 v227,v227
v_exp_f32 v214,v214
v_accvgpr_read_b32 v55,a183
v_mul_f32 v52,v52,v15
v_mul_f32 v53,v53,v15
v_cvt_pk_bf16_f32 v121,v50,v51
v_mfma_f32_16x16x32_bf16 v[236:239],a[124:127],a[28:31],0
v_exp_f32 v215,v215
v_mfma_f32_16x16x32_bf16 v[236:239],a[120:123],a[24:27],v[236:239]
v_accvgpr_read_b32 v56,a184
v_accvgpr_read_b32 v57,a185
v_mfma_f32_16x16x32_bf16 v[236:239],a[116:119],a[20:23],v[236:239]
ds_read_b128 a[152:155],v4 offset:19456
v_cvt_pk_bf16_f32 v224,v224,v225
v_mfma_f32_16x16x32_bf16 v[236:239],a[112:115],a[16:19],v[236:239]
buffer_load_dwordx4 v1,s[12:15],s22 offen offset:3072 nt lds
v_mul_f32 v54,v54,v15
v_mul_f32 v55,v55,v15
v_cvt_pk_bf16_f32 v122,v52,v53
v_accvgpr_read_b32 v58,a186
v_cvt_pk_bf16_f32 v225,v226,v227
v_accvgpr_read_b32 v59,a187
v_cvt_pk_bf16_f32 v183,v214,v215
v_mul_f32 v56,v56,v15
v_mfma_f32_16x16x32_bf16 v[244:247],a[112:115],a[32:35],0
s_add_u32 s22,s22,16384
v_mul_f32 v57,v57,v15
v_cvt_pk_bf16_f32 v123,v54,v55
v_mfma_f32_16x16x32_bf16 v[244:247],a[116:119],a[36:39],v[244:247]
v_fma_f32 v228,v228,s26,-v18
v_fma_f32 v229,v229,s26,-v18
v_mfma_f32_16x16x32_bf16 v[244:247],a[120:123],a[40:43],v[244:247]
s_add_u32 m0,s25,0
ds_read_b128 a[156:159],v5 offset:19456
v_mfma_f32_16x16x32_bf16 v[244:247],a[124:127],a[44:47],v[244:247]
buffer_load_dwordx4 v1,s[8:11],s21 offen nt lds
v_accvgpr_read_b32 v60,a188
v_exp_f32 v228,v228
v_exp_f32 v229,v229
v_fma_f32 v220,v220,s26,-v21
v_fma_f32 v221,v221,s26,-v21
v_mfma_f32_16x16x32_bf16 v[252:255],a[124:127],a[60:63],0
v_exp_f32 v220,v220
v_mfma_f32_16x16x32_bf16 v[252:255],a[120:123],a[56:59],v[252:255]
v_exp_f32 v221,v221
v_mfma_f32_16x16x32_bf16 v[252:255],a[116:119],a[52:55],v[252:255]
v_accvgpr_read_b32 v61,a189
v_mul_f32 v58,v58,v15
v_mfma_f32_16x16x32_bf16 v[252:255],a[112:115],a[48:51],v[252:255]
s_waitcnt lgkmcnt(4)
v_mul_f32 v59,v59,v15
v_cvt_pk_bf16_f32 v124,v56,v57
v_accvgpr_read_b32 v62,a190
v_accvgpr_read_b32 v63,a191
v_mul_f32 v60,v60,v15
v_mul_f32 v61,v61,v15
v_cvt_pk_bf16_f32 v226,v228,v229
v_accvgpr_read_b32 v64,a192
v_cvt_pk_bf16_f32 v190,v220,v221
v_fma_f32 v230,v230,s26,-v18
v_mfma_f32_16x16x32_bf16 v[192:195],a[128:131],a[0:3],0
v_exp_f32 v230,v230
v_mfma_f32_16x16x32_bf16 v[192:195],a[132:135],a[4:7],v[192:195]
v_cvt_pk_bf16_f32 v125,v58,v59
v_fma_f32 v231,v231,s26,-v18
v_mfma_f32_16x16x32_bf16 v[192:195],a[136:139],a[8:11],v[192:195]
v_exp_f32 v231,v231
v_mfma_f32_16x16x32_bf16 v[192:195],a[140:143],a[12:15],v[192:195]
buffer_load_dwordx4 v1,s[8:11],s21 offen offset:1024 nt lds
v_accvgpr_read_b32 v65,a193
v_mul_f32 v62,v62,v15
v_mul_f32 v63,v63,v15
v_cvt_pk_bf16_f32 v126,v60,v61
v_fma_f32 v222,v222,s26,-v21
v_fma_f32 v223,v223,s26,-v21
v_accvgpr_read_b32 v66,a194
v_accvgpr_read_b32 v67,a195
v_mfma_f32_16x16x32_bf16 v[200:203],a[140:143],a[28:31],0
v_exp_f32 v222,v222
v_mfma_f32_16x16x32_bf16 v[200:203],a[136:139],a[24:27],v[200:203]
ds_read_b64_tr_b16 a[96:97],v8 offset:0
v_mul_f32 v64,v64,v16
v_mfma_f32_16x16x32_bf16 v[200:203],a[132:135],a[20:23],v[200:203]
ds_read_b64_tr_b16 a[98:99],v8 offset:1024
v_mul_f32 v65,v65,v16
v_mfma_f32_16x16x32_bf16 v[200:203],a[128:131],a[16:19],v[200:203]
buffer_load_dwordx4 v1,s[8:11],s21 offen offset:2048 nt lds
v_cvt_pk_bf16_f32 v127,v62,v63
v_exp_f32 v223,v223
v_accvgpr_read_b32 v68,a196
v_accvgpr_read_b32 v69,a197
v_mul_f32 v66,v66,v16
v_mul_f32 v67,v67,v16
v_mfma_f32_16x16x32_bf16 v[208:211],a[128:131],a[32:35],0
ds_read_b64_tr_b16 a[100:101],v8 offset:2048
v_cvt_pk_bf16_f32 v227,v230,v231
v_mfma_f32_16x16x32_bf16 v[208:211],a[132:135],a[36:39],v[208:211]
ds_read_b64_tr_b16 a[102:103],v8 offset:3072
v_cvt_pk_bf16_f32 v136,v64,v65
v_mfma_f32_16x16x32_bf16 v[208:211],a[136:139],a[40:43],v[208:211]
v_cvt_pk_bf16_f32 v191,v222,v223
v_accvgpr_read_b32 v70,a198
v_mfma_f32_16x16x32_bf16 v[208:211],a[140:143],a[44:47],v[208:211]
buffer_load_dwordx4 v1,s[8:11],s21 offen offset:3072 nt lds
v_fma_f32 v232,v232,s26,-v19
v_fma_f32 v233,v233,s26,-v19
v_accvgpr_read_b32 v71,a199
v_mul_f32 v68,v68,v16
v_mul_f32 v69,v69,v16
v_cvt_pk_bf16_f32 v137,v66,v67
v_accvgpr_read_b32 v72,a200
v_accvgpr_read_b32 v73,a201
v_mfma_f32_16x16x32_bf16 v[216:219],a[140:143],a[60:63],0
s_add_u32 s21,s21,16384
ds_read_b64_tr_b16 a[104:105],v8 offset:8
v_mfma_f32_16x16x32_bf16 v[216:219],a[136:139],a[56:59],v[216:219]
ds_read_b64_tr_b16 a[106:107],v8 offset:1032
v_mul_f32 v70,v70,v16
v_mfma_f32_16x16x32_bf16 v[216:219],a[132:135],a[52:55],v[216:219]
v_exp_f32 v232,v232
v_mfma_f32_16x16x32_bf16 v[216:219],a[128:131],a[48:51],v[216:219]
s_waitcnt lgkmcnt(6)
v_exp_f32 v233,v233
v_mul_f32 v71,v71,v16
v_cvt_pk_bf16_f32 v138,v68,v69
v_accvgpr_read_b32 v74,a202
v_accvgpr_read_b32 v75,a203
v_mul_f32 v72,v72,v16
v_mul_f32 v73,v73,v16
v_fma_f32 v234,v234,s26,-v19
v_fma_f32 v235,v235,s26,-v19
v_mfma_f32_16x16x32_bf16 v[196:199],a[144:147],a[0:3],0
ds_read_b64_tr_b16 a[108:109],v8 offset:2056
v_cvt_pk_bf16_f32 v232,v232,v233
v_mfma_f32_16x16x32_bf16 v[196:199],a[148:151],a[4:7],v[196:199]
ds_read_b64_tr_b16 a[110:111],v8 offset:3080
v_cvt_pk_bf16_f32 v139,v70,v71
v_mfma_f32_16x16x32_bf16 v[196:199],a[152:155],a[8:11],v[196:199]
v_exp_f32 v234,v234
v_mfma_f32_16x16x32_bf16 v[196:199],a[156:159],a[12:15],v[196:199]
ds_read_b64_tr_b16 a[112:113],v9 offset:0
v_exp_f32 v235,v235
v_accvgpr_read_b32 v76,a204
v_accvgpr_read_b32 v77,a205
v_mul_f32 v74,v74,v16
v_mul_f32 v75,v75,v16
v_cvt_pk_bf16_f32 v140,v72,v73
v_accvgpr_read_b32 v78,a206
v_mfma_f32_16x16x32_bf16 v[204:207],a[156:159],a[28:31],0
ds_read_b64_tr_b16 a[114:115],v9 offset:1024
v_accvgpr_read_b32 v79,a207
v_mfma_f32_16x16x32_bf16 v[204:207],a[152:155],a[24:27],v[204:207]
v_mul_f32 v76,v76,v16
v_mul_f32 v77,v77,v16
v_mfma_f32_16x16x32_bf16 v[204:207],a[148:151],a[20:23],v[204:207]
v_cvt_pk_bf16_f32 v141,v74,v75
v_accvgpr_read_b32 v80,a208
v_mfma_f32_16x16x32_bf16 v[204:207],a[144:147],a[16:19],v[204:207]
ds_read_b64_tr_b16 a[116:117],v9 offset:2048
v_cvt_pk_bf16_f32 v233,v234,v235
v_accvgpr_read_b32 v81,a209
v_fma_f32 v240,v240,s26,-v20
v_fma_f32 v241,v241,s26,-v20
v_mul_f32 v78,v78,v16
v_mul_f32 v79,v79,v16
v_cvt_pk_bf16_f32 v142,v76,v77
v_accvgpr_read_b32 v82,a210
v_accvgpr_read_b32 v83,a211
v_mfma_f32_16x16x32_bf16 v[212:215],a[144:147],a[32:35],0
ds_read_b64_tr_b16 a[118:119],v9 offset:3072
v_mul_f32 v80,v80,v17
v_mfma_f32_16x16x32_bf16 v[212:215],a[148:151],a[36:39],v[212:215]
v_exp_f32 v240,v240
v_mfma_f32_16x16x32_bf16 v[212:215],a[152:155],a[40:43],v[212:215]
v_exp_f32 v241,v241
v_mfma_f32_16x16x32_bf16 v[212:215],a[156:159],a[44:47],v[212:215]
ds_read_b64_tr_b16 a[120:121],v9 offset:8
v_mul_f32 v81,v81,v17
v_cvt_pk_bf16_f32 v143,v78,v79
v_accvgpr_read_b32 v84,a212
v_accvgpr_read_b32 v85,a213
v_mul_f32 v82,v82,v17
v_mul_f32 v83,v83,v17
v_cvt_pk_bf16_f32 v240,v240,v241
v_accvgpr_read_b32 v86,a214
v_fma_f32 v242,v242,s26,-v20
v_mfma_f32_16x16x32_bf16 v[220:223],a[156:159],a[60:63],0
ds_read_b64_tr_b16 a[122:123],v9 offset:1032
v_cvt_pk_bf16_f32 v152,v80,v81
v_mfma_f32_16x16x32_bf16 v[220:223],a[152:155],a[56:59],v[220:223]
v_exp_f32 v242,v242
v_mfma_f32_16x16x32_bf16 v[220:223],a[148:151],a[52:55],v[220:223]
ds_read_b64_tr_b16 a[124:125],v9 offset:2056
v_fma_f32 v243,v243,s26,-v20
v_mfma_f32_16x16x32_bf16 v[220:223],a[144:147],a[48:51],v[220:223]
s_waitcnt lgkmcnt(14)
ds_read_b64_tr_b16 a[126:127],v9 offset:3080
v_exp_f32 v243,v243
v_accvgpr_read_b32 v87,a215
v_mul_f32 v84,v84,v17
v_mul_f32 v85,v85,v17
v_cvt_pk_bf16_f32 v153,v82,v83
v_accvgpr_read_b32 v88,a216
v_accvgpr_read_b32 v89,a217
v_mfma_f32_16x16x32_bf16 a[224:227],a[240:243],v[160:163],0
s_add_u32 m0,s25,114688
v_mul_f32 v86,v86,v17
v_mul_f32 v87,v87,v17
v_mfma_f32_16x16x32_bf16 a[224:227],a[240:243],v[164:167],a[224:227]
buffer_load_dwordx4 v1,s[12:15],s22 offen nt lds
v_cvt_pk_bf16_f32 v154,v84,v85
v_accvgpr_read_b32 v90,a218
v_accvgpr_read_b32 v91,a219
v_cvt_pk_bf16_f32 v241,v242,v243
v_mul_f32 v88,v88,v17
v_mul_f32 v89,v89,v17
v_cvt_pk_bf16_f32 v155,v86,v87
v_fma_f32 v248,v248,s26,-v21
v_mfma_f32_16x16x32_bf16 a[228:231],a[240:243],v[168:171],0
s_waitcnt lgkmcnt(14)
ds_read_b64_tr_b16 a[128:129],v6 offset:0
v_fma_f32 v249,v249,s26,-v21
v_mfma_f32_16x16x32_bf16 a[228:231],a[240:243],v[172:175],a[228:231]
s_waitcnt lgkmcnt(14)
ds_read_b64_tr_b16 a[130:131],v6 offset:1024
v_accvgpr_read_b32 v92,a220
v_exp_f32 v248,v248
v_exp_f32 v249,v249
v_accvgpr_read_b32 v93,a221
v_mul_f32 v90,v90,v17
v_mul_f32 v91,v91,v17
v_cvt_pk_bf16_f32 v156,v88,v89
v_mfma_f32_16x16x32_bf16 a[232:235],a[240:243],v[176:179],0
v_accvgpr_read_b32 v94,a222
v_accvgpr_read_b32 v95,a223
v_mfma_f32_16x16x32_bf16 a[232:235],a[240:243],v[180:183],a[232:235]
s_waitcnt lgkmcnt(14)
v_mul_f32 v92,v92,v17
v_mul_f32 v93,v93,v17
v_cvt_pk_bf16_f32 v157,v90,v91
v_cvt_pk_bf16_f32 v248,v248,v249
v_mul_f32 v94,v94,v17
v_mul_f32 v95,v95,v17
v_fma_f32 v250,v250,s26,-v21
v_fma_f32 v251,v251,s26,-v21
v_fma_f32 v236,v236,s26,-v19
v_mfma_f32_16x16x32_bf16 a[236:239],a[240:243],v[184:187],0
ds_read_b64_tr_b16 a[132:133],v6 offset:2048
v_cvt_pk_bf16_f32 v158,v92,v93
v_mfma_f32_16x16x32_bf16 a[236:239],a[240:243],v[188:191],a[236:239]
s_waitcnt lgkmcnt(14)
ds_read_b64_tr_b16 a[134:135],v6 offset:3072
v_cvt_pk_bf16_f32 v159,v94,v95
v_exp_f32 v250,v250
v_exp_f32 v251,v251
v_exp_f32 v236,v236
v_fma_f32 v237,v237,s26,-v19
v_fma_f32 v238,v238,s26,-v19
v_mfma_f32_16x16x32_bf16 a[208:211],a[96:99],v[184:187],0
v_exp_f32 v237,v237
v_mfma_f32_16x16x32_bf16 a[208:211],a[100:103],v[188:191],a[208:211]
s_waitcnt lgkmcnt(14)
ds_read_b64_tr_b16 a[136:137],v6 offset:8
v_exp_f32 v238,v238
v_cvt_pk_bf16_f32 v249,v250,v251
v_cvt_pk_bf16_f32 v234,v236,v237
v_fma_f32 v239,v239,s26,-v19
v_fma_f32 v244,v244,s26,-v20
v_fma_f32 v245,v245,s26,-v20
v_fma_f32 v246,v246,s26,-v20
v_mfma_f32_16x16x32_bf16 a[192:195],a[100:103],v[180:183],0
s_waitcnt lgkmcnt(14)
ds_read_b64_tr_b16 a[138:139],v6 offset:1032
v_fma_f32 v247,v247,s26,-v20
v_mfma_f32_16x16x32_bf16 a[192:195],a[96:99],v[176:179],a[192:195]
buffer_load_dwordx4 v1,s[12:15],s22 offen offset:1024 nt lds
v_exp_f32 v239,v239
v_exp_f32 v244,v244
v_exp_f32 v245,v245
v_exp_f32 v246,v246
v_mfma_f32_16x16x32_bf16 a[176:179],a[96:99],v[168:171],0
v_exp_f32 v247,v247
v_mfma_f32_16x16x32_bf16 a[176:179],a[100:103],v[172:175],a[176:179]
s_waitcnt lgkmcnt(14)
ds_read_b64_tr_b16 a[140:141],v6 offset:2056
v_cvt_pk_bf16_f32 v235,v238,v239
v_cvt_pk_bf16_f32 v242,v244,v245
v_cvt_pk_bf16_f32 v243,v246,v247
v_fma_f32 v252,v252,s26,-v21
v_fma_f32 v253,v253,s26,-v21
v_fma_f32 v254,v254,s26,-v21
v_fma_f32 v255,v255,s26,-v21
v_mfma_f32_16x16x32_bf16 a[160:163],a[100:103],v[164:167],0
s_waitcnt lgkmcnt(14)
ds_read_b64_tr_b16 a[142:143],v6 offset:3080
v_mfma_f32_16x16x32_bf16 a[160:163],a[96:99],v[160:163],a[160:163]
v_exp_f32 v252,v252
v_exp_f32 v253,v253
v_exp_f32 v254,v254
v_exp_f32 v255,v255
v_mfma_f32_16x16x32_bf16 a[164:167],a[104:107],v[160:163],0
v_cvt_pk_bf16_f32 v250,v252,v253
v_cvt_pk_bf16_f32 v251,v254,v255
v_mfma_f32_16x16x32_bf16 a[164:167],a[108:111],v[164:167],a[164:167]
s_waitcnt lgkmcnt(14)
ds_read_b64_tr_b16 a[144:145],v7 offset:0
v_mfma_f32_16x16x32_bf16 a[180:183],a[108:111],v[172:175],0
s_waitcnt lgkmcnt(14)
ds_read_b64_tr_b16 a[146:147],v7 offset:1024
v_mfma_f32_16x16x32_bf16 a[180:183],a[104:107],v[168:171],a[180:183]
buffer_load_dwordx4 v1,s[12:15],s22 offen offset:2048 nt lds
v_mfma_f32_16x16x32_bf16 a[196:199],a[104:107],v[176:179],0
s_waitcnt lgkmcnt(14)
ds_read_b64_tr_b16 a[148:149],v7 offset:2048
v_mfma_f32_16x16x32_bf16 a[196:199],a[108:111],v[180:183],a[196:199]
s_waitcnt lgkmcnt(14)
ds_read_b64_tr_b16 a[150:151],v7 offset:3072
v_mfma_f32_16x16x32_bf16 a[212:215],a[108:111],v[188:191],0
v_mfma_f32_16x16x32_bf16 a[212:215],a[104:107],v[184:187],a[212:215]
v_mfma_f32_16x16x32_bf16 a[216:219],a[112:115],v[184:187],0
s_waitcnt lgkmcnt(14)
ds_read_b64_tr_b16 a[152:153],v7 offset:8
v_mfma_f32_16x16x32_bf16 a[216:219],a[116:119],v[188:191],a[216:219]
s_waitcnt lgkmcnt(14)
ds_read_b64_tr_b16 a[154:155],v7 offset:1032
v_mfma_f32_16x16x32_bf16 a[200:203],a[116:119],v[180:183],0
v_mfma_f32_16x16x32_bf16 a[200:203],a[112:115],v[176:179],a[200:203]
s_waitcnt lgkmcnt(14)
ds_read_b64_tr_b16 a[156:157],v7 offset:2056
v_mfma_f32_16x16x32_bf16 a[184:187],a[112:115],v[168:171],0
s_waitcnt lgkmcnt(14)
ds_read_b64_tr_b16 a[158:159],v7 offset:3080
v_mfma_f32_16x16x32_bf16 a[184:187],a[116:119],v[172:175],a[184:187]
buffer_load_dwordx4 v1,s[12:15],s22 offen offset:3072 nt lds
v_mfma_f32_16x16x32_bf16 a[168:171],a[116:119],v[164:167],0
s_add_u32 s22,s22,16384
v_mfma_f32_16x16x32_bf16 a[168:171],a[112:115],v[160:163],a[168:171]
v_mfma_f32_16x16x32_bf16 a[172:175],a[120:123],v[160:163],0
v_mfma_f32_16x16x32_bf16 a[172:175],a[124:127],v[164:167],a[172:175]
v_mfma_f32_16x16x32_bf16 a[188:191],a[124:127],v[172:175],0
v_mfma_f32_16x16x32_bf16 a[188:191],a[120:123],v[168:171],a[188:191]
s_mov_b32 s24,131072
v_mfma_f32_16x16x32_bf16 a[204:207],a[120:123],v[176:179],0
v_fma_f32 v192,v192,s26,-v18
v_mfma_f32_16x16x32_bf16 a[204:207],a[124:127],v[180:183],a[204:207]
v_exp_f32 v192,v192
v_fma_f32 v193,v193,s26,-v18
v_fma_f32 v194,v194,s26,-v18
v_mfma_f32_16x16x32_bf16 a[220:223],a[124:127],v[188:191],0
v_fma_f32 v195,v195,s26,-v18
v_mfma_f32_16x16x32_bf16 a[220:223],a[120:123],v[184:187],a[220:223]
s_waitcnt lgkmcnt(12)
v_exp_f32 v193,v193
v_exp_f32 v194,v194
v_mfma_f32_16x16x32_bf16 v[80:83],a[128:131],v[184:187],0
v_cvt_pk_bf16_f32 v228,v192,v193
v_mfma_f32_16x16x32_bf16 v[80:83],a[132:135],v[188:191],v[80:83]
v_exp_f32 v195,v195
v_fma_f32 v196,v196,s26,-v18
v_fma_f32 v197,v197,s26,-v18
v_mfma_f32_16x16x32_bf16 v[64:67],a[132:135],v[180:183],0
v_cvt_pk_bf16_f32 v229,v194,v195
v_mfma_f32_16x16x32_bf16 v[64:67],a[128:131],v[176:179],v[64:67]
s_waitcnt vmcnt(16)
s_waitcnt lgkmcnt(0)
s_barrier
L_h0_1:
ds_read_b128 a[96:99],v2 offset:32768
v_exp_f32 v196,v196
v_fma_f32 v198,v198,s26,-v18
v_mfma_f32_16x16x32_bf16 v[48:51],a[128:131],v[168:171],0
s_add_u32 m0,s25,16384
v_fma_f32 v199,v199,s26,-v18
v_mfma_f32_16x16x32_bf16 v[48:51],a[132:135],v[172:175],v[48:51]
buffer_load_dwordx4 v1,s[8:11],s21 offen nt lds
v_exp_f32 v197,v197
v_mfma_f32_16x16x32_bf16 v[32:35],a[132:135],v[164:167],0
v_cvt_pk_bf16_f32 v230,v196,v197
v_mfma_f32_16x16x32_bf16 v[32:35],a[128:131],v[160:163],v[32:35]
ds_read_b128 a[100:103],v3 offset:32768
v_exp_f32 v198,v198
v_fma_f32 v200,v200,s26,-v19
v_mfma_f32_16x16x32_bf16 v[36:39],a[136:139],v[160:163],0
v_fma_f32 v201,v201,s26,-v19
v_mfma_f32_16x16x32_bf16 v[36:39],a[140:143],v[164:167],v[36:39]
v_exp_f32 v199,v199
v_exp_f32 v200,v200
v_mfma_f32_16x16x32_bf16 v[52:55],a[140:143],v[172:175],0
ds_read_b128 a[104:107],v4 offset:32768
v_cvt_pk_bf16_f32 v231,v198,v199
v_mfma_f32_16x16x32_bf16 v[52:55],a[136:139],v[168:171],v[52:55]
v_exp_f32 v201,v201
v_fma_f32 v202,v202,s26,-v19
v_fma_f32 v203,v203,s26,-v19
v_mfma_f32_16x16x32_bf16 v[68:71],a[136:139],v[176:179],0
v_cvt_pk_bf16_f32 v236,v200,v201
v_mfma_f32_16x16x32_bf16 v[68:71],a[140:143],v[180:183],v[68:71]
buffer_load_dwordx4 v1,s[8:11],s21 offen offset:1024 nt lds
v_exp_f32 v202,v202
v_mfma_f32_16x16x32_bf16 v[84:87],a[140:143],v[188:191],0
ds_read_b128 a[108:111],v5 offset:32768
v_fma_f32 v204,v204,s26,-v19
v_mfma_f32_16x16x32_bf16 v[84:87],a[136:139],v[184:187],v[84:87]
v_exp_f32 v203,v203
v_exp_f32 v204,v204
v_mfma_f32_16x16x32_bf16 v[88:91],a[144:147],v[184:187],0
v_cvt_pk_bf16_f32 v237,v202,v203
v_mfma_f32_16x16x32_bf16 v[88:91],a[148:151],v[188:191],v[88:91]
v_fma_f32 v205,v205,s26,-v19
v_fma_f32 v206,v206,s26,-v19
v_fma_f32 v207,v207,s26,-v19
v_fma_f32 v208,v208,s26,-v20
v_mfma_f32_16x16x32_bf16 v[72:75],a[148:151],v[180:183],0
ds_read_b128 a[112:115],v2 offset:33792
v_fma_f32 v209,v209,s26,-v20
v_mfma_f32_16x16x32_bf16 v[72:75],a[144:147],v[176:179],v[72:75]
v_exp_f32 v205,v205
v_exp_f32 v206,v206
v_mfma_f32_16x16x32_bf16 v[56:59],a[144:147],v[168:171],0
v_cvt_pk_bf16_f32 v238,v204,v205
v_mfma_f32_16x16x32_bf16 v[56:59],a[148:151],v[172:175],v[56:59]
ds_read_b128 a[116:119],v3 offset:33792
v_exp_f32 v207,v207
v_fma_f32 v210,v210,s26,-v20
v_mfma_f32_16x16x32_bf16 v[40:43],a[148:151],v[164:167],0
v_cvt_pk_bf16_f32 v239,v206,v207
v_mfma_f32_16x16x32_bf16 v[40:43],a[144:147],v[160:163],v[40:43]
v_exp_f32 v208,v208
v_exp_f32 v209,v209
v_mfma_f32_16x16x32_bf16 v[44:47],a[152:155],v[160:163],0
v_cvt_pk_bf16_f32 v244,v208,v209
v_mfma_f32_16x16x32_bf16 v[44:47],a[156:159],v[164:167],v[44:47]
ds_read_b128 a[120:123],v4 offset:33792
v_fma_f32 v211,v211,s26,-v20
v_exp_f32 v210,v210
v_mfma_f32_16x16x32_bf16 v[60:63],a[156:159],v[172:175],0
v_fma_f32 v212,v212,s26,-v20
v_mfma_f32_16x16x32_bf16 v[60:63],a[152:155],v[168:171],v[60:63]
buffer_load_dwordx4 v1,s[8:11],s21 offen offset:2048 nt lds
v_exp_f32 v211,v211
v_mfma_f32_16x16x32_bf16 v[76:79],a[152:155],v[176:179],0
v_cvt_pk_bf16_f32 v245,v210,v211
v_mfma_f32_16x16x32_bf16 v[76:79],a[156:159],v[180:183],v[76:79]
ds_read_b128 a[124:127],v5 offset:33792
v_fma_f32 v213,v213,s26,-v20
v_exp_f32 v212,v212
v_mfma_f32_16x16x32_bf16 v[92:95],a[156:159],v[188:191],0
v_fma_f32 v214,v214,s26,-v20
v_mfma_f32_16x16x32_bf16 v[92:95],a[152:155],v[184:187],v[92:95]
s_waitcnt lgkmcnt(4)
v_exp_f32 v213,v213
v_exp_f32 v214,v214
v_mfma_f32_16x16x32_bf16 v[160:163],a[96:99],a[0:3],0
ds_read_b128 a[128:131],v2 offset:34816
v_cvt_pk_bf16_f32 v246,v212,v213
v_mfma_f32_16x16x32_bf16 v[160:163],a[100:103],a[4:7],v[160:163]
v_fma_f32 v215,v215,s26,-v20
v_mfma_f32_16x16x32_bf16 v[160:163],a[104:107],a[8:11],v[160:163]
v_fma_f32 v216,v216,s26,-v21
v_mfma_f32_16x16x32_bf16 v[160:163],a[108:111],a[12:15],v[160:163]
buffer_load_dwordx4 v1,s[8:11],s21 offen offset:3072 nt lds
v_exp_f32 v215,v215
v_mfma_f32_16x16x32_bf16 v[168:171],a[108:111],a[28:31],0
s_add_u32 s21,s21,16384
ds_read_b128 a[132:135],v3 offset:34816
v_mfma_f32_16x16x32_bf16 v[168:171],a[104:107],a[24:27],v[168:171]
v_cvt_pk_bf16_f32 v247,v214,v215
v_mfma_f32_16x16x32_bf16 v[168:171],a[100:103],a[20:23],v[168:171]
v_fma_f32 v217,v217,s26,-v21
v_mfma_f32_16x16x32_bf16 v[168:171],a[96:99],a[16:19],v[168:171]
v_exp_f32 v216,v216
v_exp_f32 v217,v217
v_mfma_f32_16x16x32_bf16 v[176:179],a[96:99],a[32:35],0
ds_read_b128 a[136:139],v4 offset:34816
v_cvt_pk_bf16_f32 v252,v216,v217
v_mfma_f32_16x16x32_bf16 v[176:179],a[100:103],a[36:39],v[176:179]
v_fma_f32 v218,v218,s26,-v21
v_mfma_f32_16x16x32_bf16 v[176:179],a[104:107],a[40:43],v[176:179]
v_fma_f32 v219,v219,s26,-v21
v_mfma_f32_16x16x32_bf16 v[176:179],a[108:111],a[44:47],v[176:179]
ds_read_b128 a[140:143],v5 offset:34816
v_exp_f32 v218,v218
v_fma_f32 v220,v220,s26,-v21
v_mfma_f32_16x16x32_bf16 v[184:187],a[108:111],a[60:63],0
v_fma_f32 v221,v221,s26,-v21
v_mfma_f32_16x16x32_bf16 v[184:187],a[104:107],a[56:59],v[184:187]
v_fma_f32 v222,v222,s26,-v21
v_mfma_f32_16x16x32_bf16 v[184:187],a[100:103],a[52:55],v[184:187]
s_waitcnt lgkmcnt(4)
v_fma_f32 v223,v223,s26,-v21
v_mfma_f32_16x16x32_bf16 v[184:187],a[96:99],a[48:51],v[184:187]
ds_read_b128 a[144:147],v2 offset:35840
v_exp_f32 v219,v219
v_mfma_f32_16x16x32_bf16 v[164:167],a[112:115],a[0:3],0
v_cvt_pk_bf16_f32 v253,v218,v219
v_mfma_f32_16x16x32_bf16 v[164:167],a[116:119],a[4:7],v[164:167]
v_mfma_f32_16x16x32_bf16 v[164:167],a[120:123],a[8:11],v[164:167]
v_mfma_f32_16x16x32_bf16 v[164:167],a[124:127],a[12:15],v[164:167]
ds_read_b128 a[148:151],v3 offset:35840
v_exp_f32 v220,v220
v_mfma_f32_16x16x32_bf16 v[172:175],a[124:127],a[28:31],0
v_mfma_f32_16x16x32_bf16 v[172:175],a[120:123],a[24:27],v[172:175]
v_mfma_f32_16x16x32_bf16 v[172:175],a[116:119],a[20:23],v[172:175]
s_add_u32 m0,s25,65536
ds_read_b128 a[152:155],v4 offset:35840
v_mfma_f32_16x16x32_bf16 v[172:175],a[112:115],a[16:19],v[172:175]
buffer_load_dwordx4 v1,s[12:15],s22 offen nt lds
v_exp_f32 v221,v221
v_mfma_f32_16x16x32_bf16 v[180:183],a[112:115],a[32:35],0
v_cvt_pk_bf16_f32 v254,v220,v221
v_mfma_f32_16x16x32_bf16 v[180:183],a[116:119],a[36:39],v[180:183]
v_mfma_f32_16x16x32_bf16 v[180:183],a[120:123],a[40:43],v[180:183]
ds_read_b128 a[156:159],v5 offset:35840
v_mfma_f32_16x16x32_bf16 v[180:183],a[124:127],a[44:47],v[180:183]
v_exp_f32 v222,v222
v_exp_f32 v223,v223
v_mfma_f32_16x16x32_bf16 v[188:191],a[124:127],a[60:63],0
v_cvt_pk_bf16_f32 v255,v222,v223
v_mfma_f32_16x16x32_bf16 v[188:191],a[120:123],a[56:59],v[188:191]
v_mfma_f32_16x16x32_bf16 v[188:191],a[116:119],a[52:55],v[188:191]
v_mfma_f32_16x16x32_bf16 v[188:191],a[112:115],a[48:51],v[188:191]
s_waitcnt lgkmcnt(4)
v_mfma_f32_16x16x32_bf16 v[192:195],a[128:131],a[0:3],0
v_fma_f32 v160,v160,s26,-v18
v_fma_f32 v161,v161,s26,-v18
v_mfma_f32_16x16x32_bf16 v[192:195],a[132:135],a[4:7],v[192:195]
v_exp_f32 v160,v160
v_mfma_f32_16x16x32_bf16 v[192:195],a[136:139],a[8:11],v[192:195]
v_exp_f32 v161,v161
v_mfma_f32_16x16x32_bf16 v[192:195],a[140:143],a[12:15],v[192:195]
buffer_load_dwordx4 v1,s[12:15],s22 offen offset:1024 nt lds
v_cvt_pk_bf16_f32 v160,v160,v161
v_mfma_f32_16x16x32_bf16 v[200:203],a[140:143],a[28:31],0
v_fma_f32 v162,v162,s26,-v18
v_fma_f32 v163,v163,s26,-v18
v_mfma_f32_16x16x32_bf16 v[200:203],a[136:139],a[24:27],v[200:203]
ds_read_b64_tr_b16 a[96:97],v6 offset:16384
v_fma_f32 v164,v164,s26,-v18
v_mfma_f32_16x16x32_bf16 v[200:203],a[132:135],a[20:23],v[200:203]
ds_read_b64_tr_b16 a[98:99],v6 offset:17408
v_fma_f32 v165,v165,s26,-v18
v_mfma_f32_16x16x32_bf16 v[200:203],a[128:131],a[16:19],v[200:203]
v_exp_f32 v162,v162
v_mfma_f32_16x16x32_bf16 v[208:211],a[128:131],a[32:35],0
ds_read_b64_tr_b16 a[100:101],v6 offset:18432
v_fma_f32 v166,v166,s26,-v18
v_mfma_f32_16x16x32_bf16 v[208:211],a[132:135],a[36:39],v[208:211]
ds_read_b64_tr_b16 a[102:103],v6 offset:19456
v_fma_f32 v167,v167,s26,-v18
v_mfma_f32_16x16x32_bf16 v[208:211],a[136:139],a[40:43],v[208:211]
v_exp_f32 v163,v163
v_mfma_f32_16x16x32_bf16 v[208:211],a[140:143],a[44:47],v[208:211]
buffer_load_dwordx4 v1,s[12:15],s22 offen offset:2048 nt lds
v_cvt_pk_bf16_f32 v161,v162,v163
v_mfma_f32_16x16x32_bf16 v[216:219],a[140:143],a[60:63],0
ds_read_b64_tr_b16 a[104:105],v6 offset:16392
v_fma_f32 v168,v168,s26,-v19
v_mfma_f32_16x16x32_bf16 v[216:219],a[136:139],a[56:59],v[216:219]
ds_read_b64_tr_b16 a[106:107],v6 offset:17416
v_fma_f32 v169,v169,s26,-v19
v_mfma_f32_16x16x32_bf16 v[216:219],a[132:135],a[52:55],v[216:219]
v_exp_f32 v164,v164
v_mfma_f32_16x16x32_bf16 v[216:219],a[128:131],a[48:51],v[216:219]
s_waitcnt lgkmcnt(6)
v_exp_f32 v165,v165
v_fma_f32 v170,v170,s26,-v19
v_mfma_f32_16x16x32_bf16 v[196:199],a[144:147],a[0:3],0
ds_read_b64_tr_b16 a[108:109],v6 offset:18440
v_cvt_pk_bf16_f32 v162,v164,v165
v_mfma_f32_16x16x32_bf16 v[196:199],a[148:151],a[4:7],v[196:199]
ds_read_b64_tr_b16 a[110:111],v6 offset:19464
v_fma_f32 v171,v171,s26,-v19
v_mfma_f32_16x16x32_bf16 v[196:199],a[152:155],a[8:11],v[196:199]
v_exp_f32 v166,v166
v_mfma_f32_16x16x32_bf16 v[196:199],a[156:159],a[12:15],v[196:199]
ds_read_b64_tr_b16 a[112:113],v7 offset:16384
v_fma_f32 v172,v172,s26,-v19
v_mfma_f32_16x16x32_bf16 v[204:207],a[156:159],a[28:31],0
ds_read_b64_tr_b16 a[114:115],v7 offset:17408
v_fma_f32 v173,v173,s26,-v19
v_mfma_f32_16x16x32_bf16 v[204:207],a[152:155],a[24:27],v[204:207]
v_exp_f32 v167,v167
v_mfma_f32_16x16x32_bf16 v[204:207],a[148:151],a[20:23],v[204:207]
v_exp_f32 v168,v168
v_mfma_f32_16x16x32_bf16 v[204:207],a[144:147],a[16:19],v[204:207]
ds_read_b64_tr_b16 a[116:117],v7 offset:18432
v_exp_f32 v169,v169
v_mfma_f32_16x16x32_bf16 v[212:215],a[144:147],a[32:35],0
ds_read_b64_tr_b16 a[118:119],v7 offset:19456
v_cvt_pk_bf16_f32 v163,v166,v167
v_mfma_f32_16x16x32_bf16 v[212:215],a[148:151],a[36:39],v[212:215]
v_exp_f32 v170,v170
v_mfma_f32_16x16x32_bf16 v[212:215],a[152:155],a[40:43],v[212:215]
v_exp_f32 v171,v171
v_mfma_f32_16x16x32_bf16 v[212:215],a[156:159],a[44:47],v[212:215]
ds_read_b64_tr_b16 a[120:121],v7 offset:16392
v_exp_f32 v172,v172
v_mfma_f32_16x16x32_bf16 v[220:223],a[156:159],a[60:63],0
ds_read_b64_tr_b16 a[122:123],v7 offset:17416
v_cvt_pk_bf16_f32 v168,v168,v169
v_mfma_f32_16x16x32_bf16 v[220:223],a[152:155],a[56:59],v[220:223]
v_exp_f32 v173,v173
v_mfma_f32_16x16x32_bf16 v[220:223],a[148:151],a[52:55],v[220:223]
ds_read_b64_tr_b16 a[124:125],v7 offset:18440
v_cvt_pk_bf16_f32 v169,v170,v171
v_mfma_f32_16x16x32_bf16 v[220:223],a[144:147],a[48:51],v[220:223]
s_waitcnt lgkmcnt(14)
ds_read_b64_tr_b16 a[126:127],v7 offset:19464
v_cvt_pk_bf16_f32 v170,v172,v173
v_fma_f32 v174,v174,s26,-v19
v_mfma_f32_16x16x32_bf16 a[224:227],a[240:243],v[224:227],a[224:227]
v_exp_f32 v174,v174
v_mfma_f32_16x16x32_bf16 a[224:227],a[240:243],v[228:231],a[224:227]
buffer_load_dwordx4 v1,s[12:15],s22 offen offset:3072 nt lds
v_mfma_f32_16x16x32_bf16 a[228:231],a[240:243],v[232:235],a[228:231]
s_add_u32 s22,s22,16384
s_waitcnt lgkmcnt(14)
ds_read_b64_tr_b16 a[128:129],v8 offset:16384
v_mfma_f32_16x16x32_bf16 a[228:231],a[240:243],v[236:239],a[228:231]
s_waitcnt lgkmcnt(14)
ds_read_b64_tr_b16 a[130:131],v8 offset:17408
v_fma_f32 v175,v175,s26,-v19
v_fma_f32 v176,v176,s26,-v20
v_mfma_f32_16x16x32_bf16 a[232:235],a[240:243],v[240:243],a[232:235]
v_exp_f32 v175,v175
v_mfma_f32_16x16x32_bf16 a[232:235],a[240:243],v[244:247],a[232:235]
s_waitcnt lgkmcnt(14)
v_cvt_pk_bf16_f32 v171,v174,v175
v_exp_f32 v176,v176
v_mfma_f32_16x16x32_bf16 a[236:239],a[240:243],v[248:251],a[236:239]
ds_read_b64_tr_b16 a[132:133],v8 offset:18432
v_fma_f32 v177,v177,s26,-v20
v_mfma_f32_16x16x32_bf16 a[236:239],a[240:243],v[252:255],a[236:239]
s_waitcnt lgkmcnt(14)
ds_read_b64_tr_b16 a[134:135],v8 offset:19456
v_fma_f32 v178,v178,s26,-v20
v_mfma_f32_16x16x32_bf16 v[80:83],a[96:99],v[248:251],v[80:83]
v_exp_f32 v177,v177
v_mfma_f32_16x16x32_bf16 v[80:83],a[100:103],v[252:255],v[80:83]
s_waitcnt lgkmcnt(14)
ds_read_b64_tr_b16 a[136:137],v8 offset:16392
v_exp_f32 v178,v178
v_mfma_f32_16x16x32_bf16 v[64:67],a[100:103],v[244:247],v[64:67]
s_waitcnt lgkmcnt(14)
ds_read_b64_tr_b16 a[138:139],v8 offset:17416
v_cvt_pk_bf16_f32 v176,v176,v177
v_mfma_f32_16x16x32_bf16 v[64:67],a[96:99],v[240:243],v[64:67]
v_fma_f32 v179,v179,s26,-v20
v_fma_f32 v180,v180,s26,-v20
v_fma_f32 v181,v181,s26,-v20
v_mfma_f32_16x16x32_bf16 v[48:51],a[96:99],v[232:235],v[48:51]
v_exp_f32 v179,v179
v_mfma_f32_16x16x32_bf16 v[48:51],a[100:103],v[236:239],v[48:51]
s_waitcnt lgkmcnt(14)
ds_read_b64_tr_b16 a[140:141],v8 offset:18440
v_cvt_pk_bf16_f32 v177,v178,v179
v_mfma_f32_16x16x32_bf16 v[32:35],a[100:103],v[228:231],v[32:35]
s_waitcnt lgkmcnt(14)
ds_read_b64_tr_b16 a[142:143],v8 offset:19464
v_fma_f32 v182,v182,s26,-v20
v_mfma_f32_16x16x32_bf16 v[32:35],a[96:99],v[224:227],v[32:35]
v_exp_f32 v180,v180
v_fma_f32 v183,v183,s26,-v20
v_mfma_f32_16x16x32_bf16 v[36:39],a[104:107],v[224:227],v[36:39]
v_exp_f32 v181,v181
v_mfma_f32_16x16x32_bf16 v[36:39],a[108:111],v[228:231],v[36:39]
s_waitcnt lgkmcnt(14)
ds_read_b64_tr_b16 a[144:145],v9 offset:16384
v_exp_f32 v182,v182
v_mfma_f32_16x16x32_bf16 v[52:55],a[108:111],v[236:239],v[52:55]
s_waitcnt lgkmcnt(14)
ds_read_b64_tr_b16 a[146:147],v9 offset:17408
v_cvt_pk_bf16_f32 v178,v180,v181
v_mfma_f32_16x16x32_bf16 v[52:55],a[104:107],v[232:235],v[52:55]
v_exp_f32 v183,v183
v_mfma_f32_16x16x32_bf16 v[68:71],a[104:107],v[240:243],v[68:71]
s_waitcnt lgkmcnt(14)
ds_read_b64_tr_b16 a[148:149],v9 offset:18432
v_cvt_pk_bf16_f32 v179,v182,v183
v_mfma_f32_16x16x32_bf16 v[68:71],a[108:111],v[244:247],v[68:71]
s_waitcnt lgkmcnt(14)
ds_read_b64_tr_b16 a[150:151],v9 offset:19456
v_fma_f32 v184,v184,s26,-v21
v_fma_f32 v185,v185,s26,-v21
v_mfma_f32_16x16x32_bf16 v[84:87],a[108:111],v[252:255],v[84:87]
v_exp_f32 v184,v184
v_mfma_f32_16x16x32_bf16 v[84:87],a[104:107],v[248:251],v[84:87]
v_exp_f32 v185,v185
v_fma_f32 v186,v186,s26,-v21
v_mfma_f32_16x16x32_bf16 v[88:91],a[112:115],v[248:251],v[88:91]
s_waitcnt lgkmcnt(14)
ds_read_b64_tr_b16 a[152:153],v9 offset:16392
v_cvt_pk_bf16_f32 v184,v184,v185
v_mfma_f32_16x16x32_bf16 v[88:91],a[116:119],v[252:255],v[88:91]
s_waitcnt lgkmcnt(14)
ds_read_b64_tr_b16 a[154:155],v9 offset:17416
v_exp_f32 v186,v186
v_mfma_f32_16x16x32_bf16 v[72:75],a[116:119],v[244:247],v[72:75]
v_fma_f32 v187,v187,s26,-v21
v_fma_f32 v188,v188,s26,-v21
v_mfma_f32_16x16x32_bf16 v[72:75],a[112:115],v[240:243],v[72:75]
s_waitcnt lgkmcnt(14)
ds_read_b64_tr_b16 a[156:157],v9 offset:18440
v_fma_f32 v189,v189,s26,-v21
v_mfma_f32_16x16x32_bf16 v[56:59],a[112:115],v[232:235],v[56:59]
s_waitcnt lgkmcnt(14)
ds_read_b64_tr_b16 a[158:159],v9 offset:19464
v_fma_f32 v190,v190,s26,-v21
v_mfma_f32_16x16x32_bf16 v[56:59],a[116:119],v[236:239],v[56:59]
v_exp_f32 v187,v187
v_fma_f32 v191,v191,s26,-v21
v_mfma_f32_16x16x32_bf16 v[40:43],a[116:119],v[228:231],v[40:43]
v_exp_f32 v188,v188
v_mfma_f32_16x16x32_bf16 v[40:43],a[112:115],v[224:227],v[40:43]
v_cvt_pk_bf16_f32 v185,v186,v187
v_exp_f32 v189,v189
v_mfma_f32_16x16x32_bf16 v[44:47],a[120:123],v[224:227],v[44:47]
v_exp_f32 v190,v190
v_mfma_f32_16x16x32_bf16 v[44:47],a[124:127],v[228:231],v[44:47]
v_exp_f32 v191,v191
v_mfma_f32_16x16x32_bf16 v[60:63],a[124:127],v[236:239],v[60:63]
v_cvt_pk_bf16_f32 v186,v188,v189
v_cvt_pk_bf16_f32 v187,v190,v191
v_mfma_f32_16x16x32_bf16 v[60:63],a[120:123],v[232:235],v[60:63]
v_mfma_f32_16x16x32_bf16 v[76:79],a[120:123],v[240:243],v[76:79]
v_fma_f32 v192,v192,s26,-v18
v_fma_f32 v193,v193,s26,-v18
v_mfma_f32_16x16x32_bf16 v[76:79],a[124:127],v[244:247],v[76:79]
v_exp_f32 v192,v192
v_mfma_f32_16x16x32_bf16 v[92:95],a[124:127],v[252:255],v[92:95]
v_exp_f32 v193,v193
v_mfma_f32_16x16x32_bf16 v[92:95],a[120:123],v[248:251],v[92:95]
s_waitcnt lgkmcnt(12)
v_cvt_pk_bf16_f32 v164,v192,v193
v_fma_f32 v194,v194,s26,-v18
v_mfma_f32_16x16x32_bf16 a[208:211],a[128:131],v[248:251],a[208:211]
v_exp_f32 v194,v194
v_mfma_f32_16x16x32_bf16 a[208:211],a[132:135],v[252:255],a[208:211]
v_fma_f32 v195,v195,s26,-v18
v_fma_f32 v196,v196,s26,-v18
v_fma_f32 v197,v197,s26,-v18
v_mfma_f32_16x16x32_bf16 a[192:195],a[132:135],v[244:247],a[192:195]
v_exp_f32 v195,v195
v_mfma_f32_16x16x32_bf16 a[192:195],a[128:131],v[240:243],a[192:195]
s_waitcnt vmcnt(16)
s_waitcnt lgkmcnt(0)
s_barrier
ds_read_b128 a[96:99],v2 offset:49152
v_cvt_pk_bf16_f32 v165,v194,v195
v_mfma_f32_16x16x32_bf16 a[176:179],a[128:131],v[232:235],a[176:179]
s_add_u32 m0,s25,32768
v_exp_f32 v196,v196
v_mfma_f32_16x16x32_bf16 a[176:179],a[132:135],v[236:239],a[176:179]
buffer_load_dwordx4 v1,s[8:11],s21 offen nt lds
v_mfma_f32_16x16x32_bf16 a[160:163],a[132:135],v[228:231],a[160:163]
v_exp_f32 v197,v197
v_mfma_f32_16x16x32_bf16 a[160:163],a[128:131],v[224:227],a[160:163]
ds_read_b128 a[100:103],v3 offset:49152
v_cvt_pk_bf16_f32 v166,v196,v197
v_mfma_f32_16x16x32_bf16 a[164:167],a[136:139],v[224:227],a[164:167]
v_fma_f32 v198,v198,s26,-v18
v_fma_f32 v199,v199,s26,-v18
v_mfma_f32_16x16x32_bf16 a[164:167],a[140:143],v[228:231],a[164:167]
v_exp_f32 v198,v198
v_fma_f32 v200,v200,s26,-v19
v_mfma_f32_16x16x32_bf16 a[180:183],a[140:143],v[236:239],a[180:183]
ds_read_b128 a[104:107],v4 offset:49152
v_fma_f32 v201,v201,s26,-v19
v_mfma_f32_16x16x32_bf16 a[180:183],a[136:139],v[232:235],a[180:183]
v_exp_f32 v199,v199
v_mfma_f32_16x16x32_bf16 a[196:199],a[136:139],v[240:243],a[196:199]
v_exp_f32 v200,v200
v_mfma_f32_16x16x32_bf16 a[196:199],a[140:143],v[244:247],a[196:199]
buffer_load_dwordx4 v1,s[8:11],s21 offen offset:1024 nt lds
v_mfma_f32_16x16x32_bf16 a[212:215],a[140:143],v[252:255],a[212:215]
ds_read_b128 a[108:111],v5 offset:49152
v_cvt_pk_bf16_f32 v167,v198,v199
v_mfma_f32_16x16x32_bf16 a[212:215],a[136:139],v[248:251],a[212:215]
v_exp_f32 v201,v201
v_mfma_f32_16x16x32_bf16 a[216:219],a[144:147],v[248:251],a[216:219]
v_cvt_pk_bf16_f32 v172,v200,v201
v_fma_f32 v202,v202,s26,-v19
v_mfma_f32_16x16x32_bf16 a[216:219],a[148:151],v[252:255],a[216:219]
v_fma_f32 v203,v203,s26,-v19
v_exp_f32 v202,v202
v_mfma_f32_16x16x32_bf16 a[200:203],a[148:151],v[244:247],a[200:203]
ds_read_b128 a[112:115],v2 offset:50176
v_fma_f32 v204,v204,s26,-v19
v_mfma_f32_16x16x32_bf16 a[200:203],a[144:147],v[240:243],a[200:203]
v_exp_f32 v203,v203
v_mfma_f32_16x16x32_bf16 a[184:187],a[144:147],v[232:235],a[184:187]
v_exp_f32 v204,v204
v_mfma_f32_16x16x32_bf16 a[184:187],a[148:151],v[236:239],a[184:187]
ds_read_b128 a[116:119],v3 offset:50176
v_cvt_pk_bf16_f32 v173,v202,v203
v_mfma_f32_16x16x32_bf16 a[168:171],a[148:151],v[228:231],a[168:171]
v_fma_f32 v205,v205,s26,-v19
v_fma_f32 v206,v206,s26,-v19
v_mfma_f32_16x16x32_bf16 a[168:171],a[144:147],v[224:227],a[168:171]
v_exp_f32 v205,v205
v_mfma_f32_16x16x32_bf16 a[172:175],a[152:155],v[224:227],a[172:175]
v_exp_f32 v206,v206
v_mfma_f32_16x16x32_bf16 a[172:175],a[156:159],v[228:231],a[172:175]
ds_read_b128 a[120:123],v4 offset:50176
v_cvt_pk_bf16_f32 v174,v204,v205
v_mfma_f32_16x16x32_bf16 a[188:191],a[156:159],v[236:239],a[188:191]
v_fma_f32 v207,v207,s26,-v19
v_fma_f32 v208,v208,s26,-v20
v_mfma_f32_16x16x32_bf16 a[188:191],a[152:155],v[232:235],a[188:191]
buffer_load_dwordx4 v1,s[8:11],s21 offen offset:2048 nt lds
v_fma_f32 v209,v209,s26,-v20
v_mfma_f32_16x16x32_bf16 a[204:207],a[152:155],v[240:243],a[204:207]
v_exp_f32 v207,v207
v_mfma_f32_16x16x32_bf16 a[204:207],a[156:159],v[244:247],a[204:207]
ds_read_b128 a[124:127],v5 offset:50176
v_cvt_pk_bf16_f32 v175,v206,v207
v_mfma_f32_16x16x32_bf16 a[220:223],a[156:159],v[252:255],a[220:223]
v_exp_f32 v208,v208
v_mfma_f32_16x16x32_bf16 a[220:223],a[152:155],v[248:251],a[220:223]
s_waitcnt lgkmcnt(4)
v_exp_f32 v209,v209
v_mfma_f32_16x16x32_bf16 v[224:227],a[96:99],a[0:3],0
ds_read_b128 a[128:131],v2 offset:51200
v_cvt_pk_bf16_f32 v180,v208,v209
v_mfma_f32_16x16x32_bf16 v[224:227],a[100:103],a[4:7],v[224:227]
v_fma_f32 v210,v210,s26,-v20
v_fma_f32 v211,v211,s26,-v20
v_mfma_f32_16x16x32_bf16 v[224:227],a[104:107],a[8:11],v[224:227]
v_exp_f32 v210,v210
v_mfma_f32_16x16x32_bf16 v[224:227],a[108:111],a[12:15],v[224:227]
buffer_load_dwordx4 v1,s[8:11],s21 offen offset:3072 nt lds
v_mfma_f32_16x16x32_bf16 v[232:235],a[108:111],a[28:31],0
s_add_u32 s21,s21,16384
ds_read_b128 a[132:135],v3 offset:51200
v_mfma_f32_16x16x32_bf16 v[232:235],a[104:107],a[24:27],v[232:235]
v_exp_f32 v211,v211
v_mfma_f32_16x16x32_bf16 v[232:235],a[100:103],a[20:23],v[232:235]
v_cvt_pk_bf16_f32 v181,v210,v211
v_fma_f32 v212,v212,s26,-v20
v_mfma_f32_16x16x32_bf16 v[232:235],a[96:99],a[16:19],v[232:235]
v_fma_f32 v213,v213,s26,-v20
v_exp_f32 v212,v212
v_mfma_f32_16x16x32_bf16 v[240:243],a[96:99],a[32:35],0
ds_read_b128 a[136:139],v4 offset:51200
v_fma_f32 v214,v214,s26,-v20
v_mfma_f32_16x16x32_bf16 v[240:243],a[100:103],a[36:39],v[240:243]
v_exp_f32 v213,v213
v_mfma_f32_16x16x32_bf16 v[240:243],a[104:107],a[40:43],v[240:243]
v_exp_f32 v214,v214
v_mfma_f32_16x16x32_bf16 v[240:243],a[108:111],a[44:47],v[240:243]
ds_read_b128 a[140:143],v5 offset:51200
v_cvt_pk_bf16_f32 v182,v212,v213
v_mfma_f32_16x16x32_bf16 v[248:251],a[108:111],a[60:63],0
v_fma_f32 v215,v215,s26,-v20
v_fma_f32 v216,v216,s26,-v21
v_mfma_f32_16x16x32_bf16 v[248:251],a[104:107],a[56:59],v[248:251]
v_exp_f32 v215,v215
v_mfma_f32_16x16x32_bf16 v[248:251],a[100:103],a[52:55],v[248:251]
s_waitcnt lgkmcnt(4)
v_exp_f32 v216,v216
v_mfma_f32_16x16x32_bf16 v[248:251],a[96:99],a[48:51],v[248:251]
ds_read_b128 a[144:147],v2 offset:52224
v_cvt_pk_bf16_f32 v183,v214,v215
v_mfma_f32_16x16x32_bf16 v[228:231],a[112:115],a[0:3],0
v_fma_f32 v217,v217,s26,-v21
v_fma_f32 v218,v218,s26,-v21
v_mfma_f32_16x16x32_bf16 v[228:231],a[116:119],a[4:7],v[228:231]
v_exp_f32 v217,v217
v_mfma_f32_16x16x32_bf16 v[228:231],a[120:123],a[8:11],v[228:231]
v_exp_f32 v218,v218
v_mfma_f32_16x16x32_bf16 v[228:231],a[124:127],a[12:15],v[228:231]
ds_read_b128 a[148:151],v3 offset:52224
v_cvt_pk_bf16_f32 v188,v216,v217
v_mfma_f32_16x16x32_bf16 v[236:239],a[124:127],a[28:31],0
v_fma_f32 v219,v219,s26,-v21
v_fma_f32 v220,v220,s26,-v21
v_mfma_f32_16x16x32_bf16 v[236:239],a[120:123],a[24:27],v[236:239]
v_exp_f32 v219,v219
v_mfma_f32_16x16x32_bf16 v[236:239],a[116:119],a[20:23],v[236:239]
s_add_u32 m0,s25,81920
ds_read_b128 a[152:155],v4 offset:52224
v_mfma_f32_16x16x32_bf16 v[236:239],a[112:115],a[16:19],v[236:239]
buffer_load_dwordx4 v1,s[12:15],s22 offen nt lds
v_cvt_pk_bf16_f32 v189,v218,v219
v_mfma_f32_16x16x32_bf16 v[244:247],a[112:115],a[32:35],0
v_exp_f32 v220,v220
v_mfma_f32_16x16x32_bf16 v[244:247],a[116:119],a[36:39],v[244:247]
v_fma_f32 v221,v221,s26,-v21
v_fma_f32 v222,v222,s26,-v21
v_mfma_f32_16x16x32_bf16 v[244:247],a[120:123],a[40:43],v[244:247]
ds_read_b128 a[156:159],v5 offset:52224
v_fma_f32 v223,v223,s26,-v21
v_mfma_f32_16x16x32_bf16 v[244:247],a[124:127],a[44:47],v[244:247]
v_exp_f32 v221,v221
v_mfma_f32_16x16x32_bf16 v[252:255],a[124:127],a[60:63],0
v_exp_f32 v222,v222
v_mfma_f32_16x16x32_bf16 v[252:255],a[120:123],a[56:59],v[252:255]
v_exp_f32 v223,v223
v_mfma_f32_16x16x32_bf16 v[252:255],a[116:119],a[52:55],v[252:255]
v_cvt_pk_bf16_f32 v190,v220,v221
v_cvt_pk_bf16_f32 v191,v222,v223
v_mfma_f32_16x16x32_bf16 v[252:255],a[112:115],a[48:51],v[252:255]
s_waitcnt lgkmcnt(4)
v_mfma_f32_16x16x32_bf16 v[192:195],a[128:131],a[0:3],0
v_fma_f32 v224,v224,s26,-v18
v_fma_f32 v225,v225,s26,-v18
v_mfma_f32_16x16x32_bf16 v[192:195],a[132:135],a[4:7],v[192:195]
v_exp_f32 v224,v224
v_mfma_f32_16x16x32_bf16 v[192:195],a[136:139],a[8:11],v[192:195]
v_exp_f32 v225,v225
v_mfma_f32_16x16x32_bf16 v[192:195],a[140:143],a[12:15],v[192:195]
buffer_load_dwordx4 v1,s[12:15],s22 offen offset:1024 nt lds
v_cvt_pk_bf16_f32 v224,v224,v225
v_mfma_f32_16x16x32_bf16 v[200:203],a[140:143],a[28:31],0
v_fma_f32 v226,v226,s26,-v18
v_fma_f32 v227,v227,s26,-v18
v_mfma_f32_16x16x32_bf16 v[200:203],a[136:139],a[24:27],v[200:203]
ds_read_b64_tr_b16 a[96:97],v6 offset:32768
v_fma_f32 v228,v228,s26,-v18
v_mfma_f32_16x16x32_bf16 v[200:203],a[132:135],a[20:23],v[200:203]
ds_read_b64_tr_b16 a[98:99],v6 offset:33792
v_fma_f32 v229,v229,s26,-v18
v_mfma_f32_16x16x32_bf16 v[200:203],a[128:131],a[16:19],v[200:203]
v_exp_f32 v226,v226
v_mfma_f32_16x16x32_bf16 v[208:211],a[128:131],a[32:35],0
ds_read_b64_tr_b16 a[100:101],v6 offset:34816
v_fma_f32 v230,v230,s26,-v18
v_mfma_f32_16x16x32_bf16 v[208:211],a[132:135],a[36:39],v[208:211]
ds_read_b64_tr_b16 a[102:103],v6 offset:35840
v_fma_f32 v231,v231,s26,-v18
v_mfma_f32_16x16x32_bf16 v[208:211],a[136:139],a[40:43],v[208:211]
v_exp_f32 v227,v227
v_mfma_f32_16x16x32_bf16 v[208:211],a[140:143],a[44:47],v[208:211]
buffer_load_dwordx4 v1,s[12:15],s22 offen offset:2048 nt lds
v_cvt_pk_bf16_f32 v225,v226,v227
v_mfma_f32_16x16x32_bf16 v[216:219],a[140:143],a[60:63],0
ds_read_b64_tr_b16 a[104:105],v6 offset:32776
v_fma_f32 v232,v232,s26,-v19
v_mfma_f32_16x16x32_bf16 v[216:219],a[136:139],a[56:59],v[216:219]
ds_read_b64_tr_b16 a[106:107],v6 offset:33800
v_fma_f32 v233,v233,s26,-v19
v_mfma_f32_16x16x32_bf16 v[216:219],a[132:135],a[52:55],v[216:219]
v_exp_f32 v228,v228
v_mfma_f32_16x16x32_bf16 v[216:219],a[128:131],a[48:51],v[216:219]
s_waitcnt lgkmcnt(6)
v_exp_f32 v229,v229
v_fma_f32 v234,v234,s26,-v19
v_mfma_f32_16x16x32_bf16 v[196:199],a[144:147],a[0:3],0
ds_read_b64_tr_b16 a[108:109],v6 offset:34824
v_cvt_pk_bf16_f32 v226,v228,v229
v_mfma_f32_16x16x32_bf16 v[196:199],a[148:151],a[4:7],v[196:199]
ds_read_b64_tr_b16 a[110:111],v6 offset:35848
v_fma_f32 v235,v235,s26,-v19
v_mfma_f32_16x16x32_bf16 v[196:199],a[152:155],a[8:11],v[196:199]
v_exp_f32 v230,v230
v_mfma_f32_16x16x32_bf16 v[196:199],a[156:159],a[12:15],v[196:199]
ds_read_b64_tr_b16 a[112:113],v7 offset:32768
v_fma_f32 v236,v236,s26,-v19
v_mfma_f32_16x16x32_bf16 v[204:207],a[156:159],a[28:31],0
ds_read_b64_tr_b16 a[114:115],v7 offset:33792
v_fma_f32 v237,v237,s26,-v19
v_mfma_f32_16x16x32_bf16 v[204:207],a[152:155],a[24:27],v[204:207]
v_exp_f32 v231,v231
v_mfma_f32_16x16x32_bf16 v[204:207],a[148:151],a[20:23],v[204:207]
v_exp_f32 v232,v232
v_mfma_f32_16x16x32_bf16 v[204:207],a[144:147],a[16:19],v[204:207]
ds_read_b64_tr_b16 a[116:117],v7 offset:34816
v_exp_f32 v233,v233
v_mfma_f32_16x16x32_bf16 v[212:215],a[144:147],a[32:35],0
ds_read_b64_tr_b16 a[118:119],v7 offset:35840
v_cvt_pk_bf16_f32 v227,v230,v231
v_mfma_f32_16x16x32_bf16 v[212:215],a[148:151],a[36:39],v[212:215]
v_exp_f32 v234,v234
v_mfma_f32_16x16x32_bf16 v[212:215],a[152:155],a[40:43],v[212:215]
v_exp_f32 v235,v235
v_mfma_f32_16x16x32_bf16 v[212:215],a[156:159],a[44:47],v[212:215]
ds_read_b64_tr_b16 a[120:121],v7 offset:32776
v_exp_f32 v236,v236
v_mfma_f32_16x16x32_bf16 v[220:223],a[156:159],a[60:63],0
ds_read_b64_tr_b16 a[122:123],v7 offset:33800
v_cvt_pk_bf16_f32 v232,v232,v233
v_mfma_f32_16x16x32_bf16 v[220:223],a[152:155],a[56:59],v[220:223]
v_exp_f32 v237,v237
v_mfma_f32_16x16x32_bf16 v[220:223],a[148:151],a[52:55],v[220:223]
ds_read_b64_tr_b16 a[124:125],v7 offset:34824
v_cvt_pk_bf16_f32 v233,v234,v235
v_mfma_f32_16x16x32_bf16 v[220:223],a[144:147],a[48:51],v[220:223]
s_waitcnt lgkmcnt(14)
ds_read_b64_tr_b16 a[126:127],v7 offset:35848
v_cvt_pk_bf16_f32 v234,v236,v237
v_fma_f32 v238,v238,s26,-v19
v_mfma_f32_16x16x32_bf16 a[224:227],a[240:243],v[160:163],a[224:227]
v_exp_f32 v238,v238
v_mfma_f32_16x16x32_bf16 a[224:227],a[240:243],v[164:167],a[224:227]
buffer_load_dwordx4 v1,s[12:15],s22 offen offset:3072 nt lds
v_mfma_f32_16x16x32_bf16 a[228:231],a[240:243],v[168:171],a[228:231]
s_add_u32 s22,s22,16384
s_waitcnt lgkmcnt(14)
ds_read_b64_tr_b16 a[128:129],v8 offset:32768
v_mfma_f32_16x16x32_bf16 a[228:231],a[240:243],v[172:175],a[228:231]
s_waitcnt lgkmcnt(14)
ds_read_b64_tr_b16 a[130:131],v8 offset:33792
v_fma_f32 v239,v239,s26,-v19
v_fma_f32 v240,v240,s26,-v20
v_mfma_f32_16x16x32_bf16 a[232:235],a[240:243],v[176:179],a[232:235]
v_exp_f32 v239,v239
v_mfma_f32_16x16x32_bf16 a[232:235],a[240:243],v[180:183],a[232:235]
s_waitcnt lgkmcnt(14)
v_cvt_pk_bf16_f32 v235,v238,v239
v_exp_f32 v240,v240
v_mfma_f32_16x16x32_bf16 a[236:239],a[240:243],v[184:187],a[236:239]
ds_read_b64_tr_b16 a[132:133],v8 offset:34816
v_fma_f32 v241,v241,s26,-v20
v_mfma_f32_16x16x32_bf16 a[236:239],a[240:243],v[188:191],a[236:239]
s_waitcnt lgkmcnt(14)
ds_read_b64_tr_b16 a[134:135],v8 offset:35840
v_fma_f32 v242,v242,s26,-v20
v_mfma_f32_16x16x32_bf16 v[80:83],a[96:99],v[184:187],v[80:83]
v_exp_f32 v241,v241
v_mfma_f32_16x16x32_bf16 v[80:83],a[100:103],v[188:191],v[80:83]
s_waitcnt lgkmcnt(14)
ds_read_b64_tr_b16 a[136:137],v8 offset:32776
v_exp_f32 v242,v242
v_mfma_f32_16x16x32_bf16 v[64:67],a[100:103],v[180:183],v[64:67]
s_waitcnt lgkmcnt(14)
ds_read_b64_tr_b16 a[138:139],v8 offset:33800
v_cvt_pk_bf16_f32 v240,v240,v241
v_mfma_f32_16x16x32_bf16 v[64:67],a[96:99],v[176:179],v[64:67]
v_fma_f32 v243,v243,s26,-v20
v_fma_f32 v244,v244,s26,-v20
v_fma_f32 v245,v245,s26,-v20
v_mfma_f32_16x16x32_bf16 v[48:51],a[96:99],v[168:171],v[48:51]
v_exp_f32 v243,v243
v_mfma_f32_16x16x32_bf16 v[48:51],a[100:103],v[172:175],v[48:51]
s_waitcnt lgkmcnt(14)
ds_read_b64_tr_b16 a[140:141],v8 offset:34824
v_cvt_pk_bf16_f32 v241,v242,v243
v_mfma_f32_16x16x32_bf16 v[32:35],a[100:103],v[164:167],v[32:35]
s_waitcnt lgkmcnt(14)
ds_read_b64_tr_b16 a[142:143],v8 offset:35848
v_fma_f32 v246,v246,s26,-v20
v_mfma_f32_16x16x32_bf16 v[32:35],a[96:99],v[160:163],v[32:35]
v_exp_f32 v244,v244
v_fma_f32 v247,v247,s26,-v20
v_mfma_f32_16x16x32_bf16 v[36:39],a[104:107],v[160:163],v[36:39]
v_exp_f32 v245,v245
v_mfma_f32_16x16x32_bf16 v[36:39],a[108:111],v[164:167],v[36:39]
s_waitcnt lgkmcnt(14)
ds_read_b64_tr_b16 a[144:145],v9 offset:32768
v_exp_f32 v246,v246
v_mfma_f32_16x16x32_bf16 v[52:55],a[108:111],v[172:175],v[52:55]
s_waitcnt lgkmcnt(14)
ds_read_b64_tr_b16 a[146:147],v9 offset:33792
v_cvt_pk_bf16_f32 v242,v244,v245
v_mfma_f32_16x16x32_bf16 v[52:55],a[104:107],v[168:171],v[52:55]
v_exp_f32 v247,v247
v_mfma_f32_16x16x32_bf16 v[68:71],a[104:107],v[176:179],v[68:71]
s_waitcnt lgkmcnt(14)
ds_read_b64_tr_b16 a[148:149],v9 offset:34816
v_cvt_pk_bf16_f32 v243,v246,v247
v_mfma_f32_16x16x32_bf16 v[68:71],a[108:111],v[180:183],v[68:71]
s_waitcnt lgkmcnt(14)
ds_read_b64_tr_b16 a[150:151],v9 offset:35840
v_fma_f32 v248,v248,s26,-v21
v_fma_f32 v249,v249,s26,-v21
v_mfma_f32_16x16x32_bf16 v[84:87],a[108:111],v[188:191],v[84:87]
v_exp_f32 v248,v248
v_mfma_f32_16x16x32_bf16 v[84:87],a[104:107],v[184:187],v[84:87]
v_exp_f32 v249,v249
v_fma_f32 v250,v250,s26,-v21
v_mfma_f32_16x16x32_bf16 v[88:91],a[112:115],v[184:187],v[88:91]
s_waitcnt lgkmcnt(14)
ds_read_b64_tr_b16 a[152:153],v9 offset:32776
v_cvt_pk_bf16_f32 v248,v248,v249
v_mfma_f32_16x16x32_bf16 v[88:91],a[116:119],v[188:191],v[88:91]
s_waitcnt lgkmcnt(14)
ds_read_b64_tr_b16 a[154:155],v9 offset:33800
v_exp_f32 v250,v250
v_mfma_f32_16x16x32_bf16 v[72:75],a[116:119],v[180:183],v[72:75]
v_fma_f32 v251,v251,s26,-v21
v_fma_f32 v252,v252,s26,-v21
v_mfma_f32_16x16x32_bf16 v[72:75],a[112:115],v[176:179],v[72:75]
s_waitcnt lgkmcnt(14)
ds_read_b64_tr_b16 a[156:157],v9 offset:34824
v_fma_f32 v253,v253,s26,-v21
v_mfma_f32_16x16x32_bf16 v[56:59],a[112:115],v[168:171],v[56:59]
s_waitcnt lgkmcnt(14)
ds_read_b64_tr_b16 a[158:159],v9 offset:35848
v_fma_f32 v254,v254,s26,-v21
v_mfma_f32_16x16x32_bf16 v[56:59],a[116:119],v[172:175],v[56:59]
v_exp_f32 v251,v251
v_fma_f32 v255,v255,s26,-v21
v_mfma_f32_16x16x32_bf16 v[40:43],a[116:119],v[164:167],v[40:43]
v_exp_f32 v252,v252
v_mfma_f32_16x16x32_bf16 v[40:43],a[112:115],v[160:163],v[40:43]
v_cvt_pk_bf16_f32 v249,v250,v251
v_exp_f32 v253,v253
v_mfma_f32_16x16x32_bf16 v[44:47],a[120:123],v[160:163],v[44:47]
v_exp_f32 v254,v254
v_mfma_f32_16x16x32_bf16 v[44:47],a[124:127],v[164:167],v[44:47]
v_exp_f32 v255,v255
v_mfma_f32_16x16x32_bf16 v[60:63],a[124:127],v[172:175],v[60:63]
v_cvt_pk_bf16_f32 v250,v252,v253
v_cvt_pk_bf16_f32 v251,v254,v255
v_mfma_f32_16x16x32_bf16 v[60:63],a[120:123],v[168:171],v[60:63]
v_mfma_f32_16x16x32_bf16 v[76:79],a[120:123],v[176:179],v[76:79]
v_fma_f32 v192,v192,s26,-v18
v_fma_f32 v193,v193,s26,-v18
v_mfma_f32_16x16x32_bf16 v[76:79],a[124:127],v[180:183],v[76:79]
v_exp_f32 v192,v192
v_mfma_f32_16x16x32_bf16 v[92:95],a[124:127],v[188:191],v[92:95]
v_exp_f32 v193,v193
v_mfma_f32_16x16x32_bf16 v[92:95],a[120:123],v[184:187],v[92:95]
s_waitcnt lgkmcnt(12)
v_cvt_pk_bf16_f32 v228,v192,v193
v_fma_f32 v194,v194,s26,-v18
v_mfma_f32_16x16x32_bf16 a[208:211],a[128:131],v[184:187],a[208:211]
v_exp_f32 v194,v194
v_mfma_f32_16x16x32_bf16 a[208:211],a[132:135],v[188:191],a[208:211]
v_fma_f32 v195,v195,s26,-v18
v_fma_f32 v196,v196,s26,-v18
v_fma_f32 v197,v197,s26,-v18
v_mfma_f32_16x16x32_bf16 a[192:195],a[132:135],v[180:183],a[192:195]
v_exp_f32 v195,v195
v_mfma_f32_16x16x32_bf16 a[192:195],a[128:131],v[176:179],a[192:195]
s_waitcnt vmcnt(16)
s_waitcnt lgkmcnt(0)
s_barrier
ds_read_b128 a[96:99],v2 offset:0
v_cvt_pk_bf16_f32 v229,v194,v195
v_mfma_f32_16x16x32_bf16 a[176:179],a[128:131],v[168:171],a[176:179]
s_add_u32 m0,s25,49152
v_exp_f32 v196,v196
v_mfma_f32_16x16x32_bf16 a[176:179],a[132:135],v[172:175],a[176:179]
buffer_load_dwordx4 v1,s[8:11],s21 offen nt lds
v_mfma_f32_16x16x32_bf16 a[160:163],a[132:135],v[164:167],a[160:163]
v_exp_f32 v197,v197
v_mfma_f32_16x16x32_bf16 a[160:163],a[128:131],v[160:163],a[160:163]
ds_read_b128 a[100:103],v3 offset:0
v_cvt_pk_bf16_f32 v230,v196,v197
v_mfma_f32_16x16x32_bf16 a[164:167],a[136:139],v[160:163],a[164:167]
v_fma_f32 v198,v198,s26,-v18
v_fma_f32 v199,v199,s26,-v18
v_mfma_f32_16x16x32_bf16 a[164:167],a[140:143],v[164:167],a[164:167]
v_exp_f32 v198,v198
v_fma_f32 v200,v200,s26,-v19
v_mfma_f32_16x16x32_bf16 a[180:183],a[140:143],v[172:175],a[180:183]
ds_read_b128 a[104:107],v4 offset:0
v_fma_f32 v201,v201,s26,-v19
v_mfma_f32_16x16x32_bf16 a[180:183],a[136:139],v[168:171],a[180:183]
v_exp_f32 v199,v199
v_mfma_f32_16x16x32_bf16 a[196:199],a[136:139],v[176:179],a[196:199]
v_exp_f32 v200,v200
v_mfma_f32_16x16x32_bf16 a[196:199],a[140:143],v[180:183],a[196:199]
buffer_load_dwordx4 v1,s[8:11],s21 offen offset:1024 nt lds
v_mfma_f32_16x16x32_bf16 a[212:215],a[140:143],v[188:191],a[212:215]
ds_read_b128 a[108:111],v5 offset:0
v_cvt_pk_bf16_f32 v231,v198,v199
v_mfma_f32_16x16x32_bf16 a[212:215],a[136:139],v[184:187],a[212:215]
v_exp_f32 v201,v201
v_mfma_f32_16x16x32_bf16 a[216:219],a[144:147],v[184:187],a[216:219]
v_cvt_pk_bf16_f32 v236,v200,v201
v_fma_f32 v202,v202,s26,-v19
v_mfma_f32_16x16x32_bf16 a[216:219],a[148:151],v[188:191],a[216:219]
v_fma_f32 v203,v203,s26,-v19
v_exp_f32 v202,v202
v_mfma_f32_16x16x32_bf16 a[200:203],a[148:151],v[180:183],a[200:203]
ds_read_b128 a[112:115],v2 offset:1024
v_fma_f32 v204,v204,s26,-v19
v_mfma_f32_16x16x32_bf16 a[200:203],a[144:147],v[176:179],a[200:203]
v_exp_f32 v203,v203
v_mfma_f32_16x16x32_bf16 a[184:187],a[144:147],v[168:171],a[184:187]
v_exp_f32 v204,v204
v_mfma_f32_16x16x32_bf16 a[184:187],a[148:151],v[172:175],a[184:187]
ds_read_b128 a[116:119],v3 offset:1024
v_cvt_pk_bf16_f32 v237,v202,v203
v_mfma_f32_16x16x32_bf16 a[168:171],a[148:151],v[164:167],a[168:171]
v_fma_f32 v205,v205,s26,-v19
v_fma_f32 v206,v206,s26,-v19
v_mfma_f32_16x16x32_bf16 a[168:171],a[144:147],v[160:163],a[168:171]
v_exp_f32 v205,v205
v_mfma_f32_16x16x32_bf16 a[172:175],a[152:155],v[160:163],a[172:175]
v_exp_f32 v206,v206
v_mfma_f32_16x16x32_bf16 a[172:175],a[156:159],v[164:167],a[172:175]
ds_read_b128 a[120:123],v4 offset:1024
v_cvt_pk_bf16_f32 v238,v204,v205
v_mfma_f32_16x16x32_bf16 a[188:191],a[156:159],v[172:175],a[188:191]
v_fma_f32 v207,v207,s26,-v19
v_fma_f32 v208,v208,s26,-v20
v_mfma_f32_16x16x32_bf16 a[188:191],a[152:155],v[168:171],a[188:191]
buffer_load_dwordx4 v1,s[8:11],s21 offen offset:2048 nt lds
v_fma_f32 v209,v209,s26,-v20
v_mfma_f32_16x16x32_bf16 a[204:207],a[152:155],v[176:179],a[204:207]
v_exp_f32 v207,v207
v_mfma_f32_16x16x32_bf16 a[204:207],a[156:159],v[180:183],a[204:207]
ds_read_b128 a[124:127],v5 offset:1024
v_cvt_pk_bf16_f32 v239,v206,v207
v_mfma_f32_16x16x32_bf16 a[220:223],a[156:159],v[188:191],a[220:223]
v_exp_f32 v208,v208
v_mfma_f32_16x16x32_bf16 a[220:223],a[152:155],v[184:187],a[220:223]
s_waitcnt lgkmcnt(4)
v_exp_f32 v209,v209
v_mfma_f32_16x16x32_bf16 v[160:163],a[96:99],a[0:3],0
ds_read_b128 a[128:131],v2 offset:2048
v_cvt_pk_bf16_f32 v244,v208,v209
v_mfma_f32_16x16x32_bf16 v[160:163],a[100:103],a[4:7],v[160:163]
v_fma_f32 v210,v210,s26,-v20
v_fma_f32 v211,v211,s26,-v20
v_mfma_f32_16x16x32_bf16 v[160:163],a[104:107],a[8:11],v[160:163]
v_exp_f32 v210,v210
v_mfma_f32_16x16x32_bf16 v[160:163],a[108:111],a[12:15],v[160:163]
buffer_load_dwordx4 v1,s[8:11],s21 offen offset:3072 nt lds
v_mfma_f32_16x16x32_bf16 v[168:171],a[108:111],a[28:31],0
s_add_u32 s21,s21,16384
ds_read_b128 a[132:135],v3 offset:2048
v_mfma_f32_16x16x32_bf16 v[168:171],a[104:107],a[24:27],v[168:171]
v_exp_f32 v211,v211
v_mfma_f32_16x16x32_bf16 v[168:171],a[100:103],a[20:23],v[168:171]
v_cvt_pk_bf16_f32 v245,v210,v211
v_fma_f32 v212,v212,s26,-v20
v_mfma_f32_16x16x32_bf16 v[168:171],a[96:99],a[16:19],v[168:171]
v_fma_f32 v213,v213,s26,-v20
v_exp_f32 v212,v212
v_mfma_f32_16x16x32_bf16 v[176:179],a[96:99],a[32:35],0
ds_read_b128 a[136:139],v4 offset:2048
v_fma_f32 v214,v214,s26,-v20
v_mfma_f32_16x16x32_bf16 v[176:179],a[100:103],a[36:39],v[176:179]
v_exp_f32 v213,v213
v_mfma_f32_16x16x32_bf16 v[176:179],a[104:107],a[40:43],v[176:179]
v_exp_f32 v214,v214
v_mfma_f32_16x16x32_bf16 v[176:179],a[108:111],a[44:47],v[176:179]
ds_read_b128 a[140:143],v5 offset:2048
v_cvt_pk_bf16_f32 v246,v212,v213
v_mfma_f32_16x16x32_bf16 v[184:187],a[108:111],a[60:63],0
v_fma_f32 v215,v215,s26,-v20
v_fma_f32 v216,v216,s26,-v21
v_mfma_f32_16x16x32_bf16 v[184:187],a[104:107],a[56:59],v[184:187]
v_exp_f32 v215,v215
v_mfma_f32_16x16x32_bf16 v[184:187],a[100:103],a[52:55],v[184:187]
s_waitcnt lgkmcnt(4)
v_exp_f32 v216,v216
v_mfma_f32_16x16x32_bf16 v[184:187],a[96:99],a[48:51],v[184:187]
ds_read_b128 a[144:147],v2 offset:3072
v_cvt_pk_bf16_f32 v247,v214,v215
v_mfma_f32_16x16x32_bf16 v[164:167],a[112:115],a[0:3],0
v_fma_f32 v217,v217,s26,-v21
v_fma_f32 v218,v218,s26,-v21
v_mfma_f32_16x16x32_bf16 v[164:167],a[116:119],a[4:7],v[164:167]
v_exp_f32 v217,v217
v_mfma_f32_16x16x32_bf16 v[164:167],a[120:123],a[8:11],v[164:167]
v_exp_f32 v218,v218
v_mfma_f32_16x16x32_bf16 v[164:167],a[124:127],a[12:15],v[164:167]
ds_read_b128 a[148:151],v3 offset:3072
v_cvt_pk_bf16_f32 v252,v216,v217
v_mfma_f32_16x16x32_bf16 v[172:175],a[124:127],a[28:31],0
v_fma_f32 v219,v219,s26,-v21
v_fma_f32 v220,v220,s26,-v21
v_mfma_f32_16x16x32_bf16 v[172:175],a[120:123],a[24:27],v[172:175]
v_exp_f32 v219,v219
v_mfma_f32_16x16x32_bf16 v[172:175],a[116:119],a[20:23],v[172:175]
s_add_u32 m0,s25,98304
ds_read_b128 a[152:155],v4 offset:3072
v_mfma_f32_16x16x32_bf16 v[172:175],a[112:115],a[16:19],v[172:175]
buffer_load_dwordx4 v1,s[12:15],s22 offen nt lds
v_cvt_pk_bf16_f32 v253,v218,v219
v_mfma_f32_16x16x32_bf16 v[180:183],a[112:115],a[32:35],0
v_exp_f32 v220,v220
v_mfma_f32_16x16x32_bf16 v[180:183],a[116:119],a[36:39],v[180:183]
v_fma_f32 v221,v221,s26,-v21
v_fma_f32 v222,v222,s26,-v21
v_mfma_f32_16x16x32_bf16 v[180:183],a[120:123],a[40:43],v[180:183]
ds_read_b128 a[156:159],v5 offset:3072
v_fma_f32 v223,v223,s26,-v21
v_mfma_f32_16x16x32_bf16 v[180:183],a[124:127],a[44:47],v[180:183]
v_exp_f32 v221,v221
v_mfma_f32_16x16x32_bf16 v[188:191],a[124:127],a[60:63],0
v_exp_f32 v222,v222
v_mfma_f32_16x16x32_bf16 v[188:191],a[120:123],a[56:59],v[188:191]
v_exp_f32 v223,v223
v_mfma_f32_16x16x32_bf16 v[188:191],a[116:119],a[52:55],v[188:191]
v_cvt_pk_bf16_f32 v254,v220,v221
v_cvt_pk_bf16_f32 v255,v222,v223
v_mfma_f32_16x16x32_bf16 v[188:191],a[112:115],a[48:51],v[188:191]
s_waitcnt lgkmcnt(4)
v_mfma_f32_16x16x32_bf16 v[192:195],a[128:131],a[0:3],0
v_fma_f32 v160,v160,s26,-v18
v_fma_f32 v161,v161,s26,-v18
v_mfma_f32_16x16x32_bf16 v[192:195],a[132:135],a[4:7],v[192:195]
v_exp_f32 v160,v160
v_mfma_f32_16x16x32_bf16 v[192:195],a[136:139],a[8:11],v[192:195]
v_exp_f32 v161,v161
v_mfma_f32_16x16x32_bf16 v[192:195],a[140:143],a[12:15],v[192:195]
buffer_load_dwordx4 v1,s[12:15],s22 offen offset:1024 nt lds
v_cvt_pk_bf16_f32 v160,v160,v161
v_mfma_f32_16x16x32_bf16 v[200:203],a[140:143],a[28:31],0
v_fma_f32 v162,v162,s26,-v18
v_fma_f32 v163,v163,s26,-v18
v_mfma_f32_16x16x32_bf16 v[200:203],a[136:139],a[24:27],v[200:203]
ds_read_b64_tr_b16 a[96:97],v6 offset:49152
v_fma_f32 v164,v164,s26,-v18
v_mfma_f32_16x16x32_bf16 v[200:203],a[132:135],a[20:23],v[200:203]
ds_read_b64_tr_b16 a[98:99],v6 offset:50176
v_fma_f32 v165,v165,s26,-v18
v_mfma_f32_16x16x32_bf16 v[200:203],a[128:131],a[16:19],v[200:203]
v_exp_f32 v162,v162
v_mfma_f32_16x16x32_bf16 v[208:211],a[128:131],a[32:35],0
ds_read_b64_tr_b16 a[100:101],v6 offset:51200
v_fma_f32 v166,v166,s26,-v18
v_mfma_f32_16x16x32_bf16 v[208:211],a[132:135],a[36:39],v[208:211]
ds_read_b64_tr_b16 a[102:103],v6 offset:52224
v_fma_f32 v167,v167,s26,-v18
v_mfma_f32_16x16x32_bf16 v[208:211],a[136:139],a[40:43],v[208:211]
v_exp_f32 v163,v163
v_mfma_f32_16x16x32_bf16 v[208:211],a[140:143],a[44:47],v[208:211]
buffer_load_dwordx4 v1,s[12:15],s22 offen offset:2048 nt lds
v_cvt_pk_bf16_f32 v161,v162,v163
v_mfma_f32_16x16x32_bf16 v[216:219],a[140:143],a[60:63],0
ds_read_b64_tr_b16 a[104:105],v6 offset:49160
v_fma_f32 v168,v168,s26,-v19
v_mfma_f32_16x16x32_bf16 v[216:219],a[136:139],a[56:59],v[216:219]
ds_read_b64_tr_b16 a[106:107],v6 offset:50184
v_fma_f32 v169,v169,s26,-v19
v_mfma_f32_16x16x32_bf16 v[216:219],a[132:135],a[52:55],v[216:219]
v_exp_f32 v164,v164
v_mfma_f32_16x16x32_bf16 v[216:219],a[128:131],a[48:51],v[216:219]
s_waitcnt lgkmcnt(6)
v_exp_f32 v165,v165
v_fma_f32 v170,v170,s26,-v19
v_mfma_f32_16x16x32_bf16 v[196:199],a[144:147],a[0:3],0
ds_read_b64_tr_b16 a[108:109],v6 offset:51208
v_cvt_pk_bf16_f32 v162,v164,v165
v_mfma_f32_16x16x32_bf16 v[196:199],a[148:151],a[4:7],v[196:199]
ds_read_b64_tr_b16 a[110:111],v6 offset:52232
v_fma_f32 v171,v171,s26,-v19
v_mfma_f32_16x16x32_bf16 v[196:199],a[152:155],a[8:11],v[196:199]
v_exp_f32 v166,v166
v_mfma_f32_16x16x32_bf16 v[196:199],a[156:159],a[12:15],v[196:199]
ds_read_b64_tr_b16 a[112:113],v7 offset:49152
v_fma_f32 v172,v172,s26,-v19
v_mfma_f32_16x16x32_bf16 v[204:207],a[156:159],a[28:31],0
ds_read_b64_tr_b16 a[114:115],v7 offset:50176
v_fma_f32 v173,v173,s26,-v19
v_mfma_f32_16x16x32_bf16 v[204:207],a[152:155],a[24:27],v[204:207]
v_exp_f32 v167,v167
v_mfma_f32_16x16x32_bf16 v[204:207],a[148:151],a[20:23],v[204:207]
v_exp_f32 v168,v168
v_mfma_f32_16x16x32_bf16 v[204:207],a[144:147],a[16:19],v[204:207]
ds_read_b64_tr_b16 a[116:117],v7 offset:51200
v_exp_f32 v169,v169
v_mfma_f32_16x16x32_bf16 v[212:215],a[144:147],a[32:35],0
ds_read_b64_tr_b16 a[118:119],v7 offset:52224
v_cvt_pk_bf16_f32 v163,v166,v167
v_mfma_f32_16x16x32_bf16 v[212:215],a[148:151],a[36:39],v[212:215]
v_exp_f32 v170,v170
v_mfma_f32_16x16x32_bf16 v[212:215],a[152:155],a[40:43],v[212:215]
v_exp_f32 v171,v171
v_mfma_f32_16x16x32_bf16 v[212:215],a[156:159],a[44:47],v[212:215]
ds_read_b64_tr_b16 a[120:121],v7 offset:49160
v_exp_f32 v172,v172
v_mfma_f32_16x16x32_bf16 v[220:223],a[156:159],a[60:63],0
ds_read_b64_tr_b16 a[122:123],v7 offset:50184
v_cvt_pk_bf16_f32 v168,v168,v169
v_mfma_f32_16x16x32_bf16 v[220:223],a[152:155],a[56:59],v[220:223]
v_exp_f32 v173,v173
v_mfma_f32_16x16x32_bf16 v[220:223],a[148:151],a[52:55],v[220:223]
ds_read_b64_tr_b16 a[124:125],v7 offset:51208
v_cvt_pk_bf16_f32 v169,v170,v171
v_mfma_f32_16x16x32_bf16 v[220:223],a[144:147],a[48:51],v[220:223]
s_waitcnt lgkmcnt(14)
ds_read_b64_tr_b16 a[126:127],v7 offset:52232
v_cvt_pk_bf16_f32 v170,v172,v173
v_fma_f32 v174,v174,s26,-v19
v_mfma_f32_16x16x32_bf16 a[224:227],a[240:243],v[224:227],a[224:227]
v_exp_f32 v174,v174
v_mfma_f32_16x16x32_bf16 a[224:227],a[240:243],v[228:231],a[224:227]
buffer_load_dwordx4 v1,s[12:15],s22 offen offset:3072 nt lds
v_mfma_f32_16x16x32_bf16 a[228:231],a[240:243],v[232:235],a[228:231]
s_add_u32 s22,s22,16384
s_waitcnt lgkmcnt(14)
ds_read_b64_tr_b16 a[128:129],v8 offset:49152
v_mfma_f32_16x16x32_bf16 a[228:231],a[240:243],v[236:239],a[228:231]
s_waitcnt lgkmcnt(14)
ds_read_b64_tr_b16 a[130:131],v8 offset:50176
v_fma_f32 v175,v175,s26,-v19
v_fma_f32 v176,v176,s26,-v20
v_mfma_f32_16x16x32_bf16 a[232:235],a[240:243],v[240:243],a[232:235]
v_exp_f32 v175,v175
v_mfma_f32_16x16x32_bf16 a[232:235],a[240:243],v[244:247],a[232:235]
s_waitcnt lgkmcnt(14)
v_cvt_pk_bf16_f32 v171,v174,v175
v_exp_f32 v176,v176
v_mfma_f32_16x16x32_bf16 a[236:239],a[240:243],v[248:251],a[236:239]
ds_read_b64_tr_b16 a[132:133],v8 offset:51200
v_fma_f32 v177,v177,s26,-v20
v_mfma_f32_16x16x32_bf16 a[236:239],a[240:243],v[252:255],a[236:239]
s_waitcnt lgkmcnt(14)
ds_read_b64_tr_b16 a[134:135],v8 offset:52224
v_fma_f32 v178,v178,s26,-v20
v_mfma_f32_16x16x32_bf16 v[80:83],a[96:99],v[248:251],v[80:83]
v_exp_f32 v177,v177
v_mfma_f32_16x16x32_bf16 v[80:83],a[100:103],v[252:255],v[80:83]
s_waitcnt lgkmcnt(14)
ds_read_b64_tr_b16 a[136:137],v8 offset:49160
v_exp_f32 v178,v178
v_mfma_f32_16x16x32_bf16 v[64:67],a[100:103],v[244:247],v[64:67]
s_waitcnt lgkmcnt(14)
ds_read_b64_tr_b16 a[138:139],v8 offset:50184
v_cvt_pk_bf16_f32 v176,v176,v177
v_mfma_f32_16x16x32_bf16 v[64:67],a[96:99],v[240:243],v[64:67]
v_fma_f32 v179,v179,s26,-v20
v_fma_f32 v180,v180,s26,-v20
v_fma_f32 v181,v181,s26,-v20
v_mfma_f32_16x16x32_bf16 v[48:51],a[96:99],v[232:235],v[48:51]
v_exp_f32 v179,v179
v_mfma_f32_16x16x32_bf16 v[48:51],a[100:103],v[236:239],v[48:51]
s_waitcnt lgkmcnt(14)
ds_read_b64_tr_b16 a[140:141],v8 offset:51208
v_cvt_pk_bf16_f32 v177,v178,v179
v_mfma_f32_16x16x32_bf16 v[32:35],a[100:103],v[228:231],v[32:35]
s_waitcnt lgkmcnt(14)
ds_read_b64_tr_b16 a[142:143],v8 offset:52232
v_fma_f32 v182,v182,s26,-v20
v_mfma_f32_16x16x32_bf16 v[32:35],a[96:99],v[224:227],v[32:35]
v_exp_f32 v180,v180
v_fma_f32 v183,v183,s26,-v20
v_mfma_f32_16x16x32_bf16 v[36:39],a[104:107],v[224:227],v[36:39]
v_exp_f32 v181,v181
v_mfma_f32_16x16x32_bf16 v[36:39],a[108:111],v[228:231],v[36:39]
s_waitcnt lgkmcnt(14)
ds_read_b64_tr_b16 a[144:145],v9 offset:49152
v_exp_f32 v182,v182
v_mfma_f32_16x16x32_bf16 v[52:55],a[108:111],v[236:239],v[52:55]
s_waitcnt lgkmcnt(14)
ds_read_b64_tr_b16 a[146:147],v9 offset:50176
v_cvt_pk_bf16_f32 v178,v180,v181
v_mfma_f32_16x16x32_bf16 v[52:55],a[104:107],v[232:235],v[52:55]
v_exp_f32 v183,v183
v_mfma_f32_16x16x32_bf16 v[68:71],a[104:107],v[240:243],v[68:71]
s_waitcnt lgkmcnt(14)
ds_read_b64_tr_b16 a[148:149],v9 offset:51200
v_cvt_pk_bf16_f32 v179,v182,v183
v_mfma_f32_16x16x32_bf16 v[68:71],a[108:111],v[244:247],v[68:71]
s_waitcnt lgkmcnt(14)
ds_read_b64_tr_b16 a[150:151],v9 offset:52224
v_fma_f32 v184,v184,s26,-v21
v_fma_f32 v185,v185,s26,-v21
v_mfma_f32_16x16x32_bf16 v[84:87],a[108:111],v[252:255],v[84:87]
v_exp_f32 v184,v184
v_mfma_f32_16x16x32_bf16 v[84:87],a[104:107],v[248:251],v[84:87]
v_exp_f32 v185,v185
v_fma_f32 v186,v186,s26,-v21
v_mfma_f32_16x16x32_bf16 v[88:91],a[112:115],v[248:251],v[88:91]
s_waitcnt lgkmcnt(14)
ds_read_b64_tr_b16 a[152:153],v9 offset:49160
v_cvt_pk_bf16_f32 v184,v184,v185
v_mfma_f32_16x16x32_bf16 v[88:91],a[116:119],v[252:255],v[88:91]
s_waitcnt lgkmcnt(14)
ds_read_b64_tr_b16 a[154:155],v9 offset:50184
v_exp_f32 v186,v186
v_mfma_f32_16x16x32_bf16 v[72:75],a[116:119],v[244:247],v[72:75]
v_fma_f32 v187,v187,s26,-v21
v_fma_f32 v188,v188,s26,-v21
v_mfma_f32_16x16x32_bf16 v[72:75],a[112:115],v[240:243],v[72:75]
s_waitcnt lgkmcnt(14)
ds_read_b64_tr_b16 a[156:157],v9 offset:51208
v_fma_f32 v189,v189,s26,-v21
v_mfma_f32_16x16x32_bf16 v[56:59],a[112:115],v[232:235],v[56:59]
s_waitcnt lgkmcnt(14)
ds_read_b64_tr_b16 a[158:159],v9 offset:52232
v_fma_f32 v190,v190,s26,-v21
v_mfma_f32_16x16x32_bf16 v[56:59],a[116:119],v[236:239],v[56:59]
v_exp_f32 v187,v187
v_fma_f32 v191,v191,s26,-v21
v_mfma_f32_16x16x32_bf16 v[40:43],a[116:119],v[228:231],v[40:43]
v_exp_f32 v188,v188
v_mfma_f32_16x16x32_bf16 v[40:43],a[112:115],v[224:227],v[40:43]
v_cvt_pk_bf16_f32 v185,v186,v187
v_exp_f32 v189,v189
v_mfma_f32_16x16x32_bf16 v[44:47],a[120:123],v[224:227],v[44:47]
v_exp_f32 v190,v190
v_mfma_f32_16x16x32_bf16 v[44:47],a[124:127],v[228:231],v[44:47]
v_exp_f32 v191,v191
v_mfma_f32_16x16x32_bf16 v[60:63],a[124:127],v[236:239],v[60:63]
v_cvt_pk_bf16_f32 v186,v188,v189
v_cvt_pk_bf16_f32 v187,v190,v191
v_mfma_f32_16x16x32_bf16 v[60:63],a[120:123],v[232:235],v[60:63]
v_mfma_f32_16x16x32_bf16 v[76:79],a[120:123],v[240:243],v[76:79]
v_fma_f32 v192,v192,s26,-v18
v_fma_f32 v193,v193,s26,-v18
v_mfma_f32_16x16x32_bf16 v[76:79],a[124:127],v[244:247],v[76:79]
v_exp_f32 v192,v192
v_mfma_f32_16x16x32_bf16 v[92:95],a[124:127],v[252:255],v[92:95]
v_exp_f32 v193,v193
v_mfma_f32_16x16x32_bf16 v[92:95],a[120:123],v[248:251],v[92:95]
s_waitcnt lgkmcnt(12)
v_cvt_pk_bf16_f32 v164,v192,v193
v_fma_f32 v194,v194,s26,-v18
v_mfma_f32_16x16x32_bf16 a[208:211],a[128:131],v[248:251],a[208:211]
v_exp_f32 v194,v194
v_mfma_f32_16x16x32_bf16 a[208:211],a[132:135],v[252:255],a[208:211]
v_fma_f32 v195,v195,s26,-v18
v_fma_f32 v196,v196,s26,-v18
v_mfma_f32_16x16x32_bf16 a[192:195],a[132:135],v[244:247],a[192:195]
v_exp_f32 v195,v195
v_mfma_f32_16x16x32_bf16 a[192:195],a[128:131],v[240:243],a[192:195]
s_waitcnt vmcnt(16)
s_waitcnt lgkmcnt(0)
s_barrier
ds_read_b128 a[96:99],v2 offset:16384
v_exp_f32 v196,v196
v_mfma_f32_16x16x32_bf16 a[176:179],a[128:131],v[232:235],a[176:179]
s_add_u32 m0,s25,114688
v_cvt_pk_bf16_f32 v165,v194,v195
v_fma_f32 v197,v197,s26,-v18
v_mfma_f32_16x16x32_bf16 a[176:179],a[132:135],v[236:239],a[176:179]
buffer_load_dwordx4 v1,s[12:15],s22 offen nt lds
v_mfma_f32_16x16x32_bf16 a[160:163],a[132:135],v[228:231],a[160:163]
v_exp_f32 v197,v197
v_mfma_f32_16x16x32_bf16 a[160:163],a[128:131],v[224:227],a[160:163]
ds_read_b128 a[100:103],v3 offset:16384
v_cvt_pk_bf16_f32 v166,v196,v197
v_mfma_f32_16x16x32_bf16 a[164:167],a[136:139],v[224:227],a[164:167]
v_fma_f32 v198,v198,s26,-v18
v_fma_f32 v199,v199,s26,-v18
v_mfma_f32_16x16x32_bf16 a[164:167],a[140:143],v[228:231],a[164:167]
v_exp_f32 v198,v198
v_mfma_f32_16x16x32_bf16 a[180:183],a[140:143],v[236:239],a[180:183]
ds_read_b128 a[104:107],v4 offset:16384
v_fma_f32 v200,v200,s26,-v19
v_mfma_f32_16x16x32_bf16 a[180:183],a[136:139],v[232:235],a[180:183]
v_exp_f32 v199,v199
v_mfma_f32_16x16x32_bf16 a[196:199],a[136:139],v[240:243],a[196:199]
v_exp_f32 v200,v200
v_mfma_f32_16x16x32_bf16 a[196:199],a[140:143],v[244:247],a[196:199]
buffer_load_dwordx4 v1,s[12:15],s22 offen offset:1024 nt lds
v_mfma_f32_16x16x32_bf16 a[212:215],a[140:143],v[252:255],a[212:215]
ds_read_b128 a[108:111],v5 offset:16384
v_cvt_pk_bf16_f32 v167,v198,v199
v_mfma_f32_16x16x32_bf16 a[212:215],a[136:139],v[248:251],a[212:215]
v_fma_f32 v201,v201,s26,-v19
v_fma_f32 v202,v202,s26,-v19
v_fma_f32 v203,v203,s26,-v19
v_mfma_f32_16x16x32_bf16 a[216:219],a[144:147],v[248:251],a[216:219]
v_exp_f32 v201,v201
v_mfma_f32_16x16x32_bf16 a[216:219],a[148:151],v[252:255],a[216:219]
v_exp_f32 v202,v202
v_mfma_f32_16x16x32_bf16 a[200:203],a[148:151],v[244:247],a[200:203]
ds_read_b128 a[112:115],v2 offset:17408
v_cvt_pk_bf16_f32 v172,v200,v201
v_mfma_f32_16x16x32_bf16 a[200:203],a[144:147],v[240:243],a[200:203]
v_exp_f32 v203,v203
v_mfma_f32_16x16x32_bf16 a[184:187],a[144:147],v[232:235],a[184:187]
v_cvt_pk_bf16_f32 v173,v202,v203
v_fma_f32 v204,v204,s26,-v19
v_mfma_f32_16x16x32_bf16 a[184:187],a[148:151],v[236:239],a[184:187]
ds_read_b128 a[116:119],v3 offset:17408
v_fma_f32 v205,v205,s26,-v19
v_mfma_f32_16x16x32_bf16 a[168:171],a[148:151],v[228:231],a[168:171]
v_exp_f32 v204,v204
v_mfma_f32_16x16x32_bf16 a[168:171],a[144:147],v[224:227],a[168:171]
v_exp_f32 v205,v205
v_mfma_f32_16x16x32_bf16 a[172:175],a[152:155],v[224:227],a[172:175]
v_cvt_pk_bf16_f32 v174,v204,v205
v_fma_f32 v206,v206,s26,-v19
v_mfma_f32_16x16x32_bf16 a[172:175],a[156:159],v[228:231],a[172:175]
ds_read_b128 a[120:123],v4 offset:17408
v_fma_f32 v207,v207,s26,-v19
v_mfma_f32_16x16x32_bf16 a[188:191],a[156:159],v[236:239],a[188:191]
v_exp_f32 v206,v206
v_mfma_f32_16x16x32_bf16 a[188:191],a[152:155],v[232:235],a[188:191]
buffer_load_dwordx4 v1,s[12:15],s22 offen offset:2048 nt lds
v_mfma_f32_16x16x32_bf16 a[204:207],a[152:155],v[240:243],a[204:207]
v_exp_f32 v207,v207
v_mfma_f32_16x16x32_bf16 a[204:207],a[156:159],v[244:247],a[204:207]
ds_read_b128 a[124:127],v5 offset:17408
v_cvt_pk_bf16_f32 v175,v206,v207
v_fma_f32 v208,v208,s26,-v20
v_mfma_f32_16x16x32_bf16 a[220:223],a[156:159],v[252:255],a[220:223]
v_exp_f32 v208,v208
v_mfma_f32_16x16x32_bf16 a[220:223],a[152:155],v[248:251],a[220:223]
s_waitcnt lgkmcnt(4)
v_fma_f32 v209,v209,s26,-v20
v_fma_f32 v210,v210,s26,-v20
v_mfma_f32_16x16x32_bf16 v[224:227],a[96:99],a[0:3],0
ds_read_b128 a[128:131],v2 offset:18432
v_fma_f32 v211,v211,s26,-v20
v_mfma_f32_16x16x32_bf16 v[224:227],a[100:103],a[4:7],v[224:227]
v_exp_f32 v209,v209
v_mfma_f32_16x16x32_bf16 v[224:227],a[104:107],a[8:11],v[224:227]
v_exp_f32 v210,v210
v_mfma_f32_16x16x32_bf16 v[224:227],a[108:111],a[12:15],v[224:227]
buffer_load_dwordx4 v1,s[12:15],s22 offen offset:3072 nt lds
v_mfma_f32_16x16x32_bf16 v[232:235],a[108:111],a[28:31],0
s_add_u32 s22,s22,16384
ds_read_b128 a[132:135],v3 offset:18432
v_mfma_f32_16x16x32_bf16 v[232:235],a[104:107],a[24:27],v[232:235]
v_exp_f32 v211,v211
v_mfma_f32_16x16x32_bf16 v[232:235],a[100:103],a[20:23],v[232:235]
v_cvt_pk_bf16_f32 v180,v208,v209
v_cvt_pk_bf16_f32 v181,v210,v211
v_mfma_f32_16x16x32_bf16 v[232:235],a[96:99],a[16:19],v[232:235]
v_fma_f32 v212,v212,s26,-v20
v_fma_f32 v213,v213,s26,-v20
v_mfma_f32_16x16x32_bf16 v[240:243],a[96:99],a[32:35],0
ds_read_b128 a[136:139],v4 offset:18432
v_fma_f32 v214,v214,s26,-v20
v_mfma_f32_16x16x32_bf16 v[240:243],a[100:103],a[36:39],v[240:243]
v_exp_f32 v212,v212
v_mfma_f32_16x16x32_bf16 v[240:243],a[104:107],a[40:43],v[240:243]
v_exp_f32 v213,v213
v_mfma_f32_16x16x32_bf16 v[240:243],a[108:111],a[44:47],v[240:243]
ds_read_b128 a[140:143],v5 offset:18432
v_cvt_pk_bf16_f32 v182,v212,v213
v_mfma_f32_16x16x32_bf16 v[248:251],a[108:111],a[60:63],0
v_exp_f32 v214,v214
v_mfma_f32_16x16x32_bf16 v[248:251],a[104:107],a[56:59],v[248:251]
v_fma_f32 v215,v215,s26,-v20
v_fma_f32 v216,v216,s26,-v21
v_mfma_f32_16x16x32_bf16 v[248:251],a[100:103],a[52:55],v[248:251]
s_waitcnt lgkmcnt(4)
v_exp_f32 v215,v215
v_mfma_f32_16x16x32_bf16 v[248:251],a[96:99],a[48:51],v[248:251]
ds_read_b128 a[144:147],v2 offset:19456
v_cvt_pk_bf16_f32 v183,v214,v215
v_mfma_f32_16x16x32_bf16 v[228:231],a[112:115],a[0:3],0
v_exp_f32 v216,v216
v_mfma_f32_16x16x32_bf16 v[228:231],a[116:119],a[4:7],v[228:231]
v_fma_f32 v217,v217,s26,-v21
v_fma_f32 v218,v218,s26,-v21
v_mfma_f32_16x16x32_bf16 v[228:231],a[120:123],a[8:11],v[228:231]
v_exp_f32 v217,v217
v_mfma_f32_16x16x32_bf16 v[228:231],a[124:127],a[12:15],v[228:231]
ds_read_b128 a[148:151],v3 offset:19456
v_exp_f32 v218,v218
v_mfma_f32_16x16x32_bf16 v[236:239],a[124:127],a[28:31],0
v_cvt_pk_bf16_f32 v188,v216,v217
v_fma_f32 v219,v219,s26,-v21
v_mfma_f32_16x16x32_bf16 v[236:239],a[120:123],a[24:27],v[236:239]
v_exp_f32 v219,v219
v_mfma_f32_16x16x32_bf16 v[236:239],a[116:119],a[20:23],v[236:239]
ds_read_b128 a[152:155],v4 offset:19456
v_cvt_pk_bf16_f32 v189,v218,v219
v_mfma_f32_16x16x32_bf16 v[236:239],a[112:115],a[16:19],v[236:239]
v_fma_f32 v220,v220,s26,-v21
v_fma_f32 v221,v221,s26,-v21
v_mfma_f32_16x16x32_bf16 v[244:247],a[112:115],a[32:35],0
v_exp_f32 v220,v220
v_mfma_f32_16x16x32_bf16 v[244:247],a[116:119],a[36:39],v[244:247]
v_exp_f32 v221,v221
v_mfma_f32_16x16x32_bf16 v[244:247],a[120:123],a[40:43],v[244:247]
ds_read_b128 a[156:159],v5 offset:19456
v_cvt_pk_bf16_f32 v190,v220,v221
v_mfma_f32_16x16x32_bf16 v[244:247],a[124:127],a[44:47],v[244:247]
v_fma_f32 v222,v222,s26,-v21
v_fma_f32 v223,v223,s26,-v21
v_mfma_f32_16x16x32_bf16 v[252:255],a[124:127],a[60:63],0
v_exp_f32 v222,v222
v_mfma_f32_16x16x32_bf16 v[252:255],a[120:123],a[56:59],v[252:255]
v_exp_f32 v223,v223
v_mfma_f32_16x16x32_bf16 v[252:255],a[116:119],a[52:55],v[252:255]
v_cvt_pk_bf16_f32 v191,v222,v223
v_mfma_f32_16x16x32_bf16 v[252:255],a[112:115],a[48:51],v[252:255]
s_waitcnt lgkmcnt(4)
v_mfma_f32_16x16x32_bf16 v[192:195],a[128:131],a[0:3],0
v_fma_f32 v224,v224,s26,-v18
v_fma_f32 v225,v225,s26,-v18
v_mfma_f32_16x16x32_bf16 v[192:195],a[132:135],a[4:7],v[192:195]
v_exp_f32 v224,v224
v_mfma_f32_16x16x32_bf16 v[192:195],a[136:139],a[8:11],v[192:195]
v_exp_f32 v225,v225
v_mfma_f32_16x16x32_bf16 v[192:195],a[140:143],a[12:15],v[192:195]
v_cvt_pk_bf16_f32 v224,v224,v225
v_fma_f32 v226,v226,s26,-v18
v_mfma_f32_16x16x32_bf16 v[200:203],a[140:143],a[28:31],0
v_exp_f32 v226,v226
v_mfma_f32_16x16x32_bf16 v[200:203],a[136:139],a[24:27],v[200:203]
ds_read_b64_tr_b16 a[96:97],v6 offset:0
v_fma_f32 v227,v227,s26,-v18
v_mfma_f32_16x16x32_bf16 v[200:203],a[132:135],a[20:23],v[200:203]
ds_read_b64_tr_b16 a[98:99],v6 offset:1024
v_fma_f32 v228,v228,s26,-v18
v_mfma_f32_16x16x32_bf16 v[200:203],a[128:131],a[16:19],v[200:203]
v_exp_f32 v227,v227
v_fma_f32 v229,v229,s26,-v18
v_mfma_f32_16x16x32_bf16 v[208:211],a[128:131],a[32:35],0
ds_read_b64_tr_b16 a[100:101],v6 offset:2048
v_cvt_pk_bf16_f32 v225,v226,v227
v_mfma_f32_16x16x32_bf16 v[208:211],a[132:135],a[36:39],v[208:211]
ds_read_b64_tr_b16 a[102:103],v6 offset:3072
v_fma_f32 v230,v230,s26,-v18
v_mfma_f32_16x16x32_bf16 v[208:211],a[136:139],a[40:43],v[208:211]
v_exp_f32 v228,v228
v_mfma_f32_16x16x32_bf16 v[208:211],a[140:143],a[44:47],v[208:211]
v_exp_f32 v229,v229
v_mfma_f32_16x16x32_bf16 v[216:219],a[140:143],a[60:63],0
ds_read_b64_tr_b16 a[104:105],v6 offset:8
v_cvt_pk_bf16_f32 v226,v228,v229
v_mfma_f32_16x16x32_bf16 v[216:219],a[136:139],a[56:59],v[216:219]
ds_read_b64_tr_b16 a[106:107],v6 offset:1032
v_fma_f32 v231,v231,s26,-v18
v_mfma_f32_16x16x32_bf16 v[216:219],a[132:135],a[52:55],v[216:219]
v_exp_f32 v230,v230
v_mfma_f32_16x16x32_bf16 v[216:219],a[128:131],a[48:51],v[216:219]
s_waitcnt lgkmcnt(6)
v_exp_f32 v231,v231
v_fma_f32 v232,v232,s26,-v19
v_mfma_f32_16x16x32_bf16 v[196:199],a[144:147],a[0:3],0
ds_read_b64_tr_b16 a[108:109],v6 offset:2056
v_cvt_pk_bf16_f32 v227,v230,v231
v_mfma_f32_16x16x32_bf16 v[196:199],a[148:151],a[4:7],v[196:199]
ds_read_b64_tr_b16 a[110:111],v6 offset:3080
v_fma_f32 v233,v233,s26,-v19
v_mfma_f32_16x16x32_bf16 v[196:199],a[152:155],a[8:11],v[196:199]
v_exp_f32 v232,v232
v_mfma_f32_16x16x32_bf16 v[196:199],a[156:159],a[12:15],v[196:199]
ds_read_b64_tr_b16 a[112:113],v7 offset:0
v_fma_f32 v234,v234,s26,-v19
v_mfma_f32_16x16x32_bf16 v[204:207],a[156:159],a[28:31],0
ds_read_b64_tr_b16 a[114:115],v7 offset:1024
v_fma_f32 v235,v235,s26,-v19
v_mfma_f32_16x16x32_bf16 v[204:207],a[152:155],a[24:27],v[204:207]
v_exp_f32 v233,v233
v_mfma_f32_16x16x32_bf16 v[204:207],a[148:151],a[20:23],v[204:207]
v_exp_f32 v234,v234
v_mfma_f32_16x16x32_bf16 v[204:207],a[144:147],a[16:19],v[204:207]
ds_read_b64_tr_b16 a[116:117],v7 offset:2048
v_cvt_pk_bf16_f32 v232,v232,v233
v_mfma_f32_16x16x32_bf16 v[212:215],a[144:147],a[32:35],0
ds_read_b64_tr_b16 a[118:119],v7 offset:3072
v_fma_f32 v236,v236,s26,-v19
v_mfma_f32_16x16x32_bf16 v[212:215],a[148:151],a[36:39],v[212:215]
v_exp_f32 v235,v235
v_mfma_f32_16x16x32_bf16 v[212:215],a[152:155],a[40:43],v[212:215]
v_exp_f32 v236,v236
v_mfma_f32_16x16x32_bf16 v[212:215],a[156:159],a[44:47],v[212:215]
ds_read_b64_tr_b16 a[120:121],v7 offset:8
v_cvt_pk_bf16_f32 v233,v234,v235
v_fma_f32 v237,v237,s26,-v19
v_mfma_f32_16x16x32_bf16 v[220:223],a[156:159],a[60:63],0
ds_read_b64_tr_b16 a[122:123],v7 offset:1032
v_fma_f32 v238,v238,s26,-v19
v_mfma_f32_16x16x32_bf16 v[220:223],a[152:155],a[56:59],v[220:223]
v_exp_f32 v237,v237
v_mfma_f32_16x16x32_bf16 v[220:223],a[148:151],a[52:55],v[220:223]
ds_read_b64_tr_b16 a[124:125],v7 offset:2056
v_cvt_pk_bf16_f32 v234,v236,v237
v_mfma_f32_16x16x32_bf16 v[220:223],a[144:147],a[48:51],v[220:223]
s_waitcnt lgkmcnt(14)
ds_read_b64_tr_b16 a[126:127],v7 offset:3080
v_fma_f32 v239,v239,s26,-v19
v_mfma_f32_16x16x32_bf16 a[224:227],a[240:243],v[160:163],a[224:227]
v_exp_f32 v238,v238
v_mfma_f32_16x16x32_bf16 a[224:227],a[240:243],v[164:167],a[224:227]
v_exp_f32 v239,v239
v_mfma_f32_16x16x32_bf16 a[228:231],a[240:243],v[168:171],a[228:231]
s_waitcnt lgkmcnt(14)
ds_read_b64_tr_b16 a[128:129],v8 offset:0
v_cvt_pk_bf16_f32 v235,v238,v239
v_mfma_f32_16x16x32_bf16 a[228:231],a[240:243],v[172:175],a[228:231]
s_waitcnt lgkmcnt(14)
ds_read_b64_tr_b16 a[130:131],v8 offset:1024
v_fma_f32 v240,v240,s26,-v20
v_fma_f32 v241,v241,s26,-v20
v_mfma_f32_16x16x32_bf16 a[232:235],a[240:243],v[176:179],a[232:235]
v_exp_f32 v240,v240
v_mfma_f32_16x16x32_bf16 a[232:235],a[240:243],v[180:183],a[232:235]
s_waitcnt lgkmcnt(14)
v_exp_f32 v241,v241
v_mfma_f32_16x16x32_bf16 a[236:239],a[240:243],v[184:187],a[236:239]
ds_read_b64_tr_b16 a[132:133],v8 offset:2048
v_cvt_pk_bf16_f32 v240,v240,v241
v_mfma_f32_16x16x32_bf16 a[236:239],a[240:243],v[188:191],a[236:239]
s_waitcnt lgkmcnt(14)
ds_read_b64_tr_b16 a[134:135],v8 offset:3072
v_fma_f32 v242,v242,s26,-v20
v_fma_f32 v243,v243,s26,-v20
v_mfma_f32_16x16x32_bf16 v[80:83],a[96:99],v[184:187],v[80:83]
v_exp_f32 v242,v242
v_mfma_f32_16x16x32_bf16 v[80:83],a[100:103],v[188:191],v[80:83]
s_waitcnt lgkmcnt(14)
ds_read_b64_tr_b16 a[136:137],v8 offset:8
v_fma_f32 v244,v244,s26,-v20
v_mfma_f32_16x16x32_bf16 v[64:67],a[100:103],v[180:183],v[64:67]
s_waitcnt lgkmcnt(14)
ds_read_b64_tr_b16 a[138:139],v8 offset:1032
v_fma_f32 v245,v245,s26,-v20
v_mfma_f32_16x16x32_bf16 v[64:67],a[96:99],v[176:179],v[64:67]
v_exp_f32 v243,v243
v_mfma_f32_16x16x32_bf16 v[48:51],a[96:99],v[168:171],v[48:51]
v_exp_f32 v244,v244
v_mfma_f32_16x16x32_bf16 v[48:51],a[100:103],v[172:175],v[48:51]
s_waitcnt lgkmcnt(14)
ds_read_b64_tr_b16 a[140:141],v8 offset:2056
v_exp_f32 v245,v245
v_mfma_f32_16x16x32_bf16 v[32:35],a[100:103],v[164:167],v[32:35]
s_waitcnt lgkmcnt(14)
ds_read_b64_tr_b16 a[142:143],v8 offset:3080
v_cvt_pk_bf16_f32 v241,v242,v243
v_mfma_f32_16x16x32_bf16 v[32:35],a[96:99],v[160:163],v[32:35]
v_cvt_pk_bf16_f32 v242,v244,v245
v_fma_f32 v246,v246,s26,-v20
v_mfma_f32_16x16x32_bf16 v[36:39],a[104:107],v[160:163],v[36:39]
v_exp_f32 v246,v246
v_mfma_f32_16x16x32_bf16 v[36:39],a[108:111],v[164:167],v[36:39]
s_waitcnt lgkmcnt(14)
ds_read_b64_tr_b16 a[144:145],v9 offset:0
v_fma_f32 v247,v247,s26,-v20
v_fma_f32 v248,v248,s26,-v21
v_mfma_f32_16x16x32_bf16 v[52:55],a[108:111],v[172:175],v[52:55]
s_waitcnt lgkmcnt(14)
ds_read_b64_tr_b16 a[146:147],v9 offset:1024
v_fma_f32 v249,v249,s26,-v21
v_mfma_f32_16x16x32_bf16 v[52:55],a[104:107],v[168:171],v[52:55]
v_exp_f32 v247,v247
v_mfma_f32_16x16x32_bf16 v[68:71],a[104:107],v[176:179],v[68:71]
s_waitcnt lgkmcnt(14)
ds_read_b64_tr_b16 a[148:149],v9 offset:2048
v_cvt_pk_bf16_f32 v243,v246,v247
v_mfma_f32_16x16x32_bf16 v[68:71],a[108:111],v[180:183],v[68:71]
s_waitcnt lgkmcnt(14)
ds_read_b64_tr_b16 a[150:151],v9 offset:3072
v_fma_f32 v250,v250,s26,-v21
v_mfma_f32_16x16x32_bf16 v[84:87],a[108:111],v[188:191],v[84:87]
v_exp_f32 v248,v248
v_mfma_f32_16x16x32_bf16 v[84:87],a[104:107],v[184:187],v[84:87]
v_exp_f32 v249,v249
v_fma_f32 v251,v251,s26,-v21
v_mfma_f32_16x16x32_bf16 v[88:91],a[112:115],v[184:187],v[88:91]
s_waitcnt lgkmcnt(14)
ds_read_b64_tr_b16 a[152:153],v9 offset:8
v_cvt_pk_bf16_f32 v248,v248,v249
v_mfma_f32_16x16x32_bf16 v[88:91],a[116:119],v[188:191],v[88:91]
s_waitcnt lgkmcnt(14)
ds_read_b64_tr_b16 a[154:155],v9 offset:1032
v_fma_f32 v252,v252,s26,-v21
v_mfma_f32_16x16x32_bf16 v[72:75],a[116:119],v[180:183],v[72:75]
v_exp_f32 v250,v250
v_mfma_f32_16x16x32_bf16 v[72:75],a[112:115],v[176:179],v[72:75]
s_waitcnt lgkmcnt(14)
ds_read_b64_tr_b16 a[156:157],v9 offset:2056
v_fma_f32 v253,v253,s26,-v21
v_mfma_f32_16x16x32_bf16 v[56:59],a[112:115],v[168:171],v[56:59]
s_waitcnt lgkmcnt(14)
ds_read_b64_tr_b16 a[158:159],v9 offset:3080
v_fma_f32 v254,v254,s26,-v21
v_mfma_f32_16x16x32_bf16 v[56:59],a[116:119],v[172:175],v[56:59]
v_exp_f32 v251,v251
v_fma_f32 v255,v255,s26,-v21
v_mfma_f32_16x16x32_bf16 v[40:43],a[116:119],v[164:167],v[40:43]
v_exp_f32 v252,v252
v_mfma_f32_16x16x32_bf16 v[40:43],a[112:115],v[160:163],v[40:43]
v_exp_f32 v253,v253
v_mfma_f32_16x16x32_bf16 v[44:47],a[120:123],v[160:163],v[44:47]
v_exp_f32 v254,v254
v_mfma_f32_16x16x32_bf16 v[44:47],a[124:127],v[164:167],v[44:47]
v_cvt_pk_bf16_f32 v249,v250,v251
v_exp_f32 v255,v255
v_mfma_f32_16x16x32_bf16 v[60:63],a[124:127],v[172:175],v[60:63]
v_cvt_pk_bf16_f32 v250,v252,v253
v_cvt_pk_bf16_f32 v251,v254,v255
v_mfma_f32_16x16x32_bf16 v[60:63],a[120:123],v[168:171],v[60:63]
v_mfma_f32_16x16x32_bf16 v[76:79],a[120:123],v[176:179],v[76:79]
v_fma_f32 v192,v192,s26,-v18
v_fma_f32 v193,v193,s26,-v18
v_mfma_f32_16x16x32_bf16 v[76:79],a[124:127],v[180:183],v[76:79]
v_exp_f32 v192,v192
v_mfma_f32_16x16x32_bf16 v[92:95],a[124:127],v[188:191],v[92:95]
v_exp_f32 v193,v193
v_mfma_f32_16x16x32_bf16 v[92:95],a[120:123],v[184:187],v[92:95]
s_waitcnt lgkmcnt(12)
v_cvt_pk_bf16_f32 v228,v192,v193
v_fma_f32 v194,v194,s26,-v18
v_mfma_f32_16x16x32_bf16 a[208:211],a[128:131],v[184:187],a[208:211]
v_exp_f32 v194,v194
v_mfma_f32_16x16x32_bf16 a[208:211],a[132:135],v[188:191],a[208:211]
v_fma_f32 v195,v195,s26,-v18
v_fma_f32 v196,v196,s26,-v18
v_mfma_f32_16x16x32_bf16 a[192:195],a[132:135],v[180:183],a[192:195]
v_exp_f32 v195,v195
v_mfma_f32_16x16x32_bf16 a[192:195],a[128:131],v[176:179],a[192:195]
s_waitcnt vmcnt(12)
s_waitcnt lgkmcnt(0)
s_barrier
ds_read_b128 a[96:99],v2 offset:32768
v_cvt_pk_bf16_f32 v229,v194,v195
v_mfma_f32_16x16x32_bf16 a[176:179],a[128:131],v[168:171],a[176:179]
v_exp_f32 v196,v196
v_mfma_f32_16x16x32_bf16 a[176:179],a[132:135],v[172:175],a[176:179]
v_fma_f32 v197,v197,s26,-v18
v_fma_f32 v198,v198,s26,-v18
v_fma_f32 v199,v199,s26,-v18
v_mfma_f32_16x16x32_bf16 a[160:163],a[132:135],v[164:167],a[160:163]
v_exp_f32 v197,v197
v_mfma_f32_16x16x32_bf16 a[160:163],a[128:131],v[160:163],a[160:163]
ds_read_b128 a[100:103],v3 offset:32768
v_cvt_pk_bf16_f32 v230,v196,v197
v_mfma_f32_16x16x32_bf16 a[164:167],a[136:139],v[160:163],a[164:167]
s_add_u32 s30,s24,4294901760
s_add_u32 s32,s24,4294905856
v_fma_f32 v200,v200,s26,-v19
v_mfma_f32_16x16x32_bf16 a[164:167],a[140:143],v[164:167],a[164:167]
buffer_store_dwordx4 a[64:67],v22,s[16:19],s30 offen sc0 sc1
buffer_store_dwordx4 a[68:71],v22,s[16:19],s32 offen sc0 sc1
v_mfma_f32_16x16x32_bf16 a[180:183],a[140:143],v[172:175],a[180:183]
ds_read_b128 a[104:107],v4 offset:32768
v_fma_f32 v201,v201,s26,-v19
v_mfma_f32_16x16x32_bf16 a[180:183],a[136:139],v[168:171],a[180:183]
v_exp_f32 v198,v198
v_mfma_f32_16x16x32_bf16 a[196:199],a[136:139],v[176:179],a[196:199]
v_exp_f32 v199,v199
v_mfma_f32_16x16x32_bf16 a[196:199],a[140:143],v[180:183],a[196:199]
v_exp_f32 v200,v200
v_mfma_f32_16x16x32_bf16 a[212:215],a[140:143],v[188:191],a[212:215]
ds_read_b128 a[108:111],v5 offset:32768
v_cvt_pk_bf16_f32 v231,v198,v199
v_mfma_f32_16x16x32_bf16 a[212:215],a[136:139],v[184:187],a[212:215]
v_exp_f32 v201,v201
v_mfma_f32_16x16x32_bf16 a[216:219],a[144:147],v[184:187],a[216:219]
v_cvt_pk_bf16_f32 v236,v200,v201
v_fma_f32 v202,v202,s26,-v19
v_mfma_f32_16x16x32_bf16 a[216:219],a[148:151],v[188:191],a[216:219]
v_exp_f32 v202,v202
v_mfma_f32_16x16x32_bf16 a[200:203],a[148:151],v[180:183],a[200:203]
ds_read_b128 a[112:115],v2 offset:33792
v_fma_f32 v203,v203,s26,-v19
v_mfma_f32_16x16x32_bf16 a[200:203],a[144:147],v[176:179],a[200:203]
v_exp_f32 v203,v203
v_mfma_f32_16x16x32_bf16 a[184:187],a[144:147],v[168:171],a[184:187]
v_cvt_pk_bf16_f32 v237,v202,v203
v_fma_f32 v204,v204,s26,-v19
v_mfma_f32_16x16x32_bf16 a[184:187],a[148:151],v[172:175],a[184:187]
ds_read_b128 a[116:119],v3 offset:33792
v_fma_f32 v205,v205,s26,-v19
v_mfma_f32_16x16x32_bf16 a[168:171],a[148:151],v[164:167],a[168:171]
v_exp_f32 v204,v204
v_mfma_f32_16x16x32_bf16 a[168:171],a[144:147],v[160:163],a[168:171]
v_exp_f32 v205,v205
v_fma_f32 v206,v206,s26,-v19
v_mfma_f32_16x16x32_bf16 a[172:175],a[152:155],v[160:163],a[172:175]
v_exp_f32 v206,v206
v_mfma_f32_16x16x32_bf16 a[172:175],a[156:159],v[164:167],a[172:175]
ds_read_b128 a[120:123],v4 offset:33792
v_cvt_pk_bf16_f32 v238,v204,v205
v_mfma_f32_16x16x32_bf16 a[188:191],a[156:159],v[172:175],a[188:191]
s_add_u32 s30,s24,4294909952
s_add_u32 s32,s24,4294914048
v_fma_f32 v207,v207,s26,-v19
v_mfma_f32_16x16x32_bf16 a[188:191],a[152:155],v[168:171],a[188:191]
buffer_store_dwordx4 a[72:75],v22,s[16:19],s30 offen sc0 sc1
buffer_store_dwordx4 a[76:79],v22,s[16:19],s32 offen sc0 sc1
v_mfma_f32_16x16x32_bf16 a[204:207],a[152:155],v[176:179],a[204:207]
v_exp_f32 v207,v207
v_mfma_f32_16x16x32_bf16 a[204:207],a[156:159],v[180:183],a[204:207]
ds_read_b128 a[124:127],v5 offset:33792
v_cvt_pk_bf16_f32 v239,v206,v207
v_mfma_f32_16x16x32_bf16 a[220:223],a[156:159],v[188:191],a[220:223]
v_fma_f32 v208,v208,s26,-v20
v_fma_f32 v209,v209,s26,-v20
v_mfma_f32_16x16x32_bf16 a[220:223],a[152:155],v[184:187],a[220:223]
s_waitcnt lgkmcnt(4)
v_exp_f32 v208,v208
v_mfma_f32_16x16x32_bf16 v[160:163],a[96:99],a[0:3],0
ds_read_b128 a[128:131],v2 offset:34816
v_fma_f32 v210,v210,s26,-v20
v_mfma_f32_16x16x32_bf16 v[160:163],a[100:103],a[4:7],v[160:163]
v_exp_f32 v209,v209
v_mfma_f32_16x16x32_bf16 v[160:163],a[104:107],a[8:11],v[160:163]
v_exp_f32 v210,v210
v_mfma_f32_16x16x32_bf16 v[160:163],a[108:111],a[12:15],v[160:163]
v_cvt_pk_bf16_f32 v244,v208,v209
v_fma_f32 v211,v211,s26,-v20
v_mfma_f32_16x16x32_bf16 v[168:171],a[108:111],a[28:31],0
ds_read_b128 a[132:135],v3 offset:34816
v_fma_f32 v212,v212,s26,-v20
v_mfma_f32_16x16x32_bf16 v[168:171],a[104:107],a[24:27],v[168:171]
v_exp_f32 v211,v211
v_mfma_f32_16x16x32_bf16 v[168:171],a[100:103],a[20:23],v[168:171]
v_exp_f32 v212,v212
v_mfma_f32_16x16x32_bf16 v[168:171],a[96:99],a[16:19],v[168:171]
v_cvt_pk_bf16_f32 v245,v210,v211
v_fma_f32 v213,v213,s26,-v20
v_mfma_f32_16x16x32_bf16 v[176:179],a[96:99],a[32:35],0
ds_read_b128 a[136:139],v4 offset:34816
v_fma_f32 v214,v214,s26,-v20
v_mfma_f32_16x16x32_bf16 v[176:179],a[100:103],a[36:39],v[176:179]
v_exp_f32 v213,v213
v_mfma_f32_16x16x32_bf16 v[176:179],a[104:107],a[40:43],v[176:179]
v_exp_f32 v214,v214
v_mfma_f32_16x16x32_bf16 v[176:179],a[108:111],a[44:47],v[176:179]
ds_read_b128 a[140:143],v5 offset:34816
v_cvt_pk_bf16_f32 v246,v212,v213
v_mfma_f32_16x16x32_bf16 v[184:187],a[108:111],a[60:63],0
v_fma_f32 v215,v215,s26,-v20
v_fma_f32 v216,v216,s26,-v21
v_mfma_f32_16x16x32_bf16 v[184:187],a[104:107],a[56:59],v[184:187]
v_exp_f32 v215,v215
v_mfma_f32_16x16x32_bf16 v[184:187],a[100:103],a[52:55],v[184:187]
s_waitcnt lgkmcnt(4)
v_exp_f32 v216,v216
v_mfma_f32_16x16x32_bf16 v[184:187],a[96:99],a[48:51],v[184:187]
ds_read_b128 a[144:147],v2 offset:35840
v_cvt_pk_bf16_f32 v247,v214,v215
v_fma_f32 v217,v217,s26,-v21
v_mfma_f32_16x16x32_bf16 v[164:167],a[112:115],a[0:3],0
v_exp_f32 v217,v217
v_mfma_f32_16x16x32_bf16 v[164:167],a[116:119],a[4:7],v[164:167]
v_cvt_pk_bf16_f32 v252,v216,v217
v_fma_f32 v218,v218,s26,-v21
v_mfma_f32_16x16x32_bf16 v[164:167],a[120:123],a[8:11],v[164:167]
v_exp_f32 v218,v218
v_mfma_f32_16x16x32_bf16 v[164:167],a[124:127],a[12:15],v[164:167]
ds_read_b128 a[148:151],v3 offset:35840
v_fma_f32 v219,v219,s26,-v21
v_mfma_f32_16x16x32_bf16 v[172:175],a[124:127],a[28:31],0
v_exp_f32 v219,v219
v_mfma_f32_16x16x32_bf16 v[172:175],a[120:123],a[24:27],v[172:175]
v_cvt_pk_bf16_f32 v253,v218,v219
v_fma_f32 v220,v220,s26,-v21
v_mfma_f32_16x16x32_bf16 v[172:175],a[116:119],a[20:23],v[172:175]
s_add_u32 s30,s24,4294918144
s_add_u32 s32,s24,4294922240
ds_read_b128 a[152:155],v4 offset:35840
v_mfma_f32_16x16x32_bf16 v[172:175],a[112:115],a[16:19],v[172:175]
buffer_store_dwordx4 a[80:83],v22,s[16:19],s30 offen sc0 sc1
buffer_store_dwordx4 a[84:87],v22,s[16:19],s32 offen sc0 sc1
v_mfma_f32_16x16x32_bf16 v[180:183],a[112:115],a[32:35],0
v_exp_f32 v220,v220
v_mfma_f32_16x16x32_bf16 v[180:183],a[116:119],a[36:39],v[180:183]
v_fma_f32 v221,v221,s26,-v21
v_fma_f32 v222,v222,s26,-v21
v_mfma_f32_16x16x32_bf16 v[180:183],a[120:123],a[40:43],v[180:183]
ds_read_b128 a[156:159],v5 offset:35840
v_fma_f32 v223,v223,s26,-v21
v_mfma_f32_16x16x32_bf16 v[180:183],a[124:127],a[44:47],v[180:183]
v_exp_f32 v221,v221
v_mfma_f32_16x16x32_bf16 v[188:191],a[124:127],a[60:63],0
v_exp_f32 v222,v222
v_mfma_f32_16x16x32_bf16 v[188:191],a[120:123],a[56:59],v[188:191]
v_exp_f32 v223,v223
v_mfma_f32_16x16x32_bf16 v[188:191],a[116:119],a[52:55],v[188:191]
v_cvt_pk_bf16_f32 v254,v220,v221
v_cvt_pk_bf16_f32 v255,v222,v223
v_mfma_f32_16x16x32_bf16 v[188:191],a[112:115],a[48:51],v[188:191]
s_waitcnt lgkmcnt(4)
v_mfma_f32_16x16x32_bf16 v[192:195],a[128:131],a[0:3],0
v_accvgpr_read_b32 v23,a244
v_accvgpr_read_b32 v24,a245
v_mfma_f32_16x16x32_bf16 v[192:195],a[132:135],a[4:7],v[192:195]
v_fma_f32 v160,v160,s26,-v18
v_fma_f32 v161,v161,s26,-v18
v_mfma_f32_16x16x32_bf16 v[192:195],a[136:139],a[8:11],v[192:195]
v_exp_f32 v160,v160
v_mfma_f32_16x16x32_bf16 v[192:195],a[140:143],a[12:15],v[192:195]
v_exp_f32 v161,v161
v_fma_f32 v162,v162,s26,-v18
v_fma_f32 v163,v163,s26,-v18
v_mfma_f32_16x16x32_bf16 v[200:203],a[140:143],a[28:31],0
ds_write_b128 v23,v[96:99] offset:0
v_cvt_pk_bf16_f32 v160,v160,v161
v_mfma_f32_16x16x32_bf16 v[200:203],a[136:139],a[24:27],v[200:203]
ds_read_b64_tr_b16 a[96:97],v6 offset:16384
v_fma_f32 v164,v164,s26,-v18
v_mfma_f32_16x16x32_bf16 v[200:203],a[132:135],a[20:23],v[200:203]
s_add_u32 s30,s24,4294926336
s_add_u32 s32,s24,4294930432
ds_read_b64_tr_b16 a[98:99],v6 offset:17408
v_mfma_f32_16x16x32_bf16 v[200:203],a[128:131],a[16:19],v[200:203]
buffer_store_dwordx4 a[88:91],v22,s[16:19],s30 offen sc0 sc1
buffer_store_dwordx4 a[92:95],v22,s[16:19],s32 offen sc0 sc1
v_exp_f32 v162,v162
v_mfma_f32_16x16x32_bf16 v[208:211],a[128:131],a[32:35],0
ds_read_b64_tr_b16 a[100:101],v6 offset:18432
v_fma_f32 v165,v165,s26,-v18
v_mfma_f32_16x16x32_bf16 v[208:211],a[132:135],a[36:39],v[208:211]
ds_read_b64_tr_b16 a[102:103],v6 offset:19456
v_fma_f32 v166,v166,s26,-v18
v_mfma_f32_16x16x32_bf16 v[208:211],a[136:139],a[40:43],v[208:211]
ds_read_b128 a[64:67],v10 offset:16384
v_fma_f32 v167,v167,s26,-v18
v_mfma_f32_16x16x32_bf16 v[208:211],a[140:143],a[44:47],v[208:211]
ds_read_b128 a[68:71],v11 offset:16384
v_exp_f32 v163,v163
v_exp_f32 v164,v164
v_mfma_f32_16x16x32_bf16 v[216:219],a[140:143],a[60:63],0
ds_read_b64_tr_b16 a[104:105],v6 offset:16392
v_cvt_pk_bf16_f32 v161,v162,v163
v_mfma_f32_16x16x32_bf16 v[216:219],a[136:139],a[56:59],v[216:219]
ds_read_b64_tr_b16 a[106:107],v6 offset:17416
v_fma_f32 v168,v168,s26,-v19
v_mfma_f32_16x16x32_bf16 v[216:219],a[132:135],a[52:55],v[216:219]
ds_read_b128 a[72:75],v12 offset:16384
v_fma_f32 v169,v169,s26,-v19
v_mfma_f32_16x16x32_bf16 v[216:219],a[128:131],a[48:51],v[216:219]
s_waitcnt lgkmcnt(10)
ds_read_b128 a[76:79],v13 offset:16384
v_exp_f32 v165,v165
v_mfma_f32_16x16x32_bf16 v[196:199],a[144:147],a[0:3],0
ds_read_b64_tr_b16 a[108:109],v6 offset:18440
v_cvt_pk_bf16_f32 v162,v164,v165
v_mfma_f32_16x16x32_bf16 v[196:199],a[148:151],a[4:7],v[196:199]
ds_read_b64_tr_b16 a[110:111],v6 offset:19464
v_fma_f32 v170,v170,s26,-v19
v_mfma_f32_16x16x32_bf16 v[196:199],a[152:155],a[8:11],v[196:199]
ds_read_b128 a[80:83],v10 offset:0
v_fma_f32 v171,v171,s26,-v19
v_mfma_f32_16x16x32_bf16 v[196:199],a[156:159],a[12:15],v[196:199]
ds_read_b64_tr_b16 a[112:113],v7 offset:16384
v_exp_f32 v166,v166
v_fma_f32 v172,v172,s26,-v19
v_mfma_f32_16x16x32_bf16 v[204:207],a[156:159],a[28:31],0
s_waitcnt lgkmcnt(14)
ds_read_b64_tr_b16 a[114:115],v7 offset:17408
v_fma_f32 v173,v173,s26,-v19
v_mfma_f32_16x16x32_bf16 v[204:207],a[152:155],a[24:27],v[204:207]
s_waitcnt lgkmcnt(14)
ds_read_b128 a[84:87],v11 offset:0
v_fma_f32 v174,v174,s26,-v19
v_mfma_f32_16x16x32_bf16 v[204:207],a[148:151],a[20:23],v[204:207]
s_waitcnt lgkmcnt(14)
ds_read_b128 a[88:91],v12 offset:0
v_fma_f32 v175,v175,s26,-v19
v_mfma_f32_16x16x32_bf16 v[204:207],a[144:147],a[16:19],v[204:207]
s_waitcnt lgkmcnt(14)
ds_read_b64_tr_b16 a[116:117],v7 offset:18432
v_exp_f32 v167,v167
v_fma_f32 v176,v176,s26,-v20
v_mfma_f32_16x16x32_bf16 v[212:215],a[144:147],a[32:35],0
s_waitcnt lgkmcnt(14)
ds_read_b64_tr_b16 a[118:119],v7 offset:19456
v_cvt_pk_bf16_f32 v163,v166,v167
v_mfma_f32_16x16x32_bf16 v[212:215],a[148:151],a[36:39],v[212:215]
s_waitcnt lgkmcnt(14)
ds_read_b128 a[92:95],v13 offset:0
v_fma_f32 v177,v177,s26,-v20
v_mfma_f32_16x16x32_bf16 v[212:215],a[152:155],a[40:43],v[212:215]
s_waitcnt lgkmcnt(14)
ds_write_b128 v23,v[100:103] offset:64
v_fma_f32 v178,v178,s26,-v20
v_mfma_f32_16x16x32_bf16 v[212:215],a[156:159],a[44:47],v[212:215]
s_waitcnt lgkmcnt(14)
ds_read_b64_tr_b16 a[120:121],v7 offset:16392
v_exp_f32 v168,v168
v_fma_f32 v179,v179,s26,-v20
v_mfma_f32_16x16x32_bf16 v[220:223],a[156:159],a[60:63],0
s_waitcnt lgkmcnt(14)
ds_read_b64_tr_b16 a[122:123],v7 offset:17416
v_fma_f32 v180,v180,s26,-v20
v_mfma_f32_16x16x32_bf16 v[220:223],a[152:155],a[56:59],v[220:223]
s_waitcnt lgkmcnt(14)
ds_write_b128 v23,v[104:107] offset:128
v_fma_f32 v181,v181,s26,-v20
v_mfma_f32_16x16x32_bf16 v[220:223],a[148:151],a[52:55],v[220:223]
s_waitcnt lgkmcnt(14)
ds_read_b64_tr_b16 a[124:125],v7 offset:18440
v_fma_f32 v182,v182,s26,-v20
v_mfma_f32_16x16x32_bf16 v[220:223],a[144:147],a[48:51],v[220:223]
s_waitcnt lgkmcnt(14)
ds_read_b64_tr_b16 a[126:127],v7 offset:19464
v_exp_f32 v169,v169
v_exp_f32 v170,v170
v_mfma_f32_16x16x32_bf16 a[224:227],a[240:243],v[224:227],a[224:227]
s_add_u32 s30,s24,4294934528
s_add_u32 s32,s24,4294938624
s_waitcnt lgkmcnt(14)
ds_write_b128 v23,v[108:111] offset:192
v_mfma_f32_16x16x32_bf16 a[224:227],a[240:243],v[228:231],a[224:227]
buffer_store_dwordx4 a[64:67],v22,s[16:19],s30 offen sc0 sc1
buffer_store_dwordx4 a[68:71],v22,s[16:19],s32 offen sc0 sc1
v_exp_f32 v171,v171
v_mfma_f32_16x16x32_bf16 a[228:231],a[240:243],v[232:235],a[228:231]
s_waitcnt lgkmcnt(14)
ds_read_b64_tr_b16 a[128:129],v8 offset:16384
v_cvt_pk_bf16_f32 v168,v168,v169
v_mfma_f32_16x16x32_bf16 a[228:231],a[240:243],v[236:239],a[228:231]
s_waitcnt lgkmcnt(14)
ds_read_b64_tr_b16 a[130:131],v8 offset:17408
v_cvt_pk_bf16_f32 v169,v170,v171
v_exp_f32 v172,v172
v_mfma_f32_16x16x32_bf16 a[232:235],a[240:243],v[240:243],a[232:235]
s_waitcnt lgkmcnt(14)
ds_read_b128 v[96:99],v24 offset:0
v_fma_f32 v183,v183,s26,-v20
v_mfma_f32_16x16x32_bf16 a[232:235],a[240:243],v[244:247],a[232:235]
s_waitcnt lgkmcnt(14)
ds_read_b128 v[100:103],v24 offset:1088
v_exp_f32 v173,v173
v_mfma_f32_16x16x32_bf16 a[236:239],a[240:243],v[248:251],a[236:239]
s_waitcnt lgkmcnt(14)
ds_read_b64_tr_b16 a[132:133],v8 offset:18432
v_cvt_pk_bf16_f32 v170,v172,v173
v_mfma_f32_16x16x32_bf16 a[236:239],a[240:243],v[252:255],a[236:239]
s_waitcnt lgkmcnt(14)
ds_read_b64_tr_b16 a[134:135],v8 offset:19456
v_exp_f32 v174,v174
v_fma_f32 v184,v184,s26,-v21
v_mfma_f32_16x16x32_bf16 v[80:83],a[96:99],v[248:251],v[80:83]
s_waitcnt lgkmcnt(14)
ds_read_b128 v[104:107],v24 offset:2176
v_fma_f32 v185,v185,s26,-v21
v_mfma_f32_16x16x32_bf16 v[80:83],a[100:103],v[252:255],v[80:83]
s_waitcnt lgkmcnt(14)
ds_read_b64_tr_b16 a[136:137],v8 offset:16392
v_exp_f32 v175,v175
v_fma_f32 v186,v186,s26,-v21
v_mfma_f32_16x16x32_bf16 v[64:67],a[100:103],v[244:247],v[64:67]
s_waitcnt lgkmcnt(14)
ds_read_b64_tr_b16 a[138:139],v8 offset:17416
v_cvt_pk_bf16_f32 v171,v174,v175
v_mfma_f32_16x16x32_bf16 v[64:67],a[96:99],v[240:243],v[64:67]
s_waitcnt lgkmcnt(14)
ds_read_b128 v[108:111],v24 offset:3264
v_exp_f32 v176,v176
v_exp_f32 v177,v177
v_mfma_f32_16x16x32_bf16 v[48:51],a[96:99],v[232:235],v[48:51]
s_waitcnt lgkmcnt(14)
ds_write_b128 v23,v[112:115] offset:0
v_cvt_pk_bf16_f32 v176,v176,v177
v_mfma_f32_16x16x32_bf16 v[48:51],a[100:103],v[236:239],v[48:51]
s_waitcnt lgkmcnt(14)
ds_read_b64_tr_b16 a[140:141],v8 offset:18440
v_exp_f32 v178,v178
v_fma_f32 v187,v187,s26,-v21
v_mfma_f32_16x16x32_bf16 v[32:35],a[100:103],v[228:231],v[32:35]
s_waitcnt lgkmcnt(14)
ds_read_b64_tr_b16 a[142:143],v8 offset:19464
v_fma_f32 v188,v188,s26,-v21
v_mfma_f32_16x16x32_bf16 v[32:35],a[96:99],v[224:227],v[32:35]
s_waitcnt lgkmcnt(14)
ds_write_b128 v23,v[116:119] offset:64
v_exp_f32 v179,v179
v_mfma_f32_16x16x32_bf16 v[36:39],a[104:107],v[224:227],v[36:39]
s_waitcnt lgkmcnt(14)
ds_write_b128 v23,v[120:123] offset:128
v_cvt_pk_bf16_f32 v177,v178,v179
v_mfma_f32_16x16x32_bf16 v[36:39],a[108:111],v[228:231],v[36:39]
s_waitcnt lgkmcnt(14)
ds_read_b64_tr_b16 a[144:145],v9 offset:16384
v_exp_f32 v180,v180
v_fma_f32 v189,v189,s26,-v21
v_mfma_f32_16x16x32_bf16 v[52:55],a[108:111],v[236:239],v[52:55]
s_add_u32 s30,s24,4294942720
s_add_u32 s32,s24,4294946816
s_waitcnt lgkmcnt(14)
ds_read_b64_tr_b16 a[146:147],v9 offset:17408
v_mfma_f32_16x16x32_bf16 v[52:55],a[104:107],v[232:235],v[52:55]
buffer_store_dwordx4 a[72:75],v22,s[16:19],s30 offen sc0 sc1
buffer_store_dwordx4 a[76:79],v22,s[16:19],s32 offen sc0 sc1
v_exp_f32 v181,v181
v_mfma_f32_16x16x32_bf16 v[68:71],a[104:107],v[240:243],v[68:71]
s_waitcnt lgkmcnt(14)
ds_read_b64_tr_b16 a[148:149],v9 offset:18432
v_cvt_pk_bf16_f32 v178,v180,v181
v_mfma_f32_16x16x32_bf16 v[68:71],a[108:111],v[244:247],v[68:71]
s_waitcnt lgkmcnt(14)
ds_read_b64_tr_b16 a[150:151],v9 offset:19456
v_exp_f32 v182,v182
v_exp_f32 v183,v183
v_mfma_f32_16x16x32_bf16 v[84:87],a[108:111],v[252:255],v[84:87]
s_waitcnt lgkmcnt(14)
ds_write_b128 v23,v[124:127] offset:192
v_cvt_pk_bf16_f32 v179,v182,v183
v_mfma_f32_16x16x32_bf16 v[84:87],a[104:107],v[248:251],v[84:87]
s_waitcnt lgkmcnt(14)
ds_read_b128 v[112:115],v24 offset:0
v_exp_f32 v184,v184
v_mfma_f32_16x16x32_bf16 v[88:91],a[112:115],v[248:251],v[88:91]
s_waitcnt lgkmcnt(14)
ds_read_b64_tr_b16 a[152:153],v9 offset:16392
v_fma_f32 v190,v190,s26,-v21
v_mfma_f32_16x16x32_bf16 v[88:91],a[116:119],v[252:255],v[88:91]
s_waitcnt lgkmcnt(14)
ds_read_b64_tr_b16 a[154:155],v9 offset:17416
v_exp_f32 v185,v185
v_fma_f32 v191,v191,s26,-v21
v_mfma_f32_16x16x32_bf16 v[72:75],a[116:119],v[244:247],v[72:75]
s_waitcnt lgkmcnt(14)
ds_read_b128 v[116:119],v24 offset:1088
v_cvt_pk_bf16_f32 v184,v184,v185
v_mfma_f32_16x16x32_bf16 v[72:75],a[112:115],v[240:243],v[72:75]
s_waitcnt lgkmcnt(14)
ds_read_b64_tr_b16 a[156:157],v9 offset:18440
v_exp_f32 v186,v186
v_mfma_f32_16x16x32_bf16 v[56:59],a[112:115],v[232:235],v[56:59]
s_waitcnt lgkmcnt(14)
ds_read_b64_tr_b16 a[158:159],v9 offset:19464
v_mfma_f32_16x16x32_bf16 v[56:59],a[116:119],v[236:239],v[56:59]
s_waitcnt lgkmcnt(14)
ds_read_b128 v[120:123],v24 offset:2176
v_exp_f32 v187,v187
v_mfma_f32_16x16x32_bf16 v[40:43],a[116:119],v[228:231],v[40:43]
s_waitcnt lgkmcnt(14)
ds_read_b128 v[124:127],v24 offset:3264
v_cvt_pk_bf16_f32 v185,v186,v187
v_mfma_f32_16x16x32_bf16 v[40:43],a[112:115],v[224:227],v[40:43]
v_exp_f32 v188,v188
v_exp_f32 v189,v189
v_mfma_f32_16x16x32_bf16 v[44:47],a[120:123],v[224:227],v[44:47]
v_exp_f32 v190,v190
v_mfma_f32_16x16x32_bf16 v[44:47],a[124:127],v[228:231],v[44:47]
v_exp_f32 v191,v191
v_cvt_pk_bf16_f32 v186,v188,v189
v_mfma_f32_16x16x32_bf16 v[60:63],a[124:127],v[236:239],v[60:63]
s_add_u32 s30,s24,4294950912
s_add_u32 s32,s24,4294955008
v_cvt_pk_bf16_f32 v187,v190,v191
v_mfma_f32_16x16x32_bf16 v[60:63],a[120:123],v[232:235],v[60:63]
buffer_store_dwordx4 a[80:83],v22,s[16:19],s30 offen sc0 sc1
buffer_store_dwordx4 a[84:87],v22,s[16:19],s32 offen sc0 sc1
v_mfma_f32_16x16x32_bf16 v[76:79],a[120:123],v[240:243],v[76:79]
v_fma_f32 v192,v192,s26,-v18
v_fma_f32 v193,v193,s26,-v18
v_mfma_f32_16x16x32_bf16 v[76:79],a[124:127],v[244:247],v[76:79]
v_exp_f32 v192,v192
v_mfma_f32_16x16x32_bf16 v[92:95],a[124:127],v[252:255],v[92:95]
v_exp_f32 v193,v193
v_mfma_f32_16x16x32_bf16 v[92:95],a[120:123],v[248:251],v[92:95]
v_cvt_pk_bf16_f32 v164,v192,v193
v_fma_f32 v194,v194,s26,-v18
v_mfma_f32_16x16x32_bf16 a[208:211],a[128:131],v[248:251],a[208:211]
v_exp_f32 v194,v194
v_mfma_f32_16x16x32_bf16 a[208:211],a[132:135],v[252:255],a[208:211]
v_fma_f32 v195,v195,s26,-v18
v_fma_f32 v196,v196,s26,-v18
v_mfma_f32_16x16x32_bf16 a[192:195],a[132:135],v[244:247],a[192:195]
v_exp_f32 v195,v195
v_mfma_f32_16x16x32_bf16 a[192:195],a[128:131],v[240:243],a[192:195]
s_waitcnt vmcnt(18)
s_waitcnt lgkmcnt(0)
s_barrier
ds_read_b128 a[96:99],v2 offset:49152
v_cvt_pk_bf16_f32 v165,v194,v195
v_mfma_f32_16x16x32_bf16 a[176:179],a[128:131],v[232:235],a[176:179]
v_exp_f32 v196,v196
v_mfma_f32_16x16x32_bf16 a[176:179],a[132:135],v[236:239],a[176:179]
v_fma_f32 v197,v197,s26,-v18
v_fma_f32 v198,v198,s26,-v18
v_fma_f32 v199,v199,s26,-v18
v_mfma_f32_16x16x32_bf16 a[160:163],a[132:135],v[228:231],a[160:163]
v_exp_f32 v197,v197
v_mfma_f32_16x16x32_bf16 a[160:163],a[128:131],v[224:227],a[160:163]
ds_read_b128 a[100:103],v3 offset:49152
v_cvt_pk_bf16_f32 v166,v196,v197
v_mfma_f32_16x16x32_bf16 a[164:167],a[136:139],v[224:227],a[164:167]
v_exp_f32 v198,v198
v_mfma_f32_16x16x32_bf16 a[164:167],a[140:143],v[228:231],a[164:167]
v_exp_f32 v199,v199
v_mfma_f32_16x16x32_bf16 a[180:183],a[140:143],v[236:239],a[180:183]
s_add_u32 s30,s24,4294959104
s_add_u32 s32,s24,4294963200
ds_read_b128 a[104:107],v4 offset:49152
v_mfma_f32_16x16x32_bf16 a[180:183],a[136:139],v[232:235],a[180:183]
buffer_store_dwordx4 a[88:91],v22,s[16:19],s30 offen sc0 sc1
buffer_store_dwordx4 a[92:95],v22,s[16:19],s32 offen sc0 sc1
v_mfma_f32_16x16x32_bf16 a[196:199],a[136:139],v[240:243],a[196:199]
v_cvt_pk_bf16_f32 v167,v198,v199
v_fma_f32 v200,v200,s26,-v19
v_mfma_f32_16x16x32_bf16 a[196:199],a[140:143],v[244:247],a[196:199]
v_exp_f32 v200,v200
v_mfma_f32_16x16x32_bf16 a[212:215],a[140:143],v[252:255],a[212:215]
ds_read_b128 a[108:111],v5 offset:49152
v_fma_f32 v201,v201,s26,-v19
v_mfma_f32_16x16x32_bf16 a[212:215],a[136:139],v[248:251],a[212:215]
v_exp_f32 v201,v201
v_mfma_f32_16x16x32_bf16 a[216:219],a[144:147],v[248:251],a[216:219]
v_cvt_pk_bf16_f32 v172,v200,v201
v_fma_f32 v202,v202,s26,-v19
v_mfma_f32_16x16x32_bf16 a[216:219],a[148:151],v[252:255],a[216:219]
v_exp_f32 v202,v202
v_mfma_f32_16x16x32_bf16 a[200:203],a[148:151],v[244:247],a[200:203]
ds_read_b128 a[112:115],v2 offset:50176
v_fma_f32 v203,v203,s26,-v19
v_mfma_f32_16x16x32_bf16 a[200:203],a[144:147],v[240:243],a[200:203]
v_exp_f32 v203,v203
v_mfma_f32_16x16x32_bf16 a[184:187],a[144:147],v[232:235],a[184:187]
v_cvt_pk_bf16_f32 v173,v202,v203
v_fma_f32 v204,v204,s26,-v19
v_mfma_f32_16x16x32_bf16 a[184:187],a[148:151],v[236:239],a[184:187]
ds_read_b128 a[116:119],v3 offset:50176
v_fma_f32 v205,v205,s26,-v19
v_mfma_f32_16x16x32_bf16 a[168:171],a[148:151],v[228:231],a[168:171]
v_exp_f32 v204,v204
v_mfma_f32_16x16x32_bf16 a[168:171],a[144:147],v[224:227],a[168:171]
v_exp_f32 v205,v205
v_fma_f32 v206,v206,s26,-v19
v_mfma_f32_16x16x32_bf16 a[172:175],a[152:155],v[224:227],a[172:175]
v_exp_f32 v206,v206
v_mfma_f32_16x16x32_bf16 a[172:175],a[156:159],v[228:231],a[172:175]
ds_read_b128 a[120:123],v4 offset:50176
v_cvt_pk_bf16_f32 v174,v204,v205
v_mfma_f32_16x16x32_bf16 a[188:191],a[156:159],v[236:239],a[188:191]
s_add_u32 s30,s24,0
s_add_u32 s32,s24,4096
v_fma_f32 v207,v207,s26,-v19
v_mfma_f32_16x16x32_bf16 a[188:191],a[152:155],v[232:235],a[188:191]
buffer_store_dwordx4 v[96:99],v22,s[16:19],s30 offen sc0 sc1
buffer_store_dwordx4 v[100:103],v22,s[16:19],s32 offen sc0 sc1
v_mfma_f32_16x16x32_bf16 a[204:207],a[152:155],v[240:243],a[204:207]
v_exp_f32 v207,v207
v_mfma_f32_16x16x32_bf16 a[204:207],a[156:159],v[244:247],a[204:207]
ds_read_b128 a[124:127],v5 offset:50176
v_cvt_pk_bf16_f32 v175,v206,v207
v_mfma_f32_16x16x32_bf16 a[220:223],a[156:159],v[252:255],a[220:223]
v_fma_f32 v208,v208,s26,-v20
v_fma_f32 v209,v209,s26,-v20
v_mfma_f32_16x16x32_bf16 a[220:223],a[152:155],v[248:251],a[220:223]
s_waitcnt lgkmcnt(4)
v_exp_f32 v208,v208
v_mfma_f32_16x16x32_bf16 v[224:227],a[96:99],a[0:3],0
ds_read_b128 a[128:131],v2 offset:51200
v_fma_f32 v210,v210,s26,-v20
v_mfma_f32_16x16x32_bf16 v[224:227],a[100:103],a[4:7],v[224:227]
v_exp_f32 v209,v209
v_mfma_f32_16x16x32_bf16 v[224:227],a[104:107],a[8:11],v[224:227]
v_exp_f32 v210,v210
v_mfma_f32_16x16x32_bf16 v[224:227],a[108:111],a[12:15],v[224:227]
v_cvt_pk_bf16_f32 v180,v208,v209
v_fma_f32 v211,v211,s26,-v20
v_mfma_f32_16x16x32_bf16 v[232:235],a[108:111],a[28:31],0
ds_read_b128 a[132:135],v3 offset:51200
v_fma_f32 v212,v212,s26,-v20
v_mfma_f32_16x16x32_bf16 v[232:235],a[104:107],a[24:27],v[232:235]
v_exp_f32 v211,v211
v_mfma_f32_16x16x32_bf16 v[232:235],a[100:103],a[20:23],v[232:235]
v_exp_f32 v212,v212
v_mfma_f32_16x16x32_bf16 v[232:235],a[96:99],a[16:19],v[232:235]
v_cvt_pk_bf16_f32 v181,v210,v211
v_fma_f32 v213,v213,s26,-v20
v_mfma_f32_16x16x32_bf16 v[240:243],a[96:99],a[32:35],0
ds_read_b128 a[136:139],v4 offset:51200
v_fma_f32 v214,v214,s26,-v20
v_mfma_f32_16x16x32_bf16 v[240:243],a[100:103],a[36:39],v[240:243]
v_exp_f32 v213,v213
v_mfma_f32_16x16x32_bf16 v[240:243],a[104:107],a[40:43],v[240:243]
v_exp_f32 v214,v214
v_mfma_f32_16x16x32_bf16 v[240:243],a[108:111],a[44:47],v[240:243]
ds_read_b128 a[140:143],v5 offset:51200
v_cvt_pk_bf16_f32 v182,v212,v213
v_mfma_f32_16x16x32_bf16 v[248:251],a[108:111],a[60:63],0
v_fma_f32 v215,v215,s26,-v20
v_fma_f32 v216,v216,s26,-v21
v_mfma_f32_16x16x32_bf16 v[248:251],a[104:107],a[56:59],v[248:251]
v_exp_f32 v215,v215
v_mfma_f32_16x16x32_bf16 v[248:251],a[100:103],a[52:55],v[248:251]
s_waitcnt lgkmcnt(4)
v_exp_f32 v216,v216
v_mfma_f32_16x16x32_bf16 v[248:251],a[96:99],a[48:51],v[248:251]
ds_read_b128 a[144:147],v2 offset:52224
v_cvt_pk_bf16_f32 v183,v214,v215
v_fma_f32 v217,v217,s26,-v21
v_mfma_f32_16x16x32_bf16 v[228:231],a[112:115],a[0:3],0
v_exp_f32 v217,v217
v_mfma_f32_16x16x32_bf16 v[228:231],a[116:119],a[4:7],v[228:231]
v_cvt_pk_bf16_f32 v188,v216,v217
v_fma_f32 v218,v218,s26,-v21
v_mfma_f32_16x16x32_bf16 v[228:231],a[120:123],a[8:11],v[228:231]
v_exp_f32 v218,v218
v_mfma_f32_16x16x32_bf16 v[228:231],a[124:127],a[12:15],v[228:231]
ds_read_b128 a[148:151],v3 offset:52224
v_fma_f32 v219,v219,s26,-v21
v_mfma_f32_16x16x32_bf16 v[236:239],a[124:127],a[28:31],0
v_exp_f32 v219,v219
v_mfma_f32_16x16x32_bf16 v[236:239],a[120:123],a[24:27],v[236:239]
v_cvt_pk_bf16_f32 v189,v218,v219
v_fma_f32 v220,v220,s26,-v21
v_mfma_f32_16x16x32_bf16 v[236:239],a[116:119],a[20:23],v[236:239]
s_add_u32 s30,s24,8192
s_add_u32 s32,s24,12288
ds_read_b128 a[152:155],v4 offset:52224
v_mfma_f32_16x16x32_bf16 v[236:239],a[112:115],a[16:19],v[236:239]
buffer_store_dwordx4 v[104:107],v22,s[16:19],s30 offen sc0 sc1
buffer_store_dwordx4 v[108:111],v22,s[16:19],s32 offen sc0 sc1
v_mfma_f32_16x16x32_bf16 v[244:247],a[112:115],a[32:35],0
v_exp_f32 v220,v220
v_mfma_f32_16x16x32_bf16 v[244:247],a[116:119],a[36:39],v[244:247]
v_fma_f32 v221,v221,s26,-v21
v_fma_f32 v222,v222,s26,-v21
v_mfma_f32_16x16x32_bf16 v[244:247],a[120:123],a[40:43],v[244:247]
ds_read_b128 a[156:159],v5 offset:52224
v_fma_f32 v223,v223,s26,-v21
v_mfma_f32_16x16x32_bf16 v[244:247],a[124:127],a[44:47],v[244:247]
v_exp_f32 v221,v221
v_mfma_f32_16x16x32_bf16 v[252:255],a[124:127],a[60:63],0
v_exp_f32 v222,v222
v_mfma_f32_16x16x32_bf16 v[252:255],a[120:123],a[56:59],v[252:255]
v_exp_f32 v223,v223
v_mfma_f32_16x16x32_bf16 v[252:255],a[116:119],a[52:55],v[252:255]
v_cvt_pk_bf16_f32 v190,v220,v221
v_cvt_pk_bf16_f32 v191,v222,v223
v_mfma_f32_16x16x32_bf16 v[252:255],a[112:115],a[48:51],v[252:255]
s_waitcnt lgkmcnt(4)
v_mfma_f32_16x16x32_bf16 v[192:195],a[128:131],a[0:3],0
v_accvgpr_read_b32 v23,a244
v_accvgpr_read_b32 v24,a245
v_mfma_f32_16x16x32_bf16 v[192:195],a[132:135],a[4:7],v[192:195]
v_fma_f32 v224,v224,s26,-v18
v_fma_f32 v225,v225,s26,-v18
v_mfma_f32_16x16x32_bf16 v[192:195],a[136:139],a[8:11],v[192:195]
v_exp_f32 v224,v224
v_mfma_f32_16x16x32_bf16 v[192:195],a[140:143],a[12:15],v[192:195]
v_exp_f32 v225,v225
v_fma_f32 v226,v226,s26,-v18
v_fma_f32 v227,v227,s26,-v18
v_mfma_f32_16x16x32_bf16 v[200:203],a[140:143],a[28:31],0
ds_write_b128 v23,v[128:131] offset:16384
v_cvt_pk_bf16_f32 v224,v224,v225
v_mfma_f32_16x16x32_bf16 v[200:203],a[136:139],a[24:27],v[200:203]
ds_read_b64_tr_b16 a[96:97],v6 offset:32768
v_fma_f32 v228,v228,s26,-v18
v_mfma_f32_16x16x32_bf16 v[200:203],a[132:135],a[20:23],v[200:203]
s_add_u32 s30,s24,16384
s_add_u32 s32,s24,20480
ds_read_b64_tr_b16 a[98:99],v6 offset:33792
v_mfma_f32_16x16x32_bf16 v[200:203],a[128:131],a[16:19],v[200:203]
buffer_store_dwordx4 v[112:115],v22,s[16:19],s30 offen sc0 sc1
buffer_store_dwordx4 v[116:119],v22,s[16:19],s32 offen sc0 sc1
v_exp_f32 v226,v226
v_mfma_f32_16x16x32_bf16 v[208:211],a[128:131],a[32:35],0
ds_read_b64_tr_b16 a[100:101],v6 offset:34816
v_fma_f32 v229,v229,s26,-v18
v_mfma_f32_16x16x32_bf16 v[208:211],a[132:135],a[36:39],v[208:211]
ds_read_b64_tr_b16 a[102:103],v6 offset:35840
v_fma_f32 v230,v230,s26,-v18
v_mfma_f32_16x16x32_bf16 v[208:211],a[136:139],a[40:43],v[208:211]
ds_write_b128 v23,v[132:135] offset:16448
v_fma_f32 v231,v231,s26,-v18
v_mfma_f32_16x16x32_bf16 v[208:211],a[140:143],a[44:47],v[208:211]
ds_write_b128 v23,v[136:139] offset:16512
v_exp_f32 v227,v227
v_mfma_f32_16x16x32_bf16 v[216:219],a[140:143],a[60:63],0
ds_read_b64_tr_b16 a[104:105],v6 offset:32776
v_cvt_pk_bf16_f32 v225,v226,v227
v_mfma_f32_16x16x32_bf16 v[216:219],a[136:139],a[56:59],v[216:219]
ds_read_b64_tr_b16 a[106:107],v6 offset:33800
v_fma_f32 v232,v232,s26,-v19
v_mfma_f32_16x16x32_bf16 v[216:219],a[132:135],a[52:55],v[216:219]
ds_write_b128 v23,v[140:143] offset:16576
v_fma_f32 v233,v233,s26,-v19
v_mfma_f32_16x16x32_bf16 v[216:219],a[128:131],a[48:51],v[216:219]
s_waitcnt lgkmcnt(10)
ds_read_b128 v[128:131],v24 offset:16384
v_exp_f32 v228,v228
v_mfma_f32_16x16x32_bf16 v[196:199],a[144:147],a[0:3],0
ds_read_b64_tr_b16 a[108:109],v6 offset:34824
v_fma_f32 v234,v234,s26,-v19
v_mfma_f32_16x16x32_bf16 v[196:199],a[148:151],a[4:7],v[196:199]
ds_read_b64_tr_b16 a[110:111],v6 offset:35848
v_fma_f32 v235,v235,s26,-v19
v_mfma_f32_16x16x32_bf16 v[196:199],a[152:155],a[8:11],v[196:199]
ds_read_b128 v[132:135],v24 offset:17472
v_fma_f32 v236,v236,s26,-v19
v_mfma_f32_16x16x32_bf16 v[196:199],a[156:159],a[12:15],v[196:199]
ds_read_b64_tr_b16 a[112:113],v7 offset:32768
v_exp_f32 v229,v229
v_fma_f32 v237,v237,s26,-v19
v_mfma_f32_16x16x32_bf16 v[204:207],a[156:159],a[28:31],0
s_waitcnt lgkmcnt(14)
ds_read_b64_tr_b16 a[114:115],v7 offset:33792
v_cvt_pk_bf16_f32 v226,v228,v229
v_mfma_f32_16x16x32_bf16 v[204:207],a[152:155],a[24:27],v[204:207]
s_waitcnt lgkmcnt(14)
ds_read_b128 v[136:139],v24 offset:18560
v_fma_f32 v238,v238,s26,-v19
v_mfma_f32_16x16x32_bf16 v[204:207],a[148:151],a[20:23],v[204:207]
s_waitcnt lgkmcnt(14)
ds_read_b128 v[140:143],v24 offset:19648
v_fma_f32 v239,v239,s26,-v19
v_mfma_f32_16x16x32_bf16 v[204:207],a[144:147],a[16:19],v[204:207]
s_waitcnt lgkmcnt(14)
ds_read_b64_tr_b16 a[116:117],v7 offset:34816
v_exp_f32 v230,v230
v_fma_f32 v240,v240,s26,-v20
v_mfma_f32_16x16x32_bf16 v[212:215],a[144:147],a[32:35],0
s_waitcnt lgkmcnt(14)
ds_read_b64_tr_b16 a[118:119],v7 offset:35840
v_fma_f32 v241,v241,s26,-v20
v_mfma_f32_16x16x32_bf16 v[212:215],a[148:151],a[36:39],v[212:215]
s_waitcnt lgkmcnt(14)
ds_write_b128 v23,v[144:147] offset:16384
v_fma_f32 v242,v242,s26,-v20
v_mfma_f32_16x16x32_bf16 v[212:215],a[152:155],a[40:43],v[212:215]
s_waitcnt lgkmcnt(14)
ds_write_b128 v23,v[148:151] offset:16448
v_fma_f32 v243,v243,s26,-v20
v_mfma_f32_16x16x32_bf16 v[212:215],a[156:159],a[44:47],v[212:215]
s_waitcnt lgkmcnt(14)
ds_read_b64_tr_b16 a[120:121],v7 offset:32776
v_exp_f32 v231,v231
v_fma_f32 v244,v244,s26,-v20
v_mfma_f32_16x16x32_bf16 v[220:223],a[156:159],a[60:63],0
s_waitcnt lgkmcnt(14)
ds_read_b64_tr_b16 a[122:123],v7 offset:33800
v_cvt_pk_bf16_f32 v227,v230,v231
v_mfma_f32_16x16x32_bf16 v[220:223],a[152:155],a[56:59],v[220:223]
s_waitcnt lgkmcnt(14)
ds_write_b128 v23,v[152:155] offset:16512
v_fma_f32 v245,v245,s26,-v20
v_mfma_f32_16x16x32_bf16 v[220:223],a[148:151],a[52:55],v[220:223]
s_waitcnt lgkmcnt(14)
ds_read_b64_tr_b16 a[124:125],v7 offset:34824
v_fma_f32 v246,v246,s26,-v20
v_mfma_f32_16x16x32_bf16 v[220:223],a[144:147],a[48:51],v[220:223]
s_waitcnt lgkmcnt(14)
ds_read_b64_tr_b16 a[126:127],v7 offset:35848
v_exp_f32 v232,v232
v_mfma_f32_16x16x32_bf16 a[224:227],a[240:243],v[160:163],a[224:227]
s_add_u32 s30,s24,24576
s_add_u32 s32,s24,28672
s_waitcnt lgkmcnt(14)
ds_write_b128 v23,v[156:159] offset:16576
v_mfma_f32_16x16x32_bf16 a[224:227],a[240:243],v[164:167],a[224:227]
buffer_store_dwordx4 v[120:123],v22,s[16:19],s30 offen sc0 sc1
buffer_store_dwordx4 v[124:127],v22,s[16:19],s32 offen sc0 sc1
v_exp_f32 v233,v233
v_mfma_f32_16x16x32_bf16 a[228:231],a[240:243],v[168:171],a[228:231]
s_waitcnt lgkmcnt(14)
ds_read_b64_tr_b16 a[128:129],v8 offset:32768
v_cvt_pk_bf16_f32 v232,v232,v233
v_mfma_f32_16x16x32_bf16 a[228:231],a[240:243],v[172:175],a[228:231]
s_waitcnt lgkmcnt(14)
ds_read_b64_tr_b16 a[130:131],v8 offset:33792
v_exp_f32 v234,v234
v_fma_f32 v247,v247,s26,-v20
v_mfma_f32_16x16x32_bf16 a[232:235],a[240:243],v[176:179],a[232:235]
s_waitcnt lgkmcnt(14)
ds_read_b128 v[144:147],v24 offset:16384
v_fma_f32 v248,v248,s26,-v21
v_mfma_f32_16x16x32_bf16 a[232:235],a[240:243],v[180:183],a[232:235]
s_waitcnt lgkmcnt(14)
ds_read_b128 v[148:151],v24 offset:17472
v_exp_f32 v235,v235
v_mfma_f32_16x16x32_bf16 a[236:239],a[240:243],v[184:187],a[236:239]
s_waitcnt lgkmcnt(14)
ds_read_b64_tr_b16 a[132:133],v8 offset:34816
v_cvt_pk_bf16_f32 v233,v234,v235
v_mfma_f32_16x16x32_bf16 a[236:239],a[240:243],v[188:191],a[236:239]
s_waitcnt lgkmcnt(14)
ds_read_b64_tr_b16 a[134:135],v8 offset:35840
v_exp_f32 v236,v236
v_fma_f32 v249,v249,s26,-v21
v_mfma_f32_16x16x32_bf16 v[80:83],a[96:99],v[184:187],v[80:83]
s_waitcnt lgkmcnt(14)
ds_read_b128 v[152:155],v24 offset:18560
v_fma_f32 v250,v250,s26,-v21
v_mfma_f32_16x16x32_bf16 v[80:83],a[100:103],v[188:191],v[80:83]
s_waitcnt lgkmcnt(14)
ds_read_b64_tr_b16 a[136:137],v8 offset:32776
v_exp_f32 v237,v237
v_mfma_f32_16x16x32_bf16 v[64:67],a[100:103],v[180:183],v[64:67]
s_add_u32 s30,s24,32768
s_add_u32 s32,s24,36864
s_waitcnt lgkmcnt(14)
ds_read_b64_tr_b16 a[138:139],v8 offset:33800
v_mfma_f32_16x16x32_bf16 v[64:67],a[96:99],v[176:179],v[64:67]
buffer_store_dwordx4 v[128:131],v22,s[16:19],s30 offen sc0 sc1
buffer_store_dwordx4 v[132:135],v22,s[16:19],s32 offen sc0 sc1
v_exp_f32 v238,v238
v_mfma_f32_16x16x32_bf16 v[48:51],a[96:99],v[168:171],v[48:51]
s_waitcnt lgkmcnt(14)
ds_read_b128 v[156:159],v24 offset:19648
v_cvt_pk_bf16_f32 v234,v236,v237
v_mfma_f32_16x16x32_bf16 v[48:51],a[100:103],v[172:175],v[48:51]
s_waitcnt lgkmcnt(14)
ds_read_b64_tr_b16 a[140:141],v8 offset:34824
v_exp_f32 v239,v239
v_fma_f32 v251,v251,s26,-v21
v_mfma_f32_16x16x32_bf16 v[32:35],a[100:103],v[164:167],v[32:35]
s_waitcnt lgkmcnt(14)
ds_read_b64_tr_b16 a[142:143],v8 offset:35848
v_cvt_pk_bf16_f32 v235,v238,v239
v_mfma_f32_16x16x32_bf16 v[32:35],a[96:99],v[160:163],v[32:35]
v_exp_f32 v240,v240
v_exp_f32 v241,v241
v_mfma_f32_16x16x32_bf16 v[36:39],a[104:107],v[160:163],v[36:39]
v_exp_f32 v242,v242
v_mfma_f32_16x16x32_bf16 v[36:39],a[108:111],v[164:167],v[36:39]
s_waitcnt lgkmcnt(14)
ds_read_b64_tr_b16 a[144:145],v9 offset:32768
v_cvt_pk_bf16_f32 v240,v240,v241
v_exp_f32 v243,v243
v_mfma_f32_16x16x32_bf16 v[52:55],a[108:111],v[172:175],v[52:55]
s_waitcnt lgkmcnt(14)
ds_read_b64_tr_b16 a[146:147],v9 offset:33792
v_cvt_pk_bf16_f32 v241,v242,v243
v_mfma_f32_16x16x32_bf16 v[52:55],a[104:107],v[168:171],v[52:55]
v_exp_f32 v244,v244
v_exp_f32 v245,v245
v_mfma_f32_16x16x32_bf16 v[68:71],a[104:107],v[176:179],v[68:71]
s_waitcnt lgkmcnt(14)
ds_read_b64_tr_b16 a[148:149],v9 offset:34816
v_cvt_pk_bf16_f32 v242,v244,v245
v_mfma_f32_16x16x32_bf16 v[68:71],a[108:111],v[180:183],v[68:71]
s_waitcnt lgkmcnt(14)
ds_read_b64_tr_b16 a[150:151],v9 offset:35840
v_exp_f32 v246,v246
v_mfma_f32_16x16x32_bf16 v[84:87],a[108:111],v[188:191],v[84:87]
v_exp_f32 v247,v247
v_mfma_f32_16x16x32_bf16 v[84:87],a[104:107],v[184:187],v[84:87]
v_exp_f32 v248,v248
v_exp_f32 v249,v249
v_mfma_f32_16x16x32_bf16 v[88:91],a[112:115],v[184:187],v[88:91]
s_waitcnt lgkmcnt(14)
ds_read_b64_tr_b16 a[152:153],v9 offset:32776
v_cvt_pk_bf16_f32 v243,v246,v247
v_mfma_f32_16x16x32_bf16 v[88:91],a[116:119],v[188:191],v[88:91]
s_waitcnt lgkmcnt(14)
ds_read_b64_tr_b16 a[154:155],v9 offset:33800
v_cvt_pk_bf16_f32 v248,v248,v249
v_exp_f32 v250,v250
v_mfma_f32_16x16x32_bf16 v[72:75],a[116:119],v[180:183],v[72:75]
v_exp_f32 v251,v251
v_mfma_f32_16x16x32_bf16 v[72:75],a[112:115],v[176:179],v[72:75]
s_waitcnt lgkmcnt(14)
ds_read_b64_tr_b16 a[156:157],v9 offset:34824
v_cvt_pk_bf16_f32 v249,v250,v251
v_fma_f32 v252,v252,s26,-v21
v_fma_f32 v253,v253,s26,-v21
v_mfma_f32_16x16x32_bf16 v[56:59],a[112:115],v[168:171],v[56:59]
s_add_u32 s30,s24,40960
s_add_u32 s32,s24,45056
s_waitcnt lgkmcnt(14)
ds_read_b64_tr_b16 a[158:159],v9 offset:35848
v_mfma_f32_16x16x32_bf16 v[56:59],a[116:119],v[172:175],v[56:59]
buffer_store_dwordx4 v[136:139],v22,s[16:19],s30 offen sc0 sc1
buffer_store_dwordx4 v[140:143],v22,s[16:19],s32 offen sc0 sc1
v_exp_f32 v252,v252
v_mfma_f32_16x16x32_bf16 v[40:43],a[116:119],v[164:167],v[40:43]
v_exp_f32 v253,v253
v_mfma_f32_16x16x32_bf16 v[40:43],a[112:115],v[160:163],v[40:43]
v_cvt_pk_bf16_f32 v250,v252,v253
v_fma_f32 v254,v254,s26,-v21
v_fma_f32 v255,v255,s26,-v21
v_mfma_f32_16x16x32_bf16 v[44:47],a[120:123],v[160:163],v[44:47]
v_exp_f32 v254,v254
v_mfma_f32_16x16x32_bf16 v[44:47],a[124:127],v[164:167],v[44:47]
v_exp_f32 v255,v255
v_mfma_f32_16x16x32_bf16 v[60:63],a[124:127],v[172:175],v[60:63]
v_cvt_pk_bf16_f32 v251,v254,v255
v_mfma_f32_16x16x32_bf16 v[60:63],a[120:123],v[168:171],v[60:63]
v_mfma_f32_16x16x32_bf16 v[76:79],a[120:123],v[176:179],v[76:79]
v_fma_f32 v192,v192,s26,-v18
v_fma_f32 v193,v193,s26,-v18
v_mfma_f32_16x16x32_bf16 v[76:79],a[124:127],v[180:183],v[76:79]
v_exp_f32 v192,v192
v_mfma_f32_16x16x32_bf16 v[92:95],a[124:127],v[188:191],v[92:95]
v_exp_f32 v193,v193
v_mfma_f32_16x16x32_bf16 v[92:95],a[120:123],v[184:187],v[92:95]
s_waitcnt lgkmcnt(14)
v_cvt_pk_bf16_f32 v228,v192,v193
v_fma_f32 v194,v194,s26,-v18
v_mfma_f32_16x16x32_bf16 a[208:211],a[128:131],v[184:187],a[208:211]
v_exp_f32 v194,v194
v_mfma_f32_16x16x32_bf16 a[208:211],a[132:135],v[188:191],a[208:211]
v_fma_f32 v195,v195,s26,-v18
v_fma_f32 v196,v196,s26,-v18
v_mfma_f32_16x16x32_bf16 a[192:195],a[132:135],v[180:183],a[192:195]
v_exp_f32 v195,v195
v_mfma_f32_16x16x32_bf16 a[192:195],a[128:131],v[176:179],a[192:195]
s_waitcnt vmcnt(28)
s_waitcnt lgkmcnt(0)
s_barrier
s_sub_u32 s20,s20,1
L_tail0:
v_cvt_pk_bf16_f32 v229,v194,v195
v_mfma_f32_16x16x32_bf16 a[176:179],a[128:131],v[168:171],a[176:179]
s_add_u32 s30,s24,49152
s_add_u32 s32,s24,53248
v_fma_f32 v197,v197,s26,-v18
v_mfma_f32_16x16x32_bf16 a[176:179],a[132:135],v[172:175],a[176:179]
buffer_store_dwordx4 v[144:147],v22,s[16:19],s30 offen sc0 sc1
buffer_store_dwordx4 v[148:151],v22,s[16:19],s32 offen sc0 sc1
v_mfma_f32_16x16x32_bf16 a[160:163],a[132:135],v[164:167],a[160:163]
v_exp_f32 v196,v196
v_mfma_f32_16x16x32_bf16 a[160:163],a[128:131],v[160:163],a[160:163]
v_fma_f32 v198,v198,s26,-v18
v_mfma_f32_16x16x32_bf16 a[164:167],a[136:139],v[160:163],a[164:167]
v_exp_f32 v197,v197
v_mfma_f32_16x16x32_bf16 a[164:167],a[140:143],v[164:167],a[164:167]
v_exp_f32 v198,v198
v_mfma_f32_16x16x32_bf16 a[180:183],a[140:143],v[172:175],a[180:183]
v_cvt_pk_bf16_f32 v230,v196,v197
v_mfma_f32_16x16x32_bf16 a[180:183],a[136:139],v[168:171],a[180:183]
v_fma_f32 v199,v199,s26,-v18
v_fma_f32 v200,v200,s26,-v19
v_mfma_f32_16x16x32_bf16 a[196:199],a[136:139],v[176:179],a[196:199]
v_exp_f32 v199,v199
v_mfma_f32_16x16x32_bf16 a[196:199],a[140:143],v[180:183],a[196:199]
v_exp_f32 v200,v200
v_mfma_f32_16x16x32_bf16 a[212:215],a[140:143],v[188:191],a[212:215]
v_cvt_pk_bf16_f32 v231,v198,v199
v_mfma_f32_16x16x32_bf16 a[212:215],a[136:139],v[184:187],a[212:215]
v_fma_f32 v201,v201,s26,-v19
v_fma_f32 v202,v202,s26,-v19
v_mfma_f32_16x16x32_bf16 a[216:219],a[144:147],v[184:187],a[216:219]
v_exp_f32 v201,v201
v_mfma_f32_16x16x32_bf16 a[216:219],a[148:151],v[188:191],a[216:219]
v_exp_f32 v202,v202
v_mfma_f32_16x16x32_bf16 a[200:203],a[148:151],v[180:183],a[200:203]
v_cvt_pk_bf16_f32 v236,v200,v201
v_mfma_f32_16x16x32_bf16 a[200:203],a[144:147],v[176:179],a[200:203]
v_fma_f32 v203,v203,s26,-v19
v_fma_f32 v204,v204,s26,-v19
v_mfma_f32_16x16x32_bf16 a[184:187],a[144:147],v[168:171],a[184:187]
v_exp_f32 v203,v203
v_mfma_f32_16x16x32_bf16 a[184:187],a[148:151],v[172:175],a[184:187]
v_cvt_pk_bf16_f32 v237,v202,v203
v_mfma_f32_16x16x32_bf16 a[168:171],a[148:151],v[164:167],a[168:171]
v_exp_f32 v204,v204
v_mfma_f32_16x16x32_bf16 a[168:171],a[144:147],v[160:163],a[168:171]
v_fma_f32 v205,v205,s26,-v19
v_fma_f32 v206,v206,s26,-v19
v_fma_f32 v207,v207,s26,-v19
v_mfma_f32_16x16x32_bf16 a[172:175],a[152:155],v[160:163],a[172:175]
v_exp_f32 v205,v205
v_mfma_f32_16x16x32_bf16 a[172:175],a[156:159],v[164:167],a[172:175]
v_cvt_pk_bf16_f32 v238,v204,v205
v_mfma_f32_16x16x32_bf16 a[188:191],a[156:159],v[172:175],a[188:191]
s_add_u32 s30,s24,57344
s_add_u32 s32,s24,61440
v_fma_f32 v208,v208,s26,-v20
v_mfma_f32_16x16x32_bf16 a[188:191],a[152:155],v[168:171],a[188:191]
buffer_store_dwordx4 v[152:155],v22,s[16:19],s30 offen sc0 sc1
buffer_store_dwordx4 v[156:159],v22,s[16:19],s32 offen sc0 sc1
v_mfma_f32_16x16x32_bf16 a[204:207],a[152:155],v[176:179],a[204:207]
v_exp_f32 v206,v206
v_mfma_f32_16x16x32_bf16 a[204:207],a[156:159],v[180:183],a[204:207]
v_fma_f32 v209,v209,s26,-v20
v_mfma_f32_16x16x32_bf16 a[220:223],a[156:159],v[188:191],a[220:223]
v_exp_f32 v207,v207
v_mfma_f32_16x16x32_bf16 a[220:223],a[152:155],v[184:187],a[220:223]
v_exp_f32 v208,v208
v_cvt_pk_bf16_f32 v239,v206,v207
v_exp_f32 v209,v209
s_nop 0
v_cvt_pk_bf16_f32 v244,v208,v209
v_fma_f32 v210,v210,s26,-v20
v_exp_f32 v210,v210
v_fma_f32 v211,v211,s26,-v20
v_exp_f32 v211,v211
s_nop 0
v_cvt_pk_bf16_f32 v245,v210,v211
v_fma_f32 v212,v212,s26,-v20
v_exp_f32 v212,v212
v_fma_f32 v213,v213,s26,-v20
v_exp_f32 v213,v213
s_nop 0
v_cvt_pk_bf16_f32 v246,v212,v213
v_fma_f32 v214,v214,s26,-v20
v_fma_f32 v215,v215,s26,-v20
v_exp_f32 v214,v214
v_exp_f32 v215,v215
s_nop 0
v_cvt_pk_bf16_f32 v247,v214,v215
v_fma_f32 v216,v216,s26,-v21
v_fma_f32 v217,v217,s26,-v21
v_exp_f32 v216,v216
v_exp_f32 v217,v217
s_nop 0
v_cvt_pk_bf16_f32 v252,v216,v217
v_fma_f32 v218,v218,s26,-v21
v_fma_f32 v219,v219,s26,-v21
v_exp_f32 v218,v218
v_exp_f32 v219,v219
s_nop 0
v_cvt_pk_bf16_f32 v253,v218,v219
v_fma_f32 v220,v220,s26,-v21
v_fma_f32 v221,v221,s26,-v21
v_exp_f32 v220,v220
v_exp_f32 v221,v221
s_nop 0
v_cvt_pk_bf16_f32 v254,v220,v221
v_fma_f32 v222,v222,s26,-v21
v_fma_f32 v223,v223,s26,-v21
v_exp_f32 v222,v222
v_exp_f32 v223,v223
s_nop 0
v_cvt_pk_bf16_f32 v255,v222,v223
ds_read_b64_tr_b16 a[96:97],v6 offset:49152
ds_read_b64_tr_b16 a[98:99],v6 offset:50176
ds_read_b64_tr_b16 a[100:101],v6 offset:51200
ds_read_b64_tr_b16 a[102:103],v6 offset:52224
ds_read_b64_tr_b16 a[104:105],v6 offset:49160
ds_read_b64_tr_b16 a[106:107],v6 offset:50184
ds_read_b64_tr_b16 a[108:109],v6 offset:51208
ds_read_b64_tr_b16 a[110:111],v6 offset:52232
ds_read_b64_tr_b16 a[112:113],v7 offset:49152
ds_read_b64_tr_b16 a[114:115],v7 offset:50176
ds_read_b64_tr_b16 a[116:117],v7 offset:51200
ds_read_b64_tr_b16 a[118:119],v7 offset:52224
ds_read_b64_tr_b16 a[120:121],v7 offset:49160
ds_read_b64_tr_b16 a[122:123],v7 offset:50184
ds_read_b64_tr_b16 a[124:125],v7 offset:51208
s_waitcnt lgkmcnt(14)
ds_read_b64_tr_b16 a[126:127],v7 offset:52232
v_mfma_f32_16x16x32_bf16 a[224:227],a[240:243],v[224:227],a[224:227]
v_mfma_f32_16x16x32_bf16 a[224:227],a[240:243],v[228:231],a[224:227]
v_mfma_f32_16x16x32_bf16 a[228:231],a[240:243],v[232:235],a[228:231]
s_waitcnt lgkmcnt(14)
ds_read_b64_tr_b16 a[128:129],v8 offset:49152
v_mfma_f32_16x16x32_bf16 a[228:231],a[240:243],v[236:239],a[228:231]
s_waitcnt lgkmcnt(14)
ds_read_b64_tr_b16 a[130:131],v8 offset:50176
v_mfma_f32_16x16x32_bf16 a[232:235],a[240:243],v[240:243],a[232:235]
v_mfma_f32_16x16x32_bf16 a[232:235],a[240:243],v[244:247],a[232:235]
s_waitcnt lgkmcnt(14)
v_mfma_f32_16x16x32_bf16 a[236:239],a[240:243],v[248:251],a[236:239]
ds_read_b64_tr_b16 a[132:133],v8 offset:51200
v_mfma_f32_16x16x32_bf16 a[236:239],a[240:243],v[252:255],a[236:239]
s_waitcnt lgkmcnt(14)
ds_read_b64_tr_b16 a[134:135],v8 offset:52224
v_mfma_f32_16x16x32_bf16 v[80:83],a[96:99],v[248:251],v[80:83]
v_mfma_f32_16x16x32_bf16 v[80:83],a[100:103],v[252:255],v[80:83]
s_waitcnt lgkmcnt(14)
ds_read_b64_tr_b16 a[136:137],v8 offset:49160
v_mfma_f32_16x16x32_bf16 v[64:67],a[100:103],v[244:247],v[64:67]
s_waitcnt lgkmcnt(14)
ds_read_b64_tr_b16 a[138:139],v8 offset:50184
v_mfma_f32_16x16x32_bf16 v[64:67],a[96:99],v[240:243],v[64:67]
v_mfma_f32_16x16x32_bf16 v[48:51],a[96:99],v[232:235],v[48:51]
v_mfma_f32_16x16x32_bf16 v[48:51],a[100:103],v[236:239],v[48:51]
s_waitcnt lgkmcnt(14)
ds_read_b64_tr_b16 a[140:141],v8 offset:51208
v_mfma_f32_16x16x32_bf16 v[32:35],a[100:103],v[228:231],v[32:35]
s_waitcnt lgkmcnt(14)
ds_read_b64_tr_b16 a[142:143],v8 offset:52232
v_mfma_f32_16x16x32_bf16 v[32:35],a[96:99],v[224:227],v[32:35]
v_mfma_f32_16x16x32_bf16 v[36:39],a[104:107],v[224:227],v[36:39]
v_mfma_f32_16x16x32_bf16 v[36:39],a[108:111],v[228:231],v[36:39]
s_waitcnt lgkmcnt(14)
ds_read_b64_tr_b16 a[144:145],v9 offset:49152
v_mfma_f32_16x16x32_bf16 v[52:55],a[108:111],v[236:239],v[52:55]
s_waitcnt lgkmcnt(14)
ds_read_b64_tr_b16 a[146:147],v9 offset:50176
v_mfma_f32_16x16x32_bf16 v[52:55],a[104:107],v[232:235],v[52:55]
v_mfma_f32_16x16x32_bf16 v[68:71],a[104:107],v[240:243],v[68:71]
s_waitcnt lgkmcnt(14)
ds_read_b64_tr_b16 a[148:149],v9 offset:51200
v_mfma_f32_16x16x32_bf16 v[68:71],a[108:111],v[244:247],v[68:71]
s_waitcnt lgkmcnt(14)
ds_read_b64_tr_b16 a[150:151],v9 offset:52224
v_mfma_f32_16x16x32_bf16 v[84:87],a[108:111],v[252:255],v[84:87]
v_mfma_f32_16x16x32_bf16 v[84:87],a[104:107],v[248:251],v[84:87]
v_mfma_f32_16x16x32_bf16 v[88:91],a[112:115],v[248:251],v[88:91]
s_waitcnt lgkmcnt(14)
ds_read_b64_tr_b16 a[152:153],v9 offset:49160
v_mfma_f32_16x16x32_bf16 v[88:91],a[116:119],v[252:255],v[88:91]
s_waitcnt lgkmcnt(14)
ds_read_b64_tr_b16 a[154:155],v9 offset:50184
v_mfma_f32_16x16x32_bf16 v[72:75],a[116:119],v[244:247],v[72:75]
v_mfma_f32_16x16x32_bf16 v[72:75],a[112:115],v[240:243],v[72:75]
s_waitcnt lgkmcnt(14)
ds_read_b64_tr_b16 a[156:157],v9 offset:51208
v_mfma_f32_16x16x32_bf16 v[56:59],a[112:115],v[232:235],v[56:59]
s_waitcnt lgkmcnt(14)
ds_read_b64_tr_b16 a[158:159],v9 offset:52232
v_mfma_f32_16x16x32_bf16 v[56:59],a[116:119],v[236:239],v[56:59]
v_mfma_f32_16x16x32_bf16 v[40:43],a[116:119],v[228:231],v[40:43]
v_mfma_f32_16x16x32_bf16 v[40:43],a[112:115],v[224:227],v[40:43]
v_mfma_f32_16x16x32_bf16 v[44:47],a[120:123],v[224:227],v[44:47]
v_mfma_f32_16x16x32_bf16 v[44:47],a[124:127],v[228:231],v[44:47]
v_mfma_f32_16x16x32_bf16 v[60:63],a[124:127],v[236:239],v[60:63]
v_mfma_f32_16x16x32_bf16 v[60:63],a[120:123],v[232:235],v[60:63]
v_mfma_f32_16x16x32_bf16 v[76:79],a[120:123],v[240:243],v[76:79]
v_mfma_f32_16x16x32_bf16 v[76:79],a[124:127],v[244:247],v[76:79]
v_mfma_f32_16x16x32_bf16 v[92:95],a[124:127],v[252:255],v[92:95]
v_mfma_f32_16x16x32_bf16 v[92:95],a[120:123],v[248:251],v[92:95]
s_waitcnt lgkmcnt(12)
v_mfma_f32_16x16x32_bf16 a[208:211],a[128:131],v[248:251],a[208:211]
v_mfma_f32_16x16x32_bf16 a[208:211],a[132:135],v[252:255],a[208:211]
v_mfma_f32_16x16x32_bf16 a[192:195],a[132:135],v[244:247],a[192:195]
v_mfma_f32_16x16x32_bf16 a[192:195],a[128:131],v[240:243],a[192:195]
v_mfma_f32_16x16x32_bf16 a[176:179],a[128:131],v[232:235],a[176:179]
v_mfma_f32_16x16x32_bf16 a[176:179],a[132:135],v[236:239],a[176:179]
v_mfma_f32_16x16x32_bf16 a[160:163],a[132:135],v[228:231],a[160:163]
s_waitcnt lgkmcnt(8)
v_mfma_f32_16x16x32_bf16 a[160:163],a[128:131],v[224:227],a[160:163]
v_mfma_f32_16x16x32_bf16 a[164:167],a[136:139],v[224:227],a[164:167]
v_mfma_f32_16x16x32_bf16 a[164:167],a[140:143],v[228:231],a[164:167]
v_mfma_f32_16x16x32_bf16 a[180:183],a[140:143],v[236:239],a[180:183]
v_mfma_f32_16x16x32_bf16 a[180:183],a[136:139],v[232:235],a[180:183]
v_mfma_f32_16x16x32_bf16 a[196:199],a[136:139],v[240:243],a[196:199]
v_mfma_f32_16x16x32_bf16 a[196:199],a[140:143],v[244:247],a[196:199]
v_mfma_f32_16x16x32_bf16 a[212:215],a[140:143],v[252:255],a[212:215]
v_mfma_f32_16x16x32_bf16 a[212:215],a[136:139],v[248:251],a[212:215]
s_waitcnt lgkmcnt(4)
v_mfma_f32_16x16x32_bf16 a[216:219],a[144:147],v[248:251],a[216:219]
v_mfma_f32_16x16x32_bf16 a[216:219],a[148:151],v[252:255],a[216:219]
v_mfma_f32_16x16x32_bf16 a[200:203],a[148:151],v[244:247],a[200:203]
v_mfma_f32_16x16x32_bf16 a[200:203],a[144:147],v[240:243],a[200:203]
v_mfma_f32_16x16x32_bf16 a[184:187],a[144:147],v[232:235],a[184:187]
v_mfma_f32_16x16x32_bf16 a[184:187],a[148:151],v[236:239],a[184:187]
v_mfma_f32_16x16x32_bf16 a[168:171],a[148:151],v[228:231],a[168:171]
v_mfma_f32_16x16x32_bf16 a[168:171],a[144:147],v[224:227],a[168:171]
s_waitcnt lgkmcnt(0)
v_mfma_f32_16x16x32_bf16 a[172:175],a[152:155],v[224:227],a[172:175]
v_mfma_f32_16x16x32_bf16 a[172:175],a[156:159],v[228:231],a[172:175]
v_mfma_f32_16x16x32_bf16 a[188:191],a[156:159],v[236:239],a[188:191]
v_mfma_f32_16x16x32_bf16 a[188:191],a[152:155],v[232:235],a[188:191]
v_mfma_f32_16x16x32_bf16 a[204:207],a[152:155],v[240:243],a[204:207]
v_mfma_f32_16x16x32_bf16 a[204:207],a[156:159],v[244:247],a[204:207]
v_mfma_f32_16x16x32_bf16 a[220:223],a[156:159],v[252:255],a[220:223]
v_mfma_f32_16x16x32_bf16 a[220:223],a[152:155],v[248:251],a[220:223]
v_accvgpr_read_b32 v14,a224
v_accvgpr_read_b32 v15,a228
v_accvgpr_read_b32 v16,a232
v_accvgpr_read_b32 v17,a236
v_add_f32 v31,v14,v15
v_add_f32 v31,v31,v16
v_add_f32 v31,v31,v17
v_cmp_nge_f32 vcc,s27,v31
v_rcp_f32 v14,v14
v_rcp_f32 v15,v15
v_rcp_f32 v16,v16
v_rcp_f32 v17,v17
s_cmp_lg_u64 vcc,0
s_cselect_b32 s32,s29,0
s_or_b32 s28,s28,s32
s_lshl_b32 s29,s29,1
s_add_u32 s24,s24,65536
v_accvgpr_read_b32 v23,a244
v_accvgpr_read_b32 v24,a245
v_accvgpr_read_b32 v96,a160
v_accvgpr_read_b32 v97,a161
v_accvgpr_read_b32 v98,a162
v_accvgpr_read_b32 v99,a163
v_accvgpr_read_b32 v100,a164
v_accvgpr_read_b32 v101,a165
v_accvgpr_read_b32 v102,a166
v_accvgpr_read_b32 v103,a167
v_accvgpr_read_b32 v104,a168
v_accvgpr_read_b32 v105,a169
v_accvgpr_read_b32 v106,a170
v_accvgpr_read_b32 v107,a171
v_accvgpr_read_b32 v108,a172
v_accvgpr_read_b32 v109,a173
v_accvgpr_read_b32 v110,a174
v_accvgpr_read_b32 v111,a175
v_pk_mul_f32 v[32:33],v[32:33],v[14:15] op_sel_hi:[1,0]
v_pk_mul_f32 v[34:35],v[34:35],v[14:15] op_sel_hi:[1,0]
v_pk_mul_f32 v[36:37],v[36:37],v[14:15] op_sel_hi:[1,0]
v_pk_mul_f32 v[38:39],v[38:39],v[14:15] op_sel_hi:[1,0]
v_pk_mul_f32 v[40:41],v[40:41],v[14:15] op_sel_hi:[1,0]
v_pk_mul_f32 v[42:43],v[42:43],v[14:15] op_sel_hi:[1,0]
v_pk_mul_f32 v[44:45],v[44:45],v[14:15] op_sel_hi:[1,0]
v_pk_mul_f32 v[46:47],v[46:47],v[14:15] op_sel_hi:[1,0]
v_pk_mul_f32 v[96:97],v[96:97],v[14:15] op_sel_hi:[1,0]
v_pk_mul_f32 v[98:99],v[98:99],v[14:15] op_sel_hi:[1,0]
v_pk_mul_f32 v[100:101],v[100:101],v[14:15] op_sel_hi:[1,0]
v_pk_mul_f32 v[102:103],v[102:103],v[14:15] op_sel_hi:[1,0]
v_pk_mul_f32 v[104:105],v[104:105],v[14:15] op_sel_hi:[1,0]
v_pk_mul_f32 v[106:107],v[106:107],v[14:15] op_sel_hi:[1,0]
v_pk_mul_f32 v[108:109],v[108:109],v[14:15] op_sel_hi:[1,0]
v_pk_mul_f32 v[110:111],v[110:111],v[14:15] op_sel_hi:[1,0]
v_cvt_pk_bf16_f32 v32,v32,v33
v_cvt_pk_bf16_f32 v33,v34,v35
v_cvt_pk_bf16_f32 v34,v36,v37
v_cvt_pk_bf16_f32 v35,v38,v39
v_cvt_pk_bf16_f32 v40,v40,v41
v_cvt_pk_bf16_f32 v41,v42,v43
v_cvt_pk_bf16_f32 v42,v44,v45
v_cvt_pk_bf16_f32 v43,v46,v47
v_cvt_pk_bf16_f32 v96,v96,v97
v_cvt_pk_bf16_f32 v97,v98,v99
v_cvt_pk_bf16_f32 v98,v100,v101
v_cvt_pk_bf16_f32 v99,v102,v103
v_cvt_pk_bf16_f32 v104,v104,v105
v_cvt_pk_bf16_f32 v105,v106,v107
v_cvt_pk_bf16_f32 v106,v108,v109
v_cvt_pk_bf16_f32 v107,v110,v111
ds_write_b128 v23,v[32:35] offset:32768
ds_write_b128 v23,v[40:43] offset:32832
ds_write_b128 v23,v[96:99] offset:32896
ds_write_b128 v23,v[104:107] offset:32960
ds_read_b128 v[32:35],v24 offset:32768
ds_read_b128 v[40:43],v24 offset:33856
ds_read_b128 v[96:99],v24 offset:34944
ds_read_b128 v[104:107],v24 offset:36032
v_accvgpr_read_b32 v112,a176
v_accvgpr_read_b32 v113,a177
v_accvgpr_read_b32 v114,a178
v_accvgpr_read_b32 v115,a179
v_accvgpr_read_b32 v116,a180
v_accvgpr_read_b32 v117,a181
v_accvgpr_read_b32 v118,a182
v_accvgpr_read_b32 v119,a183
v_accvgpr_read_b32 v120,a184
v_accvgpr_read_b32 v121,a185
v_accvgpr_read_b32 v122,a186
v_accvgpr_read_b32 v123,a187
v_accvgpr_read_b32 v124,a188
v_accvgpr_read_b32 v125,a189
v_accvgpr_read_b32 v126,a190
v_accvgpr_read_b32 v127,a191
v_pk_mul_f32 v[48:49],v[48:49],v[14:15] op_sel:[0,1] op_sel_hi:[1,1]
v_pk_mul_f32 v[50:51],v[50:51],v[14:15] op_sel:[0,1] op_sel_hi:[1,1]
v_pk_mul_f32 v[52:53],v[52:53],v[14:15] op_sel:[0,1] op_sel_hi:[1,1]
v_pk_mul_f32 v[54:55],v[54:55],v[14:15] op_sel:[0,1] op_sel_hi:[1,1]
v_pk_mul_f32 v[56:57],v[56:57],v[14:15] op_sel:[0,1] op_sel_hi:[1,1]
v_pk_mul_f32 v[58:59],v[58:59],v[14:15] op_sel:[0,1] op_sel_hi:[1,1]
v_pk_mul_f32 v[60:61],v[60:61],v[14:15] op_sel:[0,1] op_sel_hi:[1,1]
v_pk_mul_f32 v[62:63],v[62:63],v[14:15] op_sel:[0,1] op_sel_hi:[1,1]
v_pk_mul_f32 v[112:113],v[112:113],v[14:15] op_sel:[0,1] op_sel_hi:[1,1]
v_pk_mul_f32 v[114:115],v[114:115],v[14:15] op_sel:[0,1] op_sel_hi:[1,1]
v_pk_mul_f32 v[116:117],v[116:117],v[14:15] op_sel:[0,1] op_sel_hi:[1,1]
v_pk_mul_f32 v[118:119],v[118:119],v[14:15] op_sel:[0,1] op_sel_hi:[1,1]
v_pk_mul_f32 v[120:121],v[120:121],v[14:15] op_sel:[0,1] op_sel_hi:[1,1]
v_pk_mul_f32 v[122:123],v[122:123],v[14:15] op_sel:[0,1] op_sel_hi:[1,1]
v_pk_mul_f32 v[124:125],v[124:125],v[14:15] op_sel:[0,1] op_sel_hi:[1,1]
v_pk_mul_f32 v[126:127],v[126:127],v[14:15] op_sel:[0,1] op_sel_hi:[1,1]
s_add_u32 s30,s24,0
s_waitcnt lgkmcnt(3)
buffer_store_dwordx4 v[32:35],v22,s[16:19],s30 offen sc0 sc1
s_add_u32 s32,s24,4096
s_waitcnt lgkmcnt(2)
buffer_store_dwordx4 v[40:43],v22,s[16:19],s32 offen sc0 sc1
s_add_u32 s30,s24,8192
s_waitcnt lgkmcnt(1)
buffer_store_dwordx4 v[96:99],v22,s[16:19],s30 offen sc0 sc1
s_add_u32 s32,s24,12288
s_waitcnt lgkmcnt(0)
buffer_store_dwordx4 v[104:107],v22,s[16:19],s32 offen sc0 sc1
v_cvt_pk_bf16_f32 v48,v48,v49
v_cvt_pk_bf16_f32 v49,v50,v51
v_cvt_pk_bf16_f32 v50,v52,v53
v_cvt_pk_bf16_f32 v51,v54,v55
v_cvt_pk_bf16_f32 v56,v56,v57
v_cvt_pk_bf16_f32 v57,v58,v59
v_cvt_pk_bf16_f32 v58,v60,v61
v_cvt_pk_bf16_f32 v59,v62,v63
v_cvt_pk_bf16_f32 v112,v112,v113
v_cvt_pk_bf16_f32 v113,v114,v115
v_cvt_pk_bf16_f32 v114,v116,v117
v_cvt_pk_bf16_f32 v115,v118,v119
v_cvt_pk_bf16_f32 v120,v120,v121
v_cvt_pk_bf16_f32 v121,v122,v123
v_cvt_pk_bf16_f32 v122,v124,v125
v_cvt_pk_bf16_f32 v123,v126,v127
ds_write_b128 v23,v[48:51] offset:32768
ds_write_b128 v23,v[56:59] offset:32832
ds_write_b128 v23,v[112:115] offset:32896
ds_write_b128 v23,v[120:123] offset:32960
ds_read_b128 v[48:51],v24 offset:32768
ds_read_b128 v[56:59],v24 offset:33856
ds_read_b128 v[112:115],v24 offset:34944
ds_read_b128 v[120:123],v24 offset:36032
v_accvgpr_read_b32 v128,a192
v_accvgpr_read_b32 v129,a193
v_accvgpr_read_b32 v130,a194
v_accvgpr_read_b32 v131,a195
v_accvgpr_read_b32 v132,a196
v_accvgpr_read_b32 v133,a197
v_accvgpr_read_b32 v134,a198
v_accvgpr_read_b32 v135,a199
v_accvgpr_read_b32 v136,a200
v_accvgpr_read_b32 v137,a201
v_accvgpr_read_b32 v138,a202
v_accvgpr_read_b32 v139,a203
v_accvgpr_read_b32 v140,a204
v_accvgpr_read_b32 v141,a205
v_accvgpr_read_b32 v142,a206
v_accvgpr_read_b32 v143,a207
v_pk_mul_f32 v[64:65],v[64:65],v[16:17] op_sel_hi:[1,0]
v_pk_mul_f32 v[66:67],v[66:67],v[16:17] op_sel_hi:[1,0]
v_pk_mul_f32 v[68:69],v[68:69],v[16:17] op_sel_hi:[1,0]
v_pk_mul_f32 v[70:71],v[70:71],v[16:17] op_sel_hi:[1,0]
v_pk_mul_f32 v[72:73],v[72:73],v[16:17] op_sel_hi:[1,0]
v_pk_mul_f32 v[74:75],v[74:75],v[16:17] op_sel_hi:[1,0]
v_pk_mul_f32 v[76:77],v[76:77],v[16:17] op_sel_hi:[1,0]
v_pk_mul_f32 v[78:79],v[78:79],v[16:17] op_sel_hi:[1,0]
v_pk_mul_f32 v[128:129],v[128:129],v[16:17] op_sel_hi:[1,0]
v_pk_mul_f32 v[130:131],v[130:131],v[16:17] op_sel_hi:[1,0]
v_pk_mul_f32 v[132:133],v[132:133],v[16:17] op_sel_hi:[1,0]
v_pk_mul_f32 v[134:135],v[134:135],v[16:17] op_sel_hi:[1,0]
v_pk_mul_f32 v[136:137],v[136:137],v[16:17] op_sel_hi:[1,0]
v_pk_mul_f32 v[138:139],v[138:139],v[16:17] op_sel_hi:[1,0]
v_pk_mul_f32 v[140:141],v[140:141],v[16:17] op_sel_hi:[1,0]
v_pk_mul_f32 v[142:143],v[142:143],v[16:17] op_sel_hi:[1,0]
s_add_u32 s30,s24,16384
s_waitcnt lgkmcnt(3)
buffer_store_dwordx4 v[48:51],v22,s[16:19],s30 offen sc0 sc1
s_add_u32 s32,s24,20480
s_waitcnt lgkmcnt(2)
buffer_store_dwordx4 v[56:59],v22,s[16:19],s32 offen sc0 sc1
s_add_u32 s30,s24,24576
s_waitcnt lgkmcnt(1)
buffer_store_dwordx4 v[112:115],v22,s[16:19],s30 offen sc0 sc1
s_add_u32 s32,s24,28672
s_waitcnt lgkmcnt(0)
buffer_store_dwordx4 v[120:123],v22,s[16:19],s32 offen sc0 sc1
v_cvt_pk_bf16_f32 v64,v64,v65
v_cvt_pk_bf16_f32 v65,v66,v67
v_cvt_pk_bf16_f32 v66,v68,v69
v_cvt_pk_bf16_f32 v67,v70,v71
v_cvt_pk_bf16_f32 v72,v72,v73
v_cvt_pk_bf16_f32 v73,v74,v75
v_cvt_pk_bf16_f32 v74,v76,v77
v_cvt_pk_bf16_f32 v75,v78,v79
v_cvt_pk_bf16_f32 v128,v128,v129
v_cvt_pk_bf16_f32 v129,v130,v131
v_cvt_pk_bf16_f32 v130,v132,v133
v_cvt_pk_bf16_f32 v131,v134,v135
v_cvt_pk_bf16_f32 v136,v136,v137
v_cvt_pk_bf16_f32 v137,v138,v139
v_cvt_pk_bf16_f32 v138,v140,v141
v_cvt_pk_bf16_f32 v139,v142,v143
ds_write_b128 v23,v[64:67] offset:32768
ds_write_b128 v23,v[72:75] offset:32832
ds_write_b128 v23,v[128:131] offset:32896
ds_write_b128 v23,v[136:139] offset:32960
ds_read_b128 v[64:67],v24 offset:32768
ds_read_b128 v[72:75],v24 offset:33856
ds_read_b128 v[128:131],v24 offset:34944
ds_read_b128 v[136:139],v24 offset:36032
v_accvgpr_read_b32 v144,a208
v_accvgpr_read_b32 v145,a209
v_accvgpr_read_b32 v146,a210
v_accvgpr_read_b32 v147,a211
v_accvgpr_read_b32 v148,a212
v_accvgpr_read_b32 v149,a213
v_accvgpr_read_b32 v150,a214
v_accvgpr_read_b32 v151,a215
v_accvgpr_read_b32 v152,a216
v_accvgpr_read_b32 v153,a217
v_accvgpr_read_b32 v154,a218
v_accvgpr_read_b32 v155,a219
v_accvgpr_read_b32 v156,a220
v_accvgpr_read_b32 v157,a221
v_accvgpr_read_b32 v158,a222
v_accvgpr_read_b32 v159,a223
v_pk_mul_f32 v[80:81],v[80:81],v[16:17] op_sel:[0,1] op_sel_hi:[1,1]
v_pk_mul_f32 v[82:83],v[82:83],v[16:17] op_sel:[0,1] op_sel_hi:[1,1]
v_pk_mul_f32 v[84:85],v[84:85],v[16:17] op_sel:[0,1] op_sel_hi:[1,1]
v_pk_mul_f32 v[86:87],v[86:87],v[16:17] op_sel:[0,1] op_sel_hi:[1,1]
v_pk_mul_f32 v[88:89],v[88:89],v[16:17] op_sel:[0,1] op_sel_hi:[1,1]
v_pk_mul_f32 v[90:91],v[90:91],v[16:17] op_sel:[0,1] op_sel_hi:[1,1]
v_pk_mul_f32 v[92:93],v[92:93],v[16:17] op_sel:[0,1] op_sel_hi:[1,1]
v_pk_mul_f32 v[94:95],v[94:95],v[16:17] op_sel:[0,1] op_sel_hi:[1,1]
v_pk_mul_f32 v[144:145],v[144:145],v[16:17] op_sel:[0,1] op_sel_hi:[1,1]
v_pk_mul_f32 v[146:147],v[146:147],v[16:17] op_sel:[0,1] op_sel_hi:[1,1]
v_pk_mul_f32 v[148:149],v[148:149],v[16:17] op_sel:[0,1] op_sel_hi:[1,1]
v_pk_mul_f32 v[150:151],v[150:151],v[16:17] op_sel:[0,1] op_sel_hi:[1,1]
v_pk_mul_f32 v[152:153],v[152:153],v[16:17] op_sel:[0,1] op_sel_hi:[1,1]
v_pk_mul_f32 v[154:155],v[154:155],v[16:17] op_sel:[0,1] op_sel_hi:[1,1]
v_pk_mul_f32 v[156:157],v[156:157],v[16:17] op_sel:[0,1] op_sel_hi:[1,1]
v_pk_mul_f32 v[158:159],v[158:159],v[16:17] op_sel:[0,1] op_sel_hi:[1,1]
s_add_u32 s30,s24,32768
s_waitcnt lgkmcnt(3)
buffer_store_dwordx4 v[64:67],v22,s[16:19],s30 offen sc0 sc1
s_add_u32 s32,s24,36864
s_waitcnt lgkmcnt(2)
buffer_store_dwordx4 v[72:75],v22,s[16:19],s32 offen sc0 sc1
s_add_u32 s30,s24,40960
s_waitcnt lgkmcnt(1)
buffer_store_dwordx4 v[128:131],v22,s[16:19],s30 offen sc0 sc1
s_add_u32 s32,s24,45056
s_waitcnt lgkmcnt(0)
buffer_store_dwordx4 v[136:139],v22,s[16:19],s32 offen sc0 sc1
v_cvt_pk_bf16_f32 v80,v80,v81
v_cvt_pk_bf16_f32 v81,v82,v83
v_cvt_pk_bf16_f32 v82,v84,v85
v_cvt_pk_bf16_f32 v83,v86,v87
v_cvt_pk_bf16_f32 v88,v88,v89
v_cvt_pk_bf16_f32 v89,v90,v91
v_cvt_pk_bf16_f32 v90,v92,v93
v_cvt_pk_bf16_f32 v91,v94,v95
v_cvt_pk_bf16_f32 v144,v144,v145
v_cvt_pk_bf16_f32 v145,v146,v147
v_cvt_pk_bf16_f32 v146,v148,v149
v_cvt_pk_bf16_f32 v147,v150,v151
v_cvt_pk_bf16_f32 v152,v152,v153
v_cvt_pk_bf16_f32 v153,v154,v155
v_cvt_pk_bf16_f32 v154,v156,v157
v_cvt_pk_bf16_f32 v155,v158,v159
ds_write_b128 v23,v[80:83] offset:32768
ds_write_b128 v23,v[88:91] offset:32832
ds_write_b128 v23,v[144:147] offset:32896
ds_write_b128 v23,v[152:155] offset:32960
ds_read_b128 v[80:83],v24 offset:32768
ds_read_b128 v[88:91],v24 offset:33856
ds_read_b128 v[144:147],v24 offset:34944
ds_read_b128 v[152:155],v24 offset:36032
s_add_u32 s30,s24,49152
s_waitcnt lgkmcnt(3)
buffer_store_dwordx4 v[80:83],v22,s[16:19],s30 offen sc0 sc1
s_add_u32 s32,s24,53248
s_waitcnt lgkmcnt(2)
buffer_store_dwordx4 v[88:91],v22,s[16:19],s32 offen sc0 sc1
s_add_u32 s30,s24,57344
s_waitcnt lgkmcnt(1)
buffer_store_dwordx4 v[144:147],v22,s[16:19],s30 offen sc0 sc1
s_add_u32 s32,s24,61440
s_waitcnt lgkmcnt(0)
buffer_store_dwordx4 v[152:155],v22,s[16:19],s32 offen sc0 sc1
s_add_u32 s24,s24,65536
s_lshl_b32 s30,s31,2
s_add_u32 s30,s30,0
v_mov_b32 v23,s30
v_mov_b32 v24,s28
ds_write_b32 v23,v24
v_mov_b32 v23,0
s_waitcnt lgkmcnt(0)
s_barrier
ds_read_b128 v[24:27],v23 offset:0
s_waitcnt lgkmcnt(0)
v_or_b32 v24,v24,v25
v_or3_b32 v24,v24,v26,v27
s_nop 0
v_readfirstlane_b32 s28,v24
s_nop 3
s_cmp_lg_u32 s28,0
s_cbranch_scc1 L_fin
s_endpgm
L_fin:
v_bfe_u32 v23,v22,4,6
v_lshrrev_b32 v24,10,v22
v_lshrrev_b32 v25,4,v23
v_and_b32 v26,3,v23
v_bfe_u32 v27,v23,2,2
v_lshlrev_b32 v22,4,v25
v_lshl_add_u32 v22,v26,8,v22
v_lshl_add_u32 v22,v24,10,v22
v_bfe_u32 v28,v23,2,1
v_lshl_add_u32 v22,v28,12,v22
v_bfe_u32 v28,v23,3,1
v_lshl_add_u32 v22,v28,6,v22
L_safe:
s_nop 3
s_cmp_eq_u32 s28,0
s_cbranch_scc1 L_end
s_ff1_i32_b32 s30,s28
s_bitset0_b32 s28,s30
s_lshl_b32 s21,s30,17
s_mov_b32 s22,s21
s_lshl_b32 s23,s30,16
s_mov_b32 s24,s23
s_waitcnt vmcnt(0) lgkmcnt(0)
s_barrier
s_add_u32 m0,s25,131072
s_nop 0
buffer_load_dwordx4 v1,s[4:7],s23 offen nt lds
buffer_load_dwordx4 v1,s[4:7],s23 offen offset:1024 nt lds
buffer_load_dwordx4 v1,s[4:7],s23 offen offset:2048 nt lds
buffer_load_dwordx4 v1,s[4:7],s23 offen offset:3072 nt lds
s_add_u32 s23,s23,16384
s_add_u32 m0,s25,147456
s_nop 0
buffer_load_dwordx4 v1,s[4:7],s23 offen nt lds
buffer_load_dwordx4 v1,s[4:7],s23 offen offset:1024 nt lds
buffer_load_dwordx4 v1,s[4:7],s23 offen offset:2048 nt lds
buffer_load_dwordx4 v1,s[4:7],s23 offen offset:3072 nt lds
s_add_u32 s23,s23,16384
s_add_u32 m0,s25,98304
s_nop 0
buffer_load_dwordx4 v1,s[4:7],s23 offen nt lds
buffer_load_dwordx4 v1,s[4:7],s23 offen offset:1024 nt lds
buffer_load_dwordx4 v1,s[4:7],s23 offen offset:2048 nt lds
buffer_load_dwordx4 v1,s[4:7],s23 offen offset:3072 nt lds
s_add_u32 s23,s23,16384
s_add_u32 m0,s25,114688
s_nop 0
buffer_load_dwordx4 v1,s[4:7],s23 offen nt lds
buffer_load_dwordx4 v1,s[4:7],s23 offen offset:1024 nt lds
buffer_load_dwordx4 v1,s[4:7],s23 offen offset:2048 nt lds
buffer_load_dwordx4 v1,s[4:7],s23 offen offset:3072 nt lds
s_add_u32 s23,s23,16384
s_add_u32 m0,s25,0
s_nop 0
buffer_load_dwordx4 v1,s[8:11],s21 offen nt lds
buffer_load_dwordx4 v1,s[8:11],s21 offen offset:1024 nt lds
buffer_load_dwordx4 v1,s[8:11],s21 offen offset:2048 nt lds
buffer_load_dwordx4 v1,s[8:11],s21 offen offset:3072 nt lds
s_add_u32 s21,s21,16384
s_add_u32 m0,s25,16384
s_nop 0
buffer_load_dwordx4 v1,s[8:11],s21 offen nt lds
buffer_load_dwordx4 v1,s[8:11],s21 offen offset:1024 nt lds
buffer_load_dwordx4 v1,s[8:11],s21 offen offset:2048 nt lds
buffer_load_dwordx4 v1,s[8:11],s21 offen offset:3072 nt lds
s_add_u32 s21,s21,16384
s_add_u32 m0,s25,65536
s_nop 0
buffer_load_dwordx4 v1,s[12:15],s22 offen nt lds
buffer_load_dwordx4 v1,s[12:15],s22 offen offset:1024 nt lds
buffer_load_dwordx4 v1,s[12:15],s22 offen offset:2048 nt lds
buffer_load_dwordx4 v1,s[12:15],s22 offen offset:3072 nt lds
s_add_u32 s22,s22,16384
s_add_u32 m0,s25,32768
s_nop 0
buffer_load_dwordx4 v1,s[8:11],s21 offen nt lds
buffer_load_dwordx4 v1,s[8:11],s21 offen offset:1024 nt lds
buffer_load_dwordx4 v1,s[8:11],s21 offen offset:2048 nt lds
buffer_load_dwordx4 v1,s[8:11],s21 offen offset:3072 nt lds
s_add_u32 s21,s21,16384
s_add_u32 m0,s25,81920
s_nop 0
buffer_load_dwordx4 v1,s[12:15],s22 offen nt lds
buffer_load_dwordx4 v1,s[12:15],s22 offen offset:1024 nt lds
buffer_load_dwordx4 v1,s[12:15],s22 offen offset:2048 nt lds
buffer_load_dwordx4 v1,s[12:15],s22 offen offset:3072 nt lds
s_add_u32 s22,s22,16384
v_subrev_u32 v23,32768,v10
v_subrev_u32 v24,32768,v11
v_subrev_u32 v25,32768,v12
v_subrev_u32 v26,32768,v13
s_waitcnt vmcnt(20)
s_barrier
ds_read_b128 a[0:3],v10 offset:0
ds_read_b128 a[4:7],v11 offset:0
ds_read_b128 a[8:11],v12 offset:0
ds_read_b128 a[12:15],v13 offset:0
ds_read_b128 a[16:19],v10 offset:16384
ds_read_b128 a[20:23],v11 offset:16384
ds_read_b128 a[24:27],v12 offset:16384
ds_read_b128 a[28:31],v13 offset:16384
ds_read_b128 a[32:35],v23 offset:0
ds_read_b128 a[36:39],v24 offset:0
ds_read_b128 a[40:43],v25 offset:0
ds_read_b128 a[44:47],v26 offset:0
ds_read_b128 a[48:51],v23 offset:16384
ds_read_b128 a[52:55],v24 offset:16384
ds_read_b128 a[56:59],v25 offset:16384
s_waitcnt lgkmcnt(14)
ds_read_b128 a[60:63],v26 offset:16384
s_waitcnt vmcnt(16)
s_waitcnt lgkmcnt(0)
s_barrier
ds_read_b128 a[96:99],v2 offset:0
ds_read_b128 a[100:103],v3 offset:0
ds_read_b128 a[104:107],v4 offset:0
ds_read_b128 a[108:111],v5 offset:0
ds_read_b128 a[112:115],v2 offset:1024
ds_read_b128 a[116:119],v3 offset:1024
ds_read_b128 a[120:123],v4 offset:1024
ds_read_b128 a[124:127],v5 offset:1024
s_waitcnt lgkmcnt(4)
v_mfma_f32_16x16x32_bf16 v[160:163],a[96:99],a[0:3],0
ds_read_b128 a[128:131],v2 offset:2048
v_mfma_f32_16x16x32_bf16 v[160:163],a[100:103],a[4:7],v[160:163]
v_mfma_f32_16x16x32_bf16 v[160:163],a[104:107],a[8:11],v[160:163]
v_mfma_f32_16x16x32_bf16 v[160:163],a[108:111],a[12:15],v[160:163]
v_mfma_f32_16x16x32_bf16 v[168:171],a[108:111],a[28:31],0
ds_read_b128 a[132:135],v3 offset:2048
v_mfma_f32_16x16x32_bf16 v[168:171],a[104:107],a[24:27],v[168:171]
v_mfma_f32_16x16x32_bf16 v[168:171],a[100:103],a[20:23],v[168:171]
v_mfma_f32_16x16x32_bf16 v[168:171],a[96:99],a[16:19],v[168:171]
v_mfma_f32_16x16x32_bf16 v[176:179],a[96:99],a[32:35],0
ds_read_b128 a[136:139],v4 offset:2048
v_mfma_f32_16x16x32_bf16 v[176:179],a[100:103],a[36:39],v[176:179]
v_mfma_f32_16x16x32_bf16 v[176:179],a[104:107],a[40:43],v[176:179]
v_mfma_f32_16x16x32_bf16 v[176:179],a[108:111],a[44:47],v[176:179]
ds_read_b128 a[140:143],v5 offset:2048
v_mfma_f32_16x16x32_bf16 v[184:187],a[108:111],a[60:63],0
v_mfma_f32_16x16x32_bf16 v[184:187],a[104:107],a[56:59],v[184:187]
v_mfma_f32_16x16x32_bf16 v[184:187],a[100:103],a[52:55],v[184:187]
s_waitcnt lgkmcnt(4)
v_mfma_f32_16x16x32_bf16 v[184:187],a[96:99],a[48:51],v[184:187]
ds_read_b128 a[144:147],v2 offset:3072
v_mfma_f32_16x16x32_bf16 v[164:167],a[112:115],a[0:3],0
v_mfma_f32_16x16x32_bf16 v[164:167],a[116:119],a[4:7],v[164:167]
v_mfma_f32_16x16x32_bf16 v[164:167],a[120:123],a[8:11],v[164:167]
v_mfma_f32_16x16x32_bf16 v[164:167],a[124:127],a[12:15],v[164:167]
ds_read_b128 a[148:151],v3 offset:3072
v_mfma_f32_16x16x32_bf16 v[172:175],a[124:127],a[28:31],0
v_mfma_f32_16x16x32_bf16 v[172:175],a[120:123],a[24:27],v[172:175]
v_mfma_f32_16x16x32_bf16 v[172:175],a[116:119],a[20:23],v[172:175]
ds_read_b128 a[152:155],v4 offset:3072
v_mfma_f32_16x16x32_bf16 v[172:175],a[112:115],a[16:19],v[172:175]
v_mfma_f32_16x16x32_bf16 v[180:183],a[112:115],a[32:35],0
v_mfma_f32_16x16x32_bf16 v[180:183],a[116:119],a[36:39],v[180:183]
v_mfma_f32_16x16x32_bf16 v[180:183],a[120:123],a[40:43],v[180:183]
ds_read_b128 a[156:159],v5 offset:3072
v_mfma_f32_16x16x32_bf16 v[180:183],a[124:127],a[44:47],v[180:183]
v_mfma_f32_16x16x32_bf16 v[188:191],a[124:127],a[60:63],0
v_mfma_f32_16x16x32_bf16 v[188:191],a[120:123],a[56:59],v[188:191]
v_mfma_f32_16x16x32_bf16 v[188:191],a[116:119],a[52:55],v[188:191]
v_mfma_f32_16x16x32_bf16 v[188:191],a[112:115],a[48:51],v[188:191]
s_waitcnt lgkmcnt(4)
v_mfma_f32_16x16x32_bf16 v[192:195],a[128:131],a[0:3],0
v_mfma_f32_16x16x32_bf16 v[192:195],a[132:135],a[4:7],v[192:195]
v_mfma_f32_16x16x32_bf16 v[192:195],a[136:139],a[8:11],v[192:195]
v_mfma_f32_16x16x32_bf16 v[192:195],a[140:143],a[12:15],v[192:195]
v_mfma_f32_16x16x32_bf16 v[200:203],a[140:143],a[28:31],0
v_mfma_f32_16x16x32_bf16 v[200:203],a[136:139],a[24:27],v[200:203]
v_mfma_f32_16x16x32_bf16 v[200:203],a[132:135],a[20:23],v[200:203]
v_mfma_f32_16x16x32_bf16 v[200:203],a[128:131],a[16:19],v[200:203]
v_mfma_f32_16x16x32_bf16 v[208:211],a[128:131],a[32:35],0
v_mfma_f32_16x16x32_bf16 v[208:211],a[132:135],a[36:39],v[208:211]
v_mfma_f32_16x16x32_bf16 v[208:211],a[136:139],a[40:43],v[208:211]
v_mfma_f32_16x16x32_bf16 v[208:211],a[140:143],a[44:47],v[208:211]
v_mfma_f32_16x16x32_bf16 v[216:219],a[140:143],a[60:63],0
v_mfma_f32_16x16x32_bf16 v[216:219],a[136:139],a[56:59],v[216:219]
v_mfma_f32_16x16x32_bf16 v[216:219],a[132:135],a[52:55],v[216:219]
v_mfma_f32_16x16x32_bf16 v[216:219],a[128:131],a[48:51],v[216:219]
s_waitcnt lgkmcnt(0)
v_mfma_f32_16x16x32_bf16 v[196:199],a[144:147],a[0:3],0
v_mfma_f32_16x16x32_bf16 v[196:199],a[148:151],a[4:7],v[196:199]
v_mfma_f32_16x16x32_bf16 v[196:199],a[152:155],a[8:11],v[196:199]
v_mfma_f32_16x16x32_bf16 v[196:199],a[156:159],a[12:15],v[196:199]
v_mfma_f32_16x16x32_bf16 v[204:207],a[156:159],a[28:31],0
v_mfma_f32_16x16x32_bf16 v[204:207],a[152:155],a[24:27],v[204:207]
v_mfma_f32_16x16x32_bf16 v[204:207],a[148:151],a[20:23],v[204:207]
v_mfma_f32_16x16x32_bf16 v[204:207],a[144:147],a[16:19],v[204:207]
v_mfma_f32_16x16x32_bf16 v[212:215],a[144:147],a[32:35],0
v_mfma_f32_16x16x32_bf16 v[212:215],a[148:151],a[36:39],v[212:215]
v_mfma_f32_16x16x32_bf16 v[212:215],a[152:155],a[40:43],v[212:215]
v_mfma_f32_16x16x32_bf16 v[212:215],a[156:159],a[44:47],v[212:215]
v_mfma_f32_16x16x32_bf16 v[220:223],a[156:159],a[60:63],0
v_mfma_f32_16x16x32_bf16 v[220:223],a[152:155],a[56:59],v[220:223]
v_mfma_f32_16x16x32_bf16 v[220:223],a[148:151],a[52:55],v[220:223]
v_mfma_f32_16x16x32_bf16 v[220:223],a[144:147],a[48:51],v[220:223]
s_add_u32 m0,s25,49152
s_nop 0
buffer_load_dwordx4 v1,s[8:11],s21 offen nt lds
buffer_load_dwordx4 v1,s[8:11],s21 offen offset:1024 nt lds
buffer_load_dwordx4 v1,s[8:11],s21 offen offset:2048 nt lds
buffer_load_dwordx4 v1,s[8:11],s21 offen offset:3072 nt lds
s_add_u32 s21,s21,16384
s_add_u32 m0,s25,98304
s_nop 0
buffer_load_dwordx4 v1,s[12:15],s22 offen nt lds
buffer_load_dwordx4 v1,s[12:15],s22 offen offset:1024 nt lds
buffer_load_dwordx4 v1,s[12:15],s22 offen offset:2048 nt lds
buffer_load_dwordx4 v1,s[12:15],s22 offen offset:3072 nt lds
s_add_u32 s22,s22,16384
s_waitcnt vmcnt(16)
s_barrier
ds_read_b128 a[96:99],v2 offset:16384
s_add_u32 m0,s25,0
s_nop 0
buffer_load_dwordx4 v1,s[8:11],s21 offen nt lds
ds_read_b128 a[100:103],v3 offset:16384
ds_read_b128 a[104:107],v4 offset:16384
buffer_load_dwordx4 v1,s[8:11],s21 offen offset:1024 nt lds
ds_read_b128 a[108:111],v5 offset:16384
ds_read_b128 a[112:115],v2 offset:17408
ds_read_b128 a[116:119],v3 offset:17408
ds_read_b128 a[120:123],v4 offset:17408
buffer_load_dwordx4 v1,s[8:11],s21 offen offset:2048 nt lds
ds_read_b128 a[124:127],v5 offset:17408
s_waitcnt lgkmcnt(4)
v_max3_f32 v23,v160,v161,v162
v_max3_f32 v24,v168,v169,v170
v_max3_f32 v25,v176,v177,v178
v_max3_f32 v26,v184,v185,v186
v_max3_f32 v23,v23,v163,v164
v_max3_f32 v24,v24,v171,v172
v_max3_f32 v25,v25,v179,v180
v_max3_f32 v26,v26,v187,v188
v_max3_f32 v23,v23,v165,v166
v_max3_f32 v24,v24,v173,v174
v_max3_f32 v25,v25,v181,v182
v_max3_f32 v26,v26,v189,v190
v_max_f32 v23,v23,v167
v_max_f32 v24,v24,v175
v_max_f32 v25,v25,v183
v_max_f32 v26,v26,v191
v_mov_b32 v27,v23
v_mov_b32 v28,v24
v_mov_b32 v29,v25
v_mov_b32 v30,v26
v_permlane16_swap_b32 v23,v27
v_permlane16_swap_b32 v24,v28
v_permlane16_swap_b32 v25,v29
v_permlane16_swap_b32 v26,v30
v_max_f32 v23,v23,v27
v_max_f32 v24,v24,v28
v_max_f32 v25,v25,v29
v_max_f32 v26,v26,v30
v_mov_b32 v27,v23
v_mov_b32 v28,v24
v_mov_b32 v29,v25
v_mov_b32 v30,v26
v_permlane32_swap_b32 v23,v27
v_permlane32_swap_b32 v24,v28
v_permlane32_swap_b32 v25,v29
v_permlane32_swap_b32 v26,v30
v_max_f32 v23,v23,v27
v_max_f32 v24,v24,v28
v_max_f32 v25,v25,v29
v_max_f32 v26,v26,v30
v_mul_f32 v14,s26,v23
v_mul_f32 v15,s26,v24
v_mul_f32 v16,s26,v25
v_mul_f32 v17,s26,v26
v_max3_f32 v23,v192,v193,v194
v_max3_f32 v24,v200,v201,v202
v_max3_f32 v25,v208,v209,v210
v_max3_f32 v26,v216,v217,v218
v_max3_f32 v23,v23,v195,v196
v_max3_f32 v24,v24,v203,v204
v_max3_f32 v25,v25,v211,v212
v_max3_f32 v26,v26,v219,v220
v_max3_f32 v23,v23,v197,v198
v_max3_f32 v24,v24,v205,v206
v_max3_f32 v25,v25,v213,v214
v_max3_f32 v26,v26,v221,v222
v_max_f32 v23,v23,v199
v_max_f32 v24,v24,v207
v_max_f32 v25,v25,v215
v_max_f32 v26,v26,v223
v_mov_b32 v27,v23
v_mov_b32 v28,v24
v_mov_b32 v29,v25
v_mov_b32 v30,v26
v_permlane16_swap_b32 v23,v27
v_permlane16_swap_b32 v24,v28
v_permlane16_swap_b32 v25,v29
v_permlane16_swap_b32 v26,v30
v_max_f32 v23,v23,v27
v_max_f32 v24,v24,v28
v_max_f32 v25,v25,v29
v_max_f32 v26,v26,v30
v_mov_b32 v27,v23
v_mov_b32 v28,v24
v_mov_b32 v29,v25
v_mov_b32 v30,v26
v_permlane32_swap_b32 v23,v27
v_permlane32_swap_b32 v24,v28
v_permlane32_swap_b32 v25,v29
v_permlane32_swap_b32 v26,v30
v_max_f32 v23,v23,v27
v_max_f32 v24,v24,v28
v_max_f32 v25,v25,v29
v_max_f32 v26,v26,v30
v_mul_f32 v27,s26,v23
v_mul_f32 v28,s26,v24
v_mul_f32 v29,s26,v25
v_mul_f32 v30,s26,v26
v_max_f32 v18,v14,v27
v_max_f32 v19,v15,v28
v_max_f32 v20,v16,v29
v_max_f32 v21,v17,v30
v_fma_f32 v160,v160,s26,-v18
v_fma_f32 v161,v161,s26,-v18
v_fma_f32 v162,v162,s26,-v18
v_fma_f32 v163,v163,s26,-v18
v_fma_f32 v164,v164,s26,-v18
v_fma_f32 v165,v165,s26,-v18
v_fma_f32 v166,v166,s26,-v18
v_fma_f32 v167,v167,s26,-v18
v_fma_f32 v168,v168,s26,-v19
v_fma_f32 v169,v169,s26,-v19
v_fma_f32 v170,v170,s26,-v19
v_fma_f32 v171,v171,s26,-v19
v_fma_f32 v172,v172,s26,-v19
v_fma_f32 v173,v173,s26,-v19
v_fma_f32 v174,v174,s26,-v19
v_fma_f32 v175,v175,s26,-v19
v_fma_f32 v176,v176,s26,-v20
v_fma_f32 v177,v177,s26,-v20
v_fma_f32 v178,v178,s26,-v20
v_fma_f32 v179,v179,s26,-v20
v_fma_f32 v180,v180,s26,-v20
v_fma_f32 v181,v181,s26,-v20
v_fma_f32 v182,v182,s26,-v20
v_fma_f32 v183,v183,s26,-v20
v_fma_f32 v184,v184,s26,-v21
v_fma_f32 v185,v185,s26,-v21
v_fma_f32 v186,v186,s26,-v21
v_fma_f32 v187,v187,s26,-v21
v_fma_f32 v188,v188,s26,-v21
v_fma_f32 v189,v189,s26,-v21
v_fma_f32 v190,v190,s26,-v21
v_fma_f32 v191,v191,s26,-v21
v_exp_f32 v160,v160
v_exp_f32 v161,v161
v_exp_f32 v162,v162
v_exp_f32 v163,v163
v_exp_f32 v164,v164
v_exp_f32 v165,v165
v_exp_f32 v166,v166
v_exp_f32 v167,v167
v_exp_f32 v168,v168
v_exp_f32 v169,v169
v_exp_f32 v170,v170
v_exp_f32 v171,v171
v_exp_f32 v172,v172
v_exp_f32 v173,v173
v_exp_f32 v174,v174
v_exp_f32 v175,v175
v_exp_f32 v176,v176
v_exp_f32 v177,v177
v_exp_f32 v178,v178
v_exp_f32 v179,v179
v_exp_f32 v180,v180
v_exp_f32 v181,v181
v_exp_f32 v182,v182
v_exp_f32 v183,v183
v_exp_f32 v184,v184
v_exp_f32 v185,v185
v_exp_f32 v186,v186
v_exp_f32 v187,v187
v_exp_f32 v188,v188
v_exp_f32 v189,v189
v_exp_f32 v190,v190
v_exp_f32 v191,v191
v_cvt_pk_bf16_f32 v160,v160,v161
v_cvt_pk_bf16_f32 v161,v162,v163
v_cvt_pk_bf16_f32 v162,v164,v165
v_cvt_pk_bf16_f32 v163,v166,v167
v_cvt_pk_bf16_f32 v168,v168,v169
v_cvt_pk_bf16_f32 v169,v170,v171
v_cvt_pk_bf16_f32 v170,v172,v173
v_cvt_pk_bf16_f32 v171,v174,v175
v_cvt_pk_bf16_f32 v176,v176,v177
v_cvt_pk_bf16_f32 v177,v178,v179
v_cvt_pk_bf16_f32 v178,v180,v181
v_cvt_pk_bf16_f32 v179,v182,v183
v_cvt_pk_bf16_f32 v184,v184,v185
v_cvt_pk_bf16_f32 v185,v186,v187
v_cvt_pk_bf16_f32 v186,v188,v189
v_cvt_pk_bf16_f32 v187,v190,v191
v_fma_f32 v192,v192,s26,-v18
v_fma_f32 v193,v193,s26,-v18
v_fma_f32 v194,v194,s26,-v18
v_fma_f32 v195,v195,s26,-v18
v_fma_f32 v196,v196,s26,-v18
v_fma_f32 v197,v197,s26,-v18
v_fma_f32 v198,v198,s26,-v18
v_fma_f32 v199,v199,s26,-v18
v_fma_f32 v200,v200,s26,-v19
v_fma_f32 v201,v201,s26,-v19
v_fma_f32 v202,v202,s26,-v19
v_fma_f32 v203,v203,s26,-v19
v_fma_f32 v204,v204,s26,-v19
v_fma_f32 v205,v205,s26,-v19
v_fma_f32 v206,v206,s26,-v19
v_fma_f32 v207,v207,s26,-v19
v_fma_f32 v208,v208,s26,-v20
v_fma_f32 v209,v209,s26,-v20
v_fma_f32 v210,v210,s26,-v20
v_fma_f32 v211,v211,s26,-v20
v_fma_f32 v212,v212,s26,-v20
v_fma_f32 v213,v213,s26,-v20
v_fma_f32 v214,v214,s26,-v20
v_fma_f32 v215,v215,s26,-v20
v_fma_f32 v216,v216,s26,-v21
v_fma_f32 v217,v217,s26,-v21
v_fma_f32 v218,v218,s26,-v21
v_fma_f32 v219,v219,s26,-v21
v_fma_f32 v220,v220,s26,-v21
v_fma_f32 v221,v221,s26,-v21
v_fma_f32 v222,v222,s26,-v21
v_fma_f32 v223,v223,s26,-v21
v_exp_f32 v192,v192
v_exp_f32 v193,v193
v_exp_f32 v194,v194
v_exp_f32 v195,v195
v_exp_f32 v196,v196
v_exp_f32 v197,v197
v_exp_f32 v198,v198
v_exp_f32 v199,v199
v_exp_f32 v200,v200
v_exp_f32 v201,v201
v_exp_f32 v202,v202
v_exp_f32 v203,v203
v_exp_f32 v204,v204
v_exp_f32 v205,v205
v_exp_f32 v206,v206
v_exp_f32 v207,v207
v_exp_f32 v208,v208
v_exp_f32 v209,v209
v_exp_f32 v210,v210
v_exp_f32 v211,v211
v_exp_f32 v212,v212
v_exp_f32 v213,v213
v_exp_f32 v214,v214
v_exp_f32 v215,v215
v_exp_f32 v216,v216
v_exp_f32 v217,v217
v_exp_f32 v218,v218
v_exp_f32 v219,v219
v_exp_f32 v220,v220
v_exp_f32 v221,v221
v_exp_f32 v222,v222
v_exp_f32 v223,v223
v_cvt_pk_bf16_f32 v164,v192,v193
v_cvt_pk_bf16_f32 v165,v194,v195
v_cvt_pk_bf16_f32 v166,v196,v197
v_cvt_pk_bf16_f32 v167,v198,v199
v_cvt_pk_bf16_f32 v172,v200,v201
v_cvt_pk_bf16_f32 v173,v202,v203
v_cvt_pk_bf16_f32 v174,v204,v205
v_cvt_pk_bf16_f32 v175,v206,v207
v_cvt_pk_bf16_f32 v180,v208,v209
v_cvt_pk_bf16_f32 v181,v210,v211
v_cvt_pk_bf16_f32 v182,v212,v213
v_cvt_pk_bf16_f32 v183,v214,v215
v_cvt_pk_bf16_f32 v188,v216,v217
v_cvt_pk_bf16_f32 v189,v218,v219
v_cvt_pk_bf16_f32 v190,v220,v221
v_cvt_pk_bf16_f32 v191,v222,v223
v_mfma_f32_16x16x32_bf16 v[224:227],a[96:99],a[0:3],0
ds_read_b128 a[128:131],v2 offset:18432
v_mfma_f32_16x16x32_bf16 v[224:227],a[100:103],a[4:7],v[224:227]
v_mfma_f32_16x16x32_bf16 v[224:227],a[104:107],a[8:11],v[224:227]
v_mfma_f32_16x16x32_bf16 v[224:227],a[108:111],a[12:15],v[224:227]
buffer_load_dwordx4 v1,s[8:11],s21 offen offset:3072 nt lds
v_mfma_f32_16x16x32_bf16 v[232:235],a[108:111],a[28:31],0
s_add_u32 s21,s21,16384
ds_read_b128 a[132:135],v3 offset:18432
v_mfma_f32_16x16x32_bf16 v[232:235],a[104:107],a[24:27],v[232:235]
v_mfma_f32_16x16x32_bf16 v[232:235],a[100:103],a[20:23],v[232:235]
v_mfma_f32_16x16x32_bf16 v[232:235],a[96:99],a[16:19],v[232:235]
v_mfma_f32_16x16x32_bf16 v[240:243],a[96:99],a[32:35],0
ds_read_b128 a[136:139],v4 offset:18432
v_mfma_f32_16x16x32_bf16 v[240:243],a[100:103],a[36:39],v[240:243]
v_mfma_f32_16x16x32_bf16 v[240:243],a[104:107],a[40:43],v[240:243]
v_mfma_f32_16x16x32_bf16 v[240:243],a[108:111],a[44:47],v[240:243]
ds_read_b128 a[140:143],v5 offset:18432
v_mfma_f32_16x16x32_bf16 v[248:251],a[108:111],a[60:63],0
v_mfma_f32_16x16x32_bf16 v[248:251],a[104:107],a[56:59],v[248:251]
v_mfma_f32_16x16x32_bf16 v[248:251],a[100:103],a[52:55],v[248:251]
s_waitcnt lgkmcnt(4)
v_mfma_f32_16x16x32_bf16 v[248:251],a[96:99],a[48:51],v[248:251]
ds_read_b128 a[144:147],v2 offset:19456
v_mfma_f32_16x16x32_bf16 v[228:231],a[112:115],a[0:3],0
v_mfma_f32_16x16x32_bf16 v[228:231],a[116:119],a[4:7],v[228:231]
v_mfma_f32_16x16x32_bf16 v[228:231],a[120:123],a[8:11],v[228:231]
v_mfma_f32_16x16x32_bf16 v[228:231],a[124:127],a[12:15],v[228:231]
ds_read_b128 a[148:151],v3 offset:19456
v_mfma_f32_16x16x32_bf16 v[236:239],a[124:127],a[28:31],0
v_mfma_f32_16x16x32_bf16 v[236:239],a[120:123],a[24:27],v[236:239]
v_mfma_f32_16x16x32_bf16 v[236:239],a[116:119],a[20:23],v[236:239]
s_add_u32 m0,s25,114688
ds_read_b128 a[152:155],v4 offset:19456
v_mfma_f32_16x16x32_bf16 v[236:239],a[112:115],a[16:19],v[236:239]
buffer_load_dwordx4 v1,s[12:15],s22 offen nt lds
v_mfma_f32_16x16x32_bf16 v[244:247],a[112:115],a[32:35],0
v_mfma_f32_16x16x32_bf16 v[244:247],a[116:119],a[36:39],v[244:247]
v_mfma_f32_16x16x32_bf16 v[244:247],a[120:123],a[40:43],v[244:247]
ds_read_b128 a[156:159],v5 offset:19456
v_mfma_f32_16x16x32_bf16 v[244:247],a[124:127],a[44:47],v[244:247]
v_mfma_f32_16x16x32_bf16 v[252:255],a[124:127],a[60:63],0
v_mfma_f32_16x16x32_bf16 v[252:255],a[120:123],a[56:59],v[252:255]
v_mfma_f32_16x16x32_bf16 v[252:255],a[116:119],a[52:55],v[252:255]
v_mfma_f32_16x16x32_bf16 v[252:255],a[112:115],a[48:51],v[252:255]
s_waitcnt lgkmcnt(4)
v_mfma_f32_16x16x32_bf16 v[192:195],a[128:131],a[0:3],0
v_mfma_f32_16x16x32_bf16 v[192:195],a[132:135],a[4:7],v[192:195]
v_mfma_f32_16x16x32_bf16 v[192:195],a[136:139],a[8:11],v[192:195]
v_mfma_f32_16x16x32_bf16 v[192:195],a[140:143],a[12:15],v[192:195]
buffer_load_dwordx4 v1,s[12:15],s22 offen offset:1024 nt lds
v_mfma_f32_16x16x32_bf16 v[200:203],a[140:143],a[28:31],0
v_mfma_f32_16x16x32_bf16 v[200:203],a[136:139],a[24:27],v[200:203]
ds_read_b64_tr_b16 a[96:97],v6 offset:0
v_mfma_f32_16x16x32_bf16 v[200:203],a[132:135],a[20:23],v[200:203]
ds_read_b64_tr_b16 a[98:99],v6 offset:1024
v_mfma_f32_16x16x32_bf16 v[200:203],a[128:131],a[16:19],v[200:203]
v_mfma_f32_16x16x32_bf16 v[208:211],a[128:131],a[32:35],0
ds_read_b64_tr_b16 a[100:101],v6 offset:2048
v_mfma_f32_16x16x32_bf16 v[208:211],a[132:135],a[36:39],v[208:211]
ds_read_b64_tr_b16 a[102:103],v6 offset:3072
v_mfma_f32_16x16x32_bf16 v[208:211],a[136:139],a[40:43],v[208:211]
v_mfma_f32_16x16x32_bf16 v[208:211],a[140:143],a[44:47],v[208:211]
buffer_load_dwordx4 v1,s[12:15],s22 offen offset:2048 nt lds
v_mfma_f32_16x16x32_bf16 v[216:219],a[140:143],a[60:63],0
ds_read_b64_tr_b16 a[104:105],v6 offset:8
v_mfma_f32_16x16x32_bf16 v[216:219],a[136:139],a[56:59],v[216:219]
ds_read_b64_tr_b16 a[106:107],v6 offset:1032
v_mfma_f32_16x16x32_bf16 v[216:219],a[132:135],a[52:55],v[216:219]
v_mfma_f32_16x16x32_bf16 v[216:219],a[128:131],a[48:51],v[216:219]
s_waitcnt lgkmcnt(6)
v_mfma_f32_16x16x32_bf16 v[196:199],a[144:147],a[0:3],0
ds_read_b64_tr_b16 a[108:109],v6 offset:2056
v_mfma_f32_16x16x32_bf16 v[196:199],a[148:151],a[4:7],v[196:199]
ds_read_b64_tr_b16 a[110:111],v6 offset:3080
v_mfma_f32_16x16x32_bf16 v[196:199],a[152:155],a[8:11],v[196:199]
v_mfma_f32_16x16x32_bf16 v[196:199],a[156:159],a[12:15],v[196:199]
ds_read_b64_tr_b16 a[112:113],v7 offset:0
v_mfma_f32_16x16x32_bf16 v[204:207],a[156:159],a[28:31],0
ds_read_b64_tr_b16 a[114:115],v7 offset:1024
v_mfma_f32_16x16x32_bf16 v[204:207],a[152:155],a[24:27],v[204:207]
v_mfma_f32_16x16x32_bf16 v[204:207],a[148:151],a[20:23],v[204:207]
v_mfma_f32_16x16x32_bf16 v[204:207],a[144:147],a[16:19],v[204:207]
ds_read_b64_tr_b16 a[116:117],v7 offset:2048
v_mfma_f32_16x16x32_bf16 v[212:215],a[144:147],a[32:35],0
ds_read_b64_tr_b16 a[118:119],v7 offset:3072
v_mfma_f32_16x16x32_bf16 v[212:215],a[148:151],a[36:39],v[212:215]
v_mfma_f32_16x16x32_bf16 v[212:215],a[152:155],a[40:43],v[212:215]
v_mfma_f32_16x16x32_bf16 v[212:215],a[156:159],a[44:47],v[212:215]
ds_read_b64_tr_b16 a[120:121],v7 offset:8
v_mfma_f32_16x16x32_bf16 v[220:223],a[156:159],a[60:63],0
ds_read_b64_tr_b16 a[122:123],v7 offset:1032
v_mfma_f32_16x16x32_bf16 v[220:223],a[152:155],a[56:59],v[220:223]
v_mfma_f32_16x16x32_bf16 v[220:223],a[148:151],a[52:55],v[220:223]
ds_read_b64_tr_b16 a[124:125],v7 offset:2056
v_mfma_f32_16x16x32_bf16 v[220:223],a[144:147],a[48:51],v[220:223]
s_waitcnt lgkmcnt(14)
ds_read_b64_tr_b16 a[126:127],v7 offset:3080
v_mfma_f32_16x16x32_bf16 a[224:227],a[240:243],v[160:163],0
v_mfma_f32_16x16x32_bf16 a[224:227],a[240:243],v[164:167],a[224:227]
buffer_load_dwordx4 v1,s[12:15],s22 offen offset:3072 nt lds
v_mfma_f32_16x16x32_bf16 a[228:231],a[240:243],v[168:171],0
s_add_u32 s22,s22,16384
s_waitcnt lgkmcnt(14)
ds_read_b64_tr_b16 a[128:129],v8 offset:0
v_mfma_f32_16x16x32_bf16 a[228:231],a[240:243],v[172:175],a[228:231]
s_waitcnt lgkmcnt(14)
ds_read_b64_tr_b16 a[130:131],v8 offset:1024
v_mfma_f32_16x16x32_bf16 a[232:235],a[240:243],v[176:179],0
v_mfma_f32_16x16x32_bf16 a[232:235],a[240:243],v[180:183],a[232:235]
s_waitcnt lgkmcnt(14)
v_mfma_f32_16x16x32_bf16 a[236:239],a[240:243],v[184:187],0
ds_read_b64_tr_b16 a[132:133],v8 offset:2048
v_mfma_f32_16x16x32_bf16 a[236:239],a[240:243],v[188:191],a[236:239]
s_waitcnt lgkmcnt(14)
ds_read_b64_tr_b16 a[134:135],v8 offset:3072
v_mfma_f32_16x16x32_bf16 v[80:83],a[96:99],v[184:187],0
v_mfma_f32_16x16x32_bf16 v[80:83],a[100:103],v[188:191],v[80:83]
s_waitcnt lgkmcnt(14)
ds_read_b64_tr_b16 a[136:137],v8 offset:8
v_mfma_f32_16x16x32_bf16 v[64:67],a[100:103],v[180:183],0
s_waitcnt lgkmcnt(14)
ds_read_b64_tr_b16 a[138:139],v8 offset:1032
v_mfma_f32_16x16x32_bf16 v[64:67],a[96:99],v[176:179],v[64:67]
v_mfma_f32_16x16x32_bf16 v[48:51],a[96:99],v[168:171],0
v_mfma_f32_16x16x32_bf16 v[48:51],a[100:103],v[172:175],v[48:51]
s_waitcnt lgkmcnt(14)
ds_read_b64_tr_b16 a[140:141],v8 offset:2056
v_mfma_f32_16x16x32_bf16 v[32:35],a[100:103],v[164:167],0
s_waitcnt lgkmcnt(14)
ds_read_b64_tr_b16 a[142:143],v8 offset:3080
v_mfma_f32_16x16x32_bf16 v[32:35],a[96:99],v[160:163],v[32:35]
v_mfma_f32_16x16x32_bf16 v[36:39],a[104:107],v[160:163],0
v_mfma_f32_16x16x32_bf16 v[36:39],a[108:111],v[164:167],v[36:39]
s_waitcnt lgkmcnt(14)
ds_read_b64_tr_b16 a[144:145],v9 offset:0
v_mfma_f32_16x16x32_bf16 v[52:55],a[108:111],v[172:175],0
s_waitcnt lgkmcnt(14)
ds_read_b64_tr_b16 a[146:147],v9 offset:1024
v_mfma_f32_16x16x32_bf16 v[52:55],a[104:107],v[168:171],v[52:55]
v_mfma_f32_16x16x32_bf16 v[68:71],a[104:107],v[176:179],0
s_waitcnt lgkmcnt(14)
ds_read_b64_tr_b16 a[148:149],v9 offset:2048
v_mfma_f32_16x16x32_bf16 v[68:71],a[108:111],v[180:183],v[68:71]
s_waitcnt lgkmcnt(14)
ds_read_b64_tr_b16 a[150:151],v9 offset:3072
v_mfma_f32_16x16x32_bf16 v[84:87],a[108:111],v[188:191],0
v_mfma_f32_16x16x32_bf16 v[84:87],a[104:107],v[184:187],v[84:87]
v_mfma_f32_16x16x32_bf16 v[88:91],a[112:115],v[184:187],0
s_waitcnt lgkmcnt(14)
ds_read_b64_tr_b16 a[152:153],v9 offset:8
v_mfma_f32_16x16x32_bf16 v[88:91],a[116:119],v[188:191],v[88:91]
s_waitcnt lgkmcnt(14)
ds_read_b64_tr_b16 a[154:155],v9 offset:1032
v_mfma_f32_16x16x32_bf16 v[72:75],a[116:119],v[180:183],0
v_mfma_f32_16x16x32_bf16 v[72:75],a[112:115],v[176:179],v[72:75]
s_waitcnt lgkmcnt(14)
ds_read_b64_tr_b16 a[156:157],v9 offset:2056
v_mfma_f32_16x16x32_bf16 v[56:59],a[112:115],v[168:171],0
s_waitcnt lgkmcnt(14)
ds_read_b64_tr_b16 a[158:159],v9 offset:3080
v_mfma_f32_16x16x32_bf16 v[56:59],a[116:119],v[172:175],v[56:59]
v_mfma_f32_16x16x32_bf16 v[40:43],a[116:119],v[164:167],0
v_mfma_f32_16x16x32_bf16 v[40:43],a[112:115],v[160:163],v[40:43]
v_mfma_f32_16x16x32_bf16 v[44:47],a[120:123],v[160:163],0
v_mfma_f32_16x16x32_bf16 v[44:47],a[124:127],v[164:167],v[44:47]
v_mfma_f32_16x16x32_bf16 v[60:63],a[124:127],v[172:175],0
v_mfma_f32_16x16x32_bf16 v[60:63],a[120:123],v[168:171],v[60:63]
v_mfma_f32_16x16x32_bf16 v[76:79],a[120:123],v[176:179],0
v_mfma_f32_16x16x32_bf16 v[76:79],a[124:127],v[180:183],v[76:79]
v_mfma_f32_16x16x32_bf16 v[92:95],a[124:127],v[188:191],0
v_mfma_f32_16x16x32_bf16 v[92:95],a[120:123],v[184:187],v[92:95]
s_waitcnt lgkmcnt(12)
v_mfma_f32_16x16x32_bf16 v[144:147],a[128:131],v[184:187],0
v_mfma_f32_16x16x32_bf16 v[144:147],a[132:135],v[188:191],v[144:147]
v_mfma_f32_16x16x32_bf16 v[128:131],a[132:135],v[180:183],0
v_mfma_f32_16x16x32_bf16 v[128:131],a[128:131],v[176:179],v[128:131]
s_waitcnt vmcnt(16)
s_waitcnt lgkmcnt(0)
s_barrier
ds_read_b128 a[96:99],v2 offset:32768
v_mfma_f32_16x16x32_bf16 v[112:115],a[128:131],v[168:171],0
s_add_u32 m0,s25,16384
v_mfma_f32_16x16x32_bf16 v[112:115],a[132:135],v[172:175],v[112:115]
buffer_load_dwordx4 v1,s[8:11],s21 offen nt lds
v_mfma_f32_16x16x32_bf16 v[96:99],a[132:135],v[164:167],0
v_mfma_f32_16x16x32_bf16 v[96:99],a[128:131],v[160:163],v[96:99]
ds_read_b128 a[100:103],v3 offset:32768
v_mfma_f32_16x16x32_bf16 v[100:103],a[136:139],v[160:163],0
v_mfma_f32_16x16x32_bf16 v[100:103],a[140:143],v[164:167],v[100:103]
v_mfma_f32_16x16x32_bf16 v[116:119],a[140:143],v[172:175],0
ds_read_b128 a[104:107],v4 offset:32768
v_mfma_f32_16x16x32_bf16 v[116:119],a[136:139],v[168:171],v[116:119]
v_mfma_f32_16x16x32_bf16 v[132:135],a[136:139],v[176:179],0
v_mfma_f32_16x16x32_bf16 v[132:135],a[140:143],v[180:183],v[132:135]
buffer_load_dwordx4 v1,s[8:11],s21 offen offset:1024 nt lds
v_mfma_f32_16x16x32_bf16 v[148:151],a[140:143],v[188:191],0
ds_read_b128 a[108:111],v5 offset:32768
v_mfma_f32_16x16x32_bf16 v[148:151],a[136:139],v[184:187],v[148:151]
v_mfma_f32_16x16x32_bf16 v[152:155],a[144:147],v[184:187],0
v_mfma_f32_16x16x32_bf16 v[152:155],a[148:151],v[188:191],v[152:155]
v_mfma_f32_16x16x32_bf16 v[136:139],a[148:151],v[180:183],0
ds_read_b128 a[112:115],v2 offset:33792
v_mfma_f32_16x16x32_bf16 v[136:139],a[144:147],v[176:179],v[136:139]
v_mfma_f32_16x16x32_bf16 v[120:123],a[144:147],v[168:171],0
v_mfma_f32_16x16x32_bf16 v[120:123],a[148:151],v[172:175],v[120:123]
ds_read_b128 a[116:119],v3 offset:33792
v_mfma_f32_16x16x32_bf16 v[104:107],a[148:151],v[164:167],0
v_mfma_f32_16x16x32_bf16 v[104:107],a[144:147],v[160:163],v[104:107]
v_mfma_f32_16x16x32_bf16 v[108:111],a[152:155],v[160:163],0
v_mfma_f32_16x16x32_bf16 v[108:111],a[156:159],v[164:167],v[108:111]
ds_read_b128 a[120:123],v4 offset:33792
v_mfma_f32_16x16x32_bf16 v[124:127],a[156:159],v[172:175],0
v_mfma_f32_16x16x32_bf16 v[124:127],a[152:155],v[168:171],v[124:127]
buffer_load_dwordx4 v1,s[8:11],s21 offen offset:2048 nt lds
v_mfma_f32_16x16x32_bf16 v[140:143],a[152:155],v[176:179],0
v_mfma_f32_16x16x32_bf16 v[140:143],a[156:159],v[180:183],v[140:143]
ds_read_b128 a[124:127],v5 offset:33792
v_mfma_f32_16x16x32_bf16 v[156:159],a[156:159],v[188:191],0
v_mfma_f32_16x16x32_bf16 v[156:159],a[152:155],v[184:187],v[156:159]
s_waitcnt lgkmcnt(4)
v_max3_f32 v23,v224,v225,v226
v_max3_f32 v24,v232,v233,v234
v_max3_f32 v25,v240,v241,v242
v_max3_f32 v26,v248,v249,v250
v_max3_f32 v23,v23,v227,v228
v_max3_f32 v24,v24,v235,v236
v_max3_f32 v25,v25,v243,v244
v_max3_f32 v26,v26,v251,v252
v_max3_f32 v23,v23,v229,v230
v_max3_f32 v24,v24,v237,v238
v_max3_f32 v25,v25,v245,v246
v_max3_f32 v26,v26,v253,v254
v_max_f32 v23,v23,v231
v_max_f32 v24,v24,v239
v_max_f32 v25,v25,v247
v_max_f32 v26,v26,v255
v_mov_b32 v27,v23
v_mov_b32 v28,v24
v_mov_b32 v29,v25
v_mov_b32 v30,v26
v_permlane16_swap_b32 v23,v27
v_permlane16_swap_b32 v24,v28
v_permlane16_swap_b32 v25,v29
v_permlane16_swap_b32 v26,v30
v_max_f32 v23,v23,v27
v_max_f32 v24,v24,v28
v_max_f32 v25,v25,v29
v_max_f32 v26,v26,v30
v_mov_b32 v27,v23
v_mov_b32 v28,v24
v_mov_b32 v29,v25
v_mov_b32 v30,v26
v_permlane32_swap_b32 v23,v27
v_permlane32_swap_b32 v24,v28
v_permlane32_swap_b32 v25,v29
v_permlane32_swap_b32 v26,v30
v_max_f32 v23,v23,v27
v_max_f32 v24,v24,v28
v_max_f32 v25,v25,v29
v_max_f32 v26,v26,v30
v_mul_f32 v14,s26,v23
v_mul_f32 v15,s26,v24
v_mul_f32 v16,s26,v25
v_mul_f32 v17,s26,v26
v_max3_f32 v23,v192,v193,v194
v_max3_f32 v24,v200,v201,v202
v_max3_f32 v25,v208,v209,v210
v_max3_f32 v26,v216,v217,v218
v_max3_f32 v23,v23,v195,v196
v_max3_f32 v24,v24,v203,v204
v_max3_f32 v25,v25,v211,v212
v_max3_f32 v26,v26,v219,v220
v_max3_f32 v23,v23,v197,v198
v_max3_f32 v24,v24,v205,v206
v_max3_f32 v25,v25,v213,v214
v_max3_f32 v26,v26,v221,v222
v_max_f32 v23,v23,v199
v_max_f32 v24,v24,v207
v_max_f32 v25,v25,v215
v_max_f32 v26,v26,v223
v_mov_b32 v27,v23
v_mov_b32 v28,v24
v_mov_b32 v29,v25
v_mov_b32 v30,v26
v_permlane16_swap_b32 v23,v27
v_permlane16_swap_b32 v24,v28
v_permlane16_swap_b32 v25,v29
v_permlane16_swap_b32 v26,v30
v_max_f32 v23,v23,v27
v_max_f32 v24,v24,v28
v_max_f32 v25,v25,v29
v_max_f32 v26,v26,v30
v_mov_b32 v27,v23
v_mov_b32 v28,v24
v_mov_b32 v29,v25
v_mov_b32 v30,v26
v_permlane32_swap_b32 v23,v27
v_permlane32_swap_b32 v24,v28
v_permlane32_swap_b32 v25,v29
v_permlane32_swap_b32 v26,v30
v_max_f32 v23,v23,v27
v_max_f32 v24,v24,v28
v_max_f32 v25,v25,v29
v_max_f32 v26,v26,v30
v_mul_f32 v27,s26,v23
v_mul_f32 v28,s26,v24
v_mul_f32 v29,s26,v25
v_mul_f32 v30,s26,v26
v_max3_f32 v14,v14,v27,v18
v_max3_f32 v15,v15,v28,v19
v_max3_f32 v16,v16,v29,v20
v_max3_f32 v17,v17,v30,v21
v_sub_f32 v23,v18,v14
v_sub_f32 v24,v19,v15
v_sub_f32 v25,v20,v16
v_sub_f32 v26,v21,v17
v_exp_f32 v23,v23
v_exp_f32 v24,v24
v_exp_f32 v25,v25
v_exp_f32 v26,v26
v_mov_b32 v18,v14
v_mov_b32 v19,v15
v_mov_b32 v20,v16
v_mov_b32 v21,v17
v_accvgpr_read_b32 v27,a224
v_accvgpr_read_b32 v28,a228
v_accvgpr_read_b32 v29,a232
v_accvgpr_read_b32 v30,a236
v_mul_f32 v27,v27,v23
v_mul_f32 v28,v28,v24
v_mul_f32 v29,v29,v25
v_mul_f32 v30,v30,v26
v_accvgpr_write_b32 a224,v27
v_accvgpr_write_b32 a228,v28
v_accvgpr_write_b32 a232,v29
v_accvgpr_write_b32 a236,v30
v_mul_f32 v32,v32,v23
v_mul_f32 v33,v33,v23
v_mul_f32 v34,v34,v23
v_mul_f32 v35,v35,v23
v_mul_f32 v36,v36,v23
v_mul_f32 v37,v37,v23
v_mul_f32 v38,v38,v23
v_mul_f32 v39,v39,v23
v_mul_f32 v40,v40,v23
v_mul_f32 v41,v41,v23
v_mul_f32 v42,v42,v23
v_mul_f32 v43,v43,v23
v_mul_f32 v44,v44,v23
v_mul_f32 v45,v45,v23
v_mul_f32 v46,v46,v23
v_mul_f32 v47,v47,v23
v_mul_f32 v96,v96,v23
v_mul_f32 v97,v97,v23
v_mul_f32 v98,v98,v23
v_mul_f32 v99,v99,v23
v_mul_f32 v100,v100,v23
v_mul_f32 v101,v101,v23
v_mul_f32 v102,v102,v23
v_mul_f32 v103,v103,v23
v_mul_f32 v104,v104,v23
v_mul_f32 v105,v105,v23
v_mul_f32 v106,v106,v23
v_mul_f32 v107,v107,v23
v_mul_f32 v108,v108,v23
v_mul_f32 v109,v109,v23
v_mul_f32 v110,v110,v23
v_mul_f32 v111,v111,v23
v_mul_f32 v48,v48,v24
v_mul_f32 v49,v49,v24
v_mul_f32 v50,v50,v24
v_mul_f32 v51,v51,v24
v_mul_f32 v52,v52,v24
v_mul_f32 v53,v53,v24
v_mul_f32 v54,v54,v24
v_mul_f32 v55,v55,v24
v_mul_f32 v56,v56,v24
v_mul_f32 v57,v57,v24
v_mul_f32 v58,v58,v24
v_mul_f32 v59,v59,v24
v_mul_f32 v60,v60,v24
v_mul_f32 v61,v61,v24
v_mul_f32 v62,v62,v24
v_mul_f32 v63,v63,v24
v_mul_f32 v112,v112,v24
v_mul_f32 v113,v113,v24
v_mul_f32 v114,v114,v24
v_mul_f32 v115,v115,v24
v_mul_f32 v116,v116,v24
v_mul_f32 v117,v117,v24
v_mul_f32 v118,v118,v24
v_mul_f32 v119,v119,v24
v_mul_f32 v120,v120,v24
v_mul_f32 v121,v121,v24
v_mul_f32 v122,v122,v24
v_mul_f32 v123,v123,v24
v_mul_f32 v124,v124,v24
v_mul_f32 v125,v125,v24
v_mul_f32 v126,v126,v24
v_mul_f32 v127,v127,v24
v_mul_f32 v64,v64,v25
v_mul_f32 v65,v65,v25
v_mul_f32 v66,v66,v25
v_mul_f32 v67,v67,v25
v_mul_f32 v68,v68,v25
v_mul_f32 v69,v69,v25
v_mul_f32 v70,v70,v25
v_mul_f32 v71,v71,v25
v_mul_f32 v72,v72,v25
v_mul_f32 v73,v73,v25
v_mul_f32 v74,v74,v25
v_mul_f32 v75,v75,v25
v_mul_f32 v76,v76,v25
v_mul_f32 v77,v77,v25
v_mul_f32 v78,v78,v25
v_mul_f32 v79,v79,v25
v_mul_f32 v128,v128,v25
v_mul_f32 v129,v129,v25
v_mul_f32 v130,v130,v25
v_mul_f32 v131,v131,v25
v_mul_f32 v132,v132,v25
v_mul_f32 v133,v133,v25
v_mul_f32 v134,v134,v25
v_mul_f32 v135,v135,v25
v_mul_f32 v136,v136,v25
v_mul_f32 v137,v137,v25
v_mul_f32 v138,v138,v25
v_mul_f32 v139,v139,v25
v_mul_f32 v140,v140,v25
v_mul_f32 v141,v141,v25
v_mul_f32 v142,v142,v25
v_mul_f32 v143,v143,v25
v_mul_f32 v80,v80,v26
v_mul_f32 v81,v81,v26
v_mul_f32 v82,v82,v26
v_mul_f32 v83,v83,v26
v_mul_f32 v84,v84,v26
v_mul_f32 v85,v85,v26
v_mul_f32 v86,v86,v26
v_mul_f32 v87,v87,v26
v_mul_f32 v88,v88,v26
v_mul_f32 v89,v89,v26
v_mul_f32 v90,v90,v26
v_mul_f32 v91,v91,v26
v_mul_f32 v92,v92,v26
v_mul_f32 v93,v93,v26
v_mul_f32 v94,v94,v26
v_mul_f32 v95,v95,v26
v_mul_f32 v144,v144,v26
v_mul_f32 v145,v145,v26
v_mul_f32 v146,v146,v26
v_mul_f32 v147,v147,v26
v_mul_f32 v148,v148,v26
v_mul_f32 v149,v149,v26
v_mul_f32 v150,v150,v26
v_mul_f32 v151,v151,v26
v_mul_f32 v152,v152,v26
v_mul_f32 v153,v153,v26
v_mul_f32 v154,v154,v26
v_mul_f32 v155,v155,v26
v_mul_f32 v156,v156,v26
v_mul_f32 v157,v157,v26
v_mul_f32 v158,v158,v26
v_mul_f32 v159,v159,v26
v_fma_f32 v224,v224,s26,-v18
v_fma_f32 v225,v225,s26,-v18
v_fma_f32 v226,v226,s26,-v18
v_fma_f32 v227,v227,s26,-v18
v_fma_f32 v228,v228,s26,-v18
v_fma_f32 v229,v229,s26,-v18
v_fma_f32 v230,v230,s26,-v18
v_fma_f32 v231,v231,s26,-v18
v_fma_f32 v232,v232,s26,-v19
v_fma_f32 v233,v233,s26,-v19
v_fma_f32 v234,v234,s26,-v19
v_fma_f32 v235,v235,s26,-v19
v_fma_f32 v236,v236,s26,-v19
v_fma_f32 v237,v237,s26,-v19
v_fma_f32 v238,v238,s26,-v19
v_fma_f32 v239,v239,s26,-v19
v_fma_f32 v240,v240,s26,-v20
v_fma_f32 v241,v241,s26,-v20
v_fma_f32 v242,v242,s26,-v20
v_fma_f32 v243,v243,s26,-v20
v_fma_f32 v244,v244,s26,-v20
v_fma_f32 v245,v245,s26,-v20
v_fma_f32 v246,v246,s26,-v20
v_fma_f32 v247,v247,s26,-v20
v_fma_f32 v248,v248,s26,-v21
v_fma_f32 v249,v249,s26,-v21
v_fma_f32 v250,v250,s26,-v21
v_fma_f32 v251,v251,s26,-v21
v_fma_f32 v252,v252,s26,-v21
v_fma_f32 v253,v253,s26,-v21
v_fma_f32 v254,v254,s26,-v21
v_fma_f32 v255,v255,s26,-v21
v_exp_f32 v224,v224
v_exp_f32 v225,v225
v_exp_f32 v226,v226
v_exp_f32 v227,v227
v_exp_f32 v228,v228
v_exp_f32 v229,v229
v_exp_f32 v230,v230
v_exp_f32 v231,v231
v_exp_f32 v232,v232
v_exp_f32 v233,v233
v_exp_f32 v234,v234
v_exp_f32 v235,v235
v_exp_f32 v236,v236
v_exp_f32 v237,v237
v_exp_f32 v238,v238
v_exp_f32 v239,v239
v_exp_f32 v240,v240
v_exp_f32 v241,v241
v_exp_f32 v242,v242
v_exp_f32 v243,v243
v_exp_f32 v244,v244
v_exp_f32 v245,v245
v_exp_f32 v246,v246
v_exp_f32 v247,v247
v_exp_f32 v248,v248
v_exp_f32 v249,v249
v_exp_f32 v250,v250
v_exp_f32 v251,v251
v_exp_f32 v252,v252
v_exp_f32 v253,v253
v_exp_f32 v254,v254
v_exp_f32 v255,v255
v_cvt_pk_bf16_f32 v224,v224,v225
v_cvt_pk_bf16_f32 v225,v226,v227
v_cvt_pk_bf16_f32 v226,v228,v229
v_cvt_pk_bf16_f32 v227,v230,v231
v_cvt_pk_bf16_f32 v232,v232,v233
v_cvt_pk_bf16_f32 v233,v234,v235
v_cvt_pk_bf16_f32 v234,v236,v237
v_cvt_pk_bf16_f32 v235,v238,v239
v_cvt_pk_bf16_f32 v240,v240,v241
v_cvt_pk_bf16_f32 v241,v242,v243
v_cvt_pk_bf16_f32 v242,v244,v245
v_cvt_pk_bf16_f32 v243,v246,v247
v_cvt_pk_bf16_f32 v248,v248,v249
v_cvt_pk_bf16_f32 v249,v250,v251
v_cvt_pk_bf16_f32 v250,v252,v253
v_cvt_pk_bf16_f32 v251,v254,v255
v_fma_f32 v192,v192,s26,-v18
v_fma_f32 v193,v193,s26,-v18
v_fma_f32 v194,v194,s26,-v18
v_fma_f32 v195,v195,s26,-v18
v_fma_f32 v196,v196,s26,-v18
v_fma_f32 v197,v197,s26,-v18
v_fma_f32 v198,v198,s26,-v18
v_fma_f32 v199,v199,s26,-v18
v_fma_f32 v200,v200,s26,-v19
v_fma_f32 v201,v201,s26,-v19
v_fma_f32 v202,v202,s26,-v19
v_fma_f32 v203,v203,s26,-v19
v_fma_f32 v204,v204,s26,-v19
v_fma_f32 v205,v205,s26,-v19
v_fma_f32 v206,v206,s26,-v19
v_fma_f32 v207,v207,s26,-v19
v_fma_f32 v208,v208,s26,-v20
v_fma_f32 v209,v209,s26,-v20
v_fma_f32 v210,v210,s26,-v20
v_fma_f32 v211,v211,s26,-v20
v_fma_f32 v212,v212,s26,-v20
v_fma_f32 v213,v213,s26,-v20
v_fma_f32 v214,v214,s26,-v20
v_fma_f32 v215,v215,s26,-v20
v_fma_f32 v216,v216,s26,-v21
v_fma_f32 v217,v217,s26,-v21
v_fma_f32 v218,v218,s26,-v21
v_fma_f32 v219,v219,s26,-v21
v_fma_f32 v220,v220,s26,-v21
v_fma_f32 v221,v221,s26,-v21
v_fma_f32 v222,v222,s26,-v21
v_fma_f32 v223,v223,s26,-v21
v_exp_f32 v192,v192
v_exp_f32 v193,v193
v_exp_f32 v194,v194
v_exp_f32 v195,v195
v_exp_f32 v196,v196
v_exp_f32 v197,v197
v_exp_f32 v198,v198
v_exp_f32 v199,v199
v_exp_f32 v200,v200
v_exp_f32 v201,v201
v_exp_f32 v202,v202
v_exp_f32 v203,v203
v_exp_f32 v204,v204
v_exp_f32 v205,v205
v_exp_f32 v206,v206
v_exp_f32 v207,v207
v_exp_f32 v208,v208
v_exp_f32 v209,v209
v_exp_f32 v210,v210
v_exp_f32 v211,v211
v_exp_f32 v212,v212
v_exp_f32 v213,v213
v_exp_f32 v214,v214
v_exp_f32 v215,v215
v_exp_f32 v216,v216
v_exp_f32 v217,v217
v_exp_f32 v218,v218
v_exp_f32 v219,v219
v_exp_f32 v220,v220
v_exp_f32 v221,v221
v_exp_f32 v222,v222
v_exp_f32 v223,v223
v_cvt_pk_bf16_f32 v228,v192,v193
v_cvt_pk_bf16_f32 v229,v194,v195
v_cvt_pk_bf16_f32 v230,v196,v197
v_cvt_pk_bf16_f32 v231,v198,v199
v_cvt_pk_bf16_f32 v236,v200,v201
v_cvt_pk_bf16_f32 v237,v202,v203
v_cvt_pk_bf16_f32 v238,v204,v205
v_cvt_pk_bf16_f32 v239,v206,v207
v_cvt_pk_bf16_f32 v244,v208,v209
v_cvt_pk_bf16_f32 v245,v210,v211
v_cvt_pk_bf16_f32 v246,v212,v213
v_cvt_pk_bf16_f32 v247,v214,v215
v_cvt_pk_bf16_f32 v252,v216,v217
v_cvt_pk_bf16_f32 v253,v218,v219
v_cvt_pk_bf16_f32 v254,v220,v221
v_cvt_pk_bf16_f32 v255,v222,v223
v_mfma_f32_16x16x32_bf16 v[160:163],a[96:99],a[0:3],0
ds_read_b128 a[128:131],v2 offset:34816
v_mfma_f32_16x16x32_bf16 v[160:163],a[100:103],a[4:7],v[160:163]
v_mfma_f32_16x16x32_bf16 v[160:163],a[104:107],a[8:11],v[160:163]
v_mfma_f32_16x16x32_bf16 v[160:163],a[108:111],a[12:15],v[160:163]
buffer_load_dwordx4 v1,s[8:11],s21 offen offset:3072 nt lds
v_mfma_f32_16x16x32_bf16 v[168:171],a[108:111],a[28:31],0
s_add_u32 s21,s21,16384
ds_read_b128 a[132:135],v3 offset:34816
v_mfma_f32_16x16x32_bf16 v[168:171],a[104:107],a[24:27],v[168:171]
v_mfma_f32_16x16x32_bf16 v[168:171],a[100:103],a[20:23],v[168:171]
v_mfma_f32_16x16x32_bf16 v[168:171],a[96:99],a[16:19],v[168:171]
v_mfma_f32_16x16x32_bf16 v[176:179],a[96:99],a[32:35],0
ds_read_b128 a[136:139],v4 offset:34816
v_mfma_f32_16x16x32_bf16 v[176:179],a[100:103],a[36:39],v[176:179]
v_mfma_f32_16x16x32_bf16 v[176:179],a[104:107],a[40:43],v[176:179]
v_mfma_f32_16x16x32_bf16 v[176:179],a[108:111],a[44:47],v[176:179]
ds_read_b128 a[140:143],v5 offset:34816
v_mfma_f32_16x16x32_bf16 v[184:187],a[108:111],a[60:63],0
v_mfma_f32_16x16x32_bf16 v[184:187],a[104:107],a[56:59],v[184:187]
v_mfma_f32_16x16x32_bf16 v[184:187],a[100:103],a[52:55],v[184:187]
s_waitcnt lgkmcnt(4)
v_mfma_f32_16x16x32_bf16 v[184:187],a[96:99],a[48:51],v[184:187]
ds_read_b128 a[144:147],v2 offset:35840
v_mfma_f32_16x16x32_bf16 v[164:167],a[112:115],a[0:3],0
v_mfma_f32_16x16x32_bf16 v[164:167],a[116:119],a[4:7],v[164:167]
v_mfma_f32_16x16x32_bf16 v[164:167],a[120:123],a[8:11],v[164:167]
v_mfma_f32_16x16x32_bf16 v[164:167],a[124:127],a[12:15],v[164:167]
ds_read_b128 a[148:151],v3 offset:35840
v_mfma_f32_16x16x32_bf16 v[172:175],a[124:127],a[28:31],0
v_mfma_f32_16x16x32_bf16 v[172:175],a[120:123],a[24:27],v[172:175]
v_mfma_f32_16x16x32_bf16 v[172:175],a[116:119],a[20:23],v[172:175]
s_add_u32 m0,s25,65536
ds_read_b128 a[152:155],v4 offset:35840
v_mfma_f32_16x16x32_bf16 v[172:175],a[112:115],a[16:19],v[172:175]
buffer_load_dwordx4 v1,s[12:15],s22 offen nt lds
v_mfma_f32_16x16x32_bf16 v[180:183],a[112:115],a[32:35],0
v_mfma_f32_16x16x32_bf16 v[180:183],a[116:119],a[36:39],v[180:183]
v_mfma_f32_16x16x32_bf16 v[180:183],a[120:123],a[40:43],v[180:183]
ds_read_b128 a[156:159],v5 offset:35840
v_mfma_f32_16x16x32_bf16 v[180:183],a[124:127],a[44:47],v[180:183]
v_mfma_f32_16x16x32_bf16 v[188:191],a[124:127],a[60:63],0
v_mfma_f32_16x16x32_bf16 v[188:191],a[120:123],a[56:59],v[188:191]
v_mfma_f32_16x16x32_bf16 v[188:191],a[116:119],a[52:55],v[188:191]
v_mfma_f32_16x16x32_bf16 v[188:191],a[112:115],a[48:51],v[188:191]
s_waitcnt lgkmcnt(4)
v_mfma_f32_16x16x32_bf16 v[192:195],a[128:131],a[0:3],0
v_mfma_f32_16x16x32_bf16 v[192:195],a[132:135],a[4:7],v[192:195]
v_mfma_f32_16x16x32_bf16 v[192:195],a[136:139],a[8:11],v[192:195]
v_mfma_f32_16x16x32_bf16 v[192:195],a[140:143],a[12:15],v[192:195]
buffer_load_dwordx4 v1,s[12:15],s22 offen offset:1024 nt lds
v_mfma_f32_16x16x32_bf16 v[200:203],a[140:143],a[28:31],0
v_mfma_f32_16x16x32_bf16 v[200:203],a[136:139],a[24:27],v[200:203]
ds_read_b64_tr_b16 a[96:97],v6 offset:16384
v_mfma_f32_16x16x32_bf16 v[200:203],a[132:135],a[20:23],v[200:203]
ds_read_b64_tr_b16 a[98:99],v6 offset:17408
v_mfma_f32_16x16x32_bf16 v[200:203],a[128:131],a[16:19],v[200:203]
v_mfma_f32_16x16x32_bf16 v[208:211],a[128:131],a[32:35],0
ds_read_b64_tr_b16 a[100:101],v6 offset:18432
v_mfma_f32_16x16x32_bf16 v[208:211],a[132:135],a[36:39],v[208:211]
ds_read_b64_tr_b16 a[102:103],v6 offset:19456
v_mfma_f32_16x16x32_bf16 v[208:211],a[136:139],a[40:43],v[208:211]
v_mfma_f32_16x16x32_bf16 v[208:211],a[140:143],a[44:47],v[208:211]
buffer_load_dwordx4 v1,s[12:15],s22 offen offset:2048 nt lds
v_mfma_f32_16x16x32_bf16 v[216:219],a[140:143],a[60:63],0
ds_read_b64_tr_b16 a[104:105],v6 offset:16392
v_mfma_f32_16x16x32_bf16 v[216:219],a[136:139],a[56:59],v[216:219]
ds_read_b64_tr_b16 a[106:107],v6 offset:17416
v_mfma_f32_16x16x32_bf16 v[216:219],a[132:135],a[52:55],v[216:219]
v_mfma_f32_16x16x32_bf16 v[216:219],a[128:131],a[48:51],v[216:219]
s_waitcnt lgkmcnt(6)
v_mfma_f32_16x16x32_bf16 v[196:199],a[144:147],a[0:3],0
ds_read_b64_tr_b16 a[108:109],v6 offset:18440
v_mfma_f32_16x16x32_bf16 v[196:199],a[148:151],a[4:7],v[196:199]
ds_read_b64_tr_b16 a[110:111],v6 offset:19464
v_mfma_f32_16x16x32_bf16 v[196:199],a[152:155],a[8:11],v[196:199]
v_mfma_f32_16x16x32_bf16 v[196:199],a[156:159],a[12:15],v[196:199]
ds_read_b64_tr_b16 a[112:113],v7 offset:16384
v_mfma_f32_16x16x32_bf16 v[204:207],a[156:159],a[28:31],0
ds_read_b64_tr_b16 a[114:115],v7 offset:17408
v_mfma_f32_16x16x32_bf16 v[204:207],a[152:155],a[24:27],v[204:207]
v_mfma_f32_16x16x32_bf16 v[204:207],a[148:151],a[20:23],v[204:207]
v_mfma_f32_16x16x32_bf16 v[204:207],a[144:147],a[16:19],v[204:207]
ds_read_b64_tr_b16 a[116:117],v7 offset:18432
v_mfma_f32_16x16x32_bf16 v[212:215],a[144:147],a[32:35],0
ds_read_b64_tr_b16 a[118:119],v7 offset:19456
v_mfma_f32_16x16x32_bf16 v[212:215],a[148:151],a[36:39],v[212:215]
v_mfma_f32_16x16x32_bf16 v[212:215],a[152:155],a[40:43],v[212:215]
v_mfma_f32_16x16x32_bf16 v[212:215],a[156:159],a[44:47],v[212:215]
ds_read_b64_tr_b16 a[120:121],v7 offset:16392
v_mfma_f32_16x16x32_bf16 v[220:223],a[156:159],a[60:63],0
ds_read_b64_tr_b16 a[122:123],v7 offset:17416
v_mfma_f32_16x16x32_bf16 v[220:223],a[152:155],a[56:59],v[220:223]
v_mfma_f32_16x16x32_bf16 v[220:223],a[148:151],a[52:55],v[220:223]
ds_read_b64_tr_b16 a[124:125],v7 offset:18440
v_mfma_f32_16x16x32_bf16 v[220:223],a[144:147],a[48:51],v[220:223]
s_waitcnt lgkmcnt(14)
ds_read_b64_tr_b16 a[126:127],v7 offset:19464
v_mfma_f32_16x16x32_bf16 a[224:227],a[240:243],v[224:227],a[224:227]
v_mfma_f32_16x16x32_bf16 a[224:227],a[240:243],v[228:231],a[224:227]
buffer_load_dwordx4 v1,s[12:15],s22 offen offset:3072 nt lds
v_mfma_f32_16x16x32_bf16 a[228:231],a[240:243],v[232:235],a[228:231]
s_add_u32 s22,s22,16384
s_waitcnt lgkmcnt(14)
ds_read_b64_tr_b16 a[128:129],v8 offset:16384
v_mfma_f32_16x16x32_bf16 a[228:231],a[240:243],v[236:239],a[228:231]
s_waitcnt lgkmcnt(14)
ds_read_b64_tr_b16 a[130:131],v8 offset:17408
v_mfma_f32_16x16x32_bf16 a[232:235],a[240:243],v[240:243],a[232:235]
v_mfma_f32_16x16x32_bf16 a[232:235],a[240:243],v[244:247],a[232:235]
s_waitcnt lgkmcnt(14)
v_mfma_f32_16x16x32_bf16 a[236:239],a[240:243],v[248:251],a[236:239]
ds_read_b64_tr_b16 a[132:133],v8 offset:18432
v_mfma_f32_16x16x32_bf16 a[236:239],a[240:243],v[252:255],a[236:239]
s_waitcnt lgkmcnt(14)
ds_read_b64_tr_b16 a[134:135],v8 offset:19456
v_mfma_f32_16x16x32_bf16 v[80:83],a[96:99],v[248:251],v[80:83]
v_mfma_f32_16x16x32_bf16 v[80:83],a[100:103],v[252:255],v[80:83]
s_waitcnt lgkmcnt(14)
ds_read_b64_tr_b16 a[136:137],v8 offset:16392
v_mfma_f32_16x16x32_bf16 v[64:67],a[100:103],v[244:247],v[64:67]
s_waitcnt lgkmcnt(14)
ds_read_b64_tr_b16 a[138:139],v8 offset:17416
v_mfma_f32_16x16x32_bf16 v[64:67],a[96:99],v[240:243],v[64:67]
v_mfma_f32_16x16x32_bf16 v[48:51],a[96:99],v[232:235],v[48:51]
v_mfma_f32_16x16x32_bf16 v[48:51],a[100:103],v[236:239],v[48:51]
s_waitcnt lgkmcnt(14)
ds_read_b64_tr_b16 a[140:141],v8 offset:18440
v_mfma_f32_16x16x32_bf16 v[32:35],a[100:103],v[228:231],v[32:35]
s_waitcnt lgkmcnt(14)
ds_read_b64_tr_b16 a[142:143],v8 offset:19464
v_mfma_f32_16x16x32_bf16 v[32:35],a[96:99],v[224:227],v[32:35]
v_mfma_f32_16x16x32_bf16 v[36:39],a[104:107],v[224:227],v[36:39]
v_mfma_f32_16x16x32_bf16 v[36:39],a[108:111],v[228:231],v[36:39]
s_waitcnt lgkmcnt(14)
ds_read_b64_tr_b16 a[144:145],v9 offset:16384
v_mfma_f32_16x16x32_bf16 v[52:55],a[108:111],v[236:239],v[52:55]
s_waitcnt lgkmcnt(14)
ds_read_b64_tr_b16 a[146:147],v9 offset:17408
v_mfma_f32_16x16x32_bf16 v[52:55],a[104:107],v[232:235],v[52:55]
v_mfma_f32_16x16x32_bf16 v[68:71],a[104:107],v[240:243],v[68:71]
s_waitcnt lgkmcnt(14)
ds_read_b64_tr_b16 a[148:149],v9 offset:18432
v_mfma_f32_16x16x32_bf16 v[68:71],a[108:111],v[244:247],v[68:71]
s_waitcnt lgkmcnt(14)
ds_read_b64_tr_b16 a[150:151],v9 offset:19456
v_mfma_f32_16x16x32_bf16 v[84:87],a[108:111],v[252:255],v[84:87]
v_mfma_f32_16x16x32_bf16 v[84:87],a[104:107],v[248:251],v[84:87]
v_mfma_f32_16x16x32_bf16 v[88:91],a[112:115],v[248:251],v[88:91]
s_waitcnt lgkmcnt(14)
ds_read_b64_tr_b16 a[152:153],v9 offset:16392
v_mfma_f32_16x16x32_bf16 v[88:91],a[116:119],v[252:255],v[88:91]
s_waitcnt lgkmcnt(14)
ds_read_b64_tr_b16 a[154:155],v9 offset:17416
v_mfma_f32_16x16x32_bf16 v[72:75],a[116:119],v[244:247],v[72:75]
v_mfma_f32_16x16x32_bf16 v[72:75],a[112:115],v[240:243],v[72:75]
s_waitcnt lgkmcnt(14)
ds_read_b64_tr_b16 a[156:157],v9 offset:18440
v_mfma_f32_16x16x32_bf16 v[56:59],a[112:115],v[232:235],v[56:59]
s_waitcnt lgkmcnt(14)
ds_read_b64_tr_b16 a[158:159],v9 offset:19464
v_mfma_f32_16x16x32_bf16 v[56:59],a[116:119],v[236:239],v[56:59]
v_mfma_f32_16x16x32_bf16 v[40:43],a[116:119],v[228:231],v[40:43]
v_mfma_f32_16x16x32_bf16 v[40:43],a[112:115],v[224:227],v[40:43]
v_mfma_f32_16x16x32_bf16 v[44:47],a[120:123],v[224:227],v[44:47]
v_mfma_f32_16x16x32_bf16 v[44:47],a[124:127],v[228:231],v[44:47]
v_mfma_f32_16x16x32_bf16 v[60:63],a[124:127],v[236:239],v[60:63]
v_mfma_f32_16x16x32_bf16 v[60:63],a[120:123],v[232:235],v[60:63]
v_mfma_f32_16x16x32_bf16 v[76:79],a[120:123],v[240:243],v[76:79]
v_mfma_f32_16x16x32_bf16 v[76:79],a[124:127],v[244:247],v[76:79]
v_mfma_f32_16x16x32_bf16 v[92:95],a[124:127],v[252:255],v[92:95]
v_mfma_f32_16x16x32_bf16 v[92:95],a[120:123],v[248:251],v[92:95]
s_waitcnt lgkmcnt(12)
v_mfma_f32_16x16x32_bf16 v[144:147],a[128:131],v[248:251],v[144:147]
v_mfma_f32_16x16x32_bf16 v[144:147],a[132:135],v[252:255],v[144:147]
v_mfma_f32_16x16x32_bf16 v[128:131],a[132:135],v[244:247],v[128:131]
v_mfma_f32_16x16x32_bf16 v[128:131],a[128:131],v[240:243],v[128:131]
s_waitcnt vmcnt(16)
s_waitcnt lgkmcnt(0)
s_barrier
ds_read_b128 a[96:99],v2 offset:49152
v_mfma_f32_16x16x32_bf16 v[112:115],a[128:131],v[232:235],v[112:115]
s_add_u32 m0,s25,32768
v_mfma_f32_16x16x32_bf16 v[112:115],a[132:135],v[236:239],v[112:115]
buffer_load_dwordx4 v1,s[8:11],s21 offen nt lds
v_mfma_f32_16x16x32_bf16 v[96:99],a[132:135],v[228:231],v[96:99]
v_mfma_f32_16x16x32_bf16 v[96:99],a[128:131],v[224:227],v[96:99]
ds_read_b128 a[100:103],v3 offset:49152
v_mfma_f32_16x16x32_bf16 v[100:103],a[136:139],v[224:227],v[100:103]
v_mfma_f32_16x16x32_bf16 v[100:103],a[140:143],v[228:231],v[100:103]
v_mfma_f32_16x16x32_bf16 v[116:119],a[140:143],v[236:239],v[116:119]
ds_read_b128 a[104:107],v4 offset:49152
v_mfma_f32_16x16x32_bf16 v[116:119],a[136:139],v[232:235],v[116:119]
v_mfma_f32_16x16x32_bf16 v[132:135],a[136:139],v[240:243],v[132:135]
v_mfma_f32_16x16x32_bf16 v[132:135],a[140:143],v[244:247],v[132:135]
buffer_load_dwordx4 v1,s[8:11],s21 offen offset:1024 nt lds
v_mfma_f32_16x16x32_bf16 v[148:151],a[140:143],v[252:255],v[148:151]
ds_read_b128 a[108:111],v5 offset:49152
v_mfma_f32_16x16x32_bf16 v[148:151],a[136:139],v[248:251],v[148:151]
v_mfma_f32_16x16x32_bf16 v[152:155],a[144:147],v[248:251],v[152:155]
v_mfma_f32_16x16x32_bf16 v[152:155],a[148:151],v[252:255],v[152:155]
v_mfma_f32_16x16x32_bf16 v[136:139],a[148:151],v[244:247],v[136:139]
ds_read_b128 a[112:115],v2 offset:50176
v_mfma_f32_16x16x32_bf16 v[136:139],a[144:147],v[240:243],v[136:139]
v_mfma_f32_16x16x32_bf16 v[120:123],a[144:147],v[232:235],v[120:123]
v_mfma_f32_16x16x32_bf16 v[120:123],a[148:151],v[236:239],v[120:123]
ds_read_b128 a[116:119],v3 offset:50176
v_mfma_f32_16x16x32_bf16 v[104:107],a[148:151],v[228:231],v[104:107]
v_mfma_f32_16x16x32_bf16 v[104:107],a[144:147],v[224:227],v[104:107]
v_mfma_f32_16x16x32_bf16 v[108:111],a[152:155],v[224:227],v[108:111]
v_mfma_f32_16x16x32_bf16 v[108:111],a[156:159],v[228:231],v[108:111]
ds_read_b128 a[120:123],v4 offset:50176
v_mfma_f32_16x16x32_bf16 v[124:127],a[156:159],v[236:239],v[124:127]
v_mfma_f32_16x16x32_bf16 v[124:127],a[152:155],v[232:235],v[124:127]
buffer_load_dwordx4 v1,s[8:11],s21 offen offset:2048 nt lds
v_mfma_f32_16x16x32_bf16 v[140:143],a[152:155],v[240:243],v[140:143]
v_mfma_f32_16x16x32_bf16 v[140:143],a[156:159],v[244:247],v[140:143]
ds_read_b128 a[124:127],v5 offset:50176
v_mfma_f32_16x16x32_bf16 v[156:159],a[156:159],v[252:255],v[156:159]
v_mfma_f32_16x16x32_bf16 v[156:159],a[152:155],v[248:251],v[156:159]
s_waitcnt lgkmcnt(4)
v_max3_f32 v23,v160,v161,v162
v_max3_f32 v24,v168,v169,v170
v_max3_f32 v25,v176,v177,v178
v_max3_f32 v26,v184,v185,v186
v_max3_f32 v23,v23,v163,v164
v_max3_f32 v24,v24,v171,v172
v_max3_f32 v25,v25,v179,v180
v_max3_f32 v26,v26,v187,v188
v_max3_f32 v23,v23,v165,v166
v_max3_f32 v24,v24,v173,v174
v_max3_f32 v25,v25,v181,v182
v_max3_f32 v26,v26,v189,v190
v_max_f32 v23,v23,v167
v_max_f32 v24,v24,v175
v_max_f32 v25,v25,v183
v_max_f32 v26,v26,v191
v_mov_b32 v27,v23
v_mov_b32 v28,v24
v_mov_b32 v29,v25
v_mov_b32 v30,v26
v_permlane16_swap_b32 v23,v27
v_permlane16_swap_b32 v24,v28
v_permlane16_swap_b32 v25,v29
v_permlane16_swap_b32 v26,v30
v_max_f32 v23,v23,v27
v_max_f32 v24,v24,v28
v_max_f32 v25,v25,v29
v_max_f32 v26,v26,v30
v_mov_b32 v27,v23
v_mov_b32 v28,v24
v_mov_b32 v29,v25
v_mov_b32 v30,v26
v_permlane32_swap_b32 v23,v27
v_permlane32_swap_b32 v24,v28
v_permlane32_swap_b32 v25,v29
v_permlane32_swap_b32 v26,v30
v_max_f32 v23,v23,v27
v_max_f32 v24,v24,v28
v_max_f32 v25,v25,v29
v_max_f32 v26,v26,v30
v_mul_f32 v14,s26,v23
v_mul_f32 v15,s26,v24
v_mul_f32 v16,s26,v25
v_mul_f32 v17,s26,v26
v_max3_f32 v23,v192,v193,v194
v_max3_f32 v24,v200,v201,v202
v_max3_f32 v25,v208,v209,v210
v_max3_f32 v26,v216,v217,v218
v_max3_f32 v23,v23,v195,v196
v_max3_f32 v24,v24,v203,v204
v_max3_f32 v25,v25,v211,v212
v_max3_f32 v26,v26,v219,v220
v_max3_f32 v23,v23,v197,v198
v_max3_f32 v24,v24,v205,v206
v_max3_f32 v25,v25,v213,v214
v_max3_f32 v26,v26,v221,v222
v_max_f32 v23,v23,v199
v_max_f32 v24,v24,v207
v_max_f32 v25,v25,v215
v_max_f32 v26,v26,v223
v_mov_b32 v27,v23
v_mov_b32 v28,v24
v_mov_b32 v29,v25
v_mov_b32 v30,v26
v_permlane16_swap_b32 v23,v27
v_permlane16_swap_b32 v24,v28
v_permlane16_swap_b32 v25,v29
v_permlane16_swap_b32 v26,v30
v_max_f32 v23,v23,v27
v_max_f32 v24,v24,v28
v_max_f32 v25,v25,v29
v_max_f32 v26,v26,v30
v_mov_b32 v27,v23
v_mov_b32 v28,v24
v_mov_b32 v29,v25
v_mov_b32 v30,v26
v_permlane32_swap_b32 v23,v27
v_permlane32_swap_b32 v24,v28
v_permlane32_swap_b32 v25,v29
v_permlane32_swap_b32 v26,v30
v_max_f32 v23,v23,v27
v_max_f32 v24,v24,v28
v_max_f32 v25,v25,v29
v_max_f32 v26,v26,v30
v_mul_f32 v27,s26,v23
v_mul_f32 v28,s26,v24
v_mul_f32 v29,s26,v25
v_mul_f32 v30,s26,v26
v_max3_f32 v14,v14,v27,v18
v_max3_f32 v15,v15,v28,v19
v_max3_f32 v16,v16,v29,v20
v_max3_f32 v17,v17,v30,v21
v_sub_f32 v23,v18,v14
v_sub_f32 v24,v19,v15
v_sub_f32 v25,v20,v16
v_sub_f32 v26,v21,v17
v_exp_f32 v23,v23
v_exp_f32 v24,v24
v_exp_f32 v25,v25
v_exp_f32 v26,v26
v_mov_b32 v18,v14
v_mov_b32 v19,v15
v_mov_b32 v20,v16
v_mov_b32 v21,v17
v_accvgpr_read_b32 v27,a224
v_accvgpr_read_b32 v28,a228
v_accvgpr_read_b32 v29,a232
v_accvgpr_read_b32 v30,a236
v_mul_f32 v27,v27,v23
v_mul_f32 v28,v28,v24
v_mul_f32 v29,v29,v25
v_mul_f32 v30,v30,v26
v_accvgpr_write_b32 a224,v27
v_accvgpr_write_b32 a228,v28
v_accvgpr_write_b32 a232,v29
v_accvgpr_write_b32 a236,v30
v_mul_f32 v32,v32,v23
v_mul_f32 v33,v33,v23
v_mul_f32 v34,v34,v23
v_mul_f32 v35,v35,v23
v_mul_f32 v36,v36,v23
v_mul_f32 v37,v37,v23
v_mul_f32 v38,v38,v23
v_mul_f32 v39,v39,v23
v_mul_f32 v40,v40,v23
v_mul_f32 v41,v41,v23
v_mul_f32 v42,v42,v23
v_mul_f32 v43,v43,v23
v_mul_f32 v44,v44,v23
v_mul_f32 v45,v45,v23
v_mul_f32 v46,v46,v23
v_mul_f32 v47,v47,v23
v_mul_f32 v96,v96,v23
v_mul_f32 v97,v97,v23
v_mul_f32 v98,v98,v23
v_mul_f32 v99,v99,v23
v_mul_f32 v100,v100,v23
v_mul_f32 v101,v101,v23
v_mul_f32 v102,v102,v23
v_mul_f32 v103,v103,v23
v_mul_f32 v104,v104,v23
v_mul_f32 v105,v105,v23
v_mul_f32 v106,v106,v23
v_mul_f32 v107,v107,v23
v_mul_f32 v108,v108,v23
v_mul_f32 v109,v109,v23
v_mul_f32 v110,v110,v23
v_mul_f32 v111,v111,v23
v_mul_f32 v48,v48,v24
v_mul_f32 v49,v49,v24
v_mul_f32 v50,v50,v24
v_mul_f32 v51,v51,v24
v_mul_f32 v52,v52,v24
v_mul_f32 v53,v53,v24
v_mul_f32 v54,v54,v24
v_mul_f32 v55,v55,v24
v_mul_f32 v56,v56,v24
v_mul_f32 v57,v57,v24
v_mul_f32 v58,v58,v24
v_mul_f32 v59,v59,v24
v_mul_f32 v60,v60,v24
v_mul_f32 v61,v61,v24
v_mul_f32 v62,v62,v24
v_mul_f32 v63,v63,v24
v_mul_f32 v112,v112,v24
v_mul_f32 v113,v113,v24
v_mul_f32 v114,v114,v24
v_mul_f32 v115,v115,v24
v_mul_f32 v116,v116,v24
v_mul_f32 v117,v117,v24
v_mul_f32 v118,v118,v24
v_mul_f32 v119,v119,v24
v_mul_f32 v120,v120,v24
v_mul_f32 v121,v121,v24
v_mul_f32 v122,v122,v24
v_mul_f32 v123,v123,v24
v_mul_f32 v124,v124,v24
v_mul_f32 v125,v125,v24
v_mul_f32 v126,v126,v24
v_mul_f32 v127,v127,v24
v_mul_f32 v64,v64,v25
v_mul_f32 v65,v65,v25
v_mul_f32 v66,v66,v25
v_mul_f32 v67,v67,v25
v_mul_f32 v68,v68,v25
v_mul_f32 v69,v69,v25
v_mul_f32 v70,v70,v25
v_mul_f32 v71,v71,v25
v_mul_f32 v72,v72,v25
v_mul_f32 v73,v73,v25
v_mul_f32 v74,v74,v25
v_mul_f32 v75,v75,v25
v_mul_f32 v76,v76,v25
v_mul_f32 v77,v77,v25
v_mul_f32 v78,v78,v25
v_mul_f32 v79,v79,v25
v_mul_f32 v128,v128,v25
v_mul_f32 v129,v129,v25
v_mul_f32 v130,v130,v25
v_mul_f32 v131,v131,v25
v_mul_f32 v132,v132,v25
v_mul_f32 v133,v133,v25
v_mul_f32 v134,v134,v25
v_mul_f32 v135,v135,v25
v_mul_f32 v136,v136,v25
v_mul_f32 v137,v137,v25
v_mul_f32 v138,v138,v25
v_mul_f32 v139,v139,v25
v_mul_f32 v140,v140,v25
v_mul_f32 v141,v141,v25
v_mul_f32 v142,v142,v25
v_mul_f32 v143,v143,v25
v_mul_f32 v80,v80,v26
v_mul_f32 v81,v81,v26
v_mul_f32 v82,v82,v26
v_mul_f32 v83,v83,v26
v_mul_f32 v84,v84,v26
v_mul_f32 v85,v85,v26
v_mul_f32 v86,v86,v26
v_mul_f32 v87,v87,v26
v_mul_f32 v88,v88,v26
v_mul_f32 v89,v89,v26
v_mul_f32 v90,v90,v26
v_mul_f32 v91,v91,v26
v_mul_f32 v92,v92,v26
v_mul_f32 v93,v93,v26
v_mul_f32 v94,v94,v26
v_mul_f32 v95,v95,v26
v_mul_f32 v144,v144,v26
v_mul_f32 v145,v145,v26
v_mul_f32 v146,v146,v26
v_mul_f32 v147,v147,v26
v_mul_f32 v148,v148,v26
v_mul_f32 v149,v149,v26
v_mul_f32 v150,v150,v26
v_mul_f32 v151,v151,v26
v_mul_f32 v152,v152,v26
v_mul_f32 v153,v153,v26
v_mul_f32 v154,v154,v26
v_mul_f32 v155,v155,v26
v_mul_f32 v156,v156,v26
v_mul_f32 v157,v157,v26
v_mul_f32 v158,v158,v26
v_mul_f32 v159,v159,v26
v_fma_f32 v160,v160,s26,-v18
v_fma_f32 v161,v161,s26,-v18
v_fma_f32 v162,v162,s26,-v18
v_fma_f32 v163,v163,s26,-v18
v_fma_f32 v164,v164,s26,-v18
v_fma_f32 v165,v165,s26,-v18
v_fma_f32 v166,v166,s26,-v18
v_fma_f32 v167,v167,s26,-v18
v_fma_f32 v168,v168,s26,-v19
v_fma_f32 v169,v169,s26,-v19
v_fma_f32 v170,v170,s26,-v19
v_fma_f32 v171,v171,s26,-v19
v_fma_f32 v172,v172,s26,-v19
v_fma_f32 v173,v173,s26,-v19
v_fma_f32 v174,v174,s26,-v19
v_fma_f32 v175,v175,s26,-v19
v_fma_f32 v176,v176,s26,-v20
v_fma_f32 v177,v177,s26,-v20
v_fma_f32 v178,v178,s26,-v20
v_fma_f32 v179,v179,s26,-v20
v_fma_f32 v180,v180,s26,-v20
v_fma_f32 v181,v181,s26,-v20
v_fma_f32 v182,v182,s26,-v20
v_fma_f32 v183,v183,s26,-v20
v_fma_f32 v184,v184,s26,-v21
v_fma_f32 v185,v185,s26,-v21
v_fma_f32 v186,v186,s26,-v21
v_fma_f32 v187,v187,s26,-v21
v_fma_f32 v188,v188,s26,-v21
v_fma_f32 v189,v189,s26,-v21
v_fma_f32 v190,v190,s26,-v21
v_fma_f32 v191,v191,s26,-v21
v_exp_f32 v160,v160
v_exp_f32 v161,v161
v_exp_f32 v162,v162
v_exp_f32 v163,v163
v_exp_f32 v164,v164
v_exp_f32 v165,v165
v_exp_f32 v166,v166
v_exp_f32 v167,v167
v_exp_f32 v168,v168
v_exp_f32 v169,v169
v_exp_f32 v170,v170
v_exp_f32 v171,v171
v_exp_f32 v172,v172
v_exp_f32 v173,v173
v_exp_f32 v174,v174
v_exp_f32 v175,v175
v_exp_f32 v176,v176
v_exp_f32 v177,v177
v_exp_f32 v178,v178
v_exp_f32 v179,v179
v_exp_f32 v180,v180
v_exp_f32 v181,v181
v_exp_f32 v182,v182
v_exp_f32 v183,v183
v_exp_f32 v184,v184
v_exp_f32 v185,v185
v_exp_f32 v186,v186
v_exp_f32 v187,v187
v_exp_f32 v188,v188
v_exp_f32 v189,v189
v_exp_f32 v190,v190
v_exp_f32 v191,v191
v_cvt_pk_bf16_f32 v160,v160,v161
v_cvt_pk_bf16_f32 v161,v162,v163
v_cvt_pk_bf16_f32 v162,v164,v165
v_cvt_pk_bf16_f32 v163,v166,v167
v_cvt_pk_bf16_f32 v168,v168,v169
v_cvt_pk_bf16_f32 v169,v170,v171
v_cvt_pk_bf16_f32 v170,v172,v173
v_cvt_pk_bf16_f32 v171,v174,v175
v_cvt_pk_bf16_f32 v176,v176,v177
v_cvt_pk_bf16_f32 v177,v178,v179
v_cvt_pk_bf16_f32 v178,v180,v181
v_cvt_pk_bf16_f32 v179,v182,v183
v_cvt_pk_bf16_f32 v184,v184,v185
v_cvt_pk_bf16_f32 v185,v186,v187
v_cvt_pk_bf16_f32 v186,v188,v189
v_cvt_pk_bf16_f32 v187,v190,v191
v_fma_f32 v192,v192,s26,-v18
v_fma_f32 v193,v193,s26,-v18
v_fma_f32 v194,v194,s26,-v18
v_fma_f32 v195,v195,s26,-v18
v_fma_f32 v196,v196,s26,-v18
v_fma_f32 v197,v197,s26,-v18
v_fma_f32 v198,v198,s26,-v18
v_fma_f32 v199,v199,s26,-v18
v_fma_f32 v200,v200,s26,-v19
v_fma_f32 v201,v201,s26,-v19
v_fma_f32 v202,v202,s26,-v19
v_fma_f32 v203,v203,s26,-v19
v_fma_f32 v204,v204,s26,-v19
v_fma_f32 v205,v205,s26,-v19
v_fma_f32 v206,v206,s26,-v19
v_fma_f32 v207,v207,s26,-v19
v_fma_f32 v208,v208,s26,-v20
v_fma_f32 v209,v209,s26,-v20
v_fma_f32 v210,v210,s26,-v20
v_fma_f32 v211,v211,s26,-v20
v_fma_f32 v212,v212,s26,-v20
v_fma_f32 v213,v213,s26,-v20
v_fma_f32 v214,v214,s26,-v20
v_fma_f32 v215,v215,s26,-v20
v_fma_f32 v216,v216,s26,-v21
v_fma_f32 v217,v217,s26,-v21
v_fma_f32 v218,v218,s26,-v21
v_fma_f32 v219,v219,s26,-v21
v_fma_f32 v220,v220,s26,-v21
v_fma_f32 v221,v221,s26,-v21
v_fma_f32 v222,v222,s26,-v21
v_fma_f32 v223,v223,s26,-v21
v_exp_f32 v192,v192
v_exp_f32 v193,v193
v_exp_f32 v194,v194
v_exp_f32 v195,v195
v_exp_f32 v196,v196
v_exp_f32 v197,v197
v_exp_f32 v198,v198
v_exp_f32 v199,v199
v_exp_f32 v200,v200
v_exp_f32 v201,v201
v_exp_f32 v202,v202
v_exp_f32 v203,v203
v_exp_f32 v204,v204
v_exp_f32 v205,v205
v_exp_f32 v206,v206
v_exp_f32 v207,v207
v_exp_f32 v208,v208
v_exp_f32 v209,v209
v_exp_f32 v210,v210
v_exp_f32 v211,v211
v_exp_f32 v212,v212
v_exp_f32 v213,v213
v_exp_f32 v214,v214
v_exp_f32 v215,v215
v_exp_f32 v216,v216
v_exp_f32 v217,v217
v_exp_f32 v218,v218
v_exp_f32 v219,v219
v_exp_f32 v220,v220
v_exp_f32 v221,v221
v_exp_f32 v222,v222
v_exp_f32 v223,v223
v_cvt_pk_bf16_f32 v164,v192,v193
v_cvt_pk_bf16_f32 v165,v194,v195
v_cvt_pk_bf16_f32 v166,v196,v197
v_cvt_pk_bf16_f32 v167,v198,v199
v_cvt_pk_bf16_f32 v172,v200,v201
v_cvt_pk_bf16_f32 v173,v202,v203
v_cvt_pk_bf16_f32 v174,v204,v205
v_cvt_pk_bf16_f32 v175,v206,v207
v_cvt_pk_bf16_f32 v180,v208,v209
v_cvt_pk_bf16_f32 v181,v210,v211
v_cvt_pk_bf16_f32 v182,v212,v213
v_cvt_pk_bf16_f32 v183,v214,v215
v_cvt_pk_bf16_f32 v188,v216,v217
v_cvt_pk_bf16_f32 v189,v218,v219
v_cvt_pk_bf16_f32 v190,v220,v221
v_cvt_pk_bf16_f32 v191,v222,v223
v_mfma_f32_16x16x32_bf16 v[224:227],a[96:99],a[0:3],0
ds_read_b128 a[128:131],v2 offset:51200
v_mfma_f32_16x16x32_bf16 v[224:227],a[100:103],a[4:7],v[224:227]
v_mfma_f32_16x16x32_bf16 v[224:227],a[104:107],a[8:11],v[224:227]
v_mfma_f32_16x16x32_bf16 v[224:227],a[108:111],a[12:15],v[224:227]
buffer_load_dwordx4 v1,s[8:11],s21 offen offset:3072 nt lds
v_mfma_f32_16x16x32_bf16 v[232:235],a[108:111],a[28:31],0
s_add_u32 s21,s21,16384
ds_read_b128 a[132:135],v3 offset:51200
v_mfma_f32_16x16x32_bf16 v[232:235],a[104:107],a[24:27],v[232:235]
v_mfma_f32_16x16x32_bf16 v[232:235],a[100:103],a[20:23],v[232:235]
v_mfma_f32_16x16x32_bf16 v[232:235],a[96:99],a[16:19],v[232:235]
v_mfma_f32_16x16x32_bf16 v[240:243],a[96:99],a[32:35],0
ds_read_b128 a[136:139],v4 offset:51200
v_mfma_f32_16x16x32_bf16 v[240:243],a[100:103],a[36:39],v[240:243]
v_mfma_f32_16x16x32_bf16 v[240:243],a[104:107],a[40:43],v[240:243]
v_mfma_f32_16x16x32_bf16 v[240:243],a[108:111],a[44:47],v[240:243]
ds_read_b128 a[140:143],v5 offset:51200
v_mfma_f32_16x16x32_bf16 v[248:251],a[108:111],a[60:63],0
v_mfma_f32_16x16x32_bf16 v[248:251],a[104:107],a[56:59],v[248:251]
v_mfma_f32_16x16x32_bf16 v[248:251],a[100:103],a[52:55],v[248:251]
s_waitcnt lgkmcnt(4)
v_mfma_f32_16x16x32_bf16 v[248:251],a[96:99],a[48:51],v[248:251]
ds_read_b128 a[144:147],v2 offset:52224
v_mfma_f32_16x16x32_bf16 v[228:231],a[112:115],a[0:3],0
v_mfma_f32_16x16x32_bf16 v[228:231],a[116:119],a[4:7],v[228:231]
v_mfma_f32_16x16x32_bf16 v[228:231],a[120:123],a[8:11],v[228:231]
v_mfma_f32_16x16x32_bf16 v[228:231],a[124:127],a[12:15],v[228:231]
ds_read_b128 a[148:151],v3 offset:52224
v_mfma_f32_16x16x32_bf16 v[236:239],a[124:127],a[28:31],0
v_mfma_f32_16x16x32_bf16 v[236:239],a[120:123],a[24:27],v[236:239]
v_mfma_f32_16x16x32_bf16 v[236:239],a[116:119],a[20:23],v[236:239]
s_add_u32 m0,s25,81920
ds_read_b128 a[152:155],v4 offset:52224
v_mfma_f32_16x16x32_bf16 v[236:239],a[112:115],a[16:19],v[236:239]
buffer_load_dwordx4 v1,s[12:15],s22 offen nt lds
v_mfma_f32_16x16x32_bf16 v[244:247],a[112:115],a[32:35],0
v_mfma_f32_16x16x32_bf16 v[244:247],a[116:119],a[36:39],v[244:247]
v_mfma_f32_16x16x32_bf16 v[244:247],a[120:123],a[40:43],v[244:247]
ds_read_b128 a[156:159],v5 offset:52224
v_mfma_f32_16x16x32_bf16 v[244:247],a[124:127],a[44:47],v[244:247]
v_mfma_f32_16x16x32_bf16 v[252:255],a[124:127],a[60:63],0
v_mfma_f32_16x16x32_bf16 v[252:255],a[120:123],a[56:59],v[252:255]
v_mfma_f32_16x16x32_bf16 v[252:255],a[116:119],a[52:55],v[252:255]
v_mfma_f32_16x16x32_bf16 v[252:255],a[112:115],a[48:51],v[252:255]
s_waitcnt lgkmcnt(4)
v_mfma_f32_16x16x32_bf16 v[192:195],a[128:131],a[0:3],0
v_mfma_f32_16x16x32_bf16 v[192:195],a[132:135],a[4:7],v[192:195]
v_mfma_f32_16x16x32_bf16 v[192:195],a[136:139],a[8:11],v[192:195]
v_mfma_f32_16x16x32_bf16 v[192:195],a[140:143],a[12:15],v[192:195]
buffer_load_dwordx4 v1,s[12:15],s22 offen offset:1024 nt lds
v_mfma_f32_16x16x32_bf16 v[200:203],a[140:143],a[28:31],0
v_mfma_f32_16x16x32_bf16 v[200:203],a[136:139],a[24:27],v[200:203]
ds_read_b64_tr_b16 a[96:97],v6 offset:32768
v_mfma_f32_16x16x32_bf16 v[200:203],a[132:135],a[20:23],v[200:203]
ds_read_b64_tr_b16 a[98:99],v6 offset:33792
v_mfma_f32_16x16x32_bf16 v[200:203],a[128:131],a[16:19],v[200:203]
v_mfma_f32_16x16x32_bf16 v[208:211],a[128:131],a[32:35],0
ds_read_b64_tr_b16 a[100:101],v6 offset:34816
v_mfma_f32_16x16x32_bf16 v[208:211],a[132:135],a[36:39],v[208:211]
ds_read_b64_tr_b16 a[102:103],v6 offset:35840
v_mfma_f32_16x16x32_bf16 v[208:211],a[136:139],a[40:43],v[208:211]
v_mfma_f32_16x16x32_bf16 v[208:211],a[140:143],a[44:47],v[208:211]
buffer_load_dwordx4 v1,s[12:15],s22 offen offset:2048 nt lds
v_mfma_f32_16x16x32_bf16 v[216:219],a[140:143],a[60:63],0
ds_read_b64_tr_b16 a[104:105],v6 offset:32776
v_mfma_f32_16x16x32_bf16 v[216:219],a[136:139],a[56:59],v[216:219]
ds_read_b64_tr_b16 a[106:107],v6 offset:33800
v_mfma_f32_16x16x32_bf16 v[216:219],a[132:135],a[52:55],v[216:219]
v_mfma_f32_16x16x32_bf16 v[216:219],a[128:131],a[48:51],v[216:219]
s_waitcnt lgkmcnt(6)
v_mfma_f32_16x16x32_bf16 v[196:199],a[144:147],a[0:3],0
ds_read_b64_tr_b16 a[108:109],v6 offset:34824
v_mfma_f32_16x16x32_bf16 v[196:199],a[148:151],a[4:7],v[196:199]
ds_read_b64_tr_b16 a[110:111],v6 offset:35848
v_mfma_f32_16x16x32_bf16 v[196:199],a[152:155],a[8:11],v[196:199]
v_mfma_f32_16x16x32_bf16 v[196:199],a[156:159],a[12:15],v[196:199]
ds_read_b64_tr_b16 a[112:113],v7 offset:32768
v_mfma_f32_16x16x32_bf16 v[204:207],a[156:159],a[28:31],0
ds_read_b64_tr_b16 a[114:115],v7 offset:33792
v_mfma_f32_16x16x32_bf16 v[204:207],a[152:155],a[24:27],v[204:207]
v_mfma_f32_16x16x32_bf16 v[204:207],a[148:151],a[20:23],v[204:207]
v_mfma_f32_16x16x32_bf16 v[204:207],a[144:147],a[16:19],v[204:207]
ds_read_b64_tr_b16 a[116:117],v7 offset:34816
v_mfma_f32_16x16x32_bf16 v[212:215],a[144:147],a[32:35],0
ds_read_b64_tr_b16 a[118:119],v7 offset:35840
v_mfma_f32_16x16x32_bf16 v[212:215],a[148:151],a[36:39],v[212:215]
v_mfma_f32_16x16x32_bf16 v[212:215],a[152:155],a[40:43],v[212:215]
v_mfma_f32_16x16x32_bf16 v[212:215],a[156:159],a[44:47],v[212:215]
ds_read_b64_tr_b16 a[120:121],v7 offset:32776
v_mfma_f32_16x16x32_bf16 v[220:223],a[156:159],a[60:63],0
ds_read_b64_tr_b16 a[122:123],v7 offset:33800
v_mfma_f32_16x16x32_bf16 v[220:223],a[152:155],a[56:59],v[220:223]
v_mfma_f32_16x16x32_bf16 v[220:223],a[148:151],a[52:55],v[220:223]
ds_read_b64_tr_b16 a[124:125],v7 offset:34824
v_mfma_f32_16x16x32_bf16 v[220:223],a[144:147],a[48:51],v[220:223]
s_waitcnt lgkmcnt(14)
ds_read_b64_tr_b16 a[126:127],v7 offset:35848
v_mfma_f32_16x16x32_bf16 a[224:227],a[240:243],v[160:163],a[224:227]
v_mfma_f32_16x16x32_bf16 a[224:227],a[240:243],v[164:167],a[224:227]
buffer_load_dwordx4 v1,s[12:15],s22 offen offset:3072 nt lds
v_mfma_f32_16x16x32_bf16 a[228:231],a[240:243],v[168:171],a[228:231]
s_add_u32 s22,s22,16384
s_waitcnt lgkmcnt(14)
ds_read_b64_tr_b16 a[128:129],v8 offset:32768
v_mfma_f32_16x16x32_bf16 a[228:231],a[240:243],v[172:175],a[228:231]
s_waitcnt lgkmcnt(14)
ds_read_b64_tr_b16 a[130:131],v8 offset:33792
v_mfma_f32_16x16x32_bf16 a[232:235],a[240:243],v[176:179],a[232:235]
v_mfma_f32_16x16x32_bf16 a[232:235],a[240:243],v[180:183],a[232:235]
s_waitcnt lgkmcnt(14)
v_mfma_f32_16x16x32_bf16 a[236:239],a[240:243],v[184:187],a[236:239]
ds_read_b64_tr_b16 a[132:133],v8 offset:34816
v_mfma_f32_16x16x32_bf16 a[236:239],a[240:243],v[188:191],a[236:239]
s_waitcnt lgkmcnt(14)
ds_read_b64_tr_b16 a[134:135],v8 offset:35840
v_mfma_f32_16x16x32_bf16 v[80:83],a[96:99],v[184:187],v[80:83]
v_mfma_f32_16x16x32_bf16 v[80:83],a[100:103],v[188:191],v[80:83]
s_waitcnt lgkmcnt(14)
ds_read_b64_tr_b16 a[136:137],v8 offset:32776
v_mfma_f32_16x16x32_bf16 v[64:67],a[100:103],v[180:183],v[64:67]
s_waitcnt lgkmcnt(14)
ds_read_b64_tr_b16 a[138:139],v8 offset:33800
v_mfma_f32_16x16x32_bf16 v[64:67],a[96:99],v[176:179],v[64:67]
v_mfma_f32_16x16x32_bf16 v[48:51],a[96:99],v[168:171],v[48:51]
v_mfma_f32_16x16x32_bf16 v[48:51],a[100:103],v[172:175],v[48:51]
s_waitcnt lgkmcnt(14)
ds_read_b64_tr_b16 a[140:141],v8 offset:34824
v_mfma_f32_16x16x32_bf16 v[32:35],a[100:103],v[164:167],v[32:35]
s_waitcnt lgkmcnt(14)
ds_read_b64_tr_b16 a[142:143],v8 offset:35848
v_mfma_f32_16x16x32_bf16 v[32:35],a[96:99],v[160:163],v[32:35]
v_mfma_f32_16x16x32_bf16 v[36:39],a[104:107],v[160:163],v[36:39]
v_mfma_f32_16x16x32_bf16 v[36:39],a[108:111],v[164:167],v[36:39]
s_waitcnt lgkmcnt(14)
ds_read_b64_tr_b16 a[144:145],v9 offset:32768
v_mfma_f32_16x16x32_bf16 v[52:55],a[108:111],v[172:175],v[52:55]
s_waitcnt lgkmcnt(14)
ds_read_b64_tr_b16 a[146:147],v9 offset:33792
v_mfma_f32_16x16x32_bf16 v[52:55],a[104:107],v[168:171],v[52:55]
v_mfma_f32_16x16x32_bf16 v[68:71],a[104:107],v[176:179],v[68:71]
s_waitcnt lgkmcnt(14)
ds_read_b64_tr_b16 a[148:149],v9 offset:34816
v_mfma_f32_16x16x32_bf16 v[68:71],a[108:111],v[180:183],v[68:71]
s_waitcnt lgkmcnt(14)
ds_read_b64_tr_b16 a[150:151],v9 offset:35840
v_mfma_f32_16x16x32_bf16 v[84:87],a[108:111],v[188:191],v[84:87]
v_mfma_f32_16x16x32_bf16 v[84:87],a[104:107],v[184:187],v[84:87]
v_mfma_f32_16x16x32_bf16 v[88:91],a[112:115],v[184:187],v[88:91]
s_waitcnt lgkmcnt(14)
ds_read_b64_tr_b16 a[152:153],v9 offset:32776
v_mfma_f32_16x16x32_bf16 v[88:91],a[116:119],v[188:191],v[88:91]
s_waitcnt lgkmcnt(14)
ds_read_b64_tr_b16 a[154:155],v9 offset:33800
v_mfma_f32_16x16x32_bf16 v[72:75],a[116:119],v[180:183],v[72:75]
v_mfma_f32_16x16x32_bf16 v[72:75],a[112:115],v[176:179],v[72:75]
s_waitcnt lgkmcnt(14)
ds_read_b64_tr_b16 a[156:157],v9 offset:34824
v_mfma_f32_16x16x32_bf16 v[56:59],a[112:115],v[168:171],v[56:59]
s_waitcnt lgkmcnt(14)
ds_read_b64_tr_b16 a[158:159],v9 offset:35848
v_mfma_f32_16x16x32_bf16 v[56:59],a[116:119],v[172:175],v[56:59]
v_mfma_f32_16x16x32_bf16 v[40:43],a[116:119],v[164:167],v[40:43]
v_mfma_f32_16x16x32_bf16 v[40:43],a[112:115],v[160:163],v[40:43]
v_mfma_f32_16x16x32_bf16 v[44:47],a[120:123],v[160:163],v[44:47]
v_mfma_f32_16x16x32_bf16 v[44:47],a[124:127],v[164:167],v[44:47]
v_mfma_f32_16x16x32_bf16 v[60:63],a[124:127],v[172:175],v[60:63]
v_mfma_f32_16x16x32_bf16 v[60:63],a[120:123],v[168:171],v[60:63]
v_mfma_f32_16x16x32_bf16 v[76:79],a[120:123],v[176:179],v[76:79]
v_mfma_f32_16x16x32_bf16 v[76:79],a[124:127],v[180:183],v[76:79]
v_mfma_f32_16x16x32_bf16 v[92:95],a[124:127],v[188:191],v[92:95]
v_mfma_f32_16x16x32_bf16 v[92:95],a[120:123],v[184:187],v[92:95]
s_waitcnt lgkmcnt(12)
v_mfma_f32_16x16x32_bf16 v[144:147],a[128:131],v[184:187],v[144:147]
v_mfma_f32_16x16x32_bf16 v[144:147],a[132:135],v[188:191],v[144:147]
v_mfma_f32_16x16x32_bf16 v[128:131],a[132:135],v[180:183],v[128:131]
v_mfma_f32_16x16x32_bf16 v[128:131],a[128:131],v[176:179],v[128:131]
s_waitcnt vmcnt(16)
s_waitcnt lgkmcnt(0)
s_barrier
ds_read_b128 a[96:99],v2 offset:0
v_mfma_f32_16x16x32_bf16 v[112:115],a[128:131],v[168:171],v[112:115]
s_add_u32 m0,s25,49152
v_mfma_f32_16x16x32_bf16 v[112:115],a[132:135],v[172:175],v[112:115]
buffer_load_dwordx4 v1,s[8:11],s21 offen nt lds
v_mfma_f32_16x16x32_bf16 v[96:99],a[132:135],v[164:167],v[96:99]
v_mfma_f32_16x16x32_bf16 v[96:99],a[128:131],v[160:163],v[96:99]
ds_read_b128 a[100:103],v3 offset:0
v_mfma_f32_16x16x32_bf16 v[100:103],a[136:139],v[160:163],v[100:103]
v_mfma_f32_16x16x32_bf16 v[100:103],a[140:143],v[164:167],v[100:103]
v_mfma_f32_16x16x32_bf16 v[116:119],a[140:143],v[172:175],v[116:119]
ds_read_b128 a[104:107],v4 offset:0
v_mfma_f32_16x16x32_bf16 v[116:119],a[136:139],v[168:171],v[116:119]
v_mfma_f32_16x16x32_bf16 v[132:135],a[136:139],v[176:179],v[132:135]
v_mfma_f32_16x16x32_bf16 v[132:135],a[140:143],v[180:183],v[132:135]
buffer_load_dwordx4 v1,s[8:11],s21 offen offset:1024 nt lds
v_mfma_f32_16x16x32_bf16 v[148:151],a[140:143],v[188:191],v[148:151]
ds_read_b128 a[108:111],v5 offset:0
v_mfma_f32_16x16x32_bf16 v[148:151],a[136:139],v[184:187],v[148:151]
v_mfma_f32_16x16x32_bf16 v[152:155],a[144:147],v[184:187],v[152:155]
v_mfma_f32_16x16x32_bf16 v[152:155],a[148:151],v[188:191],v[152:155]
v_mfma_f32_16x16x32_bf16 v[136:139],a[148:151],v[180:183],v[136:139]
ds_read_b128 a[112:115],v2 offset:1024
v_mfma_f32_16x16x32_bf16 v[136:139],a[144:147],v[176:179],v[136:139]
v_mfma_f32_16x16x32_bf16 v[120:123],a[144:147],v[168:171],v[120:123]
v_mfma_f32_16x16x32_bf16 v[120:123],a[148:151],v[172:175],v[120:123]
ds_read_b128 a[116:119],v3 offset:1024
v_mfma_f32_16x16x32_bf16 v[104:107],a[148:151],v[164:167],v[104:107]
v_mfma_f32_16x16x32_bf16 v[104:107],a[144:147],v[160:163],v[104:107]
v_mfma_f32_16x16x32_bf16 v[108:111],a[152:155],v[160:163],v[108:111]
v_mfma_f32_16x16x32_bf16 v[108:111],a[156:159],v[164:167],v[108:111]
ds_read_b128 a[120:123],v4 offset:1024
v_mfma_f32_16x16x32_bf16 v[124:127],a[156:159],v[172:175],v[124:127]
v_mfma_f32_16x16x32_bf16 v[124:127],a[152:155],v[168:171],v[124:127]
buffer_load_dwordx4 v1,s[8:11],s21 offen offset:2048 nt lds
v_mfma_f32_16x16x32_bf16 v[140:143],a[152:155],v[176:179],v[140:143]
v_mfma_f32_16x16x32_bf16 v[140:143],a[156:159],v[180:183],v[140:143]
ds_read_b128 a[124:127],v5 offset:1024
v_mfma_f32_16x16x32_bf16 v[156:159],a[156:159],v[188:191],v[156:159]
v_mfma_f32_16x16x32_bf16 v[156:159],a[152:155],v[184:187],v[156:159]
s_waitcnt lgkmcnt(4)
v_max3_f32 v23,v224,v225,v226
v_max3_f32 v24,v232,v233,v234
v_max3_f32 v25,v240,v241,v242
v_max3_f32 v26,v248,v249,v250
v_max3_f32 v23,v23,v227,v228
v_max3_f32 v24,v24,v235,v236
v_max3_f32 v25,v25,v243,v244
v_max3_f32 v26,v26,v251,v252
v_max3_f32 v23,v23,v229,v230
v_max3_f32 v24,v24,v237,v238
v_max3_f32 v25,v25,v245,v246
v_max3_f32 v26,v26,v253,v254
v_max_f32 v23,v23,v231
v_max_f32 v24,v24,v239
v_max_f32 v25,v25,v247
v_max_f32 v26,v26,v255
v_mov_b32 v27,v23
v_mov_b32 v28,v24
v_mov_b32 v29,v25
v_mov_b32 v30,v26
v_permlane16_swap_b32 v23,v27
v_permlane16_swap_b32 v24,v28
v_permlane16_swap_b32 v25,v29
v_permlane16_swap_b32 v26,v30
v_max_f32 v23,v23,v27
v_max_f32 v24,v24,v28
v_max_f32 v25,v25,v29
v_max_f32 v26,v26,v30
v_mov_b32 v27,v23
v_mov_b32 v28,v24
v_mov_b32 v29,v25
v_mov_b32 v30,v26
v_permlane32_swap_b32 v23,v27
v_permlane32_swap_b32 v24,v28
v_permlane32_swap_b32 v25,v29
v_permlane32_swap_b32 v26,v30
v_max_f32 v23,v23,v27
v_max_f32 v24,v24,v28
v_max_f32 v25,v25,v29
v_max_f32 v26,v26,v30
v_mul_f32 v14,s26,v23
v_mul_f32 v15,s26,v24
v_mul_f32 v16,s26,v25
v_mul_f32 v17,s26,v26
v_max3_f32 v23,v192,v193,v194
v_max3_f32 v24,v200,v201,v202
v_max3_f32 v25,v208,v209,v210
v_max3_f32 v26,v216,v217,v218
v_max3_f32 v23,v23,v195,v196
v_max3_f32 v24,v24,v203,v204
v_max3_f32 v25,v25,v211,v212
v_max3_f32 v26,v26,v219,v220
v_max3_f32 v23,v23,v197,v198
v_max3_f32 v24,v24,v205,v206
v_max3_f32 v25,v25,v213,v214
v_max3_f32 v26,v26,v221,v222
v_max_f32 v23,v23,v199
v_max_f32 v24,v24,v207
v_max_f32 v25,v25,v215
v_max_f32 v26,v26,v223
v_mov_b32 v27,v23
v_mov_b32 v28,v24
v_mov_b32 v29,v25
v_mov_b32 v30,v26
v_permlane16_swap_b32 v23,v27
v_permlane16_swap_b32 v24,v28
v_permlane16_swap_b32 v25,v29
v_permlane16_swap_b32 v26,v30
v_max_f32 v23,v23,v27
v_max_f32 v24,v24,v28
v_max_f32 v25,v25,v29
v_max_f32 v26,v26,v30
v_mov_b32 v27,v23
v_mov_b32 v28,v24
v_mov_b32 v29,v25
v_mov_b32 v30,v26
v_permlane32_swap_b32 v23,v27
v_permlane32_swap_b32 v24,v28
v_permlane32_swap_b32 v25,v29
v_permlane32_swap_b32 v26,v30
v_max_f32 v23,v23,v27
v_max_f32 v24,v24,v28
v_max_f32 v25,v25,v29
v_max_f32 v26,v26,v30
v_mul_f32 v27,s26,v23
v_mul_f32 v28,s26,v24
v_mul_f32 v29,s26,v25
v_mul_f32 v30,s26,v26
v_max3_f32 v14,v14,v27,v18
v_max3_f32 v15,v15,v28,v19
v_max3_f32 v16,v16,v29,v20
v_max3_f32 v17,v17,v30,v21
v_sub_f32 v23,v18,v14
v_sub_f32 v24,v19,v15
v_sub_f32 v25,v20,v16
v_sub_f32 v26,v21,v17
v_exp_f32 v23,v23
v_exp_f32 v24,v24
v_exp_f32 v25,v25
v_exp_f32 v26,v26
v_mov_b32 v18,v14
v_mov_b32 v19,v15
v_mov_b32 v20,v16
v_mov_b32 v21,v17
v_accvgpr_read_b32 v27,a224
v_accvgpr_read_b32 v28,a228
v_accvgpr_read_b32 v29,a232
v_accvgpr_read_b32 v30,a236
v_mul_f32 v27,v27,v23
v_mul_f32 v28,v28,v24
v_mul_f32 v29,v29,v25
v_mul_f32 v30,v30,v26
v_accvgpr_write_b32 a224,v27
v_accvgpr_write_b32 a228,v28
v_accvgpr_write_b32 a232,v29
v_accvgpr_write_b32 a236,v30
v_mul_f32 v32,v32,v23
v_mul_f32 v33,v33,v23
v_mul_f32 v34,v34,v23
v_mul_f32 v35,v35,v23
v_mul_f32 v36,v36,v23
v_mul_f32 v37,v37,v23
v_mul_f32 v38,v38,v23
v_mul_f32 v39,v39,v23
v_mul_f32 v40,v40,v23
v_mul_f32 v41,v41,v23
v_mul_f32 v42,v42,v23
v_mul_f32 v43,v43,v23
v_mul_f32 v44,v44,v23
v_mul_f32 v45,v45,v23
v_mul_f32 v46,v46,v23
v_mul_f32 v47,v47,v23
v_mul_f32 v96,v96,v23
v_mul_f32 v97,v97,v23
v_mul_f32 v98,v98,v23
v_mul_f32 v99,v99,v23
v_mul_f32 v100,v100,v23
v_mul_f32 v101,v101,v23
v_mul_f32 v102,v102,v23
v_mul_f32 v103,v103,v23
v_mul_f32 v104,v104,v23
v_mul_f32 v105,v105,v23
v_mul_f32 v106,v106,v23
v_mul_f32 v107,v107,v23
v_mul_f32 v108,v108,v23
v_mul_f32 v109,v109,v23
v_mul_f32 v110,v110,v23
v_mul_f32 v111,v111,v23
v_mul_f32 v48,v48,v24
v_mul_f32 v49,v49,v24
v_mul_f32 v50,v50,v24
v_mul_f32 v51,v51,v24
v_mul_f32 v52,v52,v24
v_mul_f32 v53,v53,v24
v_mul_f32 v54,v54,v24
v_mul_f32 v55,v55,v24
v_mul_f32 v56,v56,v24
v_mul_f32 v57,v57,v24
v_mul_f32 v58,v58,v24
v_mul_f32 v59,v59,v24
v_mul_f32 v60,v60,v24
v_mul_f32 v61,v61,v24
v_mul_f32 v62,v62,v24
v_mul_f32 v63,v63,v24
v_mul_f32 v112,v112,v24
v_mul_f32 v113,v113,v24
v_mul_f32 v114,v114,v24
v_mul_f32 v115,v115,v24
v_mul_f32 v116,v116,v24
v_mul_f32 v117,v117,v24
v_mul_f32 v118,v118,v24
v_mul_f32 v119,v119,v24
v_mul_f32 v120,v120,v24
v_mul_f32 v121,v121,v24
v_mul_f32 v122,v122,v24
v_mul_f32 v123,v123,v24
v_mul_f32 v124,v124,v24
v_mul_f32 v125,v125,v24
v_mul_f32 v126,v126,v24
v_mul_f32 v127,v127,v24
v_mul_f32 v64,v64,v25
v_mul_f32 v65,v65,v25
v_mul_f32 v66,v66,v25
v_mul_f32 v67,v67,v25
v_mul_f32 v68,v68,v25
v_mul_f32 v69,v69,v25
v_mul_f32 v70,v70,v25
v_mul_f32 v71,v71,v25
v_mul_f32 v72,v72,v25
v_mul_f32 v73,v73,v25
v_mul_f32 v74,v74,v25
v_mul_f32 v75,v75,v25
v_mul_f32 v76,v76,v25
v_mul_f32 v77,v77,v25
v_mul_f32 v78,v78,v25
v_mul_f32 v79,v79,v25
v_mul_f32 v128,v128,v25
v_mul_f32 v129,v129,v25
v_mul_f32 v130,v130,v25
v_mul_f32 v131,v131,v25
v_mul_f32 v132,v132,v25
v_mul_f32 v133,v133,v25
v_mul_f32 v134,v134,v25
v_mul_f32 v135,v135,v25
v_mul_f32 v136,v136,v25
v_mul_f32 v137,v137,v25
v_mul_f32 v138,v138,v25
v_mul_f32 v139,v139,v25
v_mul_f32 v140,v140,v25
v_mul_f32 v141,v141,v25
v_mul_f32 v142,v142,v25
v_mul_f32 v143,v143,v25
v_mul_f32 v80,v80,v26
v_mul_f32 v81,v81,v26
v_mul_f32 v82,v82,v26
v_mul_f32 v83,v83,v26
v_mul_f32 v84,v84,v26
v_mul_f32 v85,v85,v26
v_mul_f32 v86,v86,v26
v_mul_f32 v87,v87,v26
v_mul_f32 v88,v88,v26
v_mul_f32 v89,v89,v26
v_mul_f32 v90,v90,v26
v_mul_f32 v91,v91,v26
v_mul_f32 v92,v92,v26
v_mul_f32 v93,v93,v26
v_mul_f32 v94,v94,v26
v_mul_f32 v95,v95,v26
v_mul_f32 v144,v144,v26
v_mul_f32 v145,v145,v26
v_mul_f32 v146,v146,v26
v_mul_f32 v147,v147,v26
v_mul_f32 v148,v148,v26
v_mul_f32 v149,v149,v26
v_mul_f32 v150,v150,v26
v_mul_f32 v151,v151,v26
v_mul_f32 v152,v152,v26
v_mul_f32 v153,v153,v26
v_mul_f32 v154,v154,v26
v_mul_f32 v155,v155,v26
v_mul_f32 v156,v156,v26
v_mul_f32 v157,v157,v26
v_mul_f32 v158,v158,v26
v_mul_f32 v159,v159,v26
v_fma_f32 v224,v224,s26,-v18
v_fma_f32 v225,v225,s26,-v18
v_fma_f32 v226,v226,s26,-v18
v_fma_f32 v227,v227,s26,-v18
v_fma_f32 v228,v228,s26,-v18
v_fma_f32 v229,v229,s26,-v18
v_fma_f32 v230,v230,s26,-v18
v_fma_f32 v231,v231,s26,-v18
v_fma_f32 v232,v232,s26,-v19
v_fma_f32 v233,v233,s26,-v19
v_fma_f32 v234,v234,s26,-v19
v_fma_f32 v235,v235,s26,-v19
v_fma_f32 v236,v236,s26,-v19
v_fma_f32 v237,v237,s26,-v19
v_fma_f32 v238,v238,s26,-v19
v_fma_f32 v239,v239,s26,-v19
v_fma_f32 v240,v240,s26,-v20
v_fma_f32 v241,v241,s26,-v20
v_fma_f32 v242,v242,s26,-v20
v_fma_f32 v243,v243,s26,-v20
v_fma_f32 v244,v244,s26,-v20
v_fma_f32 v245,v245,s26,-v20
v_fma_f32 v246,v246,s26,-v20
v_fma_f32 v247,v247,s26,-v20
v_fma_f32 v248,v248,s26,-v21
v_fma_f32 v249,v249,s26,-v21
v_fma_f32 v250,v250,s26,-v21
v_fma_f32 v251,v251,s26,-v21
v_fma_f32 v252,v252,s26,-v21
v_fma_f32 v253,v253,s26,-v21
v_fma_f32 v254,v254,s26,-v21
v_fma_f32 v255,v255,s26,-v21
v_exp_f32 v224,v224
v_exp_f32 v225,v225
v_exp_f32 v226,v226
v_exp_f32 v227,v227
v_exp_f32 v228,v228
v_exp_f32 v229,v229
v_exp_f32 v230,v230
v_exp_f32 v231,v231
v_exp_f32 v232,v232
v_exp_f32 v233,v233
v_exp_f32 v234,v234
v_exp_f32 v235,v235
v_exp_f32 v236,v236
v_exp_f32 v237,v237
v_exp_f32 v238,v238
v_exp_f32 v239,v239
v_exp_f32 v240,v240
v_exp_f32 v241,v241
v_exp_f32 v242,v242
v_exp_f32 v243,v243
v_exp_f32 v244,v244
v_exp_f32 v245,v245
v_exp_f32 v246,v246
v_exp_f32 v247,v247
v_exp_f32 v248,v248
v_exp_f32 v249,v249
v_exp_f32 v250,v250
v_exp_f32 v251,v251
v_exp_f32 v252,v252
v_exp_f32 v253,v253
v_exp_f32 v254,v254
v_exp_f32 v255,v255
v_cvt_pk_bf16_f32 v224,v224,v225
v_cvt_pk_bf16_f32 v225,v226,v227
v_cvt_pk_bf16_f32 v226,v228,v229
v_cvt_pk_bf16_f32 v227,v230,v231
v_cvt_pk_bf16_f32 v232,v232,v233
v_cvt_pk_bf16_f32 v233,v234,v235
v_cvt_pk_bf16_f32 v234,v236,v237
v_cvt_pk_bf16_f32 v235,v238,v239
v_cvt_pk_bf16_f32 v240,v240,v241
v_cvt_pk_bf16_f32 v241,v242,v243
v_cvt_pk_bf16_f32 v242,v244,v245
v_cvt_pk_bf16_f32 v243,v246,v247
v_cvt_pk_bf16_f32 v248,v248,v249
v_cvt_pk_bf16_f32 v249,v250,v251
v_cvt_pk_bf16_f32 v250,v252,v253
v_cvt_pk_bf16_f32 v251,v254,v255
v_fma_f32 v192,v192,s26,-v18
v_fma_f32 v193,v193,s26,-v18
v_fma_f32 v194,v194,s26,-v18
v_fma_f32 v195,v195,s26,-v18
v_fma_f32 v196,v196,s26,-v18
v_fma_f32 v197,v197,s26,-v18
v_fma_f32 v198,v198,s26,-v18
v_fma_f32 v199,v199,s26,-v18
v_fma_f32 v200,v200,s26,-v19
v_fma_f32 v201,v201,s26,-v19
v_fma_f32 v202,v202,s26,-v19
v_fma_f32 v203,v203,s26,-v19
v_fma_f32 v204,v204,s26,-v19
v_fma_f32 v205,v205,s26,-v19
v_fma_f32 v206,v206,s26,-v19
v_fma_f32 v207,v207,s26,-v19
v_fma_f32 v208,v208,s26,-v20
v_fma_f32 v209,v209,s26,-v20
v_fma_f32 v210,v210,s26,-v20
v_fma_f32 v211,v211,s26,-v20
v_fma_f32 v212,v212,s26,-v20
v_fma_f32 v213,v213,s26,-v20
v_fma_f32 v214,v214,s26,-v20
v_fma_f32 v215,v215,s26,-v20
v_fma_f32 v216,v216,s26,-v21
v_fma_f32 v217,v217,s26,-v21
v_fma_f32 v218,v218,s26,-v21
v_fma_f32 v219,v219,s26,-v21
v_fma_f32 v220,v220,s26,-v21
v_fma_f32 v221,v221,s26,-v21
v_fma_f32 v222,v222,s26,-v21
v_fma_f32 v223,v223,s26,-v21
v_exp_f32 v192,v192
v_exp_f32 v193,v193
v_exp_f32 v194,v194
v_exp_f32 v195,v195
v_exp_f32 v196,v196
v_exp_f32 v197,v197
v_exp_f32 v198,v198
v_exp_f32 v199,v199
v_exp_f32 v200,v200
v_exp_f32 v201,v201
v_exp_f32 v202,v202
v_exp_f32 v203,v203
v_exp_f32 v204,v204
v_exp_f32 v205,v205
v_exp_f32 v206,v206
v_exp_f32 v207,v207
v_exp_f32 v208,v208
v_exp_f32 v209,v209
v_exp_f32 v210,v210
v_exp_f32 v211,v211
v_exp_f32 v212,v212
v_exp_f32 v213,v213
v_exp_f32 v214,v214
v_exp_f32 v215,v215
v_exp_f32 v216,v216
v_exp_f32 v217,v217
v_exp_f32 v218,v218
v_exp_f32 v219,v219
v_exp_f32 v220,v220
v_exp_f32 v221,v221
v_exp_f32 v222,v222
v_exp_f32 v223,v223
v_cvt_pk_bf16_f32 v228,v192,v193
v_cvt_pk_bf16_f32 v229,v194,v195
v_cvt_pk_bf16_f32 v230,v196,v197
v_cvt_pk_bf16_f32 v231,v198,v199
v_cvt_pk_bf16_f32 v236,v200,v201
v_cvt_pk_bf16_f32 v237,v202,v203
v_cvt_pk_bf16_f32 v238,v204,v205
v_cvt_pk_bf16_f32 v239,v206,v207
v_cvt_pk_bf16_f32 v244,v208,v209
v_cvt_pk_bf16_f32 v245,v210,v211
v_cvt_pk_bf16_f32 v246,v212,v213
v_cvt_pk_bf16_f32 v247,v214,v215
v_cvt_pk_bf16_f32 v252,v216,v217
v_cvt_pk_bf16_f32 v253,v218,v219
v_cvt_pk_bf16_f32 v254,v220,v221
v_cvt_pk_bf16_f32 v255,v222,v223
v_mfma_f32_16x16x32_bf16 v[160:163],a[96:99],a[0:3],0
ds_read_b128 a[128:131],v2 offset:2048
v_mfma_f32_16x16x32_bf16 v[160:163],a[100:103],a[4:7],v[160:163]
v_mfma_f32_16x16x32_bf16 v[160:163],a[104:107],a[8:11],v[160:163]
v_mfma_f32_16x16x32_bf16 v[160:163],a[108:111],a[12:15],v[160:163]
buffer_load_dwordx4 v1,s[8:11],s21 offen offset:3072 nt lds
v_mfma_f32_16x16x32_bf16 v[168:171],a[108:111],a[28:31],0
s_add_u32 s21,s21,16384
ds_read_b128 a[132:135],v3 offset:2048
v_mfma_f32_16x16x32_bf16 v[168:171],a[104:107],a[24:27],v[168:171]
v_mfma_f32_16x16x32_bf16 v[168:171],a[100:103],a[20:23],v[168:171]
v_mfma_f32_16x16x32_bf16 v[168:171],a[96:99],a[16:19],v[168:171]
v_mfma_f32_16x16x32_bf16 v[176:179],a[96:99],a[32:35],0
ds_read_b128 a[136:139],v4 offset:2048
v_mfma_f32_16x16x32_bf16 v[176:179],a[100:103],a[36:39],v[176:179]
v_mfma_f32_16x16x32_bf16 v[176:179],a[104:107],a[40:43],v[176:179]
v_mfma_f32_16x16x32_bf16 v[176:179],a[108:111],a[44:47],v[176:179]
ds_read_b128 a[140:143],v5 offset:2048
v_mfma_f32_16x16x32_bf16 v[184:187],a[108:111],a[60:63],0
v_mfma_f32_16x16x32_bf16 v[184:187],a[104:107],a[56:59],v[184:187]
v_mfma_f32_16x16x32_bf16 v[184:187],a[100:103],a[52:55],v[184:187]
s_waitcnt lgkmcnt(4)
v_mfma_f32_16x16x32_bf16 v[184:187],a[96:99],a[48:51],v[184:187]
ds_read_b128 a[144:147],v2 offset:3072
v_mfma_f32_16x16x32_bf16 v[164:167],a[112:115],a[0:3],0
v_mfma_f32_16x16x32_bf16 v[164:167],a[116:119],a[4:7],v[164:167]
v_mfma_f32_16x16x32_bf16 v[164:167],a[120:123],a[8:11],v[164:167]
v_mfma_f32_16x16x32_bf16 v[164:167],a[124:127],a[12:15],v[164:167]
ds_read_b128 a[148:151],v3 offset:3072
v_mfma_f32_16x16x32_bf16 v[172:175],a[124:127],a[28:31],0
v_mfma_f32_16x16x32_bf16 v[172:175],a[120:123],a[24:27],v[172:175]
v_mfma_f32_16x16x32_bf16 v[172:175],a[116:119],a[20:23],v[172:175]
s_add_u32 m0,s25,98304
ds_read_b128 a[152:155],v4 offset:3072
v_mfma_f32_16x16x32_bf16 v[172:175],a[112:115],a[16:19],v[172:175]
buffer_load_dwordx4 v1,s[12:15],s22 offen nt lds
v_mfma_f32_16x16x32_bf16 v[180:183],a[112:115],a[32:35],0
v_mfma_f32_16x16x32_bf16 v[180:183],a[116:119],a[36:39],v[180:183]
v_mfma_f32_16x16x32_bf16 v[180:183],a[120:123],a[40:43],v[180:183]
ds_read_b128 a[156:159],v5 offset:3072
v_mfma_f32_16x16x32_bf16 v[180:183],a[124:127],a[44:47],v[180:183]
v_mfma_f32_16x16x32_bf16 v[188:191],a[124:127],a[60:63],0
v_mfma_f32_16x16x32_bf16 v[188:191],a[120:123],a[56:59],v[188:191]
v_mfma_f32_16x16x32_bf16 v[188:191],a[116:119],a[52:55],v[188:191]
v_mfma_f32_16x16x32_bf16 v[188:191],a[112:115],a[48:51],v[188:191]
s_waitcnt lgkmcnt(4)
v_mfma_f32_16x16x32_bf16 v[192:195],a[128:131],a[0:3],0
v_mfma_f32_16x16x32_bf16 v[192:195],a[132:135],a[4:7],v[192:195]
v_mfma_f32_16x16x32_bf16 v[192:195],a[136:139],a[8:11],v[192:195]
v_mfma_f32_16x16x32_bf16 v[192:195],a[140:143],a[12:15],v[192:195]
buffer_load_dwordx4 v1,s[12:15],s22 offen offset:1024 nt lds
v_mfma_f32_16x16x32_bf16 v[200:203],a[140:143],a[28:31],0
v_mfma_f32_16x16x32_bf16 v[200:203],a[136:139],a[24:27],v[200:203]
ds_read_b64_tr_b16 a[96:97],v6 offset:49152
v_mfma_f32_16x16x32_bf16 v[200:203],a[132:135],a[20:23],v[200:203]
ds_read_b64_tr_b16 a[98:99],v6 offset:50176
v_mfma_f32_16x16x32_bf16 v[200:203],a[128:131],a[16:19],v[200:203]
v_mfma_f32_16x16x32_bf16 v[208:211],a[128:131],a[32:35],0
ds_read_b64_tr_b16 a[100:101],v6 offset:51200
v_mfma_f32_16x16x32_bf16 v[208:211],a[132:135],a[36:39],v[208:211]
ds_read_b64_tr_b16 a[102:103],v6 offset:52224
v_mfma_f32_16x16x32_bf16 v[208:211],a[136:139],a[40:43],v[208:211]
v_mfma_f32_16x16x32_bf16 v[208:211],a[140:143],a[44:47],v[208:211]
buffer_load_dwordx4 v1,s[12:15],s22 offen offset:2048 nt lds
v_mfma_f32_16x16x32_bf16 v[216:219],a[140:143],a[60:63],0
ds_read_b64_tr_b16 a[104:105],v6 offset:49160
v_mfma_f32_16x16x32_bf16 v[216:219],a[136:139],a[56:59],v[216:219]
ds_read_b64_tr_b16 a[106:107],v6 offset:50184
v_mfma_f32_16x16x32_bf16 v[216:219],a[132:135],a[52:55],v[216:219]
v_mfma_f32_16x16x32_bf16 v[216:219],a[128:131],a[48:51],v[216:219]
s_waitcnt lgkmcnt(6)
v_mfma_f32_16x16x32_bf16 v[196:199],a[144:147],a[0:3],0
ds_read_b64_tr_b16 a[108:109],v6 offset:51208
v_mfma_f32_16x16x32_bf16 v[196:199],a[148:151],a[4:7],v[196:199]
ds_read_b64_tr_b16 a[110:111],v6 offset:52232
v_mfma_f32_16x16x32_bf16 v[196:199],a[152:155],a[8:11],v[196:199]
v_mfma_f32_16x16x32_bf16 v[196:199],a[156:159],a[12:15],v[196:199]
ds_read_b64_tr_b16 a[112:113],v7 offset:49152
v_mfma_f32_16x16x32_bf16 v[204:207],a[156:159],a[28:31],0
ds_read_b64_tr_b16 a[114:115],v7 offset:50176
v_mfma_f32_16x16x32_bf16 v[204:207],a[152:155],a[24:27],v[204:207]
v_mfma_f32_16x16x32_bf16 v[204:207],a[148:151],a[20:23],v[204:207]
v_mfma_f32_16x16x32_bf16 v[204:207],a[144:147],a[16:19],v[204:207]
ds_read_b64_tr_b16 a[116:117],v7 offset:51200
v_mfma_f32_16x16x32_bf16 v[212:215],a[144:147],a[32:35],0
ds_read_b64_tr_b16 a[118:119],v7 offset:52224
v_mfma_f32_16x16x32_bf16 v[212:215],a[148:151],a[36:39],v[212:215]
v_mfma_f32_16x16x32_bf16 v[212:215],a[152:155],a[40:43],v[212:215]
v_mfma_f32_16x16x32_bf16 v[212:215],a[156:159],a[44:47],v[212:215]
ds_read_b64_tr_b16 a[120:121],v7 offset:49160
v_mfma_f32_16x16x32_bf16 v[220:223],a[156:159],a[60:63],0
ds_read_b64_tr_b16 a[122:123],v7 offset:50184
v_mfma_f32_16x16x32_bf16 v[220:223],a[152:155],a[56:59],v[220:223]
v_mfma_f32_16x16x32_bf16 v[220:223],a[148:151],a[52:55],v[220:223]
ds_read_b64_tr_b16 a[124:125],v7 offset:51208
v_mfma_f32_16x16x32_bf16 v[220:223],a[144:147],a[48:51],v[220:223]
s_waitcnt lgkmcnt(14)
ds_read_b64_tr_b16 a[126:127],v7 offset:52232
v_mfma_f32_16x16x32_bf16 a[224:227],a[240:243],v[224:227],a[224:227]
v_mfma_f32_16x16x32_bf16 a[224:227],a[240:243],v[228:231],a[224:227]
buffer_load_dwordx4 v1,s[12:15],s22 offen offset:3072 nt lds
v_mfma_f32_16x16x32_bf16 a[228:231],a[240:243],v[232:235],a[228:231]
s_add_u32 s22,s22,16384
s_waitcnt lgkmcnt(14)
ds_read_b64_tr_b16 a[128:129],v8 offset:49152
v_mfma_f32_16x16x32_bf16 a[228:231],a[240:243],v[236:239],a[228:231]
s_waitcnt lgkmcnt(14)
ds_read_b64_tr_b16 a[130:131],v8 offset:50176
v_mfma_f32_16x16x32_bf16 a[232:235],a[240:243],v[240:243],a[232:235]
v_mfma_f32_16x16x32_bf16 a[232:235],a[240:243],v[244:247],a[232:235]
s_waitcnt lgkmcnt(14)
v_mfma_f32_16x16x32_bf16 a[236:239],a[240:243],v[248:251],a[236:239]
ds_read_b64_tr_b16 a[132:133],v8 offset:51200
v_mfma_f32_16x16x32_bf16 a[236:239],a[240:243],v[252:255],a[236:239]
s_waitcnt lgkmcnt(14)
ds_read_b64_tr_b16 a[134:135],v8 offset:52224
v_mfma_f32_16x16x32_bf16 v[80:83],a[96:99],v[248:251],v[80:83]
v_mfma_f32_16x16x32_bf16 v[80:83],a[100:103],v[252:255],v[80:83]
s_waitcnt lgkmcnt(14)
ds_read_b64_tr_b16 a[136:137],v8 offset:49160
v_mfma_f32_16x16x32_bf16 v[64:67],a[100:103],v[244:247],v[64:67]
s_waitcnt lgkmcnt(14)
ds_read_b64_tr_b16 a[138:139],v8 offset:50184
v_mfma_f32_16x16x32_bf16 v[64:67],a[96:99],v[240:243],v[64:67]
v_mfma_f32_16x16x32_bf16 v[48:51],a[96:99],v[232:235],v[48:51]
v_mfma_f32_16x16x32_bf16 v[48:51],a[100:103],v[236:239],v[48:51]
s_waitcnt lgkmcnt(14)
ds_read_b64_tr_b16 a[140:141],v8 offset:51208
v_mfma_f32_16x16x32_bf16 v[32:35],a[100:103],v[228:231],v[32:35]
s_waitcnt lgkmcnt(14)
ds_read_b64_tr_b16 a[142:143],v8 offset:52232
v_mfma_f32_16x16x32_bf16 v[32:35],a[96:99],v[224:227],v[32:35]
v_mfma_f32_16x16x32_bf16 v[36:39],a[104:107],v[224:227],v[36:39]
v_mfma_f32_16x16x32_bf16 v[36:39],a[108:111],v[228:231],v[36:39]
s_waitcnt lgkmcnt(14)
ds_read_b64_tr_b16 a[144:145],v9 offset:49152
v_mfma_f32_16x16x32_bf16 v[52:55],a[108:111],v[236:239],v[52:55]
s_waitcnt lgkmcnt(14)
ds_read_b64_tr_b16 a[146:147],v9 offset:50176
v_mfma_f32_16x16x32_bf16 v[52:55],a[104:107],v[232:235],v[52:55]
v_mfma_f32_16x16x32_bf16 v[68:71],a[104:107],v[240:243],v[68:71]
s_waitcnt lgkmcnt(14)
ds_read_b64_tr_b16 a[148:149],v9 offset:51200
v_mfma_f32_16x16x32_bf16 v[68:71],a[108:111],v[244:247],v[68:71]
s_waitcnt lgkmcnt(14)
ds_read_b64_tr_b16 a[150:151],v9 offset:52224
v_mfma_f32_16x16x32_bf16 v[84:87],a[108:111],v[252:255],v[84:87]
v_mfma_f32_16x16x32_bf16 v[84:87],a[104:107],v[248:251],v[84:87]
v_mfma_f32_16x16x32_bf16 v[88:91],a[112:115],v[248:251],v[88:91]
s_waitcnt lgkmcnt(14)
ds_read_b64_tr_b16 a[152:153],v9 offset:49160
v_mfma_f32_16x16x32_bf16 v[88:91],a[116:119],v[252:255],v[88:91]
s_waitcnt lgkmcnt(14)
ds_read_b64_tr_b16 a[154:155],v9 offset:50184
v_mfma_f32_16x16x32_bf16 v[72:75],a[116:119],v[244:247],v[72:75]
v_mfma_f32_16x16x32_bf16 v[72:75],a[112:115],v[240:243],v[72:75]
s_waitcnt lgkmcnt(14)
ds_read_b64_tr_b16 a[156:157],v9 offset:51208
v_mfma_f32_16x16x32_bf16 v[56:59],a[112:115],v[232:235],v[56:59]
s_waitcnt lgkmcnt(14)
ds_read_b64_tr_b16 a[158:159],v9 offset:52232
v_mfma_f32_16x16x32_bf16 v[56:59],a[116:119],v[236:239],v[56:59]
v_mfma_f32_16x16x32_bf16 v[40:43],a[116:119],v[228:231],v[40:43]
v_mfma_f32_16x16x32_bf16 v[40:43],a[112:115],v[224:227],v[40:43]
v_mfma_f32_16x16x32_bf16 v[44:47],a[120:123],v[224:227],v[44:47]
v_mfma_f32_16x16x32_bf16 v[44:47],a[124:127],v[228:231],v[44:47]
v_mfma_f32_16x16x32_bf16 v[60:63],a[124:127],v[236:239],v[60:63]
v_mfma_f32_16x16x32_bf16 v[60:63],a[120:123],v[232:235],v[60:63]
v_mfma_f32_16x16x32_bf16 v[76:79],a[120:123],v[240:243],v[76:79]
v_mfma_f32_16x16x32_bf16 v[76:79],a[124:127],v[244:247],v[76:79]
v_mfma_f32_16x16x32_bf16 v[92:95],a[124:127],v[252:255],v[92:95]
v_mfma_f32_16x16x32_bf16 v[92:95],a[120:123],v[248:251],v[92:95]
s_waitcnt lgkmcnt(12)
v_mfma_f32_16x16x32_bf16 v[144:147],a[128:131],v[248:251],v[144:147]
v_mfma_f32_16x16x32_bf16 v[144:147],a[132:135],v[252:255],v[144:147]
v_mfma_f32_16x16x32_bf16 v[128:131],a[132:135],v[244:247],v[128:131]
v_mfma_f32_16x16x32_bf16 v[128:131],a[128:131],v[240:243],v[128:131]
s_waitcnt vmcnt(16)
s_waitcnt lgkmcnt(0)
s_barrier
ds_read_b128 a[96:99],v2 offset:16384
v_mfma_f32_16x16x32_bf16 v[112:115],a[128:131],v[232:235],v[112:115]
s_add_u32 m0,s25,0
v_mfma_f32_16x16x32_bf16 v[112:115],a[132:135],v[236:239],v[112:115]
buffer_load_dwordx4 v1,s[8:11],s21 offen nt lds
v_mfma_f32_16x16x32_bf16 v[96:99],a[132:135],v[228:231],v[96:99]
v_mfma_f32_16x16x32_bf16 v[96:99],a[128:131],v[224:227],v[96:99]
ds_read_b128 a[100:103],v3 offset:16384
v_mfma_f32_16x16x32_bf16 v[100:103],a[136:139],v[224:227],v[100:103]
v_mfma_f32_16x16x32_bf16 v[100:103],a[140:143],v[228:231],v[100:103]
v_mfma_f32_16x16x32_bf16 v[116:119],a[140:143],v[236:239],v[116:119]
ds_read_b128 a[104:107],v4 offset:16384
v_mfma_f32_16x16x32_bf16 v[116:119],a[136:139],v[232:235],v[116:119]
v_mfma_f32_16x16x32_bf16 v[132:135],a[136:139],v[240:243],v[132:135]
v_mfma_f32_16x16x32_bf16 v[132:135],a[140:143],v[244:247],v[132:135]
buffer_load_dwordx4 v1,s[8:11],s21 offen offset:1024 nt lds
v_mfma_f32_16x16x32_bf16 v[148:151],a[140:143],v[252:255],v[148:151]
ds_read_b128 a[108:111],v5 offset:16384
v_mfma_f32_16x16x32_bf16 v[148:151],a[136:139],v[248:251],v[148:151]
v_mfma_f32_16x16x32_bf16 v[152:155],a[144:147],v[248:251],v[152:155]
v_mfma_f32_16x16x32_bf16 v[152:155],a[148:151],v[252:255],v[152:155]
v_mfma_f32_16x16x32_bf16 v[136:139],a[148:151],v[244:247],v[136:139]
ds_read_b128 a[112:115],v2 offset:17408
v_mfma_f32_16x16x32_bf16 v[136:139],a[144:147],v[240:243],v[136:139]
v_mfma_f32_16x16x32_bf16 v[120:123],a[144:147],v[232:235],v[120:123]
v_mfma_f32_16x16x32_bf16 v[120:123],a[148:151],v[236:239],v[120:123]
ds_read_b128 a[116:119],v3 offset:17408
v_mfma_f32_16x16x32_bf16 v[104:107],a[148:151],v[228:231],v[104:107]
v_mfma_f32_16x16x32_bf16 v[104:107],a[144:147],v[224:227],v[104:107]
v_mfma_f32_16x16x32_bf16 v[108:111],a[152:155],v[224:227],v[108:111]
v_mfma_f32_16x16x32_bf16 v[108:111],a[156:159],v[228:231],v[108:111]
ds_read_b128 a[120:123],v4 offset:17408
v_mfma_f32_16x16x32_bf16 v[124:127],a[156:159],v[236:239],v[124:127]
v_mfma_f32_16x16x32_bf16 v[124:127],a[152:155],v[232:235],v[124:127]
buffer_load_dwordx4 v1,s[8:11],s21 offen offset:2048 nt lds
v_mfma_f32_16x16x32_bf16 v[140:143],a[152:155],v[240:243],v[140:143]
v_mfma_f32_16x16x32_bf16 v[140:143],a[156:159],v[244:247],v[140:143]
ds_read_b128 a[124:127],v5 offset:17408
v_mfma_f32_16x16x32_bf16 v[156:159],a[156:159],v[252:255],v[156:159]
v_mfma_f32_16x16x32_bf16 v[156:159],a[152:155],v[248:251],v[156:159]
s_waitcnt lgkmcnt(4)
v_max3_f32 v23,v160,v161,v162
v_max3_f32 v24,v168,v169,v170
v_max3_f32 v25,v176,v177,v178
v_max3_f32 v26,v184,v185,v186
v_max3_f32 v23,v23,v163,v164
v_max3_f32 v24,v24,v171,v172
v_max3_f32 v25,v25,v179,v180
v_max3_f32 v26,v26,v187,v188
v_max3_f32 v23,v23,v165,v166
v_max3_f32 v24,v24,v173,v174
v_max3_f32 v25,v25,v181,v182
v_max3_f32 v26,v26,v189,v190
v_max_f32 v23,v23,v167
v_max_f32 v24,v24,v175
v_max_f32 v25,v25,v183
v_max_f32 v26,v26,v191
v_mov_b32 v27,v23
v_mov_b32 v28,v24
v_mov_b32 v29,v25
v_mov_b32 v30,v26
v_permlane16_swap_b32 v23,v27
v_permlane16_swap_b32 v24,v28
v_permlane16_swap_b32 v25,v29
v_permlane16_swap_b32 v26,v30
v_max_f32 v23,v23,v27
v_max_f32 v24,v24,v28
v_max_f32 v25,v25,v29
v_max_f32 v26,v26,v30
v_mov_b32 v27,v23
v_mov_b32 v28,v24
v_mov_b32 v29,v25
v_mov_b32 v30,v26
v_permlane32_swap_b32 v23,v27
v_permlane32_swap_b32 v24,v28
v_permlane32_swap_b32 v25,v29
v_permlane32_swap_b32 v26,v30
v_max_f32 v23,v23,v27
v_max_f32 v24,v24,v28
v_max_f32 v25,v25,v29
v_max_f32 v26,v26,v30
v_mul_f32 v14,s26,v23
v_mul_f32 v15,s26,v24
v_mul_f32 v16,s26,v25
v_mul_f32 v17,s26,v26
v_max3_f32 v23,v192,v193,v194
v_max3_f32 v24,v200,v201,v202
v_max3_f32 v25,v208,v209,v210
v_max3_f32 v26,v216,v217,v218
v_max3_f32 v23,v23,v195,v196
v_max3_f32 v24,v24,v203,v204
v_max3_f32 v25,v25,v211,v212
v_max3_f32 v26,v26,v219,v220
v_max3_f32 v23,v23,v197,v198
v_max3_f32 v24,v24,v205,v206
v_max3_f32 v25,v25,v213,v214
v_max3_f32 v26,v26,v221,v222
v_max_f32 v23,v23,v199
v_max_f32 v24,v24,v207
v_max_f32 v25,v25,v215
v_max_f32 v26,v26,v223
v_mov_b32 v27,v23
v_mov_b32 v28,v24
v_mov_b32 v29,v25
v_mov_b32 v30,v26
v_permlane16_swap_b32 v23,v27
v_permlane16_swap_b32 v24,v28
v_permlane16_swap_b32 v25,v29
v_permlane16_swap_b32 v26,v30
v_max_f32 v23,v23,v27
v_max_f32 v24,v24,v28
v_max_f32 v25,v25,v29
v_max_f32 v26,v26,v30
v_mov_b32 v27,v23
v_mov_b32 v28,v24
v_mov_b32 v29,v25
v_mov_b32 v30,v26
v_permlane32_swap_b32 v23,v27
v_permlane32_swap_b32 v24,v28
v_permlane32_swap_b32 v25,v29
v_permlane32_swap_b32 v26,v30
v_max_f32 v23,v23,v27
v_max_f32 v24,v24,v28
v_max_f32 v25,v25,v29
v_max_f32 v26,v26,v30
v_mul_f32 v27,s26,v23
v_mul_f32 v28,s26,v24
v_mul_f32 v29,s26,v25
v_mul_f32 v30,s26,v26
v_max3_f32 v14,v14,v27,v18
v_max3_f32 v15,v15,v28,v19
v_max3_f32 v16,v16,v29,v20
v_max3_f32 v17,v17,v30,v21
v_sub_f32 v23,v18,v14
v_sub_f32 v24,v19,v15
v_sub_f32 v25,v20,v16
v_sub_f32 v26,v21,v17
v_exp_f32 v23,v23
v_exp_f32 v24,v24
v_exp_f32 v25,v25
v_exp_f32 v26,v26
v_mov_b32 v18,v14
v_mov_b32 v19,v15
v_mov_b32 v20,v16
v_mov_b32 v21,v17
v_accvgpr_read_b32 v27,a224
v_accvgpr_read_b32 v28,a228
v_accvgpr_read_b32 v29,a232
v_accvgpr_read_b32 v30,a236
v_mul_f32 v27,v27,v23
v_mul_f32 v28,v28,v24
v_mul_f32 v29,v29,v25
v_mul_f32 v30,v30,v26
v_accvgpr_write_b32 a224,v27
v_accvgpr_write_b32 a228,v28
v_accvgpr_write_b32 a232,v29
v_accvgpr_write_b32 a236,v30
v_mul_f32 v32,v32,v23
v_mul_f32 v33,v33,v23
v_mul_f32 v34,v34,v23
v_mul_f32 v35,v35,v23
v_mul_f32 v36,v36,v23
v_mul_f32 v37,v37,v23
v_mul_f32 v38,v38,v23
v_mul_f32 v39,v39,v23
v_mul_f32 v40,v40,v23
v_mul_f32 v41,v41,v23
v_mul_f32 v42,v42,v23
v_mul_f32 v43,v43,v23
v_mul_f32 v44,v44,v23
v_mul_f32 v45,v45,v23
v_mul_f32 v46,v46,v23
v_mul_f32 v47,v47,v23
v_mul_f32 v96,v96,v23
v_mul_f32 v97,v97,v23
v_mul_f32 v98,v98,v23
v_mul_f32 v99,v99,v23
v_mul_f32 v100,v100,v23
v_mul_f32 v101,v101,v23
v_mul_f32 v102,v102,v23
v_mul_f32 v103,v103,v23
v_mul_f32 v104,v104,v23
v_mul_f32 v105,v105,v23
v_mul_f32 v106,v106,v23
v_mul_f32 v107,v107,v23
v_mul_f32 v108,v108,v23
v_mul_f32 v109,v109,v23
v_mul_f32 v110,v110,v23
v_mul_f32 v111,v111,v23
v_mul_f32 v48,v48,v24
v_mul_f32 v49,v49,v24
v_mul_f32 v50,v50,v24
v_mul_f32 v51,v51,v24
v_mul_f32 v52,v52,v24
v_mul_f32 v53,v53,v24
v_mul_f32 v54,v54,v24
v_mul_f32 v55,v55,v24
v_mul_f32 v56,v56,v24
v_mul_f32 v57,v57,v24
v_mul_f32 v58,v58,v24
v_mul_f32 v59,v59,v24
v_mul_f32 v60,v60,v24
v_mul_f32 v61,v61,v24
v_mul_f32 v62,v62,v24
v_mul_f32 v63,v63,v24
v_mul_f32 v112,v112,v24
v_mul_f32 v113,v113,v24
v_mul_f32 v114,v114,v24
v_mul_f32 v115,v115,v24
v_mul_f32 v116,v116,v24
v_mul_f32 v117,v117,v24
v_mul_f32 v118,v118,v24
v_mul_f32 v119,v119,v24
v_mul_f32 v120,v120,v24
v_mul_f32 v121,v121,v24
v_mul_f32 v122,v122,v24
v_mul_f32 v123,v123,v24
v_mul_f32 v124,v124,v24
v_mul_f32 v125,v125,v24
v_mul_f32 v126,v126,v24
v_mul_f32 v127,v127,v24
v_mul_f32 v64,v64,v25
v_mul_f32 v65,v65,v25
v_mul_f32 v66,v66,v25
v_mul_f32 v67,v67,v25
v_mul_f32 v68,v68,v25
v_mul_f32 v69,v69,v25
v_mul_f32 v70,v70,v25
v_mul_f32 v71,v71,v25
v_mul_f32 v72,v72,v25
v_mul_f32 v73,v73,v25
v_mul_f32 v74,v74,v25
v_mul_f32 v75,v75,v25
v_mul_f32 v76,v76,v25
v_mul_f32 v77,v77,v25
v_mul_f32 v78,v78,v25
v_mul_f32 v79,v79,v25
v_mul_f32 v128,v128,v25
v_mul_f32 v129,v129,v25
v_mul_f32 v130,v130,v25
v_mul_f32 v131,v131,v25
v_mul_f32 v132,v132,v25
v_mul_f32 v133,v133,v25
v_mul_f32 v134,v134,v25
v_mul_f32 v135,v135,v25
v_mul_f32 v136,v136,v25
v_mul_f32 v137,v137,v25
v_mul_f32 v138,v138,v25
v_mul_f32 v139,v139,v25
v_mul_f32 v140,v140,v25
v_mul_f32 v141,v141,v25
v_mul_f32 v142,v142,v25
v_mul_f32 v143,v143,v25
v_mul_f32 v80,v80,v26
v_mul_f32 v81,v81,v26
v_mul_f32 v82,v82,v26
v_mul_f32 v83,v83,v26
v_mul_f32 v84,v84,v26
v_mul_f32 v85,v85,v26
v_mul_f32 v86,v86,v26
v_mul_f32 v87,v87,v26
v_mul_f32 v88,v88,v26
v_mul_f32 v89,v89,v26
v_mul_f32 v90,v90,v26
v_mul_f32 v91,v91,v26
v_mul_f32 v92,v92,v26
v_mul_f32 v93,v93,v26
v_mul_f32 v94,v94,v26
v_mul_f32 v95,v95,v26
v_mul_f32 v144,v144,v26
v_mul_f32 v145,v145,v26
v_mul_f32 v146,v146,v26
v_mul_f32 v147,v147,v26
v_mul_f32 v148,v148,v26
v_mul_f32 v149,v149,v26
v_mul_f32 v150,v150,v26
v_mul_f32 v151,v151,v26
v_mul_f32 v152,v152,v26
v_mul_f32 v153,v153,v26
v_mul_f32 v154,v154,v26
v_mul_f32 v155,v155,v26
v_mul_f32 v156,v156,v26
v_mul_f32 v157,v157,v26
v_mul_f32 v158,v158,v26
v_mul_f32 v159,v159,v26
v_fma_f32 v160,v160,s26,-v18
v_fma_f32 v161,v161,s26,-v18
v_fma_f32 v162,v162,s26,-v18
v_fma_f32 v163,v163,s26,-v18
v_fma_f32 v164,v164,s26,-v18
v_fma_f32 v165,v165,s26,-v18
v_fma_f32 v166,v166,s26,-v18
v_fma_f32 v167,v167,s26,-v18
v_fma_f32 v168,v168,s26,-v19
v_fma_f32 v169,v169,s26,-v19
v_fma_f32 v170,v170,s26,-v19
v_fma_f32 v171,v171,s26,-v19
v_fma_f32 v172,v172,s26,-v19
v_fma_f32 v173,v173,s26,-v19
v_fma_f32 v174,v174,s26,-v19
v_fma_f32 v175,v175,s26,-v19
v_fma_f32 v176,v176,s26,-v20
v_fma_f32 v177,v177,s26,-v20
v_fma_f32 v178,v178,s26,-v20
v_fma_f32 v179,v179,s26,-v20
v_fma_f32 v180,v180,s26,-v20
v_fma_f32 v181,v181,s26,-v20
v_fma_f32 v182,v182,s26,-v20
v_fma_f32 v183,v183,s26,-v20
v_fma_f32 v184,v184,s26,-v21
v_fma_f32 v185,v185,s26,-v21
v_fma_f32 v186,v186,s26,-v21
v_fma_f32 v187,v187,s26,-v21
v_fma_f32 v188,v188,s26,-v21
v_fma_f32 v189,v189,s26,-v21
v_fma_f32 v190,v190,s26,-v21
v_fma_f32 v191,v191,s26,-v21
v_exp_f32 v160,v160
v_exp_f32 v161,v161
v_exp_f32 v162,v162
v_exp_f32 v163,v163
v_exp_f32 v164,v164
v_exp_f32 v165,v165
v_exp_f32 v166,v166
v_exp_f32 v167,v167
v_exp_f32 v168,v168
v_exp_f32 v169,v169
v_exp_f32 v170,v170
v_exp_f32 v171,v171
v_exp_f32 v172,v172
v_exp_f32 v173,v173
v_exp_f32 v174,v174
v_exp_f32 v175,v175
v_exp_f32 v176,v176
v_exp_f32 v177,v177
v_exp_f32 v178,v178
v_exp_f32 v179,v179
v_exp_f32 v180,v180
v_exp_f32 v181,v181
v_exp_f32 v182,v182
v_exp_f32 v183,v183
v_exp_f32 v184,v184
v_exp_f32 v185,v185
v_exp_f32 v186,v186
v_exp_f32 v187,v187
v_exp_f32 v188,v188
v_exp_f32 v189,v189
v_exp_f32 v190,v190
v_exp_f32 v191,v191
v_cvt_pk_bf16_f32 v160,v160,v161
v_cvt_pk_bf16_f32 v161,v162,v163
v_cvt_pk_bf16_f32 v162,v164,v165
v_cvt_pk_bf16_f32 v163,v166,v167
v_cvt_pk_bf16_f32 v168,v168,v169
v_cvt_pk_bf16_f32 v169,v170,v171
v_cvt_pk_bf16_f32 v170,v172,v173
v_cvt_pk_bf16_f32 v171,v174,v175
v_cvt_pk_bf16_f32 v176,v176,v177
v_cvt_pk_bf16_f32 v177,v178,v179
v_cvt_pk_bf16_f32 v178,v180,v181
v_cvt_pk_bf16_f32 v179,v182,v183
v_cvt_pk_bf16_f32 v184,v184,v185
v_cvt_pk_bf16_f32 v185,v186,v187
v_cvt_pk_bf16_f32 v186,v188,v189
v_cvt_pk_bf16_f32 v187,v190,v191
v_fma_f32 v192,v192,s26,-v18
v_fma_f32 v193,v193,s26,-v18
v_fma_f32 v194,v194,s26,-v18
v_fma_f32 v195,v195,s26,-v18
v_fma_f32 v196,v196,s26,-v18
v_fma_f32 v197,v197,s26,-v18
v_fma_f32 v198,v198,s26,-v18
v_fma_f32 v199,v199,s26,-v18
v_fma_f32 v200,v200,s26,-v19
v_fma_f32 v201,v201,s26,-v19
v_fma_f32 v202,v202,s26,-v19
v_fma_f32 v203,v203,s26,-v19
v_fma_f32 v204,v204,s26,-v19
v_fma_f32 v205,v205,s26,-v19
v_fma_f32 v206,v206,s26,-v19
v_fma_f32 v207,v207,s26,-v19
v_fma_f32 v208,v208,s26,-v20
v_fma_f32 v209,v209,s26,-v20
v_fma_f32 v210,v210,s26,-v20
v_fma_f32 v211,v211,s26,-v20
v_fma_f32 v212,v212,s26,-v20
v_fma_f32 v213,v213,s26,-v20
v_fma_f32 v214,v214,s26,-v20
v_fma_f32 v215,v215,s26,-v20
v_fma_f32 v216,v216,s26,-v21
v_fma_f32 v217,v217,s26,-v21
v_fma_f32 v218,v218,s26,-v21
v_fma_f32 v219,v219,s26,-v21
v_fma_f32 v220,v220,s26,-v21
v_fma_f32 v221,v221,s26,-v21
v_fma_f32 v222,v222,s26,-v21
v_fma_f32 v223,v223,s26,-v21
v_exp_f32 v192,v192
v_exp_f32 v193,v193
v_exp_f32 v194,v194
v_exp_f32 v195,v195
v_exp_f32 v196,v196
v_exp_f32 v197,v197
v_exp_f32 v198,v198
v_exp_f32 v199,v199
v_exp_f32 v200,v200
v_exp_f32 v201,v201
v_exp_f32 v202,v202
v_exp_f32 v203,v203
v_exp_f32 v204,v204
v_exp_f32 v205,v205
v_exp_f32 v206,v206
v_exp_f32 v207,v207
v_exp_f32 v208,v208
v_exp_f32 v209,v209
v_exp_f32 v210,v210
v_exp_f32 v211,v211
v_exp_f32 v212,v212
v_exp_f32 v213,v213
v_exp_f32 v214,v214
v_exp_f32 v215,v215
v_exp_f32 v216,v216
v_exp_f32 v217,v217
v_exp_f32 v218,v218
v_exp_f32 v219,v219
v_exp_f32 v220,v220
v_exp_f32 v221,v221
v_exp_f32 v222,v222
v_exp_f32 v223,v223
v_cvt_pk_bf16_f32 v164,v192,v193
v_cvt_pk_bf16_f32 v165,v194,v195
v_cvt_pk_bf16_f32 v166,v196,v197
v_cvt_pk_bf16_f32 v167,v198,v199
v_cvt_pk_bf16_f32 v172,v200,v201
v_cvt_pk_bf16_f32 v173,v202,v203
v_cvt_pk_bf16_f32 v174,v204,v205
v_cvt_pk_bf16_f32 v175,v206,v207
v_cvt_pk_bf16_f32 v180,v208,v209
v_cvt_pk_bf16_f32 v181,v210,v211
v_cvt_pk_bf16_f32 v182,v212,v213
v_cvt_pk_bf16_f32 v183,v214,v215
v_cvt_pk_bf16_f32 v188,v216,v217
v_cvt_pk_bf16_f32 v189,v218,v219
v_cvt_pk_bf16_f32 v190,v220,v221
v_cvt_pk_bf16_f32 v191,v222,v223
v_mfma_f32_16x16x32_bf16 v[224:227],a[96:99],a[0:3],0
ds_read_b128 a[128:131],v2 offset:18432
v_mfma_f32_16x16x32_bf16 v[224:227],a[100:103],a[4:7],v[224:227]
v_mfma_f32_16x16x32_bf16 v[224:227],a[104:107],a[8:11],v[224:227]
v_mfma_f32_16x16x32_bf16 v[224:227],a[108:111],a[12:15],v[224:227]
buffer_load_dwordx4 v1,s[8:11],s21 offen offset:3072 nt lds
v_mfma_f32_16x16x32_bf16 v[232:235],a[108:111],a[28:31],0
s_add_u32 s21,s21,16384
ds_read_b128 a[132:135],v3 offset:18432
v_mfma_f32_16x16x32_bf16 v[232:235],a[104:107],a[24:27],v[232:235]
v_mfma_f32_16x16x32_bf16 v[232:235],a[100:103],a[20:23],v[232:235]
v_mfma_f32_16x16x32_bf16 v[232:235],a[96:99],a[16:19],v[232:235]
v_mfma_f32_16x16x32_bf16 v[240:243],a[96:99],a[32:35],0
ds_read_b128 a[136:139],v4 offset:18432
v_mfma_f32_16x16x32_bf16 v[240:243],a[100:103],a[36:39],v[240:243]
v_mfma_f32_16x16x32_bf16 v[240:243],a[104:107],a[40:43],v[240:243]
v_mfma_f32_16x16x32_bf16 v[240:243],a[108:111],a[44:47],v[240:243]
ds_read_b128 a[140:143],v5 offset:18432
v_mfma_f32_16x16x32_bf16 v[248:251],a[108:111],a[60:63],0
v_mfma_f32_16x16x32_bf16 v[248:251],a[104:107],a[56:59],v[248:251]
v_mfma_f32_16x16x32_bf16 v[248:251],a[100:103],a[52:55],v[248:251]
s_waitcnt lgkmcnt(4)
v_mfma_f32_16x16x32_bf16 v[248:251],a[96:99],a[48:51],v[248:251]
ds_read_b128 a[144:147],v2 offset:19456
v_mfma_f32_16x16x32_bf16 v[228:231],a[112:115],a[0:3],0
v_mfma_f32_16x16x32_bf16 v[228:231],a[116:119],a[4:7],v[228:231]
v_mfma_f32_16x16x32_bf16 v[228:231],a[120:123],a[8:11],v[228:231]
v_mfma_f32_16x16x32_bf16 v[228:231],a[124:127],a[12:15],v[228:231]
ds_read_b128 a[148:151],v3 offset:19456
v_mfma_f32_16x16x32_bf16 v[236:239],a[124:127],a[28:31],0
v_mfma_f32_16x16x32_bf16 v[236:239],a[120:123],a[24:27],v[236:239]
v_mfma_f32_16x16x32_bf16 v[236:239],a[116:119],a[20:23],v[236:239]
s_add_u32 m0,s25,114688
ds_read_b128 a[152:155],v4 offset:19456
v_mfma_f32_16x16x32_bf16 v[236:239],a[112:115],a[16:19],v[236:239]
buffer_load_dwordx4 v1,s[12:15],s22 offen nt lds
v_mfma_f32_16x16x32_bf16 v[244:247],a[112:115],a[32:35],0
v_mfma_f32_16x16x32_bf16 v[244:247],a[116:119],a[36:39],v[244:247]
v_mfma_f32_16x16x32_bf16 v[244:247],a[120:123],a[40:43],v[244:247]
ds_read_b128 a[156:159],v5 offset:19456
v_mfma_f32_16x16x32_bf16 v[244:247],a[124:127],a[44:47],v[244:247]
v_mfma_f32_16x16x32_bf16 v[252:255],a[124:127],a[60:63],0
v_mfma_f32_16x16x32_bf16 v[252:255],a[120:123],a[56:59],v[252:255]
v_mfma_f32_16x16x32_bf16 v[252:255],a[116:119],a[52:55],v[252:255]
v_mfma_f32_16x16x32_bf16 v[252:255],a[112:115],a[48:51],v[252:255]
s_waitcnt lgkmcnt(4)
v_mfma_f32_16x16x32_bf16 v[192:195],a[128:131],a[0:3],0
v_mfma_f32_16x16x32_bf16 v[192:195],a[132:135],a[4:7],v[192:195]
v_mfma_f32_16x16x32_bf16 v[192:195],a[136:139],a[8:11],v[192:195]
v_mfma_f32_16x16x32_bf16 v[192:195],a[140:143],a[12:15],v[192:195]
buffer_load_dwordx4 v1,s[12:15],s22 offen offset:1024 nt lds
v_mfma_f32_16x16x32_bf16 v[200:203],a[140:143],a[28:31],0
v_mfma_f32_16x16x32_bf16 v[200:203],a[136:139],a[24:27],v[200:203]
ds_read_b64_tr_b16 a[96:97],v6 offset:0
v_mfma_f32_16x16x32_bf16 v[200:203],a[132:135],a[20:23],v[200:203]
ds_read_b64_tr_b16 a[98:99],v6 offset:1024
v_mfma_f32_16x16x32_bf16 v[200:203],a[128:131],a[16:19],v[200:203]
v_mfma_f32_16x16x32_bf16 v[208:211],a[128:131],a[32:35],0
ds_read_b64_tr_b16 a[100:101],v6 offset:2048
v_mfma_f32_16x16x32_bf16 v[208:211],a[132:135],a[36:39],v[208:211]
ds_read_b64_tr_b16 a[102:103],v6 offset:3072
v_mfma_f32_16x16x32_bf16 v[208:211],a[136:139],a[40:43],v[208:211]
v_mfma_f32_16x16x32_bf16 v[208:211],a[140:143],a[44:47],v[208:211]
buffer_load_dwordx4 v1,s[12:15],s22 offen offset:2048 nt lds
v_mfma_f32_16x16x32_bf16 v[216:219],a[140:143],a[60:63],0
ds_read_b64_tr_b16 a[104:105],v6 offset:8
v_mfma_f32_16x16x32_bf16 v[216:219],a[136:139],a[56:59],v[216:219]
ds_read_b64_tr_b16 a[106:107],v6 offset:1032
v_mfma_f32_16x16x32_bf16 v[216:219],a[132:135],a[52:55],v[216:219]
v_mfma_f32_16x16x32_bf16 v[216:219],a[128:131],a[48:51],v[216:219]
s_waitcnt lgkmcnt(6)
v_mfma_f32_16x16x32_bf16 v[196:199],a[144:147],a[0:3],0
ds_read_b64_tr_b16 a[108:109],v6 offset:2056
v_mfma_f32_16x16x32_bf16 v[196:199],a[148:151],a[4:7],v[196:199]
ds_read_b64_tr_b16 a[110:111],v6 offset:3080
v_mfma_f32_16x16x32_bf16 v[196:199],a[152:155],a[8:11],v[196:199]
v_mfma_f32_16x16x32_bf16 v[196:199],a[156:159],a[12:15],v[196:199]
ds_read_b64_tr_b16 a[112:113],v7 offset:0
v_mfma_f32_16x16x32_bf16 v[204:207],a[156:159],a[28:31],0
ds_read_b64_tr_b16 a[114:115],v7 offset:1024
v_mfma_f32_16x16x32_bf16 v[204:207],a[152:155],a[24:27],v[204:207]
v_mfma_f32_16x16x32_bf16 v[204:207],a[148:151],a[20:23],v[204:207]
v_mfma_f32_16x16x32_bf16 v[204:207],a[144:147],a[16:19],v[204:207]
ds_read_b64_tr_b16 a[116:117],v7 offset:2048
v_mfma_f32_16x16x32_bf16 v[212:215],a[144:147],a[32:35],0
ds_read_b64_tr_b16 a[118:119],v7 offset:3072
v_mfma_f32_16x16x32_bf16 v[212:215],a[148:151],a[36:39],v[212:215]
v_mfma_f32_16x16x32_bf16 v[212:215],a[152:155],a[40:43],v[212:215]
v_mfma_f32_16x16x32_bf16 v[212:215],a[156:159],a[44:47],v[212:215]
ds_read_b64_tr_b16 a[120:121],v7 offset:8
v_mfma_f32_16x16x32_bf16 v[220:223],a[156:159],a[60:63],0
ds_read_b64_tr_b16 a[122:123],v7 offset:1032
v_mfma_f32_16x16x32_bf16 v[220:223],a[152:155],a[56:59],v[220:223]
v_mfma_f32_16x16x32_bf16 v[220:223],a[148:151],a[52:55],v[220:223]
ds_read_b64_tr_b16 a[124:125],v7 offset:2056
v_mfma_f32_16x16x32_bf16 v[220:223],a[144:147],a[48:51],v[220:223]
s_waitcnt lgkmcnt(14)
ds_read_b64_tr_b16 a[126:127],v7 offset:3080
v_mfma_f32_16x16x32_bf16 a[224:227],a[240:243],v[160:163],a[224:227]
v_mfma_f32_16x16x32_bf16 a[224:227],a[240:243],v[164:167],a[224:227]
buffer_load_dwordx4 v1,s[12:15],s22 offen offset:3072 nt lds
v_mfma_f32_16x16x32_bf16 a[228:231],a[240:243],v[168:171],a[228:231]
s_add_u32 s22,s22,16384
s_waitcnt lgkmcnt(14)
ds_read_b64_tr_b16 a[128:129],v8 offset:0
v_mfma_f32_16x16x32_bf16 a[228:231],a[240:243],v[172:175],a[228:231]
s_waitcnt lgkmcnt(14)
ds_read_b64_tr_b16 a[130:131],v8 offset:1024
v_mfma_f32_16x16x32_bf16 a[232:235],a[240:243],v[176:179],a[232:235]
v_mfma_f32_16x16x32_bf16 a[232:235],a[240:243],v[180:183],a[232:235]
s_waitcnt lgkmcnt(14)
v_mfma_f32_16x16x32_bf16 a[236:239],a[240:243],v[184:187],a[236:239]
ds_read_b64_tr_b16 a[132:133],v8 offset:2048
v_mfma_f32_16x16x32_bf16 a[236:239],a[240:243],v[188:191],a[236:239]
s_waitcnt lgkmcnt(14)
ds_read_b64_tr_b16 a[134:135],v8 offset:3072
v_mfma_f32_16x16x32_bf16 v[80:83],a[96:99],v[184:187],v[80:83]
v_mfma_f32_16x16x32_bf16 v[80:83],a[100:103],v[188:191],v[80:83]
s_waitcnt lgkmcnt(14)
ds_read_b64_tr_b16 a[136:137],v8 offset:8
v_mfma_f32_16x16x32_bf16 v[64:67],a[100:103],v[180:183],v[64:67]
s_waitcnt lgkmcnt(14)
ds_read_b64_tr_b16 a[138:139],v8 offset:1032
v_mfma_f32_16x16x32_bf16 v[64:67],a[96:99],v[176:179],v[64:67]
v_mfma_f32_16x16x32_bf16 v[48:51],a[96:99],v[168:171],v[48:51]
v_mfma_f32_16x16x32_bf16 v[48:51],a[100:103],v[172:175],v[48:51]
s_waitcnt lgkmcnt(14)
ds_read_b64_tr_b16 a[140:141],v8 offset:2056
v_mfma_f32_16x16x32_bf16 v[32:35],a[100:103],v[164:167],v[32:35]
s_waitcnt lgkmcnt(14)
ds_read_b64_tr_b16 a[142:143],v8 offset:3080
v_mfma_f32_16x16x32_bf16 v[32:35],a[96:99],v[160:163],v[32:35]
v_mfma_f32_16x16x32_bf16 v[36:39],a[104:107],v[160:163],v[36:39]
v_mfma_f32_16x16x32_bf16 v[36:39],a[108:111],v[164:167],v[36:39]
s_waitcnt lgkmcnt(14)
ds_read_b64_tr_b16 a[144:145],v9 offset:0
v_mfma_f32_16x16x32_bf16 v[52:55],a[108:111],v[172:175],v[52:55]
s_waitcnt lgkmcnt(14)
ds_read_b64_tr_b16 a[146:147],v9 offset:1024
v_mfma_f32_16x16x32_bf16 v[52:55],a[104:107],v[168:171],v[52:55]
v_mfma_f32_16x16x32_bf16 v[68:71],a[104:107],v[176:179],v[68:71]
s_waitcnt lgkmcnt(14)
ds_read_b64_tr_b16 a[148:149],v9 offset:2048
v_mfma_f32_16x16x32_bf16 v[68:71],a[108:111],v[180:183],v[68:71]
s_waitcnt lgkmcnt(14)
ds_read_b64_tr_b16 a[150:151],v9 offset:3072
v_mfma_f32_16x16x32_bf16 v[84:87],a[108:111],v[188:191],v[84:87]
v_mfma_f32_16x16x32_bf16 v[84:87],a[104:107],v[184:187],v[84:87]
v_mfma_f32_16x16x32_bf16 v[88:91],a[112:115],v[184:187],v[88:91]
s_waitcnt lgkmcnt(14)
ds_read_b64_tr_b16 a[152:153],v9 offset:8
v_mfma_f32_16x16x32_bf16 v[88:91],a[116:119],v[188:191],v[88:91]
s_waitcnt lgkmcnt(14)
ds_read_b64_tr_b16 a[154:155],v9 offset:1032
v_mfma_f32_16x16x32_bf16 v[72:75],a[116:119],v[180:183],v[72:75]
v_mfma_f32_16x16x32_bf16 v[72:75],a[112:115],v[176:179],v[72:75]
s_waitcnt lgkmcnt(14)
ds_read_b64_tr_b16 a[156:157],v9 offset:2056
v_mfma_f32_16x16x32_bf16 v[56:59],a[112:115],v[168:171],v[56:59]
s_waitcnt lgkmcnt(14)
ds_read_b64_tr_b16 a[158:159],v9 offset:3080
v_mfma_f32_16x16x32_bf16 v[56:59],a[116:119],v[172:175],v[56:59]
v_mfma_f32_16x16x32_bf16 v[40:43],a[116:119],v[164:167],v[40:43]
v_mfma_f32_16x16x32_bf16 v[40:43],a[112:115],v[160:163],v[40:43]
v_mfma_f32_16x16x32_bf16 v[44:47],a[120:123],v[160:163],v[44:47]
v_mfma_f32_16x16x32_bf16 v[44:47],a[124:127],v[164:167],v[44:47]
v_mfma_f32_16x16x32_bf16 v[60:63],a[124:127],v[172:175],v[60:63]
v_mfma_f32_16x16x32_bf16 v[60:63],a[120:123],v[168:171],v[60:63]
v_mfma_f32_16x16x32_bf16 v[76:79],a[120:123],v[176:179],v[76:79]
v_mfma_f32_16x16x32_bf16 v[76:79],a[124:127],v[180:183],v[76:79]
v_mfma_f32_16x16x32_bf16 v[92:95],a[124:127],v[188:191],v[92:95]
v_mfma_f32_16x16x32_bf16 v[92:95],a[120:123],v[184:187],v[92:95]
s_waitcnt lgkmcnt(12)
v_mfma_f32_16x16x32_bf16 v[144:147],a[128:131],v[184:187],v[144:147]
v_mfma_f32_16x16x32_bf16 v[144:147],a[132:135],v[188:191],v[144:147]
v_mfma_f32_16x16x32_bf16 v[128:131],a[132:135],v[180:183],v[128:131]
v_mfma_f32_16x16x32_bf16 v[128:131],a[128:131],v[176:179],v[128:131]
s_waitcnt vmcnt(16)
s_waitcnt lgkmcnt(0)
s_barrier
ds_read_b128 a[96:99],v2 offset:32768
v_mfma_f32_16x16x32_bf16 v[112:115],a[128:131],v[168:171],v[112:115]
s_add_u32 m0,s25,16384
v_mfma_f32_16x16x32_bf16 v[112:115],a[132:135],v[172:175],v[112:115]
buffer_load_dwordx4 v1,s[8:11],s21 offen nt lds
v_mfma_f32_16x16x32_bf16 v[96:99],a[132:135],v[164:167],v[96:99]
v_mfma_f32_16x16x32_bf16 v[96:99],a[128:131],v[160:163],v[96:99]
ds_read_b128 a[100:103],v3 offset:32768
v_mfma_f32_16x16x32_bf16 v[100:103],a[136:139],v[160:163],v[100:103]
v_mfma_f32_16x16x32_bf16 v[100:103],a[140:143],v[164:167],v[100:103]
v_mfma_f32_16x16x32_bf16 v[116:119],a[140:143],v[172:175],v[116:119]
ds_read_b128 a[104:107],v4 offset:32768
v_mfma_f32_16x16x32_bf16 v[116:119],a[136:139],v[168:171],v[116:119]
v_mfma_f32_16x16x32_bf16 v[132:135],a[136:139],v[176:179],v[132:135]
v_mfma_f32_16x16x32_bf16 v[132:135],a[140:143],v[180:183],v[132:135]
buffer_load_dwordx4 v1,s[8:11],s21 offen offset:1024 nt lds
v_mfma_f32_16x16x32_bf16 v[148:151],a[140:143],v[188:191],v[148:151]
ds_read_b128 a[108:111],v5 offset:32768
v_mfma_f32_16x16x32_bf16 v[148:151],a[136:139],v[184:187],v[148:151]
v_mfma_f32_16x16x32_bf16 v[152:155],a[144:147],v[184:187],v[152:155]
v_mfma_f32_16x16x32_bf16 v[152:155],a[148:151],v[188:191],v[152:155]
v_mfma_f32_16x16x32_bf16 v[136:139],a[148:151],v[180:183],v[136:139]
ds_read_b128 a[112:115],v2 offset:33792
v_mfma_f32_16x16x32_bf16 v[136:139],a[144:147],v[176:179],v[136:139]
v_mfma_f32_16x16x32_bf16 v[120:123],a[144:147],v[168:171],v[120:123]
v_mfma_f32_16x16x32_bf16 v[120:123],a[148:151],v[172:175],v[120:123]
ds_read_b128 a[116:119],v3 offset:33792
v_mfma_f32_16x16x32_bf16 v[104:107],a[148:151],v[164:167],v[104:107]
v_mfma_f32_16x16x32_bf16 v[104:107],a[144:147],v[160:163],v[104:107]
v_mfma_f32_16x16x32_bf16 v[108:111],a[152:155],v[160:163],v[108:111]
v_mfma_f32_16x16x32_bf16 v[108:111],a[156:159],v[164:167],v[108:111]
ds_read_b128 a[120:123],v4 offset:33792
v_mfma_f32_16x16x32_bf16 v[124:127],a[156:159],v[172:175],v[124:127]
v_mfma_f32_16x16x32_bf16 v[124:127],a[152:155],v[168:171],v[124:127]
buffer_load_dwordx4 v1,s[8:11],s21 offen offset:2048 nt lds
v_mfma_f32_16x16x32_bf16 v[140:143],a[152:155],v[176:179],v[140:143]
v_mfma_f32_16x16x32_bf16 v[140:143],a[156:159],v[180:183],v[140:143]
ds_read_b128 a[124:127],v5 offset:33792
v_mfma_f32_16x16x32_bf16 v[156:159],a[156:159],v[188:191],v[156:159]
v_mfma_f32_16x16x32_bf16 v[156:159],a[152:155],v[184:187],v[156:159]
s_waitcnt lgkmcnt(4)
v_max3_f32 v23,v224,v225,v226
v_max3_f32 v24,v232,v233,v234
v_max3_f32 v25,v240,v241,v242
v_max3_f32 v26,v248,v249,v250
v_max3_f32 v23,v23,v227,v228
v_max3_f32 v24,v24,v235,v236
v_max3_f32 v25,v25,v243,v244
v_max3_f32 v26,v26,v251,v252
v_max3_f32 v23,v23,v229,v230
v_max3_f32 v24,v24,v237,v238
v_max3_f32 v25,v25,v245,v246
v_max3_f32 v26,v26,v253,v254
v_max_f32 v23,v23,v231
v_max_f32 v24,v24,v239
v_max_f32 v25,v25,v247
v_max_f32 v26,v26,v255
v_mov_b32 v27,v23
v_mov_b32 v28,v24
v_mov_b32 v29,v25
v_mov_b32 v30,v26
v_permlane16_swap_b32 v23,v27
v_permlane16_swap_b32 v24,v28
v_permlane16_swap_b32 v25,v29
v_permlane16_swap_b32 v26,v30
v_max_f32 v23,v23,v27
v_max_f32 v24,v24,v28
v_max_f32 v25,v25,v29
v_max_f32 v26,v26,v30
v_mov_b32 v27,v23
v_mov_b32 v28,v24
v_mov_b32 v29,v25
v_mov_b32 v30,v26
v_permlane32_swap_b32 v23,v27
v_permlane32_swap_b32 v24,v28
v_permlane32_swap_b32 v25,v29
v_permlane32_swap_b32 v26,v30
v_max_f32 v23,v23,v27
v_max_f32 v24,v24,v28
v_max_f32 v25,v25,v29
v_max_f32 v26,v26,v30
v_mul_f32 v14,s26,v23
v_mul_f32 v15,s26,v24
v_mul_f32 v16,s26,v25
v_mul_f32 v17,s26,v26
v_max3_f32 v23,v192,v193,v194
v_max3_f32 v24,v200,v201,v202
v_max3_f32 v25,v208,v209,v210
v_max3_f32 v26,v216,v217,v218
v_max3_f32 v23,v23,v195,v196
v_max3_f32 v24,v24,v203,v204
v_max3_f32 v25,v25,v211,v212
v_max3_f32 v26,v26,v219,v220
v_max3_f32 v23,v23,v197,v198
v_max3_f32 v24,v24,v205,v206
v_max3_f32 v25,v25,v213,v214
v_max3_f32 v26,v26,v221,v222
v_max_f32 v23,v23,v199
v_max_f32 v24,v24,v207
v_max_f32 v25,v25,v215
v_max_f32 v26,v26,v223
v_mov_b32 v27,v23
v_mov_b32 v28,v24
v_mov_b32 v29,v25
v_mov_b32 v30,v26
v_permlane16_swap_b32 v23,v27
v_permlane16_swap_b32 v24,v28
v_permlane16_swap_b32 v25,v29
v_permlane16_swap_b32 v26,v30
v_max_f32 v23,v23,v27
v_max_f32 v24,v24,v28
v_max_f32 v25,v25,v29
v_max_f32 v26,v26,v30
v_mov_b32 v27,v23
v_mov_b32 v28,v24
v_mov_b32 v29,v25
v_mov_b32 v30,v26
v_permlane32_swap_b32 v23,v27
v_permlane32_swap_b32 v24,v28
v_permlane32_swap_b32 v25,v29
v_permlane32_swap_b32 v26,v30
v_max_f32 v23,v23,v27
v_max_f32 v24,v24,v28
v_max_f32 v25,v25,v29
v_max_f32 v26,v26,v30
v_mul_f32 v27,s26,v23
v_mul_f32 v28,s26,v24
v_mul_f32 v29,s26,v25
v_mul_f32 v30,s26,v26
v_max3_f32 v14,v14,v27,v18
v_max3_f32 v15,v15,v28,v19
v_max3_f32 v16,v16,v29,v20
v_max3_f32 v17,v17,v30,v21
v_sub_f32 v23,v18,v14
v_sub_f32 v24,v19,v15
v_sub_f32 v25,v20,v16
v_sub_f32 v26,v21,v17
v_exp_f32 v23,v23
v_exp_f32 v24,v24
v_exp_f32 v25,v25
v_exp_f32 v26,v26
v_mov_b32 v18,v14
v_mov_b32 v19,v15
v_mov_b32 v20,v16
v_mov_b32 v21,v17
v_accvgpr_read_b32 v27,a224
v_accvgpr_read_b32 v28,a228
v_accvgpr_read_b32 v29,a232
v_accvgpr_read_b32 v30,a236
v_mul_f32 v27,v27,v23
v_mul_f32 v28,v28,v24
v_mul_f32 v29,v29,v25
v_mul_f32 v30,v30,v26
v_accvgpr_write_b32 a224,v27
v_accvgpr_write_b32 a228,v28
v_accvgpr_write_b32 a232,v29
v_accvgpr_write_b32 a236,v30
v_mul_f32 v32,v32,v23
v_mul_f32 v33,v33,v23
v_mul_f32 v34,v34,v23
v_mul_f32 v35,v35,v23
v_mul_f32 v36,v36,v23
v_mul_f32 v37,v37,v23
v_mul_f32 v38,v38,v23
v_mul_f32 v39,v39,v23
v_mul_f32 v40,v40,v23
v_mul_f32 v41,v41,v23
v_mul_f32 v42,v42,v23
v_mul_f32 v43,v43,v23
v_mul_f32 v44,v44,v23
v_mul_f32 v45,v45,v23
v_mul_f32 v46,v46,v23
v_mul_f32 v47,v47,v23
v_mul_f32 v96,v96,v23
v_mul_f32 v97,v97,v23
v_mul_f32 v98,v98,v23
v_mul_f32 v99,v99,v23
v_mul_f32 v100,v100,v23
v_mul_f32 v101,v101,v23
v_mul_f32 v102,v102,v23
v_mul_f32 v103,v103,v23
v_mul_f32 v104,v104,v23
v_mul_f32 v105,v105,v23
v_mul_f32 v106,v106,v23
v_mul_f32 v107,v107,v23
v_mul_f32 v108,v108,v23
v_mul_f32 v109,v109,v23
v_mul_f32 v110,v110,v23
v_mul_f32 v111,v111,v23
v_mul_f32 v48,v48,v24
v_mul_f32 v49,v49,v24
v_mul_f32 v50,v50,v24
v_mul_f32 v51,v51,v24
v_mul_f32 v52,v52,v24
v_mul_f32 v53,v53,v24
v_mul_f32 v54,v54,v24
v_mul_f32 v55,v55,v24
v_mul_f32 v56,v56,v24
v_mul_f32 v57,v57,v24
v_mul_f32 v58,v58,v24
v_mul_f32 v59,v59,v24
v_mul_f32 v60,v60,v24
v_mul_f32 v61,v61,v24
v_mul_f32 v62,v62,v24
v_mul_f32 v63,v63,v24
v_mul_f32 v112,v112,v24
v_mul_f32 v113,v113,v24
v_mul_f32 v114,v114,v24
v_mul_f32 v115,v115,v24
v_mul_f32 v116,v116,v24
v_mul_f32 v117,v117,v24
v_mul_f32 v118,v118,v24
v_mul_f32 v119,v119,v24
v_mul_f32 v120,v120,v24
v_mul_f32 v121,v121,v24
v_mul_f32 v122,v122,v24
v_mul_f32 v123,v123,v24
v_mul_f32 v124,v124,v24
v_mul_f32 v125,v125,v24
v_mul_f32 v126,v126,v24
v_mul_f32 v127,v127,v24
v_mul_f32 v64,v64,v25
v_mul_f32 v65,v65,v25
v_mul_f32 v66,v66,v25
v_mul_f32 v67,v67,v25
v_mul_f32 v68,v68,v25
v_mul_f32 v69,v69,v25
v_mul_f32 v70,v70,v25
v_mul_f32 v71,v71,v25
v_mul_f32 v72,v72,v25
v_mul_f32 v73,v73,v25
v_mul_f32 v74,v74,v25
v_mul_f32 v75,v75,v25
v_mul_f32 v76,v76,v25
v_mul_f32 v77,v77,v25
v_mul_f32 v78,v78,v25
v_mul_f32 v79,v79,v25
v_mul_f32 v128,v128,v25
v_mul_f32 v129,v129,v25
v_mul_f32 v130,v130,v25
v_mul_f32 v131,v131,v25
v_mul_f32 v132,v132,v25
v_mul_f32 v133,v133,v25
v_mul_f32 v134,v134,v25
v_mul_f32 v135,v135,v25
v_mul_f32 v136,v136,v25
v_mul_f32 v137,v137,v25
v_mul_f32 v138,v138,v25
v_mul_f32 v139,v139,v25
v_mul_f32 v140,v140,v25
v_mul_f32 v141,v141,v25
v_mul_f32 v142,v142,v25
v_mul_f32 v143,v143,v25
v_mul_f32 v80,v80,v26
v_mul_f32 v81,v81,v26
v_mul_f32 v82,v82,v26
v_mul_f32 v83,v83,v26
v_mul_f32 v84,v84,v26
v_mul_f32 v85,v85,v26
v_mul_f32 v86,v86,v26
v_mul_f32 v87,v87,v26
v_mul_f32 v88,v88,v26
v_mul_f32 v89,v89,v26
v_mul_f32 v90,v90,v26
v_mul_f32 v91,v91,v26
v_mul_f32 v92,v92,v26
v_mul_f32 v93,v93,v26
v_mul_f32 v94,v94,v26
v_mul_f32 v95,v95,v26
v_mul_f32 v144,v144,v26
v_mul_f32 v145,v145,v26
v_mul_f32 v146,v146,v26
v_mul_f32 v147,v147,v26
v_mul_f32 v148,v148,v26
v_mul_f32 v149,v149,v26
v_mul_f32 v150,v150,v26
v_mul_f32 v151,v151,v26
v_mul_f32 v152,v152,v26
v_mul_f32 v153,v153,v26
v_mul_f32 v154,v154,v26
v_mul_f32 v155,v155,v26
v_mul_f32 v156,v156,v26
v_mul_f32 v157,v157,v26
v_mul_f32 v158,v158,v26
v_mul_f32 v159,v159,v26
v_fma_f32 v224,v224,s26,-v18
v_fma_f32 v225,v225,s26,-v18
v_fma_f32 v226,v226,s26,-v18
v_fma_f32 v227,v227,s26,-v18
v_fma_f32 v228,v228,s26,-v18
v_fma_f32 v229,v229,s26,-v18
v_fma_f32 v230,v230,s26,-v18
v_fma_f32 v231,v231,s26,-v18
v_fma_f32 v232,v232,s26,-v19
v_fma_f32 v233,v233,s26,-v19
v_fma_f32 v234,v234,s26,-v19
v_fma_f32 v235,v235,s26,-v19
v_fma_f32 v236,v236,s26,-v19
v_fma_f32 v237,v237,s26,-v19
v_fma_f32 v238,v238,s26,-v19
v_fma_f32 v239,v239,s26,-v19
v_fma_f32 v240,v240,s26,-v20
v_fma_f32 v241,v241,s26,-v20
v_fma_f32 v242,v242,s26,-v20
v_fma_f32 v243,v243,s26,-v20
v_fma_f32 v244,v244,s26,-v20
v_fma_f32 v245,v245,s26,-v20
v_fma_f32 v246,v246,s26,-v20
v_fma_f32 v247,v247,s26,-v20
v_fma_f32 v248,v248,s26,-v21
v_fma_f32 v249,v249,s26,-v21
v_fma_f32 v250,v250,s26,-v21
v_fma_f32 v251,v251,s26,-v21
v_fma_f32 v252,v252,s26,-v21
v_fma_f32 v253,v253,s26,-v21
v_fma_f32 v254,v254,s26,-v21
v_fma_f32 v255,v255,s26,-v21
v_exp_f32 v224,v224
v_exp_f32 v225,v225
v_exp_f32 v226,v226
v_exp_f32 v227,v227
v_exp_f32 v228,v228
v_exp_f32 v229,v229
v_exp_f32 v230,v230
v_exp_f32 v231,v231
v_exp_f32 v232,v232
v_exp_f32 v233,v233
v_exp_f32 v234,v234
v_exp_f32 v235,v235
v_exp_f32 v236,v236
v_exp_f32 v237,v237
v_exp_f32 v238,v238
v_exp_f32 v239,v239
v_exp_f32 v240,v240
v_exp_f32 v241,v241
v_exp_f32 v242,v242
v_exp_f32 v243,v243
v_exp_f32 v244,v244
v_exp_f32 v245,v245
v_exp_f32 v246,v246
v_exp_f32 v247,v247
v_exp_f32 v248,v248
v_exp_f32 v249,v249
v_exp_f32 v250,v250
v_exp_f32 v251,v251
v_exp_f32 v252,v252
v_exp_f32 v253,v253
v_exp_f32 v254,v254
v_exp_f32 v255,v255
v_cvt_pk_bf16_f32 v224,v224,v225
v_cvt_pk_bf16_f32 v225,v226,v227
v_cvt_pk_bf16_f32 v226,v228,v229
v_cvt_pk_bf16_f32 v227,v230,v231
v_cvt_pk_bf16_f32 v232,v232,v233
v_cvt_pk_bf16_f32 v233,v234,v235
v_cvt_pk_bf16_f32 v234,v236,v237
v_cvt_pk_bf16_f32 v235,v238,v239
v_cvt_pk_bf16_f32 v240,v240,v241
v_cvt_pk_bf16_f32 v241,v242,v243
v_cvt_pk_bf16_f32 v242,v244,v245
v_cvt_pk_bf16_f32 v243,v246,v247
v_cvt_pk_bf16_f32 v248,v248,v249
v_cvt_pk_bf16_f32 v249,v250,v251
v_cvt_pk_bf16_f32 v250,v252,v253
v_cvt_pk_bf16_f32 v251,v254,v255
v_fma_f32 v192,v192,s26,-v18
v_fma_f32 v193,v193,s26,-v18
v_fma_f32 v194,v194,s26,-v18
v_fma_f32 v195,v195,s26,-v18
v_fma_f32 v196,v196,s26,-v18
v_fma_f32 v197,v197,s26,-v18
v_fma_f32 v198,v198,s26,-v18
v_fma_f32 v199,v199,s26,-v18
v_fma_f32 v200,v200,s26,-v19
v_fma_f32 v201,v201,s26,-v19
v_fma_f32 v202,v202,s26,-v19
v_fma_f32 v203,v203,s26,-v19
v_fma_f32 v204,v204,s26,-v19
v_fma_f32 v205,v205,s26,-v19
v_fma_f32 v206,v206,s26,-v19
v_fma_f32 v207,v207,s26,-v19
v_fma_f32 v208,v208,s26,-v20
v_fma_f32 v209,v209,s26,-v20
v_fma_f32 v210,v210,s26,-v20
v_fma_f32 v211,v211,s26,-v20
v_fma_f32 v212,v212,s26,-v20
v_fma_f32 v213,v213,s26,-v20
v_fma_f32 v214,v214,s26,-v20
v_fma_f32 v215,v215,s26,-v20
v_fma_f32 v216,v216,s26,-v21
v_fma_f32 v217,v217,s26,-v21
v_fma_f32 v218,v218,s26,-v21
v_fma_f32 v219,v219,s26,-v21
v_fma_f32 v220,v220,s26,-v21
v_fma_f32 v221,v221,s26,-v21
v_fma_f32 v222,v222,s26,-v21
v_fma_f32 v223,v223,s26,-v21
v_exp_f32 v192,v192
v_exp_f32 v193,v193
v_exp_f32 v194,v194
v_exp_f32 v195,v195
v_exp_f32 v196,v196
v_exp_f32 v197,v197
v_exp_f32 v198,v198
v_exp_f32 v199,v199
v_exp_f32 v200,v200
v_exp_f32 v201,v201
v_exp_f32 v202,v202
v_exp_f32 v203,v203
v_exp_f32 v204,v204
v_exp_f32 v205,v205
v_exp_f32 v206,v206
v_exp_f32 v207,v207
v_exp_f32 v208,v208
v_exp_f32 v209,v209
v_exp_f32 v210,v210
v_exp_f32 v211,v211
v_exp_f32 v212,v212
v_exp_f32 v213,v213
v_exp_f32 v214,v214
v_exp_f32 v215,v215
v_exp_f32 v216,v216
v_exp_f32 v217,v217
v_exp_f32 v218,v218
v_exp_f32 v219,v219
v_exp_f32 v220,v220
v_exp_f32 v221,v221
v_exp_f32 v222,v222
v_exp_f32 v223,v223
v_cvt_pk_bf16_f32 v228,v192,v193
v_cvt_pk_bf16_f32 v229,v194,v195
v_cvt_pk_bf16_f32 v230,v196,v197
v_cvt_pk_bf16_f32 v231,v198,v199
v_cvt_pk_bf16_f32 v236,v200,v201
v_cvt_pk_bf16_f32 v237,v202,v203
v_cvt_pk_bf16_f32 v238,v204,v205
v_cvt_pk_bf16_f32 v239,v206,v207
v_cvt_pk_bf16_f32 v244,v208,v209
v_cvt_pk_bf16_f32 v245,v210,v211
v_cvt_pk_bf16_f32 v246,v212,v213
v_cvt_pk_bf16_f32 v247,v214,v215
v_cvt_pk_bf16_f32 v252,v216,v217
v_cvt_pk_bf16_f32 v253,v218,v219
v_cvt_pk_bf16_f32 v254,v220,v221
v_cvt_pk_bf16_f32 v255,v222,v223
v_mfma_f32_16x16x32_bf16 v[160:163],a[96:99],a[0:3],0
ds_read_b128 a[128:131],v2 offset:34816
v_mfma_f32_16x16x32_bf16 v[160:163],a[100:103],a[4:7],v[160:163]
v_mfma_f32_16x16x32_bf16 v[160:163],a[104:107],a[8:11],v[160:163]
v_mfma_f32_16x16x32_bf16 v[160:163],a[108:111],a[12:15],v[160:163]
buffer_load_dwordx4 v1,s[8:11],s21 offen offset:3072 nt lds
v_mfma_f32_16x16x32_bf16 v[168:171],a[108:111],a[28:31],0
s_add_u32 s21,s21,16384
ds_read_b128 a[132:135],v3 offset:34816
v_mfma_f32_16x16x32_bf16 v[168:171],a[104:107],a[24:27],v[168:171]
v_mfma_f32_16x16x32_bf16 v[168:171],a[100:103],a[20:23],v[168:171]
v_mfma_f32_16x16x32_bf16 v[168:171],a[96:99],a[16:19],v[168:171]
v_mfma_f32_16x16x32_bf16 v[176:179],a[96:99],a[32:35],0
ds_read_b128 a[136:139],v4 offset:34816
v_mfma_f32_16x16x32_bf16 v[176:179],a[100:103],a[36:39],v[176:179]
v_mfma_f32_16x16x32_bf16 v[176:179],a[104:107],a[40:43],v[176:179]
v_mfma_f32_16x16x32_bf16 v[176:179],a[108:111],a[44:47],v[176:179]
ds_read_b128 a[140:143],v5 offset:34816
v_mfma_f32_16x16x32_bf16 v[184:187],a[108:111],a[60:63],0
v_mfma_f32_16x16x32_bf16 v[184:187],a[104:107],a[56:59],v[184:187]
v_mfma_f32_16x16x32_bf16 v[184:187],a[100:103],a[52:55],v[184:187]
s_waitcnt lgkmcnt(4)
v_mfma_f32_16x16x32_bf16 v[184:187],a[96:99],a[48:51],v[184:187]
ds_read_b128 a[144:147],v2 offset:35840
v_mfma_f32_16x16x32_bf16 v[164:167],a[112:115],a[0:3],0
v_mfma_f32_16x16x32_bf16 v[164:167],a[116:119],a[4:7],v[164:167]
v_mfma_f32_16x16x32_bf16 v[164:167],a[120:123],a[8:11],v[164:167]
v_mfma_f32_16x16x32_bf16 v[164:167],a[124:127],a[12:15],v[164:167]
ds_read_b128 a[148:151],v3 offset:35840
v_mfma_f32_16x16x32_bf16 v[172:175],a[124:127],a[28:31],0
v_mfma_f32_16x16x32_bf16 v[172:175],a[120:123],a[24:27],v[172:175]
v_mfma_f32_16x16x32_bf16 v[172:175],a[116:119],a[20:23],v[172:175]
s_add_u32 m0,s25,65536
ds_read_b128 a[152:155],v4 offset:35840
v_mfma_f32_16x16x32_bf16 v[172:175],a[112:115],a[16:19],v[172:175]
buffer_load_dwordx4 v1,s[12:15],s22 offen nt lds
v_mfma_f32_16x16x32_bf16 v[180:183],a[112:115],a[32:35],0
v_mfma_f32_16x16x32_bf16 v[180:183],a[116:119],a[36:39],v[180:183]
v_mfma_f32_16x16x32_bf16 v[180:183],a[120:123],a[40:43],v[180:183]
ds_read_b128 a[156:159],v5 offset:35840
v_mfma_f32_16x16x32_bf16 v[180:183],a[124:127],a[44:47],v[180:183]
v_mfma_f32_16x16x32_bf16 v[188:191],a[124:127],a[60:63],0
v_mfma_f32_16x16x32_bf16 v[188:191],a[120:123],a[56:59],v[188:191]
v_mfma_f32_16x16x32_bf16 v[188:191],a[116:119],a[52:55],v[188:191]
v_mfma_f32_16x16x32_bf16 v[188:191],a[112:115],a[48:51],v[188:191]
s_waitcnt lgkmcnt(4)
v_mfma_f32_16x16x32_bf16 v[192:195],a[128:131],a[0:3],0
v_mfma_f32_16x16x32_bf16 v[192:195],a[132:135],a[4:7],v[192:195]
v_mfma_f32_16x16x32_bf16 v[192:195],a[136:139],a[8:11],v[192:195]
v_mfma_f32_16x16x32_bf16 v[192:195],a[140:143],a[12:15],v[192:195]
buffer_load_dwordx4 v1,s[12:15],s22 offen offset:1024 nt lds
v_mfma_f32_16x16x32_bf16 v[200:203],a[140:143],a[28:31],0
v_mfma_f32_16x16x32_bf16 v[200:203],a[136:139],a[24:27],v[200:203]
ds_read_b64_tr_b16 a[96:97],v6 offset:16384
v_mfma_f32_16x16x32_bf16 v[200:203],a[132:135],a[20:23],v[200:203]
ds_read_b64_tr_b16 a[98:99],v6 offset:17408
v_mfma_f32_16x16x32_bf16 v[200:203],a[128:131],a[16:19],v[200:203]
v_mfma_f32_16x16x32_bf16 v[208:211],a[128:131],a[32:35],0
ds_read_b64_tr_b16 a[100:101],v6 offset:18432
v_mfma_f32_16x16x32_bf16 v[208:211],a[132:135],a[36:39],v[208:211]
ds_read_b64_tr_b16 a[102:103],v6 offset:19456
v_mfma_f32_16x16x32_bf16 v[208:211],a[136:139],a[40:43],v[208:211]
v_mfma_f32_16x16x32_bf16 v[208:211],a[140:143],a[44:47],v[208:211]
buffer_load_dwordx4 v1,s[12:15],s22 offen offset:2048 nt lds
v_mfma_f32_16x16x32_bf16 v[216:219],a[140:143],a[60:63],0
ds_read_b64_tr_b16 a[104:105],v6 offset:16392
v_mfma_f32_16x16x32_bf16 v[216:219],a[136:139],a[56:59],v[216:219]
ds_read_b64_tr_b16 a[106:107],v6 offset:17416
v_mfma_f32_16x16x32_bf16 v[216:219],a[132:135],a[52:55],v[216:219]
v_mfma_f32_16x16x32_bf16 v[216:219],a[128:131],a[48:51],v[216:219]
s_waitcnt lgkmcnt(6)
v_mfma_f32_16x16x32_bf16 v[196:199],a[144:147],a[0:3],0
ds_read_b64_tr_b16 a[108:109],v6 offset:18440
v_mfma_f32_16x16x32_bf16 v[196:199],a[148:151],a[4:7],v[196:199]
ds_read_b64_tr_b16 a[110:111],v6 offset:19464
v_mfma_f32_16x16x32_bf16 v[196:199],a[152:155],a[8:11],v[196:199]
v_mfma_f32_16x16x32_bf16 v[196:199],a[156:159],a[12:15],v[196:199]
ds_read_b64_tr_b16 a[112:113],v7 offset:16384
v_mfma_f32_16x16x32_bf16 v[204:207],a[156:159],a[28:31],0
ds_read_b64_tr_b16 a[114:115],v7 offset:17408
v_mfma_f32_16x16x32_bf16 v[204:207],a[152:155],a[24:27],v[204:207]
v_mfma_f32_16x16x32_bf16 v[204:207],a[148:151],a[20:23],v[204:207]
v_mfma_f32_16x16x32_bf16 v[204:207],a[144:147],a[16:19],v[204:207]
ds_read_b64_tr_b16 a[116:117],v7 offset:18432
v_mfma_f32_16x16x32_bf16 v[212:215],a[144:147],a[32:35],0
ds_read_b64_tr_b16 a[118:119],v7 offset:19456
v_mfma_f32_16x16x32_bf16 v[212:215],a[148:151],a[36:39],v[212:215]
v_mfma_f32_16x16x32_bf16 v[212:215],a[152:155],a[40:43],v[212:215]
v_mfma_f32_16x16x32_bf16 v[212:215],a[156:159],a[44:47],v[212:215]
ds_read_b64_tr_b16 a[120:121],v7 offset:16392
v_mfma_f32_16x16x32_bf16 v[220:223],a[156:159],a[60:63],0
ds_read_b64_tr_b16 a[122:123],v7 offset:17416
v_mfma_f32_16x16x32_bf16 v[220:223],a[152:155],a[56:59],v[220:223]
v_mfma_f32_16x16x32_bf16 v[220:223],a[148:151],a[52:55],v[220:223]
ds_read_b64_tr_b16 a[124:125],v7 offset:18440
v_mfma_f32_16x16x32_bf16 v[220:223],a[144:147],a[48:51],v[220:223]
s_waitcnt lgkmcnt(14)
ds_read_b64_tr_b16 a[126:127],v7 offset:19464
v_mfma_f32_16x16x32_bf16 a[224:227],a[240:243],v[224:227],a[224:227]
v_mfma_f32_16x16x32_bf16 a[224:227],a[240:243],v[228:231],a[224:227]
buffer_load_dwordx4 v1,s[12:15],s22 offen offset:3072 nt lds
v_mfma_f32_16x16x32_bf16 a[228:231],a[240:243],v[232:235],a[228:231]
s_add_u32 s22,s22,16384
s_waitcnt lgkmcnt(14)
ds_read_b64_tr_b16 a[128:129],v8 offset:16384
v_mfma_f32_16x16x32_bf16 a[228:231],a[240:243],v[236:239],a[228:231]
s_waitcnt lgkmcnt(14)
ds_read_b64_tr_b16 a[130:131],v8 offset:17408
v_mfma_f32_16x16x32_bf16 a[232:235],a[240:243],v[240:243],a[232:235]
v_mfma_f32_16x16x32_bf16 a[232:235],a[240:243],v[244:247],a[232:235]
s_waitcnt lgkmcnt(14)
v_mfma_f32_16x16x32_bf16 a[236:239],a[240:243],v[248:251],a[236:239]
ds_read_b64_tr_b16 a[132:133],v8 offset:18432
v_mfma_f32_16x16x32_bf16 a[236:239],a[240:243],v[252:255],a[236:239]
s_waitcnt lgkmcnt(14)
ds_read_b64_tr_b16 a[134:135],v8 offset:19456
v_mfma_f32_16x16x32_bf16 v[80:83],a[96:99],v[248:251],v[80:83]
v_mfma_f32_16x16x32_bf16 v[80:83],a[100:103],v[252:255],v[80:83]
s_waitcnt lgkmcnt(14)
ds_read_b64_tr_b16 a[136:137],v8 offset:16392
v_mfma_f32_16x16x32_bf16 v[64:67],a[100:103],v[244:247],v[64:67]
s_waitcnt lgkmcnt(14)
ds_read_b64_tr_b16 a[138:139],v8 offset:17416
v_mfma_f32_16x16x32_bf16 v[64:67],a[96:99],v[240:243],v[64:67]
v_mfma_f32_16x16x32_bf16 v[48:51],a[96:99],v[232:235],v[48:51]
v_mfma_f32_16x16x32_bf16 v[48:51],a[100:103],v[236:239],v[48:51]
s_waitcnt lgkmcnt(14)
ds_read_b64_tr_b16 a[140:141],v8 offset:18440
v_mfma_f32_16x16x32_bf16 v[32:35],a[100:103],v[228:231],v[32:35]
s_waitcnt lgkmcnt(14)
ds_read_b64_tr_b16 a[142:143],v8 offset:19464
v_mfma_f32_16x16x32_bf16 v[32:35],a[96:99],v[224:227],v[32:35]
v_mfma_f32_16x16x32_bf16 v[36:39],a[104:107],v[224:227],v[36:39]
v_mfma_f32_16x16x32_bf16 v[36:39],a[108:111],v[228:231],v[36:39]
s_waitcnt lgkmcnt(14)
ds_read_b64_tr_b16 a[144:145],v9 offset:16384
v_mfma_f32_16x16x32_bf16 v[52:55],a[108:111],v[236:239],v[52:55]
s_waitcnt lgkmcnt(14)
ds_read_b64_tr_b16 a[146:147],v9 offset:17408
v_mfma_f32_16x16x32_bf16 v[52:55],a[104:107],v[232:235],v[52:55]
v_mfma_f32_16x16x32_bf16 v[68:71],a[104:107],v[240:243],v[68:71]
s_waitcnt lgkmcnt(14)
ds_read_b64_tr_b16 a[148:149],v9 offset:18432
v_mfma_f32_16x16x32_bf16 v[68:71],a[108:111],v[244:247],v[68:71]
s_waitcnt lgkmcnt(14)
ds_read_b64_tr_b16 a[150:151],v9 offset:19456
v_mfma_f32_16x16x32_bf16 v[84:87],a[108:111],v[252:255],v[84:87]
v_mfma_f32_16x16x32_bf16 v[84:87],a[104:107],v[248:251],v[84:87]
v_mfma_f32_16x16x32_bf16 v[88:91],a[112:115],v[248:251],v[88:91]
s_waitcnt lgkmcnt(14)
ds_read_b64_tr_b16 a[152:153],v9 offset:16392
v_mfma_f32_16x16x32_bf16 v[88:91],a[116:119],v[252:255],v[88:91]
s_waitcnt lgkmcnt(14)
ds_read_b64_tr_b16 a[154:155],v9 offset:17416
v_mfma_f32_16x16x32_bf16 v[72:75],a[116:119],v[244:247],v[72:75]
v_mfma_f32_16x16x32_bf16 v[72:75],a[112:115],v[240:243],v[72:75]
s_waitcnt lgkmcnt(14)
ds_read_b64_tr_b16 a[156:157],v9 offset:18440
v_mfma_f32_16x16x32_bf16 v[56:59],a[112:115],v[232:235],v[56:59]
s_waitcnt lgkmcnt(14)
ds_read_b64_tr_b16 a[158:159],v9 offset:19464
v_mfma_f32_16x16x32_bf16 v[56:59],a[116:119],v[236:239],v[56:59]
v_mfma_f32_16x16x32_bf16 v[40:43],a[116:119],v[228:231],v[40:43]
v_mfma_f32_16x16x32_bf16 v[40:43],a[112:115],v[224:227],v[40:43]
v_mfma_f32_16x16x32_bf16 v[44:47],a[120:123],v[224:227],v[44:47]
v_mfma_f32_16x16x32_bf16 v[44:47],a[124:127],v[228:231],v[44:47]
v_mfma_f32_16x16x32_bf16 v[60:63],a[124:127],v[236:239],v[60:63]
v_mfma_f32_16x16x32_bf16 v[60:63],a[120:123],v[232:235],v[60:63]
v_mfma_f32_16x16x32_bf16 v[76:79],a[120:123],v[240:243],v[76:79]
v_mfma_f32_16x16x32_bf16 v[76:79],a[124:127],v[244:247],v[76:79]
v_mfma_f32_16x16x32_bf16 v[92:95],a[124:127],v[252:255],v[92:95]
v_mfma_f32_16x16x32_bf16 v[92:95],a[120:123],v[248:251],v[92:95]
s_waitcnt lgkmcnt(12)
v_mfma_f32_16x16x32_bf16 v[144:147],a[128:131],v[248:251],v[144:147]
v_mfma_f32_16x16x32_bf16 v[144:147],a[132:135],v[252:255],v[144:147]
v_mfma_f32_16x16x32_bf16 v[128:131],a[132:135],v[244:247],v[128:131]
v_mfma_f32_16x16x32_bf16 v[128:131],a[128:131],v[240:243],v[128:131]
s_waitcnt vmcnt(16)
s_waitcnt lgkmcnt(0)
s_barrier
ds_read_b128 a[96:99],v2 offset:49152
v_mfma_f32_16x16x32_bf16 v[112:115],a[128:131],v[232:235],v[112:115]
s_add_u32 m0,s25,32768
v_mfma_f32_16x16x32_bf16 v[112:115],a[132:135],v[236:239],v[112:115]
buffer_load_dwordx4 v1,s[8:11],s21 offen nt lds
v_mfma_f32_16x16x32_bf16 v[96:99],a[132:135],v[228:231],v[96:99]
v_mfma_f32_16x16x32_bf16 v[96:99],a[128:131],v[224:227],v[96:99]
ds_read_b128 a[100:103],v3 offset:49152
v_mfma_f32_16x16x32_bf16 v[100:103],a[136:139],v[224:227],v[100:103]
v_mfma_f32_16x16x32_bf16 v[100:103],a[140:143],v[228:231],v[100:103]
v_mfma_f32_16x16x32_bf16 v[116:119],a[140:143],v[236:239],v[116:119]
ds_read_b128 a[104:107],v4 offset:49152
v_mfma_f32_16x16x32_bf16 v[116:119],a[136:139],v[232:235],v[116:119]
v_mfma_f32_16x16x32_bf16 v[132:135],a[136:139],v[240:243],v[132:135]
v_mfma_f32_16x16x32_bf16 v[132:135],a[140:143],v[244:247],v[132:135]
buffer_load_dwordx4 v1,s[8:11],s21 offen offset:1024 nt lds
v_mfma_f32_16x16x32_bf16 v[148:151],a[140:143],v[252:255],v[148:151]
ds_read_b128 a[108:111],v5 offset:49152
v_mfma_f32_16x16x32_bf16 v[148:151],a[136:139],v[248:251],v[148:151]
v_mfma_f32_16x16x32_bf16 v[152:155],a[144:147],v[248:251],v[152:155]
v_mfma_f32_16x16x32_bf16 v[152:155],a[148:151],v[252:255],v[152:155]
v_mfma_f32_16x16x32_bf16 v[136:139],a[148:151],v[244:247],v[136:139]
ds_read_b128 a[112:115],v2 offset:50176
v_mfma_f32_16x16x32_bf16 v[136:139],a[144:147],v[240:243],v[136:139]
v_mfma_f32_16x16x32_bf16 v[120:123],a[144:147],v[232:235],v[120:123]
v_mfma_f32_16x16x32_bf16 v[120:123],a[148:151],v[236:239],v[120:123]
ds_read_b128 a[116:119],v3 offset:50176
v_mfma_f32_16x16x32_bf16 v[104:107],a[148:151],v[228:231],v[104:107]
v_mfma_f32_16x16x32_bf16 v[104:107],a[144:147],v[224:227],v[104:107]
v_mfma_f32_16x16x32_bf16 v[108:111],a[152:155],v[224:227],v[108:111]
v_mfma_f32_16x16x32_bf16 v[108:111],a[156:159],v[228:231],v[108:111]
ds_read_b128 a[120:123],v4 offset:50176
v_mfma_f32_16x16x32_bf16 v[124:127],a[156:159],v[236:239],v[124:127]
v_mfma_f32_16x16x32_bf16 v[124:127],a[152:155],v[232:235],v[124:127]
buffer_load_dwordx4 v1,s[8:11],s21 offen offset:2048 nt lds
v_mfma_f32_16x16x32_bf16 v[140:143],a[152:155],v[240:243],v[140:143]
v_mfma_f32_16x16x32_bf16 v[140:143],a[156:159],v[244:247],v[140:143]
ds_read_b128 a[124:127],v5 offset:50176
v_mfma_f32_16x16x32_bf16 v[156:159],a[156:159],v[252:255],v[156:159]
v_mfma_f32_16x16x32_bf16 v[156:159],a[152:155],v[248:251],v[156:159]
s_waitcnt lgkmcnt(4)
v_max3_f32 v23,v160,v161,v162
v_max3_f32 v24,v168,v169,v170
v_max3_f32 v25,v176,v177,v178
v_max3_f32 v26,v184,v185,v186
v_max3_f32 v23,v23,v163,v164
v_max3_f32 v24,v24,v171,v172
v_max3_f32 v25,v25,v179,v180
v_max3_f32 v26,v26,v187,v188
v_max3_f32 v23,v23,v165,v166
v_max3_f32 v24,v24,v173,v174
v_max3_f32 v25,v25,v181,v182
v_max3_f32 v26,v26,v189,v190
v_max_f32 v23,v23,v167
v_max_f32 v24,v24,v175
v_max_f32 v25,v25,v183
v_max_f32 v26,v26,v191
v_mov_b32 v27,v23
v_mov_b32 v28,v24
v_mov_b32 v29,v25
v_mov_b32 v30,v26
v_permlane16_swap_b32 v23,v27
v_permlane16_swap_b32 v24,v28
v_permlane16_swap_b32 v25,v29
v_permlane16_swap_b32 v26,v30
v_max_f32 v23,v23,v27
v_max_f32 v24,v24,v28
v_max_f32 v25,v25,v29
v_max_f32 v26,v26,v30
v_mov_b32 v27,v23
v_mov_b32 v28,v24
v_mov_b32 v29,v25
v_mov_b32 v30,v26
v_permlane32_swap_b32 v23,v27
v_permlane32_swap_b32 v24,v28
v_permlane32_swap_b32 v25,v29
v_permlane32_swap_b32 v26,v30
v_max_f32 v23,v23,v27
v_max_f32 v24,v24,v28
v_max_f32 v25,v25,v29
v_max_f32 v26,v26,v30
v_mul_f32 v14,s26,v23
v_mul_f32 v15,s26,v24
v_mul_f32 v16,s26,v25
v_mul_f32 v17,s26,v26
v_max3_f32 v23,v192,v193,v194
v_max3_f32 v24,v200,v201,v202
v_max3_f32 v25,v208,v209,v210
v_max3_f32 v26,v216,v217,v218
v_max3_f32 v23,v23,v195,v196
v_max3_f32 v24,v24,v203,v204
v_max3_f32 v25,v25,v211,v212
v_max3_f32 v26,v26,v219,v220
v_max3_f32 v23,v23,v197,v198
v_max3_f32 v24,v24,v205,v206
v_max3_f32 v25,v25,v213,v214
v_max3_f32 v26,v26,v221,v222
v_max_f32 v23,v23,v199
v_max_f32 v24,v24,v207
v_max_f32 v25,v25,v215
v_max_f32 v26,v26,v223
v_mov_b32 v27,v23
v_mov_b32 v28,v24
v_mov_b32 v29,v25
v_mov_b32 v30,v26
v_permlane16_swap_b32 v23,v27
v_permlane16_swap_b32 v24,v28
v_permlane16_swap_b32 v25,v29
v_permlane16_swap_b32 v26,v30
v_max_f32 v23,v23,v27
v_max_f32 v24,v24,v28
v_max_f32 v25,v25,v29
v_max_f32 v26,v26,v30
v_mov_b32 v27,v23
v_mov_b32 v28,v24
v_mov_b32 v29,v25
v_mov_b32 v30,v26
v_permlane32_swap_b32 v23,v27
v_permlane32_swap_b32 v24,v28
v_permlane32_swap_b32 v25,v29
v_permlane32_swap_b32 v26,v30
v_max_f32 v23,v23,v27
v_max_f32 v24,v24,v28
v_max_f32 v25,v25,v29
v_max_f32 v26,v26,v30
v_mul_f32 v27,s26,v23
v_mul_f32 v28,s26,v24
v_mul_f32 v29,s26,v25
v_mul_f32 v30,s26,v26
v_max3_f32 v14,v14,v27,v18
v_max3_f32 v15,v15,v28,v19
v_max3_f32 v16,v16,v29,v20
v_max3_f32 v17,v17,v30,v21
v_sub_f32 v23,v18,v14
v_sub_f32 v24,v19,v15
v_sub_f32 v25,v20,v16
v_sub_f32 v26,v21,v17
v_exp_f32 v23,v23
v_exp_f32 v24,v24
v_exp_f32 v25,v25
v_exp_f32 v26,v26
v_mov_b32 v18,v14
v_mov_b32 v19,v15
v_mov_b32 v20,v16
v_mov_b32 v21,v17
v_accvgpr_read_b32 v27,a224
v_accvgpr_read_b32 v28,a228
v_accvgpr_read_b32 v29,a232
v_accvgpr_read_b32 v30,a236
v_mul_f32 v27,v27,v23
v_mul_f32 v28,v28,v24
v_mul_f32 v29,v29,v25
v_mul_f32 v30,v30,v26
v_accvgpr_write_b32 a224,v27
v_accvgpr_write_b32 a228,v28
v_accvgpr_write_b32 a232,v29
v_accvgpr_write_b32 a236,v30
v_mul_f32 v32,v32,v23
v_mul_f32 v33,v33,v23
v_mul_f32 v34,v34,v23
v_mul_f32 v35,v35,v23
v_mul_f32 v36,v36,v23
v_mul_f32 v37,v37,v23
v_mul_f32 v38,v38,v23
v_mul_f32 v39,v39,v23
v_mul_f32 v40,v40,v23
v_mul_f32 v41,v41,v23
v_mul_f32 v42,v42,v23
v_mul_f32 v43,v43,v23
v_mul_f32 v44,v44,v23
v_mul_f32 v45,v45,v23
v_mul_f32 v46,v46,v23
v_mul_f32 v47,v47,v23
v_mul_f32 v96,v96,v23
v_mul_f32 v97,v97,v23
v_mul_f32 v98,v98,v23
v_mul_f32 v99,v99,v23
v_mul_f32 v100,v100,v23
v_mul_f32 v101,v101,v23
v_mul_f32 v102,v102,v23
v_mul_f32 v103,v103,v23
v_mul_f32 v104,v104,v23
v_mul_f32 v105,v105,v23
v_mul_f32 v106,v106,v23
v_mul_f32 v107,v107,v23
v_mul_f32 v108,v108,v23
v_mul_f32 v109,v109,v23
v_mul_f32 v110,v110,v23
v_mul_f32 v111,v111,v23
v_mul_f32 v48,v48,v24
v_mul_f32 v49,v49,v24
v_mul_f32 v50,v50,v24
v_mul_f32 v51,v51,v24
v_mul_f32 v52,v52,v24
v_mul_f32 v53,v53,v24
v_mul_f32 v54,v54,v24
v_mul_f32 v55,v55,v24
v_mul_f32 v56,v56,v24
v_mul_f32 v57,v57,v24
v_mul_f32 v58,v58,v24
v_mul_f32 v59,v59,v24
v_mul_f32 v60,v60,v24
v_mul_f32 v61,v61,v24
v_mul_f32 v62,v62,v24
v_mul_f32 v63,v63,v24
v_mul_f32 v112,v112,v24
v_mul_f32 v113,v113,v24
v_mul_f32 v114,v114,v24
v_mul_f32 v115,v115,v24
v_mul_f32 v116,v116,v24
v_mul_f32 v117,v117,v24
v_mul_f32 v118,v118,v24
v_mul_f32 v119,v119,v24
v_mul_f32 v120,v120,v24
v_mul_f32 v121,v121,v24
v_mul_f32 v122,v122,v24
v_mul_f32 v123,v123,v24
v_mul_f32 v124,v124,v24
v_mul_f32 v125,v125,v24
v_mul_f32 v126,v126,v24
v_mul_f32 v127,v127,v24
v_mul_f32 v64,v64,v25
v_mul_f32 v65,v65,v25
v_mul_f32 v66,v66,v25
v_mul_f32 v67,v67,v25
v_mul_f32 v68,v68,v25
v_mul_f32 v69,v69,v25
v_mul_f32 v70,v70,v25
v_mul_f32 v71,v71,v25
v_mul_f32 v72,v72,v25
v_mul_f32 v73,v73,v25
v_mul_f32 v74,v74,v25
v_mul_f32 v75,v75,v25
v_mul_f32 v76,v76,v25
v_mul_f32 v77,v77,v25
v_mul_f32 v78,v78,v25
v_mul_f32 v79,v79,v25
v_mul_f32 v128,v128,v25
v_mul_f32 v129,v129,v25
v_mul_f32 v130,v130,v25
v_mul_f32 v131,v131,v25
v_mul_f32 v132,v132,v25
v_mul_f32 v133,v133,v25
v_mul_f32 v134,v134,v25
v_mul_f32 v135,v135,v25
v_mul_f32 v136,v136,v25
v_mul_f32 v137,v137,v25
v_mul_f32 v138,v138,v25
v_mul_f32 v139,v139,v25
v_mul_f32 v140,v140,v25
v_mul_f32 v141,v141,v25
v_mul_f32 v142,v142,v25
v_mul_f32 v143,v143,v25
v_mul_f32 v80,v80,v26
v_mul_f32 v81,v81,v26
v_mul_f32 v82,v82,v26
v_mul_f32 v83,v83,v26
v_mul_f32 v84,v84,v26
v_mul_f32 v85,v85,v26
v_mul_f32 v86,v86,v26
v_mul_f32 v87,v87,v26
v_mul_f32 v88,v88,v26
v_mul_f32 v89,v89,v26
v_mul_f32 v90,v90,v26
v_mul_f32 v91,v91,v26
v_mul_f32 v92,v92,v26
v_mul_f32 v93,v93,v26
v_mul_f32 v94,v94,v26
v_mul_f32 v95,v95,v26
v_mul_f32 v144,v144,v26
v_mul_f32 v145,v145,v26
v_mul_f32 v146,v146,v26
v_mul_f32 v147,v147,v26
v_mul_f32 v148,v148,v26
v_mul_f32 v149,v149,v26
v_mul_f32 v150,v150,v26
v_mul_f32 v151,v151,v26
v_mul_f32 v152,v152,v26
v_mul_f32 v153,v153,v26
v_mul_f32 v154,v154,v26
v_mul_f32 v155,v155,v26
v_mul_f32 v156,v156,v26
v_mul_f32 v157,v157,v26
v_mul_f32 v158,v158,v26
v_mul_f32 v159,v159,v26
v_fma_f32 v160,v160,s26,-v18
v_fma_f32 v161,v161,s26,-v18
v_fma_f32 v162,v162,s26,-v18
v_fma_f32 v163,v163,s26,-v18
v_fma_f32 v164,v164,s26,-v18
v_fma_f32 v165,v165,s26,-v18
v_fma_f32 v166,v166,s26,-v18
v_fma_f32 v167,v167,s26,-v18
v_fma_f32 v168,v168,s26,-v19
v_fma_f32 v169,v169,s26,-v19
v_fma_f32 v170,v170,s26,-v19
v_fma_f32 v171,v171,s26,-v19
v_fma_f32 v172,v172,s26,-v19
v_fma_f32 v173,v173,s26,-v19
v_fma_f32 v174,v174,s26,-v19
v_fma_f32 v175,v175,s26,-v19
v_fma_f32 v176,v176,s26,-v20
v_fma_f32 v177,v177,s26,-v20
v_fma_f32 v178,v178,s26,-v20
v_fma_f32 v179,v179,s26,-v20
v_fma_f32 v180,v180,s26,-v20
v_fma_f32 v181,v181,s26,-v20
v_fma_f32 v182,v182,s26,-v20
v_fma_f32 v183,v183,s26,-v20
v_fma_f32 v184,v184,s26,-v21
v_fma_f32 v185,v185,s26,-v21
v_fma_f32 v186,v186,s26,-v21
v_fma_f32 v187,v187,s26,-v21
v_fma_f32 v188,v188,s26,-v21
v_fma_f32 v189,v189,s26,-v21
v_fma_f32 v190,v190,s26,-v21
v_fma_f32 v191,v191,s26,-v21
v_exp_f32 v160,v160
v_exp_f32 v161,v161
v_exp_f32 v162,v162
v_exp_f32 v163,v163
v_exp_f32 v164,v164
v_exp_f32 v165,v165
v_exp_f32 v166,v166
v_exp_f32 v167,v167
v_exp_f32 v168,v168
v_exp_f32 v169,v169
v_exp_f32 v170,v170
v_exp_f32 v171,v171
v_exp_f32 v172,v172
v_exp_f32 v173,v173
v_exp_f32 v174,v174
v_exp_f32 v175,v175
v_exp_f32 v176,v176
v_exp_f32 v177,v177
v_exp_f32 v178,v178
v_exp_f32 v179,v179
v_exp_f32 v180,v180
v_exp_f32 v181,v181
v_exp_f32 v182,v182
v_exp_f32 v183,v183
v_exp_f32 v184,v184
v_exp_f32 v185,v185
v_exp_f32 v186,v186
v_exp_f32 v187,v187
v_exp_f32 v188,v188
v_exp_f32 v189,v189
v_exp_f32 v190,v190
v_exp_f32 v191,v191
v_cvt_pk_bf16_f32 v160,v160,v161
v_cvt_pk_bf16_f32 v161,v162,v163
v_cvt_pk_bf16_f32 v162,v164,v165
v_cvt_pk_bf16_f32 v163,v166,v167
v_cvt_pk_bf16_f32 v168,v168,v169
v_cvt_pk_bf16_f32 v169,v170,v171
v_cvt_pk_bf16_f32 v170,v172,v173
v_cvt_pk_bf16_f32 v171,v174,v175
v_cvt_pk_bf16_f32 v176,v176,v177
v_cvt_pk_bf16_f32 v177,v178,v179
v_cvt_pk_bf16_f32 v178,v180,v181
v_cvt_pk_bf16_f32 v179,v182,v183
v_cvt_pk_bf16_f32 v184,v184,v185
v_cvt_pk_bf16_f32 v185,v186,v187
v_cvt_pk_bf16_f32 v186,v188,v189
v_cvt_pk_bf16_f32 v187,v190,v191
v_fma_f32 v192,v192,s26,-v18
v_fma_f32 v193,v193,s26,-v18
v_fma_f32 v194,v194,s26,-v18
v_fma_f32 v195,v195,s26,-v18
v_fma_f32 v196,v196,s26,-v18
v_fma_f32 v197,v197,s26,-v18
v_fma_f32 v198,v198,s26,-v18
v_fma_f32 v199,v199,s26,-v18
v_fma_f32 v200,v200,s26,-v19
v_fma_f32 v201,v201,s26,-v19
v_fma_f32 v202,v202,s26,-v19
v_fma_f32 v203,v203,s26,-v19
v_fma_f32 v204,v204,s26,-v19
v_fma_f32 v205,v205,s26,-v19
v_fma_f32 v206,v206,s26,-v19
v_fma_f32 v207,v207,s26,-v19
v_fma_f32 v208,v208,s26,-v20
v_fma_f32 v209,v209,s26,-v20
v_fma_f32 v210,v210,s26,-v20
v_fma_f32 v211,v211,s26,-v20
v_fma_f32 v212,v212,s26,-v20
v_fma_f32 v213,v213,s26,-v20
v_fma_f32 v214,v214,s26,-v20
v_fma_f32 v215,v215,s26,-v20
v_fma_f32 v216,v216,s26,-v21
v_fma_f32 v217,v217,s26,-v21
v_fma_f32 v218,v218,s26,-v21
v_fma_f32 v219,v219,s26,-v21
v_fma_f32 v220,v220,s26,-v21
v_fma_f32 v221,v221,s26,-v21
v_fma_f32 v222,v222,s26,-v21
v_fma_f32 v223,v223,s26,-v21
v_exp_f32 v192,v192
v_exp_f32 v193,v193
v_exp_f32 v194,v194
v_exp_f32 v195,v195
v_exp_f32 v196,v196
v_exp_f32 v197,v197
v_exp_f32 v198,v198
v_exp_f32 v199,v199
v_exp_f32 v200,v200
v_exp_f32 v201,v201
v_exp_f32 v202,v202
v_exp_f32 v203,v203
v_exp_f32 v204,v204
v_exp_f32 v205,v205
v_exp_f32 v206,v206
v_exp_f32 v207,v207
v_exp_f32 v208,v208
v_exp_f32 v209,v209
v_exp_f32 v210,v210
v_exp_f32 v211,v211
v_exp_f32 v212,v212
v_exp_f32 v213,v213
v_exp_f32 v214,v214
v_exp_f32 v215,v215
v_exp_f32 v216,v216
v_exp_f32 v217,v217
v_exp_f32 v218,v218
v_exp_f32 v219,v219
v_exp_f32 v220,v220
v_exp_f32 v221,v221
v_exp_f32 v222,v222
v_exp_f32 v223,v223
v_cvt_pk_bf16_f32 v164,v192,v193
v_cvt_pk_bf16_f32 v165,v194,v195
v_cvt_pk_bf16_f32 v166,v196,v197
v_cvt_pk_bf16_f32 v167,v198,v199
v_cvt_pk_bf16_f32 v172,v200,v201
v_cvt_pk_bf16_f32 v173,v202,v203
v_cvt_pk_bf16_f32 v174,v204,v205
v_cvt_pk_bf16_f32 v175,v206,v207
v_cvt_pk_bf16_f32 v180,v208,v209
v_cvt_pk_bf16_f32 v181,v210,v211
v_cvt_pk_bf16_f32 v182,v212,v213
v_cvt_pk_bf16_f32 v183,v214,v215
v_cvt_pk_bf16_f32 v188,v216,v217
v_cvt_pk_bf16_f32 v189,v218,v219
v_cvt_pk_bf16_f32 v190,v220,v221
v_cvt_pk_bf16_f32 v191,v222,v223
v_mfma_f32_16x16x32_bf16 v[224:227],a[96:99],a[0:3],0
ds_read_b128 a[128:131],v2 offset:51200
v_mfma_f32_16x16x32_bf16 v[224:227],a[100:103],a[4:7],v[224:227]
v_mfma_f32_16x16x32_bf16 v[224:227],a[104:107],a[8:11],v[224:227]
v_mfma_f32_16x16x32_bf16 v[224:227],a[108:111],a[12:15],v[224:227]
buffer_load_dwordx4 v1,s[8:11],s21 offen offset:3072 nt lds
v_mfma_f32_16x16x32_bf16 v[232:235],a[108:111],a[28:31],0
s_add_u32 s21,s21,16384
ds_read_b128 a[132:135],v3 offset:51200
v_mfma_f32_16x16x32_bf16 v[232:235],a[104:107],a[24:27],v[232:235]
v_mfma_f32_16x16x32_bf16 v[232:235],a[100:103],a[20:23],v[232:235]
v_mfma_f32_16x16x32_bf16 v[232:235],a[96:99],a[16:19],v[232:235]
v_mfma_f32_16x16x32_bf16 v[240:243],a[96:99],a[32:35],0
ds_read_b128 a[136:139],v4 offset:51200
v_mfma_f32_16x16x32_bf16 v[240:243],a[100:103],a[36:39],v[240:243]
v_mfma_f32_16x16x32_bf16 v[240:243],a[104:107],a[40:43],v[240:243]
v_mfma_f32_16x16x32_bf16 v[240:243],a[108:111],a[44:47],v[240:243]
ds_read_b128 a[140:143],v5 offset:51200
v_mfma_f32_16x16x32_bf16 v[248:251],a[108:111],a[60:63],0
v_mfma_f32_16x16x32_bf16 v[248:251],a[104:107],a[56:59],v[248:251]
v_mfma_f32_16x16x32_bf16 v[248:251],a[100:103],a[52:55],v[248:251]
s_waitcnt lgkmcnt(4)
v_mfma_f32_16x16x32_bf16 v[248:251],a[96:99],a[48:51],v[248:251]
ds_read_b128 a[144:147],v2 offset:52224
v_mfma_f32_16x16x32_bf16 v[228:231],a[112:115],a[0:3],0
v_mfma_f32_16x16x32_bf16 v[228:231],a[116:119],a[4:7],v[228:231]
v_mfma_f32_16x16x32_bf16 v[228:231],a[120:123],a[8:11],v[228:231]
v_mfma_f32_16x16x32_bf16 v[228:231],a[124:127],a[12:15],v[228:231]
ds_read_b128 a[148:151],v3 offset:52224
v_mfma_f32_16x16x32_bf16 v[236:239],a[124:127],a[28:31],0
v_mfma_f32_16x16x32_bf16 v[236:239],a[120:123],a[24:27],v[236:239]
v_mfma_f32_16x16x32_bf16 v[236:239],a[116:119],a[20:23],v[236:239]
s_add_u32 m0,s25,81920
ds_read_b128 a[152:155],v4 offset:52224
v_mfma_f32_16x16x32_bf16 v[236:239],a[112:115],a[16:19],v[236:239]
buffer_load_dwordx4 v1,s[12:15],s22 offen nt lds
v_mfma_f32_16x16x32_bf16 v[244:247],a[112:115],a[32:35],0
v_mfma_f32_16x16x32_bf16 v[244:247],a[116:119],a[36:39],v[244:247]
v_mfma_f32_16x16x32_bf16 v[244:247],a[120:123],a[40:43],v[244:247]
ds_read_b128 a[156:159],v5 offset:52224
v_mfma_f32_16x16x32_bf16 v[244:247],a[124:127],a[44:47],v[244:247]
v_mfma_f32_16x16x32_bf16 v[252:255],a[124:127],a[60:63],0
v_mfma_f32_16x16x32_bf16 v[252:255],a[120:123],a[56:59],v[252:255]
v_mfma_f32_16x16x32_bf16 v[252:255],a[116:119],a[52:55],v[252:255]
v_mfma_f32_16x16x32_bf16 v[252:255],a[112:115],a[48:51],v[252:255]
s_waitcnt lgkmcnt(4)
v_mfma_f32_16x16x32_bf16 v[192:195],a[128:131],a[0:3],0
v_mfma_f32_16x16x32_bf16 v[192:195],a[132:135],a[4:7],v[192:195]
v_mfma_f32_16x16x32_bf16 v[192:195],a[136:139],a[8:11],v[192:195]
v_mfma_f32_16x16x32_bf16 v[192:195],a[140:143],a[12:15],v[192:195]
buffer_load_dwordx4 v1,s[12:15],s22 offen offset:1024 nt lds
v_mfma_f32_16x16x32_bf16 v[200:203],a[140:143],a[28:31],0
v_mfma_f32_16x16x32_bf16 v[200:203],a[136:139],a[24:27],v[200:203]
ds_read_b64_tr_b16 a[96:97],v6 offset:32768
v_mfma_f32_16x16x32_bf16 v[200:203],a[132:135],a[20:23],v[200:203]
ds_read_b64_tr_b16 a[98:99],v6 offset:33792
v_mfma_f32_16x16x32_bf16 v[200:203],a[128:131],a[16:19],v[200:203]
v_mfma_f32_16x16x32_bf16 v[208:211],a[128:131],a[32:35],0
ds_read_b64_tr_b16 a[100:101],v6 offset:34816
v_mfma_f32_16x16x32_bf16 v[208:211],a[132:135],a[36:39],v[208:211]
ds_read_b64_tr_b16 a[102:103],v6 offset:35840
v_mfma_f32_16x16x32_bf16 v[208:211],a[136:139],a[40:43],v[208:211]
v_mfma_f32_16x16x32_bf16 v[208:211],a[140:143],a[44:47],v[208:211]
buffer_load_dwordx4 v1,s[12:15],s22 offen offset:2048 nt lds
v_mfma_f32_16x16x32_bf16 v[216:219],a[140:143],a[60:63],0
ds_read_b64_tr_b16 a[104:105],v6 offset:32776
v_mfma_f32_16x16x32_bf16 v[216:219],a[136:139],a[56:59],v[216:219]
ds_read_b64_tr_b16 a[106:107],v6 offset:33800
v_mfma_f32_16x16x32_bf16 v[216:219],a[132:135],a[52:55],v[216:219]
v_mfma_f32_16x16x32_bf16 v[216:219],a[128:131],a[48:51],v[216:219]
s_waitcnt lgkmcnt(6)
v_mfma_f32_16x16x32_bf16 v[196:199],a[144:147],a[0:3],0
ds_read_b64_tr_b16 a[108:109],v6 offset:34824
v_mfma_f32_16x16x32_bf16 v[196:199],a[148:151],a[4:7],v[196:199]
ds_read_b64_tr_b16 a[110:111],v6 offset:35848
v_mfma_f32_16x16x32_bf16 v[196:199],a[152:155],a[8:11],v[196:199]
v_mfma_f32_16x16x32_bf16 v[196:199],a[156:159],a[12:15],v[196:199]
ds_read_b64_tr_b16 a[112:113],v7 offset:32768
v_mfma_f32_16x16x32_bf16 v[204:207],a[156:159],a[28:31],0
ds_read_b64_tr_b16 a[114:115],v7 offset:33792
v_mfma_f32_16x16x32_bf16 v[204:207],a[152:155],a[24:27],v[204:207]
v_mfma_f32_16x16x32_bf16 v[204:207],a[148:151],a[20:23],v[204:207]
v_mfma_f32_16x16x32_bf16 v[204:207],a[144:147],a[16:19],v[204:207]
ds_read_b64_tr_b16 a[116:117],v7 offset:34816
v_mfma_f32_16x16x32_bf16 v[212:215],a[144:147],a[32:35],0
ds_read_b64_tr_b16 a[118:119],v7 offset:35840
v_mfma_f32_16x16x32_bf16 v[212:215],a[148:151],a[36:39],v[212:215]
v_mfma_f32_16x16x32_bf16 v[212:215],a[152:155],a[40:43],v[212:215]
v_mfma_f32_16x16x32_bf16 v[212:215],a[156:159],a[44:47],v[212:215]
ds_read_b64_tr_b16 a[120:121],v7 offset:32776
v_mfma_f32_16x16x32_bf16 v[220:223],a[156:159],a[60:63],0
ds_read_b64_tr_b16 a[122:123],v7 offset:33800
v_mfma_f32_16x16x32_bf16 v[220:223],a[152:155],a[56:59],v[220:223]
v_mfma_f32_16x16x32_bf16 v[220:223],a[148:151],a[52:55],v[220:223]
ds_read_b64_tr_b16 a[124:125],v7 offset:34824
v_mfma_f32_16x16x32_bf16 v[220:223],a[144:147],a[48:51],v[220:223]
s_waitcnt lgkmcnt(14)
ds_read_b64_tr_b16 a[126:127],v7 offset:35848
v_mfma_f32_16x16x32_bf16 a[224:227],a[240:243],v[160:163],a[224:227]
v_mfma_f32_16x16x32_bf16 a[224:227],a[240:243],v[164:167],a[224:227]
buffer_load_dwordx4 v1,s[12:15],s22 offen offset:3072 nt lds
v_mfma_f32_16x16x32_bf16 a[228:231],a[240:243],v[168:171],a[228:231]
s_add_u32 s22,s22,16384
s_waitcnt lgkmcnt(14)
ds_read_b64_tr_b16 a[128:129],v8 offset:32768
v_mfma_f32_16x16x32_bf16 a[228:231],a[240:243],v[172:175],a[228:231]
s_waitcnt lgkmcnt(14)
ds_read_b64_tr_b16 a[130:131],v8 offset:33792
v_mfma_f32_16x16x32_bf16 a[232:235],a[240:243],v[176:179],a[232:235]
v_mfma_f32_16x16x32_bf16 a[232:235],a[240:243],v[180:183],a[232:235]
s_waitcnt lgkmcnt(14)
v_mfma_f32_16x16x32_bf16 a[236:239],a[240:243],v[184:187],a[236:239]
ds_read_b64_tr_b16 a[132:133],v8 offset:34816
v_mfma_f32_16x16x32_bf16 a[236:239],a[240:243],v[188:191],a[236:239]
s_waitcnt lgkmcnt(14)
ds_read_b64_tr_b16 a[134:135],v8 offset:35840
v_mfma_f32_16x16x32_bf16 v[80:83],a[96:99],v[184:187],v[80:83]
v_mfma_f32_16x16x32_bf16 v[80:83],a[100:103],v[188:191],v[80:83]
s_waitcnt lgkmcnt(14)
ds_read_b64_tr_b16 a[136:137],v8 offset:32776
v_mfma_f32_16x16x32_bf16 v[64:67],a[100:103],v[180:183],v[64:67]
s_waitcnt lgkmcnt(14)
ds_read_b64_tr_b16 a[138:139],v8 offset:33800
v_mfma_f32_16x16x32_bf16 v[64:67],a[96:99],v[176:179],v[64:67]
v_mfma_f32_16x16x32_bf16 v[48:51],a[96:99],v[168:171],v[48:51]
v_mfma_f32_16x16x32_bf16 v[48:51],a[100:103],v[172:175],v[48:51]
s_waitcnt lgkmcnt(14)
ds_read_b64_tr_b16 a[140:141],v8 offset:34824
v_mfma_f32_16x16x32_bf16 v[32:35],a[100:103],v[164:167],v[32:35]
s_waitcnt lgkmcnt(14)
ds_read_b64_tr_b16 a[142:143],v8 offset:35848
v_mfma_f32_16x16x32_bf16 v[32:35],a[96:99],v[160:163],v[32:35]
v_mfma_f32_16x16x32_bf16 v[36:39],a[104:107],v[160:163],v[36:39]
v_mfma_f32_16x16x32_bf16 v[36:39],a[108:111],v[164:167],v[36:39]
s_waitcnt lgkmcnt(14)
ds_read_b64_tr_b16 a[144:145],v9 offset:32768
v_mfma_f32_16x16x32_bf16 v[52:55],a[108:111],v[172:175],v[52:55]
s_waitcnt lgkmcnt(14)
ds_read_b64_tr_b16 a[146:147],v9 offset:33792
v_mfma_f32_16x16x32_bf16 v[52:55],a[104:107],v[168:171],v[52:55]
v_mfma_f32_16x16x32_bf16 v[68:71],a[104:107],v[176:179],v[68:71]
s_waitcnt lgkmcnt(14)
ds_read_b64_tr_b16 a[148:149],v9 offset:34816
v_mfma_f32_16x16x32_bf16 v[68:71],a[108:111],v[180:183],v[68:71]
s_waitcnt lgkmcnt(14)
ds_read_b64_tr_b16 a[150:151],v9 offset:35840
v_mfma_f32_16x16x32_bf16 v[84:87],a[108:111],v[188:191],v[84:87]
v_mfma_f32_16x16x32_bf16 v[84:87],a[104:107],v[184:187],v[84:87]
v_mfma_f32_16x16x32_bf16 v[88:91],a[112:115],v[184:187],v[88:91]
s_waitcnt lgkmcnt(14)
ds_read_b64_tr_b16 a[152:153],v9 offset:32776
v_mfma_f32_16x16x32_bf16 v[88:91],a[116:119],v[188:191],v[88:91]
s_waitcnt lgkmcnt(14)
ds_read_b64_tr_b16 a[154:155],v9 offset:33800
v_mfma_f32_16x16x32_bf16 v[72:75],a[116:119],v[180:183],v[72:75]
v_mfma_f32_16x16x32_bf16 v[72:75],a[112:115],v[176:179],v[72:75]
s_waitcnt lgkmcnt(14)
ds_read_b64_tr_b16 a[156:157],v9 offset:34824
v_mfma_f32_16x16x32_bf16 v[56:59],a[112:115],v[168:171],v[56:59]
s_waitcnt lgkmcnt(14)
ds_read_b64_tr_b16 a[158:159],v9 offset:35848
v_mfma_f32_16x16x32_bf16 v[56:59],a[116:119],v[172:175],v[56:59]
v_mfma_f32_16x16x32_bf16 v[40:43],a[116:119],v[164:167],v[40:43]
v_mfma_f32_16x16x32_bf16 v[40:43],a[112:115],v[160:163],v[40:43]
v_mfma_f32_16x16x32_bf16 v[44:47],a[120:123],v[160:163],v[44:47]
v_mfma_f32_16x16x32_bf16 v[44:47],a[124:127],v[164:167],v[44:47]
v_mfma_f32_16x16x32_bf16 v[60:63],a[124:127],v[172:175],v[60:63]
v_mfma_f32_16x16x32_bf16 v[60:63],a[120:123],v[168:171],v[60:63]
v_mfma_f32_16x16x32_bf16 v[76:79],a[120:123],v[176:179],v[76:79]
v_mfma_f32_16x16x32_bf16 v[76:79],a[124:127],v[180:183],v[76:79]
v_mfma_f32_16x16x32_bf16 v[92:95],a[124:127],v[188:191],v[92:95]
v_mfma_f32_16x16x32_bf16 v[92:95],a[120:123],v[184:187],v[92:95]
s_waitcnt lgkmcnt(12)
v_mfma_f32_16x16x32_bf16 v[144:147],a[128:131],v[184:187],v[144:147]
v_mfma_f32_16x16x32_bf16 v[144:147],a[132:135],v[188:191],v[144:147]
v_mfma_f32_16x16x32_bf16 v[128:131],a[132:135],v[180:183],v[128:131]
v_mfma_f32_16x16x32_bf16 v[128:131],a[128:131],v[176:179],v[128:131]
s_waitcnt vmcnt(16)
s_waitcnt lgkmcnt(0)
s_barrier
v_mfma_f32_16x16x32_bf16 v[112:115],a[128:131],v[168:171],v[112:115]
v_mfma_f32_16x16x32_bf16 v[112:115],a[132:135],v[172:175],v[112:115]
v_mfma_f32_16x16x32_bf16 v[96:99],a[132:135],v[164:167],v[96:99]
v_mfma_f32_16x16x32_bf16 v[96:99],a[128:131],v[160:163],v[96:99]
v_mfma_f32_16x16x32_bf16 v[100:103],a[136:139],v[160:163],v[100:103]
v_mfma_f32_16x16x32_bf16 v[100:103],a[140:143],v[164:167],v[100:103]
v_mfma_f32_16x16x32_bf16 v[116:119],a[140:143],v[172:175],v[116:119]
v_mfma_f32_16x16x32_bf16 v[116:119],a[136:139],v[168:171],v[116:119]
v_mfma_f32_16x16x32_bf16 v[132:135],a[136:139],v[176:179],v[132:135]
v_mfma_f32_16x16x32_bf16 v[132:135],a[140:143],v[180:183],v[132:135]
v_mfma_f32_16x16x32_bf16 v[148:151],a[140:143],v[188:191],v[148:151]
v_mfma_f32_16x16x32_bf16 v[148:151],a[136:139],v[184:187],v[148:151]
v_mfma_f32_16x16x32_bf16 v[152:155],a[144:147],v[184:187],v[152:155]
v_mfma_f32_16x16x32_bf16 v[152:155],a[148:151],v[188:191],v[152:155]
v_mfma_f32_16x16x32_bf16 v[136:139],a[148:151],v[180:183],v[136:139]
v_mfma_f32_16x16x32_bf16 v[136:139],a[144:147],v[176:179],v[136:139]
v_mfma_f32_16x16x32_bf16 v[120:123],a[144:147],v[168:171],v[120:123]
v_mfma_f32_16x16x32_bf16 v[120:123],a[148:151],v[172:175],v[120:123]
v_mfma_f32_16x16x32_bf16 v[104:107],a[148:151],v[164:167],v[104:107]
v_mfma_f32_16x16x32_bf16 v[104:107],a[144:147],v[160:163],v[104:107]
v_mfma_f32_16x16x32_bf16 v[108:111],a[152:155],v[160:163],v[108:111]
v_mfma_f32_16x16x32_bf16 v[108:111],a[156:159],v[164:167],v[108:111]
v_mfma_f32_16x16x32_bf16 v[124:127],a[156:159],v[172:175],v[124:127]
v_mfma_f32_16x16x32_bf16 v[124:127],a[152:155],v[168:171],v[124:127]
v_mfma_f32_16x16x32_bf16 v[140:143],a[152:155],v[176:179],v[140:143]
v_mfma_f32_16x16x32_bf16 v[140:143],a[156:159],v[180:183],v[140:143]
v_mfma_f32_16x16x32_bf16 v[156:159],a[156:159],v[188:191],v[156:159]
v_mfma_f32_16x16x32_bf16 v[156:159],a[152:155],v[184:187],v[156:159]
v_max3_f32 v23,v224,v225,v226
v_max3_f32 v24,v232,v233,v234
v_max3_f32 v25,v240,v241,v242
v_max3_f32 v26,v248,v249,v250
v_max3_f32 v23,v23,v227,v228
v_max3_f32 v24,v24,v235,v236
v_max3_f32 v25,v25,v243,v244
v_max3_f32 v26,v26,v251,v252
v_max3_f32 v23,v23,v229,v230
v_max3_f32 v24,v24,v237,v238
v_max3_f32 v25,v25,v245,v246
v_max3_f32 v26,v26,v253,v254
v_max_f32 v23,v23,v231
v_max_f32 v24,v24,v239
v_max_f32 v25,v25,v247
v_max_f32 v26,v26,v255
v_mov_b32 v27,v23
v_mov_b32 v28,v24
v_mov_b32 v29,v25
v_mov_b32 v30,v26
v_permlane16_swap_b32 v23,v27
v_permlane16_swap_b32 v24,v28
v_permlane16_swap_b32 v25,v29
v_permlane16_swap_b32 v26,v30
v_max_f32 v23,v23,v27
v_max_f32 v24,v24,v28
v_max_f32 v25,v25,v29
v_max_f32 v26,v26,v30
v_mov_b32 v27,v23
v_mov_b32 v28,v24
v_mov_b32 v29,v25
v_mov_b32 v30,v26
v_permlane32_swap_b32 v23,v27
v_permlane32_swap_b32 v24,v28
v_permlane32_swap_b32 v25,v29
v_permlane32_swap_b32 v26,v30
v_max_f32 v23,v23,v27
v_max_f32 v24,v24,v28
v_max_f32 v25,v25,v29
v_max_f32 v26,v26,v30
v_mul_f32 v14,s26,v23
v_mul_f32 v15,s26,v24
v_mul_f32 v16,s26,v25
v_mul_f32 v17,s26,v26
v_max3_f32 v23,v192,v193,v194
v_max3_f32 v24,v200,v201,v202
v_max3_f32 v25,v208,v209,v210
v_max3_f32 v26,v216,v217,v218
v_max3_f32 v23,v23,v195,v196
v_max3_f32 v24,v24,v203,v204
v_max3_f32 v25,v25,v211,v212
v_max3_f32 v26,v26,v219,v220
v_max3_f32 v23,v23,v197,v198
v_max3_f32 v24,v24,v205,v206
v_max3_f32 v25,v25,v213,v214
v_max3_f32 v26,v26,v221,v222
v_max_f32 v23,v23,v199
v_max_f32 v24,v24,v207
v_max_f32 v25,v25,v215
v_max_f32 v26,v26,v223
v_mov_b32 v27,v23
v_mov_b32 v28,v24
v_mov_b32 v29,v25
v_mov_b32 v30,v26
v_permlane16_swap_b32 v23,v27
v_permlane16_swap_b32 v24,v28
v_permlane16_swap_b32 v25,v29
v_permlane16_swap_b32 v26,v30
v_max_f32 v23,v23,v27
v_max_f32 v24,v24,v28
v_max_f32 v25,v25,v29
v_max_f32 v26,v26,v30
v_mov_b32 v27,v23
v_mov_b32 v28,v24
v_mov_b32 v29,v25
v_mov_b32 v30,v26
v_permlane32_swap_b32 v23,v27
v_permlane32_swap_b32 v24,v28
v_permlane32_swap_b32 v25,v29
v_permlane32_swap_b32 v26,v30
v_max_f32 v23,v23,v27
v_max_f32 v24,v24,v28
v_max_f32 v25,v25,v29
v_max_f32 v26,v26,v30
v_mul_f32 v27,s26,v23
v_mul_f32 v28,s26,v24
v_mul_f32 v29,s26,v25
v_mul_f32 v30,s26,v26
v_max3_f32 v14,v14,v27,v18
v_max3_f32 v15,v15,v28,v19
v_max3_f32 v16,v16,v29,v20
v_max3_f32 v17,v17,v30,v21
v_sub_f32 v23,v18,v14
v_sub_f32 v24,v19,v15
v_sub_f32 v25,v20,v16
v_sub_f32 v26,v21,v17
v_exp_f32 v23,v23
v_exp_f32 v24,v24
v_exp_f32 v25,v25
v_exp_f32 v26,v26
v_mov_b32 v18,v14
v_mov_b32 v19,v15
v_mov_b32 v20,v16
v_mov_b32 v21,v17
v_accvgpr_read_b32 v27,a224
v_accvgpr_read_b32 v28,a228
v_accvgpr_read_b32 v29,a232
v_accvgpr_read_b32 v30,a236
v_mul_f32 v27,v27,v23
v_mul_f32 v28,v28,v24
v_mul_f32 v29,v29,v25
v_mul_f32 v30,v30,v26
v_accvgpr_write_b32 a224,v27
v_accvgpr_write_b32 a228,v28
v_accvgpr_write_b32 a232,v29
v_accvgpr_write_b32 a236,v30
v_mul_f32 v32,v32,v23
v_mul_f32 v33,v33,v23
v_mul_f32 v34,v34,v23
v_mul_f32 v35,v35,v23
v_mul_f32 v36,v36,v23
v_mul_f32 v37,v37,v23
v_mul_f32 v38,v38,v23
v_mul_f32 v39,v39,v23
v_mul_f32 v40,v40,v23
v_mul_f32 v41,v41,v23
v_mul_f32 v42,v42,v23
v_mul_f32 v43,v43,v23
v_mul_f32 v44,v44,v23
v_mul_f32 v45,v45,v23
v_mul_f32 v46,v46,v23
v_mul_f32 v47,v47,v23
v_mul_f32 v96,v96,v23
v_mul_f32 v97,v97,v23
v_mul_f32 v98,v98,v23
v_mul_f32 v99,v99,v23
v_mul_f32 v100,v100,v23
v_mul_f32 v101,v101,v23
v_mul_f32 v102,v102,v23
v_mul_f32 v103,v103,v23
v_mul_f32 v104,v104,v23
v_mul_f32 v105,v105,v23
v_mul_f32 v106,v106,v23
v_mul_f32 v107,v107,v23
v_mul_f32 v108,v108,v23
v_mul_f32 v109,v109,v23
v_mul_f32 v110,v110,v23
v_mul_f32 v111,v111,v23
v_mul_f32 v48,v48,v24
v_mul_f32 v49,v49,v24
v_mul_f32 v50,v50,v24
v_mul_f32 v51,v51,v24
v_mul_f32 v52,v52,v24
v_mul_f32 v53,v53,v24
v_mul_f32 v54,v54,v24
v_mul_f32 v55,v55,v24
v_mul_f32 v56,v56,v24
v_mul_f32 v57,v57,v24
v_mul_f32 v58,v58,v24
v_mul_f32 v59,v59,v24
v_mul_f32 v60,v60,v24
v_mul_f32 v61,v61,v24
v_mul_f32 v62,v62,v24
v_mul_f32 v63,v63,v24
v_mul_f32 v112,v112,v24
v_mul_f32 v113,v113,v24
v_mul_f32 v114,v114,v24
v_mul_f32 v115,v115,v24
v_mul_f32 v116,v116,v24
v_mul_f32 v117,v117,v24
v_mul_f32 v118,v118,v24
v_mul_f32 v119,v119,v24
v_mul_f32 v120,v120,v24
v_mul_f32 v121,v121,v24
v_mul_f32 v122,v122,v24
v_mul_f32 v123,v123,v24
v_mul_f32 v124,v124,v24
v_mul_f32 v125,v125,v24
v_mul_f32 v126,v126,v24
v_mul_f32 v127,v127,v24
v_mul_f32 v64,v64,v25
v_mul_f32 v65,v65,v25
v_mul_f32 v66,v66,v25
v_mul_f32 v67,v67,v25
v_mul_f32 v68,v68,v25
v_mul_f32 v69,v69,v25
v_mul_f32 v70,v70,v25
v_mul_f32 v71,v71,v25
v_mul_f32 v72,v72,v25
v_mul_f32 v73,v73,v25
v_mul_f32 v74,v74,v25
v_mul_f32 v75,v75,v25
v_mul_f32 v76,v76,v25
v_mul_f32 v77,v77,v25
v_mul_f32 v78,v78,v25
v_mul_f32 v79,v79,v25
v_mul_f32 v128,v128,v25
v_mul_f32 v129,v129,v25
v_mul_f32 v130,v130,v25
v_mul_f32 v131,v131,v25
v_mul_f32 v132,v132,v25
v_mul_f32 v133,v133,v25
v_mul_f32 v134,v134,v25
v_mul_f32 v135,v135,v25
v_mul_f32 v136,v136,v25
v_mul_f32 v137,v137,v25
v_mul_f32 v138,v138,v25
v_mul_f32 v139,v139,v25
v_mul_f32 v140,v140,v25
v_mul_f32 v141,v141,v25
v_mul_f32 v142,v142,v25
v_mul_f32 v143,v143,v25
v_mul_f32 v80,v80,v26
v_mul_f32 v81,v81,v26
v_mul_f32 v82,v82,v26
v_mul_f32 v83,v83,v26
v_mul_f32 v84,v84,v26
v_mul_f32 v85,v85,v26
v_mul_f32 v86,v86,v26
v_mul_f32 v87,v87,v26
v_mul_f32 v88,v88,v26
v_mul_f32 v89,v89,v26
v_mul_f32 v90,v90,v26
v_mul_f32 v91,v91,v26
v_mul_f32 v92,v92,v26
v_mul_f32 v93,v93,v26
v_mul_f32 v94,v94,v26
v_mul_f32 v95,v95,v26
v_mul_f32 v144,v144,v26
v_mul_f32 v145,v145,v26
v_mul_f32 v146,v146,v26
v_mul_f32 v147,v147,v26
v_mul_f32 v148,v148,v26
v_mul_f32 v149,v149,v26
v_mul_f32 v150,v150,v26
v_mul_f32 v151,v151,v26
v_mul_f32 v152,v152,v26
v_mul_f32 v153,v153,v26
v_mul_f32 v154,v154,v26
v_mul_f32 v155,v155,v26
v_mul_f32 v156,v156,v26
v_mul_f32 v157,v157,v26
v_mul_f32 v158,v158,v26
v_mul_f32 v159,v159,v26
v_fma_f32 v224,v224,s26,-v18
v_fma_f32 v225,v225,s26,-v18
v_fma_f32 v226,v226,s26,-v18
v_fma_f32 v227,v227,s26,-v18
v_fma_f32 v228,v228,s26,-v18
v_fma_f32 v229,v229,s26,-v18
v_fma_f32 v230,v230,s26,-v18
v_fma_f32 v231,v231,s26,-v18
v_fma_f32 v232,v232,s26,-v19
v_fma_f32 v233,v233,s26,-v19
v_fma_f32 v234,v234,s26,-v19
v_fma_f32 v235,v235,s26,-v19
v_fma_f32 v236,v236,s26,-v19
v_fma_f32 v237,v237,s26,-v19
v_fma_f32 v238,v238,s26,-v19
v_fma_f32 v239,v239,s26,-v19
v_fma_f32 v240,v240,s26,-v20
v_fma_f32 v241,v241,s26,-v20
v_fma_f32 v242,v242,s26,-v20
v_fma_f32 v243,v243,s26,-v20
v_fma_f32 v244,v244,s26,-v20
v_fma_f32 v245,v245,s26,-v20
v_fma_f32 v246,v246,s26,-v20
v_fma_f32 v247,v247,s26,-v20
v_fma_f32 v248,v248,s26,-v21
v_fma_f32 v249,v249,s26,-v21
v_fma_f32 v250,v250,s26,-v21
v_fma_f32 v251,v251,s26,-v21
v_fma_f32 v252,v252,s26,-v21
v_fma_f32 v253,v253,s26,-v21
v_fma_f32 v254,v254,s26,-v21
v_fma_f32 v255,v255,s26,-v21
v_exp_f32 v224,v224
v_exp_f32 v225,v225
v_exp_f32 v226,v226
v_exp_f32 v227,v227
v_exp_f32 v228,v228
v_exp_f32 v229,v229
v_exp_f32 v230,v230
v_exp_f32 v231,v231
v_exp_f32 v232,v232
v_exp_f32 v233,v233
v_exp_f32 v234,v234
v_exp_f32 v235,v235
v_exp_f32 v236,v236
v_exp_f32 v237,v237
v_exp_f32 v238,v238
v_exp_f32 v239,v239
v_exp_f32 v240,v240
v_exp_f32 v241,v241
v_exp_f32 v242,v242
v_exp_f32 v243,v243
v_exp_f32 v244,v244
v_exp_f32 v245,v245
v_exp_f32 v246,v246
v_exp_f32 v247,v247
v_exp_f32 v248,v248
v_exp_f32 v249,v249
v_exp_f32 v250,v250
v_exp_f32 v251,v251
v_exp_f32 v252,v252
v_exp_f32 v253,v253
v_exp_f32 v254,v254
v_exp_f32 v255,v255
v_cvt_pk_bf16_f32 v224,v224,v225
v_cvt_pk_bf16_f32 v225,v226,v227
v_cvt_pk_bf16_f32 v226,v228,v229
v_cvt_pk_bf16_f32 v227,v230,v231
v_cvt_pk_bf16_f32 v232,v232,v233
v_cvt_pk_bf16_f32 v233,v234,v235
v_cvt_pk_bf16_f32 v234,v236,v237
v_cvt_pk_bf16_f32 v235,v238,v239
v_cvt_pk_bf16_f32 v240,v240,v241
v_cvt_pk_bf16_f32 v241,v242,v243
v_cvt_pk_bf16_f32 v242,v244,v245
v_cvt_pk_bf16_f32 v243,v246,v247
v_cvt_pk_bf16_f32 v248,v248,v249
v_cvt_pk_bf16_f32 v249,v250,v251
v_cvt_pk_bf16_f32 v250,v252,v253
v_cvt_pk_bf16_f32 v251,v254,v255
v_fma_f32 v192,v192,s26,-v18
v_fma_f32 v193,v193,s26,-v18
v_fma_f32 v194,v194,s26,-v18
v_fma_f32 v195,v195,s26,-v18
v_fma_f32 v196,v196,s26,-v18
v_fma_f32 v197,v197,s26,-v18
v_fma_f32 v198,v198,s26,-v18
v_fma_f32 v199,v199,s26,-v18
v_fma_f32 v200,v200,s26,-v19
v_fma_f32 v201,v201,s26,-v19
v_fma_f32 v202,v202,s26,-v19
v_fma_f32 v203,v203,s26,-v19
v_fma_f32 v204,v204,s26,-v19
v_fma_f32 v205,v205,s26,-v19
v_fma_f32 v206,v206,s26,-v19
v_fma_f32 v207,v207,s26,-v19
v_fma_f32 v208,v208,s26,-v20
v_fma_f32 v209,v209,s26,-v20
v_fma_f32 v210,v210,s26,-v20
v_fma_f32 v211,v211,s26,-v20
v_fma_f32 v212,v212,s26,-v20
v_fma_f32 v213,v213,s26,-v20
v_fma_f32 v214,v214,s26,-v20
v_fma_f32 v215,v215,s26,-v20
v_fma_f32 v216,v216,s26,-v21
v_fma_f32 v217,v217,s26,-v21
v_fma_f32 v218,v218,s26,-v21
v_fma_f32 v219,v219,s26,-v21
v_fma_f32 v220,v220,s26,-v21
v_fma_f32 v221,v221,s26,-v21
v_fma_f32 v222,v222,s26,-v21
v_fma_f32 v223,v223,s26,-v21
v_exp_f32 v192,v192
v_exp_f32 v193,v193
v_exp_f32 v194,v194
v_exp_f32 v195,v195
v_exp_f32 v196,v196
v_exp_f32 v197,v197
v_exp_f32 v198,v198
v_exp_f32 v199,v199
v_exp_f32 v200,v200
v_exp_f32 v201,v201
v_exp_f32 v202,v202
v_exp_f32 v203,v203
v_exp_f32 v204,v204
v_exp_f32 v205,v205
v_exp_f32 v206,v206
v_exp_f32 v207,v207
v_exp_f32 v208,v208
v_exp_f32 v209,v209
v_exp_f32 v210,v210
v_exp_f32 v211,v211
v_exp_f32 v212,v212
v_exp_f32 v213,v213
v_exp_f32 v214,v214
v_exp_f32 v215,v215
v_exp_f32 v216,v216
v_exp_f32 v217,v217
v_exp_f32 v218,v218
v_exp_f32 v219,v219
v_exp_f32 v220,v220
v_exp_f32 v221,v221
v_exp_f32 v222,v222
v_exp_f32 v223,v223
v_cvt_pk_bf16_f32 v228,v192,v193
v_cvt_pk_bf16_f32 v229,v194,v195
v_cvt_pk_bf16_f32 v230,v196,v197
v_cvt_pk_bf16_f32 v231,v198,v199
v_cvt_pk_bf16_f32 v236,v200,v201
v_cvt_pk_bf16_f32 v237,v202,v203
v_cvt_pk_bf16_f32 v238,v204,v205
v_cvt_pk_bf16_f32 v239,v206,v207
v_cvt_pk_bf16_f32 v244,v208,v209
v_cvt_pk_bf16_f32 v245,v210,v211
v_cvt_pk_bf16_f32 v246,v212,v213
v_cvt_pk_bf16_f32 v247,v214,v215
v_cvt_pk_bf16_f32 v252,v216,v217
v_cvt_pk_bf16_f32 v253,v218,v219
v_cvt_pk_bf16_f32 v254,v220,v221
v_cvt_pk_bf16_f32 v255,v222,v223
ds_read_b64_tr_b16 a[96:97],v6 offset:49152
ds_read_b64_tr_b16 a[98:99],v6 offset:50176
ds_read_b64_tr_b16 a[100:101],v6 offset:51200
ds_read_b64_tr_b16 a[102:103],v6 offset:52224
ds_read_b64_tr_b16 a[104:105],v6 offset:49160
ds_read_b64_tr_b16 a[106:107],v6 offset:50184
ds_read_b64_tr_b16 a[108:109],v6 offset:51208
ds_read_b64_tr_b16 a[110:111],v6 offset:52232
ds_read_b64_tr_b16 a[112:113],v7 offset:49152
ds_read_b64_tr_b16 a[114:115],v7 offset:50176
ds_read_b64_tr_b16 a[116:117],v7 offset:51200
ds_read_b64_tr_b16 a[118:119],v7 offset:52224
ds_read_b64_tr_b16 a[120:121],v7 offset:49160
ds_read_b64_tr_b16 a[122:123],v7 offset:50184
ds_read_b64_tr_b16 a[124:125],v7 offset:51208
s_waitcnt lgkmcnt(14)
ds_read_b64_tr_b16 a[126:127],v7 offset:52232
v_mfma_f32_16x16x32_bf16 a[224:227],a[240:243],v[224:227],a[224:227]
v_mfma_f32_16x16x32_bf16 a[224:227],a[240:243],v[228:231],a[224:227]
v_mfma_f32_16x16x32_bf16 a[228:231],a[240:243],v[232:235],a[228:231]
s_waitcnt lgkmcnt(14)
ds_read_b64_tr_b16 a[128:129],v8 offset:49152
v_mfma_f32_16x16x32_bf16 a[228:231],a[240:243],v[236:239],a[228:231]
s_waitcnt lgkmcnt(14)
ds_read_b64_tr_b16 a[130:131],v8 offset:50176
v_mfma_f32_16x16x32_bf16 a[232:235],a[240:243],v[240:243],a[232:235]
v_mfma_f32_16x16x32_bf16 a[232:235],a[240:243],v[244:247],a[232:235]
s_waitcnt lgkmcnt(14)
v_mfma_f32_16x16x32_bf16 a[236:239],a[240:243],v[248:251],a[236:239]
ds_read_b64_tr_b16 a[132:133],v8 offset:51200
v_mfma_f32_16x16x32_bf16 a[236:239],a[240:243],v[252:255],a[236:239]
s_waitcnt lgkmcnt(14)
ds_read_b64_tr_b16 a[134:135],v8 offset:52224
v_mfma_f32_16x16x32_bf16 v[80:83],a[96:99],v[248:251],v[80:83]
v_mfma_f32_16x16x32_bf16 v[80:83],a[100:103],v[252:255],v[80:83]
s_waitcnt lgkmcnt(14)
ds_read_b64_tr_b16 a[136:137],v8 offset:49160
v_mfma_f32_16x16x32_bf16 v[64:67],a[100:103],v[244:247],v[64:67]
s_waitcnt lgkmcnt(14)
ds_read_b64_tr_b16 a[138:139],v8 offset:50184
v_mfma_f32_16x16x32_bf16 v[64:67],a[96:99],v[240:243],v[64:67]
v_mfma_f32_16x16x32_bf16 v[48:51],a[96:99],v[232:235],v[48:51]
v_mfma_f32_16x16x32_bf16 v[48:51],a[100:103],v[236:239],v[48:51]
s_waitcnt lgkmcnt(14)
ds_read_b64_tr_b16 a[140:141],v8 offset:51208
v_mfma_f32_16x16x32_bf16 v[32:35],a[100:103],v[228:231],v[32:35]
s_waitcnt lgkmcnt(14)
ds_read_b64_tr_b16 a[142:143],v8 offset:52232
v_mfma_f32_16x16x32_bf16 v[32:35],a[96:99],v[224:227],v[32:35]
v_mfma_f32_16x16x32_bf16 v[36:39],a[104:107],v[224:227],v[36:39]
v_mfma_f32_16x16x32_bf16 v[36:39],a[108:111],v[228:231],v[36:39]
s_waitcnt lgkmcnt(14)
ds_read_b64_tr_b16 a[144:145],v9 offset:49152
v_mfma_f32_16x16x32_bf16 v[52:55],a[108:111],v[236:239],v[52:55]
s_waitcnt lgkmcnt(14)
ds_read_b64_tr_b16 a[146:147],v9 offset:50176
v_mfma_f32_16x16x32_bf16 v[52:55],a[104:107],v[232:235],v[52:55]
v_mfma_f32_16x16x32_bf16 v[68:71],a[104:107],v[240:243],v[68:71]
s_waitcnt lgkmcnt(14)
ds_read_b64_tr_b16 a[148:149],v9 offset:51200
v_mfma_f32_16x16x32_bf16 v[68:71],a[108:111],v[244:247],v[68:71]
s_waitcnt lgkmcnt(14)
ds_read_b64_tr_b16 a[150:151],v9 offset:52224
v_mfma_f32_16x16x32_bf16 v[84:87],a[108:111],v[252:255],v[84:87]
v_mfma_f32_16x16x32_bf16 v[84:87],a[104:107],v[248:251],v[84:87]
v_mfma_f32_16x16x32_bf16 v[88:91],a[112:115],v[248:251],v[88:91]
s_waitcnt lgkmcnt(14)
ds_read_b64_tr_b16 a[152:153],v9 offset:49160
v_mfma_f32_16x16x32_bf16 v[88:91],a[116:119],v[252:255],v[88:91]
s_waitcnt lgkmcnt(14)
ds_read_b64_tr_b16 a[154:155],v9 offset:50184
v_mfma_f32_16x16x32_bf16 v[72:75],a[116:119],v[244:247],v[72:75]
v_mfma_f32_16x16x32_bf16 v[72:75],a[112:115],v[240:243],v[72:75]
s_waitcnt lgkmcnt(14)
ds_read_b64_tr_b16 a[156:157],v9 offset:51208
v_mfma_f32_16x16x32_bf16 v[56:59],a[112:115],v[232:235],v[56:59]
s_waitcnt lgkmcnt(14)
ds_read_b64_tr_b16 a[158:159],v9 offset:52232
v_mfma_f32_16x16x32_bf16 v[56:59],a[116:119],v[236:239],v[56:59]
v_mfma_f32_16x16x32_bf16 v[40:43],a[116:119],v[228:231],v[40:43]
v_mfma_f32_16x16x32_bf16 v[40:43],a[112:115],v[224:227],v[40:43]
v_mfma_f32_16x16x32_bf16 v[44:47],a[120:123],v[224:227],v[44:47]
v_mfma_f32_16x16x32_bf16 v[44:47],a[124:127],v[228:231],v[44:47]
v_mfma_f32_16x16x32_bf16 v[60:63],a[124:127],v[236:239],v[60:63]
v_mfma_f32_16x16x32_bf16 v[60:63],a[120:123],v[232:235],v[60:63]
v_mfma_f32_16x16x32_bf16 v[76:79],a[120:123],v[240:243],v[76:79]
v_mfma_f32_16x16x32_bf16 v[76:79],a[124:127],v[244:247],v[76:79]
v_mfma_f32_16x16x32_bf16 v[92:95],a[124:127],v[252:255],v[92:95]
v_mfma_f32_16x16x32_bf16 v[92:95],a[120:123],v[248:251],v[92:95]
s_waitcnt lgkmcnt(12)
v_mfma_f32_16x16x32_bf16 v[144:147],a[128:131],v[248:251],v[144:147]
v_mfma_f32_16x16x32_bf16 v[144:147],a[132:135],v[252:255],v[144:147]
v_mfma_f32_16x16x32_bf16 v[128:131],a[132:135],v[244:247],v[128:131]
v_mfma_f32_16x16x32_bf16 v[128:131],a[128:131],v[240:243],v[128:131]
v_mfma_f32_16x16x32_bf16 v[112:115],a[128:131],v[232:235],v[112:115]
v_mfma_f32_16x16x32_bf16 v[112:115],a[132:135],v[236:239],v[112:115]
v_mfma_f32_16x16x32_bf16 v[96:99],a[132:135],v[228:231],v[96:99]
s_waitcnt lgkmcnt(8)
v_mfma_f32_16x16x32_bf16 v[96:99],a[128:131],v[224:227],v[96:99]
v_mfma_f32_16x16x32_bf16 v[100:103],a[136:139],v[224:227],v[100:103]
v_mfma_f32_16x16x32_bf16 v[100:103],a[140:143],v[228:231],v[100:103]
v_mfma_f32_16x16x32_bf16 v[116:119],a[140:143],v[236:239],v[116:119]
v_mfma_f32_16x16x32_bf16 v[116:119],a[136:139],v[232:235],v[116:119]
v_mfma_f32_16x16x32_bf16 v[132:135],a[136:139],v[240:243],v[132:135]
v_mfma_f32_16x16x32_bf16 v[132:135],a[140:143],v[244:247],v[132:135]
v_mfma_f32_16x16x32_bf16 v[148:151],a[140:143],v[252:255],v[148:151]
v_mfma_f32_16x16x32_bf16 v[148:151],a[136:139],v[248:251],v[148:151]
s_waitcnt lgkmcnt(4)
v_mfma_f32_16x16x32_bf16 v[152:155],a[144:147],v[248:251],v[152:155]
v_mfma_f32_16x16x32_bf16 v[152:155],a[148:151],v[252:255],v[152:155]
v_mfma_f32_16x16x32_bf16 v[136:139],a[148:151],v[244:247],v[136:139]
v_mfma_f32_16x16x32_bf16 v[136:139],a[144:147],v[240:243],v[136:139]
v_mfma_f32_16x16x32_bf16 v[120:123],a[144:147],v[232:235],v[120:123]
v_mfma_f32_16x16x32_bf16 v[120:123],a[148:151],v[236:239],v[120:123]
v_mfma_f32_16x16x32_bf16 v[104:107],a[148:151],v[228:231],v[104:107]
v_mfma_f32_16x16x32_bf16 v[104:107],a[144:147],v[224:227],v[104:107]
s_waitcnt lgkmcnt(0)
v_mfma_f32_16x16x32_bf16 v[108:111],a[152:155],v[224:227],v[108:111]
v_mfma_f32_16x16x32_bf16 v[108:111],a[156:159],v[228:231],v[108:111]
v_mfma_f32_16x16x32_bf16 v[124:127],a[156:159],v[236:239],v[124:127]
v_mfma_f32_16x16x32_bf16 v[124:127],a[152:155],v[232:235],v[124:127]
v_mfma_f32_16x16x32_bf16 v[140:143],a[152:155],v[240:243],v[140:143]
v_mfma_f32_16x16x32_bf16 v[140:143],a[156:159],v[244:247],v[140:143]
v_mfma_f32_16x16x32_bf16 v[156:159],a[156:159],v[252:255],v[156:159]
v_mfma_f32_16x16x32_bf16 v[156:159],a[152:155],v[248:251],v[156:159]
v_accvgpr_read_b32 v14,a224
v_accvgpr_read_b32 v15,a228
v_accvgpr_read_b32 v16,a232
v_accvgpr_read_b32 v17,a236
v_rcp_f32 v14,v14
v_rcp_f32 v15,v15
v_rcp_f32 v16,v16
v_rcp_f32 v17,v17
v_pk_mul_f32 v[32:33],v[32:33],v[14:15] op_sel_hi:[1,0]
v_pk_mul_f32 v[34:35],v[34:35],v[14:15] op_sel_hi:[1,0]
v_pk_mul_f32 v[36:37],v[36:37],v[14:15] op_sel_hi:[1,0]
v_pk_mul_f32 v[38:39],v[38:39],v[14:15] op_sel_hi:[1,0]
v_pk_mul_f32 v[40:41],v[40:41],v[14:15] op_sel_hi:[1,0]
v_pk_mul_f32 v[42:43],v[42:43],v[14:15] op_sel_hi:[1,0]
v_pk_mul_f32 v[44:45],v[44:45],v[14:15] op_sel_hi:[1,0]
v_pk_mul_f32 v[46:47],v[46:47],v[14:15] op_sel_hi:[1,0]
v_pk_mul_f32 v[48:49],v[48:49],v[14:15] op_sel:[0,1] op_sel_hi:[1,1]
v_pk_mul_f32 v[50:51],v[50:51],v[14:15] op_sel:[0,1] op_sel_hi:[1,1]
v_pk_mul_f32 v[52:53],v[52:53],v[14:15] op_sel:[0,1] op_sel_hi:[1,1]
v_pk_mul_f32 v[54:55],v[54:55],v[14:15] op_sel:[0,1] op_sel_hi:[1,1]
v_pk_mul_f32 v[56:57],v[56:57],v[14:15] op_sel:[0,1] op_sel_hi:[1,1]
v_pk_mul_f32 v[58:59],v[58:59],v[14:15] op_sel:[0,1] op_sel_hi:[1,1]
v_pk_mul_f32 v[60:61],v[60:61],v[14:15] op_sel:[0,1] op_sel_hi:[1,1]
v_pk_mul_f32 v[62:63],v[62:63],v[14:15] op_sel:[0,1] op_sel_hi:[1,1]
v_pk_mul_f32 v[64:65],v[64:65],v[16:17] op_sel_hi:[1,0]
v_pk_mul_f32 v[66:67],v[66:67],v[16:17] op_sel_hi:[1,0]
v_pk_mul_f32 v[68:69],v[68:69],v[16:17] op_sel_hi:[1,0]
v_pk_mul_f32 v[70:71],v[70:71],v[16:17] op_sel_hi:[1,0]
v_pk_mul_f32 v[72:73],v[72:73],v[16:17] op_sel_hi:[1,0]
v_pk_mul_f32 v[74:75],v[74:75],v[16:17] op_sel_hi:[1,0]
v_pk_mul_f32 v[76:77],v[76:77],v[16:17] op_sel_hi:[1,0]
v_pk_mul_f32 v[78:79],v[78:79],v[16:17] op_sel_hi:[1,0]
v_pk_mul_f32 v[80:81],v[80:81],v[16:17] op_sel:[0,1] op_sel_hi:[1,1]
v_pk_mul_f32 v[82:83],v[82:83],v[16:17] op_sel:[0,1] op_sel_hi:[1,1]
v_pk_mul_f32 v[84:85],v[84:85],v[16:17] op_sel:[0,1] op_sel_hi:[1,1]
v_pk_mul_f32 v[86:87],v[86:87],v[16:17] op_sel:[0,1] op_sel_hi:[1,1]
v_pk_mul_f32 v[88:89],v[88:89],v[16:17] op_sel:[0,1] op_sel_hi:[1,1]
v_pk_mul_f32 v[90:91],v[90:91],v[16:17] op_sel:[0,1] op_sel_hi:[1,1]
v_pk_mul_f32 v[92:93],v[92:93],v[16:17] op_sel:[0,1] op_sel_hi:[1,1]
v_pk_mul_f32 v[94:95],v[94:95],v[16:17] op_sel:[0,1] op_sel_hi:[1,1]
v_cvt_pk_bf16_f32 v32,v32,v33
v_cvt_pk_bf16_f32 v33,v34,v35
v_cvt_pk_bf16_f32 v34,v36,v37
v_cvt_pk_bf16_f32 v35,v38,v39
v_cvt_pk_bf16_f32 v40,v40,v41
v_cvt_pk_bf16_f32 v41,v42,v43
v_cvt_pk_bf16_f32 v42,v44,v45
v_cvt_pk_bf16_f32 v43,v46,v47
v_mov_b32 v36,v32
v_mov_b32 v37,v33
v_mov_b32 v38,v34
v_mov_b32 v39,v35
v_mov_b32_dpp v32,v40 row_shr:8 row_mask:0xf bank_mask:0xc
v_mov_b32_dpp v33,v41 row_shr:8 row_mask:0xf bank_mask:0xc
v_mov_b32_dpp v34,v42 row_shr:8 row_mask:0xf bank_mask:0xc
v_mov_b32_dpp v35,v43 row_shr:8 row_mask:0xf bank_mask:0xc
v_mov_b32_dpp v40,v36 row_shl:8 row_mask:0xf bank_mask:0x3
v_mov_b32_dpp v41,v37 row_shl:8 row_mask:0xf bank_mask:0x3
v_mov_b32_dpp v42,v38 row_shl:8 row_mask:0xf bank_mask:0x3
v_mov_b32_dpp v43,v39 row_shl:8 row_mask:0xf bank_mask:0x3
s_add_u32 s30,s24,0
buffer_store_dwordx4 v[32:35],v22,s[16:19],s30 offen sc0 sc1
s_add_u32 s30,s24,8192
buffer_store_dwordx4 v[40:43],v22,s[16:19],s30 offen sc0 sc1
v_cvt_pk_bf16_f32 v48,v48,v49
v_cvt_pk_bf16_f32 v49,v50,v51
v_cvt_pk_bf16_f32 v50,v52,v53
v_cvt_pk_bf16_f32 v51,v54,v55
v_cvt_pk_bf16_f32 v56,v56,v57
v_cvt_pk_bf16_f32 v57,v58,v59
v_cvt_pk_bf16_f32 v58,v60,v61
v_cvt_pk_bf16_f32 v59,v62,v63
v_mov_b32 v52,v48
v_mov_b32 v53,v49
v_mov_b32 v54,v50
v_mov_b32 v55,v51
v_mov_b32_dpp v48,v56 row_shr:8 row_mask:0xf bank_mask:0xc
v_mov_b32_dpp v49,v57 row_shr:8 row_mask:0xf bank_mask:0xc
v_mov_b32_dpp v50,v58 row_shr:8 row_mask:0xf bank_mask:0xc
v_mov_b32_dpp v51,v59 row_shr:8 row_mask:0xf bank_mask:0xc
v_mov_b32_dpp v56,v52 row_shl:8 row_mask:0xf bank_mask:0x3
v_mov_b32_dpp v57,v53 row_shl:8 row_mask:0xf bank_mask:0x3
v_mov_b32_dpp v58,v54 row_shl:8 row_mask:0xf bank_mask:0x3
v_mov_b32_dpp v59,v55 row_shl:8 row_mask:0xf bank_mask:0x3
s_add_u32 s30,s24,16384
buffer_store_dwordx4 v[48:51],v22,s[16:19],s30 offen sc0 sc1
s_add_u32 s30,s24,24576
buffer_store_dwordx4 v[56:59],v22,s[16:19],s30 offen sc0 sc1
v_cvt_pk_bf16_f32 v64,v64,v65
v_cvt_pk_bf16_f32 v65,v66,v67
v_cvt_pk_bf16_f32 v66,v68,v69
v_cvt_pk_bf16_f32 v67,v70,v71
v_cvt_pk_bf16_f32 v72,v72,v73
v_cvt_pk_bf16_f32 v73,v74,v75
v_cvt_pk_bf16_f32 v74,v76,v77
v_cvt_pk_bf16_f32 v75,v78,v79
v_mov_b32 v68,v64
v_mov_b32 v69,v65
v_mov_b32 v70,v66
v_mov_b32 v71,v67
v_mov_b32_dpp v64,v72 row_shr:8 row_mask:0xf bank_mask:0xc
v_mov_b32_dpp v65,v73 row_shr:8 row_mask:0xf bank_mask:0xc
v_mov_b32_dpp v66,v74 row_shr:8 row_mask:0xf bank_mask:0xc
v_mov_b32_dpp v67,v75 row_shr:8 row_mask:0xf bank_mask:0xc
v_mov_b32_dpp v72,v68 row_shl:8 row_mask:0xf bank_mask:0x3
v_mov_b32_dpp v73,v69 row_shl:8 row_mask:0xf bank_mask:0x3
v_mov_b32_dpp v74,v70 row_shl:8 row_mask:0xf bank_mask:0x3
v_mov_b32_dpp v75,v71 row_shl:8 row_mask:0xf bank_mask:0x3
s_add_u32 s30,s24,32768
buffer_store_dwordx4 v[64:67],v22,s[16:19],s30 offen sc0 sc1
s_add_u32 s30,s24,40960
buffer_store_dwordx4 v[72:75],v22,s[16:19],s30 offen sc0 sc1
v_cvt_pk_bf16_f32 v80,v80,v81
v_cvt_pk_bf16_f32 v81,v82,v83
v_cvt_pk_bf16_f32 v82,v84,v85
v_cvt_pk_bf16_f32 v83,v86,v87
v_cvt_pk_bf16_f32 v88,v88,v89
v_cvt_pk_bf16_f32 v89,v90,v91
v_cvt_pk_bf16_f32 v90,v92,v93
v_cvt_pk_bf16_f32 v91,v94,v95
v_mov_b32 v84,v80
v_mov_b32 v85,v81
v_mov_b32 v86,v82
v_mov_b32 v87,v83
v_mov_b32_dpp v80,v88 row_shr:8 row_mask:0xf bank_mask:0xc
v_mov_b32_dpp v81,v89 row_shr:8 row_mask:0xf bank_mask:0xc
v_mov_b32_dpp v82,v90 row_shr:8 row_mask:0xf bank_mask:0xc
v_mov_b32_dpp v83,v91 row_shr:8 row_mask:0xf bank_mask:0xc
v_mov_b32_dpp v88,v84 row_shl:8 row_mask:0xf bank_mask:0x3
v_mov_b32_dpp v89,v85 row_shl:8 row_mask:0xf bank_mask:0x3
v_mov_b32_dpp v90,v86 row_shl:8 row_mask:0xf bank_mask:0x3
v_mov_b32_dpp v91,v87 row_shl:8 row_mask:0xf bank_mask:0x3
s_add_u32 s30,s24,49152
buffer_store_dwordx4 v[80:83],v22,s[16:19],s30 offen sc0 sc1
s_add_u32 s30,s24,57344
buffer_store_dwordx4 v[88:91],v22,s[16:19],s30 offen sc0 sc1
v_pk_mul_f32 v[96:97],v[96:97],v[14:15] op_sel_hi:[1,0]
v_pk_mul_f32 v[98:99],v[98:99],v[14:15] op_sel_hi:[1,0]
v_pk_mul_f32 v[100:101],v[100:101],v[14:15] op_sel_hi:[1,0]
v_pk_mul_f32 v[102:103],v[102:103],v[14:15] op_sel_hi:[1,0]
v_pk_mul_f32 v[104:105],v[104:105],v[14:15] op_sel_hi:[1,0]
v_pk_mul_f32 v[106:107],v[106:107],v[14:15] op_sel_hi:[1,0]
v_pk_mul_f32 v[108:109],v[108:109],v[14:15] op_sel_hi:[1,0]
v_pk_mul_f32 v[110:111],v[110:111],v[14:15] op_sel_hi:[1,0]
v_pk_mul_f32 v[112:113],v[112:113],v[14:15] op_sel:[0,1] op_sel_hi:[1,1]
v_pk_mul_f32 v[114:115],v[114:115],v[14:15] op_sel:[0,1] op_sel_hi:[1,1]
v_pk_mul_f32 v[116:117],v[116:117],v[14:15] op_sel:[0,1] op_sel_hi:[1,1]
v_pk_mul_f32 v[118:119],v[118:119],v[14:15] op_sel:[0,1] op_sel_hi:[1,1]
v_pk_mul_f32 v[120:121],v[120:121],v[14:15] op_sel:[0,1] op_sel_hi:[1,1]
v_pk_mul_f32 v[122:123],v[122:123],v[14:15] op_sel:[0,1] op_sel_hi:[1,1]
v_pk_mul_f32 v[124:125],v[124:125],v[14:15] op_sel:[0,1] op_sel_hi:[1,1]
v_pk_mul_f32 v[126:127],v[126:127],v[14:15] op_sel:[0,1] op_sel_hi:[1,1]
v_pk_mul_f32 v[128:129],v[128:129],v[16:17] op_sel_hi:[1,0]
v_pk_mul_f32 v[130:131],v[130:131],v[16:17] op_sel_hi:[1,0]
v_pk_mul_f32 v[132:133],v[132:133],v[16:17] op_sel_hi:[1,0]
v_pk_mul_f32 v[134:135],v[134:135],v[16:17] op_sel_hi:[1,0]
v_pk_mul_f32 v[136:137],v[136:137],v[16:17] op_sel_hi:[1,0]
v_pk_mul_f32 v[138:139],v[138:139],v[16:17] op_sel_hi:[1,0]
v_pk_mul_f32 v[140:141],v[140:141],v[16:17] op_sel_hi:[1,0]
v_pk_mul_f32 v[142:143],v[142:143],v[16:17] op_sel_hi:[1,0]
v_pk_mul_f32 v[144:145],v[144:145],v[16:17] op_sel:[0,1] op_sel_hi:[1,1]
v_pk_mul_f32 v[146:147],v[146:147],v[16:17] op_sel:[0,1] op_sel_hi:[1,1]
v_pk_mul_f32 v[148:149],v[148:149],v[16:17] op_sel:[0,1] op_sel_hi:[1,1]
v_pk_mul_f32 v[150:151],v[150:151],v[16:17] op_sel:[0,1] op_sel_hi:[1,1]
v_pk_mul_f32 v[152:153],v[152:153],v[16:17] op_sel:[0,1] op_sel_hi:[1,1]
v_pk_mul_f32 v[154:155],v[154:155],v[16:17] op_sel:[0,1] op_sel_hi:[1,1]
v_pk_mul_f32 v[156:157],v[156:157],v[16:17] op_sel:[0,1] op_sel_hi:[1,1]
v_pk_mul_f32 v[158:159],v[158:159],v[16:17] op_sel:[0,1] op_sel_hi:[1,1]
v_cvt_pk_bf16_f32 v96,v96,v97
v_cvt_pk_bf16_f32 v97,v98,v99
v_cvt_pk_bf16_f32 v98,v100,v101
v_cvt_pk_bf16_f32 v99,v102,v103
v_cvt_pk_bf16_f32 v104,v104,v105
v_cvt_pk_bf16_f32 v105,v106,v107
v_cvt_pk_bf16_f32 v106,v108,v109
v_cvt_pk_bf16_f32 v107,v110,v111
v_mov_b32 v100,v96
v_mov_b32 v101,v97
v_mov_b32 v102,v98
v_mov_b32 v103,v99
v_mov_b32_dpp v96,v104 row_shr:8 row_mask:0xf bank_mask:0xc
v_mov_b32_dpp v97,v105 row_shr:8 row_mask:0xf bank_mask:0xc
v_mov_b32_dpp v98,v106 row_shr:8 row_mask:0xf bank_mask:0xc
v_mov_b32_dpp v99,v107 row_shr:8 row_mask:0xf bank_mask:0xc
v_mov_b32_dpp v104,v100 row_shl:8 row_mask:0xf bank_mask:0x3
v_mov_b32_dpp v105,v101 row_shl:8 row_mask:0xf bank_mask:0x3
v_mov_b32_dpp v106,v102 row_shl:8 row_mask:0xf bank_mask:0x3
v_mov_b32_dpp v107,v103 row_shl:8 row_mask:0xf bank_mask:0x3
s_add_u32 s30,s24,0
buffer_store_dwordx4 v[96:99],v22,s[16:19],s30 offen offset:128 sc0 sc1
s_add_u32 s30,s24,8192
buffer_store_dwordx4 v[104:107],v22,s[16:19],s30 offen offset:128 sc0 sc1
v_cvt_pk_bf16_f32 v112,v112,v113
v_cvt_pk_bf16_f32 v113,v114,v115
v_cvt_pk_bf16_f32 v114,v116,v117
v_cvt_pk_bf16_f32 v115,v118,v119
v_cvt_pk_bf16_f32 v120,v120,v121
v_cvt_pk_bf16_f32 v121,v122,v123
v_cvt_pk_bf16_f32 v122,v124,v125
v_cvt_pk_bf16_f32 v123,v126,v127
v_mov_b32 v116,v112
v_mov_b32 v117,v113
v_mov_b32 v118,v114
v_mov_b32 v119,v115
v_mov_b32_dpp v112,v120 row_shr:8 row_mask:0xf bank_mask:0xc
v_mov_b32_dpp v113,v121 row_shr:8 row_mask:0xf bank_mask:0xc
v_mov_b32_dpp v114,v122 row_shr:8 row_mask:0xf bank_mask:0xc
v_mov_b32_dpp v115,v123 row_shr:8 row_mask:0xf bank_mask:0xc
v_mov_b32_dpp v120,v116 row_shl:8 row_mask:0xf bank_mask:0x3
v_mov_b32_dpp v121,v117 row_shl:8 row_mask:0xf bank_mask:0x3
v_mov_b32_dpp v122,v118 row_shl:8 row_mask:0xf bank_mask:0x3
v_mov_b32_dpp v123,v119 row_shl:8 row_mask:0xf bank_mask:0x3
s_add_u32 s30,s24,16384
buffer_store_dwordx4 v[112:115],v22,s[16:19],s30 offen offset:128 sc0 sc1
s_add_u32 s30,s24,24576
buffer_store_dwordx4 v[120:123],v22,s[16:19],s30 offen offset:128 sc0 sc1
v_cvt_pk_bf16_f32 v128,v128,v129
v_cvt_pk_bf16_f32 v129,v130,v131
v_cvt_pk_bf16_f32 v130,v132,v133
v_cvt_pk_bf16_f32 v131,v134,v135
v_cvt_pk_bf16_f32 v136,v136,v137
v_cvt_pk_bf16_f32 v137,v138,v139
v_cvt_pk_bf16_f32 v138,v140,v141
v_cvt_pk_bf16_f32 v139,v142,v143
v_mov_b32 v132,v128
v_mov_b32 v133,v129
v_mov_b32 v134,v130
v_mov_b32 v135,v131
v_mov_b32_dpp v128,v136 row_shr:8 row_mask:0xf bank_mask:0xc
v_mov_b32_dpp v129,v137 row_shr:8 row_mask:0xf bank_mask:0xc
v_mov_b32_dpp v130,v138 row_shr:8 row_mask:0xf bank_mask:0xc
v_mov_b32_dpp v131,v139 row_shr:8 row_mask:0xf bank_mask:0xc
v_mov_b32_dpp v136,v132 row_shl:8 row_mask:0xf bank_mask:0x3
v_mov_b32_dpp v137,v133 row_shl:8 row_mask:0xf bank_mask:0x3
v_mov_b32_dpp v138,v134 row_shl:8 row_mask:0xf bank_mask:0x3
v_mov_b32_dpp v139,v135 row_shl:8 row_mask:0xf bank_mask:0x3
s_add_u32 s30,s24,32768
buffer_store_dwordx4 v[128:131],v22,s[16:19],s30 offen offset:128 sc0 sc1
s_add_u32 s30,s24,40960
buffer_store_dwordx4 v[136:139],v22,s[16:19],s30 offen offset:128 sc0 sc1
v_cvt_pk_bf16_f32 v144,v144,v145
v_cvt_pk_bf16_f32 v145,v146,v147
v_cvt_pk_bf16_f32 v146,v148,v149
v_cvt_pk_bf16_f32 v147,v150,v151
v_cvt_pk_bf16_f32 v152,v152,v153
v_cvt_pk_bf16_f32 v153,v154,v155
v_cvt_pk_bf16_f32 v154,v156,v157
v_cvt_pk_bf16_f32 v155,v158,v159
v_mov_b32 v148,v144
v_mov_b32 v149,v145
v_mov_b32 v150,v146
v_mov_b32 v151,v147
v_mov_b32_dpp v144,v152 row_shr:8 row_mask:0xf bank_mask:0xc
v_mov_b32_dpp v145,v153 row_shr:8 row_mask:0xf bank_mask:0xc
v_mov_b32_dpp v146,v154 row_shr:8 row_mask:0xf bank_mask:0xc
v_mov_b32_dpp v147,v155 row_shr:8 row_mask:0xf bank_mask:0xc
v_mov_b32_dpp v152,v148 row_shl:8 row_mask:0xf bank_mask:0x3
v_mov_b32_dpp v153,v149 row_shl:8 row_mask:0xf bank_mask:0x3
v_mov_b32_dpp v154,v150 row_shl:8 row_mask:0xf bank_mask:0x3
v_mov_b32_dpp v155,v151 row_shl:8 row_mask:0xf bank_mask:0x3
s_add_u32 s30,s24,49152
buffer_store_dwordx4 v[144:147],v22,s[16:19],s30 offen offset:128 sc0 sc1
s_add_u32 s30,s24,57344
buffer_store_dwordx4 v[152:155],v22,s[16:19],s30 offen offset:128 sc0 sc1
s_add_u32 s24,s24,65536
s_branch L_safe
L_end:
s_endpgm
.p2align 8
L_v1:
ds_read_b128 a[96:99],v2 offset:0
ds_read_b128 a[100:103],v3 offset:0
s_add_u32 s30,s24,49152
s_add_u32 s32,s24,53248
ds_read_b128 a[104:107],v4 offset:0
buffer_store_dwordx4 v[144:147],v22,s[16:19],s30 offen sc0 sc1
buffer_store_dwordx4 v[148:151],v22,s[16:19],s32 offen sc0 sc1
ds_read_b128 a[108:111],v5 offset:0
ds_read_b128 a[112:115],v2 offset:1024
ds_read_b128 a[116:119],v3 offset:1024
ds_read_b128 a[120:123],v4 offset:1024
s_add_u32 s30,s24,57344
s_add_u32 s32,s24,61440
buffer_store_dwordx4 v[152:155],v22,s[16:19],s30 offen sc0 sc1
buffer_store_dwordx4 v[156:159],v22,s[16:19],s32 offen sc0 sc1
ds_read_b128 a[124:127],v5 offset:1024
s_waitcnt lgkmcnt(4)
v_mfma_f32_16x16x32_bf16 v[160:163],a[96:99],a[0:3],0
ds_read_b128 a[128:131],v2 offset:2048
v_mfma_f32_16x16x32_bf16 v[160:163],a[100:103],a[4:7],v[160:163]
v_mfma_f32_16x16x32_bf16 v[160:163],a[104:107],a[8:11],v[160:163]
s_add_u32 m0,s25,32768
v_mfma_f32_16x16x32_bf16 v[160:163],a[108:111],a[12:15],v[160:163]
buffer_load_dwordx4 v1,s[8:11],s21 offen nt lds
v_mfma_f32_16x16x32_bf16 v[168:171],a[108:111],a[28:31],0
ds_read_b128 a[132:135],v3 offset:2048
v_mfma_f32_16x16x32_bf16 v[168:171],a[104:107],a[24:27],v[168:171]
v_mfma_f32_16x16x32_bf16 v[168:171],a[100:103],a[20:23],v[168:171]
v_mfma_f32_16x16x32_bf16 v[168:171],a[96:99],a[16:19],v[168:171]
v_mfma_f32_16x16x32_bf16 v[176:179],a[96:99],a[32:35],0
ds_read_b128 a[136:139],v4 offset:2048
v_mfma_f32_16x16x32_bf16 v[176:179],a[100:103],a[36:39],v[176:179]
v_mfma_f32_16x16x32_bf16 v[176:179],a[104:107],a[40:43],v[176:179]
v_mfma_f32_16x16x32_bf16 v[176:179],a[108:111],a[44:47],v[176:179]
ds_read_b128 a[140:143],v5 offset:2048
v_mfma_f32_16x16x32_bf16 v[184:187],a[108:111],a[60:63],0
v_mfma_f32_16x16x32_bf16 v[184:187],a[104:107],a[56:59],v[184:187]
v_mfma_f32_16x16x32_bf16 v[184:187],a[100:103],a[52:55],v[184:187]
s_waitcnt lgkmcnt(4)
v_mfma_f32_16x16x32_bf16 v[184:187],a[96:99],a[48:51],v[184:187]
ds_read_b128 a[144:147],v2 offset:3072
v_mfma_f32_16x16x32_bf16 v[164:167],a[112:115],a[0:3],0
v_mfma_f32_16x16x32_bf16 v[164:167],a[116:119],a[4:7],v[164:167]
v_mfma_f32_16x16x32_bf16 v[164:167],a[120:123],a[8:11],v[164:167]
v_mfma_f32_16x16x32_bf16 v[164:167],a[124:127],a[12:15],v[164:167]
ds_read_b128 a[148:151],v3 offset:3072
v_mfma_f32_16x16x32_bf16 v[172:175],a[124:127],a[28:31],0
v_mfma_f32_16x16x32_bf16 v[172:175],a[120:123],a[24:27],v[172:175]
v_mfma_f32_16x16x32_bf16 v[172:175],a[116:119],a[20:23],v[172:175]
ds_read_b128 a[152:155],v4 offset:3072
v_mfma_f32_16x16x32_bf16 v[172:175],a[112:115],a[16:19],v[172:175]
buffer_load_dwordx4 v1,s[8:11],s21 offen offset:1024 nt lds
v_mfma_f32_16x16x32_bf16 v[180:183],a[112:115],a[32:35],0
v_mfma_f32_16x16x32_bf16 v[180:183],a[116:119],a[36:39],v[180:183]
v_mfma_f32_16x16x32_bf16 v[180:183],a[120:123],a[40:43],v[180:183]
ds_read_b128 a[156:159],v5 offset:3072
v_mfma_f32_16x16x32_bf16 v[180:183],a[124:127],a[44:47],v[180:183]
v_mfma_f32_16x16x32_bf16 v[188:191],a[124:127],a[60:63],0
v_mfma_f32_16x16x32_bf16 v[188:191],a[120:123],a[56:59],v[188:191]
v_mfma_f32_16x16x32_bf16 v[188:191],a[116:119],a[52:55],v[188:191]
v_mfma_f32_16x16x32_bf16 v[188:191],a[112:115],a[48:51],v[188:191]
s_waitcnt lgkmcnt(4)
v_mfma_f32_16x16x32_bf16 v[192:195],a[128:131],a[0:3],0
v_mfma_f32_16x16x32_bf16 v[192:195],a[132:135],a[4:7],v[192:195]
v_mfma_f32_16x16x32_bf16 v[192:195],a[136:139],a[8:11],v[192:195]
v_mfma_f32_16x16x32_bf16 v[192:195],a[140:143],a[12:15],v[192:195]
buffer_load_dwordx4 v1,s[8:11],s21 offen offset:2048 nt lds
v_max3_f32 v23,v160,v161,v162
v_max3_f32 v24,v168,v169,v170
v_max3_f32 v25,v176,v177,v178
v_max3_f32 v26,v184,v185,v186
v_mfma_f32_16x16x32_bf16 v[200:203],a[140:143],a[28:31],0
v_max3_f32 v23,v23,v163,v164
v_max3_f32 v24,v24,v171,v172
v_mfma_f32_16x16x32_bf16 v[200:203],a[136:139],a[24:27],v[200:203]
v_max3_f32 v25,v25,v179,v180
v_mfma_f32_16x16x32_bf16 v[200:203],a[132:135],a[20:23],v[200:203]
v_max3_f32 v26,v26,v187,v188
v_mfma_f32_16x16x32_bf16 v[200:203],a[128:131],a[16:19],v[200:203]
v_max3_f32 v23,v23,v165,v166
v_max3_f32 v24,v24,v173,v174
v_max3_f32 v25,v25,v181,v182
v_max3_f32 v26,v26,v189,v190
v_mfma_f32_16x16x32_bf16 v[208:211],a[128:131],a[32:35],0
v_max_f32 v23,v23,v167
v_mfma_f32_16x16x32_bf16 v[208:211],a[132:135],a[36:39],v[208:211]
v_max_f32 v24,v24,v175
v_mfma_f32_16x16x32_bf16 v[208:211],a[136:139],a[40:43],v[208:211]
v_max_f32 v25,v25,v183
v_max_f32 v26,v26,v191
v_mfma_f32_16x16x32_bf16 v[208:211],a[140:143],a[44:47],v[208:211]
buffer_load_dwordx4 v1,s[8:11],s21 offen offset:3072 nt lds
v_mov_b32 v27,v23
v_mov_b32 v28,v24
v_mov_b32 v29,v25
v_mov_b32 v30,v26
v_mfma_f32_16x16x32_bf16 v[216:219],a[140:143],a[60:63],0
s_add_u32 s21,s21,16384
v_mfma_f32_16x16x32_bf16 v[216:219],a[136:139],a[56:59],v[216:219]
v_permlane16_swap_b32 v23,v27
v_mfma_f32_16x16x32_bf16 v[216:219],a[132:135],a[52:55],v[216:219]
v_permlane16_swap_b32 v24,v28
v_permlane16_swap_b32 v25,v29
v_mfma_f32_16x16x32_bf16 v[216:219],a[128:131],a[48:51],v[216:219]
s_waitcnt lgkmcnt(0)
v_permlane16_swap_b32 v26,v30
v_max_f32 v23,v23,v27
v_max_f32 v24,v24,v28
v_max_f32 v25,v25,v29
v_mfma_f32_16x16x32_bf16 v[196:199],a[144:147],a[0:3],0
v_max_f32 v26,v26,v30
v_mfma_f32_16x16x32_bf16 v[196:199],a[148:151],a[4:7],v[196:199]
v_mov_b32 v27,v23
v_mfma_f32_16x16x32_bf16 v[196:199],a[152:155],a[8:11],v[196:199]
v_mov_b32 v28,v24
v_mov_b32 v29,v25
v_mfma_f32_16x16x32_bf16 v[196:199],a[156:159],a[12:15],v[196:199]
v_mov_b32 v30,v26
v_permlane32_swap_b32 v23,v27
v_permlane32_swap_b32 v24,v28
v_permlane32_swap_b32 v25,v29
v_mfma_f32_16x16x32_bf16 v[204:207],a[156:159],a[28:31],0
v_permlane32_swap_b32 v26,v30
v_mfma_f32_16x16x32_bf16 v[204:207],a[152:155],a[24:27],v[204:207]
v_max_f32 v23,v23,v27
v_max_f32 v24,v24,v28
v_mfma_f32_16x16x32_bf16 v[204:207],a[148:151],a[20:23],v[204:207]
v_max_f32 v25,v25,v29
v_max_f32 v26,v26,v30
v_mfma_f32_16x16x32_bf16 v[204:207],a[144:147],a[16:19],v[204:207]
v_mul_f32 v18,s26,v23
v_mul_f32 v19,s26,v24
v_mul_f32 v20,s26,v25
v_mul_f32 v21,s26,v26
v_mfma_f32_16x16x32_bf16 v[212:215],a[144:147],a[32:35],0
v_fma_f32 v160,v160,s26,-v18
v_mfma_f32_16x16x32_bf16 v[212:215],a[148:151],a[36:39],v[212:215]
v_exp_f32 v160,v160
v_mfma_f32_16x16x32_bf16 v[212:215],a[152:155],a[40:43],v[212:215]
v_fma_f32 v161,v161,s26,-v18
v_fma_f32 v162,v162,s26,-v18
v_mfma_f32_16x16x32_bf16 v[212:215],a[156:159],a[44:47],v[212:215]
v_exp_f32 v161,v161
v_fma_f32 v163,v163,s26,-v18
v_exp_f32 v162,v162
v_mfma_f32_16x16x32_bf16 v[220:223],a[156:159],a[60:63],0
v_cvt_pk_bf16_f32 v160,v160,v161
v_mfma_f32_16x16x32_bf16 v[220:223],a[152:155],a[56:59],v[220:223]
v_exp_f32 v163,v163
v_mfma_f32_16x16x32_bf16 v[220:223],a[148:151],a[52:55],v[220:223]
v_fma_f32 v164,v164,s26,-v18
v_mfma_f32_16x16x32_bf16 v[220:223],a[144:147],a[48:51],v[220:223]
v_fma_f32 v165,v165,s26,-v18
v_exp_f32 v164,v164
v_cvt_pk_bf16_f32 v161,v162,v163
v_fma_f32 v166,v166,s26,-v18
v_exp_f32 v165,v165
v_fma_f32 v167,v167,s26,-v18
v_exp_f32 v166,v166
v_cvt_pk_bf16_f32 v162,v164,v165
v_fma_f32 v168,v168,s26,-v19
v_fma_f32 v169,v169,s26,-v19
v_exp_f32 v167,v167
v_exp_f32 v168,v168
v_fma_f32 v170,v170,s26,-v19
v_exp_f32 v169,v169
v_cvt_pk_bf16_f32 v163,v166,v167
v_exp_f32 v170,v170
v_fma_f32 v171,v171,s26,-v19
v_cvt_pk_bf16_f32 v168,v168,v169
v_fma_f32 v172,v172,s26,-v19
v_exp_f32 v171,v171
v_fma_f32 v173,v173,s26,-v19
v_exp_f32 v172,v172
v_exp_f32 v173,v173
v_cvt_pk_bf16_f32 v169,v170,v171
v_fma_f32 v174,v174,s26,-v19
v_fma_f32 v175,v175,s26,-v19
v_cvt_pk_bf16_f32 v170,v172,v173
v_exp_f32 v174,v174
v_exp_f32 v175,v175
v_fma_f32 v176,v176,s26,-v20
v_exp_f32 v176,v176
v_fma_f32 v177,v177,s26,-v20
v_cvt_pk_bf16_f32 v171,v174,v175
v_fma_f32 v178,v178,s26,-v20
v_fma_f32 v179,v179,s26,-v20
v_exp_f32 v177,v177
v_exp_f32 v178,v178
v_exp_f32 v179,v179
v_cvt_pk_bf16_f32 v176,v176,v177
v_fma_f32 v180,v180,s26,-v20
v_fma_f32 v181,v181,s26,-v20
v_cvt_pk_bf16_f32 v177,v178,v179
v_exp_f32 v180,v180
v_exp_f32 v181,v181
v_fma_f32 v182,v182,s26,-v20
v_fma_f32 v183,v183,s26,-v20
v_exp_f32 v182,v182
v_exp_f32 v183,v183
v_cvt_pk_bf16_f32 v178,v180,v181
v_fma_f32 v184,v184,s26,-v21
v_fma_f32 v185,v185,s26,-v21
v_cvt_pk_bf16_f32 v179,v182,v183
v_fma_f32 v186,v186,s26,-v21
v_exp_f32 v184,v184
v_exp_f32 v185,v185
v_fma_f32 v187,v187,s26,-v21
v_exp_f32 v186,v186
v_cvt_pk_bf16_f32 v184,v184,v185
v_exp_f32 v187,v187
v_fma_f32 v188,v188,s26,-v21
v_exp_f32 v188,v188
v_fma_f32 v189,v189,s26,-v21
v_cvt_pk_bf16_f32 v185,v186,v187
v_fma_f32 v190,v190,s26,-v21
v_fma_f32 v191,v191,s26,-v21
v_exp_f32 v189,v189
s_nop 0
v_cvt_pk_bf16_f32 v186,v188,v189
v_exp_f32 v190,v190
v_exp_f32 v191,v191
s_nop 0
v_cvt_pk_bf16_f32 v187,v190,v191
v_fma_f32 v192,v192,s26,-v18
v_fma_f32 v193,v193,s26,-v18
v_exp_f32 v192,v192
v_exp_f32 v193,v193
v_fma_f32 v194,v194,s26,-v18
v_fma_f32 v195,v195,s26,-v18
v_exp_f32 v194,v194
v_cvt_pk_bf16_f32 v164,v192,v193
v_exp_f32 v195,v195
v_fma_f32 v200,v200,s26,-v19
v_fma_f32 v201,v201,s26,-v19
v_exp_f32 v200,v200
v_exp_f32 v201,v201
v_cvt_pk_bf16_f32 v165,v194,v195
s_add_u32 m0,s25,81920
s_nop 0
buffer_load_dwordx4 v1,s[12:15],s22 offen nt lds
buffer_load_dwordx4 v1,s[12:15],s22 offen offset:1024 nt lds
buffer_load_dwordx4 v1,s[12:15],s22 offen offset:2048 nt lds
buffer_load_dwordx4 v1,s[12:15],s22 offen offset:3072 nt lds
s_add_u32 s22,s22,16384
s_add_u32 m0,s25,147456
s_nop 0
buffer_load_dwordx4 v1,s[4:7],s23 offen nt lds
buffer_load_dwordx4 v1,s[4:7],s23 offen offset:1024 nt lds
buffer_load_dwordx4 v1,s[4:7],s23 offen offset:2048 nt lds
buffer_load_dwordx4 v1,s[4:7],s23 offen offset:3072 nt lds
s_add_u32 s23,s23,16384
v_cvt_pk_bf16_f32 v172,v200,v201
v_fma_f32 v202,v202,s26,-v19
v_fma_f32 v203,v203,s26,-v19
v_exp_f32 v202,v202
v_exp_f32 v203,v203
s_nop 0
v_cvt_pk_bf16_f32 v173,v202,v203
v_fma_f32 v208,v208,s26,-v20
v_fma_f32 v209,v209,s26,-v20
v_exp_f32 v208,v208
v_exp_f32 v209,v209
s_nop 0
v_cvt_pk_bf16_f32 v180,v208,v209
v_fma_f32 v210,v210,s26,-v20
v_fma_f32 v211,v211,s26,-v20
v_exp_f32 v210,v210
v_exp_f32 v211,v211
s_nop 0
v_cvt_pk_bf16_f32 v181,v210,v211
v_fma_f32 v216,v216,s26,-v21
v_fma_f32 v217,v217,s26,-v21
v_exp_f32 v216,v216
v_exp_f32 v217,v217
v_fma_f32 v218,v218,s26,-v21
v_cvt_pk_bf16_f32 v188,v216,v217
v_fma_f32 v219,v219,s26,-v21
v_exp_f32 v218,v218
v_exp_f32 v219,v219
s_nop 0
v_cvt_pk_bf16_f32 v189,v218,v219
v_fma_f32 v196,v196,s26,-v18
v_fma_f32 v197,v197,s26,-v18
v_exp_f32 v196,v196
v_exp_f32 v197,v197
v_fma_f32 v198,v198,s26,-v18
v_fma_f32 v199,v199,s26,-v18
v_exp_f32 v198,v198
v_cvt_pk_bf16_f32 v166,v196,v197
v_exp_f32 v199,v199
s_nop 0
v_cvt_pk_bf16_f32 v167,v198,v199
v_fma_f32 v204,v204,s26,-v19
v_fma_f32 v205,v205,s26,-v19
v_exp_f32 v204,v204
v_exp_f32 v205,v205
s_waitcnt vmcnt(20)
s_barrier
ds_read_b128 a[96:99],v2 offset:16384
ds_read_b128 a[100:103],v3 offset:16384
ds_read_b128 a[104:107],v4 offset:16384
ds_read_b128 a[108:111],v5 offset:16384
ds_read_b128 a[112:115],v2 offset:17408
ds_read_b128 a[116:119],v3 offset:17408
ds_read_b128 a[120:123],v4 offset:17408
ds_read_b128 a[124:127],v5 offset:17408
s_waitcnt lgkmcnt(4)
v_mfma_f32_16x16x32_bf16 v[224:227],a[96:99],a[0:3],0
ds_read_b128 a[128:131],v2 offset:18432
v_mfma_f32_16x16x32_bf16 v[224:227],a[100:103],a[4:7],v[224:227]
v_cvt_pk_bf16_f32 v174,v204,v205
v_mfma_f32_16x16x32_bf16 v[224:227],a[104:107],a[8:11],v[224:227]
v_mfma_f32_16x16x32_bf16 v[224:227],a[108:111],a[12:15],v[224:227]
v_fma_f32 v206,v206,s26,-v19
v_fma_f32 v207,v207,s26,-v19
v_mfma_f32_16x16x32_bf16 v[232:235],a[108:111],a[28:31],0
ds_read_b128 a[132:135],v3 offset:18432
v_mfma_f32_16x16x32_bf16 v[232:235],a[104:107],a[24:27],v[232:235]
v_exp_f32 v206,v206
v_mfma_f32_16x16x32_bf16 v[232:235],a[100:103],a[20:23],v[232:235]
v_exp_f32 v207,v207
v_mfma_f32_16x16x32_bf16 v[232:235],a[96:99],a[16:19],v[232:235]
v_cvt_pk_bf16_f32 v175,v206,v207
v_fma_f32 v224,v224,s26,-v18
v_fma_f32 v225,v225,s26,-v18
v_fma_f32 v212,v212,s26,-v20
v_fma_f32 v213,v213,s26,-v20
v_mfma_f32_16x16x32_bf16 v[240:243],a[96:99],a[32:35],0
ds_read_b128 a[136:139],v4 offset:18432
v_mfma_f32_16x16x32_bf16 v[240:243],a[100:103],a[36:39],v[240:243]
v_exp_f32 v224,v224
v_mfma_f32_16x16x32_bf16 v[240:243],a[104:107],a[40:43],v[240:243]
v_exp_f32 v225,v225
v_mfma_f32_16x16x32_bf16 v[240:243],a[108:111],a[44:47],v[240:243]
ds_read_b128 a[140:143],v5 offset:18432
v_exp_f32 v212,v212
v_exp_f32 v213,v213
v_mfma_f32_16x16x32_bf16 v[248:251],a[108:111],a[60:63],0
v_mfma_f32_16x16x32_bf16 v[248:251],a[104:107],a[56:59],v[248:251]
v_mfma_f32_16x16x32_bf16 v[248:251],a[100:103],a[52:55],v[248:251]
s_waitcnt lgkmcnt(4)
v_mfma_f32_16x16x32_bf16 v[248:251],a[96:99],a[48:51],v[248:251]
ds_read_b128 a[144:147],v2 offset:19456
v_cvt_pk_bf16_f32 v182,v212,v213
v_fma_f32 v226,v226,s26,-v18
v_fma_f32 v227,v227,s26,-v18
v_fma_f32 v214,v214,s26,-v20
v_fma_f32 v215,v215,s26,-v20
v_mfma_f32_16x16x32_bf16 v[228:231],a[112:115],a[0:3],0
v_exp_f32 v226,v226
v_mfma_f32_16x16x32_bf16 v[228:231],a[116:119],a[4:7],v[228:231]
v_exp_f32 v227,v227
v_mfma_f32_16x16x32_bf16 v[228:231],a[120:123],a[8:11],v[228:231]
v_exp_f32 v214,v214
v_mfma_f32_16x16x32_bf16 v[228:231],a[124:127],a[12:15],v[228:231]
ds_read_b128 a[148:151],v3 offset:19456
v_exp_f32 v215,v215
v_mfma_f32_16x16x32_bf16 v[236:239],a[124:127],a[28:31],0
v_mfma_f32_16x16x32_bf16 v[236:239],a[120:123],a[24:27],v[236:239]
v_mfma_f32_16x16x32_bf16 v[236:239],a[116:119],a[20:23],v[236:239]
ds_read_b128 a[152:155],v4 offset:19456
v_cvt_pk_bf16_f32 v224,v224,v225
v_mfma_f32_16x16x32_bf16 v[236:239],a[112:115],a[16:19],v[236:239]
v_cvt_pk_bf16_f32 v225,v226,v227
v_cvt_pk_bf16_f32 v183,v214,v215
v_fma_f32 v228,v228,s26,-v18
v_fma_f32 v229,v229,s26,-v18
v_fma_f32 v220,v220,s26,-v21
v_mfma_f32_16x16x32_bf16 v[244:247],a[112:115],a[32:35],0
v_exp_f32 v228,v228
v_mfma_f32_16x16x32_bf16 v[244:247],a[116:119],a[36:39],v[244:247]
v_exp_f32 v229,v229
v_mfma_f32_16x16x32_bf16 v[244:247],a[120:123],a[40:43],v[244:247]
s_add_u32 m0,s25,49152
ds_read_b128 a[156:159],v5 offset:19456
v_mfma_f32_16x16x32_bf16 v[244:247],a[124:127],a[44:47],v[244:247]
buffer_load_dwordx4 v1,s[8:11],s21 offen nt lds
v_fma_f32 v221,v221,s26,-v21
v_exp_f32 v220,v220
v_mfma_f32_16x16x32_bf16 v[252:255],a[124:127],a[60:63],0
v_exp_f32 v221,v221
v_mfma_f32_16x16x32_bf16 v[252:255],a[120:123],a[56:59],v[252:255]
v_mfma_f32_16x16x32_bf16 v[252:255],a[116:119],a[52:55],v[252:255]
v_mfma_f32_16x16x32_bf16 v[252:255],a[112:115],a[48:51],v[252:255]
s_waitcnt lgkmcnt(4)
v_cvt_pk_bf16_f32 v226,v228,v229
v_cvt_pk_bf16_f32 v190,v220,v221
v_fma_f32 v230,v230,s26,-v18
v_fma_f32 v231,v231,s26,-v18
v_mfma_f32_16x16x32_bf16 v[192:195],a[128:131],a[0:3],0
v_exp_f32 v230,v230
v_mfma_f32_16x16x32_bf16 v[192:195],a[132:135],a[4:7],v[192:195]
v_exp_f32 v231,v231
v_mfma_f32_16x16x32_bf16 v[192:195],a[136:139],a[8:11],v[192:195]
v_fma_f32 v222,v222,s26,-v21
v_mfma_f32_16x16x32_bf16 v[192:195],a[140:143],a[12:15],v[192:195]
buffer_load_dwordx4 v1,s[8:11],s21 offen offset:1024 nt lds
v_fma_f32 v223,v223,s26,-v21
v_exp_f32 v222,v222
v_mfma_f32_16x16x32_bf16 v[200:203],a[140:143],a[28:31],0
v_exp_f32 v223,v223
v_mfma_f32_16x16x32_bf16 v[200:203],a[136:139],a[24:27],v[200:203]
s_waitcnt vmcnt(18)
s_barrier
ds_read_b64_tr_b16 a[96:97],v8 offset:0
v_mfma_f32_16x16x32_bf16 v[200:203],a[132:135],a[20:23],v[200:203]
ds_read_b64_tr_b16 a[98:99],v8 offset:1024
v_mfma_f32_16x16x32_bf16 v[200:203],a[128:131],a[16:19],v[200:203]
buffer_load_dwordx4 v1,s[8:11],s21 offen offset:2048 nt lds
v_cvt_pk_bf16_f32 v227,v230,v231
v_cvt_pk_bf16_f32 v191,v222,v223
v_mfma_f32_16x16x32_bf16 v[208:211],a[128:131],a[32:35],0
ds_read_b64_tr_b16 a[100:101],v8 offset:2048
v_fma_f32 v232,v232,s26,-v19
v_mfma_f32_16x16x32_bf16 v[208:211],a[132:135],a[36:39],v[208:211]
ds_read_b64_tr_b16 a[102:103],v8 offset:3072
v_fma_f32 v233,v233,s26,-v19
v_mfma_f32_16x16x32_bf16 v[208:211],a[136:139],a[40:43],v[208:211]
v_exp_f32 v232,v232
v_mfma_f32_16x16x32_bf16 v[208:211],a[140:143],a[44:47],v[208:211]
buffer_load_dwordx4 v1,s[8:11],s21 offen offset:3072 nt lds
v_exp_f32 v233,v233
v_mfma_f32_16x16x32_bf16 v[216:219],a[140:143],a[60:63],0
s_add_u32 s21,s21,16384
ds_read_b64_tr_b16 a[104:105],v8 offset:8
v_mfma_f32_16x16x32_bf16 v[216:219],a[136:139],a[56:59],v[216:219]
ds_read_b64_tr_b16 a[106:107],v8 offset:1032
v_mfma_f32_16x16x32_bf16 v[216:219],a[132:135],a[52:55],v[216:219]
v_mfma_f32_16x16x32_bf16 v[216:219],a[128:131],a[48:51],v[216:219]
s_waitcnt lgkmcnt(6)
v_cvt_pk_bf16_f32 v232,v232,v233
v_fma_f32 v234,v234,s26,-v19
v_fma_f32 v235,v235,s26,-v19
v_mfma_f32_16x16x32_bf16 v[196:199],a[144:147],a[0:3],0
ds_read_b64_tr_b16 a[108:109],v8 offset:2056
v_mfma_f32_16x16x32_bf16 v[196:199],a[148:151],a[4:7],v[196:199]
ds_read_b64_tr_b16 a[110:111],v8 offset:3080
v_mfma_f32_16x16x32_bf16 v[196:199],a[152:155],a[8:11],v[196:199]
v_exp_f32 v234,v234
v_mfma_f32_16x16x32_bf16 v[196:199],a[156:159],a[12:15],v[196:199]
ds_read_b64_tr_b16 a[112:113],v9 offset:0
v_exp_f32 v235,v235
v_mfma_f32_16x16x32_bf16 v[204:207],a[156:159],a[28:31],0
ds_read_b64_tr_b16 a[114:115],v9 offset:1024
v_mfma_f32_16x16x32_bf16 v[204:207],a[152:155],a[24:27],v[204:207]
v_cvt_pk_bf16_f32 v233,v234,v235
v_mfma_f32_16x16x32_bf16 v[204:207],a[148:151],a[20:23],v[204:207]
v_fma_f32 v240,v240,s26,-v20
v_mfma_f32_16x16x32_bf16 v[204:207],a[144:147],a[16:19],v[204:207]
ds_read_b64_tr_b16 a[116:117],v9 offset:2048
v_exp_f32 v240,v240
v_fma_f32 v241,v241,s26,-v20
v_mfma_f32_16x16x32_bf16 v[212:215],a[144:147],a[32:35],0
ds_read_b64_tr_b16 a[118:119],v9 offset:3072
v_mfma_f32_16x16x32_bf16 v[212:215],a[148:151],a[36:39],v[212:215]
v_exp_f32 v241,v241
v_mfma_f32_16x16x32_bf16 v[212:215],a[152:155],a[40:43],v[212:215]
v_mfma_f32_16x16x32_bf16 v[212:215],a[156:159],a[44:47],v[212:215]
ds_read_b64_tr_b16 a[120:121],v9 offset:8
v_cvt_pk_bf16_f32 v240,v240,v241
v_fma_f32 v242,v242,s26,-v20
v_mfma_f32_16x16x32_bf16 v[220:223],a[156:159],a[60:63],0
ds_read_b64_tr_b16 a[122:123],v9 offset:1032
v_fma_f32 v243,v243,s26,-v20
v_mfma_f32_16x16x32_bf16 v[220:223],a[152:155],a[56:59],v[220:223]
v_exp_f32 v242,v242
v_mfma_f32_16x16x32_bf16 v[220:223],a[148:151],a[52:55],v[220:223]
ds_read_b64_tr_b16 a[124:125],v9 offset:2056
v_mfma_f32_16x16x32_bf16 v[220:223],a[144:147],a[48:51],v[220:223]
s_waitcnt lgkmcnt(14)
ds_read_b64_tr_b16 a[126:127],v9 offset:3080
v_exp_f32 v243,v243
v_mfma_f32_16x16x32_bf16 a[224:227],a[240:243],v[160:163],0
s_add_u32 m0,s25,98304
v_mfma_f32_16x16x32_bf16 a[224:227],a[240:243],v[164:167],a[224:227]
buffer_load_dwordx4 v1,s[12:15],s22 offen nt lds
v_cvt_pk_bf16_f32 v241,v242,v243
v_fma_f32 v248,v248,s26,-v21
v_fma_f32 v249,v249,s26,-v21
v_mfma_f32_16x16x32_bf16 a[228:231],a[240:243],v[168:171],0
s_waitcnt lgkmcnt(14)
ds_read_b64_tr_b16 a[128:129],v6 offset:0
v_mfma_f32_16x16x32_bf16 a[228:231],a[240:243],v[172:175],a[228:231]
s_waitcnt lgkmcnt(14)
ds_read_b64_tr_b16 a[130:131],v6 offset:1024
v_exp_f32 v248,v248
v_exp_f32 v249,v249
v_mfma_f32_16x16x32_bf16 a[232:235],a[240:243],v[176:179],0
v_mfma_f32_16x16x32_bf16 a[232:235],a[240:243],v[180:183],a[232:235]
s_waitcnt lgkmcnt(14)
v_cvt_pk_bf16_f32 v248,v248,v249
v_fma_f32 v250,v250,s26,-v21
v_fma_f32 v251,v251,s26,-v21
v_fma_f32 v236,v236,s26,-v19
v_mfma_f32_16x16x32_bf16 a[236:239],a[240:243],v[184:187],0
ds_read_b64_tr_b16 a[132:133],v6 offset:2048
v_mfma_f32_16x16x32_bf16 a[236:239],a[240:243],v[188:191],a[236:239]
s_waitcnt lgkmcnt(14)
ds_read_b64_tr_b16 a[134:135],v6 offset:3072
v_exp_f32 v250,v250
v_exp_f32 v251,v251
v_exp_f32 v236,v236
v_fma_f32 v237,v237,s26,-v19
v_mfma_f32_16x16x32_bf16 a[208:211],a[96:99],v[184:187],0
v_exp_f32 v237,v237
v_mfma_f32_16x16x32_bf16 a[208:211],a[100:103],v[188:191],a[208:211]
s_waitcnt lgkmcnt(14)
ds_read_b64_tr_b16 a[136:137],v6 offset:8
v_cvt_pk_bf16_f32 v249,v250,v251
v_cvt_pk_bf16_f32 v234,v236,v237
v_fma_f32 v238,v238,s26,-v19
v_fma_f32 v239,v239,s26,-v19
v_fma_f32 v244,v244,s26,-v20
v_fma_f32 v245,v245,s26,-v20
v_fma_f32 v246,v246,s26,-v20
v_fma_f32 v247,v247,s26,-v20
v_mfma_f32_16x16x32_bf16 a[192:195],a[100:103],v[180:183],0
s_waitcnt lgkmcnt(14)
ds_read_b64_tr_b16 a[138:139],v6 offset:1032
v_fma_f32 v252,v252,s26,-v21
v_mfma_f32_16x16x32_bf16 a[192:195],a[96:99],v[176:179],a[192:195]
buffer_load_dwordx4 v1,s[12:15],s22 offen offset:1024 nt lds
v_exp_f32 v238,v238
v_exp_f32 v239,v239
v_exp_f32 v244,v244
v_exp_f32 v245,v245
v_mfma_f32_16x16x32_bf16 a[176:179],a[96:99],v[168:171],0
v_exp_f32 v246,v246
v_mfma_f32_16x16x32_bf16 a[176:179],a[100:103],v[172:175],a[176:179]
s_waitcnt lgkmcnt(14)
ds_read_b64_tr_b16 a[140:141],v6 offset:2056
v_exp_f32 v247,v247
v_cvt_pk_bf16_f32 v235,v238,v239
v_cvt_pk_bf16_f32 v242,v244,v245
v_exp_f32 v252,v252
v_fma_f32 v253,v253,s26,-v21
v_fma_f32 v254,v254,s26,-v21
v_mfma_f32_16x16x32_bf16 a[160:163],a[100:103],v[164:167],0
s_waitcnt lgkmcnt(14)
ds_read_b64_tr_b16 a[142:143],v6 offset:3080
v_cvt_pk_bf16_f32 v243,v246,v247
v_mfma_f32_16x16x32_bf16 a[160:163],a[96:99],v[160:163],a[160:163]
v_exp_f32 v253,v253
v_fma_f32 v255,v255,s26,-v21
v_exp_f32 v254,v254
v_mfma_f32_16x16x32_bf16 a[164:167],a[104:107],v[160:163],0
v_exp_f32 v255,v255
v_mfma_f32_16x16x32_bf16 a[164:167],a[108:111],v[164:167],a[164:167]
s_waitcnt lgkmcnt(14)
ds_read_b64_tr_b16 a[144:145],v7 offset:0
v_cvt_pk_bf16_f32 v250,v252,v253
v_cvt_pk_bf16_f32 v251,v254,v255
v_mfma_f32_16x16x32_bf16 a[180:183],a[108:111],v[172:175],0
s_waitcnt lgkmcnt(14)
ds_read_b64_tr_b16 a[146:147],v7 offset:1024
v_mfma_f32_16x16x32_bf16 a[180:183],a[104:107],v[168:171],a[180:183]
buffer_load_dwordx4 v1,s[12:15],s22 offen offset:2048 nt lds
v_mfma_f32_16x16x32_bf16 a[196:199],a[104:107],v[176:179],0
s_waitcnt lgkmcnt(14)
ds_read_b64_tr_b16 a[148:149],v7 offset:2048
v_mfma_f32_16x16x32_bf16 a[196:199],a[108:111],v[180:183],a[196:199]
s_waitcnt lgkmcnt(14)
ds_read_b64_tr_b16 a[150:151],v7 offset:3072
v_mfma_f32_16x16x32_bf16 a[212:215],a[108:111],v[188:191],0
v_mfma_f32_16x16x32_bf16 a[212:215],a[104:107],v[184:187],a[212:215]
v_mfma_f32_16x16x32_bf16 a[216:219],a[112:115],v[184:187],0
s_waitcnt lgkmcnt(14)
ds_read_b64_tr_b16 a[152:153],v7 offset:8
v_mfma_f32_16x16x32_bf16 a[216:219],a[116:119],v[188:191],a[216:219]
s_waitcnt lgkmcnt(14)
ds_read_b64_tr_b16 a[154:155],v7 offset:1032
v_mfma_f32_16x16x32_bf16 a[200:203],a[116:119],v[180:183],0
v_mfma_f32_16x16x32_bf16 a[200:203],a[112:115],v[176:179],a[200:203]
s_waitcnt lgkmcnt(14)
ds_read_b64_tr_b16 a[156:157],v7 offset:2056
v_mfma_f32_16x16x32_bf16 a[184:187],a[112:115],v[168:171],0
s_waitcnt lgkmcnt(14)
ds_read_b64_tr_b16 a[158:159],v7 offset:3080
v_mfma_f32_16x16x32_bf16 a[184:187],a[116:119],v[172:175],a[184:187]
buffer_load_dwordx4 v1,s[12:15],s22 offen offset:3072 nt lds
v_mfma_f32_16x16x32_bf16 a[168:171],a[116:119],v[164:167],0
s_add_u32 s22,s22,16384
v_mfma_f32_16x16x32_bf16 a[168:171],a[112:115],v[160:163],a[168:171]
v_mfma_f32_16x16x32_bf16 a[172:175],a[120:123],v[160:163],0
s_add_u32 m0,s25,131072
v_mfma_f32_16x16x32_bf16 a[172:175],a[124:127],v[164:167],a[172:175]
buffer_load_dwordx4 v1,s[4:7],s23 offen nt lds
v_mfma_f32_16x16x32_bf16 a[188:191],a[124:127],v[172:175],0
v_mfma_f32_16x16x32_bf16 a[188:191],a[120:123],v[168:171],a[188:191]
buffer_load_dwordx4 v1,s[4:7],s23 offen offset:1024 nt lds
v_mfma_f32_16x16x32_bf16 a[204:207],a[120:123],v[176:179],0
v_fma_f32 v192,v192,s26,-v18
v_mfma_f32_16x16x32_bf16 a[204:207],a[124:127],v[180:183],a[204:207]
buffer_load_dwordx4 v1,s[4:7],s23 offen offset:2048 nt lds
v_exp_f32 v192,v192
v_mfma_f32_16x16x32_bf16 a[220:223],a[124:127],v[188:191],0
v_fma_f32 v193,v193,s26,-v18
v_mfma_f32_16x16x32_bf16 a[220:223],a[120:123],v[184:187],a[220:223]
s_waitcnt lgkmcnt(12)
v_exp_f32 v193,v193
v_fma_f32 v194,v194,s26,-v18
v_mfma_f32_16x16x32_bf16 v[80:83],a[128:131],v[184:187],0
v_cvt_pk_bf16_f32 v228,v192,v193
v_mfma_f32_16x16x32_bf16 v[80:83],a[132:135],v[188:191],v[80:83]
buffer_load_dwordx4 v1,s[4:7],s23 offen offset:3072 nt lds
v_exp_f32 v194,v194
v_mfma_f32_16x16x32_bf16 v[64:67],a[132:135],v[180:183],0
s_add_u32 s23,s23,16384
v_fma_f32 v195,v195,s26,-v18
v_mfma_f32_16x16x32_bf16 v[64:67],a[128:131],v[176:179],v[64:67]
s_waitcnt vmcnt(16)
s_waitcnt lgkmcnt(0)
s_barrier
L_h1_0:
ds_read_b128 a[96:99],v2 offset:32768
v_exp_f32 v195,v195
v_fma_f32 v196,v196,s26,-v18
v_mfma_f32_16x16x32_bf16 v[48:51],a[128:131],v[168:171],0
v_cvt_pk_bf16_f32 v229,v194,v195
v_mfma_f32_16x16x32_bf16 v[48:51],a[132:135],v[172:175],v[48:51]
v_exp_f32 v196,v196
v_fma_f32 v197,v197,s26,-v18
v_fma_f32 v198,v198,s26,-v18
v_mfma_f32_16x16x32_bf16 v[32:35],a[132:135],v[164:167],0
v_fma_f32 v199,v199,s26,-v18
v_mfma_f32_16x16x32_bf16 v[32:35],a[128:131],v[160:163],v[32:35]
ds_read_b128 a[100:103],v3 offset:32768
v_exp_f32 v197,v197
v_mfma_f32_16x16x32_bf16 v[36:39],a[136:139],v[160:163],0
v_cvt_pk_bf16_f32 v230,v196,v197
v_mfma_f32_16x16x32_bf16 v[36:39],a[140:143],v[164:167],v[36:39]
v_exp_f32 v198,v198
v_exp_f32 v199,v199
v_mfma_f32_16x16x32_bf16 v[52:55],a[140:143],v[172:175],0
ds_read_b128 a[104:107],v4 offset:32768
v_cvt_pk_bf16_f32 v231,v198,v199
v_mfma_f32_16x16x32_bf16 v[52:55],a[136:139],v[168:171],v[52:55]
v_fma_f32 v200,v200,s26,-v19
v_fma_f32 v201,v201,s26,-v19
v_fma_f32 v202,v202,s26,-v19
v_fma_f32 v203,v203,s26,-v19
v_mfma_f32_16x16x32_bf16 v[68:71],a[136:139],v[176:179],0
v_fma_f32 v204,v204,s26,-v19
v_mfma_f32_16x16x32_bf16 v[68:71],a[140:143],v[180:183],v[68:71]
v_exp_f32 v200,v200
v_exp_f32 v201,v201
v_mfma_f32_16x16x32_bf16 v[84:87],a[140:143],v[188:191],0
ds_read_b128 a[108:111],v5 offset:32768
v_cvt_pk_bf16_f32 v236,v200,v201
v_mfma_f32_16x16x32_bf16 v[84:87],a[136:139],v[184:187],v[84:87]
v_exp_f32 v202,v202
v_fma_f32 v205,v205,s26,-v19
v_mfma_f32_16x16x32_bf16 v[88:91],a[144:147],v[184:187],0
v_fma_f32 v206,v206,s26,-v19
v_mfma_f32_16x16x32_bf16 v[88:91],a[148:151],v[188:191],v[88:91]
v_exp_f32 v203,v203
v_exp_f32 v204,v204
v_mfma_f32_16x16x32_bf16 v[72:75],a[148:151],v[180:183],0
ds_read_b128 a[112:115],v2 offset:33792
v_cvt_pk_bf16_f32 v237,v202,v203
v_mfma_f32_16x16x32_bf16 v[72:75],a[144:147],v[176:179],v[72:75]
v_exp_f32 v205,v205
v_exp_f32 v206,v206
v_mfma_f32_16x16x32_bf16 v[56:59],a[144:147],v[168:171],0
v_cvt_pk_bf16_f32 v238,v204,v205
v_mfma_f32_16x16x32_bf16 v[56:59],a[148:151],v[172:175],v[56:59]
ds_read_b128 a[116:119],v3 offset:33792
v_fma_f32 v207,v207,s26,-v19
v_fma_f32 v208,v208,s26,-v20
v_mfma_f32_16x16x32_bf16 v[40:43],a[148:151],v[164:167],0
v_fma_f32 v209,v209,s26,-v20
v_mfma_f32_16x16x32_bf16 v[40:43],a[144:147],v[160:163],v[40:43]
v_exp_f32 v207,v207
v_exp_f32 v208,v208
v_mfma_f32_16x16x32_bf16 v[44:47],a[152:155],v[160:163],0
v_cvt_pk_bf16_f32 v239,v206,v207
v_mfma_f32_16x16x32_bf16 v[44:47],a[156:159],v[164:167],v[44:47]
ds_read_b128 a[120:123],v4 offset:33792
v_exp_f32 v209,v209
v_fma_f32 v210,v210,s26,-v20
v_mfma_f32_16x16x32_bf16 v[60:63],a[156:159],v[172:175],0
v_cvt_pk_bf16_f32 v244,v208,v209
v_mfma_f32_16x16x32_bf16 v[60:63],a[152:155],v[168:171],v[60:63]
v_exp_f32 v210,v210
v_fma_f32 v211,v211,s26,-v20
v_fma_f32 v212,v212,s26,-v20
v_mfma_f32_16x16x32_bf16 v[76:79],a[152:155],v[176:179],0
v_fma_f32 v213,v213,s26,-v20
v_mfma_f32_16x16x32_bf16 v[76:79],a[156:159],v[180:183],v[76:79]
ds_read_b128 a[124:127],v5 offset:33792
v_exp_f32 v211,v211
v_mfma_f32_16x16x32_bf16 v[92:95],a[156:159],v[188:191],0
v_cvt_pk_bf16_f32 v245,v210,v211
v_mfma_f32_16x16x32_bf16 v[92:95],a[152:155],v[184:187],v[92:95]
s_waitcnt lgkmcnt(4)
v_exp_f32 v212,v212
v_exp_f32 v213,v213
v_mfma_f32_16x16x32_bf16 v[160:163],a[96:99],a[0:3],0
ds_read_b128 a[128:131],v2 offset:34816
v_cvt_pk_bf16_f32 v246,v212,v213
v_mfma_f32_16x16x32_bf16 v[160:163],a[100:103],a[4:7],v[160:163]
v_fma_f32 v214,v214,s26,-v20
v_mfma_f32_16x16x32_bf16 v[160:163],a[104:107],a[8:11],v[160:163]
v_fma_f32 v215,v215,s26,-v20
v_mfma_f32_16x16x32_bf16 v[160:163],a[108:111],a[12:15],v[160:163]
v_exp_f32 v214,v214
v_exp_f32 v215,v215
v_mfma_f32_16x16x32_bf16 v[168:171],a[108:111],a[28:31],0
ds_read_b128 a[132:135],v3 offset:34816
v_cvt_pk_bf16_f32 v247,v214,v215
v_mfma_f32_16x16x32_bf16 v[168:171],a[104:107],a[24:27],v[168:171]
v_fma_f32 v216,v216,s26,-v21
v_mfma_f32_16x16x32_bf16 v[168:171],a[100:103],a[20:23],v[168:171]
v_fma_f32 v217,v217,s26,-v21
v_mfma_f32_16x16x32_bf16 v[168:171],a[96:99],a[16:19],v[168:171]
v_exp_f32 v216,v216
v_exp_f32 v217,v217
v_mfma_f32_16x16x32_bf16 v[176:179],a[96:99],a[32:35],0
ds_read_b128 a[136:139],v4 offset:34816
v_cvt_pk_bf16_f32 v252,v216,v217
v_mfma_f32_16x16x32_bf16 v[176:179],a[100:103],a[36:39],v[176:179]
v_fma_f32 v218,v218,s26,-v21
v_mfma_f32_16x16x32_bf16 v[176:179],a[104:107],a[40:43],v[176:179]
v_fma_f32 v219,v219,s26,-v21
v_mfma_f32_16x16x32_bf16 v[176:179],a[108:111],a[44:47],v[176:179]
ds_read_b128 a[140:143],v5 offset:34816
v_exp_f32 v218,v218
v_mfma_f32_16x16x32_bf16 v[184:187],a[108:111],a[60:63],0
v_fma_f32 v220,v220,s26,-v21
v_mfma_f32_16x16x32_bf16 v[184:187],a[104:107],a[56:59],v[184:187]
v_fma_f32 v221,v221,s26,-v21
v_mfma_f32_16x16x32_bf16 v[184:187],a[100:103],a[52:55],v[184:187]
s_waitcnt lgkmcnt(4)
v_fma_f32 v222,v222,s26,-v21
v_mfma_f32_16x16x32_bf16 v[184:187],a[96:99],a[48:51],v[184:187]
ds_read_b128 a[144:147],v2 offset:35840
v_exp_f32 v219,v219
v_fma_f32 v223,v223,s26,-v21
v_mfma_f32_16x16x32_bf16 v[164:167],a[112:115],a[0:3],0
v_cvt_pk_bf16_f32 v253,v218,v219
v_mfma_f32_16x16x32_bf16 v[164:167],a[116:119],a[4:7],v[164:167]
v_mfma_f32_16x16x32_bf16 v[164:167],a[120:123],a[8:11],v[164:167]
v_mfma_f32_16x16x32_bf16 v[164:167],a[124:127],a[12:15],v[164:167]
ds_read_b128 a[148:151],v3 offset:35840
v_exp_f32 v220,v220
v_mfma_f32_16x16x32_bf16 v[172:175],a[124:127],a[28:31],0
v_mfma_f32_16x16x32_bf16 v[172:175],a[120:123],a[24:27],v[172:175]
v_mfma_f32_16x16x32_bf16 v[172:175],a[116:119],a[20:23],v[172:175]
ds_read_b128 a[152:155],v4 offset:35840
v_mfma_f32_16x16x32_bf16 v[172:175],a[112:115],a[16:19],v[172:175]
v_exp_f32 v221,v221
v_exp_f32 v222,v222
v_mfma_f32_16x16x32_bf16 v[180:183],a[112:115],a[32:35],0
v_cvt_pk_bf16_f32 v254,v220,v221
v_mfma_f32_16x16x32_bf16 v[180:183],a[116:119],a[36:39],v[180:183]
v_mfma_f32_16x16x32_bf16 v[180:183],a[120:123],a[40:43],v[180:183]
ds_read_b128 a[156:159],v5 offset:35840
v_mfma_f32_16x16x32_bf16 v[180:183],a[124:127],a[44:47],v[180:183]
v_exp_f32 v223,v223
v_mfma_f32_16x16x32_bf16 v[188:191],a[124:127],a[60:63],0
v_cvt_pk_bf16_f32 v255,v222,v223
v_mfma_f32_16x16x32_bf16 v[188:191],a[120:123],a[56:59],v[188:191]
v_mfma_f32_16x16x32_bf16 v[188:191],a[116:119],a[52:55],v[188:191]
v_mfma_f32_16x16x32_bf16 v[188:191],a[112:115],a[48:51],v[188:191]
s_waitcnt lgkmcnt(4)
v_mfma_f32_16x16x32_bf16 v[192:195],a[128:131],a[0:3],0
v_accvgpr_read_b32 v23,a244
v_mfma_f32_16x16x32_bf16 v[192:195],a[132:135],a[4:7],v[192:195]
v_accvgpr_read_b32 v24,a245
v_mfma_f32_16x16x32_bf16 v[192:195],a[136:139],a[8:11],v[192:195]
v_fma_f32 v160,v160,s26,-v18
v_mfma_f32_16x16x32_bf16 v[192:195],a[140:143],a[12:15],v[192:195]
v_exp_f32 v160,v160
v_fma_f32 v161,v161,s26,-v18
v_fma_f32 v162,v162,s26,-v18
v_mfma_f32_16x16x32_bf16 v[200:203],a[140:143],a[28:31],0
ds_write_b128 v23,v[96:99] offset:0
v_fma_f32 v163,v163,s26,-v18
v_mfma_f32_16x16x32_bf16 v[200:203],a[136:139],a[24:27],v[200:203]
ds_read_b64_tr_b16 a[96:97],v6 offset:16384
v_fma_f32 v164,v164,s26,-v18
v_mfma_f32_16x16x32_bf16 v[200:203],a[132:135],a[20:23],v[200:203]
ds_read_b64_tr_b16 a[98:99],v6 offset:17408
v_fma_f32 v165,v165,s26,-v18
v_mfma_f32_16x16x32_bf16 v[200:203],a[128:131],a[16:19],v[200:203]
ds_write_b128 v23,v[100:103] offset:64
v_exp_f32 v161,v161
v_fma_f32 v166,v166,s26,-v18
v_mfma_f32_16x16x32_bf16 v[208:211],a[128:131],a[32:35],0
ds_read_b64_tr_b16 a[100:101],v6 offset:18432
v_cvt_pk_bf16_f32 v160,v160,v161
v_mfma_f32_16x16x32_bf16 v[208:211],a[132:135],a[36:39],v[208:211]
ds_read_b64_tr_b16 a[102:103],v6 offset:19456
v_fma_f32 v167,v167,s26,-v18
v_mfma_f32_16x16x32_bf16 v[208:211],a[136:139],a[40:43],v[208:211]
ds_write_b128 v23,v[104:107] offset:128
v_fma_f32 v168,v168,s26,-v19
v_mfma_f32_16x16x32_bf16 v[208:211],a[140:143],a[44:47],v[208:211]
ds_write_b128 v23,v[108:111] offset:192
v_exp_f32 v162,v162
v_exp_f32 v163,v163
v_mfma_f32_16x16x32_bf16 v[216:219],a[140:143],a[60:63],0
ds_read_b64_tr_b16 a[104:105],v6 offset:16392
v_cvt_pk_bf16_f32 v161,v162,v163
v_mfma_f32_16x16x32_bf16 v[216:219],a[136:139],a[56:59],v[216:219]
ds_read_b64_tr_b16 a[106:107],v6 offset:17416
v_fma_f32 v169,v169,s26,-v19
v_mfma_f32_16x16x32_bf16 v[216:219],a[132:135],a[52:55],v[216:219]
ds_read_b128 v[96:99],v24 offset:0
v_fma_f32 v170,v170,s26,-v19
v_mfma_f32_16x16x32_bf16 v[216:219],a[128:131],a[48:51],v[216:219]
s_waitcnt lgkmcnt(11)
ds_read_b128 v[100:103],v24 offset:1088
v_exp_f32 v164,v164
v_mfma_f32_16x16x32_bf16 v[196:199],a[144:147],a[0:3],0
ds_read_b64_tr_b16 a[108:109],v6 offset:18440
v_fma_f32 v171,v171,s26,-v19
v_mfma_f32_16x16x32_bf16 v[196:199],a[148:151],a[4:7],v[196:199]
ds_read_b64_tr_b16 a[110:111],v6 offset:19464
v_fma_f32 v172,v172,s26,-v19
v_mfma_f32_16x16x32_bf16 v[196:199],a[152:155],a[8:11],v[196:199]
ds_read_b128 v[104:107],v24 offset:2176
v_fma_f32 v173,v173,s26,-v19
v_mfma_f32_16x16x32_bf16 v[196:199],a[156:159],a[12:15],v[196:199]
s_waitcnt lgkmcnt(14)
ds_read_b64_tr_b16 a[112:113],v7 offset:16384
v_exp_f32 v165,v165
v_fma_f32 v174,v174,s26,-v19
v_mfma_f32_16x16x32_bf16 v[204:207],a[156:159],a[28:31],0
s_waitcnt lgkmcnt(14)
ds_read_b64_tr_b16 a[114:115],v7 offset:17408
v_cvt_pk_bf16_f32 v162,v164,v165
v_mfma_f32_16x16x32_bf16 v[204:207],a[152:155],a[24:27],v[204:207]
s_waitcnt lgkmcnt(14)
ds_read_b128 v[108:111],v24 offset:3264
v_fma_f32 v175,v175,s26,-v19
v_mfma_f32_16x16x32_bf16 v[204:207],a[148:151],a[20:23],v[204:207]
v_fma_f32 v176,v176,s26,-v20
v_mfma_f32_16x16x32_bf16 v[204:207],a[144:147],a[16:19],v[204:207]
s_waitcnt lgkmcnt(14)
ds_read_b64_tr_b16 a[116:117],v7 offset:18432
v_exp_f32 v166,v166
v_fma_f32 v177,v177,s26,-v20
v_mfma_f32_16x16x32_bf16 v[212:215],a[144:147],a[32:35],0
s_waitcnt lgkmcnt(14)
ds_read_b64_tr_b16 a[118:119],v7 offset:19456
v_fma_f32 v178,v178,s26,-v20
v_mfma_f32_16x16x32_bf16 v[212:215],a[148:151],a[36:39],v[212:215]
v_fma_f32 v179,v179,s26,-v20
v_mfma_f32_16x16x32_bf16 v[212:215],a[152:155],a[40:43],v[212:215]
v_fma_f32 v180,v180,s26,-v20
v_mfma_f32_16x16x32_bf16 v[212:215],a[156:159],a[44:47],v[212:215]
s_waitcnt lgkmcnt(14)
ds_read_b64_tr_b16 a[120:121],v7 offset:16392
v_exp_f32 v167,v167
v_fma_f32 v181,v181,s26,-v20
v_mfma_f32_16x16x32_bf16 v[220:223],a[156:159],a[60:63],0
s_waitcnt lgkmcnt(14)
ds_read_b64_tr_b16 a[122:123],v7 offset:17416
v_cvt_pk_bf16_f32 v163,v166,v167
v_mfma_f32_16x16x32_bf16 v[220:223],a[152:155],a[56:59],v[220:223]
v_fma_f32 v182,v182,s26,-v20
v_mfma_f32_16x16x32_bf16 v[220:223],a[148:151],a[52:55],v[220:223]
s_waitcnt lgkmcnt(14)
ds_read_b64_tr_b16 a[124:125],v7 offset:18440
v_fma_f32 v183,v183,s26,-v20
v_mfma_f32_16x16x32_bf16 v[220:223],a[144:147],a[48:51],v[220:223]
s_waitcnt lgkmcnt(14)
ds_read_b64_tr_b16 a[126:127],v7 offset:19464
v_exp_f32 v168,v168
v_exp_f32 v169,v169
v_mfma_f32_16x16x32_bf16 a[224:227],a[240:243],v[224:227],a[224:227]
s_add_u32 m0,s25,0
v_cvt_pk_bf16_f32 v168,v168,v169
v_mfma_f32_16x16x32_bf16 a[224:227],a[240:243],v[228:231],a[224:227]
buffer_load_dwordx4 v1,s[8:11],s21 offen nt lds
v_exp_f32 v170,v170
v_mfma_f32_16x16x32_bf16 a[228:231],a[240:243],v[232:235],a[228:231]
s_waitcnt lgkmcnt(14)
ds_read_b64_tr_b16 a[128:129],v8 offset:16384
v_fma_f32 v184,v184,s26,-v21
v_mfma_f32_16x16x32_bf16 a[228:231],a[240:243],v[236:239],a[228:231]
s_waitcnt lgkmcnt(14)
ds_read_b64_tr_b16 a[130:131],v8 offset:17408
v_exp_f32 v171,v171
v_fma_f32 v185,v185,s26,-v21
v_mfma_f32_16x16x32_bf16 a[232:235],a[240:243],v[240:243],a[232:235]
v_cvt_pk_bf16_f32 v169,v170,v171
v_mfma_f32_16x16x32_bf16 a[232:235],a[240:243],v[244:247],a[232:235]
v_exp_f32 v172,v172
v_exp_f32 v173,v173
v_mfma_f32_16x16x32_bf16 a[236:239],a[240:243],v[248:251],a[236:239]
s_waitcnt lgkmcnt(14)
ds_read_b64_tr_b16 a[132:133],v8 offset:18432
v_cvt_pk_bf16_f32 v170,v172,v173
v_mfma_f32_16x16x32_bf16 a[236:239],a[240:243],v[252:255],a[236:239]
s_waitcnt lgkmcnt(14)
ds_read_b64_tr_b16 a[134:135],v8 offset:19456
v_exp_f32 v174,v174
v_fma_f32 v186,v186,s26,-v21
v_mfma_f32_16x16x32_bf16 v[80:83],a[96:99],v[248:251],v[80:83]
v_fma_f32 v187,v187,s26,-v21
v_mfma_f32_16x16x32_bf16 v[80:83],a[100:103],v[252:255],v[80:83]
s_waitcnt lgkmcnt(14)
ds_read_b64_tr_b16 a[136:137],v8 offset:16392
v_exp_f32 v175,v175
v_fma_f32 v188,v188,s26,-v21
v_mfma_f32_16x16x32_bf16 v[64:67],a[100:103],v[244:247],v[64:67]
s_waitcnt lgkmcnt(14)
ds_read_b64_tr_b16 a[138:139],v8 offset:17416
v_cvt_pk_bf16_f32 v171,v174,v175
v_mfma_f32_16x16x32_bf16 v[64:67],a[96:99],v[240:243],v[64:67]
buffer_load_dwordx4 v1,s[8:11],s21 offen offset:1024 nt lds
v_exp_f32 v176,v176
v_fma_f32 v189,v189,s26,-v21
v_mfma_f32_16x16x32_bf16 v[48:51],a[96:99],v[232:235],v[48:51]
v_fma_f32 v190,v190,s26,-v21
v_mfma_f32_16x16x32_bf16 v[48:51],a[100:103],v[236:239],v[48:51]
s_waitcnt lgkmcnt(14)
ds_read_b64_tr_b16 a[140:141],v8 offset:18440
v_exp_f32 v177,v177
v_fma_f32 v191,v191,s26,-v21
v_mfma_f32_16x16x32_bf16 v[32:35],a[100:103],v[228:231],v[32:35]
s_waitcnt lgkmcnt(14)
ds_read_b64_tr_b16 a[142:143],v8 offset:19464
v_cvt_pk_bf16_f32 v176,v176,v177
v_mfma_f32_16x16x32_bf16 v[32:35],a[96:99],v[224:227],v[32:35]
v_exp_f32 v178,v178
v_exp_f32 v179,v179
v_mfma_f32_16x16x32_bf16 v[36:39],a[104:107],v[224:227],v[36:39]
v_cvt_pk_bf16_f32 v177,v178,v179
v_mfma_f32_16x16x32_bf16 v[36:39],a[108:111],v[228:231],v[36:39]
s_waitcnt lgkmcnt(14)
ds_read_b64_tr_b16 a[144:145],v9 offset:16384
v_exp_f32 v180,v180
v_mfma_f32_16x16x32_bf16 v[52:55],a[108:111],v[236:239],v[52:55]
s_waitcnt lgkmcnt(14)
ds_read_b64_tr_b16 a[146:147],v9 offset:17408
v_mfma_f32_16x16x32_bf16 v[52:55],a[104:107],v[232:235],v[52:55]
buffer_load_dwordx4 v1,s[8:11],s21 offen offset:2048 nt lds
v_exp_f32 v181,v181
v_mfma_f32_16x16x32_bf16 v[68:71],a[104:107],v[240:243],v[68:71]
s_waitcnt lgkmcnt(14)
ds_read_b64_tr_b16 a[148:149],v9 offset:18432
v_cvt_pk_bf16_f32 v178,v180,v181
v_mfma_f32_16x16x32_bf16 v[68:71],a[108:111],v[244:247],v[68:71]
s_waitcnt lgkmcnt(14)
ds_read_b64_tr_b16 a[150:151],v9 offset:19456
v_exp_f32 v182,v182
v_exp_f32 v183,v183
v_mfma_f32_16x16x32_bf16 v[84:87],a[108:111],v[252:255],v[84:87]
v_cvt_pk_bf16_f32 v179,v182,v183
v_mfma_f32_16x16x32_bf16 v[84:87],a[104:107],v[248:251],v[84:87]
v_exp_f32 v184,v184
v_exp_f32 v185,v185
v_mfma_f32_16x16x32_bf16 v[88:91],a[112:115],v[248:251],v[88:91]
s_waitcnt lgkmcnt(14)
ds_read_b64_tr_b16 a[152:153],v9 offset:16392
v_cvt_pk_bf16_f32 v184,v184,v185
v_mfma_f32_16x16x32_bf16 v[88:91],a[116:119],v[252:255],v[88:91]
s_waitcnt lgkmcnt(14)
ds_read_b64_tr_b16 a[154:155],v9 offset:17416
v_exp_f32 v186,v186
v_mfma_f32_16x16x32_bf16 v[72:75],a[116:119],v[244:247],v[72:75]
v_mfma_f32_16x16x32_bf16 v[72:75],a[112:115],v[240:243],v[72:75]
s_waitcnt lgkmcnt(14)
ds_read_b64_tr_b16 a[156:157],v9 offset:18440
v_exp_f32 v187,v187
v_mfma_f32_16x16x32_bf16 v[56:59],a[112:115],v[232:235],v[56:59]
s_waitcnt lgkmcnt(14)
ds_read_b64_tr_b16 a[158:159],v9 offset:19464
v_cvt_pk_bf16_f32 v185,v186,v187
v_mfma_f32_16x16x32_bf16 v[56:59],a[116:119],v[236:239],v[56:59]
buffer_load_dwordx4 v1,s[8:11],s21 offen offset:3072 nt lds
v_exp_f32 v188,v188
v_mfma_f32_16x16x32_bf16 v[40:43],a[116:119],v[228:231],v[40:43]
s_add_u32 s21,s21,16384
v_mfma_f32_16x16x32_bf16 v[40:43],a[112:115],v[224:227],v[40:43]
v_exp_f32 v189,v189
v_exp_f32 v190,v190
v_mfma_f32_16x16x32_bf16 v[44:47],a[120:123],v[224:227],v[44:47]
s_add_u32 m0,s25,114688
v_cvt_pk_bf16_f32 v186,v188,v189
v_mfma_f32_16x16x32_bf16 v[44:47],a[124:127],v[228:231],v[44:47]
buffer_load_dwordx4 v1,s[12:15],s22 offen nt lds
v_exp_f32 v191,v191
v_mfma_f32_16x16x32_bf16 v[60:63],a[124:127],v[236:239],v[60:63]
v_cvt_pk_bf16_f32 v187,v190,v191
v_mfma_f32_16x16x32_bf16 v[60:63],a[120:123],v[232:235],v[60:63]
buffer_load_dwordx4 v1,s[12:15],s22 offen offset:1024 nt lds
v_mfma_f32_16x16x32_bf16 v[76:79],a[120:123],v[240:243],v[76:79]
v_fma_f32 v192,v192,s26,-v18
v_mfma_f32_16x16x32_bf16 v[76:79],a[124:127],v[244:247],v[76:79]
buffer_load_dwordx4 v1,s[12:15],s22 offen offset:2048 nt lds
v_exp_f32 v192,v192
v_mfma_f32_16x16x32_bf16 v[92:95],a[124:127],v[252:255],v[92:95]
v_fma_f32 v193,v193,s26,-v18
v_mfma_f32_16x16x32_bf16 v[92:95],a[120:123],v[248:251],v[92:95]
s_waitcnt lgkmcnt(12)
v_exp_f32 v193,v193
v_fma_f32 v194,v194,s26,-v18
v_fma_f32 v195,v195,s26,-v18
v_mfma_f32_16x16x32_bf16 a[208:211],a[128:131],v[248:251],a[208:211]
v_cvt_pk_bf16_f32 v164,v192,v193
v_mfma_f32_16x16x32_bf16 a[208:211],a[132:135],v[252:255],a[208:211]
buffer_load_dwordx4 v1,s[12:15],s22 offen offset:3072 nt lds
v_exp_f32 v194,v194
v_mfma_f32_16x16x32_bf16 a[192:195],a[132:135],v[244:247],a[192:195]
s_add_u32 s22,s22,16384
v_fma_f32 v196,v196,s26,-v18
v_mfma_f32_16x16x32_bf16 a[192:195],a[128:131],v[240:243],a[192:195]
s_waitcnt vmcnt(12)
s_waitcnt lgkmcnt(0)
s_barrier
ds_read_b128 a[96:99],v2 offset:49152
v_exp_f32 v195,v195
v_mfma_f32_16x16x32_bf16 a[176:179],a[128:131],v[232:235],a[176:179]
s_add_u32 s30,s24,0
s_add_u32 s32,s24,4096
v_cvt_pk_bf16_f32 v165,v194,v195
v_mfma_f32_16x16x32_bf16 a[176:179],a[132:135],v[236:239],a[176:179]
buffer_store_dwordx4 v[96:99],v22,s[16:19],s30 offen sc0 sc1
buffer_store_dwordx4 v[100:103],v22,s[16:19],s32 offen sc0 sc1
v_exp_f32 v196,v196
v_mfma_f32_16x16x32_bf16 a[160:163],a[132:135],v[228:231],a[160:163]
v_fma_f32 v197,v197,s26,-v18
v_mfma_f32_16x16x32_bf16 a[160:163],a[128:131],v[224:227],a[160:163]
ds_read_b128 a[100:103],v3 offset:49152
v_exp_f32 v197,v197
v_fma_f32 v198,v198,s26,-v18
v_mfma_f32_16x16x32_bf16 a[164:167],a[136:139],v[224:227],a[164:167]
v_cvt_pk_bf16_f32 v166,v196,v197
v_mfma_f32_16x16x32_bf16 a[164:167],a[140:143],v[228:231],a[164:167]
ds_read_b128 a[64:67],v10 offset:16384
v_fma_f32 v199,v199,s26,-v18
v_exp_f32 v198,v198
v_mfma_f32_16x16x32_bf16 a[180:183],a[140:143],v[236:239],a[180:183]
ds_read_b128 a[104:107],v4 offset:49152
v_fma_f32 v200,v200,s26,-v19
v_mfma_f32_16x16x32_bf16 a[180:183],a[136:139],v[232:235],a[180:183]
v_exp_f32 v199,v199
v_exp_f32 v200,v200
v_mfma_f32_16x16x32_bf16 a[196:199],a[136:139],v[240:243],a[196:199]
v_cvt_pk_bf16_f32 v167,v198,v199
v_mfma_f32_16x16x32_bf16 a[196:199],a[140:143],v[244:247],a[196:199]
v_fma_f32 v201,v201,s26,-v19
v_fma_f32 v202,v202,s26,-v19
v_fma_f32 v203,v203,s26,-v19
v_fma_f32 v204,v204,s26,-v19
v_mfma_f32_16x16x32_bf16 a[212:215],a[140:143],v[252:255],a[212:215]
ds_read_b128 a[108:111],v5 offset:49152
v_fma_f32 v205,v205,s26,-v19
v_mfma_f32_16x16x32_bf16 a[212:215],a[136:139],v[248:251],a[212:215]
v_exp_f32 v201,v201
v_fma_f32 v206,v206,s26,-v19
v_mfma_f32_16x16x32_bf16 a[216:219],a[144:147],v[248:251],a[216:219]
v_cvt_pk_bf16_f32 v172,v200,v201
v_mfma_f32_16x16x32_bf16 a[216:219],a[148:151],v[252:255],a[216:219]
v_exp_f32 v202,v202
v_exp_f32 v203,v203
v_mfma_f32_16x16x32_bf16 a[200:203],a[148:151],v[244:247],a[200:203]
ds_read_b128 a[112:115],v2 offset:50176
v_cvt_pk_bf16_f32 v173,v202,v203
v_mfma_f32_16x16x32_bf16 a[200:203],a[144:147],v[240:243],a[200:203]
v_exp_f32 v204,v204
v_exp_f32 v205,v205
v_mfma_f32_16x16x32_bf16 a[184:187],a[144:147],v[232:235],a[184:187]
v_cvt_pk_bf16_f32 v174,v204,v205
v_mfma_f32_16x16x32_bf16 a[184:187],a[148:151],v[236:239],a[184:187]
ds_read_b128 a[116:119],v3 offset:50176
v_fma_f32 v207,v207,s26,-v19
v_exp_f32 v206,v206
v_mfma_f32_16x16x32_bf16 a[168:171],a[148:151],v[228:231],a[168:171]
ds_read_b128 a[68:71],v11 offset:16384
v_fma_f32 v208,v208,s26,-v20
v_mfma_f32_16x16x32_bf16 a[168:171],a[144:147],v[224:227],a[168:171]
v_exp_f32 v207,v207
v_exp_f32 v208,v208
v_mfma_f32_16x16x32_bf16 a[172:175],a[152:155],v[224:227],a[172:175]
v_cvt_pk_bf16_f32 v175,v206,v207
v_mfma_f32_16x16x32_bf16 a[172:175],a[156:159],v[228:231],a[172:175]
ds_read_b128 a[120:123],v4 offset:50176
v_fma_f32 v209,v209,s26,-v20
v_fma_f32 v210,v210,s26,-v20
v_fma_f32 v211,v211,s26,-v20
v_mfma_f32_16x16x32_bf16 a[188:191],a[156:159],v[236:239],a[188:191]
s_add_u32 s30,s24,8192
s_add_u32 s32,s24,12288
v_fma_f32 v212,v212,s26,-v20
v_mfma_f32_16x16x32_bf16 a[188:191],a[152:155],v[232:235],a[188:191]
buffer_store_dwordx4 v[104:107],v22,s[16:19],s30 offen sc0 sc1
buffer_store_dwordx4 v[108:111],v22,s[16:19],s32 offen sc0 sc1
v_exp_f32 v209,v209
v_mfma_f32_16x16x32_bf16 a[204:207],a[152:155],v[240:243],a[204:207]
v_cvt_pk_bf16_f32 v180,v208,v209
v_mfma_f32_16x16x32_bf16 a[204:207],a[156:159],v[244:247],a[204:207]
ds_read_b128 a[124:127],v5 offset:50176
v_exp_f32 v210,v210
v_mfma_f32_16x16x32_bf16 a[220:223],a[156:159],v[252:255],a[220:223]
v_fma_f32 v213,v213,s26,-v20
v_mfma_f32_16x16x32_bf16 a[220:223],a[152:155],v[248:251],a[220:223]
s_waitcnt lgkmcnt(5)
v_exp_f32 v211,v211
v_exp_f32 v212,v212
v_mfma_f32_16x16x32_bf16 v[224:227],a[96:99],a[0:3],0
ds_read_b128 a[128:131],v2 offset:51200
v_cvt_pk_bf16_f32 v181,v210,v211
v_mfma_f32_16x16x32_bf16 v[224:227],a[100:103],a[4:7],v[224:227]
v_fma_f32 v214,v214,s26,-v20
v_mfma_f32_16x16x32_bf16 v[224:227],a[104:107],a[8:11],v[224:227]
ds_read_b128 a[72:75],v12 offset:16384
v_fma_f32 v215,v215,s26,-v20
v_mfma_f32_16x16x32_bf16 v[224:227],a[108:111],a[12:15],v[224:227]
v_exp_f32 v213,v213
v_exp_f32 v214,v214
v_mfma_f32_16x16x32_bf16 v[232:235],a[108:111],a[28:31],0
ds_read_b128 a[132:135],v3 offset:51200
v_cvt_pk_bf16_f32 v182,v212,v213
v_mfma_f32_16x16x32_bf16 v[232:235],a[104:107],a[24:27],v[232:235]
v_fma_f32 v216,v216,s26,-v21
v_mfma_f32_16x16x32_bf16 v[232:235],a[100:103],a[20:23],v[232:235]
v_fma_f32 v217,v217,s26,-v21
v_mfma_f32_16x16x32_bf16 v[232:235],a[96:99],a[16:19],v[232:235]
v_exp_f32 v215,v215
v_exp_f32 v216,v216
v_mfma_f32_16x16x32_bf16 v[240:243],a[96:99],a[32:35],0
ds_read_b128 a[136:139],v4 offset:51200
v_cvt_pk_bf16_f32 v183,v214,v215
v_mfma_f32_16x16x32_bf16 v[240:243],a[100:103],a[36:39],v[240:243]
v_fma_f32 v218,v218,s26,-v21
v_mfma_f32_16x16x32_bf16 v[240:243],a[104:107],a[40:43],v[240:243]
v_fma_f32 v219,v219,s26,-v21
v_mfma_f32_16x16x32_bf16 v[240:243],a[108:111],a[44:47],v[240:243]
ds_read_b128 a[140:143],v5 offset:51200
v_exp_f32 v217,v217
v_fma_f32 v220,v220,s26,-v21
v_mfma_f32_16x16x32_bf16 v[248:251],a[108:111],a[60:63],0
v_cvt_pk_bf16_f32 v188,v216,v217
v_mfma_f32_16x16x32_bf16 v[248:251],a[104:107],a[56:59],v[248:251]
s_waitcnt lgkmcnt(5)
v_fma_f32 v221,v221,s26,-v21
v_mfma_f32_16x16x32_bf16 v[248:251],a[100:103],a[52:55],v[248:251]
ds_read_b128 a[76:79],v13 offset:16384
v_fma_f32 v222,v222,s26,-v21
v_mfma_f32_16x16x32_bf16 v[248:251],a[96:99],a[48:51],v[248:251]
ds_read_b128 a[144:147],v2 offset:52224
v_exp_f32 v218,v218
v_fma_f32 v223,v223,s26,-v21
v_mfma_f32_16x16x32_bf16 v[228:231],a[112:115],a[0:3],0
v_mfma_f32_16x16x32_bf16 v[228:231],a[116:119],a[4:7],v[228:231]
v_mfma_f32_16x16x32_bf16 v[228:231],a[120:123],a[8:11],v[228:231]
v_mfma_f32_16x16x32_bf16 v[228:231],a[124:127],a[12:15],v[228:231]
ds_read_b128 a[148:151],v3 offset:52224
v_exp_f32 v219,v219
v_mfma_f32_16x16x32_bf16 v[236:239],a[124:127],a[28:31],0
v_cvt_pk_bf16_f32 v189,v218,v219
v_mfma_f32_16x16x32_bf16 v[236:239],a[120:123],a[24:27],v[236:239]
v_mfma_f32_16x16x32_bf16 v[236:239],a[116:119],a[20:23],v[236:239]
ds_read_b128 a[152:155],v4 offset:52224
v_mfma_f32_16x16x32_bf16 v[236:239],a[112:115],a[16:19],v[236:239]
v_exp_f32 v220,v220
v_exp_f32 v221,v221
v_mfma_f32_16x16x32_bf16 v[244:247],a[112:115],a[32:35],0
v_cvt_pk_bf16_f32 v190,v220,v221
v_mfma_f32_16x16x32_bf16 v[244:247],a[116:119],a[36:39],v[244:247]
v_mfma_f32_16x16x32_bf16 v[244:247],a[120:123],a[40:43],v[244:247]
ds_read_b128 a[156:159],v5 offset:52224
v_mfma_f32_16x16x32_bf16 v[244:247],a[124:127],a[44:47],v[244:247]
v_exp_f32 v222,v222
v_exp_f32 v223,v223
v_mfma_f32_16x16x32_bf16 v[252:255],a[124:127],a[60:63],0
v_cvt_pk_bf16_f32 v191,v222,v223
v_mfma_f32_16x16x32_bf16 v[252:255],a[120:123],a[56:59],v[252:255]
v_mfma_f32_16x16x32_bf16 v[252:255],a[116:119],a[52:55],v[252:255]
v_mfma_f32_16x16x32_bf16 v[252:255],a[112:115],a[48:51],v[252:255]
s_waitcnt lgkmcnt(5)
v_mfma_f32_16x16x32_bf16 v[192:195],a[128:131],a[0:3],0
v_accvgpr_read_b32 v23,a244
v_mfma_f32_16x16x32_bf16 v[192:195],a[132:135],a[4:7],v[192:195]
v_accvgpr_read_b32 v24,a245
v_mfma_f32_16x16x32_bf16 v[192:195],a[136:139],a[8:11],v[192:195]
v_fma_f32 v224,v224,s26,-v18
v_mfma_f32_16x16x32_bf16 v[192:195],a[140:143],a[12:15],v[192:195]
v_exp_f32 v224,v224
v_fma_f32 v225,v225,s26,-v18
v_fma_f32 v226,v226,s26,-v18
v_mfma_f32_16x16x32_bf16 v[200:203],a[140:143],a[28:31],0
ds_write_b128 v23,v[112:115] offset:16384
v_fma_f32 v227,v227,s26,-v18
v_mfma_f32_16x16x32_bf16 v[200:203],a[136:139],a[24:27],v[200:203]
ds_read_b64_tr_b16 a[96:97],v6 offset:32768
v_fma_f32 v228,v228,s26,-v18
v_mfma_f32_16x16x32_bf16 v[200:203],a[132:135],a[20:23],v[200:203]
ds_read_b64_tr_b16 a[98:99],v6 offset:33792
v_fma_f32 v229,v229,s26,-v18
v_mfma_f32_16x16x32_bf16 v[200:203],a[128:131],a[16:19],v[200:203]
ds_write_b128 v23,v[116:119] offset:16448
v_exp_f32 v225,v225
v_fma_f32 v230,v230,s26,-v18
v_mfma_f32_16x16x32_bf16 v[208:211],a[128:131],a[32:35],0
ds_read_b64_tr_b16 a[100:101],v6 offset:34816
v_cvt_pk_bf16_f32 v224,v224,v225
v_mfma_f32_16x16x32_bf16 v[208:211],a[132:135],a[36:39],v[208:211]
ds_read_b64_tr_b16 a[102:103],v6 offset:35840
v_fma_f32 v231,v231,s26,-v18
v_mfma_f32_16x16x32_bf16 v[208:211],a[136:139],a[40:43],v[208:211]
ds_write_b128 v23,v[120:123] offset:16512
v_fma_f32 v232,v232,s26,-v19
v_mfma_f32_16x16x32_bf16 v[208:211],a[140:143],a[44:47],v[208:211]
ds_write_b128 v23,v[124:127] offset:16576
v_exp_f32 v226,v226
v_exp_f32 v227,v227
v_mfma_f32_16x16x32_bf16 v[216:219],a[140:143],a[60:63],0
ds_read_b64_tr_b16 a[104:105],v6 offset:32776
v_cvt_pk_bf16_f32 v225,v226,v227
v_mfma_f32_16x16x32_bf16 v[216:219],a[136:139],a[56:59],v[216:219]
ds_read_b64_tr_b16 a[106:107],v6 offset:33800
v_fma_f32 v233,v233,s26,-v19
v_mfma_f32_16x16x32_bf16 v[216:219],a[132:135],a[52:55],v[216:219]
s_waitcnt lgkmcnt(14)
ds_read_b128 v[112:115],v24 offset:16384
v_fma_f32 v234,v234,s26,-v19
v_mfma_f32_16x16x32_bf16 v[216:219],a[128:131],a[48:51],v[216:219]
s_waitcnt lgkmcnt(11)
ds_read_b128 v[116:119],v24 offset:17472
v_exp_f32 v228,v228
v_mfma_f32_16x16x32_bf16 v[196:199],a[144:147],a[0:3],0
ds_read_b64_tr_b16 a[108:109],v6 offset:34824
v_fma_f32 v235,v235,s26,-v19
v_mfma_f32_16x16x32_bf16 v[196:199],a[148:151],a[4:7],v[196:199]
ds_read_b64_tr_b16 a[110:111],v6 offset:35848
v_fma_f32 v236,v236,s26,-v19
v_mfma_f32_16x16x32_bf16 v[196:199],a[152:155],a[8:11],v[196:199]
ds_read_b128 v[120:123],v24 offset:18560
v_fma_f32 v237,v237,s26,-v19
v_mfma_f32_16x16x32_bf16 v[196:199],a[156:159],a[12:15],v[196:199]
s_waitcnt lgkmcnt(14)
ds_read_b64_tr_b16 a[112:113],v7 offset:32768
v_exp_f32 v229,v229
v_fma_f32 v238,v238,s26,-v19
v_mfma_f32_16x16x32_bf16 v[204:207],a[156:159],a[28:31],0
s_waitcnt lgkmcnt(14)
ds_read_b64_tr_b16 a[114:115],v7 offset:33792
v_cvt_pk_bf16_f32 v226,v228,v229
v_mfma_f32_16x16x32_bf16 v[204:207],a[152:155],a[24:27],v[204:207]
s_waitcnt lgkmcnt(14)
ds_read_b128 v[124:127],v24 offset:19648
v_fma_f32 v239,v239,s26,-v19
v_mfma_f32_16x16x32_bf16 v[204:207],a[148:151],a[20:23],v[204:207]
v_fma_f32 v240,v240,s26,-v20
v_mfma_f32_16x16x32_bf16 v[204:207],a[144:147],a[16:19],v[204:207]
s_waitcnt lgkmcnt(14)
ds_read_b64_tr_b16 a[116:117],v7 offset:34816
v_exp_f32 v230,v230
v_fma_f32 v241,v241,s26,-v20
v_mfma_f32_16x16x32_bf16 v[212:215],a[144:147],a[32:35],0
s_waitcnt lgkmcnt(14)
ds_read_b64_tr_b16 a[118:119],v7 offset:35840
v_fma_f32 v242,v242,s26,-v20
v_mfma_f32_16x16x32_bf16 v[212:215],a[148:151],a[36:39],v[212:215]
v_fma_f32 v243,v243,s26,-v20
v_mfma_f32_16x16x32_bf16 v[212:215],a[152:155],a[40:43],v[212:215]
v_fma_f32 v244,v244,s26,-v20
v_mfma_f32_16x16x32_bf16 v[212:215],a[156:159],a[44:47],v[212:215]
s_waitcnt lgkmcnt(14)
ds_read_b64_tr_b16 a[120:121],v7 offset:32776
v_exp_f32 v231,v231
v_fma_f32 v245,v245,s26,-v20
v_mfma_f32_16x16x32_bf16 v[220:223],a[156:159],a[60:63],0
s_waitcnt lgkmcnt(14)
ds_read_b64_tr_b16 a[122:123],v7 offset:33800
v_cvt_pk_bf16_f32 v227,v230,v231
v_mfma_f32_16x16x32_bf16 v[220:223],a[152:155],a[56:59],v[220:223]
v_fma_f32 v246,v246,s26,-v20
v_mfma_f32_16x16x32_bf16 v[220:223],a[148:151],a[52:55],v[220:223]
s_waitcnt lgkmcnt(14)
ds_read_b64_tr_b16 a[124:125],v7 offset:34824
v_fma_f32 v247,v247,s26,-v20
v_mfma_f32_16x16x32_bf16 v[220:223],a[144:147],a[48:51],v[220:223]
s_waitcnt lgkmcnt(14)
ds_read_b64_tr_b16 a[126:127],v7 offset:35848
v_exp_f32 v232,v232
v_exp_f32 v233,v233
v_mfma_f32_16x16x32_bf16 a[224:227],a[240:243],v[160:163],a[224:227]
s_add_u32 m0,s25,16384
v_cvt_pk_bf16_f32 v232,v232,v233
v_mfma_f32_16x16x32_bf16 a[224:227],a[240:243],v[164:167],a[224:227]
buffer_load_dwordx4 v1,s[8:11],s21 offen nt lds
v_exp_f32 v234,v234
v_mfma_f32_16x16x32_bf16 a[228:231],a[240:243],v[168:171],a[228:231]
s_waitcnt lgkmcnt(14)
ds_read_b64_tr_b16 a[128:129],v8 offset:32768
v_fma_f32 v248,v248,s26,-v21
v_mfma_f32_16x16x32_bf16 a[228:231],a[240:243],v[172:175],a[228:231]
s_waitcnt lgkmcnt(14)
ds_read_b64_tr_b16 a[130:131],v8 offset:33792
v_exp_f32 v235,v235
v_fma_f32 v249,v249,s26,-v21
v_mfma_f32_16x16x32_bf16 a[232:235],a[240:243],v[176:179],a[232:235]
v_cvt_pk_bf16_f32 v233,v234,v235
v_mfma_f32_16x16x32_bf16 a[232:235],a[240:243],v[180:183],a[232:235]
v_exp_f32 v236,v236
v_exp_f32 v237,v237
v_mfma_f32_16x16x32_bf16 a[236:239],a[240:243],v[184:187],a[236:239]
s_waitcnt lgkmcnt(14)
ds_read_b64_tr_b16 a[132:133],v8 offset:34816
v_cvt_pk_bf16_f32 v234,v236,v237
v_mfma_f32_16x16x32_bf16 a[236:239],a[240:243],v[188:191],a[236:239]
s_waitcnt lgkmcnt(14)
ds_read_b64_tr_b16 a[134:135],v8 offset:35840
v_exp_f32 v238,v238
v_fma_f32 v250,v250,s26,-v21
v_mfma_f32_16x16x32_bf16 v[80:83],a[96:99],v[184:187],v[80:83]
v_fma_f32 v251,v251,s26,-v21
v_mfma_f32_16x16x32_bf16 v[80:83],a[100:103],v[188:191],v[80:83]
s_waitcnt lgkmcnt(14)
ds_read_b64_tr_b16 a[136:137],v8 offset:32776
v_exp_f32 v239,v239
v_fma_f32 v252,v252,s26,-v21
v_mfma_f32_16x16x32_bf16 v[64:67],a[100:103],v[180:183],v[64:67]
s_waitcnt lgkmcnt(14)
ds_read_b64_tr_b16 a[138:139],v8 offset:33800
v_cvt_pk_bf16_f32 v235,v238,v239
v_mfma_f32_16x16x32_bf16 v[64:67],a[96:99],v[176:179],v[64:67]
buffer_load_dwordx4 v1,s[8:11],s21 offen offset:1024 nt lds
v_exp_f32 v240,v240
v_fma_f32 v253,v253,s26,-v21
v_mfma_f32_16x16x32_bf16 v[48:51],a[96:99],v[168:171],v[48:51]
v_fma_f32 v254,v254,s26,-v21
v_mfma_f32_16x16x32_bf16 v[48:51],a[100:103],v[172:175],v[48:51]
s_waitcnt lgkmcnt(14)
ds_read_b64_tr_b16 a[140:141],v8 offset:34824
v_exp_f32 v241,v241
v_fma_f32 v255,v255,s26,-v21
v_mfma_f32_16x16x32_bf16 v[32:35],a[100:103],v[164:167],v[32:35]
s_waitcnt lgkmcnt(14)
ds_read_b64_tr_b16 a[142:143],v8 offset:35848
v_cvt_pk_bf16_f32 v240,v240,v241
v_mfma_f32_16x16x32_bf16 v[32:35],a[96:99],v[160:163],v[32:35]
v_exp_f32 v242,v242
v_exp_f32 v243,v243
v_mfma_f32_16x16x32_bf16 v[36:39],a[104:107],v[160:163],v[36:39]
v_cvt_pk_bf16_f32 v241,v242,v243
v_mfma_f32_16x16x32_bf16 v[36:39],a[108:111],v[164:167],v[36:39]
s_waitcnt lgkmcnt(14)
ds_read_b64_tr_b16 a[144:145],v9 offset:32768
v_exp_f32 v244,v244
v_mfma_f32_16x16x32_bf16 v[52:55],a[108:111],v[172:175],v[52:55]
s_waitcnt lgkmcnt(14)
ds_read_b64_tr_b16 a[146:147],v9 offset:33792
v_mfma_f32_16x16x32_bf16 v[52:55],a[104:107],v[168:171],v[52:55]
buffer_load_dwordx4 v1,s[8:11],s21 offen offset:2048 nt lds
v_exp_f32 v245,v245
v_mfma_f32_16x16x32_bf16 v[68:71],a[104:107],v[176:179],v[68:71]
s_waitcnt lgkmcnt(14)
ds_read_b64_tr_b16 a[148:149],v9 offset:34816
v_cvt_pk_bf16_f32 v242,v244,v245
v_mfma_f32_16x16x32_bf16 v[68:71],a[108:111],v[180:183],v[68:71]
s_waitcnt lgkmcnt(14)
ds_read_b64_tr_b16 a[150:151],v9 offset:35840
v_exp_f32 v246,v246
v_exp_f32 v247,v247
v_mfma_f32_16x16x32_bf16 v[84:87],a[108:111],v[188:191],v[84:87]
v_cvt_pk_bf16_f32 v243,v246,v247
v_mfma_f32_16x16x32_bf16 v[84:87],a[104:107],v[184:187],v[84:87]
v_exp_f32 v248,v248
v_exp_f32 v249,v249
v_mfma_f32_16x16x32_bf16 v[88:91],a[112:115],v[184:187],v[88:91]
s_waitcnt lgkmcnt(14)
ds_read_b64_tr_b16 a[152:153],v9 offset:32776
v_cvt_pk_bf16_f32 v248,v248,v249
v_mfma_f32_16x16x32_bf16 v[88:91],a[116:119],v[188:191],v[88:91]
s_waitcnt lgkmcnt(14)
ds_read_b64_tr_b16 a[154:155],v9 offset:33800
v_exp_f32 v250,v250
v_mfma_f32_16x16x32_bf16 v[72:75],a[116:119],v[180:183],v[72:75]
v_mfma_f32_16x16x32_bf16 v[72:75],a[112:115],v[176:179],v[72:75]
s_waitcnt lgkmcnt(14)
ds_read_b64_tr_b16 a[156:157],v9 offset:34824
v_exp_f32 v251,v251
v_mfma_f32_16x16x32_bf16 v[56:59],a[112:115],v[168:171],v[56:59]
s_waitcnt lgkmcnt(14)
ds_read_b64_tr_b16 a[158:159],v9 offset:35848
v_cvt_pk_bf16_f32 v249,v250,v251
v_mfma_f32_16x16x32_bf16 v[56:59],a[116:119],v[172:175],v[56:59]
buffer_load_dwordx4 v1,s[8:11],s21 offen offset:3072 nt lds
v_exp_f32 v252,v252
v_mfma_f32_16x16x32_bf16 v[40:43],a[116:119],v[164:167],v[40:43]
s_add_u32 s21,s21,16384
v_mfma_f32_16x16x32_bf16 v[40:43],a[112:115],v[160:163],v[40:43]
v_exp_f32 v253,v253
v_exp_f32 v254,v254
v_mfma_f32_16x16x32_bf16 v[44:47],a[120:123],v[160:163],v[44:47]
s_add_u32 m0,s25,65536
v_cvt_pk_bf16_f32 v250,v252,v253
v_mfma_f32_16x16x32_bf16 v[44:47],a[124:127],v[164:167],v[44:47]
buffer_load_dwordx4 v1,s[12:15],s22 offen nt lds
v_exp_f32 v255,v255
v_mfma_f32_16x16x32_bf16 v[60:63],a[124:127],v[172:175],v[60:63]
v_cvt_pk_bf16_f32 v251,v254,v255
v_mfma_f32_16x16x32_bf16 v[60:63],a[120:123],v[168:171],v[60:63]
buffer_load_dwordx4 v1,s[12:15],s22 offen offset:1024 nt lds
v_mfma_f32_16x16x32_bf16 v[76:79],a[120:123],v[176:179],v[76:79]
v_mfma_f32_16x16x32_bf16 v[76:79],a[124:127],v[180:183],v[76:79]
buffer_load_dwordx4 v1,s[12:15],s22 offen offset:2048 nt lds
v_fma_f32 v192,v192,s26,-v18
v_fma_f32 v193,v193,s26,-v18
v_fma_f32 v194,v194,s26,-v18
v_mfma_f32_16x16x32_bf16 v[92:95],a[124:127],v[188:191],v[92:95]
v_mfma_f32_16x16x32_bf16 v[92:95],a[120:123],v[184:187],v[92:95]
s_waitcnt lgkmcnt(12)
v_exp_f32 v192,v192
v_exp_f32 v193,v193
v_exp_f32 v194,v194
v_mfma_f32_16x16x32_bf16 a[208:211],a[128:131],v[184:187],a[208:211]
v_mfma_f32_16x16x32_bf16 a[208:211],a[132:135],v[188:191],a[208:211]
buffer_load_dwordx4 v1,s[12:15],s22 offen offset:3072 nt lds
v_cvt_pk_bf16_f32 v228,v192,v193
v_fma_f32 v195,v195,s26,-v18
v_fma_f32 v196,v196,s26,-v18
v_mfma_f32_16x16x32_bf16 a[192:195],a[132:135],v[180:183],a[192:195]
s_add_u32 s22,s22,16384
v_mfma_f32_16x16x32_bf16 a[192:195],a[128:131],v[176:179],a[192:195]
s_waitcnt vmcnt(12)
s_waitcnt lgkmcnt(0)
s_barrier
ds_read_b128 a[96:99],v2 offset:0
v_exp_f32 v195,v195
v_fma_f32 v197,v197,s26,-v18
v_exp_f32 v196,v196
v_mfma_f32_16x16x32_bf16 a[176:179],a[128:131],v[168:171],a[176:179]
s_add_u32 s30,s24,16384
s_add_u32 s32,s24,20480
v_mfma_f32_16x16x32_bf16 a[176:179],a[132:135],v[172:175],a[176:179]
buffer_store_dwordx4 v[112:115],v22,s[16:19],s30 offen sc0 sc1
buffer_store_dwordx4 v[116:119],v22,s[16:19],s32 offen sc0 sc1
v_cvt_pk_bf16_f32 v229,v194,v195
v_exp_f32 v197,v197
v_mfma_f32_16x16x32_bf16 a[160:163],a[132:135],v[164:167],a[160:163]
v_mfma_f32_16x16x32_bf16 a[160:163],a[128:131],v[160:163],a[160:163]
ds_read_b128 a[100:103],v3 offset:0
v_cvt_pk_bf16_f32 v230,v196,v197
v_fma_f32 v198,v198,s26,-v18
v_fma_f32 v199,v199,s26,-v18
v_fma_f32 v200,v200,s26,-v19
v_mfma_f32_16x16x32_bf16 a[164:167],a[136:139],v[160:163],a[164:167]
v_mfma_f32_16x16x32_bf16 a[164:167],a[140:143],v[164:167],a[164:167]
ds_read_b128 a[80:83],v10 offset:0
v_exp_f32 v198,v198
v_exp_f32 v199,v199
v_fma_f32 v201,v201,s26,-v19
v_mfma_f32_16x16x32_bf16 a[180:183],a[140:143],v[172:175],a[180:183]
ds_read_b128 a[104:107],v4 offset:0
v_mfma_f32_16x16x32_bf16 a[180:183],a[136:139],v[168:171],a[180:183]
v_cvt_pk_bf16_f32 v231,v198,v199
v_exp_f32 v200,v200
v_exp_f32 v201,v201
v_mfma_f32_16x16x32_bf16 a[196:199],a[136:139],v[176:179],a[196:199]
v_mfma_f32_16x16x32_bf16 a[196:199],a[140:143],v[180:183],a[196:199]
v_cvt_pk_bf16_f32 v236,v200,v201
v_fma_f32 v202,v202,s26,-v19
v_fma_f32 v203,v203,s26,-v19
v_fma_f32 v204,v204,s26,-v19
v_fma_f32 v205,v205,s26,-v19
v_mfma_f32_16x16x32_bf16 a[212:215],a[140:143],v[188:191],a[212:215]
ds_read_b128 a[108:111],v5 offset:0
v_mfma_f32_16x16x32_bf16 a[212:215],a[136:139],v[184:187],a[212:215]
v_exp_f32 v202,v202
v_exp_f32 v203,v203
v_exp_f32 v204,v204
v_mfma_f32_16x16x32_bf16 a[216:219],a[144:147],v[184:187],a[216:219]
v_mfma_f32_16x16x32_bf16 a[216:219],a[148:151],v[188:191],a[216:219]
v_cvt_pk_bf16_f32 v237,v202,v203
v_exp_f32 v205,v205
v_fma_f32 v206,v206,s26,-v19
v_fma_f32 v207,v207,s26,-v19
v_mfma_f32_16x16x32_bf16 a[200:203],a[148:151],v[180:183],a[200:203]
ds_read_b128 a[112:115],v2 offset:1024
v_mfma_f32_16x16x32_bf16 a[200:203],a[144:147],v[176:179],a[200:203]
v_exp_f32 v206,v206
v_exp_f32 v207,v207
v_cvt_pk_bf16_f32 v238,v204,v205
v_fma_f32 v208,v208,s26,-v20
v_mfma_f32_16x16x32_bf16 a[184:187],a[144:147],v[168:171],a[184:187]
v_mfma_f32_16x16x32_bf16 a[184:187],a[148:151],v[172:175],a[184:187]
ds_read_b128 a[116:119],v3 offset:1024
v_exp_f32 v208,v208
v_cvt_pk_bf16_f32 v239,v206,v207
v_fma_f32 v209,v209,s26,-v20
v_mfma_f32_16x16x32_bf16 a[168:171],a[148:151],v[164:167],a[168:171]
ds_read_b128 a[84:87],v11 offset:0
v_mfma_f32_16x16x32_bf16 a[168:171],a[144:147],v[160:163],a[168:171]
v_exp_f32 v209,v209
v_fma_f32 v210,v210,s26,-v20
v_fma_f32 v211,v211,s26,-v20
v_fma_f32 v212,v212,s26,-v20
v_mfma_f32_16x16x32_bf16 a[172:175],a[152:155],v[160:163],a[172:175]
v_mfma_f32_16x16x32_bf16 a[172:175],a[156:159],v[164:167],a[172:175]
ds_read_b128 a[120:123],v4 offset:1024
v_cvt_pk_bf16_f32 v244,v208,v209
v_exp_f32 v210,v210
v_exp_f32 v211,v211
v_mfma_f32_16x16x32_bf16 a[188:191],a[156:159],v[172:175],a[188:191]
s_add_u32 s30,s24,24576
s_add_u32 s32,s24,28672
v_mfma_f32_16x16x32_bf16 a[188:191],a[152:155],v[168:171],a[188:191]
buffer_store_dwordx4 v[120:123],v22,s[16:19],s30 offen sc0 sc1
buffer_store_dwordx4 v[124:127],v22,s[16:19],s32 offen sc0 sc1
v_cvt_pk_bf16_f32 v245,v210,v211
v_exp_f32 v212,v212
v_mfma_f32_16x16x32_bf16 a[204:207],a[152:155],v[176:179],a[204:207]
v_mfma_f32_16x16x32_bf16 a[204:207],a[156:159],v[180:183],a[204:207]
ds_read_b128 a[124:127],v5 offset:1024
v_fma_f32 v213,v213,s26,-v20
v_fma_f32 v214,v214,s26,-v20
v_fma_f32 v215,v215,s26,-v20
v_fma_f32 v216,v216,s26,-v21
v_fma_f32 v217,v217,s26,-v21
v_mfma_f32_16x16x32_bf16 a[220:223],a[156:159],v[188:191],a[220:223]
v_mfma_f32_16x16x32_bf16 a[220:223],a[152:155],v[184:187],a[220:223]
s_waitcnt lgkmcnt(5)
v_exp_f32 v213,v213
v_exp_f32 v214,v214
v_fma_f32 v218,v218,s26,-v21
v_mfma_f32_16x16x32_bf16 v[160:163],a[96:99],a[0:3],0
ds_read_b128 a[128:131],v2 offset:2048
v_mfma_f32_16x16x32_bf16 v[160:163],a[100:103],a[4:7],v[160:163]
v_mfma_f32_16x16x32_bf16 v[160:163],a[104:107],a[8:11],v[160:163]
ds_read_b128 a[88:91],v12 offset:0
v_mfma_f32_16x16x32_bf16 v[160:163],a[108:111],a[12:15],v[160:163]
v_cvt_pk_bf16_f32 v246,v212,v213
v_exp_f32 v215,v215
v_exp_f32 v216,v216
v_mfma_f32_16x16x32_bf16 v[168:171],a[108:111],a[28:31],0
ds_read_b128 a[132:135],v3 offset:2048
v_mfma_f32_16x16x32_bf16 v[168:171],a[104:107],a[24:27],v[168:171]
v_mfma_f32_16x16x32_bf16 v[168:171],a[100:103],a[20:23],v[168:171]
v_mfma_f32_16x16x32_bf16 v[168:171],a[96:99],a[16:19],v[168:171]
v_exp_f32 v217,v217
v_exp_f32 v218,v218
v_cvt_pk_bf16_f32 v247,v214,v215
v_fma_f32 v219,v219,s26,-v21
v_mfma_f32_16x16x32_bf16 v[176:179],a[96:99],a[32:35],0
ds_read_b128 a[136:139],v4 offset:2048
v_mfma_f32_16x16x32_bf16 v[176:179],a[100:103],a[36:39],v[176:179]
v_mfma_f32_16x16x32_bf16 v[176:179],a[104:107],a[40:43],v[176:179]
v_mfma_f32_16x16x32_bf16 v[176:179],a[108:111],a[44:47],v[176:179]
ds_read_b128 a[140:143],v5 offset:2048
v_exp_f32 v219,v219
v_cvt_pk_bf16_f32 v252,v216,v217
v_fma_f32 v220,v220,s26,-v21
v_mfma_f32_16x16x32_bf16 v[184:187],a[108:111],a[60:63],0
v_mfma_f32_16x16x32_bf16 v[184:187],a[104:107],a[56:59],v[184:187]
s_waitcnt lgkmcnt(5)
v_mfma_f32_16x16x32_bf16 v[184:187],a[100:103],a[52:55],v[184:187]
ds_read_b128 a[92:95],v13 offset:0
v_mfma_f32_16x16x32_bf16 v[184:187],a[96:99],a[48:51],v[184:187]
ds_read_b128 a[144:147],v2 offset:3072
v_exp_f32 v220,v220
v_cvt_pk_bf16_f32 v253,v218,v219
v_fma_f32 v221,v221,s26,-v21
v_mfma_f32_16x16x32_bf16 v[164:167],a[112:115],a[0:3],0
v_mfma_f32_16x16x32_bf16 v[164:167],a[116:119],a[4:7],v[164:167]
v_mfma_f32_16x16x32_bf16 v[164:167],a[120:123],a[8:11],v[164:167]
v_mfma_f32_16x16x32_bf16 v[164:167],a[124:127],a[12:15],v[164:167]
ds_read_b128 a[148:151],v3 offset:3072
v_exp_f32 v221,v221
v_fma_f32 v222,v222,s26,-v21
v_fma_f32 v223,v223,s26,-v21
v_mfma_f32_16x16x32_bf16 v[172:175],a[124:127],a[28:31],0
v_mfma_f32_16x16x32_bf16 v[172:175],a[120:123],a[24:27],v[172:175]
v_mfma_f32_16x16x32_bf16 v[172:175],a[116:119],a[20:23],v[172:175]
ds_read_b128 a[152:155],v4 offset:3072
v_mfma_f32_16x16x32_bf16 v[172:175],a[112:115],a[16:19],v[172:175]
v_cvt_pk_bf16_f32 v254,v220,v221
v_exp_f32 v222,v222
v_exp_f32 v223,v223
v_mfma_f32_16x16x32_bf16 v[180:183],a[112:115],a[32:35],0
v_mfma_f32_16x16x32_bf16 v[180:183],a[116:119],a[36:39],v[180:183]
v_mfma_f32_16x16x32_bf16 v[180:183],a[120:123],a[40:43],v[180:183]
s_add_u32 m0,s25,32768
ds_read_b128 a[156:159],v5 offset:3072
v_mfma_f32_16x16x32_bf16 v[180:183],a[124:127],a[44:47],v[180:183]
buffer_load_dwordx4 v1,s[8:11],s21 offen nt lds
v_cvt_pk_bf16_f32 v255,v222,v223
v_mfma_f32_16x16x32_bf16 v[188:191],a[124:127],a[60:63],0
v_mfma_f32_16x16x32_bf16 v[188:191],a[120:123],a[56:59],v[188:191]
v_mfma_f32_16x16x32_bf16 v[188:191],a[116:119],a[52:55],v[188:191]
v_mfma_f32_16x16x32_bf16 v[188:191],a[112:115],a[48:51],v[188:191]
s_waitcnt lgkmcnt(5)
v_mfma_f32_16x16x32_bf16 v[192:195],a[128:131],a[0:3],0
v_mfma_f32_16x16x32_bf16 v[192:195],a[132:135],a[4:7],v[192:195]
v_mfma_f32_16x16x32_bf16 v[192:195],a[136:139],a[8:11],v[192:195]
v_mfma_f32_16x16x32_bf16 v[192:195],a[140:143],a[12:15],v[192:195]
buffer_load_dwordx4 v1,s[8:11],s21 offen offset:1024 nt lds
v_accvgpr_read_b32 v23,a244
v_accvgpr_read_b32 v24,a245
v_fma_f32 v160,v160,s26,-v18
v_fma_f32 v161,v161,s26,-v18
v_mfma_f32_16x16x32_bf16 v[200:203],a[140:143],a[28:31],0
ds_write_b128 v23,v[128:131] offset:32768
v_mfma_f32_16x16x32_bf16 v[200:203],a[136:139],a[24:27],v[200:203]
ds_read_b64_tr_b16 a[96:97],v6 offset:49152
v_mfma_f32_16x16x32_bf16 v[200:203],a[132:135],a[20:23],v[200:203]
ds_read_b64_tr_b16 a[98:99],v6 offset:50176
v_mfma_f32_16x16x32_bf16 v[200:203],a[128:131],a[16:19],v[200:203]
buffer_load_dwordx4 v1,s[8:11],s21 offen offset:2048 nt lds
v_exp_f32 v160,v160
v_exp_f32 v161,v161
v_mfma_f32_16x16x32_bf16 v[208:211],a[128:131],a[32:35],0
ds_read_b64_tr_b16 a[100:101],v6 offset:51200
v_mfma_f32_16x16x32_bf16 v[208:211],a[132:135],a[36:39],v[208:211]
ds_read_b64_tr_b16 a[102:103],v6 offset:52224
v_mfma_f32_16x16x32_bf16 v[208:211],a[136:139],a[40:43],v[208:211]
ds_write_b128 v23,v[132:135] offset:32832
v_mfma_f32_16x16x32_bf16 v[208:211],a[140:143],a[44:47],v[208:211]
buffer_load_dwordx4 v1,s[8:11],s21 offen offset:3072 nt lds
v_cvt_pk_bf16_f32 v160,v160,v161
v_fma_f32 v162,v162,s26,-v18
v_fma_f32 v163,v163,s26,-v18
v_fma_f32 v164,v164,s26,-v18
v_mfma_f32_16x16x32_bf16 v[216:219],a[140:143],a[60:63],0
s_add_u32 s21,s21,16384
ds_read_b64_tr_b16 a[104:105],v6 offset:49160
v_mfma_f32_16x16x32_bf16 v[216:219],a[136:139],a[56:59],v[216:219]
ds_read_b64_tr_b16 a[106:107],v6 offset:50184
v_mfma_f32_16x16x32_bf16 v[216:219],a[132:135],a[52:55],v[216:219]
ds_write_b128 v23,v[136:139] offset:32896
v_mfma_f32_16x16x32_bf16 v[216:219],a[128:131],a[48:51],v[216:219]
s_waitcnt lgkmcnt(9)
ds_write_b128 v23,v[140:143] offset:32960
v_exp_f32 v162,v162
v_exp_f32 v163,v163
v_mfma_f32_16x16x32_bf16 v[196:199],a[144:147],a[0:3],0
ds_read_b64_tr_b16 a[108:109],v6 offset:51208
v_mfma_f32_16x16x32_bf16 v[196:199],a[148:151],a[4:7],v[196:199]
ds_read_b64_tr_b16 a[110:111],v6 offset:52232
v_mfma_f32_16x16x32_bf16 v[196:199],a[152:155],a[8:11],v[196:199]
ds_read_b128 v[128:131],v24 offset:32768
v_mfma_f32_16x16x32_bf16 v[196:199],a[156:159],a[12:15],v[196:199]
ds_read_b64_tr_b16 a[112:113],v7 offset:49152
v_cvt_pk_bf16_f32 v161,v162,v163
v_exp_f32 v164,v164
v_fma_f32 v165,v165,s26,-v18
v_fma_f32 v166,v166,s26,-v18
v_mfma_f32_16x16x32_bf16 v[204:207],a[156:159],a[28:31],0
ds_read_b64_tr_b16 a[114:115],v7 offset:50176
v_mfma_f32_16x16x32_bf16 v[204:207],a[152:155],a[24:27],v[204:207]
s_waitcnt lgkmcnt(14)
ds_read_b128 v[132:135],v24 offset:33856
v_mfma_f32_16x16x32_bf16 v[204:207],a[148:151],a[20:23],v[204:207]
s_waitcnt lgkmcnt(14)
ds_read_b128 v[136:139],v24 offset:34944
v_mfma_f32_16x16x32_bf16 v[204:207],a[144:147],a[16:19],v[204:207]
s_waitcnt lgkmcnt(14)
ds_read_b64_tr_b16 a[116:117],v7 offset:51200
v_exp_f32 v165,v165
v_fma_f32 v167,v167,s26,-v18
v_exp_f32 v166,v166
v_mfma_f32_16x16x32_bf16 v[212:215],a[144:147],a[32:35],0
s_waitcnt lgkmcnt(14)
ds_read_b64_tr_b16 a[118:119],v7 offset:52224
v_mfma_f32_16x16x32_bf16 v[212:215],a[148:151],a[36:39],v[212:215]
s_waitcnt lgkmcnt(14)
ds_read_b128 v[140:143],v24 offset:36032
v_mfma_f32_16x16x32_bf16 v[212:215],a[152:155],a[40:43],v[212:215]
v_mfma_f32_16x16x32_bf16 v[212:215],a[156:159],a[44:47],v[212:215]
s_waitcnt lgkmcnt(14)
ds_read_b64_tr_b16 a[120:121],v7 offset:49160
v_exp_f32 v167,v167
v_cvt_pk_bf16_f32 v162,v164,v165
v_fma_f32 v168,v168,s26,-v19
v_mfma_f32_16x16x32_bf16 v[220:223],a[156:159],a[60:63],0
s_waitcnt lgkmcnt(14)
ds_read_b64_tr_b16 a[122:123],v7 offset:50184
v_mfma_f32_16x16x32_bf16 v[220:223],a[152:155],a[56:59],v[220:223]
v_mfma_f32_16x16x32_bf16 v[220:223],a[148:151],a[52:55],v[220:223]
s_waitcnt lgkmcnt(14)
ds_read_b64_tr_b16 a[124:125],v7 offset:51208
v_mfma_f32_16x16x32_bf16 v[220:223],a[144:147],a[48:51],v[220:223]
s_waitcnt lgkmcnt(14)
ds_read_b64_tr_b16 a[126:127],v7 offset:52232
v_cvt_pk_bf16_f32 v163,v166,v167
v_exp_f32 v168,v168
v_fma_f32 v169,v169,s26,-v19
v_fma_f32 v170,v170,s26,-v19
v_mfma_f32_16x16x32_bf16 a[224:227],a[240:243],v[224:227],a[224:227]
s_add_u32 m0,s25,81920
v_mfma_f32_16x16x32_bf16 a[224:227],a[240:243],v[228:231],a[224:227]
buffer_load_dwordx4 v1,s[12:15],s22 offen nt lds
v_exp_f32 v169,v169
v_exp_f32 v170,v170
v_mfma_f32_16x16x32_bf16 a[228:231],a[240:243],v[232:235],a[228:231]
s_waitcnt lgkmcnt(14)
ds_read_b64_tr_b16 a[128:129],v8 offset:49152
v_mfma_f32_16x16x32_bf16 a[228:231],a[240:243],v[236:239],a[228:231]
s_waitcnt lgkmcnt(14)
ds_read_b64_tr_b16 a[130:131],v8 offset:50176
v_cvt_pk_bf16_f32 v168,v168,v169
v_fma_f32 v171,v171,s26,-v19
v_fma_f32 v172,v172,s26,-v19
v_fma_f32 v173,v173,s26,-v19
v_fma_f32 v174,v174,s26,-v19
v_mfma_f32_16x16x32_bf16 a[232:235],a[240:243],v[240:243],a[232:235]
v_mfma_f32_16x16x32_bf16 a[232:235],a[240:243],v[244:247],a[232:235]
v_exp_f32 v171,v171
v_exp_f32 v172,v172
v_exp_f32 v173,v173
v_mfma_f32_16x16x32_bf16 a[236:239],a[240:243],v[248:251],a[236:239]
s_waitcnt lgkmcnt(14)
ds_read_b64_tr_b16 a[132:133],v8 offset:51200
v_mfma_f32_16x16x32_bf16 a[236:239],a[240:243],v[252:255],a[236:239]
s_waitcnt lgkmcnt(14)
ds_read_b64_tr_b16 a[134:135],v8 offset:52224
v_cvt_pk_bf16_f32 v169,v170,v171
v_exp_f32 v174,v174
v_cvt_pk_bf16_f32 v170,v172,v173
v_fma_f32 v175,v175,s26,-v19
v_mfma_f32_16x16x32_bf16 v[80:83],a[96:99],v[248:251],v[80:83]
v_mfma_f32_16x16x32_bf16 v[80:83],a[100:103],v[252:255],v[80:83]
s_waitcnt lgkmcnt(14)
ds_read_b64_tr_b16 a[136:137],v8 offset:49160
v_exp_f32 v175,v175
v_fma_f32 v176,v176,s26,-v20
v_fma_f32 v177,v177,s26,-v20
v_fma_f32 v178,v178,s26,-v20
v_mfma_f32_16x16x32_bf16 v[64:67],a[100:103],v[244:247],v[64:67]
s_waitcnt lgkmcnt(14)
ds_read_b64_tr_b16 a[138:139],v8 offset:50184
v_mfma_f32_16x16x32_bf16 v[64:67],a[96:99],v[240:243],v[64:67]
buffer_load_dwordx4 v1,s[12:15],s22 offen offset:1024 nt lds
v_exp_f32 v176,v176
v_exp_f32 v177,v177
v_mfma_f32_16x16x32_bf16 v[48:51],a[96:99],v[232:235],v[48:51]
v_mfma_f32_16x16x32_bf16 v[48:51],a[100:103],v[236:239],v[48:51]
s_waitcnt lgkmcnt(14)
ds_read_b64_tr_b16 a[140:141],v8 offset:51208
v_cvt_pk_bf16_f32 v171,v174,v175
v_exp_f32 v178,v178
v_cvt_pk_bf16_f32 v176,v176,v177
v_fma_f32 v179,v179,s26,-v20
v_mfma_f32_16x16x32_bf16 v[32:35],a[100:103],v[228:231],v[32:35]
s_waitcnt lgkmcnt(14)
ds_read_b64_tr_b16 a[142:143],v8 offset:52232
v_mfma_f32_16x16x32_bf16 v[32:35],a[96:99],v[224:227],v[32:35]
v_exp_f32 v179,v179
v_fma_f32 v180,v180,s26,-v20
v_fma_f32 v181,v181,s26,-v20
v_fma_f32 v182,v182,s26,-v20
v_fma_f32 v183,v183,s26,-v20
v_mfma_f32_16x16x32_bf16 v[36:39],a[104:107],v[224:227],v[36:39]
v_mfma_f32_16x16x32_bf16 v[36:39],a[108:111],v[228:231],v[36:39]
s_waitcnt lgkmcnt(14)
ds_read_b64_tr_b16 a[144:145],v9 offset:49152
v_cvt_pk_bf16_f32 v177,v178,v179
v_exp_f32 v180,v180
v_exp_f32 v181,v181
v_mfma_f32_16x16x32_bf16 v[52:55],a[108:111],v[236:239],v[52:55]
s_waitcnt lgkmcnt(14)
ds_read_b64_tr_b16 a[146:147],v9 offset:50176
v_mfma_f32_16x16x32_bf16 v[52:55],a[104:107],v[232:235],v[52:55]
buffer_load_dwordx4 v1,s[12:15],s22 offen offset:2048 nt lds
v_exp_f32 v182,v182
v_exp_f32 v183,v183
v_mfma_f32_16x16x32_bf16 v[68:71],a[104:107],v[240:243],v[68:71]
s_waitcnt lgkmcnt(14)
ds_read_b64_tr_b16 a[148:149],v9 offset:51200
v_mfma_f32_16x16x32_bf16 v[68:71],a[108:111],v[244:247],v[68:71]
s_waitcnt lgkmcnt(14)
ds_read_b64_tr_b16 a[150:151],v9 offset:52224
v_cvt_pk_bf16_f32 v178,v180,v181
v_cvt_pk_bf16_f32 v179,v182,v183
v_fma_f32 v184,v184,s26,-v21
v_fma_f32 v185,v185,s26,-v21
v_fma_f32 v186,v186,s26,-v21
v_mfma_f32_16x16x32_bf16 v[84:87],a[108:111],v[252:255],v[84:87]
v_mfma_f32_16x16x32_bf16 v[84:87],a[104:107],v[248:251],v[84:87]
v_exp_f32 v184,v184
v_exp_f32 v185,v185
v_fma_f32 v187,v187,s26,-v21
v_mfma_f32_16x16x32_bf16 v[88:91],a[112:115],v[248:251],v[88:91]
s_waitcnt lgkmcnt(14)
ds_read_b64_tr_b16 a[152:153],v9 offset:49160
v_mfma_f32_16x16x32_bf16 v[88:91],a[116:119],v[252:255],v[88:91]
s_waitcnt lgkmcnt(14)
ds_read_b64_tr_b16 a[154:155],v9 offset:50184
v_cvt_pk_bf16_f32 v184,v184,v185
v_exp_f32 v186,v186
v_exp_f32 v187,v187
v_mfma_f32_16x16x32_bf16 v[72:75],a[116:119],v[244:247],v[72:75]
v_mfma_f32_16x16x32_bf16 v[72:75],a[112:115],v[240:243],v[72:75]
s_waitcnt lgkmcnt(14)
ds_read_b64_tr_b16 a[156:157],v9 offset:51208
v_cvt_pk_bf16_f32 v185,v186,v187
v_fma_f32 v188,v188,s26,-v21
v_fma_f32 v189,v189,s26,-v21
v_fma_f32 v190,v190,s26,-v21
v_fma_f32 v191,v191,s26,-v21
v_mfma_f32_16x16x32_bf16 v[56:59],a[112:115],v[232:235],v[56:59]
s_waitcnt lgkmcnt(14)
ds_read_b64_tr_b16 a[158:159],v9 offset:52232
v_mfma_f32_16x16x32_bf16 v[56:59],a[116:119],v[236:239],v[56:59]
buffer_load_dwordx4 v1,s[12:15],s22 offen offset:3072 nt lds
v_exp_f32 v188,v188
v_exp_f32 v189,v189
v_mfma_f32_16x16x32_bf16 v[40:43],a[116:119],v[228:231],v[40:43]
s_add_u32 s22,s22,16384
v_mfma_f32_16x16x32_bf16 v[40:43],a[112:115],v[224:227],v[40:43]
v_exp_f32 v190,v190
v_exp_f32 v191,v191
v_cvt_pk_bf16_f32 v186,v188,v189
v_mfma_f32_16x16x32_bf16 v[44:47],a[120:123],v[224:227],v[44:47]
s_add_u32 m0,s25,147456
v_mfma_f32_16x16x32_bf16 v[44:47],a[124:127],v[228:231],v[44:47]
buffer_load_dwordx4 v1,s[4:7],s23 offen nt lds
v_cvt_pk_bf16_f32 v187,v190,v191
v_mfma_f32_16x16x32_bf16 v[60:63],a[124:127],v[236:239],v[60:63]
v_mfma_f32_16x16x32_bf16 v[60:63],a[120:123],v[232:235],v[60:63]
buffer_load_dwordx4 v1,s[4:7],s23 offen offset:1024 nt lds
v_mfma_f32_16x16x32_bf16 v[76:79],a[120:123],v[240:243],v[76:79]
v_mfma_f32_16x16x32_bf16 v[76:79],a[124:127],v[244:247],v[76:79]
buffer_load_dwordx4 v1,s[4:7],s23 offen offset:2048 nt lds
v_fma_f32 v192,v192,s26,-v18
v_fma_f32 v193,v193,s26,-v18
v_fma_f32 v194,v194,s26,-v18
v_mfma_f32_16x16x32_bf16 v[92:95],a[124:127],v[252:255],v[92:95]
v_mfma_f32_16x16x32_bf16 v[92:95],a[120:123],v[248:251],v[92:95]
s_waitcnt lgkmcnt(12)
v_exp_f32 v192,v192
v_exp_f32 v193,v193
v_fma_f32 v195,v195,s26,-v18
v_mfma_f32_16x16x32_bf16 a[208:211],a[128:131],v[248:251],a[208:211]
v_mfma_f32_16x16x32_bf16 a[208:211],a[132:135],v[252:255],a[208:211]
buffer_load_dwordx4 v1,s[4:7],s23 offen offset:3072 nt lds
v_cvt_pk_bf16_f32 v164,v192,v193
v_exp_f32 v194,v194
v_mfma_f32_16x16x32_bf16 a[192:195],a[132:135],v[244:247],a[192:195]
s_add_u32 s23,s23,16384
v_mfma_f32_16x16x32_bf16 a[192:195],a[128:131],v[240:243],a[192:195]
s_waitcnt vmcnt(16)
s_waitcnt lgkmcnt(0)
s_barrier
ds_read_b128 a[96:99],v2 offset:16384
v_exp_f32 v195,v195
v_fma_f32 v196,v196,s26,-v18
v_fma_f32 v197,v197,s26,-v18
v_fma_f32 v198,v198,s26,-v18
v_mfma_f32_16x16x32_bf16 a[176:179],a[128:131],v[232:235],a[176:179]
v_mfma_f32_16x16x32_bf16 a[176:179],a[132:135],v[236:239],a[176:179]
v_cvt_pk_bf16_f32 v165,v194,v195
v_exp_f32 v196,v196
v_exp_f32 v197,v197
v_mfma_f32_16x16x32_bf16 a[160:163],a[132:135],v[228:231],a[160:163]
v_mfma_f32_16x16x32_bf16 a[160:163],a[128:131],v[224:227],a[160:163]
ds_read_b128 a[100:103],v3 offset:16384
v_exp_f32 v198,v198
v_cvt_pk_bf16_f32 v166,v196,v197
v_fma_f32 v199,v199,s26,-v18
v_mfma_f32_16x16x32_bf16 a[164:167],a[136:139],v[224:227],a[164:167]
v_mfma_f32_16x16x32_bf16 a[164:167],a[140:143],v[228:231],a[164:167]
v_exp_f32 v199,v199
v_fma_f32 v200,v200,s26,-v19
v_fma_f32 v201,v201,s26,-v19
v_fma_f32 v202,v202,s26,-v19
v_mfma_f32_16x16x32_bf16 a[180:183],a[140:143],v[236:239],a[180:183]
ds_read_b128 a[104:107],v4 offset:16384
v_mfma_f32_16x16x32_bf16 a[180:183],a[136:139],v[232:235],a[180:183]
v_cvt_pk_bf16_f32 v167,v198,v199
v_exp_f32 v200,v200
v_exp_f32 v201,v201
v_mfma_f32_16x16x32_bf16 a[196:199],a[136:139],v[240:243],a[196:199]
v_mfma_f32_16x16x32_bf16 a[196:199],a[140:143],v[244:247],a[196:199]
v_cvt_pk_bf16_f32 v172,v200,v201
v_exp_f32 v202,v202
v_fma_f32 v203,v203,s26,-v19
v_fma_f32 v204,v204,s26,-v19
v_mfma_f32_16x16x32_bf16 a[212:215],a[140:143],v[252:255],a[212:215]
ds_read_b128 a[108:111],v5 offset:16384
v_mfma_f32_16x16x32_bf16 a[212:215],a[136:139],v[248:251],a[212:215]
v_exp_f32 v203,v203
v_exp_f32 v204,v204
v_fma_f32 v205,v205,s26,-v19
v_fma_f32 v206,v206,s26,-v19
v_mfma_f32_16x16x32_bf16 a[216:219],a[144:147],v[248:251],a[216:219]
v_mfma_f32_16x16x32_bf16 a[216:219],a[148:151],v[252:255],a[216:219]
v_cvt_pk_bf16_f32 v173,v202,v203
v_exp_f32 v205,v205
v_exp_f32 v206,v206
v_mfma_f32_16x16x32_bf16 a[200:203],a[148:151],v[244:247],a[200:203]
ds_read_b128 a[112:115],v2 offset:17408
v_mfma_f32_16x16x32_bf16 a[200:203],a[144:147],v[240:243],a[200:203]
v_cvt_pk_bf16_f32 v174,v204,v205
v_fma_f32 v207,v207,s26,-v19
v_fma_f32 v208,v208,s26,-v20
v_fma_f32 v209,v209,s26,-v20
v_fma_f32 v210,v210,s26,-v20
v_mfma_f32_16x16x32_bf16 a[184:187],a[144:147],v[232:235],a[184:187]
v_mfma_f32_16x16x32_bf16 a[184:187],a[148:151],v[236:239],a[184:187]
ds_read_b128 a[116:119],v3 offset:17408
v_exp_f32 v207,v207
v_exp_f32 v208,v208
v_mfma_f32_16x16x32_bf16 a[168:171],a[148:151],v[228:231],a[168:171]
v_mfma_f32_16x16x32_bf16 a[168:171],a[144:147],v[224:227],a[168:171]
v_cvt_pk_bf16_f32 v175,v206,v207
v_exp_f32 v209,v209
v_exp_f32 v210,v210
v_mfma_f32_16x16x32_bf16 a[172:175],a[152:155],v[224:227],a[172:175]
v_mfma_f32_16x16x32_bf16 a[172:175],a[156:159],v[228:231],a[172:175]
ds_read_b128 a[120:123],v4 offset:17408
v_cvt_pk_bf16_f32 v180,v208,v209
v_fma_f32 v211,v211,s26,-v20
v_fma_f32 v212,v212,s26,-v20
v_fma_f32 v213,v213,s26,-v20
v_mfma_f32_16x16x32_bf16 a[188:191],a[156:159],v[236:239],a[188:191]
v_mfma_f32_16x16x32_bf16 a[188:191],a[152:155],v[232:235],a[188:191]
v_exp_f32 v211,v211
v_exp_f32 v212,v212
v_fma_f32 v214,v214,s26,-v20
v_mfma_f32_16x16x32_bf16 a[204:207],a[152:155],v[240:243],a[204:207]
v_mfma_f32_16x16x32_bf16 a[204:207],a[156:159],v[244:247],a[204:207]
ds_read_b128 a[124:127],v5 offset:17408
v_cvt_pk_bf16_f32 v181,v210,v211
v_exp_f32 v213,v213
v_exp_f32 v214,v214
v_mfma_f32_16x16x32_bf16 a[220:223],a[156:159],v[252:255],a[220:223]
v_mfma_f32_16x16x32_bf16 a[220:223],a[152:155],v[248:251],a[220:223]
s_waitcnt lgkmcnt(4)
v_cvt_pk_bf16_f32 v182,v212,v213
v_fma_f32 v215,v215,s26,-v20
v_fma_f32 v216,v216,s26,-v21
v_fma_f32 v217,v217,s26,-v21
v_fma_f32 v218,v218,s26,-v21
v_mfma_f32_16x16x32_bf16 v[224:227],a[96:99],a[0:3],0
ds_read_b128 a[128:131],v2 offset:18432
v_mfma_f32_16x16x32_bf16 v[224:227],a[100:103],a[4:7],v[224:227]
v_mfma_f32_16x16x32_bf16 v[224:227],a[104:107],a[8:11],v[224:227]
v_mfma_f32_16x16x32_bf16 v[224:227],a[108:111],a[12:15],v[224:227]
v_exp_f32 v215,v215
v_exp_f32 v216,v216
v_fma_f32 v219,v219,s26,-v21
v_mfma_f32_16x16x32_bf16 v[232:235],a[108:111],a[28:31],0
ds_read_b128 a[132:135],v3 offset:18432
v_mfma_f32_16x16x32_bf16 v[232:235],a[104:107],a[24:27],v[232:235]
v_mfma_f32_16x16x32_bf16 v[232:235],a[100:103],a[20:23],v[232:235]
v_mfma_f32_16x16x32_bf16 v[232:235],a[96:99],a[16:19],v[232:235]
v_cvt_pk_bf16_f32 v183,v214,v215
v_exp_f32 v217,v217
v_exp_f32 v218,v218
v_mfma_f32_16x16x32_bf16 v[240:243],a[96:99],a[32:35],0
ds_read_b128 a[136:139],v4 offset:18432
v_mfma_f32_16x16x32_bf16 v[240:243],a[100:103],a[36:39],v[240:243]
v_mfma_f32_16x16x32_bf16 v[240:243],a[104:107],a[40:43],v[240:243]
v_mfma_f32_16x16x32_bf16 v[240:243],a[108:111],a[44:47],v[240:243]
ds_read_b128 a[140:143],v5 offset:18432
v_exp_f32 v219,v219
v_cvt_pk_bf16_f32 v188,v216,v217
v_fma_f32 v220,v220,s26,-v21
v_mfma_f32_16x16x32_bf16 v[248:251],a[108:111],a[60:63],0
v_mfma_f32_16x16x32_bf16 v[248:251],a[104:107],a[56:59],v[248:251]
v_mfma_f32_16x16x32_bf16 v[248:251],a[100:103],a[52:55],v[248:251]
s_waitcnt lgkmcnt(4)
v_mfma_f32_16x16x32_bf16 v[248:251],a[96:99],a[48:51],v[248:251]
ds_read_b128 a[144:147],v2 offset:19456
v_exp_f32 v220,v220
v_cvt_pk_bf16_f32 v189,v218,v219
v_fma_f32 v221,v221,s26,-v21
v_mfma_f32_16x16x32_bf16 v[228:231],a[112:115],a[0:3],0
v_mfma_f32_16x16x32_bf16 v[228:231],a[116:119],a[4:7],v[228:231]
v_mfma_f32_16x16x32_bf16 v[228:231],a[120:123],a[8:11],v[228:231]
v_mfma_f32_16x16x32_bf16 v[228:231],a[124:127],a[12:15],v[228:231]
ds_read_b128 a[148:151],v3 offset:19456
v_exp_f32 v221,v221
v_fma_f32 v222,v222,s26,-v21
v_fma_f32 v223,v223,s26,-v21
v_mfma_f32_16x16x32_bf16 v[236:239],a[124:127],a[28:31],0
v_mfma_f32_16x16x32_bf16 v[236:239],a[120:123],a[24:27],v[236:239]
v_mfma_f32_16x16x32_bf16 v[236:239],a[116:119],a[20:23],v[236:239]
ds_read_b128 a[152:155],v4 offset:19456
v_mfma_f32_16x16x32_bf16 v[236:239],a[112:115],a[16:19],v[236:239]
v_cvt_pk_bf16_f32 v190,v220,v221
v_exp_f32 v222,v222
v_exp_f32 v223,v223
v_mfma_f32_16x16x32_bf16 v[244:247],a[112:115],a[32:35],0
v_mfma_f32_16x16x32_bf16 v[244:247],a[116:119],a[36:39],v[244:247]
v_mfma_f32_16x16x32_bf16 v[244:247],a[120:123],a[40:43],v[244:247]
ds_read_b128 a[156:159],v5 offset:19456
v_mfma_f32_16x16x32_bf16 v[244:247],a[124:127],a[44:47],v[244:247]
v_cvt_pk_bf16_f32 v191,v222,v223
v_mfma_f32_16x16x32_bf16 v[252:255],a[124:127],a[60:63],0
v_mfma_f32_16x16x32_bf16 v[252:255],a[120:123],a[56:59],v[252:255]
v_mfma_f32_16x16x32_bf16 v[252:255],a[116:119],a[52:55],v[252:255]
v_mfma_f32_16x16x32_bf16 v[252:255],a[112:115],a[48:51],v[252:255]
s_waitcnt lgkmcnt(4)
v_mfma_f32_16x16x32_bf16 v[192:195],a[128:131],a[0:3],0
v_mfma_f32_16x16x32_bf16 v[192:195],a[132:135],a[4:7],v[192:195]
v_mfma_f32_16x16x32_bf16 v[192:195],a[136:139],a[8:11],v[192:195]
v_mfma_f32_16x16x32_bf16 v[192:195],a[140:143],a[12:15],v[192:195]
v_fma_f32 v224,v224,s26,-v18
v_fma_f32 v225,v225,s26,-v18
v_fma_f32 v226,v226,s26,-v18
v_fma_f32 v227,v227,s26,-v18
v_fma_f32 v228,v228,s26,-v18
v_mfma_f32_16x16x32_bf16 v[200:203],a[140:143],a[28:31],0
v_mfma_f32_16x16x32_bf16 v[200:203],a[136:139],a[24:27],v[200:203]
ds_read_b64_tr_b16 a[96:97],v6 offset:0
v_mfma_f32_16x16x32_bf16 v[200:203],a[132:135],a[20:23],v[200:203]
ds_read_b64_tr_b16 a[98:99],v6 offset:1024
v_mfma_f32_16x16x32_bf16 v[200:203],a[128:131],a[16:19],v[200:203]
v_exp_f32 v224,v224
v_exp_f32 v225,v225
v_exp_f32 v226,v226
v_mfma_f32_16x16x32_bf16 v[208:211],a[128:131],a[32:35],0
ds_read_b64_tr_b16 a[100:101],v6 offset:2048
v_mfma_f32_16x16x32_bf16 v[208:211],a[132:135],a[36:39],v[208:211]
ds_read_b64_tr_b16 a[102:103],v6 offset:3072
v_mfma_f32_16x16x32_bf16 v[208:211],a[136:139],a[40:43],v[208:211]
v_mfma_f32_16x16x32_bf16 v[208:211],a[140:143],a[44:47],v[208:211]
v_cvt_pk_bf16_f32 v224,v224,v225
v_exp_f32 v227,v227
v_exp_f32 v228,v228
v_mfma_f32_16x16x32_bf16 v[216:219],a[140:143],a[60:63],0
ds_read_b64_tr_b16 a[104:105],v6 offset:8
v_mfma_f32_16x16x32_bf16 v[216:219],a[136:139],a[56:59],v[216:219]
ds_read_b64_tr_b16 a[106:107],v6 offset:1032
v_mfma_f32_16x16x32_bf16 v[216:219],a[132:135],a[52:55],v[216:219]
v_mfma_f32_16x16x32_bf16 v[216:219],a[128:131],a[48:51],v[216:219]
s_waitcnt lgkmcnt(6)
v_cvt_pk_bf16_f32 v225,v226,v227
v_fma_f32 v229,v229,s26,-v18
v_fma_f32 v230,v230,s26,-v18
v_fma_f32 v231,v231,s26,-v18
v_fma_f32 v232,v232,s26,-v19
v_fma_f32 v233,v233,s26,-v19
v_mfma_f32_16x16x32_bf16 v[196:199],a[144:147],a[0:3],0
ds_read_b64_tr_b16 a[108:109],v6 offset:2056
v_mfma_f32_16x16x32_bf16 v[196:199],a[148:151],a[4:7],v[196:199]
ds_read_b64_tr_b16 a[110:111],v6 offset:3080
v_mfma_f32_16x16x32_bf16 v[196:199],a[152:155],a[8:11],v[196:199]
v_mfma_f32_16x16x32_bf16 v[196:199],a[156:159],a[12:15],v[196:199]
ds_read_b64_tr_b16 a[112:113],v7 offset:0
v_exp_f32 v229,v229
v_exp_f32 v230,v230
v_mfma_f32_16x16x32_bf16 v[204:207],a[156:159],a[28:31],0
ds_read_b64_tr_b16 a[114:115],v7 offset:1024
v_mfma_f32_16x16x32_bf16 v[204:207],a[152:155],a[24:27],v[204:207]
v_mfma_f32_16x16x32_bf16 v[204:207],a[148:151],a[20:23],v[204:207]
v_mfma_f32_16x16x32_bf16 v[204:207],a[144:147],a[16:19],v[204:207]
ds_read_b64_tr_b16 a[116:117],v7 offset:2048
v_cvt_pk_bf16_f32 v226,v228,v229
v_exp_f32 v231,v231
v_exp_f32 v232,v232
v_mfma_f32_16x16x32_bf16 v[212:215],a[144:147],a[32:35],0
ds_read_b64_tr_b16 a[118:119],v7 offset:3072
v_mfma_f32_16x16x32_bf16 v[212:215],a[148:151],a[36:39],v[212:215]
v_mfma_f32_16x16x32_bf16 v[212:215],a[152:155],a[40:43],v[212:215]
v_mfma_f32_16x16x32_bf16 v[212:215],a[156:159],a[44:47],v[212:215]
ds_read_b64_tr_b16 a[120:121],v7 offset:8
v_exp_f32 v233,v233
v_cvt_pk_bf16_f32 v227,v230,v231
v_fma_f32 v234,v234,s26,-v19
v_mfma_f32_16x16x32_bf16 v[220:223],a[156:159],a[60:63],0
ds_read_b64_tr_b16 a[122:123],v7 offset:1032
v_mfma_f32_16x16x32_bf16 v[220:223],a[152:155],a[56:59],v[220:223]
v_mfma_f32_16x16x32_bf16 v[220:223],a[148:151],a[52:55],v[220:223]
ds_read_b64_tr_b16 a[124:125],v7 offset:2056
v_mfma_f32_16x16x32_bf16 v[220:223],a[144:147],a[48:51],v[220:223]
s_waitcnt lgkmcnt(14)
ds_read_b64_tr_b16 a[126:127],v7 offset:3080
v_cvt_pk_bf16_f32 v232,v232,v233
v_exp_f32 v234,v234
v_fma_f32 v235,v235,s26,-v19
v_fma_f32 v236,v236,s26,-v19
v_mfma_f32_16x16x32_bf16 a[224:227],a[240:243],v[160:163],a[224:227]
s_add_u32 m0,s25,49152
v_mfma_f32_16x16x32_bf16 a[224:227],a[240:243],v[164:167],a[224:227]
buffer_load_dwordx4 v1,s[8:11],s21 offen nt lds
v_exp_f32 v235,v235
v_fma_f32 v237,v237,s26,-v19
v_mfma_f32_16x16x32_bf16 a[228:231],a[240:243],v[168:171],a[228:231]
s_waitcnt lgkmcnt(14)
ds_read_b64_tr_b16 a[128:129],v8 offset:0
v_mfma_f32_16x16x32_bf16 a[228:231],a[240:243],v[172:175],a[228:231]
s_waitcnt lgkmcnt(14)
ds_read_b64_tr_b16 a[130:131],v8 offset:1024
v_cvt_pk_bf16_f32 v233,v234,v235
v_exp_f32 v236,v236
v_exp_f32 v237,v237
v_mfma_f32_16x16x32_bf16 a[232:235],a[240:243],v[176:179],a[232:235]
v_mfma_f32_16x16x32_bf16 a[232:235],a[240:243],v[180:183],a[232:235]
s_waitcnt lgkmcnt(14)
v_cvt_pk_bf16_f32 v234,v236,v237
v_fma_f32 v238,v238,s26,-v19
v_fma_f32 v239,v239,s26,-v19
v_fma_f32 v240,v240,s26,-v20
v_fma_f32 v241,v241,s26,-v20
v_mfma_f32_16x16x32_bf16 a[236:239],a[240:243],v[184:187],a[236:239]
ds_read_b64_tr_b16 a[132:133],v8 offset:2048
v_mfma_f32_16x16x32_bf16 a[236:239],a[240:243],v[188:191],a[236:239]
s_waitcnt lgkmcnt(14)
ds_read_b64_tr_b16 a[134:135],v8 offset:3072
v_exp_f32 v238,v238
v_exp_f32 v239,v239
v_fma_f32 v242,v242,s26,-v20
v_mfma_f32_16x16x32_bf16 v[80:83],a[96:99],v[184:187],v[80:83]
v_mfma_f32_16x16x32_bf16 v[80:83],a[100:103],v[188:191],v[80:83]
s_waitcnt lgkmcnt(14)
ds_read_b64_tr_b16 a[136:137],v8 offset:8
v_exp_f32 v240,v240
v_exp_f32 v241,v241
v_mfma_f32_16x16x32_bf16 v[64:67],a[100:103],v[180:183],v[64:67]
s_waitcnt lgkmcnt(14)
ds_read_b64_tr_b16 a[138:139],v8 offset:1032
v_mfma_f32_16x16x32_bf16 v[64:67],a[96:99],v[176:179],v[64:67]
buffer_load_dwordx4 v1,s[8:11],s21 offen offset:1024 nt lds
v_cvt_pk_bf16_f32 v235,v238,v239
v_exp_f32 v242,v242
v_mfma_f32_16x16x32_bf16 v[48:51],a[96:99],v[168:171],v[48:51]
v_mfma_f32_16x16x32_bf16 v[48:51],a[100:103],v[172:175],v[48:51]
s_waitcnt lgkmcnt(14)
ds_read_b64_tr_b16 a[140:141],v8 offset:2056
v_cvt_pk_bf16_f32 v240,v240,v241
v_fma_f32 v243,v243,s26,-v20
v_fma_f32 v244,v244,s26,-v20
v_fma_f32 v245,v245,s26,-v20
v_fma_f32 v246,v246,s26,-v20
v_mfma_f32_16x16x32_bf16 v[32:35],a[100:103],v[164:167],v[32:35]
s_waitcnt lgkmcnt(14)
ds_read_b64_tr_b16 a[142:143],v8 offset:3080
v_mfma_f32_16x16x32_bf16 v[32:35],a[96:99],v[160:163],v[32:35]
v_exp_f32 v243,v243
v_exp_f32 v244,v244
v_fma_f32 v247,v247,s26,-v20
v_mfma_f32_16x16x32_bf16 v[36:39],a[104:107],v[160:163],v[36:39]
v_mfma_f32_16x16x32_bf16 v[36:39],a[108:111],v[164:167],v[36:39]
s_waitcnt lgkmcnt(14)
ds_read_b64_tr_b16 a[144:145],v9 offset:0
v_cvt_pk_bf16_f32 v241,v242,v243
v_exp_f32 v245,v245
v_exp_f32 v246,v246
v_mfma_f32_16x16x32_bf16 v[52:55],a[108:111],v[172:175],v[52:55]
s_waitcnt lgkmcnt(14)
ds_read_b64_tr_b16 a[146:147],v9 offset:1024
v_mfma_f32_16x16x32_bf16 v[52:55],a[104:107],v[168:171],v[52:55]
buffer_load_dwordx4 v1,s[8:11],s21 offen offset:2048 nt lds
v_cvt_pk_bf16_f32 v242,v244,v245
v_exp_f32 v247,v247
v_mfma_f32_16x16x32_bf16 v[68:71],a[104:107],v[176:179],v[68:71]
s_waitcnt lgkmcnt(14)
ds_read_b64_tr_b16 a[148:149],v9 offset:2048
v_mfma_f32_16x16x32_bf16 v[68:71],a[108:111],v[180:183],v[68:71]
s_waitcnt lgkmcnt(14)
ds_read_b64_tr_b16 a[150:151],v9 offset:3072
v_cvt_pk_bf16_f32 v243,v246,v247
v_fma_f32 v248,v248,s26,-v21
v_fma_f32 v249,v249,s26,-v21
v_fma_f32 v250,v250,s26,-v21
v_fma_f32 v251,v251,s26,-v21
v_mfma_f32_16x16x32_bf16 v[84:87],a[108:111],v[188:191],v[84:87]
v_mfma_f32_16x16x32_bf16 v[84:87],a[104:107],v[184:187],v[84:87]
v_exp_f32 v248,v248
v_exp_f32 v249,v249
v_fma_f32 v252,v252,s26,-v21
v_mfma_f32_16x16x32_bf16 v[88:91],a[112:115],v[184:187],v[88:91]
s_waitcnt lgkmcnt(14)
ds_read_b64_tr_b16 a[152:153],v9 offset:8
v_mfma_f32_16x16x32_bf16 v[88:91],a[116:119],v[188:191],v[88:91]
s_waitcnt lgkmcnt(14)
ds_read_b64_tr_b16 a[154:155],v9 offset:1032
v_cvt_pk_bf16_f32 v248,v248,v249
v_exp_f32 v250,v250
v_exp_f32 v251,v251
v_mfma_f32_16x16x32_bf16 v[72:75],a[116:119],v[180:183],v[72:75]
v_mfma_f32_16x16x32_bf16 v[72:75],a[112:115],v[176:179],v[72:75]
s_waitcnt lgkmcnt(14)
ds_read_b64_tr_b16 a[156:157],v9 offset:2056
v_exp_f32 v252,v252
v_cvt_pk_bf16_f32 v249,v250,v251
v_fma_f32 v253,v253,s26,-v21
v_mfma_f32_16x16x32_bf16 v[56:59],a[112:115],v[168:171],v[56:59]
s_waitcnt lgkmcnt(14)
ds_read_b64_tr_b16 a[158:159],v9 offset:3080
v_mfma_f32_16x16x32_bf16 v[56:59],a[116:119],v[172:175],v[56:59]
buffer_load_dwordx4 v1,s[8:11],s21 offen offset:3072 nt lds
v_exp_f32 v253,v253
v_fma_f32 v254,v254,s26,-v21
v_fma_f32 v255,v255,s26,-v21
v_mfma_f32_16x16x32_bf16 v[40:43],a[116:119],v[164:167],v[40:43]
s_add_u32 s21,s21,16384
v_mfma_f32_16x16x32_bf16 v[40:43],a[112:115],v[160:163],v[40:43]
v_cvt_pk_bf16_f32 v250,v252,v253
v_exp_f32 v254,v254
v_exp_f32 v255,v255
v_mfma_f32_16x16x32_bf16 v[44:47],a[120:123],v[160:163],v[44:47]
s_add_u32 m0,s25,98304
v_mfma_f32_16x16x32_bf16 v[44:47],a[124:127],v[164:167],v[44:47]
buffer_load_dwordx4 v1,s[12:15],s22 offen nt lds
v_cvt_pk_bf16_f32 v251,v254,v255
v_mfma_f32_16x16x32_bf16 v[60:63],a[124:127],v[172:175],v[60:63]
v_mfma_f32_16x16x32_bf16 v[60:63],a[120:123],v[168:171],v[60:63]
buffer_load_dwordx4 v1,s[12:15],s22 offen offset:1024 nt lds
v_mfma_f32_16x16x32_bf16 v[76:79],a[120:123],v[176:179],v[76:79]
v_fma_f32 v192,v192,s26,-v18
v_fma_f32 v193,v193,s26,-v18
v_mfma_f32_16x16x32_bf16 v[76:79],a[124:127],v[180:183],v[76:79]
buffer_load_dwordx4 v1,s[12:15],s22 offen offset:2048 nt lds
v_mfma_f32_16x16x32_bf16 v[92:95],a[124:127],v[188:191],v[92:95]
v_exp_f32 v192,v192
v_mfma_f32_16x16x32_bf16 v[92:95],a[120:123],v[184:187],v[92:95]
s_waitcnt lgkmcnt(12)
v_exp_f32 v193,v193
v_fma_f32 v194,v194,s26,-v18
v_mfma_f32_16x16x32_bf16 a[208:211],a[128:131],v[184:187],a[208:211]
v_exp_f32 v194,v194
v_mfma_f32_16x16x32_bf16 a[208:211],a[132:135],v[188:191],a[208:211]
buffer_load_dwordx4 v1,s[12:15],s22 offen offset:3072 nt lds
v_mfma_f32_16x16x32_bf16 a[192:195],a[132:135],v[180:183],a[192:195]
s_add_u32 s22,s22,16384
v_cvt_pk_bf16_f32 v228,v192,v193
v_fma_f32 v195,v195,s26,-v18
v_mfma_f32_16x16x32_bf16 a[192:195],a[128:131],v[176:179],a[192:195]
s_waitcnt vmcnt(12)
s_waitcnt lgkmcnt(0)
s_barrier
ds_read_b128 a[96:99],v2 offset:32768
v_fma_f32 v196,v196,s26,-v18
v_mfma_f32_16x16x32_bf16 a[176:179],a[128:131],v[168:171],a[176:179]
s_add_u32 s30,s24,32768
s_add_u32 s32,s24,36864
v_fma_f32 v197,v197,s26,-v18
v_mfma_f32_16x16x32_bf16 a[176:179],a[132:135],v[172:175],a[176:179]
buffer_store_dwordx4 v[128:131],v22,s[16:19],s30 offen sc0 sc1
buffer_store_dwordx4 v[132:135],v22,s[16:19],s32 offen sc0 sc1
v_fma_f32 v198,v198,s26,-v18
v_mfma_f32_16x16x32_bf16 a[160:163],a[132:135],v[164:167],a[160:163]
v_exp_f32 v195,v195
v_mfma_f32_16x16x32_bf16 a[160:163],a[128:131],v[160:163],a[160:163]
ds_read_b128 a[100:103],v3 offset:32768
v_cvt_pk_bf16_f32 v229,v194,v195
v_mfma_f32_16x16x32_bf16 a[164:167],a[136:139],v[160:163],a[164:167]
v_exp_f32 v196,v196
v_mfma_f32_16x16x32_bf16 a[164:167],a[140:143],v[164:167],a[164:167]
v_exp_f32 v197,v197
v_mfma_f32_16x16x32_bf16 a[180:183],a[140:143],v[172:175],a[180:183]
ds_read_b128 a[104:107],v4 offset:32768
v_cvt_pk_bf16_f32 v230,v196,v197
v_mfma_f32_16x16x32_bf16 a[180:183],a[136:139],v[168:171],a[180:183]
v_exp_f32 v198,v198
v_mfma_f32_16x16x32_bf16 a[196:199],a[136:139],v[176:179],a[196:199]
v_fma_f32 v199,v199,s26,-v18
v_fma_f32 v200,v200,s26,-v19
v_mfma_f32_16x16x32_bf16 a[196:199],a[140:143],v[180:183],a[196:199]
v_exp_f32 v199,v199
v_fma_f32 v201,v201,s26,-v19
v_mfma_f32_16x16x32_bf16 a[212:215],a[140:143],v[188:191],a[212:215]
ds_read_b128 a[108:111],v5 offset:32768
v_cvt_pk_bf16_f32 v231,v198,v199
v_mfma_f32_16x16x32_bf16 a[212:215],a[136:139],v[184:187],a[212:215]
v_exp_f32 v200,v200
v_mfma_f32_16x16x32_bf16 a[216:219],a[144:147],v[184:187],a[216:219]
v_exp_f32 v201,v201
v_mfma_f32_16x16x32_bf16 a[216:219],a[148:151],v[188:191],a[216:219]
v_cvt_pk_bf16_f32 v236,v200,v201
v_fma_f32 v202,v202,s26,-v19
v_mfma_f32_16x16x32_bf16 a[200:203],a[148:151],v[180:183],a[200:203]
ds_read_b128 a[112:115],v2 offset:33792
v_fma_f32 v203,v203,s26,-v19
v_mfma_f32_16x16x32_bf16 a[200:203],a[144:147],v[176:179],a[200:203]
v_exp_f32 v202,v202
v_fma_f32 v204,v204,s26,-v19
v_mfma_f32_16x16x32_bf16 a[184:187],a[144:147],v[168:171],a[184:187]
v_exp_f32 v203,v203
v_mfma_f32_16x16x32_bf16 a[184:187],a[148:151],v[172:175],a[184:187]
ds_read_b128 a[116:119],v3 offset:33792
v_cvt_pk_bf16_f32 v237,v202,v203
v_mfma_f32_16x16x32_bf16 a[168:171],a[148:151],v[164:167],a[168:171]
v_exp_f32 v204,v204
v_mfma_f32_16x16x32_bf16 a[168:171],a[144:147],v[160:163],a[168:171]
v_fma_f32 v205,v205,s26,-v19
v_fma_f32 v206,v206,s26,-v19
v_mfma_f32_16x16x32_bf16 a[172:175],a[152:155],v[160:163],a[172:175]
v_exp_f32 v205,v205
v_mfma_f32_16x16x32_bf16 a[172:175],a[156:159],v[164:167],a[172:175]
ds_read_b128 a[120:123],v4 offset:33792
v_exp_f32 v206,v206
v_mfma_f32_16x16x32_bf16 a[188:191],a[156:159],v[172:175],a[188:191]
s_add_u32 s30,s24,40960
s_add_u32 s32,s24,45056
v_cvt_pk_bf16_f32 v238,v204,v205
v_mfma_f32_16x16x32_bf16 a[188:191],a[152:155],v[168:171],a[188:191]
buffer_store_dwordx4 v[136:139],v22,s[16:19],s30 offen sc0 sc1
buffer_store_dwordx4 v[140:143],v22,s[16:19],s32 offen sc0 sc1
v_mfma_f32_16x16x32_bf16 a[204:207],a[152:155],v[176:179],a[204:207]
v_fma_f32 v207,v207,s26,-v19
v_fma_f32 v208,v208,s26,-v20
v_mfma_f32_16x16x32_bf16 a[204:207],a[156:159],v[180:183],a[204:207]
ds_read_b128 a[124:127],v5 offset:33792
v_fma_f32 v209,v209,s26,-v20
v_mfma_f32_16x16x32_bf16 a[220:223],a[156:159],v[188:191],a[220:223]
v_exp_f32 v207,v207
v_mfma_f32_16x16x32_bf16 a[220:223],a[152:155],v[184:187],a[220:223]
s_waitcnt lgkmcnt(4)
v_cvt_pk_bf16_f32 v239,v206,v207
v_exp_f32 v208,v208
v_mfma_f32_16x16x32_bf16 v[160:163],a[96:99],a[0:3],0
ds_read_b128 a[128:131],v2 offset:34816
v_fma_f32 v210,v210,s26,-v20
v_mfma_f32_16x16x32_bf16 v[160:163],a[100:103],a[4:7],v[160:163]
v_exp_f32 v209,v209
v_mfma_f32_16x16x32_bf16 v[160:163],a[104:107],a[8:11],v[160:163]
v_exp_f32 v210,v210
v_mfma_f32_16x16x32_bf16 v[160:163],a[108:111],a[12:15],v[160:163]
v_cvt_pk_bf16_f32 v244,v208,v209
v_fma_f32 v211,v211,s26,-v20
v_mfma_f32_16x16x32_bf16 v[168:171],a[108:111],a[28:31],0
ds_read_b128 a[132:135],v3 offset:34816
v_fma_f32 v212,v212,s26,-v20
v_mfma_f32_16x16x32_bf16 v[168:171],a[104:107],a[24:27],v[168:171]
v_exp_f32 v211,v211
v_mfma_f32_16x16x32_bf16 v[168:171],a[100:103],a[20:23],v[168:171]
v_exp_f32 v212,v212
v_mfma_f32_16x16x32_bf16 v[168:171],a[96:99],a[16:19],v[168:171]
v_cvt_pk_bf16_f32 v245,v210,v211
v_fma_f32 v213,v213,s26,-v20
v_mfma_f32_16x16x32_bf16 v[176:179],a[96:99],a[32:35],0
ds_read_b128 a[136:139],v4 offset:34816
v_fma_f32 v214,v214,s26,-v20
v_mfma_f32_16x16x32_bf16 v[176:179],a[100:103],a[36:39],v[176:179]
v_exp_f32 v213,v213
v_mfma_f32_16x16x32_bf16 v[176:179],a[104:107],a[40:43],v[176:179]
v_exp_f32 v214,v214
v_mfma_f32_16x16x32_bf16 v[176:179],a[108:111],a[44:47],v[176:179]
ds_read_b128 a[140:143],v5 offset:34816
v_cvt_pk_bf16_f32 v246,v212,v213
v_mfma_f32_16x16x32_bf16 v[184:187],a[108:111],a[60:63],0
v_fma_f32 v215,v215,s26,-v20
v_fma_f32 v216,v216,s26,-v21
v_mfma_f32_16x16x32_bf16 v[184:187],a[104:107],a[56:59],v[184:187]
v_exp_f32 v215,v215
v_mfma_f32_16x16x32_bf16 v[184:187],a[100:103],a[52:55],v[184:187]
s_waitcnt lgkmcnt(4)
v_exp_f32 v216,v216
v_mfma_f32_16x16x32_bf16 v[184:187],a[96:99],a[48:51],v[184:187]
ds_read_b128 a[144:147],v2 offset:35840
v_cvt_pk_bf16_f32 v247,v214,v215
v_fma_f32 v217,v217,s26,-v21
v_mfma_f32_16x16x32_bf16 v[164:167],a[112:115],a[0:3],0
v_exp_f32 v217,v217
v_mfma_f32_16x16x32_bf16 v[164:167],a[116:119],a[4:7],v[164:167]
v_cvt_pk_bf16_f32 v252,v216,v217
v_fma_f32 v218,v218,s26,-v21
v_mfma_f32_16x16x32_bf16 v[164:167],a[120:123],a[8:11],v[164:167]
v_exp_f32 v218,v218
v_mfma_f32_16x16x32_bf16 v[164:167],a[124:127],a[12:15],v[164:167]
ds_read_b128 a[148:151],v3 offset:35840
v_fma_f32 v219,v219,s26,-v21
v_mfma_f32_16x16x32_bf16 v[172:175],a[124:127],a[28:31],0
v_exp_f32 v219,v219
v_mfma_f32_16x16x32_bf16 v[172:175],a[120:123],a[24:27],v[172:175]
v_cvt_pk_bf16_f32 v253,v218,v219
v_fma_f32 v220,v220,s26,-v21
v_mfma_f32_16x16x32_bf16 v[172:175],a[116:119],a[20:23],v[172:175]
ds_read_b128 a[152:155],v4 offset:35840
v_fma_f32 v221,v221,s26,-v21
v_mfma_f32_16x16x32_bf16 v[172:175],a[112:115],a[16:19],v[172:175]
v_exp_f32 v220,v220
v_mfma_f32_16x16x32_bf16 v[180:183],a[112:115],a[32:35],0
v_exp_f32 v221,v221
v_mfma_f32_16x16x32_bf16 v[180:183],a[116:119],a[36:39],v[180:183]
v_cvt_pk_bf16_f32 v254,v220,v221
v_fma_f32 v222,v222,s26,-v21
v_mfma_f32_16x16x32_bf16 v[180:183],a[120:123],a[40:43],v[180:183]
s_add_u32 m0,s25,0
ds_read_b128 a[156:159],v5 offset:35840
v_mfma_f32_16x16x32_bf16 v[180:183],a[124:127],a[44:47],v[180:183]
buffer_load_dwordx4 v1,s[8:11],s21 offen nt lds
v_fma_f32 v223,v223,s26,-v21
v_mfma_f32_16x16x32_bf16 v[188:191],a[124:127],a[60:63],0
v_exp_f32 v222,v222
v_mfma_f32_16x16x32_bf16 v[188:191],a[120:123],a[56:59],v[188:191]
v_exp_f32 v223,v223
v_mfma_f32_16x16x32_bf16 v[188:191],a[116:119],a[52:55],v[188:191]
v_cvt_pk_bf16_f32 v255,v222,v223
v_mfma_f32_16x16x32_bf16 v[188:191],a[112:115],a[48:51],v[188:191]
s_waitcnt lgkmcnt(4)
v_mfma_f32_16x16x32_bf16 v[192:195],a[128:131],a[0:3],0
v_fma_f32 v160,v160,s26,-v18
v_fma_f32 v161,v161,s26,-v18
v_mfma_f32_16x16x32_bf16 v[192:195],a[132:135],a[4:7],v[192:195]
v_exp_f32 v160,v160
v_mfma_f32_16x16x32_bf16 v[192:195],a[136:139],a[8:11],v[192:195]
v_exp_f32 v161,v161
v_mfma_f32_16x16x32_bf16 v[192:195],a[140:143],a[12:15],v[192:195]
buffer_load_dwordx4 v1,s[8:11],s21 offen offset:1024 nt lds
v_cvt_pk_bf16_f32 v160,v160,v161
v_mfma_f32_16x16x32_bf16 v[200:203],a[140:143],a[28:31],0
v_fma_f32 v162,v162,s26,-v18
v_fma_f32 v163,v163,s26,-v18
v_mfma_f32_16x16x32_bf16 v[200:203],a[136:139],a[24:27],v[200:203]
ds_read_b64_tr_b16 a[96:97],v6 offset:16384
v_fma_f32 v164,v164,s26,-v18
v_mfma_f32_16x16x32_bf16 v[200:203],a[132:135],a[20:23],v[200:203]
ds_read_b64_tr_b16 a[98:99],v6 offset:17408
v_fma_f32 v165,v165,s26,-v18
v_mfma_f32_16x16x32_bf16 v[200:203],a[128:131],a[16:19],v[200:203]
buffer_load_dwordx4 v1,s[8:11],s21 offen offset:2048 nt lds
v_fma_f32 v166,v166,s26,-v18
v_mfma_f32_16x16x32_bf16 v[208:211],a[128:131],a[32:35],0
ds_read_b64_tr_b16 a[100:101],v6 offset:18432
v_fma_f32 v167,v167,s26,-v18
v_mfma_f32_16x16x32_bf16 v[208:211],a[132:135],a[36:39],v[208:211]
ds_read_b64_tr_b16 a[102:103],v6 offset:19456
v_fma_f32 v168,v168,s26,-v19
v_mfma_f32_16x16x32_bf16 v[208:211],a[136:139],a[40:43],v[208:211]
v_exp_f32 v162,v162
v_mfma_f32_16x16x32_bf16 v[208:211],a[140:143],a[44:47],v[208:211]
buffer_load_dwordx4 v1,s[8:11],s21 offen offset:3072 nt lds
v_fma_f32 v169,v169,s26,-v19
v_mfma_f32_16x16x32_bf16 v[216:219],a[140:143],a[60:63],0
s_add_u32 s21,s21,16384
ds_read_b64_tr_b16 a[104:105],v6 offset:16392
v_mfma_f32_16x16x32_bf16 v[216:219],a[136:139],a[56:59],v[216:219]
ds_read_b64_tr_b16 a[106:107],v6 offset:17416
v_fma_f32 v170,v170,s26,-v19
v_mfma_f32_16x16x32_bf16 v[216:219],a[132:135],a[52:55],v[216:219]
v_exp_f32 v163,v163
v_mfma_f32_16x16x32_bf16 v[216:219],a[128:131],a[48:51],v[216:219]
s_waitcnt lgkmcnt(6)
v_exp_f32 v164,v164
v_exp_f32 v165,v165
v_mfma_f32_16x16x32_bf16 v[196:199],a[144:147],a[0:3],0
ds_read_b64_tr_b16 a[108:109],v6 offset:18440
v_cvt_pk_bf16_f32 v161,v162,v163
v_mfma_f32_16x16x32_bf16 v[196:199],a[148:151],a[4:7],v[196:199]
ds_read_b64_tr_b16 a[110:111],v6 offset:19464
v_cvt_pk_bf16_f32 v162,v164,v165
v_mfma_f32_16x16x32_bf16 v[196:199],a[152:155],a[8:11],v[196:199]
v_exp_f32 v166,v166
v_mfma_f32_16x16x32_bf16 v[196:199],a[156:159],a[12:15],v[196:199]
ds_read_b64_tr_b16 a[112:113],v7 offset:16384
v_exp_f32 v167,v167
v_mfma_f32_16x16x32_bf16 v[204:207],a[156:159],a[28:31],0
ds_read_b64_tr_b16 a[114:115],v7 offset:17408
v_cvt_pk_bf16_f32 v163,v166,v167
v_mfma_f32_16x16x32_bf16 v[204:207],a[152:155],a[24:27],v[204:207]
v_exp_f32 v168,v168
v_mfma_f32_16x16x32_bf16 v[204:207],a[148:151],a[20:23],v[204:207]
v_exp_f32 v169,v169
v_mfma_f32_16x16x32_bf16 v[204:207],a[144:147],a[16:19],v[204:207]
ds_read_b64_tr_b16 a[116:117],v7 offset:18432
v_exp_f32 v170,v170
v_mfma_f32_16x16x32_bf16 v[212:215],a[144:147],a[32:35],0
ds_read_b64_tr_b16 a[118:119],v7 offset:19456
v_cvt_pk_bf16_f32 v168,v168,v169
v_mfma_f32_16x16x32_bf16 v[212:215],a[148:151],a[36:39],v[212:215]
v_fma_f32 v171,v171,s26,-v19
v_fma_f32 v172,v172,s26,-v19
v_mfma_f32_16x16x32_bf16 v[212:215],a[152:155],a[40:43],v[212:215]
v_exp_f32 v171,v171
v_mfma_f32_16x16x32_bf16 v[212:215],a[156:159],a[44:47],v[212:215]
ds_read_b64_tr_b16 a[120:121],v7 offset:16392
v_exp_f32 v172,v172
v_mfma_f32_16x16x32_bf16 v[220:223],a[156:159],a[60:63],0
ds_read_b64_tr_b16 a[122:123],v7 offset:17416
v_cvt_pk_bf16_f32 v169,v170,v171
v_mfma_f32_16x16x32_bf16 v[220:223],a[152:155],a[56:59],v[220:223]
v_fma_f32 v173,v173,s26,-v19
v_fma_f32 v174,v174,s26,-v19
v_mfma_f32_16x16x32_bf16 v[220:223],a[148:151],a[52:55],v[220:223]
ds_read_b64_tr_b16 a[124:125],v7 offset:18440
v_fma_f32 v175,v175,s26,-v19
v_mfma_f32_16x16x32_bf16 v[220:223],a[144:147],a[48:51],v[220:223]
s_waitcnt lgkmcnt(14)
ds_read_b64_tr_b16 a[126:127],v7 offset:19464
v_exp_f32 v173,v173
v_mfma_f32_16x16x32_bf16 a[224:227],a[240:243],v[224:227],a[224:227]
s_add_u32 m0,s25,114688
v_exp_f32 v174,v174
v_mfma_f32_16x16x32_bf16 a[224:227],a[240:243],v[228:231],a[224:227]
buffer_load_dwordx4 v1,s[12:15],s22 offen nt lds
v_cvt_pk_bf16_f32 v170,v172,v173
v_mfma_f32_16x16x32_bf16 a[228:231],a[240:243],v[232:235],a[228:231]
s_waitcnt lgkmcnt(14)
ds_read_b64_tr_b16 a[128:129],v8 offset:16384
v_fma_f32 v176,v176,s26,-v20
v_mfma_f32_16x16x32_bf16 a[228:231],a[240:243],v[236:239],a[228:231]
s_waitcnt lgkmcnt(14)
ds_read_b64_tr_b16 a[130:131],v8 offset:17408
v_exp_f32 v175,v175
v_fma_f32 v177,v177,s26,-v20
v_mfma_f32_16x16x32_bf16 a[232:235],a[240:243],v[240:243],a[232:235]
v_exp_f32 v176,v176
v_mfma_f32_16x16x32_bf16 a[232:235],a[240:243],v[244:247],a[232:235]
s_waitcnt lgkmcnt(14)
v_cvt_pk_bf16_f32 v171,v174,v175
v_exp_f32 v177,v177
v_mfma_f32_16x16x32_bf16 a[236:239],a[240:243],v[248:251],a[236:239]
ds_read_b64_tr_b16 a[132:133],v8 offset:18432
v_cvt_pk_bf16_f32 v176,v176,v177
v_mfma_f32_16x16x32_bf16 a[236:239],a[240:243],v[252:255],a[236:239]
s_waitcnt lgkmcnt(14)
ds_read_b64_tr_b16 a[134:135],v8 offset:19456
v_fma_f32 v178,v178,s26,-v20
v_fma_f32 v179,v179,s26,-v20
v_mfma_f32_16x16x32_bf16 v[80:83],a[96:99],v[248:251],v[80:83]
v_exp_f32 v178,v178
v_mfma_f32_16x16x32_bf16 v[80:83],a[100:103],v[252:255],v[80:83]
s_waitcnt lgkmcnt(14)
ds_read_b64_tr_b16 a[136:137],v8 offset:16392
v_exp_f32 v179,v179
v_mfma_f32_16x16x32_bf16 v[64:67],a[100:103],v[244:247],v[64:67]
s_waitcnt lgkmcnt(14)
ds_read_b64_tr_b16 a[138:139],v8 offset:17416
v_cvt_pk_bf16_f32 v177,v178,v179
v_mfma_f32_16x16x32_bf16 v[64:67],a[96:99],v[240:243],v[64:67]
buffer_load_dwordx4 v1,s[12:15],s22 offen offset:1024 nt lds
v_fma_f32 v180,v180,s26,-v20
v_mfma_f32_16x16x32_bf16 v[48:51],a[96:99],v[232:235],v[48:51]
v_exp_f32 v180,v180
v_mfma_f32_16x16x32_bf16 v[48:51],a[100:103],v[236:239],v[48:51]
s_waitcnt lgkmcnt(14)
ds_read_b64_tr_b16 a[140:141],v8 offset:18440
v_fma_f32 v181,v181,s26,-v20
v_fma_f32 v182,v182,s26,-v20
v_mfma_f32_16x16x32_bf16 v[32:35],a[100:103],v[228:231],v[32:35]
s_waitcnt lgkmcnt(14)
ds_read_b64_tr_b16 a[142:143],v8 offset:19464
v_fma_f32 v183,v183,s26,-v20
v_mfma_f32_16x16x32_bf16 v[32:35],a[96:99],v[224:227],v[32:35]
v_exp_f32 v181,v181
v_fma_f32 v184,v184,s26,-v21
v_mfma_f32_16x16x32_bf16 v[36:39],a[104:107],v[224:227],v[36:39]
v_exp_f32 v182,v182
v_mfma_f32_16x16x32_bf16 v[36:39],a[108:111],v[228:231],v[36:39]
s_waitcnt lgkmcnt(14)
ds_read_b64_tr_b16 a[144:145],v9 offset:16384
v_cvt_pk_bf16_f32 v178,v180,v181
v_exp_f32 v183,v183
v_mfma_f32_16x16x32_bf16 v[52:55],a[108:111],v[236:239],v[52:55]
s_waitcnt lgkmcnt(14)
ds_read_b64_tr_b16 a[146:147],v9 offset:17408
v_cvt_pk_bf16_f32 v179,v182,v183
v_mfma_f32_16x16x32_bf16 v[52:55],a[104:107],v[232:235],v[52:55]
buffer_load_dwordx4 v1,s[12:15],s22 offen offset:2048 nt lds
v_fma_f32 v185,v185,s26,-v21
v_mfma_f32_16x16x32_bf16 v[68:71],a[104:107],v[240:243],v[68:71]
s_waitcnt lgkmcnt(14)
ds_read_b64_tr_b16 a[148:149],v9 offset:18432
v_fma_f32 v186,v186,s26,-v21
v_mfma_f32_16x16x32_bf16 v[68:71],a[108:111],v[244:247],v[68:71]
s_waitcnt lgkmcnt(14)
ds_read_b64_tr_b16 a[150:151],v9 offset:19456
v_exp_f32 v184,v184
v_mfma_f32_16x16x32_bf16 v[84:87],a[108:111],v[252:255],v[84:87]
v_exp_f32 v185,v185
v_mfma_f32_16x16x32_bf16 v[84:87],a[104:107],v[248:251],v[84:87]
v_cvt_pk_bf16_f32 v184,v184,v185
v_exp_f32 v186,v186
v_mfma_f32_16x16x32_bf16 v[88:91],a[112:115],v[248:251],v[88:91]
s_waitcnt lgkmcnt(14)
ds_read_b64_tr_b16 a[152:153],v9 offset:16392
v_fma_f32 v187,v187,s26,-v21
v_mfma_f32_16x16x32_bf16 v[88:91],a[116:119],v[252:255],v[88:91]
s_waitcnt lgkmcnt(14)
ds_read_b64_tr_b16 a[154:155],v9 offset:17416
v_exp_f32 v187,v187
v_mfma_f32_16x16x32_bf16 v[72:75],a[116:119],v[244:247],v[72:75]
v_cvt_pk_bf16_f32 v185,v186,v187
v_fma_f32 v188,v188,s26,-v21
v_mfma_f32_16x16x32_bf16 v[72:75],a[112:115],v[240:243],v[72:75]
s_waitcnt lgkmcnt(14)
ds_read_b64_tr_b16 a[156:157],v9 offset:18440
v_exp_f32 v188,v188
v_mfma_f32_16x16x32_bf16 v[56:59],a[112:115],v[232:235],v[56:59]
s_waitcnt lgkmcnt(14)
ds_read_b64_tr_b16 a[158:159],v9 offset:19464
v_fma_f32 v189,v189,s26,-v21
v_mfma_f32_16x16x32_bf16 v[56:59],a[116:119],v[236:239],v[56:59]
buffer_load_dwordx4 v1,s[12:15],s22 offen offset:3072 nt lds
v_exp_f32 v189,v189
v_mfma_f32_16x16x32_bf16 v[40:43],a[116:119],v[228:231],v[40:43]
s_add_u32 s22,s22,16384
v_cvt_pk_bf16_f32 v186,v188,v189
v_fma_f32 v190,v190,s26,-v21
v_mfma_f32_16x16x32_bf16 v[40:43],a[112:115],v[224:227],v[40:43]
v_fma_f32 v191,v191,s26,-v21
v_exp_f32 v190,v190
v_mfma_f32_16x16x32_bf16 v[44:47],a[120:123],v[224:227],v[44:47]
s_add_u32 m0,s25,131072
v_exp_f32 v191,v191
v_mfma_f32_16x16x32_bf16 v[44:47],a[124:127],v[228:231],v[44:47]
buffer_load_dwordx4 v1,s[4:7],s23 offen nt lds
v_cvt_pk_bf16_f32 v187,v190,v191
v_mfma_f32_16x16x32_bf16 v[60:63],a[124:127],v[236:239],v[60:63]
v_mfma_f32_16x16x32_bf16 v[60:63],a[120:123],v[232:235],v[60:63]
buffer_load_dwordx4 v1,s[4:7],s23 offen offset:1024 nt lds
v_mfma_f32_16x16x32_bf16 v[76:79],a[120:123],v[240:243],v[76:79]
v_fma_f32 v192,v192,s26,-v18
v_fma_f32 v193,v193,s26,-v18
v_mfma_f32_16x16x32_bf16 v[76:79],a[124:127],v[244:247],v[76:79]
buffer_load_dwordx4 v1,s[4:7],s23 offen offset:2048 nt lds
v_mfma_f32_16x16x32_bf16 v[92:95],a[124:127],v[252:255],v[92:95]
v_exp_f32 v192,v192
v_mfma_f32_16x16x32_bf16 v[92:95],a[120:123],v[248:251],v[92:95]
s_waitcnt lgkmcnt(12)
v_exp_f32 v193,v193
v_mfma_f32_16x16x32_bf16 a[208:211],a[128:131],v[248:251],a[208:211]
v_cvt_pk_bf16_f32 v164,v192,v193
v_fma_f32 v194,v194,s26,-v18
v_mfma_f32_16x16x32_bf16 a[208:211],a[132:135],v[252:255],a[208:211]
buffer_load_dwordx4 v1,s[4:7],s23 offen offset:3072 nt lds
v_mfma_f32_16x16x32_bf16 a[192:195],a[132:135],v[244:247],a[192:195]
s_add_u32 s23,s23,16384
v_exp_f32 v194,v194
v_mfma_f32_16x16x32_bf16 a[192:195],a[128:131],v[240:243],a[192:195]
s_waitcnt vmcnt(16)
s_waitcnt lgkmcnt(0)
s_barrier
ds_read_b128 a[96:99],v2 offset:49152
v_fma_f32 v195,v195,s26,-v18
v_mfma_f32_16x16x32_bf16 a[176:179],a[128:131],v[232:235],a[176:179]
v_exp_f32 v195,v195
v_mfma_f32_16x16x32_bf16 a[176:179],a[132:135],v[236:239],a[176:179]
v_cvt_pk_bf16_f32 v165,v194,v195
v_fma_f32 v196,v196,s26,-v18
v_mfma_f32_16x16x32_bf16 a[160:163],a[132:135],v[228:231],a[160:163]
v_exp_f32 v196,v196
v_mfma_f32_16x16x32_bf16 a[160:163],a[128:131],v[224:227],a[160:163]
ds_read_b128 a[100:103],v3 offset:49152
v_fma_f32 v197,v197,s26,-v18
v_mfma_f32_16x16x32_bf16 a[164:167],a[136:139],v[224:227],a[164:167]
v_exp_f32 v197,v197
v_mfma_f32_16x16x32_bf16 a[164:167],a[140:143],v[228:231],a[164:167]
v_cvt_pk_bf16_f32 v166,v196,v197
v_fma_f32 v198,v198,s26,-v18
v_mfma_f32_16x16x32_bf16 a[180:183],a[140:143],v[236:239],a[180:183]
ds_read_b128 a[104:107],v4 offset:49152
v_fma_f32 v199,v199,s26,-v18
v_mfma_f32_16x16x32_bf16 a[180:183],a[136:139],v[232:235],a[180:183]
v_exp_f32 v198,v198
v_mfma_f32_16x16x32_bf16 a[196:199],a[136:139],v[240:243],a[196:199]
v_exp_f32 v199,v199
v_mfma_f32_16x16x32_bf16 a[196:199],a[140:143],v[244:247],a[196:199]
v_cvt_pk_bf16_f32 v167,v198,v199
v_fma_f32 v200,v200,s26,-v19
v_mfma_f32_16x16x32_bf16 a[212:215],a[140:143],v[252:255],a[212:215]
ds_read_b128 a[108:111],v5 offset:49152
v_fma_f32 v201,v201,s26,-v19
v_mfma_f32_16x16x32_bf16 a[212:215],a[136:139],v[248:251],a[212:215]
v_exp_f32 v200,v200
v_mfma_f32_16x16x32_bf16 a[216:219],a[144:147],v[248:251],a[216:219]
v_exp_f32 v201,v201
v_mfma_f32_16x16x32_bf16 a[216:219],a[148:151],v[252:255],a[216:219]
v_cvt_pk_bf16_f32 v172,v200,v201
v_fma_f32 v202,v202,s26,-v19
v_mfma_f32_16x16x32_bf16 a[200:203],a[148:151],v[244:247],a[200:203]
ds_read_b128 a[112:115],v2 offset:50176
v_fma_f32 v203,v203,s26,-v19
v_mfma_f32_16x16x32_bf16 a[200:203],a[144:147],v[240:243],a[200:203]
v_exp_f32 v202,v202
v_mfma_f32_16x16x32_bf16 a[184:187],a[144:147],v[232:235],a[184:187]
v_exp_f32 v203,v203
v_mfma_f32_16x16x32_bf16 a[184:187],a[148:151],v[236:239],a[184:187]
ds_read_b128 a[116:119],v3 offset:50176
v_cvt_pk_bf16_f32 v173,v202,v203
v_mfma_f32_16x16x32_bf16 a[168:171],a[148:151],v[228:231],a[168:171]
v_fma_f32 v204,v204,s26,-v19
v_fma_f32 v205,v205,s26,-v19
v_mfma_f32_16x16x32_bf16 a[168:171],a[144:147],v[224:227],a[168:171]
v_exp_f32 v204,v204
v_mfma_f32_16x16x32_bf16 a[172:175],a[152:155],v[224:227],a[172:175]
v_exp_f32 v205,v205
v_mfma_f32_16x16x32_bf16 a[172:175],a[156:159],v[228:231],a[172:175]
ds_read_b128 a[120:123],v4 offset:50176
v_cvt_pk_bf16_f32 v174,v204,v205
v_mfma_f32_16x16x32_bf16 a[188:191],a[156:159],v[236:239],a[188:191]
v_fma_f32 v206,v206,s26,-v19
v_fma_f32 v207,v207,s26,-v19
v_mfma_f32_16x16x32_bf16 a[188:191],a[152:155],v[232:235],a[188:191]
v_exp_f32 v206,v206
v_mfma_f32_16x16x32_bf16 a[204:207],a[152:155],v[240:243],a[204:207]
v_exp_f32 v207,v207
v_mfma_f32_16x16x32_bf16 a[204:207],a[156:159],v[244:247],a[204:207]
ds_read_b128 a[124:127],v5 offset:50176
v_cvt_pk_bf16_f32 v175,v206,v207
v_mfma_f32_16x16x32_bf16 a[220:223],a[156:159],v[252:255],a[220:223]
v_fma_f32 v208,v208,s26,-v20
v_fma_f32 v209,v209,s26,-v20
v_mfma_f32_16x16x32_bf16 a[220:223],a[152:155],v[248:251],a[220:223]
s_waitcnt lgkmcnt(4)
v_exp_f32 v208,v208
v_mfma_f32_16x16x32_bf16 v[224:227],a[96:99],a[0:3],0
ds_read_b128 a[128:131],v2 offset:51200
v_fma_f32 v210,v210,s26,-v20
v_mfma_f32_16x16x32_bf16 v[224:227],a[100:103],a[4:7],v[224:227]
v_exp_f32 v209,v209
v_mfma_f32_16x16x32_bf16 v[224:227],a[104:107],a[8:11],v[224:227]
v_exp_f32 v210,v210
v_mfma_f32_16x16x32_bf16 v[224:227],a[108:111],a[12:15],v[224:227]
v_cvt_pk_bf16_f32 v180,v208,v209
v_fma_f32 v211,v211,s26,-v20
v_mfma_f32_16x16x32_bf16 v[232:235],a[108:111],a[28:31],0
ds_read_b128 a[132:135],v3 offset:51200
v_fma_f32 v212,v212,s26,-v20
v_mfma_f32_16x16x32_bf16 v[232:235],a[104:107],a[24:27],v[232:235]
v_exp_f32 v211,v211
v_mfma_f32_16x16x32_bf16 v[232:235],a[100:103],a[20:23],v[232:235]
v_exp_f32 v212,v212
v_mfma_f32_16x16x32_bf16 v[232:235],a[96:99],a[16:19],v[232:235]
v_cvt_pk_bf16_f32 v181,v210,v211
v_fma_f32 v213,v213,s26,-v20
v_mfma_f32_16x16x32_bf16 v[240:243],a[96:99],a[32:35],0
ds_read_b128 a[136:139],v4 offset:51200
v_fma_f32 v214,v214,s26,-v20
v_mfma_f32_16x16x32_bf16 v[240:243],a[100:103],a[36:39],v[240:243]
v_exp_f32 v213,v213
v_mfma_f32_16x16x32_bf16 v[240:243],a[104:107],a[40:43],v[240:243]
v_exp_f32 v214,v214
v_mfma_f32_16x16x32_bf16 v[240:243],a[108:111],a[44:47],v[240:243]
ds_read_b128 a[140:143],v5 offset:51200
v_cvt_pk_bf16_f32 v182,v212,v213
v_mfma_f32_16x16x32_bf16 v[248:251],a[108:111],a[60:63],0
v_fma_f32 v215,v215,s26,-v20
v_fma_f32 v216,v216,s26,-v21
v_mfma_f32_16x16x32_bf16 v[248:251],a[104:107],a[56:59],v[248:251]
v_exp_f32 v215,v215
v_mfma_f32_16x16x32_bf16 v[248:251],a[100:103],a[52:55],v[248:251]
s_waitcnt lgkmcnt(4)
v_exp_f32 v216,v216
v_mfma_f32_16x16x32_bf16 v[248:251],a[96:99],a[48:51],v[248:251]
ds_read_b128 a[144:147],v2 offset:52224
v_cvt_pk_bf16_f32 v183,v214,v215
v_mfma_f32_16x16x32_bf16 v[228:231],a[112:115],a[0:3],0
v_fma_f32 v217,v217,s26,-v21
v_fma_f32 v218,v218,s26,-v21
v_mfma_f32_16x16x32_bf16 v[228:231],a[116:119],a[4:7],v[228:231]
v_exp_f32 v217,v217
v_mfma_f32_16x16x32_bf16 v[228:231],a[120:123],a[8:11],v[228:231]
v_exp_f32 v218,v218
v_mfma_f32_16x16x32_bf16 v[228:231],a[124:127],a[12:15],v[228:231]
ds_read_b128 a[148:151],v3 offset:52224
v_cvt_pk_bf16_f32 v188,v216,v217
v_mfma_f32_16x16x32_bf16 v[236:239],a[124:127],a[28:31],0
v_fma_f32 v219,v219,s26,-v21
v_fma_f32 v220,v220,s26,-v21
v_mfma_f32_16x16x32_bf16 v[236:239],a[120:123],a[24:27],v[236:239]
v_exp_f32 v219,v219
v_mfma_f32_16x16x32_bf16 v[236:239],a[116:119],a[20:23],v[236:239]
ds_read_b128 a[152:155],v4 offset:52224
v_cvt_pk_bf16_f32 v189,v218,v219
v_mfma_f32_16x16x32_bf16 v[236:239],a[112:115],a[16:19],v[236:239]
v_exp_f32 v220,v220
v_mfma_f32_16x16x32_bf16 v[244:247],a[112:115],a[32:35],0
v_fma_f32 v221,v221,s26,-v21
v_fma_f32 v222,v222,s26,-v21
v_mfma_f32_16x16x32_bf16 v[244:247],a[116:119],a[36:39],v[244:247]
v_exp_f32 v221,v221
v_mfma_f32_16x16x32_bf16 v[244:247],a[120:123],a[40:43],v[244:247]
ds_read_b128 a[156:159],v5 offset:52224
v_cvt_pk_bf16_f32 v190,v220,v221
v_mfma_f32_16x16x32_bf16 v[244:247],a[124:127],a[44:47],v[244:247]
v_exp_f32 v222,v222
v_mfma_f32_16x16x32_bf16 v[252:255],a[124:127],a[60:63],0
v_fma_f32 v223,v223,s26,-v21
v_mfma_f32_16x16x32_bf16 v[252:255],a[120:123],a[56:59],v[252:255]
v_exp_f32 v223,v223
v_mfma_f32_16x16x32_bf16 v[252:255],a[116:119],a[52:55],v[252:255]
v_cvt_pk_bf16_f32 v191,v222,v223
v_mfma_f32_16x16x32_bf16 v[252:255],a[112:115],a[48:51],v[252:255]
s_waitcnt lgkmcnt(4)
v_mfma_f32_16x16x32_bf16 v[192:195],a[128:131],a[0:3],0
v_accvgpr_read_b32 v23,a244
v_accvgpr_read_b32 v24,a245
v_mfma_f32_16x16x32_bf16 v[192:195],a[132:135],a[4:7],v[192:195]
v_fma_f32 v224,v224,s26,-v18
v_fma_f32 v225,v225,s26,-v18
v_mfma_f32_16x16x32_bf16 v[192:195],a[136:139],a[8:11],v[192:195]
v_exp_f32 v224,v224
v_mfma_f32_16x16x32_bf16 v[192:195],a[140:143],a[12:15],v[192:195]
v_exp_f32 v225,v225
v_fma_f32 v226,v226,s26,-v18
v_fma_f32 v227,v227,s26,-v18
v_mfma_f32_16x16x32_bf16 v[200:203],a[140:143],a[28:31],0
ds_write_b128 v23,v[144:147] offset:16384
v_cvt_pk_bf16_f32 v224,v224,v225
v_mfma_f32_16x16x32_bf16 v[200:203],a[136:139],a[24:27],v[200:203]
ds_read_b64_tr_b16 a[96:97],v6 offset:32768
v_fma_f32 v228,v228,s26,-v18
v_mfma_f32_16x16x32_bf16 v[200:203],a[132:135],a[20:23],v[200:203]
ds_read_b64_tr_b16 a[98:99],v6 offset:33792
v_fma_f32 v229,v229,s26,-v18
v_mfma_f32_16x16x32_bf16 v[200:203],a[128:131],a[16:19],v[200:203]
ds_write_b128 v23,v[148:151] offset:16448
v_exp_f32 v226,v226
v_fma_f32 v230,v230,s26,-v18
v_mfma_f32_16x16x32_bf16 v[208:211],a[128:131],a[32:35],0
ds_read_b64_tr_b16 a[100:101],v6 offset:34816
v_fma_f32 v231,v231,s26,-v18
v_mfma_f32_16x16x32_bf16 v[208:211],a[132:135],a[36:39],v[208:211]
ds_read_b64_tr_b16 a[102:103],v6 offset:35840
v_fma_f32 v232,v232,s26,-v19
v_mfma_f32_16x16x32_bf16 v[208:211],a[136:139],a[40:43],v[208:211]
ds_write_b128 v23,v[152:155] offset:16512
v_fma_f32 v233,v233,s26,-v19
v_mfma_f32_16x16x32_bf16 v[208:211],a[140:143],a[44:47],v[208:211]
ds_write_b128 v23,v[156:159] offset:16576
v_exp_f32 v227,v227
v_fma_f32 v234,v234,s26,-v19
v_mfma_f32_16x16x32_bf16 v[216:219],a[140:143],a[60:63],0
ds_read_b64_tr_b16 a[104:105],v6 offset:32776
v_cvt_pk_bf16_f32 v225,v226,v227
v_mfma_f32_16x16x32_bf16 v[216:219],a[136:139],a[56:59],v[216:219]
ds_read_b64_tr_b16 a[106:107],v6 offset:33800
v_fma_f32 v235,v235,s26,-v19
v_mfma_f32_16x16x32_bf16 v[216:219],a[132:135],a[52:55],v[216:219]
ds_read_b128 v[144:147],v24 offset:16384
v_fma_f32 v236,v236,s26,-v19
v_mfma_f32_16x16x32_bf16 v[216:219],a[128:131],a[48:51],v[216:219]
s_waitcnt lgkmcnt(11)
ds_read_b128 v[148:151],v24 offset:17472
v_exp_f32 v228,v228
v_mfma_f32_16x16x32_bf16 v[196:199],a[144:147],a[0:3],0
ds_read_b64_tr_b16 a[108:109],v6 offset:34824
v_fma_f32 v237,v237,s26,-v19
v_mfma_f32_16x16x32_bf16 v[196:199],a[148:151],a[4:7],v[196:199]
ds_read_b64_tr_b16 a[110:111],v6 offset:35848
v_fma_f32 v238,v238,s26,-v19
v_mfma_f32_16x16x32_bf16 v[196:199],a[152:155],a[8:11],v[196:199]
ds_read_b128 v[152:155],v24 offset:18560
v_fma_f32 v239,v239,s26,-v19
v_mfma_f32_16x16x32_bf16 v[196:199],a[156:159],a[12:15],v[196:199]
s_waitcnt lgkmcnt(14)
ds_read_b64_tr_b16 a[112:113],v7 offset:32768
v_exp_f32 v229,v229
v_fma_f32 v240,v240,s26,-v20
v_mfma_f32_16x16x32_bf16 v[204:207],a[156:159],a[28:31],0
s_waitcnt lgkmcnt(14)
ds_read_b64_tr_b16 a[114:115],v7 offset:33792
v_cvt_pk_bf16_f32 v226,v228,v229
v_mfma_f32_16x16x32_bf16 v[204:207],a[152:155],a[24:27],v[204:207]
s_waitcnt lgkmcnt(14)
ds_read_b128 v[156:159],v24 offset:19648
v_fma_f32 v241,v241,s26,-v20
v_mfma_f32_16x16x32_bf16 v[204:207],a[148:151],a[20:23],v[204:207]
v_exp_f32 v230,v230
v_mfma_f32_16x16x32_bf16 v[204:207],a[144:147],a[16:19],v[204:207]
s_waitcnt lgkmcnt(14)
ds_read_b64_tr_b16 a[116:117],v7 offset:34816
v_exp_f32 v231,v231
v_fma_f32 v242,v242,s26,-v20
v_mfma_f32_16x16x32_bf16 v[212:215],a[144:147],a[32:35],0
s_waitcnt lgkmcnt(14)
ds_read_b64_tr_b16 a[118:119],v7 offset:35840
v_cvt_pk_bf16_f32 v227,v230,v231
v_mfma_f32_16x16x32_bf16 v[212:215],a[148:151],a[36:39],v[212:215]
v_exp_f32 v232,v232
v_mfma_f32_16x16x32_bf16 v[212:215],a[152:155],a[40:43],v[212:215]
v_exp_f32 v233,v233
v_mfma_f32_16x16x32_bf16 v[212:215],a[156:159],a[44:47],v[212:215]
s_waitcnt lgkmcnt(14)
ds_read_b64_tr_b16 a[120:121],v7 offset:32776
v_exp_f32 v234,v234
v_exp_f32 v235,v235
v_mfma_f32_16x16x32_bf16 v[220:223],a[156:159],a[60:63],0
s_waitcnt lgkmcnt(14)
ds_read_b64_tr_b16 a[122:123],v7 offset:33800
v_cvt_pk_bf16_f32 v232,v232,v233
v_mfma_f32_16x16x32_bf16 v[220:223],a[152:155],a[56:59],v[220:223]
v_exp_f32 v236,v236
v_mfma_f32_16x16x32_bf16 v[220:223],a[148:151],a[52:55],v[220:223]
s_waitcnt lgkmcnt(14)
ds_read_b64_tr_b16 a[124:125],v7 offset:34824
v_cvt_pk_bf16_f32 v233,v234,v235
v_mfma_f32_16x16x32_bf16 v[220:223],a[144:147],a[48:51],v[220:223]
s_waitcnt lgkmcnt(14)
ds_read_b64_tr_b16 a[126:127],v7 offset:35848
v_exp_f32 v237,v237
v_fma_f32 v243,v243,s26,-v20
v_mfma_f32_16x16x32_bf16 a[224:227],a[240:243],v[160:163],a[224:227]
s_add_u32 m0,s25,16384
v_exp_f32 v238,v238
v_mfma_f32_16x16x32_bf16 a[224:227],a[240:243],v[164:167],a[224:227]
buffer_load_dwordx4 v1,s[8:11],s21 offen nt lds
v_exp_f32 v239,v239
v_mfma_f32_16x16x32_bf16 a[228:231],a[240:243],v[168:171],a[228:231]
s_waitcnt lgkmcnt(14)
ds_read_b64_tr_b16 a[128:129],v8 offset:32768
v_cvt_pk_bf16_f32 v234,v236,v237
v_mfma_f32_16x16x32_bf16 a[228:231],a[240:243],v[172:175],a[228:231]
s_waitcnt lgkmcnt(14)
ds_read_b64_tr_b16 a[130:131],v8 offset:33792
v_accvgpr_mov_b32 a0,a64
v_exp_f32 v240,v240
v_mfma_f32_16x16x32_bf16 a[232:235],a[240:243],v[176:179],a[232:235]
s_waitcnt lgkmcnt(14)
ds_read_b128 a[32:35],v10 offset:16384
v_cvt_pk_bf16_f32 v235,v238,v239
v_mfma_f32_16x16x32_bf16 a[232:235],a[240:243],v[180:183],a[232:235]
v_exp_f32 v241,v241
v_exp_f32 v242,v242
v_mfma_f32_16x16x32_bf16 a[236:239],a[240:243],v[184:187],a[236:239]
s_waitcnt lgkmcnt(14)
ds_read_b64_tr_b16 a[132:133],v8 offset:34816
v_accvgpr_mov_b32 a1,a65
v_mfma_f32_16x16x32_bf16 a[236:239],a[240:243],v[188:191],a[236:239]
s_waitcnt lgkmcnt(14)
ds_read_b64_tr_b16 a[134:135],v8 offset:35840
v_accvgpr_mov_b32 a2,a66
v_exp_f32 v243,v243
v_mfma_f32_16x16x32_bf16 v[80:83],a[96:99],v[184:187],v[80:83]
s_waitcnt lgkmcnt(14)
ds_read_b128 a[36:39],v11 offset:16384
v_cvt_pk_bf16_f32 v240,v240,v241
v_mfma_f32_16x16x32_bf16 v[80:83],a[100:103],v[188:191],v[80:83]
s_waitcnt lgkmcnt(14)
ds_read_b64_tr_b16 a[136:137],v8 offset:32776
v_accvgpr_mov_b32 a3,a67
v_accvgpr_mov_b32 a4,a68
v_cvt_pk_bf16_f32 v241,v242,v243
v_mfma_f32_16x16x32_bf16 v[64:67],a[100:103],v[180:183],v[64:67]
s_waitcnt lgkmcnt(14)
ds_read_b64_tr_b16 a[138:139],v8 offset:33800
v_accvgpr_mov_b32 a5,a69
v_mfma_f32_16x16x32_bf16 v[64:67],a[96:99],v[176:179],v[64:67]
buffer_load_dwordx4 v1,s[8:11],s21 offen offset:1024 nt lds
v_fma_f32 v244,v244,s26,-v20
v_fma_f32 v245,v245,s26,-v20
v_mfma_f32_16x16x32_bf16 v[48:51],a[96:99],v[168:171],v[48:51]
s_waitcnt lgkmcnt(14)
ds_read_b128 a[40:43],v12 offset:16384
v_accvgpr_mov_b32 a6,a70
v_mfma_f32_16x16x32_bf16 v[48:51],a[100:103],v[172:175],v[48:51]
s_waitcnt lgkmcnt(14)
ds_read_b64_tr_b16 a[140:141],v8 offset:34824
v_exp_f32 v244,v244
v_accvgpr_mov_b32 a7,a71
v_mfma_f32_16x16x32_bf16 v[32:35],a[100:103],v[164:167],v[32:35]
s_waitcnt lgkmcnt(14)
ds_read_b64_tr_b16 a[142:143],v8 offset:35848
v_fma_f32 v246,v246,s26,-v20
v_mfma_f32_16x16x32_bf16 v[32:35],a[96:99],v[160:163],v[32:35]
v_exp_f32 v245,v245
v_exp_f32 v246,v246
v_mfma_f32_16x16x32_bf16 v[36:39],a[104:107],v[160:163],v[36:39]
s_waitcnt lgkmcnt(14)
ds_read_b128 a[44:47],v13 offset:16384
v_cvt_pk_bf16_f32 v242,v244,v245
v_mfma_f32_16x16x32_bf16 v[36:39],a[108:111],v[164:167],v[36:39]
s_waitcnt lgkmcnt(14)
ds_read_b64_tr_b16 a[144:145],v9 offset:32768
v_fma_f32 v247,v247,s26,-v20
v_accvgpr_mov_b32 a8,a72
v_accvgpr_mov_b32 a9,a73
v_mfma_f32_16x16x32_bf16 v[52:55],a[108:111],v[172:175],v[52:55]
s_waitcnt lgkmcnt(14)
ds_read_b64_tr_b16 a[146:147],v9 offset:33792
v_fma_f32 v248,v248,s26,-v21
v_mfma_f32_16x16x32_bf16 v[52:55],a[104:107],v[168:171],v[52:55]
buffer_load_dwordx4 v1,s[8:11],s21 offen offset:2048 nt lds
v_exp_f32 v247,v247
v_mfma_f32_16x16x32_bf16 v[68:71],a[104:107],v[176:179],v[68:71]
s_waitcnt lgkmcnt(14)
ds_read_b64_tr_b16 a[148:149],v9 offset:34816
v_cvt_pk_bf16_f32 v243,v246,v247
v_mfma_f32_16x16x32_bf16 v[68:71],a[108:111],v[180:183],v[68:71]
s_waitcnt lgkmcnt(14)
ds_read_b64_tr_b16 a[150:151],v9 offset:35840
v_fma_f32 v249,v249,s26,-v21
v_exp_f32 v248,v248
v_mfma_f32_16x16x32_bf16 v[84:87],a[108:111],v[188:191],v[84:87]
v_exp_f32 v249,v249
v_mfma_f32_16x16x32_bf16 v[84:87],a[104:107],v[184:187],v[84:87]
v_accvgpr_mov_b32 a10,a74
v_accvgpr_mov_b32 a11,a75
v_cvt_pk_bf16_f32 v248,v248,v249
v_fma_f32 v250,v250,s26,-v21
v_fma_f32 v251,v251,s26,-v21
v_mfma_f32_16x16x32_bf16 v[88:91],a[112:115],v[184:187],v[88:91]
s_waitcnt lgkmcnt(14)
ds_read_b64_tr_b16 a[152:153],v9 offset:32776
v_accvgpr_mov_b32 a12,a76
v_mfma_f32_16x16x32_bf16 v[88:91],a[116:119],v[188:191],v[88:91]
s_waitcnt lgkmcnt(14)
ds_read_b64_tr_b16 a[154:155],v9 offset:33800
v_exp_f32 v250,v250
v_accvgpr_mov_b32 a13,a77
v_mfma_f32_16x16x32_bf16 v[72:75],a[116:119],v[180:183],v[72:75]
v_exp_f32 v251,v251
v_mfma_f32_16x16x32_bf16 v[72:75],a[112:115],v[176:179],v[72:75]
s_waitcnt lgkmcnt(14)
ds_read_b64_tr_b16 a[156:157],v9 offset:34824
v_cvt_pk_bf16_f32 v249,v250,v251
v_fma_f32 v252,v252,s26,-v21
v_fma_f32 v253,v253,s26,-v21
v_mfma_f32_16x16x32_bf16 v[56:59],a[112:115],v[168:171],v[56:59]
s_waitcnt lgkmcnt(14)
ds_read_b64_tr_b16 a[158:159],v9 offset:35848
v_accvgpr_mov_b32 a14,a78
v_mfma_f32_16x16x32_bf16 v[56:59],a[116:119],v[172:175],v[56:59]
buffer_load_dwordx4 v1,s[8:11],s21 offen offset:3072 nt lds
v_exp_f32 v252,v252
v_mfma_f32_16x16x32_bf16 v[40:43],a[116:119],v[164:167],v[40:43]
s_add_u32 s21,s21,16384
v_exp_f32 v253,v253
v_mfma_f32_16x16x32_bf16 v[40:43],a[112:115],v[160:163],v[40:43]
v_accvgpr_mov_b32 a15,a79
v_cvt_pk_bf16_f32 v250,v252,v253
v_fma_f32 v254,v254,s26,-v21
v_fma_f32 v255,v255,s26,-v21
v_mfma_f32_16x16x32_bf16 v[44:47],a[120:123],v[160:163],v[44:47]
s_add_u32 m0,s25,65536
v_exp_f32 v254,v254
v_mfma_f32_16x16x32_bf16 v[44:47],a[124:127],v[164:167],v[44:47]
buffer_load_dwordx4 v1,s[12:15],s22 offen nt lds
v_exp_f32 v255,v255
v_mfma_f32_16x16x32_bf16 v[60:63],a[124:127],v[172:175],v[60:63]
v_cvt_pk_bf16_f32 v251,v254,v255
v_mfma_f32_16x16x32_bf16 v[60:63],a[120:123],v[168:171],v[60:63]
buffer_load_dwordx4 v1,s[12:15],s22 offen offset:1024 nt lds
v_mfma_f32_16x16x32_bf16 v[76:79],a[120:123],v[176:179],v[76:79]
v_accvgpr_mov_b32 a16,a80
v_fma_f32 v192,v192,s26,-v18
v_mfma_f32_16x16x32_bf16 v[76:79],a[124:127],v[180:183],v[76:79]
buffer_load_dwordx4 v1,s[12:15],s22 offen offset:2048 nt lds
v_fma_f32 v193,v193,s26,-v18
v_mfma_f32_16x16x32_bf16 v[92:95],a[124:127],v[188:191],v[92:95]
v_exp_f32 v192,v192
v_mfma_f32_16x16x32_bf16 v[92:95],a[120:123],v[184:187],v[92:95]
v_accvgpr_mov_b32 a17,a81
v_exp_f32 v193,v193
v_mfma_f32_16x16x32_bf16 a[208:211],a[128:131],v[184:187],a[208:211]
v_accvgpr_mov_b32 a18,a82
v_cvt_pk_bf16_f32 v228,v192,v193
v_mfma_f32_16x16x32_bf16 a[208:211],a[132:135],v[188:191],a[208:211]
buffer_load_dwordx4 v1,s[12:15],s22 offen offset:3072 nt lds
v_accvgpr_mov_b32 a19,a83
v_fma_f32 v194,v194,s26,-v18
v_mfma_f32_16x16x32_bf16 a[192:195],a[132:135],v[180:183],a[192:195]
s_add_u32 s22,s22,16384
v_exp_f32 v194,v194
v_mfma_f32_16x16x32_bf16 a[192:195],a[128:131],v[176:179],a[192:195]
s_waitcnt vmcnt(8)
s_waitcnt lgkmcnt(0)
s_barrier
s_sub_u32 s20,s20,1
s_cmp_eq_u32 s20,1
s_cbranch_scc1 L_x1_0
ds_read_b128 a[96:99],v2 offset:0
v_fma_f32 v195,v195,s26,-v18
v_accvgpr_mov_b32 a20,a84
v_mfma_f32_16x16x32_bf16 a[176:179],a[128:131],v[168:171],a[176:179]
v_exp_f32 v195,v195
v_mfma_f32_16x16x32_bf16 a[176:179],a[132:135],v[172:175],a[176:179]
ds_read_b128 a[48:51],v10 offset:0
v_accvgpr_mov_b32 a21,a85
v_cvt_pk_bf16_f32 v229,v194,v195
v_mfma_f32_16x16x32_bf16 a[160:163],a[132:135],v[164:167],a[160:163]
v_fma_f32 v196,v196,s26,-v18
v_fma_f32 v197,v197,s26,-v18
v_mfma_f32_16x16x32_bf16 a[160:163],a[128:131],v[160:163],a[160:163]
ds_read_b128 a[100:103],v3 offset:0
v_exp_f32 v196,v196
v_mfma_f32_16x16x32_bf16 a[164:167],a[136:139],v[160:163],a[164:167]
v_exp_f32 v197,v197
v_mfma_f32_16x16x32_bf16 a[164:167],a[140:143],v[164:167],a[164:167]
ds_read_b128 a[52:55],v11 offset:0
v_accvgpr_mov_b32 a22,a86
v_accvgpr_mov_b32 a23,a87
v_mfma_f32_16x16x32_bf16 a[180:183],a[140:143],v[172:175],a[180:183]
s_add_u32 s30,s24,49152
s_add_u32 s32,s24,53248
ds_read_b128 a[104:107],v4 offset:0
v_mfma_f32_16x16x32_bf16 a[180:183],a[136:139],v[168:171],a[180:183]
buffer_store_dwordx4 v[144:147],v22,s[16:19],s30 offen sc0 sc1
buffer_store_dwordx4 v[148:151],v22,s[16:19],s32 offen sc0 sc1
v_cvt_pk_bf16_f32 v230,v196,v197
v_fma_f32 v198,v198,s26,-v18
v_mfma_f32_16x16x32_bf16 a[196:199],a[136:139],v[176:179],a[196:199]
v_exp_f32 v198,v198
v_mfma_f32_16x16x32_bf16 a[196:199],a[140:143],v[180:183],a[196:199]
ds_read_b128 a[56:59],v12 offset:0
v_fma_f32 v199,v199,s26,-v18
v_accvgpr_mov_b32 a24,a88
v_mfma_f32_16x16x32_bf16 a[212:215],a[140:143],v[188:191],a[212:215]
ds_read_b128 a[108:111],v5 offset:0
v_accvgpr_mov_b32 a25,a89
v_mfma_f32_16x16x32_bf16 a[212:215],a[136:139],v[184:187],a[212:215]
v_exp_f32 v199,v199
v_fma_f32 v200,v200,s26,-v19
v_mfma_f32_16x16x32_bf16 a[216:219],a[144:147],v[184:187],a[216:219]
v_exp_f32 v200,v200
v_mfma_f32_16x16x32_bf16 a[216:219],a[148:151],v[188:191],a[216:219]
ds_read_b128 a[60:63],v13 offset:0
v_cvt_pk_bf16_f32 v231,v198,v199
v_fma_f32 v201,v201,s26,-v19
v_mfma_f32_16x16x32_bf16 a[200:203],a[148:151],v[180:183],a[200:203]
ds_read_b128 a[112:115],v2 offset:1024
v_accvgpr_mov_b32 a26,a90
v_mfma_f32_16x16x32_bf16 a[200:203],a[144:147],v[176:179],a[200:203]
v_exp_f32 v201,v201
v_accvgpr_mov_b32 a27,a91
v_mfma_f32_16x16x32_bf16 a[184:187],a[144:147],v[168:171],a[184:187]
v_cvt_pk_bf16_f32 v236,v200,v201
v_fma_f32 v202,v202,s26,-v19
v_mfma_f32_16x16x32_bf16 a[184:187],a[148:151],v[172:175],a[184:187]
ds_read_b128 a[116:119],v3 offset:1024
v_exp_f32 v202,v202
v_mfma_f32_16x16x32_bf16 a[168:171],a[148:151],v[164:167],a[168:171]
v_fma_f32 v203,v203,s26,-v19
v_accvgpr_mov_b32 a28,a92
v_mfma_f32_16x16x32_bf16 a[168:171],a[144:147],v[160:163],a[168:171]
v_exp_f32 v203,v203
v_accvgpr_mov_b32 a29,a93
v_fma_f32 v204,v204,s26,-v19
v_mfma_f32_16x16x32_bf16 a[172:175],a[152:155],v[160:163],a[172:175]
v_exp_f32 v204,v204
v_mfma_f32_16x16x32_bf16 a[172:175],a[156:159],v[164:167],a[172:175]
ds_read_b128 a[120:123],v4 offset:1024
v_cvt_pk_bf16_f32 v237,v202,v203
v_fma_f32 v205,v205,s26,-v19
v_mfma_f32_16x16x32_bf16 a[188:191],a[156:159],v[172:175],a[188:191]
s_add_u32 s30,s24,57344
s_add_u32 s32,s24,61440
v_accvgpr_mov_b32 a30,a94
v_mfma_f32_16x16x32_bf16 a[188:191],a[152:155],v[168:171],a[188:191]
buffer_store_dwordx4 v[152:155],v22,s[16:19],s30 offen sc0 sc1
buffer_store_dwordx4 v[156:159],v22,s[16:19],s32 offen sc0 sc1
v_accvgpr_mov_b32 a31,a95
v_mfma_f32_16x16x32_bf16 a[204:207],a[152:155],v[176:179],a[204:207]
v_exp_f32 v205,v205
v_mfma_f32_16x16x32_bf16 a[204:207],a[156:159],v[180:183],a[204:207]
ds_read_b128 a[124:127],v5 offset:1024
v_cvt_pk_bf16_f32 v238,v204,v205
v_fma_f32 v206,v206,s26,-v19
v_mfma_f32_16x16x32_bf16 a[220:223],a[156:159],v[188:191],a[220:223]
v_exp_f32 v206,v206
v_mfma_f32_16x16x32_bf16 a[220:223],a[152:155],v[184:187],a[220:223]
s_waitcnt lgkmcnt(5)
v_fma_f32 v207,v207,s26,-v19
v_fma_f32 v208,v208,s26,-v20
v_fma_f32 v209,v209,s26,-v20
v_mfma_f32_16x16x32_bf16 v[160:163],a[96:99],a[0:3],0
ds_read_b128 a[128:131],v2 offset:2048
v_fma_f32 v210,v210,s26,-v20
v_mfma_f32_16x16x32_bf16 v[160:163],a[100:103],a[4:7],v[160:163]
v_exp_f32 v207,v207
v_mfma_f32_16x16x32_bf16 v[160:163],a[104:107],a[8:11],v[160:163]
v_exp_f32 v208,v208
v_mfma_f32_16x16x32_bf16 v[160:163],a[108:111],a[12:15],v[160:163]
v_exp_f32 v209,v209
v_exp_f32 v210,v210
v_mfma_f32_16x16x32_bf16 v[168:171],a[108:111],a[28:31],0
ds_read_b128 a[132:135],v3 offset:2048
v_cvt_pk_bf16_f32 v239,v206,v207
v_mfma_f32_16x16x32_bf16 v[168:171],a[104:107],a[24:27],v[168:171]
v_cvt_pk_bf16_f32 v244,v208,v209
v_fma_f32 v211,v211,s26,-v20
v_mfma_f32_16x16x32_bf16 v[168:171],a[100:103],a[20:23],v[168:171]
v_exp_f32 v211,v211
v_mfma_f32_16x16x32_bf16 v[168:171],a[96:99],a[16:19],v[168:171]
v_cvt_pk_bf16_f32 v245,v210,v211
v_fma_f32 v212,v212,s26,-v20
v_fma_f32 v213,v213,s26,-v20
v_mfma_f32_16x16x32_bf16 v[176:179],a[96:99],a[32:35],0
ds_read_b128 a[136:139],v4 offset:2048
v_fma_f32 v214,v214,s26,-v20
v_mfma_f32_16x16x32_bf16 v[176:179],a[100:103],a[36:39],v[176:179]
v_exp_f32 v212,v212
v_mfma_f32_16x16x32_bf16 v[176:179],a[104:107],a[40:43],v[176:179]
v_exp_f32 v213,v213
v_mfma_f32_16x16x32_bf16 v[176:179],a[108:111],a[44:47],v[176:179]
ds_read_b128 a[140:143],v5 offset:2048
v_exp_f32 v214,v214
s_waitcnt lgkmcnt(8)
v_mfma_f32_16x16x32_bf16 v[184:187],a[108:111],a[60:63],0
v_cvt_pk_bf16_f32 v246,v212,v213
v_fma_f32 v215,v215,s26,-v20
v_mfma_f32_16x16x32_bf16 v[184:187],a[104:107],a[56:59],v[184:187]
v_exp_f32 v215,v215
v_mfma_f32_16x16x32_bf16 v[184:187],a[100:103],a[52:55],v[184:187]
s_waitcnt lgkmcnt(4)
v_cvt_pk_bf16_f32 v247,v214,v215
v_fma_f32 v216,v216,s26,-v21
v_mfma_f32_16x16x32_bf16 v[184:187],a[96:99],a[48:51],v[184:187]
ds_read_b128 a[144:147],v2 offset:3072
v_exp_f32 v216,v216
v_mfma_f32_16x16x32_bf16 v[164:167],a[112:115],a[0:3],0
v_fma_f32 v217,v217,s26,-v21
v_fma_f32 v218,v218,s26,-v21
v_mfma_f32_16x16x32_bf16 v[164:167],a[116:119],a[4:7],v[164:167]
v_exp_f32 v217,v217
v_mfma_f32_16x16x32_bf16 v[164:167],a[120:123],a[8:11],v[164:167]
v_exp_f32 v218,v218
v_mfma_f32_16x16x32_bf16 v[164:167],a[124:127],a[12:15],v[164:167]
ds_read_b128 a[148:151],v3 offset:3072
v_cvt_pk_bf16_f32 v252,v216,v217
v_fma_f32 v219,v219,s26,-v21
v_mfma_f32_16x16x32_bf16 v[172:175],a[124:127],a[28:31],0
v_exp_f32 v219,v219
v_mfma_f32_16x16x32_bf16 v[172:175],a[120:123],a[24:27],v[172:175]
v_cvt_pk_bf16_f32 v253,v218,v219
v_fma_f32 v220,v220,s26,-v21
v_mfma_f32_16x16x32_bf16 v[172:175],a[116:119],a[20:23],v[172:175]
ds_read_b128 a[152:155],v4 offset:3072
v_fma_f32 v221,v221,s26,-v21
v_mfma_f32_16x16x32_bf16 v[172:175],a[112:115],a[16:19],v[172:175]
v_exp_f32 v220,v220
v_exp_f32 v221,v221
v_mfma_f32_16x16x32_bf16 v[180:183],a[112:115],a[32:35],0
v_cvt_pk_bf16_f32 v254,v220,v221
v_fma_f32 v222,v222,s26,-v21
v_mfma_f32_16x16x32_bf16 v[180:183],a[116:119],a[36:39],v[180:183]
v_exp_f32 v222,v222
v_mfma_f32_16x16x32_bf16 v[180:183],a[120:123],a[40:43],v[180:183]
s_add_u32 m0,s25,32768
ds_read_b128 a[156:159],v5 offset:3072
v_mfma_f32_16x16x32_bf16 v[180:183],a[124:127],a[44:47],v[180:183]
buffer_load_dwordx4 v1,s[8:11],s21 offen nt lds
v_fma_f32 v223,v223,s26,-v21
v_mfma_f32_16x16x32_bf16 v[188:191],a[124:127],a[60:63],0
v_exp_f32 v223,v223
v_mfma_f32_16x16x32_bf16 v[188:191],a[120:123],a[56:59],v[188:191]
v_cvt_pk_bf16_f32 v255,v222,v223
v_mfma_f32_16x16x32_bf16 v[188:191],a[116:119],a[52:55],v[188:191]
v_mfma_f32_16x16x32_bf16 v[188:191],a[112:115],a[48:51],v[188:191]
s_waitcnt lgkmcnt(4)
v_mfma_f32_16x16x32_bf16 v[192:195],a[128:131],a[0:3],0
v_mfma_f32_16x16x32_bf16 v[192:195],a[132:135],a[4:7],v[192:195]
v_mfma_f32_16x16x32_bf16 v[192:195],a[136:139],a[8:11],v[192:195]
v_mfma_f32_16x16x32_bf16 v[192:195],a[140:143],a[12:15],v[192:195]
buffer_load_dwordx4 v1,s[8:11],s21 offen offset:1024 nt lds
v_max3_f32 v23,v160,v161,v162
v_max3_f32 v24,v168,v169,v170
v_max3_f32 v25,v176,v177,v178
v_max3_f32 v26,v184,v185,v186
v_mfma_f32_16x16x32_bf16 v[200:203],a[140:143],a[28:31],0
v_max3_f32 v23,v23,v163,v164
v_max3_f32 v24,v24,v171,v172
v_mfma_f32_16x16x32_bf16 v[200:203],a[136:139],a[24:27],v[200:203]
ds_read_b64_tr_b16 a[96:97],v6 offset:49152
v_max3_f32 v25,v25,v179,v180
v_mfma_f32_16x16x32_bf16 v[200:203],a[132:135],a[20:23],v[200:203]
ds_read_b64_tr_b16 a[98:99],v6 offset:50176
v_max3_f32 v26,v26,v187,v188
v_mfma_f32_16x16x32_bf16 v[200:203],a[128:131],a[16:19],v[200:203]
buffer_load_dwordx4 v1,s[8:11],s21 offen offset:2048 nt lds
v_max3_f32 v23,v23,v165,v166
v_max3_f32 v24,v24,v173,v174
v_max3_f32 v25,v25,v181,v182
v_max3_f32 v26,v26,v189,v190
v_mfma_f32_16x16x32_bf16 v[208:211],a[128:131],a[32:35],0
ds_read_b64_tr_b16 a[100:101],v6 offset:51200
v_max_f32 v23,v23,v167
v_mfma_f32_16x16x32_bf16 v[208:211],a[132:135],a[36:39],v[208:211]
ds_read_b64_tr_b16 a[102:103],v6 offset:52224
v_max_f32 v24,v24,v175
v_mfma_f32_16x16x32_bf16 v[208:211],a[136:139],a[40:43],v[208:211]
v_max_f32 v25,v25,v183
v_max_f32 v26,v26,v191
v_mfma_f32_16x16x32_bf16 v[208:211],a[140:143],a[44:47],v[208:211]
buffer_load_dwordx4 v1,s[8:11],s21 offen offset:3072 nt lds
v_mov_b32 v27,v23
v_mov_b32 v28,v24
v_mov_b32 v29,v25
v_mov_b32 v30,v26
v_mfma_f32_16x16x32_bf16 v[216:219],a[140:143],a[60:63],0
s_add_u32 s21,s21,16384
ds_read_b64_tr_b16 a[104:105],v6 offset:49160
v_mfma_f32_16x16x32_bf16 v[216:219],a[136:139],a[56:59],v[216:219]
ds_read_b64_tr_b16 a[106:107],v6 offset:50184
v_permlane16_swap_b32 v23,v27
v_mfma_f32_16x16x32_bf16 v[216:219],a[132:135],a[52:55],v[216:219]
v_permlane16_swap_b32 v24,v28
v_permlane16_swap_b32 v25,v29
v_mfma_f32_16x16x32_bf16 v[216:219],a[128:131],a[48:51],v[216:219]
s_waitcnt lgkmcnt(6)
v_permlane16_swap_b32 v26,v30
v_max_f32 v23,v23,v27
v_max_f32 v24,v24,v28
v_max_f32 v25,v25,v29
v_mfma_f32_16x16x32_bf16 v[196:199],a[144:147],a[0:3],0
ds_read_b64_tr_b16 a[108:109],v6 offset:51208
v_max_f32 v26,v26,v30
v_mfma_f32_16x16x32_bf16 v[196:199],a[148:151],a[4:7],v[196:199]
ds_read_b64_tr_b16 a[110:111],v6 offset:52232
v_mov_b32 v27,v23
v_mfma_f32_16x16x32_bf16 v[196:199],a[152:155],a[8:11],v[196:199]
v_mov_b32 v28,v24
v_mov_b32 v29,v25
v_mfma_f32_16x16x32_bf16 v[196:199],a[156:159],a[12:15],v[196:199]
ds_read_b64_tr_b16 a[112:113],v7 offset:49152
v_mov_b32 v30,v26
v_permlane32_swap_b32 v23,v27
v_permlane32_swap_b32 v24,v28
v_permlane32_swap_b32 v25,v29
v_mfma_f32_16x16x32_bf16 v[204:207],a[156:159],a[28:31],0
ds_read_b64_tr_b16 a[114:115],v7 offset:50176
v_permlane32_swap_b32 v26,v30
v_mfma_f32_16x16x32_bf16 v[204:207],a[152:155],a[24:27],v[204:207]
v_max_f32 v23,v23,v27
v_max_f32 v24,v24,v28
v_mfma_f32_16x16x32_bf16 v[204:207],a[148:151],a[20:23],v[204:207]
v_max_f32 v25,v25,v29
v_max_f32 v26,v26,v30
v_mfma_f32_16x16x32_bf16 v[204:207],a[144:147],a[16:19],v[204:207]
ds_read_b64_tr_b16 a[116:117],v7 offset:51200
v_mul_f32 v18,s26,v23
v_mul_f32 v19,s26,v24
v_mul_f32 v20,s26,v25
v_mul_f32 v21,s26,v26
v_mfma_f32_16x16x32_bf16 v[212:215],a[144:147],a[32:35],0
ds_read_b64_tr_b16 a[118:119],v7 offset:52224
v_fma_f32 v160,v160,s26,-v18
v_mfma_f32_16x16x32_bf16 v[212:215],a[148:151],a[36:39],v[212:215]
v_exp_f32 v160,v160
v_mfma_f32_16x16x32_bf16 v[212:215],a[152:155],a[40:43],v[212:215]
v_fma_f32 v161,v161,s26,-v18
v_fma_f32 v162,v162,s26,-v18
v_mfma_f32_16x16x32_bf16 v[212:215],a[156:159],a[44:47],v[212:215]
ds_read_b64_tr_b16 a[120:121],v7 offset:49160
v_exp_f32 v161,v161
v_fma_f32 v163,v163,s26,-v18
v_exp_f32 v162,v162
v_mfma_f32_16x16x32_bf16 v[220:223],a[156:159],a[60:63],0
ds_read_b64_tr_b16 a[122:123],v7 offset:50184
v_cvt_pk_bf16_f32 v160,v160,v161
v_mfma_f32_16x16x32_bf16 v[220:223],a[152:155],a[56:59],v[220:223]
v_exp_f32 v163,v163
v_mfma_f32_16x16x32_bf16 v[220:223],a[148:151],a[52:55],v[220:223]
ds_read_b64_tr_b16 a[124:125],v7 offset:51208
v_fma_f32 v164,v164,s26,-v18
v_mfma_f32_16x16x32_bf16 v[220:223],a[144:147],a[48:51],v[220:223]
s_waitcnt lgkmcnt(14)
ds_read_b64_tr_b16 a[126:127],v7 offset:52232
v_fma_f32 v165,v165,s26,-v18
v_exp_f32 v164,v164
v_cvt_pk_bf16_f32 v161,v162,v163
v_fma_f32 v166,v166,s26,-v18
v_mfma_f32_16x16x32_bf16 a[224:227],a[240:243],v[224:227],a[224:227]
s_add_u32 m0,s25,81920
v_exp_f32 v165,v165
v_mfma_f32_16x16x32_bf16 a[224:227],a[240:243],v[228:231],a[224:227]
buffer_load_dwordx4 v1,s[12:15],s22 offen nt lds
v_exp_f32 v166,v166
v_fma_f32 v167,v167,s26,-v18
v_cvt_pk_bf16_f32 v162,v164,v165
v_mfma_f32_16x16x32_bf16 a[228:231],a[240:243],v[232:235],a[228:231]
s_waitcnt lgkmcnt(14)
ds_read_b64_tr_b16 a[128:129],v8 offset:49152
v_fma_f32 v168,v168,s26,-v19
v_mfma_f32_16x16x32_bf16 a[228:231],a[240:243],v[236:239],a[228:231]
s_waitcnt lgkmcnt(14)
ds_read_b64_tr_b16 a[130:131],v8 offset:50176
v_exp_f32 v167,v167
v_fma_f32 v169,v169,s26,-v19
v_exp_f32 v168,v168
v_mfma_f32_16x16x32_bf16 a[232:235],a[240:243],v[240:243],a[232:235]
v_exp_f32 v169,v169
v_mfma_f32_16x16x32_bf16 a[232:235],a[240:243],v[244:247],a[232:235]
s_waitcnt lgkmcnt(14)
v_cvt_pk_bf16_f32 v163,v166,v167
v_fma_f32 v170,v170,s26,-v19
v_fma_f32 v171,v171,s26,-v19
v_cvt_pk_bf16_f32 v168,v168,v169
v_fma_f32 v172,v172,s26,-v19
v_fma_f32 v173,v173,s26,-v19
v_mfma_f32_16x16x32_bf16 a[236:239],a[240:243],v[248:251],a[236:239]
ds_read_b64_tr_b16 a[132:133],v8 offset:51200
v_fma_f32 v174,v174,s26,-v19
v_mfma_f32_16x16x32_bf16 a[236:239],a[240:243],v[252:255],a[236:239]
s_waitcnt lgkmcnt(14)
ds_read_b64_tr_b16 a[134:135],v8 offset:52224
v_exp_f32 v170,v170
v_exp_f32 v171,v171
v_fma_f32 v175,v175,s26,-v19
v_mfma_f32_16x16x32_bf16 v[80:83],a[96:99],v[248:251],v[80:83]
v_exp_f32 v172,v172
v_mfma_f32_16x16x32_bf16 v[80:83],a[100:103],v[252:255],v[80:83]
s_waitcnt lgkmcnt(14)
ds_read_b64_tr_b16 a[136:137],v8 offset:49160
v_exp_f32 v173,v173
v_exp_f32 v174,v174
v_mfma_f32_16x16x32_bf16 v[64:67],a[100:103],v[244:247],v[64:67]
s_waitcnt lgkmcnt(14)
ds_read_b64_tr_b16 a[138:139],v8 offset:50184
v_cvt_pk_bf16_f32 v169,v170,v171
v_mfma_f32_16x16x32_bf16 v[64:67],a[96:99],v[240:243],v[64:67]
buffer_load_dwordx4 v1,s[12:15],s22 offen offset:1024 nt lds
v_exp_f32 v175,v175
v_accvgpr_read_b32 v14,a224
v_cvt_pk_bf16_f32 v170,v172,v173
v_mfma_f32_16x16x32_bf16 v[48:51],a[96:99],v[232:235],v[48:51]
v_accvgpr_read_b32 v15,a228
v_fma_f32 v176,v176,s26,-v20
v_mfma_f32_16x16x32_bf16 v[48:51],a[100:103],v[236:239],v[48:51]
s_waitcnt lgkmcnt(14)
ds_read_b64_tr_b16 a[140:141],v8 offset:51208
v_accvgpr_read_b32 v16,a232
v_exp_f32 v176,v176
v_fma_f32 v177,v177,s26,-v20
v_cvt_pk_bf16_f32 v171,v174,v175
v_mfma_f32_16x16x32_bf16 v[32:35],a[100:103],v[228:231],v[32:35]
s_waitcnt lgkmcnt(14)
ds_read_b64_tr_b16 a[142:143],v8 offset:52232
v_accvgpr_read_b32 v17,a236
v_mfma_f32_16x16x32_bf16 v[32:35],a[96:99],v[224:227],v[32:35]
v_exp_f32 v177,v177
v_fma_f32 v178,v178,s26,-v20
v_fma_f32 v179,v179,s26,-v20
v_add_f32 v31,v14,v15
v_fma_f32 v180,v180,s26,-v20
v_mfma_f32_16x16x32_bf16 v[36:39],a[104:107],v[224:227],v[36:39]
v_exp_f32 v178,v178
v_mfma_f32_16x16x32_bf16 v[36:39],a[108:111],v[228:231],v[36:39]
s_waitcnt lgkmcnt(14)
ds_read_b64_tr_b16 a[144:145],v9 offset:49152
v_cvt_pk_bf16_f32 v176,v176,v177
v_exp_f32 v179,v179
v_exp_f32 v180,v180
v_mfma_f32_16x16x32_bf16 v[52:55],a[108:111],v[236:239],v[52:55]
s_waitcnt lgkmcnt(14)
ds_read_b64_tr_b16 a[146:147],v9 offset:50176
v_add_f32 v31,v31,v16
v_mfma_f32_16x16x32_bf16 v[52:55],a[104:107],v[232:235],v[52:55]
buffer_load_dwordx4 v1,s[12:15],s22 offen offset:2048 nt lds
v_fma_f32 v181,v181,s26,-v20
v_cvt_pk_bf16_f32 v177,v178,v179
v_add_f32 v31,v31,v17
v_fma_f32 v182,v182,s26,-v20
v_mfma_f32_16x16x32_bf16 v[68:71],a[104:107],v[240:243],v[68:71]
s_waitcnt lgkmcnt(14)
ds_read_b64_tr_b16 a[148:149],v9 offset:51200
v_cmp_nge_f32 vcc,s27,v31
v_mfma_f32_16x16x32_bf16 v[68:71],a[108:111],v[244:247],v[68:71]
s_waitcnt lgkmcnt(14)
ds_read_b64_tr_b16 a[150:151],v9 offset:52224
v_exp_f32 v181,v181
v_fma_f32 v183,v183,s26,-v20
v_rcp_f32 v14,v14
v_mfma_f32_16x16x32_bf16 v[84:87],a[108:111],v[252:255],v[84:87]
v_exp_f32 v182,v182
v_mfma_f32_16x16x32_bf16 v[84:87],a[104:107],v[248:251],v[84:87]
v_exp_f32 v183,v183
v_rcp_f32 v15,v15
v_cvt_pk_bf16_f32 v178,v180,v181
v_fma_f32 v184,v184,s26,-v21
v_mfma_f32_16x16x32_bf16 v[88:91],a[112:115],v[248:251],v[88:91]
s_waitcnt lgkmcnt(14)
ds_read_b64_tr_b16 a[152:153],v9 offset:49160
v_fma_f32 v185,v185,s26,-v21
v_mfma_f32_16x16x32_bf16 v[88:91],a[116:119],v[252:255],v[88:91]
s_waitcnt lgkmcnt(14)
ds_read_b64_tr_b16 a[154:155],v9 offset:50184
v_cvt_pk_bf16_f32 v179,v182,v183
v_exp_f32 v184,v184
v_exp_f32 v185,v185
v_mfma_f32_16x16x32_bf16 v[72:75],a[116:119],v[244:247],v[72:75]
v_rcp_f32 v16,v16
v_mfma_f32_16x16x32_bf16 v[72:75],a[112:115],v[240:243],v[72:75]
s_waitcnt lgkmcnt(14)
ds_read_b64_tr_b16 a[156:157],v9 offset:51208
v_fma_f32 v186,v186,s26,-v21
v_rcp_f32 v17,v17
v_fma_f32 v187,v187,s26,-v21
v_cvt_pk_bf16_f32 v184,v184,v185
v_mfma_f32_16x16x32_bf16 v[56:59],a[112:115],v[232:235],v[56:59]
s_waitcnt lgkmcnt(14)
ds_read_b64_tr_b16 a[158:159],v9 offset:52232
v_fma_f32 v188,v188,s26,-v21
v_mfma_f32_16x16x32_bf16 v[56:59],a[116:119],v[236:239],v[56:59]
buffer_load_dwordx4 v1,s[12:15],s22 offen offset:3072 nt lds
v_exp_f32 v186,v186
v_exp_f32 v187,v187
v_mfma_f32_16x16x32_bf16 v[40:43],a[116:119],v[228:231],v[40:43]
s_add_u32 s22,s22,16384
s_cmp_lg_u64 vcc,0
s_cselect_b32 s32,s29,0
s_or_b32 s28,s28,s32
s_lshl_b32 s29,s29,1
v_mfma_f32_16x16x32_bf16 v[40:43],a[112:115],v[224:227],v[40:43]
v_exp_f32 v188,v188
v_fma_f32 v189,v189,s26,-v21
v_cvt_pk_bf16_f32 v185,v186,v187
v_fma_f32 v190,v190,s26,-v21
v_fma_f32 v191,v191,s26,-v21
v_mfma_f32_16x16x32_bf16 v[44:47],a[120:123],v[224:227],v[44:47]
s_add_u32 m0,s25,147456
v_exp_f32 v189,v189
v_mfma_f32_16x16x32_bf16 v[44:47],a[124:127],v[228:231],v[44:47]
buffer_load_dwordx4 v1,s[4:7],s23 offen nt lds
v_exp_f32 v190,v190
v_exp_f32 v191,v191
v_mfma_f32_16x16x32_bf16 v[60:63],a[124:127],v[236:239],v[60:63]
v_cvt_pk_bf16_f32 v186,v188,v189
v_cvt_pk_bf16_f32 v187,v190,v191
v_mfma_f32_16x16x32_bf16 v[60:63],a[120:123],v[232:235],v[60:63]
buffer_load_dwordx4 v1,s[4:7],s23 offen offset:1024 nt lds
v_mfma_f32_16x16x32_bf16 v[76:79],a[120:123],v[240:243],v[76:79]
v_fma_f32 v192,v192,s26,-v18
v_fma_f32 v193,v193,s26,-v18
v_mfma_f32_16x16x32_bf16 v[76:79],a[124:127],v[244:247],v[76:79]
buffer_load_dwordx4 v1,s[4:7],s23 offen offset:2048 nt lds
v_exp_f32 v192,v192
v_exp_f32 v193,v193
v_fma_f32 v194,v194,s26,-v18
v_fma_f32 v195,v195,s26,-v18
v_mul_f32 v32,v32,v14
v_mfma_f32_16x16x32_bf16 v[92:95],a[124:127],v[252:255],v[92:95]
v_exp_f32 v194,v194
v_mfma_f32_16x16x32_bf16 v[92:95],a[120:123],v[248:251],v[92:95]
s_waitcnt lgkmcnt(12)
v_exp_f32 v195,v195
v_cvt_pk_bf16_f32 v164,v192,v193
v_mul_f32 v33,v33,v14
v_mul_f32 v34,v34,v14
v_mul_f32 v35,v35,v14
v_fma_f32 v200,v200,s26,-v19
v_fma_f32 v201,v201,s26,-v19
v_mul_f32 v36,v36,v14
v_mul_f32 v37,v37,v14
v_mfma_f32_16x16x32_bf16 a[208:211],a[128:131],v[248:251],a[208:211]
v_exp_f32 v200,v200
v_mfma_f32_16x16x32_bf16 a[208:211],a[132:135],v[252:255],a[208:211]
buffer_load_dwordx4 v1,s[4:7],s23 offen offset:3072 nt lds
v_cvt_pk_bf16_f32 v165,v194,v195
v_exp_f32 v201,v201
v_cvt_pk_bf16_f32 v96,v32,v33
v_cvt_pk_bf16_f32 v97,v34,v35
v_mul_f32 v38,v38,v14
v_mul_f32 v39,v39,v14
v_mfma_f32_16x16x32_bf16 a[192:195],a[132:135],v[244:247],a[192:195]
s_add_u32 s23,s23,16384
v_cvt_pk_bf16_f32 v98,v36,v37
v_mul_f32 v40,v40,v14
v_mfma_f32_16x16x32_bf16 a[192:195],a[128:131],v[240:243],a[192:195]
s_waitcnt vmcnt(16)
s_waitcnt lgkmcnt(0)
s_barrier
ds_read_b128 a[96:99],v2 offset:16384
v_mul_f32 v41,v41,v14
v_cvt_pk_bf16_f32 v99,v38,v39
v_mul_f32 v42,v42,v14
v_mul_f32 v43,v43,v14
v_cvt_pk_bf16_f32 v172,v200,v201
v_mul_f32 v44,v44,v14
v_mul_f32 v45,v45,v14
v_fma_f32 v202,v202,s26,-v19
v_mfma_f32_16x16x32_bf16 a[176:179],a[128:131],v[232:235],a[176:179]
v_exp_f32 v202,v202
v_mfma_f32_16x16x32_bf16 a[176:179],a[132:135],v[236:239],a[176:179]
v_cvt_pk_bf16_f32 v100,v40,v41
v_fma_f32 v203,v203,s26,-v19
v_cvt_pk_bf16_f32 v101,v42,v43
v_mul_f32 v46,v46,v14
v_mul_f32 v47,v47,v14
v_cvt_pk_bf16_f32 v102,v44,v45
v_mul_f32 v48,v48,v15
v_mul_f32 v49,v49,v15
v_mul_f32 v50,v50,v15
v_mul_f32 v51,v51,v15
v_mfma_f32_16x16x32_bf16 a[160:163],a[132:135],v[228:231],a[160:163]
v_exp_f32 v203,v203
v_mfma_f32_16x16x32_bf16 a[160:163],a[128:131],v[224:227],a[160:163]
ds_read_b128 a[100:103],v3 offset:16384
v_cvt_pk_bf16_f32 v103,v46,v47
v_cvt_pk_bf16_f32 v173,v202,v203
v_cvt_pk_bf16_f32 v112,v48,v49
v_mul_f32 v52,v52,v15
v_mul_f32 v53,v53,v15
v_fma_f32 v208,v208,s26,-v20
v_fma_f32 v209,v209,s26,-v20
v_cvt_pk_bf16_f32 v113,v50,v51
v_mfma_f32_16x16x32_bf16 a[164:167],a[136:139],v[224:227],a[164:167]
v_exp_f32 v208,v208
v_mfma_f32_16x16x32_bf16 a[164:167],a[140:143],v[228:231],a[164:167]
v_mul_f32 v54,v54,v15
v_exp_f32 v209,v209
v_mul_f32 v55,v55,v15
v_cvt_pk_bf16_f32 v114,v52,v53
v_mul_f32 v56,v56,v15
v_mul_f32 v57,v57,v15
v_mul_f32 v58,v58,v15
v_mul_f32 v59,v59,v15
v_mfma_f32_16x16x32_bf16 a[180:183],a[140:143],v[236:239],a[180:183]
ds_read_b128 a[104:107],v4 offset:16384
v_cvt_pk_bf16_f32 v115,v54,v55
v_mfma_f32_16x16x32_bf16 a[180:183],a[136:139],v[232:235],a[180:183]
v_cvt_pk_bf16_f32 v116,v56,v57
v_mul_f32 v60,v60,v15
v_mul_f32 v61,v61,v15
v_cvt_pk_bf16_f32 v180,v208,v209
v_cvt_pk_bf16_f32 v117,v58,v59
v_fma_f32 v210,v210,s26,-v20
v_fma_f32 v211,v211,s26,-v20
v_mul_f32 v62,v62,v15
v_mul_f32 v63,v63,v15
v_mfma_f32_16x16x32_bf16 a[196:199],a[136:139],v[240:243],a[196:199]
v_exp_f32 v210,v210
v_mfma_f32_16x16x32_bf16 a[196:199],a[140:143],v[244:247],a[196:199]
v_exp_f32 v211,v211
v_cvt_pk_bf16_f32 v118,v60,v61
v_mul_f32 v64,v64,v16
v_mul_f32 v65,v65,v16
v_cvt_pk_bf16_f32 v119,v62,v63
v_mul_f32 v66,v66,v16
v_mul_f32 v67,v67,v16
v_mul_f32 v68,v68,v16
v_mul_f32 v69,v69,v16
v_mfma_f32_16x16x32_bf16 a[212:215],a[140:143],v[252:255],a[212:215]
ds_read_b128 a[108:111],v5 offset:16384
v_cvt_pk_bf16_f32 v128,v64,v65
v_mfma_f32_16x16x32_bf16 a[212:215],a[136:139],v[248:251],a[212:215]
v_cvt_pk_bf16_f32 v181,v210,v211
v_cvt_pk_bf16_f32 v129,v66,v67
v_mul_f32 v70,v70,v16
v_mul_f32 v71,v71,v16
v_fma_f32 v216,v216,s26,-v21
v_fma_f32 v217,v217,s26,-v21
v_cvt_pk_bf16_f32 v130,v68,v69
v_mul_f32 v72,v72,v16
v_mul_f32 v73,v73,v16
v_mfma_f32_16x16x32_bf16 a[216:219],a[144:147],v[248:251],a[216:219]
v_exp_f32 v216,v216
v_mfma_f32_16x16x32_bf16 a[216:219],a[148:151],v[252:255],a[216:219]
v_cvt_pk_bf16_f32 v131,v70,v71
v_exp_f32 v217,v217
v_mul_f32 v74,v74,v16
v_mul_f32 v75,v75,v16
v_cvt_pk_bf16_f32 v132,v72,v73
v_mul_f32 v76,v76,v16
v_mul_f32 v77,v77,v16
v_mul_f32 v78,v78,v16
v_mfma_f32_16x16x32_bf16 a[200:203],a[148:151],v[244:247],a[200:203]
ds_read_b128 a[112:115],v2 offset:17408
v_cvt_pk_bf16_f32 v133,v74,v75
v_mfma_f32_16x16x32_bf16 a[200:203],a[144:147],v[240:243],a[200:203]
v_cvt_pk_bf16_f32 v188,v216,v217
v_mul_f32 v79,v79,v16
v_fma_f32 v218,v218,s26,-v21
v_fma_f32 v219,v219,s26,-v21
v_cvt_pk_bf16_f32 v134,v76,v77
v_mul_f32 v80,v80,v17
v_mul_f32 v81,v81,v17
v_mul_f32 v82,v82,v17
v_mul_f32 v83,v83,v17
v_mul_f32 v84,v84,v17
v_mfma_f32_16x16x32_bf16 a[184:187],a[144:147],v[232:235],a[184:187]
v_exp_f32 v218,v218
v_mfma_f32_16x16x32_bf16 a[184:187],a[148:151],v[236:239],a[184:187]
ds_read_b128 a[116:119],v3 offset:17408
v_exp_f32 v219,v219
v_cvt_pk_bf16_f32 v135,v78,v79
v_cvt_pk_bf16_f32 v144,v80,v81
v_mul_f32 v85,v85,v17
v_cvt_pk_bf16_f32 v145,v82,v83
v_mul_f32 v86,v86,v17
v_mul_f32 v87,v87,v17
v_mfma_f32_16x16x32_bf16 a[168:171],a[148:151],v[228:231],a[168:171]
v_cvt_pk_bf16_f32 v189,v218,v219
v_cvt_pk_bf16_f32 v146,v84,v85
v_mfma_f32_16x16x32_bf16 a[168:171],a[144:147],v[224:227],a[168:171]
v_mul_f32 v88,v88,v17
v_mul_f32 v89,v89,v17
v_fma_f32 v196,v196,s26,-v18
v_fma_f32 v197,v197,s26,-v18
v_cvt_pk_bf16_f32 v147,v86,v87
v_mul_f32 v90,v90,v17
v_mul_f32 v91,v91,v17
v_mul_f32 v92,v92,v17
v_mul_f32 v93,v93,v17
v_mfma_f32_16x16x32_bf16 a[172:175],a[152:155],v[224:227],a[172:175]
v_exp_f32 v196,v196
v_mfma_f32_16x16x32_bf16 a[172:175],a[156:159],v[228:231],a[172:175]
ds_read_b128 a[120:123],v4 offset:17408
v_cvt_pk_bf16_f32 v148,v88,v89
v_exp_f32 v197,v197
v_cvt_pk_bf16_f32 v149,v90,v91
v_mul_f32 v94,v94,v17
v_mul_f32 v95,v95,v17
v_cvt_pk_bf16_f32 v150,v92,v93
v_accvgpr_read_b32 v32,a160
v_fma_f32 v198,v198,s26,-v18
v_mfma_f32_16x16x32_bf16 a[188:191],a[156:159],v[236:239],a[188:191]
v_exp_f32 v198,v198
v_mfma_f32_16x16x32_bf16 a[188:191],a[152:155],v[232:235],a[188:191]
v_cvt_pk_bf16_f32 v166,v196,v197
v_fma_f32 v199,v199,s26,-v18
v_accvgpr_read_b32 v33,a161
v_cvt_pk_bf16_f32 v151,v94,v95
v_accvgpr_read_b32 v34,a162
v_accvgpr_read_b32 v35,a163
v_mul_f32 v32,v32,v14
v_accvgpr_read_b32 v36,a164
v_accvgpr_read_b32 v37,a165
v_mfma_f32_16x16x32_bf16 a[204:207],a[152:155],v[240:243],a[204:207]
v_exp_f32 v199,v199
v_mfma_f32_16x16x32_bf16 a[204:207],a[156:159],v[244:247],a[204:207]
ds_read_b128 a[124:127],v5 offset:17408
v_mul_f32 v33,v33,v14
v_mul_f32 v34,v34,v14
v_mul_f32 v35,v35,v14
v_cvt_pk_bf16_f32 v167,v198,v199
v_accvgpr_read_b32 v38,a166
v_fma_f32 v204,v204,s26,-v19
v_fma_f32 v205,v205,s26,-v19
v_accvgpr_read_b32 v39,a167
v_mfma_f32_16x16x32_bf16 a[220:223],a[156:159],v[252:255],a[220:223]
v_exp_f32 v204,v204
v_mfma_f32_16x16x32_bf16 a[220:223],a[152:155],v[248:251],a[220:223]
s_waitcnt lgkmcnt(4)
v_exp_f32 v205,v205
v_cvt_pk_bf16_f32 v104,v32,v33
v_mul_f32 v36,v36,v14
v_mul_f32 v37,v37,v14
v_cvt_pk_bf16_f32 v105,v34,v35
v_accvgpr_read_b32 v40,a168
v_accvgpr_read_b32 v41,a169
v_mul_f32 v38,v38,v14
v_mul_f32 v39,v39,v14
v_mfma_f32_16x16x32_bf16 v[224:227],a[96:99],a[0:3],0
ds_read_b128 a[128:131],v2 offset:18432
v_cvt_pk_bf16_f32 v106,v36,v37
v_mfma_f32_16x16x32_bf16 v[224:227],a[100:103],a[4:7],v[224:227]
v_accvgpr_read_b32 v42,a170
v_cvt_pk_bf16_f32 v174,v204,v205
v_mfma_f32_16x16x32_bf16 v[224:227],a[104:107],a[8:11],v[224:227]
v_accvgpr_read_b32 v43,a171
v_mul_f32 v40,v40,v14
v_mfma_f32_16x16x32_bf16 v[224:227],a[108:111],a[12:15],v[224:227]
v_mul_f32 v41,v41,v14
v_cvt_pk_bf16_f32 v107,v38,v39
v_fma_f32 v206,v206,s26,-v19
v_fma_f32 v207,v207,s26,-v19
v_accvgpr_read_b32 v44,a172
v_accvgpr_read_b32 v45,a173
v_mul_f32 v42,v42,v14
v_mul_f32 v43,v43,v14
v_accvgpr_read_b32 v46,a174
v_mfma_f32_16x16x32_bf16 v[232:235],a[108:111],a[28:31],0
ds_read_b128 a[132:135],v3 offset:18432
v_cvt_pk_bf16_f32 v108,v40,v41
v_mfma_f32_16x16x32_bf16 v[232:235],a[104:107],a[24:27],v[232:235]
v_exp_f32 v206,v206
v_mfma_f32_16x16x32_bf16 v[232:235],a[100:103],a[20:23],v[232:235]
v_exp_f32 v207,v207
v_mfma_f32_16x16x32_bf16 v[232:235],a[96:99],a[16:19],v[232:235]
v_accvgpr_read_b32 v47,a175
v_mul_f32 v44,v44,v14
v_mul_f32 v45,v45,v14
v_cvt_pk_bf16_f32 v109,v42,v43
v_accvgpr_read_b32 v48,a176
v_cvt_pk_bf16_f32 v175,v206,v207
v_fma_f32 v224,v224,s26,-v18
v_fma_f32 v225,v225,s26,-v18
v_accvgpr_read_b32 v49,a177
v_mfma_f32_16x16x32_bf16 v[240:243],a[96:99],a[32:35],0
ds_read_b128 a[136:139],v4 offset:18432
v_fma_f32 v212,v212,s26,-v20
v_mfma_f32_16x16x32_bf16 v[240:243],a[100:103],a[36:39],v[240:243]
v_exp_f32 v224,v224
v_mfma_f32_16x16x32_bf16 v[240:243],a[104:107],a[40:43],v[240:243]
v_exp_f32 v225,v225
v_mfma_f32_16x16x32_bf16 v[240:243],a[108:111],a[44:47],v[240:243]
ds_read_b128 a[140:143],v5 offset:18432
v_exp_f32 v212,v212
v_fma_f32 v213,v213,s26,-v20
v_mul_f32 v46,v46,v14
v_mul_f32 v47,v47,v14
v_cvt_pk_bf16_f32 v110,v44,v45
v_accvgpr_read_b32 v50,a178
v_accvgpr_read_b32 v51,a179
v_mfma_f32_16x16x32_bf16 v[248:251],a[108:111],a[60:63],0
v_exp_f32 v213,v213
v_mfma_f32_16x16x32_bf16 v[248:251],a[104:107],a[56:59],v[248:251]
v_mul_f32 v48,v48,v15
v_mul_f32 v49,v49,v15
v_mfma_f32_16x16x32_bf16 v[248:251],a[100:103],a[52:55],v[248:251]
s_waitcnt lgkmcnt(4)
v_cvt_pk_bf16_f32 v111,v46,v47
v_accvgpr_read_b32 v52,a180
v_mfma_f32_16x16x32_bf16 v[248:251],a[96:99],a[48:51],v[248:251]
ds_read_b128 a[144:147],v2 offset:19456
v_accvgpr_read_b32 v53,a181
v_mul_f32 v50,v50,v15
v_mul_f32 v51,v51,v15
v_cvt_pk_bf16_f32 v120,v48,v49
v_cvt_pk_bf16_f32 v182,v212,v213
v_accvgpr_read_b32 v54,a182
v_fma_f32 v226,v226,s26,-v18
v_fma_f32 v227,v227,s26,-v18
v_fma_f32 v214,v214,s26,-v20
v_mfma_f32_16x16x32_bf16 v[228:231],a[112:115],a[0:3],0
v_exp_f32 v226,v226
v_mfma_f32_16x16x32_bf16 v[228:231],a[116:119],a[4:7],v[228:231]
v_exp_f32 v227,v227
v_mfma_f32_16x16x32_bf16 v[228:231],a[120:123],a[8:11],v[228:231]
v_exp_f32 v214,v214
v_mfma_f32_16x16x32_bf16 v[228:231],a[124:127],a[12:15],v[228:231]
ds_read_b128 a[148:151],v3 offset:19456
v_fma_f32 v215,v215,s26,-v20
v_accvgpr_read_b32 v55,a183
v_mul_f32 v52,v52,v15
v_mul_f32 v53,v53,v15
v_cvt_pk_bf16_f32 v121,v50,v51
v_accvgpr_read_b32 v56,a184
v_accvgpr_read_b32 v57,a185
v_mul_f32 v54,v54,v15
v_mfma_f32_16x16x32_bf16 v[236:239],a[124:127],a[28:31],0
v_exp_f32 v215,v215
v_mfma_f32_16x16x32_bf16 v[236:239],a[120:123],a[24:27],v[236:239]
v_mul_f32 v55,v55,v15
v_cvt_pk_bf16_f32 v122,v52,v53
v_mfma_f32_16x16x32_bf16 v[236:239],a[116:119],a[20:23],v[236:239]
ds_read_b128 a[152:155],v4 offset:19456
v_cvt_pk_bf16_f32 v224,v224,v225
v_mfma_f32_16x16x32_bf16 v[236:239],a[112:115],a[16:19],v[236:239]
v_accvgpr_read_b32 v58,a186
v_cvt_pk_bf16_f32 v225,v226,v227
v_accvgpr_read_b32 v59,a187
v_cvt_pk_bf16_f32 v183,v214,v215
v_mul_f32 v56,v56,v15
v_mul_f32 v57,v57,v15
v_cvt_pk_bf16_f32 v123,v54,v55
v_fma_f32 v228,v228,s26,-v18
v_fma_f32 v229,v229,s26,-v18
v_mfma_f32_16x16x32_bf16 v[244:247],a[112:115],a[32:35],0
v_exp_f32 v228,v228
v_mfma_f32_16x16x32_bf16 v[244:247],a[116:119],a[36:39],v[244:247]
v_exp_f32 v229,v229
v_mfma_f32_16x16x32_bf16 v[244:247],a[120:123],a[40:43],v[244:247]
s_add_u32 m0,s25,49152
ds_read_b128 a[156:159],v5 offset:19456
v_mfma_f32_16x16x32_bf16 v[244:247],a[124:127],a[44:47],v[244:247]
buffer_load_dwordx4 v1,s[8:11],s21 offen nt lds
v_accvgpr_read_b32 v60,a188
v_fma_f32 v220,v220,s26,-v21
v_fma_f32 v221,v221,s26,-v21
v_accvgpr_read_b32 v61,a189
v_mul_f32 v58,v58,v15
v_mul_f32 v59,v59,v15
v_cvt_pk_bf16_f32 v124,v56,v57
v_accvgpr_read_b32 v62,a190
v_mfma_f32_16x16x32_bf16 v[252:255],a[124:127],a[60:63],0
v_exp_f32 v220,v220
v_mfma_f32_16x16x32_bf16 v[252:255],a[120:123],a[56:59],v[252:255]
v_exp_f32 v221,v221
v_mfma_f32_16x16x32_bf16 v[252:255],a[116:119],a[52:55],v[252:255]
v_accvgpr_read_b32 v63,a191
v_mul_f32 v60,v60,v15
v_mfma_f32_16x16x32_bf16 v[252:255],a[112:115],a[48:51],v[252:255]
s_waitcnt lgkmcnt(4)
v_mul_f32 v61,v61,v15
v_cvt_pk_bf16_f32 v125,v58,v59
v_cvt_pk_bf16_f32 v226,v228,v229
v_accvgpr_read_b32 v64,a192
v_cvt_pk_bf16_f32 v190,v220,v221
v_fma_f32 v230,v230,s26,-v18
v_fma_f32 v231,v231,s26,-v18
v_accvgpr_read_b32 v65,a193
v_mul_f32 v62,v62,v15
v_mfma_f32_16x16x32_bf16 v[192:195],a[128:131],a[0:3],0
v_exp_f32 v230,v230
v_mfma_f32_16x16x32_bf16 v[192:195],a[132:135],a[4:7],v[192:195]
v_exp_f32 v231,v231
v_mfma_f32_16x16x32_bf16 v[192:195],a[136:139],a[8:11],v[192:195]
v_mul_f32 v63,v63,v15
v_cvt_pk_bf16_f32 v126,v60,v61
v_mfma_f32_16x16x32_bf16 v[192:195],a[140:143],a[12:15],v[192:195]
buffer_load_dwordx4 v1,s[8:11],s21 offen offset:1024 nt lds
v_fma_f32 v222,v222,s26,-v21
v_fma_f32 v223,v223,s26,-v21
v_accvgpr_read_b32 v66,a194
v_accvgpr_read_b32 v67,a195
v_mul_f32 v64,v64,v16
v_mul_f32 v65,v65,v16
v_cvt_pk_bf16_f32 v127,v62,v63
v_mfma_f32_16x16x32_bf16 v[200:203],a[140:143],a[28:31],0
v_exp_f32 v222,v222
v_mfma_f32_16x16x32_bf16 v[200:203],a[136:139],a[24:27],v[200:203]
ds_read_b64_tr_b16 a[96:97],v8 offset:0
v_accvgpr_read_b32 v68,a196
v_mfma_f32_16x16x32_bf16 v[200:203],a[132:135],a[20:23],v[200:203]
ds_read_b64_tr_b16 a[98:99],v8 offset:1024
v_accvgpr_read_b32 v69,a197
v_mfma_f32_16x16x32_bf16 v[200:203],a[128:131],a[16:19],v[200:203]
buffer_load_dwordx4 v1,s[8:11],s21 offen offset:2048 nt lds
v_exp_f32 v223,v223
v_mul_f32 v66,v66,v16
v_mul_f32 v67,v67,v16
v_cvt_pk_bf16_f32 v227,v230,v231
v_cvt_pk_bf16_f32 v136,v64,v65
v_accvgpr_read_b32 v70,a198
v_fma_f32 v232,v232,s26,-v19
v_mfma_f32_16x16x32_bf16 v[208:211],a[128:131],a[32:35],0
ds_read_b64_tr_b16 a[100:101],v8 offset:2048
v_cvt_pk_bf16_f32 v191,v222,v223
v_mfma_f32_16x16x32_bf16 v[208:211],a[132:135],a[36:39],v[208:211]
ds_read_b64_tr_b16 a[102:103],v8 offset:3072
v_fma_f32 v233,v233,s26,-v19
v_mfma_f32_16x16x32_bf16 v[208:211],a[136:139],a[40:43],v[208:211]
v_exp_f32 v232,v232
v_mfma_f32_16x16x32_bf16 v[208:211],a[140:143],a[44:47],v[208:211]
buffer_load_dwordx4 v1,s[8:11],s21 offen offset:3072 nt lds
v_accvgpr_read_b32 v71,a199
v_exp_f32 v233,v233
v_mul_f32 v68,v68,v16
v_mul_f32 v69,v69,v16
v_cvt_pk_bf16_f32 v137,v66,v67
v_accvgpr_read_b32 v72,a200
v_mfma_f32_16x16x32_bf16 v[216:219],a[140:143],a[60:63],0
s_add_u32 s21,s21,16384
ds_read_b64_tr_b16 a[104:105],v8 offset:8
v_mfma_f32_16x16x32_bf16 v[216:219],a[136:139],a[56:59],v[216:219]
ds_read_b64_tr_b16 a[106:107],v8 offset:1032
v_accvgpr_read_b32 v73,a201
v_mfma_f32_16x16x32_bf16 v[216:219],a[132:135],a[52:55],v[216:219]
v_mul_f32 v70,v70,v16
v_mul_f32 v71,v71,v16
v_mfma_f32_16x16x32_bf16 v[216:219],a[128:131],a[48:51],v[216:219]
s_waitcnt lgkmcnt(6)
v_cvt_pk_bf16_f32 v138,v68,v69
v_accvgpr_read_b32 v74,a202
v_cvt_pk_bf16_f32 v232,v232,v233
v_accvgpr_read_b32 v75,a203
v_mul_f32 v72,v72,v16
v_mul_f32 v73,v73,v16
v_cvt_pk_bf16_f32 v139,v70,v71
v_fma_f32 v234,v234,s26,-v19
v_fma_f32 v235,v235,s26,-v19
v_mfma_f32_16x16x32_bf16 v[196:199],a[144:147],a[0:3],0
ds_read_b64_tr_b16 a[108:109],v8 offset:2056
v_accvgpr_read_b32 v76,a204
v_mfma_f32_16x16x32_bf16 v[196:199],a[148:151],a[4:7],v[196:199]
ds_read_b64_tr_b16 a[110:111],v8 offset:3080
v_accvgpr_read_b32 v77,a205
v_mfma_f32_16x16x32_bf16 v[196:199],a[152:155],a[8:11],v[196:199]
v_exp_f32 v234,v234
v_mfma_f32_16x16x32_bf16 v[196:199],a[156:159],a[12:15],v[196:199]
ds_read_b64_tr_b16 a[112:113],v9 offset:0
v_mul_f32 v74,v74,v16
v_exp_f32 v235,v235
v_mul_f32 v75,v75,v16
v_cvt_pk_bf16_f32 v140,v72,v73
v_accvgpr_read_b32 v78,a206
v_accvgpr_read_b32 v79,a207
v_mul_f32 v76,v76,v16
v_mul_f32 v77,v77,v16
v_mfma_f32_16x16x32_bf16 v[204:207],a[156:159],a[28:31],0
ds_read_b64_tr_b16 a[114:115],v9 offset:1024
v_cvt_pk_bf16_f32 v141,v74,v75
v_mfma_f32_16x16x32_bf16 v[204:207],a[152:155],a[24:27],v[204:207]
v_accvgpr_read_b32 v80,a208
v_cvt_pk_bf16_f32 v233,v234,v235
v_mfma_f32_16x16x32_bf16 v[204:207],a[148:151],a[20:23],v[204:207]
v_accvgpr_read_b32 v81,a209
v_fma_f32 v240,v240,s26,-v20
v_mfma_f32_16x16x32_bf16 v[204:207],a[144:147],a[16:19],v[204:207]
ds_read_b64_tr_b16 a[116:117],v9 offset:2048
v_exp_f32 v240,v240
v_fma_f32 v241,v241,s26,-v20
v_mul_f32 v78,v78,v16
v_mul_f32 v79,v79,v16
v_cvt_pk_bf16_f32 v142,v76,v77
v_accvgpr_read_b32 v82,a210
v_accvgpr_read_b32 v83,a211
v_mfma_f32_16x16x32_bf16 v[212:215],a[144:147],a[32:35],0
ds_read_b64_tr_b16 a[118:119],v9 offset:3072
v_mul_f32 v80,v80,v17
v_mfma_f32_16x16x32_bf16 v[212:215],a[148:151],a[36:39],v[212:215]
v_exp_f32 v241,v241
v_mfma_f32_16x16x32_bf16 v[212:215],a[152:155],a[40:43],v[212:215]
v_mul_f32 v81,v81,v17
v_cvt_pk_bf16_f32 v143,v78,v79
v_mfma_f32_16x16x32_bf16 v[212:215],a[156:159],a[44:47],v[212:215]
ds_read_b64_tr_b16 a[120:121],v9 offset:8
v_accvgpr_read_b32 v84,a212
v_accvgpr_read_b32 v85,a213
v_mul_f32 v82,v82,v17
v_mul_f32 v83,v83,v17
v_cvt_pk_bf16_f32 v152,v80,v81
v_cvt_pk_bf16_f32 v240,v240,v241
v_accvgpr_read_b32 v86,a214
v_fma_f32 v242,v242,s26,-v20
v_mfma_f32_16x16x32_bf16 v[220:223],a[156:159],a[60:63],0
ds_read_b64_tr_b16 a[122:123],v9 offset:1032
v_fma_f32 v243,v243,s26,-v20
v_mfma_f32_16x16x32_bf16 v[220:223],a[152:155],a[56:59],v[220:223]
v_exp_f32 v242,v242
v_mfma_f32_16x16x32_bf16 v[220:223],a[148:151],a[52:55],v[220:223]
ds_read_b64_tr_b16 a[124:125],v9 offset:2056
v_accvgpr_read_b32 v87,a215
v_mfma_f32_16x16x32_bf16 v[220:223],a[144:147],a[48:51],v[220:223]
s_waitcnt lgkmcnt(14)
ds_read_b64_tr_b16 a[126:127],v9 offset:3080
v_exp_f32 v243,v243
v_mul_f32 v84,v84,v17
v_mul_f32 v85,v85,v17
v_cvt_pk_bf16_f32 v153,v82,v83
v_accvgpr_read_b32 v88,a216
v_accvgpr_read_b32 v89,a217
v_mul_f32 v86,v86,v17
v_mfma_f32_16x16x32_bf16 a[224:227],a[240:243],v[160:163],0
s_add_u32 m0,s25,98304
v_mul_f32 v87,v87,v17
v_cvt_pk_bf16_f32 v154,v84,v85
v_mfma_f32_16x16x32_bf16 a[224:227],a[240:243],v[164:167],a[224:227]
buffer_load_dwordx4 v1,s[12:15],s22 offen nt lds
v_accvgpr_read_b32 v90,a218
v_accvgpr_read_b32 v91,a219
v_cvt_pk_bf16_f32 v241,v242,v243
v_mul_f32 v88,v88,v17
v_mul_f32 v89,v89,v17
v_cvt_pk_bf16_f32 v155,v86,v87
v_fma_f32 v248,v248,s26,-v21
v_fma_f32 v249,v249,s26,-v21
v_mfma_f32_16x16x32_bf16 a[228:231],a[240:243],v[168:171],0
s_waitcnt lgkmcnt(14)
ds_read_b64_tr_b16 a[128:129],v6 offset:0
v_accvgpr_read_b32 v92,a220
v_mfma_f32_16x16x32_bf16 a[228:231],a[240:243],v[172:175],a[228:231]
s_waitcnt lgkmcnt(14)
ds_read_b64_tr_b16 a[130:131],v6 offset:1024
v_exp_f32 v248,v248
v_exp_f32 v249,v249
v_accvgpr_read_b32 v93,a221
v_mul_f32 v90,v90,v17
v_mul_f32 v91,v91,v17
v_cvt_pk_bf16_f32 v156,v88,v89
v_mfma_f32_16x16x32_bf16 a[232:235],a[240:243],v[176:179],0
v_accvgpr_read_b32 v94,a222
v_accvgpr_read_b32 v95,a223
v_mfma_f32_16x16x32_bf16 a[232:235],a[240:243],v[180:183],a[232:235]
s_waitcnt lgkmcnt(14)
v_mul_f32 v92,v92,v17
v_mul_f32 v93,v93,v17
v_cvt_pk_bf16_f32 v157,v90,v91
v_cvt_pk_bf16_f32 v248,v248,v249
v_mul_f32 v94,v94,v17
v_mul_f32 v95,v95,v17
v_fma_f32 v250,v250,s26,-v21
v_fma_f32 v251,v251,s26,-v21
v_fma_f32 v236,v236,s26,-v19
v_mfma_f32_16x16x32_bf16 a[236:239],a[240:243],v[184:187],0
ds_read_b64_tr_b16 a[132:133],v6 offset:2048
v_cvt_pk_bf16_f32 v158,v92,v93
v_mfma_f32_16x16x32_bf16 a[236:239],a[240:243],v[188:191],a[236:239]
s_waitcnt lgkmcnt(14)
ds_read_b64_tr_b16 a[134:135],v6 offset:3072
v_cvt_pk_bf16_f32 v159,v94,v95
v_exp_f32 v250,v250
v_exp_f32 v251,v251
v_exp_f32 v236,v236
v_fma_f32 v237,v237,s26,-v19
v_fma_f32 v238,v238,s26,-v19
v_mfma_f32_16x16x32_bf16 a[208:211],a[96:99],v[184:187],0
v_exp_f32 v237,v237
v_mfma_f32_16x16x32_bf16 a[208:211],a[100:103],v[188:191],a[208:211]
s_waitcnt lgkmcnt(14)
ds_read_b64_tr_b16 a[136:137],v6 offset:8
v_exp_f32 v238,v238
v_cvt_pk_bf16_f32 v249,v250,v251
v_cvt_pk_bf16_f32 v234,v236,v237
v_fma_f32 v239,v239,s26,-v19
v_fma_f32 v244,v244,s26,-v20
v_fma_f32 v245,v245,s26,-v20
v_fma_f32 v246,v246,s26,-v20
v_mfma_f32_16x16x32_bf16 a[192:195],a[100:103],v[180:183],0
s_waitcnt lgkmcnt(14)
ds_read_b64_tr_b16 a[138:139],v6 offset:1032
v_fma_f32 v247,v247,s26,-v20
v_mfma_f32_16x16x32_bf16 a[192:195],a[96:99],v[176:179],a[192:195]
buffer_load_dwordx4 v1,s[12:15],s22 offen offset:1024 nt lds
v_exp_f32 v239,v239
v_exp_f32 v244,v244
v_exp_f32 v245,v245
v_fma_f32 v252,v252,s26,-v21
v_mfma_f32_16x16x32_bf16 a[176:179],a[96:99],v[168:171],0
v_exp_f32 v246,v246
v_mfma_f32_16x16x32_bf16 a[176:179],a[100:103],v[172:175],a[176:179]
s_waitcnt lgkmcnt(14)
ds_read_b64_tr_b16 a[140:141],v6 offset:2056
v_cvt_pk_bf16_f32 v235,v238,v239
v_exp_f32 v247,v247
v_exp_f32 v252,v252
v_cvt_pk_bf16_f32 v242,v244,v245
v_fma_f32 v253,v253,s26,-v21
v_fma_f32 v254,v254,s26,-v21
v_fma_f32 v255,v255,s26,-v21
v_mfma_f32_16x16x32_bf16 a[160:163],a[100:103],v[164:167],0
s_waitcnt lgkmcnt(14)
ds_read_b64_tr_b16 a[142:143],v6 offset:3080
v_cvt_pk_bf16_f32 v243,v246,v247
v_mfma_f32_16x16x32_bf16 a[160:163],a[96:99],v[160:163],a[160:163]
v_exp_f32 v253,v253
v_exp_f32 v254,v254
v_exp_f32 v255,v255
v_mfma_f32_16x16x32_bf16 a[164:167],a[104:107],v[160:163],0
v_cvt_pk_bf16_f32 v250,v252,v253
v_cvt_pk_bf16_f32 v251,v254,v255
v_mfma_f32_16x16x32_bf16 a[164:167],a[108:111],v[164:167],a[164:167]
s_waitcnt lgkmcnt(14)
ds_read_b64_tr_b16 a[144:145],v7 offset:0
v_mfma_f32_16x16x32_bf16 a[180:183],a[108:111],v[172:175],0
s_waitcnt lgkmcnt(14)
ds_read_b64_tr_b16 a[146:147],v7 offset:1024
v_mfma_f32_16x16x32_bf16 a[180:183],a[104:107],v[168:171],a[180:183]
buffer_load_dwordx4 v1,s[12:15],s22 offen offset:2048 nt lds
v_mfma_f32_16x16x32_bf16 a[196:199],a[104:107],v[176:179],0
s_waitcnt lgkmcnt(14)
ds_read_b64_tr_b16 a[148:149],v7 offset:2048
v_mfma_f32_16x16x32_bf16 a[196:199],a[108:111],v[180:183],a[196:199]
s_waitcnt lgkmcnt(14)
ds_read_b64_tr_b16 a[150:151],v7 offset:3072
v_mfma_f32_16x16x32_bf16 a[212:215],a[108:111],v[188:191],0
v_mfma_f32_16x16x32_bf16 a[212:215],a[104:107],v[184:187],a[212:215]
v_mfma_f32_16x16x32_bf16 a[216:219],a[112:115],v[184:187],0
s_waitcnt lgkmcnt(14)
ds_read_b64_tr_b16 a[152:153],v7 offset:8
v_mfma_f32_16x16x32_bf16 a[216:219],a[116:119],v[188:191],a[216:219]
s_waitcnt lgkmcnt(14)
ds_read_b64_tr_b16 a[154:155],v7 offset:1032
v_mfma_f32_16x16x32_bf16 a[200:203],a[116:119],v[180:183],0
v_mfma_f32_16x16x32_bf16 a[200:203],a[112:115],v[176:179],a[200:203]
s_waitcnt lgkmcnt(14)
ds_read_b64_tr_b16 a[156:157],v7 offset:2056
v_mfma_f32_16x16x32_bf16 a[184:187],a[112:115],v[168:171],0
s_waitcnt lgkmcnt(14)
ds_read_b64_tr_b16 a[158:159],v7 offset:3080
v_mfma_f32_16x16x32_bf16 a[184:187],a[116:119],v[172:175],a[184:187]
buffer_load_dwordx4 v1,s[12:15],s22 offen offset:3072 nt lds
v_mfma_f32_16x16x32_bf16 a[168:171],a[116:119],v[164:167],0
s_add_u32 s22,s22,16384
v_mfma_f32_16x16x32_bf16 a[168:171],a[112:115],v[160:163],a[168:171]
v_mfma_f32_16x16x32_bf16 a[172:175],a[120:123],v[160:163],0
s_add_u32 m0,s25,131072
v_mfma_f32_16x16x32_bf16 a[172:175],a[124:127],v[164:167],a[172:175]
buffer_load_dwordx4 v1,s[4:7],s23 offen nt lds
v_mfma_f32_16x16x32_bf16 a[188:191],a[124:127],v[172:175],0
v_mfma_f32_16x16x32_bf16 a[188:191],a[120:123],v[168:171],a[188:191]
s_xor_b32 s24,s24,0xffff0000
buffer_load_dwordx4 v1,s[4:7],s23 offen offset:1024 nt lds
v_mfma_f32_16x16x32_bf16 a[204:207],a[120:123],v[176:179],0
v_fma_f32 v192,v192,s26,-v18
v_mfma_f32_16x16x32_bf16 a[204:207],a[124:127],v[180:183],a[204:207]
buffer_load_dwordx4 v1,s[4:7],s23 offen offset:2048 nt lds
v_exp_f32 v192,v192
v_mfma_f32_16x16x32_bf16 a[220:223],a[124:127],v[188:191],0
v_fma_f32 v193,v193,s26,-v18
v_mfma_f32_16x16x32_bf16 a[220:223],a[120:123],v[184:187],a[220:223]
s_waitcnt lgkmcnt(12)
v_exp_f32 v193,v193
v_fma_f32 v194,v194,s26,-v18
v_mfma_f32_16x16x32_bf16 v[80:83],a[128:131],v[184:187],0
v_cvt_pk_bf16_f32 v228,v192,v193
v_mfma_f32_16x16x32_bf16 v[80:83],a[132:135],v[188:191],v[80:83]
buffer_load_dwordx4 v1,s[4:7],s23 offen offset:3072 nt lds
v_exp_f32 v194,v194
v_mfma_f32_16x16x32_bf16 v[64:67],a[132:135],v[180:183],0
s_add_u32 s23,s23,16384
v_fma_f32 v195,v195,s26,-v18
v_mfma_f32_16x16x32_bf16 v[64:67],a[128:131],v[176:179],v[64:67]
s_waitcnt vmcnt(16)
s_waitcnt lgkmcnt(0)
s_barrier
s_branch L_h1_0
L_x1_0:
ds_read_b128 a[96:99],v2 offset:0
v_fma_f32 v195,v195,s26,-v18
v_accvgpr_mov_b32 a20,a84
v_mfma_f32_16x16x32_bf16 a[176:179],a[128:131],v[168:171],a[176:179]
v_exp_f32 v195,v195
v_mfma_f32_16x16x32_bf16 a[176:179],a[132:135],v[172:175],a[176:179]
ds_read_b128 a[48:51],v10 offset:0
v_accvgpr_mov_b32 a21,a85
v_cvt_pk_bf16_f32 v229,v194,v195
v_mfma_f32_16x16x32_bf16 a[160:163],a[132:135],v[164:167],a[160:163]
v_fma_f32 v196,v196,s26,-v18
v_fma_f32 v197,v197,s26,-v18
v_mfma_f32_16x16x32_bf16 a[160:163],a[128:131],v[160:163],a[160:163]
ds_read_b128 a[100:103],v3 offset:0
v_exp_f32 v196,v196
v_mfma_f32_16x16x32_bf16 a[164:167],a[136:139],v[160:163],a[164:167]
v_exp_f32 v197,v197
v_mfma_f32_16x16x32_bf16 a[164:167],a[140:143],v[164:167],a[164:167]
ds_read_b128 a[52:55],v11 offset:0
v_accvgpr_mov_b32 a22,a86
v_accvgpr_mov_b32 a23,a87
v_mfma_f32_16x16x32_bf16 a[180:183],a[140:143],v[172:175],a[180:183]
s_add_u32 s30,s24,49152
s_add_u32 s32,s24,53248
ds_read_b128 a[104:107],v4 offset:0
v_mfma_f32_16x16x32_bf16 a[180:183],a[136:139],v[168:171],a[180:183]
buffer_store_dwordx4 v[144:147],v22,s[16:19],s30 offen sc0 sc1
buffer_store_dwordx4 v[148:151],v22,s[16:19],s32 offen sc0 sc1
v_cvt_pk_bf16_f32 v230,v196,v197
v_fma_f32 v198,v198,s26,-v18
v_mfma_f32_16x16x32_bf16 a[196:199],a[136:139],v[176:179],a[196:199]
v_exp_f32 v198,v198
v_mfma_f32_16x16x32_bf16 a[196:199],a[140:143],v[180:183],a[196:199]
ds_read_b128 a[56:59],v12 offset:0
v_fma_f32 v199,v199,s26,-v18
v_accvgpr_mov_b32 a24,a88
v_mfma_f32_16x16x32_bf16 a[212:215],a[140:143],v[188:191],a[212:215]
ds_read_b128 a[108:111],v5 offset:0
v_accvgpr_mov_b32 a25,a89
v_mfma_f32_16x16x32_bf16 a[212:215],a[136:139],v[184:187],a[212:215]
v_exp_f32 v199,v199
v_fma_f32 v200,v200,s26,-v19
v_mfma_f32_16x16x32_bf16 a[216:219],a[144:147],v[184:187],a[216:219]
v_exp_f32 v200,v200
v_mfma_f32_16x16x32_bf16 a[216:219],a[148:151],v[188:191],a[216:219]
ds_read_b128 a[60:63],v13 offset:0
v_cvt_pk_bf16_f32 v231,v198,v199
v_fma_f32 v201,v201,s26,-v19
v_mfma_f32_16x16x32_bf16 a[200:203],a[148:151],v[180:183],a[200:203]
ds_read_b128 a[112:115],v2 offset:1024
v_accvgpr_mov_b32 a26,a90
v_mfma_f32_16x16x32_bf16 a[200:203],a[144:147],v[176:179],a[200:203]
v_exp_f32 v201,v201
v_accvgpr_mov_b32 a27,a91
v_mfma_f32_16x16x32_bf16 a[184:187],a[144:147],v[168:171],a[184:187]
v_cvt_pk_bf16_f32 v236,v200,v201
v_fma_f32 v202,v202,s26,-v19
v_mfma_f32_16x16x32_bf16 a[184:187],a[148:151],v[172:175],a[184:187]
ds_read_b128 a[116:119],v3 offset:1024
v_exp_f32 v202,v202
v_mfma_f32_16x16x32_bf16 a[168:171],a[148:151],v[164:167],a[168:171]
v_fma_f32 v203,v203,s26,-v19
v_accvgpr_mov_b32 a28,a92
v_mfma_f32_16x16x32_bf16 a[168:171],a[144:147],v[160:163],a[168:171]
v_exp_f32 v203,v203
v_accvgpr_mov_b32 a29,a93
v_fma_f32 v204,v204,s26,-v19
v_mfma_f32_16x16x32_bf16 a[172:175],a[152:155],v[160:163],a[172:175]
v_exp_f32 v204,v204
v_mfma_f32_16x16x32_bf16 a[172:175],a[156:159],v[164:167],a[172:175]
ds_read_b128 a[120:123],v4 offset:1024
v_cvt_pk_bf16_f32 v237,v202,v203
v_fma_f32 v205,v205,s26,-v19
v_mfma_f32_16x16x32_bf16 a[188:191],a[156:159],v[172:175],a[188:191]
s_add_u32 s30,s24,57344
s_add_u32 s32,s24,61440
v_accvgpr_mov_b32 a30,a94
v_mfma_f32_16x16x32_bf16 a[188:191],a[152:155],v[168:171],a[188:191]
buffer_store_dwordx4 v[152:155],v22,s[16:19],s30 offen sc0 sc1
buffer_store_dwordx4 v[156:159],v22,s[16:19],s32 offen sc0 sc1
v_accvgpr_mov_b32 a31,a95
v_mfma_f32_16x16x32_bf16 a[204:207],a[152:155],v[176:179],a[204:207]
v_exp_f32 v205,v205
v_mfma_f32_16x16x32_bf16 a[204:207],a[156:159],v[180:183],a[204:207]
ds_read_b128 a[124:127],v5 offset:1024
v_cvt_pk_bf16_f32 v238,v204,v205
v_fma_f32 v206,v206,s26,-v19
v_mfma_f32_16x16x32_bf16 a[220:223],a[156:159],v[188:191],a[220:223]
v_exp_f32 v206,v206
v_mfma_f32_16x16x32_bf16 a[220:223],a[152:155],v[184:187],a[220:223]
s_waitcnt lgkmcnt(5)
v_fma_f32 v207,v207,s26,-v19
v_fma_f32 v208,v208,s26,-v20
v_fma_f32 v209,v209,s26,-v20
v_mfma_f32_16x16x32_bf16 v[160:163],a[96:99],a[0:3],0
ds_read_b128 a[128:131],v2 offset:2048
v_fma_f32 v210,v210,s26,-v20
v_mfma_f32_16x16x32_bf16 v[160:163],a[100:103],a[4:7],v[160:163]
v_exp_f32 v207,v207
v_mfma_f32_16x16x32_bf16 v[160:163],a[104:107],a[8:11],v[160:163]
v_exp_f32 v208,v208
v_mfma_f32_16x16x32_bf16 v[160:163],a[108:111],a[12:15],v[160:163]
v_exp_f32 v209,v209
v_exp_f32 v210,v210
v_mfma_f32_16x16x32_bf16 v[168:171],a[108:111],a[28:31],0
ds_read_b128 a[132:135],v3 offset:2048
v_cvt_pk_bf16_f32 v239,v206,v207
v_mfma_f32_16x16x32_bf16 v[168:171],a[104:107],a[24:27],v[168:171]
v_cvt_pk_bf16_f32 v244,v208,v209
v_fma_f32 v211,v211,s26,-v20
v_mfma_f32_16x16x32_bf16 v[168:171],a[100:103],a[20:23],v[168:171]
v_exp_f32 v211,v211
v_mfma_f32_16x16x32_bf16 v[168:171],a[96:99],a[16:19],v[168:171]
v_cvt_pk_bf16_f32 v245,v210,v211
v_fma_f32 v212,v212,s26,-v20
v_fma_f32 v213,v213,s26,-v20
v_mfma_f32_16x16x32_bf16 v[176:179],a[96:99],a[32:35],0
ds_read_b128 a[136:139],v4 offset:2048
v_fma_f32 v214,v214,s26,-v20
v_mfma_f32_16x16x32_bf16 v[176:179],a[100:103],a[36:39],v[176:179]
v_exp_f32 v212,v212
v_mfma_f32_16x16x32_bf16 v[176:179],a[104:107],a[40:43],v[176:179]
v_exp_f32 v213,v213
v_mfma_f32_16x16x32_bf16 v[176:179],a[108:111],a[44:47],v[176:179]
ds_read_b128 a[140:143],v5 offset:2048
v_exp_f32 v214,v214
s_waitcnt lgkmcnt(8)
v_mfma_f32_16x16x32_bf16 v[184:187],a[108:111],a[60:63],0
v_cvt_pk_bf16_f32 v246,v212,v213
v_fma_f32 v215,v215,s26,-v20
v_mfma_f32_16x16x32_bf16 v[184:187],a[104:107],a[56:59],v[184:187]
v_exp_f32 v215,v215
v_mfma_f32_16x16x32_bf16 v[184:187],a[100:103],a[52:55],v[184:187]
s_waitcnt lgkmcnt(4)
v_cvt_pk_bf16_f32 v247,v214,v215
v_fma_f32 v216,v216,s26,-v21
v_mfma_f32_16x16x32_bf16 v[184:187],a[96:99],a[48:51],v[184:187]
ds_read_b128 a[144:147],v2 offset:3072
v_exp_f32 v216,v216
v_mfma_f32_16x16x32_bf16 v[164:167],a[112:115],a[0:3],0
v_fma_f32 v217,v217,s26,-v21
v_fma_f32 v218,v218,s26,-v21
v_mfma_f32_16x16x32_bf16 v[164:167],a[116:119],a[4:7],v[164:167]
v_exp_f32 v217,v217
v_mfma_f32_16x16x32_bf16 v[164:167],a[120:123],a[8:11],v[164:167]
v_exp_f32 v218,v218
v_mfma_f32_16x16x32_bf16 v[164:167],a[124:127],a[12:15],v[164:167]
ds_read_b128 a[148:151],v3 offset:3072
v_cvt_pk_bf16_f32 v252,v216,v217
v_fma_f32 v219,v219,s26,-v21
v_mfma_f32_16x16x32_bf16 v[172:175],a[124:127],a[28:31],0
v_exp_f32 v219,v219
v_mfma_f32_16x16x32_bf16 v[172:175],a[120:123],a[24:27],v[172:175]
v_cvt_pk_bf16_f32 v253,v218,v219
v_fma_f32 v220,v220,s26,-v21
v_mfma_f32_16x16x32_bf16 v[172:175],a[116:119],a[20:23],v[172:175]
ds_read_b128 a[152:155],v4 offset:3072
v_fma_f32 v221,v221,s26,-v21
v_mfma_f32_16x16x32_bf16 v[172:175],a[112:115],a[16:19],v[172:175]
v_exp_f32 v220,v220
v_exp_f32 v221,v221
v_mfma_f32_16x16x32_bf16 v[180:183],a[112:115],a[32:35],0
v_cvt_pk_bf16_f32 v254,v220,v221
v_fma_f32 v222,v222,s26,-v21
v_mfma_f32_16x16x32_bf16 v[180:183],a[116:119],a[36:39],v[180:183]
v_exp_f32 v222,v222
v_mfma_f32_16x16x32_bf16 v[180:183],a[120:123],a[40:43],v[180:183]
s_add_u32 m0,s25,32768
ds_read_b128 a[156:159],v5 offset:3072
v_mfma_f32_16x16x32_bf16 v[180:183],a[124:127],a[44:47],v[180:183]
buffer_load_dwordx4 v1,s[8:11],s21 offen nt lds
v_fma_f32 v223,v223,s26,-v21
v_mfma_f32_16x16x32_bf16 v[188:191],a[124:127],a[60:63],0
v_exp_f32 v223,v223
v_mfma_f32_16x16x32_bf16 v[188:191],a[120:123],a[56:59],v[188:191]
v_cvt_pk_bf16_f32 v255,v222,v223
v_mfma_f32_16x16x32_bf16 v[188:191],a[116:119],a[52:55],v[188:191]
v_mfma_f32_16x16x32_bf16 v[188:191],a[112:115],a[48:51],v[188:191]
s_waitcnt lgkmcnt(4)
v_mfma_f32_16x16x32_bf16 v[192:195],a[128:131],a[0:3],0
ds_write_b128 v10,v[128:131] offset:16384
v_accvgpr_write_b32 a64,v96
v_mfma_f32_16x16x32_bf16 v[192:195],a[132:135],a[4:7],v[192:195]
v_accvgpr_write_b32 a65,v97
v_accvgpr_write_b32 a66,v98
v_mfma_f32_16x16x32_bf16 v[192:195],a[136:139],a[8:11],v[192:195]
v_accvgpr_write_b32 a67,v99
v_accvgpr_write_b32 a68,v100
v_mfma_f32_16x16x32_bf16 v[192:195],a[140:143],a[12:15],v[192:195]
buffer_load_dwordx4 v1,s[8:11],s21 offen offset:1024 nt lds
v_max3_f32 v23,v160,v161,v162
v_max3_f32 v24,v168,v169,v170
v_max3_f32 v25,v176,v177,v178
v_max3_f32 v26,v184,v185,v186
v_accvgpr_write_b32 a69,v101
v_mfma_f32_16x16x32_bf16 v[200:203],a[140:143],a[28:31],0
ds_write_b128 v11,v[132:135] offset:16384
v_max3_f32 v23,v23,v163,v164
v_mfma_f32_16x16x32_bf16 v[200:203],a[136:139],a[24:27],v[200:203]
ds_read_b64_tr_b16 a[96:97],v6 offset:49152
v_max3_f32 v24,v24,v171,v172
v_mfma_f32_16x16x32_bf16 v[200:203],a[132:135],a[20:23],v[200:203]
ds_read_b64_tr_b16 a[98:99],v6 offset:50176
v_max3_f32 v25,v25,v179,v180
v_mfma_f32_16x16x32_bf16 v[200:203],a[128:131],a[16:19],v[200:203]
buffer_load_dwordx4 v1,s[8:11],s21 offen offset:2048 nt lds
v_max3_f32 v26,v26,v187,v188
v_max3_f32 v23,v23,v165,v166
v_max3_f32 v24,v24,v173,v174
v_max3_f32 v25,v25,v181,v182
v_accvgpr_write_b32 a70,v102
v_mfma_f32_16x16x32_bf16 v[208:211],a[128:131],a[32:35],0
ds_read_b64_tr_b16 a[100:101],v6 offset:51200
v_max3_f32 v26,v26,v189,v190
v_mfma_f32_16x16x32_bf16 v[208:211],a[132:135],a[36:39],v[208:211]
ds_read_b64_tr_b16 a[102:103],v6 offset:52224
v_max_f32 v23,v23,v167
v_mfma_f32_16x16x32_bf16 v[208:211],a[136:139],a[40:43],v[208:211]
ds_write_b128 v12,v[136:139] offset:16384
v_max_f32 v24,v24,v175
v_mfma_f32_16x16x32_bf16 v[208:211],a[140:143],a[44:47],v[208:211]
buffer_load_dwordx4 v1,s[8:11],s21 offen offset:3072 nt lds
v_max_f32 v25,v25,v183
v_max_f32 v26,v26,v191
v_mov_b32 v27,v23
v_mov_b32 v28,v24
v_accvgpr_write_b32 a71,v103
v_mfma_f32_16x16x32_bf16 v[216:219],a[140:143],a[60:63],0
s_add_u32 s21,s21,16384
ds_read_b64_tr_b16 a[104:105],v6 offset:49160
v_mfma_f32_16x16x32_bf16 v[216:219],a[136:139],a[56:59],v[216:219]
ds_read_b64_tr_b16 a[106:107],v6 offset:50184
v_mov_b32 v29,v25
v_mfma_f32_16x16x32_bf16 v[216:219],a[132:135],a[52:55],v[216:219]
ds_write_b128 v13,v[140:143] offset:16384
v_mov_b32 v30,v26
v_mfma_f32_16x16x32_bf16 v[216:219],a[128:131],a[48:51],v[216:219]
s_waitcnt lgkmcnt(10)
v_permlane16_swap_b32 v23,v27
v_permlane16_swap_b32 v24,v28
v_permlane16_swap_b32 v25,v29
v_permlane16_swap_b32 v26,v30
v_accvgpr_write_b32 a72,v104
v_accvgpr_write_b32 a73,v105
v_accvgpr_write_b32 a74,v106
v_mfma_f32_16x16x32_bf16 v[196:199],a[144:147],a[0:3],0
ds_read_b64_tr_b16 a[108:109],v6 offset:51208
v_max_f32 v23,v23,v27
v_mfma_f32_16x16x32_bf16 v[196:199],a[148:151],a[4:7],v[196:199]
ds_read_b64_tr_b16 a[110:111],v6 offset:52232
v_max_f32 v24,v24,v28
v_mfma_f32_16x16x32_bf16 v[196:199],a[152:155],a[8:11],v[196:199]
ds_write_b128 v10,v[144:147] offset:0
v_max_f32 v25,v25,v29
v_mfma_f32_16x16x32_bf16 v[196:199],a[156:159],a[12:15],v[196:199]
ds_read_b64_tr_b16 a[112:113],v7 offset:49152
v_max_f32 v26,v26,v30
v_mov_b32 v27,v23
v_mov_b32 v28,v24
v_mov_b32 v29,v25
v_accvgpr_write_b32 a75,v107
v_accvgpr_write_b32 a76,v108
v_mfma_f32_16x16x32_bf16 v[204:207],a[156:159],a[28:31],0
ds_read_b64_tr_b16 a[114:115],v7 offset:50176
v_mov_b32 v30,v26
v_mfma_f32_16x16x32_bf16 v[204:207],a[152:155],a[24:27],v[204:207]
s_waitcnt lgkmcnt(14)
ds_write_b128 v11,v[148:151] offset:0
v_permlane32_swap_b32 v23,v27
v_mfma_f32_16x16x32_bf16 v[204:207],a[148:151],a[20:23],v[204:207]
v_permlane32_swap_b32 v24,v28
v_permlane32_swap_b32 v25,v29
v_mfma_f32_16x16x32_bf16 v[204:207],a[144:147],a[16:19],v[204:207]
s_waitcnt lgkmcnt(14)
ds_read_b64_tr_b16 a[116:117],v7 offset:51200
v_permlane32_swap_b32 v26,v30
v_max_f32 v23,v23,v27
v_max_f32 v24,v24,v28
v_max_f32 v25,v25,v29
v_accvgpr_write_b32 a77,v109
v_accvgpr_write_b32 a78,v110
v_mfma_f32_16x16x32_bf16 v[212:215],a[144:147],a[32:35],0
s_waitcnt lgkmcnt(14)
ds_read_b64_tr_b16 a[118:119],v7 offset:52224
v_max_f32 v26,v26,v30
v_mfma_f32_16x16x32_bf16 v[212:215],a[148:151],a[36:39],v[212:215]
s_waitcnt lgkmcnt(14)
ds_write_b128 v12,v[152:155] offset:0
v_mul_f32 v18,s26,v23
v_mfma_f32_16x16x32_bf16 v[212:215],a[152:155],a[40:43],v[212:215]
v_mul_f32 v19,s26,v24
v_mul_f32 v20,s26,v25
v_mfma_f32_16x16x32_bf16 v[212:215],a[156:159],a[44:47],v[212:215]
s_waitcnt lgkmcnt(14)
ds_read_b64_tr_b16 a[120:121],v7 offset:49160
v_mul_f32 v21,s26,v26
v_accvgpr_write_b32 a79,v111
v_accvgpr_write_b32 a80,v112
v_accvgpr_write_b32 a81,v113
v_accvgpr_write_b32 a82,v114
v_accvgpr_write_b32 a83,v115
v_accvgpr_write_b32 a84,v116
v_mfma_f32_16x16x32_bf16 v[220:223],a[156:159],a[60:63],0
s_waitcnt lgkmcnt(14)
ds_read_b64_tr_b16 a[122:123],v7 offset:50184
v_fma_f32 v160,v160,s26,-v18
v_mfma_f32_16x16x32_bf16 v[220:223],a[152:155],a[56:59],v[220:223]
s_waitcnt lgkmcnt(14)
ds_write_b128 v13,v[156:159] offset:0
v_fma_f32 v161,v161,s26,-v18
v_mfma_f32_16x16x32_bf16 v[220:223],a[148:151],a[52:55],v[220:223]
s_waitcnt lgkmcnt(14)
ds_read_b64_tr_b16 a[124:125],v7 offset:51208
v_fma_f32 v162,v162,s26,-v18
v_mfma_f32_16x16x32_bf16 v[220:223],a[144:147],a[48:51],v[220:223]
s_waitcnt lgkmcnt(14)
ds_read_b64_tr_b16 a[126:127],v7 offset:52232
v_exp_f32 v160,v160
v_exp_f32 v161,v161
v_exp_f32 v162,v162
v_mfma_f32_16x16x32_bf16 a[224:227],a[240:243],v[224:227],a[224:227]
s_add_u32 m0,s25,81920
v_fma_f32 v163,v163,s26,-v18
v_cvt_pk_bf16_f32 v160,v160,v161
v_mfma_f32_16x16x32_bf16 a[224:227],a[240:243],v[228:231],a[224:227]
buffer_load_dwordx4 v1,s[12:15],s22 offen nt lds
v_exp_f32 v163,v163
v_fma_f32 v164,v164,s26,-v18
v_fma_f32 v165,v165,s26,-v18
v_fma_f32 v166,v166,s26,-v18
v_mfma_f32_16x16x32_bf16 a[228:231],a[240:243],v[232:235],a[228:231]
s_waitcnt lgkmcnt(14)
ds_read_b64_tr_b16 a[128:129],v8 offset:49152
v_cvt_pk_bf16_f32 v161,v162,v163
v_mfma_f32_16x16x32_bf16 a[228:231],a[240:243],v[236:239],a[228:231]
s_waitcnt lgkmcnt(14)
ds_read_b64_tr_b16 a[130:131],v8 offset:50176
v_exp_f32 v164,v164
v_exp_f32 v165,v165
v_exp_f32 v166,v166
v_mfma_f32_16x16x32_bf16 a[232:235],a[240:243],v[240:243],a[232:235]
v_fma_f32 v167,v167,s26,-v18
v_cvt_pk_bf16_f32 v162,v164,v165
v_mfma_f32_16x16x32_bf16 a[232:235],a[240:243],v[244:247],a[232:235]
v_exp_f32 v167,v167
v_fma_f32 v168,v168,s26,-v19
v_fma_f32 v169,v169,s26,-v19
v_fma_f32 v170,v170,s26,-v19
v_fma_f32 v171,v171,s26,-v19
v_fma_f32 v172,v172,s26,-v19
v_mfma_f32_16x16x32_bf16 a[236:239],a[240:243],v[248:251],a[236:239]
s_waitcnt lgkmcnt(14)
ds_read_b64_tr_b16 a[132:133],v8 offset:51200
v_cvt_pk_bf16_f32 v163,v166,v167
v_mfma_f32_16x16x32_bf16 a[236:239],a[240:243],v[252:255],a[236:239]
s_waitcnt lgkmcnt(14)
ds_read_b64_tr_b16 a[134:135],v8 offset:52224
v_exp_f32 v168,v168
v_exp_f32 v169,v169
v_exp_f32 v170,v170
v_mfma_f32_16x16x32_bf16 v[80:83],a[96:99],v[248:251],v[80:83]
v_exp_f32 v171,v171
v_mfma_f32_16x16x32_bf16 v[80:83],a[100:103],v[252:255],v[80:83]
s_waitcnt lgkmcnt(14)
ds_read_b64_tr_b16 a[136:137],v8 offset:49160
v_exp_f32 v172,v172
v_cvt_pk_bf16_f32 v168,v168,v169
v_fma_f32 v173,v173,s26,-v19
v_cvt_pk_bf16_f32 v169,v170,v171
v_fma_f32 v174,v174,s26,-v19
v_mfma_f32_16x16x32_bf16 v[64:67],a[100:103],v[244:247],v[64:67]
s_waitcnt lgkmcnt(14)
ds_read_b64_tr_b16 a[138:139],v8 offset:50184
v_accvgpr_read_b32 v14,a224
v_mfma_f32_16x16x32_bf16 v[64:67],a[96:99],v[240:243],v[64:67]
buffer_load_dwordx4 v1,s[12:15],s22 offen offset:1024 nt lds
v_exp_f32 v173,v173
v_fma_f32 v175,v175,s26,-v19
v_exp_f32 v174,v174
v_mfma_f32_16x16x32_bf16 v[48:51],a[96:99],v[232:235],v[48:51]
v_exp_f32 v175,v175
v_mfma_f32_16x16x32_bf16 v[48:51],a[100:103],v[236:239],v[48:51]
s_waitcnt lgkmcnt(14)
ds_read_b64_tr_b16 a[140:141],v8 offset:51208
v_accvgpr_read_b32 v15,a228
v_cvt_pk_bf16_f32 v170,v172,v173
v_fma_f32 v176,v176,s26,-v20
v_fma_f32 v177,v177,s26,-v20
v_cvt_pk_bf16_f32 v171,v174,v175
v_accvgpr_write_b32 a85,v117
v_mfma_f32_16x16x32_bf16 v[32:35],a[100:103],v[228:231],v[32:35]
s_waitcnt lgkmcnt(14)
ds_read_b64_tr_b16 a[142:143],v8 offset:52232
v_accvgpr_read_b32 v16,a232
v_mfma_f32_16x16x32_bf16 v[32:35],a[96:99],v[224:227],v[32:35]
v_accvgpr_read_b32 v17,a236
v_exp_f32 v176,v176
v_exp_f32 v177,v177
v_fma_f32 v178,v178,s26,-v20
v_fma_f32 v179,v179,s26,-v20
v_mfma_f32_16x16x32_bf16 v[36:39],a[104:107],v[224:227],v[36:39]
v_exp_f32 v178,v178
v_mfma_f32_16x16x32_bf16 v[36:39],a[108:111],v[228:231],v[36:39]
s_waitcnt lgkmcnt(14)
ds_read_b64_tr_b16 a[144:145],v9 offset:49152
v_exp_f32 v179,v179
v_add_f32 v31,v14,v15
v_cvt_pk_bf16_f32 v176,v176,v177
v_accvgpr_write_b32 a86,v118
v_fma_f32 v180,v180,s26,-v20
v_mfma_f32_16x16x32_bf16 v[52:55],a[108:111],v[236:239],v[52:55]
s_waitcnt lgkmcnt(14)
ds_read_b64_tr_b16 a[146:147],v9 offset:50176
v_add_f32 v31,v31,v16
v_mfma_f32_16x16x32_bf16 v[52:55],a[104:107],v[232:235],v[52:55]
buffer_load_dwordx4 v1,s[12:15],s22 offen offset:2048 nt lds
v_fma_f32 v181,v181,s26,-v20
v_exp_f32 v180,v180
v_accvgpr_write_b32 a87,v119
v_cvt_pk_bf16_f32 v177,v178,v179
v_mfma_f32_16x16x32_bf16 v[68:71],a[104:107],v[240:243],v[68:71]
s_waitcnt lgkmcnt(14)
ds_read_b64_tr_b16 a[148:149],v9 offset:51200
v_add_f32 v31,v31,v17
v_mfma_f32_16x16x32_bf16 v[68:71],a[108:111],v[244:247],v[68:71]
s_waitcnt lgkmcnt(14)
ds_read_b64_tr_b16 a[150:151],v9 offset:52224
v_exp_f32 v181,v181
v_accvgpr_write_b32 a88,v120
v_cmp_nge_f32 vcc,s27,v31
v_fma_f32 v182,v182,s26,-v20
v_fma_f32 v183,v183,s26,-v20
v_mfma_f32_16x16x32_bf16 v[84:87],a[108:111],v[252:255],v[84:87]
v_rcp_f32 v14,v14
v_mfma_f32_16x16x32_bf16 v[84:87],a[104:107],v[248:251],v[84:87]
v_exp_f32 v182,v182
v_exp_f32 v183,v183
v_rcp_f32 v15,v15
v_cvt_pk_bf16_f32 v178,v180,v181
v_accvgpr_write_b32 a89,v121
v_mfma_f32_16x16x32_bf16 v[88:91],a[112:115],v[248:251],v[88:91]
s_waitcnt lgkmcnt(14)
ds_read_b64_tr_b16 a[152:153],v9 offset:49160
v_fma_f32 v184,v184,s26,-v21
v_mfma_f32_16x16x32_bf16 v[88:91],a[116:119],v[252:255],v[88:91]
s_waitcnt lgkmcnt(14)
ds_read_b64_tr_b16 a[154:155],v9 offset:50184
v_exp_f32 v184,v184
v_rcp_f32 v16,v16
v_fma_f32 v185,v185,s26,-v21
v_accvgpr_write_b32 a90,v122
v_mfma_f32_16x16x32_bf16 v[72:75],a[116:119],v[244:247],v[72:75]
v_exp_f32 v185,v185
v_mfma_f32_16x16x32_bf16 v[72:75],a[112:115],v[240:243],v[72:75]
s_waitcnt lgkmcnt(14)
ds_read_b64_tr_b16 a[156:157],v9 offset:51208
v_rcp_f32 v17,v17
v_cvt_pk_bf16_f32 v179,v182,v183
v_accvgpr_write_b32 a91,v123
v_fma_f32 v186,v186,s26,-v21
v_fma_f32 v187,v187,s26,-v21
v_mfma_f32_16x16x32_bf16 v[56:59],a[112:115],v[232:235],v[56:59]
s_waitcnt lgkmcnt(14)
ds_read_b64_tr_b16 a[158:159],v9 offset:52232
v_cvt_pk_bf16_f32 v184,v184,v185
v_mfma_f32_16x16x32_bf16 v[56:59],a[116:119],v[236:239],v[56:59]
buffer_load_dwordx4 v1,s[12:15],s22 offen offset:3072 nt lds
v_accvgpr_write_b32 a92,v124
v_exp_f32 v186,v186
v_exp_f32 v187,v187
v_mfma_f32_16x16x32_bf16 v[40:43],a[116:119],v[228:231],v[40:43]
s_add_u32 s22,s22,16384
s_cmp_lg_u64 vcc,0
s_cselect_b32 s32,s29,0
s_or_b32 s28,s28,s32
s_lshl_b32 s29,s29,1
v_mfma_f32_16x16x32_bf16 v[40:43],a[112:115],v[224:227],v[40:43]
v_fma_f32 v188,v188,s26,-v21
v_fma_f32 v189,v189,s26,-v21
v_accvgpr_write_b32 a93,v125
v_cvt_pk_bf16_f32 v185,v186,v187
v_accvgpr_write_b32 a94,v126
v_fma_f32 v190,v190,s26,-v21
v_fma_f32 v191,v191,s26,-v21
v_mfma_f32_16x16x32_bf16 v[44:47],a[120:123],v[224:227],v[44:47]
v_exp_f32 v188,v188
v_mfma_f32_16x16x32_bf16 v[44:47],a[124:127],v[228:231],v[44:47]
v_exp_f32 v189,v189
v_accvgpr_write_b32 a95,v127
v_exp_f32 v190,v190
v_exp_f32 v191,v191
v_mfma_f32_16x16x32_bf16 v[60:63],a[124:127],v[236:239],v[60:63]
v_cvt_pk_bf16_f32 v186,v188,v189
v_cvt_pk_bf16_f32 v187,v190,v191
v_mfma_f32_16x16x32_bf16 v[60:63],a[120:123],v[232:235],v[60:63]
v_mfma_f32_16x16x32_bf16 v[76:79],a[120:123],v[240:243],v[76:79]
v_fma_f32 v192,v192,s26,-v18
v_fma_f32 v193,v193,s26,-v18
v_mfma_f32_16x16x32_bf16 v[76:79],a[124:127],v[244:247],v[76:79]
v_exp_f32 v192,v192
v_exp_f32 v193,v193
v_fma_f32 v194,v194,s26,-v18
v_fma_f32 v195,v195,s26,-v18
v_mul_f32 v32,v32,v14
v_mul_f32 v33,v33,v14
v_mul_f32 v34,v34,v14
v_mul_f32 v35,v35,v14
v_mfma_f32_16x16x32_bf16 v[92:95],a[124:127],v[252:255],v[92:95]
v_exp_f32 v194,v194
v_mfma_f32_16x16x32_bf16 v[92:95],a[120:123],v[248:251],v[92:95]
s_waitcnt lgkmcnt(12)
v_cvt_pk_bf16_f32 v164,v192,v193
v_exp_f32 v195,v195
v_fma_f32 v200,v200,s26,-v19
v_fma_f32 v201,v201,s26,-v19
v_cvt_pk_bf16_f32 v96,v32,v33
v_mul_f32 v36,v36,v14
v_mul_f32 v37,v37,v14
v_cvt_pk_bf16_f32 v97,v34,v35
v_mfma_f32_16x16x32_bf16 a[208:211],a[128:131],v[248:251],a[208:211]
v_exp_f32 v200,v200
v_mfma_f32_16x16x32_bf16 a[208:211],a[132:135],v[252:255],a[208:211]
v_exp_f32 v201,v201
v_cvt_pk_bf16_f32 v165,v194,v195
v_mul_f32 v38,v38,v14
v_mul_f32 v39,v39,v14
v_cvt_pk_bf16_f32 v98,v36,v37
v_mul_f32 v40,v40,v14
v_mul_f32 v41,v41,v14
v_mul_f32 v42,v42,v14
v_mul_f32 v43,v43,v14
v_mfma_f32_16x16x32_bf16 a[192:195],a[132:135],v[244:247],a[192:195]
v_cvt_pk_bf16_f32 v99,v38,v39
v_cvt_pk_bf16_f32 v172,v200,v201
v_mfma_f32_16x16x32_bf16 a[192:195],a[128:131],v[240:243],a[192:195]
s_waitcnt vmcnt(12)
s_waitcnt lgkmcnt(0)
s_barrier
ds_read_b128 a[96:99],v2 offset:16384
v_cvt_pk_bf16_f32 v100,v40,v41
v_mul_f32 v44,v44,v14
v_mul_f32 v45,v45,v14
v_fma_f32 v202,v202,s26,-v19
v_fma_f32 v203,v203,s26,-v19
v_cvt_pk_bf16_f32 v101,v42,v43
v_mul_f32 v46,v46,v14
v_mul_f32 v47,v47,v14
v_mul_f32 v48,v48,v15
v_mfma_f32_16x16x32_bf16 a[176:179],a[128:131],v[232:235],a[176:179]
s_add_u32 m0,s25,49152
v_exp_f32 v202,v202
v_mfma_f32_16x16x32_bf16 a[176:179],a[132:135],v[236:239],a[176:179]
buffer_load_dwordx4 v1,s[8:11],s21 offen nt lds
v_cvt_pk_bf16_f32 v102,v44,v45
v_exp_f32 v203,v203
v_mul_f32 v49,v49,v15
v_cvt_pk_bf16_f32 v103,v46,v47
v_mul_f32 v50,v50,v15
v_mul_f32 v51,v51,v15
v_mfma_f32_16x16x32_bf16 a[160:163],a[132:135],v[228:231],a[160:163]
v_cvt_pk_bf16_f32 v173,v202,v203
v_cvt_pk_bf16_f32 v112,v48,v49
v_mfma_f32_16x16x32_bf16 a[160:163],a[128:131],v[224:227],a[160:163]
ds_read_b128 a[100:103],v3 offset:16384
v_mul_f32 v52,v52,v15
v_mul_f32 v53,v53,v15
v_fma_f32 v208,v208,s26,-v20
v_fma_f32 v209,v209,s26,-v20
v_cvt_pk_bf16_f32 v113,v50,v51
v_mul_f32 v54,v54,v15
v_mul_f32 v55,v55,v15
v_mul_f32 v56,v56,v15
v_mul_f32 v57,v57,v15
v_mfma_f32_16x16x32_bf16 a[164:167],a[136:139],v[224:227],a[164:167]
v_exp_f32 v208,v208
v_mfma_f32_16x16x32_bf16 a[164:167],a[140:143],v[228:231],a[164:167]
buffer_load_dwordx4 v1,s[8:11],s21 offen offset:1024 nt lds
v_exp_f32 v209,v209
v_cvt_pk_bf16_f32 v114,v52,v53
v_cvt_pk_bf16_f32 v115,v54,v55
v_mul_f32 v58,v58,v15
v_mul_f32 v59,v59,v15
v_cvt_pk_bf16_f32 v116,v56,v57
v_mul_f32 v60,v60,v15
v_mfma_f32_16x16x32_bf16 a[180:183],a[140:143],v[236:239],a[180:183]
ds_read_b128 a[104:107],v4 offset:16384
v_mul_f32 v61,v61,v15
v_mfma_f32_16x16x32_bf16 a[180:183],a[136:139],v[232:235],a[180:183]
v_cvt_pk_bf16_f32 v180,v208,v209
v_cvt_pk_bf16_f32 v117,v58,v59
v_fma_f32 v210,v210,s26,-v20
v_fma_f32 v211,v211,s26,-v20
v_mul_f32 v62,v62,v15
v_mul_f32 v63,v63,v15
v_cvt_pk_bf16_f32 v118,v60,v61
v_mul_f32 v64,v64,v16
v_mul_f32 v65,v65,v16
v_mfma_f32_16x16x32_bf16 a[196:199],a[136:139],v[240:243],a[196:199]
v_exp_f32 v210,v210
v_mfma_f32_16x16x32_bf16 a[196:199],a[140:143],v[244:247],a[196:199]
buffer_load_dwordx4 v1,s[8:11],s21 offen offset:2048 nt lds
v_exp_f32 v211,v211
v_cvt_pk_bf16_f32 v119,v62,v63
v_mul_f32 v66,v66,v16
v_mul_f32 v67,v67,v16
v_cvt_pk_bf16_f32 v128,v64,v65
v_mul_f32 v68,v68,v16
v_mul_f32 v69,v69,v16
v_mfma_f32_16x16x32_bf16 a[212:215],a[140:143],v[252:255],a[212:215]
ds_read_b128 a[108:111],v5 offset:16384
v_cvt_pk_bf16_f32 v181,v210,v211
v_mfma_f32_16x16x32_bf16 a[212:215],a[136:139],v[248:251],a[212:215]
v_cvt_pk_bf16_f32 v129,v66,v67
v_mul_f32 v70,v70,v16
v_mul_f32 v71,v71,v16
v_fma_f32 v216,v216,s26,-v21
v_fma_f32 v217,v217,s26,-v21
v_cvt_pk_bf16_f32 v130,v68,v69
v_mul_f32 v72,v72,v16
v_mul_f32 v73,v73,v16
v_mul_f32 v74,v74,v16
v_mul_f32 v75,v75,v16
v_mfma_f32_16x16x32_bf16 a[216:219],a[144:147],v[248:251],a[216:219]
v_exp_f32 v216,v216
v_mfma_f32_16x16x32_bf16 a[216:219],a[148:151],v[252:255],a[216:219]
buffer_load_dwordx4 v1,s[8:11],s21 offen offset:3072 nt lds
v_cvt_pk_bf16_f32 v131,v70,v71
v_exp_f32 v217,v217
v_cvt_pk_bf16_f32 v132,v72,v73
v_mul_f32 v76,v76,v16
v_mul_f32 v77,v77,v16
v_cvt_pk_bf16_f32 v133,v74,v75
v_mfma_f32_16x16x32_bf16 a[200:203],a[148:151],v[244:247],a[200:203]
s_add_u32 s21,s21,16384
ds_read_b128 a[112:115],v2 offset:17408
v_mfma_f32_16x16x32_bf16 a[200:203],a[144:147],v[240:243],a[200:203]
v_cvt_pk_bf16_f32 v188,v216,v217
v_mul_f32 v78,v78,v16
v_mul_f32 v79,v79,v16
v_fma_f32 v218,v218,s26,-v21
v_fma_f32 v219,v219,s26,-v21
v_cvt_pk_bf16_f32 v134,v76,v77
v_mul_f32 v80,v80,v17
v_mul_f32 v81,v81,v17
v_mul_f32 v82,v82,v17
v_mul_f32 v83,v83,v17
v_mfma_f32_16x16x32_bf16 a[184:187],a[144:147],v[232:235],a[184:187]
v_exp_f32 v218,v218
v_mfma_f32_16x16x32_bf16 a[184:187],a[148:151],v[236:239],a[184:187]
ds_read_b128 a[116:119],v3 offset:17408
v_exp_f32 v219,v219
v_cvt_pk_bf16_f32 v135,v78,v79
v_cvt_pk_bf16_f32 v144,v80,v81
v_mul_f32 v84,v84,v17
v_mul_f32 v85,v85,v17
v_cvt_pk_bf16_f32 v145,v82,v83
v_mul_f32 v86,v86,v17
v_mfma_f32_16x16x32_bf16 a[168:171],a[148:151],v[228:231],a[168:171]
v_mul_f32 v87,v87,v17
v_cvt_pk_bf16_f32 v189,v218,v219
v_mfma_f32_16x16x32_bf16 a[168:171],a[144:147],v[224:227],a[168:171]
v_cvt_pk_bf16_f32 v146,v84,v85
v_mul_f32 v88,v88,v17
v_mul_f32 v89,v89,v17
v_fma_f32 v196,v196,s26,-v18
v_fma_f32 v197,v197,s26,-v18
v_cvt_pk_bf16_f32 v147,v86,v87
v_mul_f32 v90,v90,v17
v_mul_f32 v91,v91,v17
v_mul_f32 v92,v92,v17
v_mul_f32 v93,v93,v17
v_mfma_f32_16x16x32_bf16 a[172:175],a[152:155],v[224:227],a[172:175]
v_exp_f32 v196,v196
v_mfma_f32_16x16x32_bf16 a[172:175],a[156:159],v[228:231],a[172:175]
ds_read_b128 a[120:123],v4 offset:17408
v_cvt_pk_bf16_f32 v148,v88,v89
v_exp_f32 v197,v197
v_cvt_pk_bf16_f32 v149,v90,v91
v_mul_f32 v94,v94,v17
v_mul_f32 v95,v95,v17
v_cvt_pk_bf16_f32 v150,v92,v93
v_accvgpr_read_b32 v32,a160
v_fma_f32 v198,v198,s26,-v18
v_mfma_f32_16x16x32_bf16 a[188:191],a[156:159],v[236:239],a[188:191]
s_add_u32 m0,s25,98304
v_exp_f32 v198,v198
v_mfma_f32_16x16x32_bf16 a[188:191],a[152:155],v[232:235],a[188:191]
buffer_load_dwordx4 v1,s[12:15],s22 offen nt lds
v_cvt_pk_bf16_f32 v166,v196,v197
v_fma_f32 v199,v199,s26,-v18
v_accvgpr_read_b32 v33,a161
v_cvt_pk_bf16_f32 v151,v94,v95
v_accvgpr_read_b32 v34,a162
v_accvgpr_read_b32 v35,a163
v_mul_f32 v32,v32,v14
v_mfma_f32_16x16x32_bf16 a[204:207],a[152:155],v[240:243],a[204:207]
v_exp_f32 v199,v199
v_mfma_f32_16x16x32_bf16 a[204:207],a[156:159],v[244:247],a[204:207]
ds_read_b128 a[124:127],v5 offset:17408
v_mul_f32 v33,v33,v14
v_accvgpr_read_b32 v36,a164
v_accvgpr_read_b32 v37,a165
v_mul_f32 v34,v34,v14
v_mul_f32 v35,v35,v14
v_cvt_pk_bf16_f32 v167,v198,v199
v_accvgpr_read_b32 v38,a166
v_fma_f32 v204,v204,s26,-v19
v_fma_f32 v205,v205,s26,-v19
v_mfma_f32_16x16x32_bf16 a[220:223],a[156:159],v[252:255],a[220:223]
v_exp_f32 v204,v204
v_mfma_f32_16x16x32_bf16 a[220:223],a[152:155],v[248:251],a[220:223]
s_waitcnt lgkmcnt(4)
v_exp_f32 v205,v205
v_cvt_pk_bf16_f32 v104,v32,v33
v_accvgpr_read_b32 v39,a167
v_mul_f32 v36,v36,v14
v_mul_f32 v37,v37,v14
v_cvt_pk_bf16_f32 v105,v34,v35
v_accvgpr_read_b32 v40,a168
v_accvgpr_read_b32 v41,a169
v_mul_f32 v38,v38,v14
v_mfma_f32_16x16x32_bf16 v[224:227],a[96:99],a[0:3],0
ds_read_b128 a[128:131],v2 offset:18432
v_mul_f32 v39,v39,v14
v_mfma_f32_16x16x32_bf16 v[224:227],a[100:103],a[4:7],v[224:227]
v_cvt_pk_bf16_f32 v106,v36,v37
v_accvgpr_read_b32 v42,a170
v_mfma_f32_16x16x32_bf16 v[224:227],a[104:107],a[8:11],v[224:227]
v_cvt_pk_bf16_f32 v174,v204,v205
v_accvgpr_read_b32 v43,a171
v_mfma_f32_16x16x32_bf16 v[224:227],a[108:111],a[12:15],v[224:227]
buffer_load_dwordx4 v1,s[12:15],s22 offen offset:1024 nt lds
v_mul_f32 v40,v40,v14
v_mul_f32 v41,v41,v14
v_cvt_pk_bf16_f32 v107,v38,v39
v_fma_f32 v206,v206,s26,-v19
v_fma_f32 v207,v207,s26,-v19
v_accvgpr_read_b32 v44,a172
v_accvgpr_read_b32 v45,a173
v_mfma_f32_16x16x32_bf16 v[232:235],a[108:111],a[28:31],0
ds_read_b128 a[132:135],v3 offset:18432
v_mul_f32 v42,v42,v14
v_mfma_f32_16x16x32_bf16 v[232:235],a[104:107],a[24:27],v[232:235]
v_exp_f32 v206,v206
v_mfma_f32_16x16x32_bf16 v[232:235],a[100:103],a[20:23],v[232:235]
v_exp_f32 v207,v207
v_mfma_f32_16x16x32_bf16 v[232:235],a[96:99],a[16:19],v[232:235]
buffer_load_dwordx4 v1,s[12:15],s22 offen offset:2048 nt lds
v_mul_f32 v43,v43,v14
v_cvt_pk_bf16_f32 v108,v40,v41
v_accvgpr_read_b32 v46,a174
v_accvgpr_read_b32 v47,a175
v_mul_f32 v44,v44,v14
v_mul_f32 v45,v45,v14
v_accvgpr_read_b32 v48,a176
v_cvt_pk_bf16_f32 v175,v206,v207
v_mfma_f32_16x16x32_bf16 v[240:243],a[96:99],a[32:35],0
ds_read_b128 a[136:139],v4 offset:18432
v_cvt_pk_bf16_f32 v109,v42,v43
v_mfma_f32_16x16x32_bf16 v[240:243],a[100:103],a[36:39],v[240:243]
v_fma_f32 v224,v224,s26,-v18
v_fma_f32 v225,v225,s26,-v18
v_mfma_f32_16x16x32_bf16 v[240:243],a[104:107],a[40:43],v[240:243]
v_exp_f32 v224,v224
v_mfma_f32_16x16x32_bf16 v[240:243],a[108:111],a[44:47],v[240:243]
ds_read_b128 a[140:143],v5 offset:18432
v_accvgpr_read_b32 v49,a177
v_exp_f32 v225,v225
v_fma_f32 v212,v212,s26,-v20
v_fma_f32 v213,v213,s26,-v20
v_mul_f32 v46,v46,v14
v_mul_f32 v47,v47,v14
v_cvt_pk_bf16_f32 v110,v44,v45
v_accvgpr_read_b32 v50,a178
v_mfma_f32_16x16x32_bf16 v[248:251],a[108:111],a[60:63],0
v_exp_f32 v212,v212
v_mfma_f32_16x16x32_bf16 v[248:251],a[104:107],a[56:59],v[248:251]
v_exp_f32 v213,v213
v_mfma_f32_16x16x32_bf16 v[248:251],a[100:103],a[52:55],v[248:251]
s_waitcnt lgkmcnt(4)
v_accvgpr_read_b32 v51,a179
v_mul_f32 v48,v48,v15
v_mfma_f32_16x16x32_bf16 v[248:251],a[96:99],a[48:51],v[248:251]
ds_read_b128 a[144:147],v2 offset:19456
v_mul_f32 v49,v49,v15
v_cvt_pk_bf16_f32 v111,v46,v47
v_accvgpr_read_b32 v52,a180
v_accvgpr_read_b32 v53,a181
v_mul_f32 v50,v50,v15
v_mul_f32 v51,v51,v15
v_cvt_pk_bf16_f32 v182,v212,v213
v_accvgpr_read_b32 v54,a182
v_mfma_f32_16x16x32_bf16 v[228:231],a[112:115],a[0:3],0
v_cvt_pk_bf16_f32 v120,v48,v49
v_fma_f32 v226,v226,s26,-v18
v_mfma_f32_16x16x32_bf16 v[228:231],a[116:119],a[4:7],v[228:231]
v_exp_f32 v226,v226
v_mfma_f32_16x16x32_bf16 v[228:231],a[120:123],a[8:11],v[228:231]
v_fma_f32 v227,v227,s26,-v18
v_fma_f32 v214,v214,s26,-v20
v_mfma_f32_16x16x32_bf16 v[228:231],a[124:127],a[12:15],v[228:231]
ds_read_b128 a[148:151],v3 offset:19456
v_fma_f32 v215,v215,s26,-v20
v_exp_f32 v227,v227
v_exp_f32 v214,v214
v_accvgpr_read_b32 v55,a183
v_mul_f32 v52,v52,v15
v_mul_f32 v53,v53,v15
v_cvt_pk_bf16_f32 v121,v50,v51
v_mfma_f32_16x16x32_bf16 v[236:239],a[124:127],a[28:31],0
v_exp_f32 v215,v215
v_mfma_f32_16x16x32_bf16 v[236:239],a[120:123],a[24:27],v[236:239]
v_accvgpr_read_b32 v56,a184
v_accvgpr_read_b32 v57,a185
v_mfma_f32_16x16x32_bf16 v[236:239],a[116:119],a[20:23],v[236:239]
ds_read_b128 a[152:155],v4 offset:19456
v_cvt_pk_bf16_f32 v224,v224,v225
v_mfma_f32_16x16x32_bf16 v[236:239],a[112:115],a[16:19],v[236:239]
buffer_load_dwordx4 v1,s[12:15],s22 offen offset:3072 nt lds
v_mul_f32 v54,v54,v15
v_mul_f32 v55,v55,v15
v_cvt_pk_bf16_f32 v122,v52,v53
v_accvgpr_read_b32 v58,a186
v_cvt_pk_bf16_f32 v225,v226,v227
v_accvgpr_read_b32 v59,a187
v_cvt_pk_bf16_f32 v183,v214,v215
v_mul_f32 v56,v56,v15
v_mfma_f32_16x16x32_bf16 v[244:247],a[112:115],a[32:35],0
s_add_u32 s22,s22,16384
v_mul_f32 v57,v57,v15
v_cvt_pk_bf16_f32 v123,v54,v55
v_mfma_f32_16x16x32_bf16 v[244:247],a[116:119],a[36:39],v[244:247]
v_fma_f32 v228,v228,s26,-v18
v_fma_f32 v229,v229,s26,-v18
v_mfma_f32_16x16x32_bf16 v[244:247],a[120:123],a[40:43],v[244:247]
s_add_u32 m0,s25,0
ds_read_b128 a[156:159],v5 offset:19456
v_mfma_f32_16x16x32_bf16 v[244:247],a[124:127],a[44:47],v[244:247]
buffer_load_dwordx4 v1,s[8:11],s21 offen nt lds
v_accvgpr_read_b32 v60,a188
v_exp_f32 v228,v228
v_exp_f32 v229,v229
v_fma_f32 v220,v220,s26,-v21
v_fma_f32 v221,v221,s26,-v21
v_mfma_f32_16x16x32_bf16 v[252:255],a[124:127],a[60:63],0
v_exp_f32 v220,v220
v_mfma_f32_16x16x32_bf16 v[252:255],a[120:123],a[56:59],v[252:255]
v_exp_f32 v221,v221
v_mfma_f32_16x16x32_bf16 v[252:255],a[116:119],a[52:55],v[252:255]
v_accvgpr_read_b32 v61,a189
v_mul_f32 v58,v58,v15
v_mfma_f32_16x16x32_bf16 v[252:255],a[112:115],a[48:51],v[252:255]
s_waitcnt lgkmcnt(4)
v_mul_f32 v59,v59,v15
v_cvt_pk_bf16_f32 v124,v56,v57
v_accvgpr_read_b32 v62,a190
v_accvgpr_read_b32 v63,a191
v_mul_f32 v60,v60,v15
v_mul_f32 v61,v61,v15
v_cvt_pk_bf16_f32 v226,v228,v229
v_accvgpr_read_b32 v64,a192
v_cvt_pk_bf16_f32 v190,v220,v221
v_fma_f32 v230,v230,s26,-v18
v_mfma_f32_16x16x32_bf16 v[192:195],a[128:131],a[0:3],0
v_exp_f32 v230,v230
v_mfma_f32_16x16x32_bf16 v[192:195],a[132:135],a[4:7],v[192:195]
v_cvt_pk_bf16_f32 v125,v58,v59
v_fma_f32 v231,v231,s26,-v18
v_mfma_f32_16x16x32_bf16 v[192:195],a[136:139],a[8:11],v[192:195]
v_exp_f32 v231,v231
v_mfma_f32_16x16x32_bf16 v[192:195],a[140:143],a[12:15],v[192:195]
buffer_load_dwordx4 v1,s[8:11],s21 offen offset:1024 nt lds
v_accvgpr_read_b32 v65,a193
v_mul_f32 v62,v62,v15
v_mul_f32 v63,v63,v15
v_cvt_pk_bf16_f32 v126,v60,v61
v_fma_f32 v222,v222,s26,-v21
v_fma_f32 v223,v223,s26,-v21
v_accvgpr_read_b32 v66,a194
v_accvgpr_read_b32 v67,a195
v_mfma_f32_16x16x32_bf16 v[200:203],a[140:143],a[28:31],0
v_exp_f32 v222,v222
v_mfma_f32_16x16x32_bf16 v[200:203],a[136:139],a[24:27],v[200:203]
ds_read_b64_tr_b16 a[96:97],v8 offset:0
v_mul_f32 v64,v64,v16
v_mfma_f32_16x16x32_bf16 v[200:203],a[132:135],a[20:23],v[200:203]
ds_read_b64_tr_b16 a[98:99],v8 offset:1024
v_mul_f32 v65,v65,v16
v_mfma_f32_16x16x32_bf16 v[200:203],a[128:131],a[16:19],v[200:203]
buffer_load_dwordx4 v1,s[8:11],s21 offen offset:2048 nt lds
v_cvt_pk_bf16_f32 v127,v62,v63
v_exp_f32 v223,v223
v_accvgpr_read_b32 v68,a196
v_accvgpr_read_b32 v69,a197
v_mul_f32 v66,v66,v16
v_mul_f32 v67,v67,v16
v_mfma_f32_16x16x32_bf16 v[208:211],a[128:131],a[32:35],0
ds_read_b64_tr_b16 a[100:101],v8 offset:2048
v_cvt_pk_bf16_f32 v227,v230,v231
v_mfma_f32_16x16x32_bf16 v[208:211],a[132:135],a[36:39],v[208:211]
ds_read_b64_tr_b16 a[102:103],v8 offset:3072
v_cvt_pk_bf16_f32 v136,v64,v65
v_mfma_f32_16x16x32_bf16 v[208:211],a[136:139],a[40:43],v[208:211]
v_cvt_pk_bf16_f32 v191,v222,v223
v_accvgpr_read_b32 v70,a198
v_mfma_f32_16x16x32_bf16 v[208:211],a[140:143],a[44:47],v[208:211]
buffer_load_dwordx4 v1,s[8:11],s21 offen offset:3072 nt lds
v_fma_f32 v232,v232,s26,-v19
v_fma_f32 v233,v233,s26,-v19
v_accvgpr_read_b32 v71,a199
v_mul_f32 v68,v68,v16
v_mul_f32 v69,v69,v16
v_cvt_pk_bf16_f32 v137,v66,v67
v_accvgpr_read_b32 v72,a200
v_accvgpr_read_b32 v73,a201
v_mfma_f32_16x16x32_bf16 v[216:219],a[140:143],a[60:63],0
s_add_u32 s21,s21,16384
ds_read_b64_tr_b16 a[104:105],v8 offset:8
v_mfma_f32_16x16x32_bf16 v[216:219],a[136:139],a[56:59],v[216:219]
ds_read_b64_tr_b16 a[106:107],v8 offset:1032
v_mul_f32 v70,v70,v16
v_mfma_f32_16x16x32_bf16 v[216:219],a[132:135],a[52:55],v[216:219]
v_exp_f32 v232,v232
v_mfma_f32_16x16x32_bf16 v[216:219],a[128:131],a[48:51],v[216:219]
s_waitcnt lgkmcnt(6)
v_exp_f32 v233,v233
v_mul_f32 v71,v71,v16
v_cvt_pk_bf16_f32 v138,v68,v69
v_accvgpr_read_b32 v74,a202
v_accvgpr_read_b32 v75,a203
v_mul_f32 v72,v72,v16
v_mul_f32 v73,v73,v16
v_fma_f32 v234,v234,s26,-v19
v_fma_f32 v235,v235,s26,-v19
v_mfma_f32_16x16x32_bf16 v[196:199],a[144:147],a[0:3],0
ds_read_b64_tr_b16 a[108:109],v8 offset:2056
v_cvt_pk_bf16_f32 v232,v232,v233
v_mfma_f32_16x16x32_bf16 v[196:199],a[148:151],a[4:7],v[196:199]
ds_read_b64_tr_b16 a[110:111],v8 offset:3080
v_cvt_pk_bf16_f32 v139,v70,v71
v_mfma_f32_16x16x32_bf16 v[196:199],a[152:155],a[8:11],v[196:199]
v_exp_f32 v234,v234
v_mfma_f32_16x16x32_bf16 v[196:199],a[156:159],a[12:15],v[196:199]
ds_read_b64_tr_b16 a[112:113],v9 offset:0
v_exp_f32 v235,v235
v_accvgpr_read_b32 v76,a204
v_accvgpr_read_b32 v77,a205
v_mul_f32 v74,v74,v16
v_mul_f32 v75,v75,v16
v_cvt_pk_bf16_f32 v140,v72,v73
v_accvgpr_read_b32 v78,a206
v_mfma_f32_16x16x32_bf16 v[204:207],a[156:159],a[28:31],0
ds_read_b64_tr_b16 a[114:115],v9 offset:1024
v_accvgpr_read_b32 v79,a207
v_mfma_f32_16x16x32_bf16 v[204:207],a[152:155],a[24:27],v[204:207]
v_mul_f32 v76,v76,v16
v_mul_f32 v77,v77,v16
v_mfma_f32_16x16x32_bf16 v[204:207],a[148:151],a[20:23],v[204:207]
v_cvt_pk_bf16_f32 v141,v74,v75
v_accvgpr_read_b32 v80,a208
v_mfma_f32_16x16x32_bf16 v[204:207],a[144:147],a[16:19],v[204:207]
ds_read_b64_tr_b16 a[116:117],v9 offset:2048
v_cvt_pk_bf16_f32 v233,v234,v235
v_accvgpr_read_b32 v81,a209
v_fma_f32 v240,v240,s26,-v20
v_fma_f32 v241,v241,s26,-v20
v_mul_f32 v78,v78,v16
v_mul_f32 v79,v79,v16
v_cvt_pk_bf16_f32 v142,v76,v77
v_accvgpr_read_b32 v82,a210
v_accvgpr_read_b32 v83,a211
v_mfma_f32_16x16x32_bf16 v[212:215],a[144:147],a[32:35],0
ds_read_b64_tr_b16 a[118:119],v9 offset:3072
v_mul_f32 v80,v80,v17
v_mfma_f32_16x16x32_bf16 v[212:215],a[148:151],a[36:39],v[212:215]
v_exp_f32 v240,v240
v_mfma_f32_16x16x32_bf16 v[212:215],a[152:155],a[40:43],v[212:215]
v_exp_f32 v241,v241
v_mfma_f32_16x16x32_bf16 v[212:215],a[156:159],a[44:47],v[212:215]
ds_read_b64_tr_b16 a[120:121],v9 offset:8
v_mul_f32 v81,v81,v17
v_cvt_pk_bf16_f32 v143,v78,v79
v_accvgpr_read_b32 v84,a212
v_accvgpr_read_b32 v85,a213
v_mul_f32 v82,v82,v17
v_mul_f32 v83,v83,v17
v_cvt_pk_bf16_f32 v240,v240,v241
v_accvgpr_read_b32 v86,a214
v_fma_f32 v242,v242,s26,-v20
v_mfma_f32_16x16x32_bf16 v[220:223],a[156:159],a[60:63],0
ds_read_b64_tr_b16 a[122:123],v9 offset:1032
v_cvt_pk_bf16_f32 v152,v80,v81
v_mfma_f32_16x16x32_bf16 v[220:223],a[152:155],a[56:59],v[220:223]
v_exp_f32 v242,v242
v_mfma_f32_16x16x32_bf16 v[220:223],a[148:151],a[52:55],v[220:223]
ds_read_b64_tr_b16 a[124:125],v9 offset:2056
v_fma_f32 v243,v243,s26,-v20
v_mfma_f32_16x16x32_bf16 v[220:223],a[144:147],a[48:51],v[220:223]
s_waitcnt lgkmcnt(14)
ds_read_b64_tr_b16 a[126:127],v9 offset:3080
v_exp_f32 v243,v243
v_accvgpr_read_b32 v87,a215
v_mul_f32 v84,v84,v17
v_mul_f32 v85,v85,v17
v_cvt_pk_bf16_f32 v153,v82,v83
v_accvgpr_read_b32 v88,a216
v_accvgpr_read_b32 v89,a217
v_mfma_f32_16x16x32_bf16 a[224:227],a[240:243],v[160:163],0
s_add_u32 m0,s25,114688
v_mul_f32 v86,v86,v17
v_mul_f32 v87,v87,v17
v_mfma_f32_16x16x32_bf16 a[224:227],a[240:243],v[164:167],a[224:227]
buffer_load_dwordx4 v1,s[12:15],s22 offen nt lds
v_cvt_pk_bf16_f32 v154,v84,v85
v_accvgpr_read_b32 v90,a218
v_accvgpr_read_b32 v91,a219
v_cvt_pk_bf16_f32 v241,v242,v243
v_mul_f32 v88,v88,v17
v_mul_f32 v89,v89,v17
v_cvt_pk_bf16_f32 v155,v86,v87
v_fma_f32 v248,v248,s26,-v21
v_mfma_f32_16x16x32_bf16 a[228:231],a[240:243],v[168:171],0
s_waitcnt lgkmcnt(14)
ds_read_b64_tr_b16 a[128:129],v6 offset:0
v_fma_f32 v249,v249,s26,-v21
v_mfma_f32_16x16x32_bf16 a[228:231],a[240:243],v[172:175],a[228:231]
s_waitcnt lgkmcnt(14)
ds_read_b64_tr_b16 a[130:131],v6 offset:1024
v_accvgpr_read_b32 v92,a220
v_exp_f32 v248,v248
v_exp_f32 v249,v249
v_accvgpr_read_b32 v93,a221
v_mul_f32 v90,v90,v17
v_mul_f32 v91,v91,v17
v_cvt_pk_bf16_f32 v156,v88,v89
v_mfma_f32_16x16x32_bf16 a[232:235],a[240:243],v[176:179],0
v_accvgpr_read_b32 v94,a222
v_accvgpr_read_b32 v95,a223
v_mfma_f32_16x16x32_bf16 a[232:235],a[240:243],v[180:183],a[232:235]
s_waitcnt lgkmcnt(14)
v_mul_f32 v92,v92,v17
v_mul_f32 v93,v93,v17
v_cvt_pk_bf16_f32 v157,v90,v91
v_cvt_pk_bf16_f32 v248,v248,v249
v_mul_f32 v94,v94,v17
v_mul_f32 v95,v95,v17
v_fma_f32 v250,v250,s26,-v21
v_fma_f32 v251,v251,s26,-v21
v_fma_f32 v236,v236,s26,-v19
v_mfma_f32_16x16x32_bf16 a[236:239],a[240:243],v[184:187],0
ds_read_b64_tr_b16 a[132:133],v6 offset:2048
v_cvt_pk_bf16_f32 v158,v92,v93
v_mfma_f32_16x16x32_bf16 a[236:239],a[240:243],v[188:191],a[236:239]
s_waitcnt lgkmcnt(14)
ds_read_b64_tr_b16 a[134:135],v6 offset:3072
v_cvt_pk_bf16_f32 v159,v94,v95
v_exp_f32 v250,v250
v_exp_f32 v251,v251
v_exp_f32 v236,v236
v_fma_f32 v237,v237,s26,-v19
v_fma_f32 v238,v238,s26,-v19
v_mfma_f32_16x16x32_bf16 a[208:211],a[96:99],v[184:187],0
v_exp_f32 v237,v237
v_mfma_f32_16x16x32_bf16 a[208:211],a[100:103],v[188:191],a[208:211]
s_waitcnt lgkmcnt(14)
ds_read_b64_tr_b16 a[136:137],v6 offset:8
v_exp_f32 v238,v238
v_cvt_pk_bf16_f32 v249,v250,v251
v_cvt_pk_bf16_f32 v234,v236,v237
v_fma_f32 v239,v239,s26,-v19
v_fma_f32 v244,v244,s26,-v20
v_fma_f32 v245,v245,s26,-v20
v_fma_f32 v246,v246,s26,-v20
v_mfma_f32_16x16x32_bf16 a[192:195],a[100:103],v[180:183],0
s_waitcnt lgkmcnt(14)
ds_read_b64_tr_b16 a[138:139],v6 offset:1032
v_fma_f32 v247,v247,s26,-v20
v_mfma_f32_16x16x32_bf16 a[192:195],a[96:99],v[176:179],a[192:195]
buffer_load_dwordx4 v1,s[12:15],s22 offen offset:1024 nt lds
v_exp_f32 v239,v239
v_exp_f32 v244,v244
v_exp_f32 v245,v245
v_exp_f32 v246,v246
v_mfma_f32_16x16x32_bf16 a[176:179],a[96:99],v[168:171],0
v_exp_f32 v247,v247
v_mfma_f32_16x16x32_bf16 a[176:179],a[100:103],v[172:175],a[176:179]
s_waitcnt lgkmcnt(14)
ds_read_b64_tr_b16 a[140:141],v6 offset:2056
v_cvt_pk_bf16_f32 v235,v238,v239
v_cvt_pk_bf16_f32 v242,v244,v245
v_cvt_pk_bf16_f32 v243,v246,v247
v_fma_f32 v252,v252,s26,-v21
v_fma_f32 v253,v253,s26,-v21
v_fma_f32 v254,v254,s26,-v21
v_fma_f32 v255,v255,s26,-v21
v_mfma_f32_16x16x32_bf16 a[160:163],a[100:103],v[164:167],0
s_waitcnt lgkmcnt(14)
ds_read_b64_tr_b16 a[142:143],v6 offset:3080
v_mfma_f32_16x16x32_bf16 a[160:163],a[96:99],v[160:163],a[160:163]
v_exp_f32 v252,v252
v_exp_f32 v253,v253
v_exp_f32 v254,v254
v_exp_f32 v255,v255
v_mfma_f32_16x16x32_bf16 a[164:167],a[104:107],v[160:163],0
v_cvt_pk_bf16_f32 v250,v252,v253
v_cvt_pk_bf16_f32 v251,v254,v255
v_mfma_f32_16x16x32_bf16 a[164:167],a[108:111],v[164:167],a[164:167]
s_waitcnt lgkmcnt(14)
ds_read_b64_tr_b16 a[144:145],v7 offset:0
v_mfma_f32_16x16x32_bf16 a[180:183],a[108:111],v[172:175],0
s_waitcnt lgkmcnt(14)
ds_read_b64_tr_b16 a[146:147],v7 offset:1024
v_mfma_f32_16x16x32_bf16 a[180:183],a[104:107],v[168:171],a[180:183]
buffer_load_dwordx4 v1,s[12:15],s22 offen offset:2048 nt lds
v_mfma_f32_16x16x32_bf16 a[196:199],a[104:107],v[176:179],0
s_waitcnt lgkmcnt(14)
ds_read_b64_tr_b16 a[148:149],v7 offset:2048
v_mfma_f32_16x16x32_bf16 a[196:199],a[108:111],v[180:183],a[196:199]
s_waitcnt lgkmcnt(14)
ds_read_b64_tr_b16 a[150:151],v7 offset:3072
v_mfma_f32_16x16x32_bf16 a[212:215],a[108:111],v[188:191],0
v_mfma_f32_16x16x32_bf16 a[212:215],a[104:107],v[184:187],a[212:215]
v_mfma_f32_16x16x32_bf16 a[216:219],a[112:115],v[184:187],0
s_waitcnt lgkmcnt(14)
ds_read_b64_tr_b16 a[152:153],v7 offset:8
v_mfma_f32_16x16x32_bf16 a[216:219],a[116:119],v[188:191],a[216:219]
s_waitcnt lgkmcnt(14)
ds_read_b64_tr_b16 a[154:155],v7 offset:1032
v_mfma_f32_16x16x32_bf16 a[200:203],a[116:119],v[180:183],0
v_mfma_f32_16x16x32_bf16 a[200:203],a[112:115],v[176:179],a[200:203]
s_waitcnt lgkmcnt(14)
ds_read_b64_tr_b16 a[156:157],v7 offset:2056
v_mfma_f32_16x16x32_bf16 a[184:187],a[112:115],v[168:171],0
s_waitcnt lgkmcnt(14)
ds_read_b64_tr_b16 a[158:159],v7 offset:3080
v_mfma_f32_16x16x32_bf16 a[184:187],a[116:119],v[172:175],a[184:187]
buffer_load_dwordx4 v1,s[12:15],s22 offen offset:3072 nt lds
v_mfma_f32_16x16x32_bf16 a[168:171],a[116:119],v[164:167],0
s_add_u32 s22,s22,16384
v_mfma_f32_16x16x32_bf16 a[168:171],a[112:115],v[160:163],a[168:171]
v_mfma_f32_16x16x32_bf16 a[172:175],a[120:123],v[160:163],0
v_mfma_f32_16x16x32_bf16 a[172:175],a[124:127],v[164:167],a[172:175]
v_mfma_f32_16x16x32_bf16 a[188:191],a[124:127],v[172:175],0
v_mfma_f32_16x16x32_bf16 a[188:191],a[120:123],v[168:171],a[188:191]
s_mov_b32 s24,131072
v_mfma_f32_16x16x32_bf16 a[204:207],a[120:123],v[176:179],0
v_fma_f32 v192,v192,s26,-v18
v_mfma_f32_16x16x32_bf16 a[204:207],a[124:127],v[180:183],a[204:207]
v_exp_f32 v192,v192
v_fma_f32 v193,v193,s26,-v18
v_fma_f32 v194,v194,s26,-v18
v_mfma_f32_16x16x32_bf16 a[220:223],a[124:127],v[188:191],0
v_fma_f32 v195,v195,s26,-v18
v_mfma_f32_16x16x32_bf16 a[220:223],a[120:123],v[184:187],a[220:223]
s_waitcnt lgkmcnt(12)
v_exp_f32 v193,v193
v_exp_f32 v194,v194
v_mfma_f32_16x16x32_bf16 v[80:83],a[128:131],v[184:187],0
v_cvt_pk_bf16_f32 v228,v192,v193
v_mfma_f32_16x16x32_bf16 v[80:83],a[132:135],v[188:191],v[80:83]
v_exp_f32 v195,v195
v_fma_f32 v196,v196,s26,-v18
v_fma_f32 v197,v197,s26,-v18
v_mfma_f32_16x16x32_bf16 v[64:67],a[132:135],v[180:183],0
v_cvt_pk_bf16_f32 v229,v194,v195
v_mfma_f32_16x16x32_bf16 v[64:67],a[128:131],v[176:179],v[64:67]
s_waitcnt vmcnt(16)
s_waitcnt lgkmcnt(0)
s_barrier
L_h1_1:
ds_read_b128 a[96:99],v2 offset:32768
v_exp_f32 v196,v196
v_fma_f32 v198,v198,s26,-v18
v_mfma_f32_16x16x32_bf16 v[48:51],a[128:131],v[168:171],0
s_add_u32 m0,s25,16384
v_fma_f32 v199,v199,s26,-v18
v_mfma_f32_16x16x32_bf16 v[48:51],a[132:135],v[172:175],v[48:51]
buffer_load_dwordx4 v1,s[8:11],s21 offen nt lds
v_exp_f32 v197,v197
v_mfma_f32_16x16x32_bf16 v[32:35],a[132:135],v[164:167],0
v_cvt_pk_bf16_f32 v230,v196,v197
v_mfma_f32_16x16x32_bf16 v[32:35],a[128:131],v[160:163],v[32:35]
ds_read_b128 a[100:103],v3 offset:32768
v_exp_f32 v198,v198
v_fma_f32 v200,v200,s26,-v19
v_mfma_f32_16x16x32_bf16 v[36:39],a[136:139],v[160:163],0
v_fma_f32 v201,v201,s26,-v19
v_mfma_f32_16x16x32_bf16 v[36:39],a[140:143],v[164:167],v[36:39]
v_exp_f32 v199,v199
v_exp_f32 v200,v200
v_mfma_f32_16x16x32_bf16 v[52:55],a[140:143],v[172:175],0
ds_read_b128 a[104:107],v4 offset:32768
v_cvt_pk_bf16_f32 v231,v198,v199
v_mfma_f32_16x16x32_bf16 v[52:55],a[136:139],v[168:171],v[52:55]
v_exp_f32 v201,v201
v_fma_f32 v202,v202,s26,-v19
v_fma_f32 v203,v203,s26,-v19
v_mfma_f32_16x16x32_bf16 v[68:71],a[136:139],v[176:179],0
v_cvt_pk_bf16_f32 v236,v200,v201
v_mfma_f32_16x16x32_bf16 v[68:71],a[140:143],v[180:183],v[68:71]
buffer_load_dwordx4 v1,s[8:11],s21 offen offset:1024 nt lds
v_exp_f32 v202,v202
v_mfma_f32_16x16x32_bf16 v[84:87],a[140:143],v[188:191],0
ds_read_b128 a[108:111],v5 offset:32768
v_fma_f32 v204,v204,s26,-v19
v_mfma_f32_16x16x32_bf16 v[84:87],a[136:139],v[184:187],v[84:87]
v_exp_f32 v203,v203
v_exp_f32 v204,v204
v_mfma_f32_16x16x32_bf16 v[88:91],a[144:147],v[184:187],0
v_cvt_pk_bf16_f32 v237,v202,v203
v_mfma_f32_16x16x32_bf16 v[88:91],a[148:151],v[188:191],v[88:91]
v_fma_f32 v205,v205,s26,-v19
v_fma_f32 v206,v206,s26,-v19
v_fma_f32 v207,v207,s26,-v19
v_fma_f32 v208,v208,s26,-v20
v_mfma_f32_16x16x32_bf16 v[72:75],a[148:151],v[180:183],0
ds_read_b128 a[112:115],v2 offset:33792
v_fma_f32 v209,v209,s26,-v20
v_mfma_f32_16x16x32_bf16 v[72:75],a[144:147],v[176:179],v[72:75]
v_exp_f32 v205,v205
v_exp_f32 v206,v206
v_mfma_f32_16x16x32_bf16 v[56:59],a[144:147],v[168:171],0
v_cvt_pk_bf16_f32 v238,v204,v205
v_mfma_f32_16x16x32_bf16 v[56:59],a[148:151],v[172:175],v[56:59]
ds_read_b128 a[116:119],v3 offset:33792
v_exp_f32 v207,v207
v_fma_f32 v210,v210,s26,-v20
v_mfma_f32_16x16x32_bf16 v[40:43],a[148:151],v[164:167],0
v_cvt_pk_bf16_f32 v239,v206,v207
v_mfma_f32_16x16x32_bf16 v[40:43],a[144:147],v[160:163],v[40:43]
v_exp_f32 v208,v208
v_exp_f32 v209,v209
v_mfma_f32_16x16x32_bf16 v[44:47],a[152:155],v[160:163],0
v_cvt_pk_bf16_f32 v244,v208,v209
v_mfma_f32_16x16x32_bf16 v[44:47],a[156:159],v[164:167],v[44:47]
ds_read_b128 a[120:123],v4 offset:33792
v_fma_f32 v211,v211,s26,-v20
v_exp_f32 v210,v210
v_mfma_f32_16x16x32_bf16 v[60:63],a[156:159],v[172:175],0
v_fma_f32 v212,v212,s26,-v20
v_mfma_f32_16x16x32_bf16 v[60:63],a[152:155],v[168:171],v[60:63]
buffer_load_dwordx4 v1,s[8:11],s21 offen offset:2048 nt lds
v_exp_f32 v211,v211
v_mfma_f32_16x16x32_bf16 v[76:79],a[152:155],v[176:179],0
v_cvt_pk_bf16_f32 v245,v210,v211
v_mfma_f32_16x16x32_bf16 v[76:79],a[156:159],v[180:183],v[76:79]
ds_read_b128 a[124:127],v5 offset:33792
v_fma_f32 v213,v213,s26,-v20
v_exp_f32 v212,v212
v_mfma_f32_16x16x32_bf16 v[92:95],a[156:159],v[188:191],0
v_fma_f32 v214,v214,s26,-v20
v_mfma_f32_16x16x32_bf16 v[92:95],a[152:155],v[184:187],v[92:95]
s_waitcnt lgkmcnt(4)
v_exp_f32 v213,v213
v_exp_f32 v214,v214
v_mfma_f32_16x16x32_bf16 v[160:163],a[96:99],a[0:3],0
ds_read_b128 a[128:131],v2 offset:34816
v_cvt_pk_bf16_f32 v246,v212,v213
v_mfma_f32_16x16x32_bf16 v[160:163],a[100:103],a[4:7],v[160:163]
v_fma_f32 v215,v215,s26,-v20
v_mfma_f32_16x16x32_bf16 v[160:163],a[104:107],a[8:11],v[160:163]
v_fma_f32 v216,v216,s26,-v21
v_mfma_f32_16x16x32_bf16 v[160:163],a[108:111],a[12:15],v[160:163]
buffer_load_dwordx4 v1,s[8:11],s21 offen offset:3072 nt lds
v_exp_f32 v215,v215
v_mfma_f32_16x16x32_bf16 v[168:171],a[108:111],a[28:31],0
s_add_u32 s21,s21,16384
ds_read_b128 a[132:135],v3 offset:34816
v_mfma_f32_16x16x32_bf16 v[168:171],a[104:107],a[24:27],v[168:171]
v_cvt_pk_bf16_f32 v247,v214,v215
v_mfma_f32_16x16x32_bf16 v[168:171],a[100:103],a[20:23],v[168:171]
v_fma_f32 v217,v217,s26,-v21
v_mfma_f32_16x16x32_bf16 v[168:171],a[96:99],a[16:19],v[168:171]
v_exp_f32 v216,v216
v_exp_f32 v217,v217
v_mfma_f32_16x16x32_bf16 v[176:179],a[96:99],a[32:35],0
ds_read_b128 a[136:139],v4 offset:34816
v_cvt_pk_bf16_f32 v252,v216,v217
v_mfma_f32_16x16x32_bf16 v[176:179],a[100:103],a[36:39],v[176:179]
v_fma_f32 v218,v218,s26,-v21
v_mfma_f32_16x16x32_bf16 v[176:179],a[104:107],a[40:43],v[176:179]
v_fma_f32 v219,v219,s26,-v21
v_mfma_f32_16x16x32_bf16 v[176:179],a[108:111],a[44:47],v[176:179]
ds_read_b128 a[140:143],v5 offset:34816
v_exp_f32 v218,v218
v_fma_f32 v220,v220,s26,-v21
v_mfma_f32_16x16x32_bf16 v[184:187],a[108:111],a[60:63],0
v_fma_f32 v221,v221,s26,-v21
v_mfma_f32_16x16x32_bf16 v[184:187],a[104:107],a[56:59],v[184:187]
v_fma_f32 v222,v222,s26,-v21
v_mfma_f32_16x16x32_bf16 v[184:187],a[100:103],a[52:55],v[184:187]
s_waitcnt lgkmcnt(4)
v_fma_f32 v223,v223,s26,-v21
v_mfma_f32_16x16x32_bf16 v[184:187],a[96:99],a[48:51],v[184:187]
ds_read_b128 a[144:147],v2 offset:35840
v_exp_f32 v219,v219
v_mfma_f32_16x16x32_bf16 v[164:167],a[112:115],a[0:3],0
v_cvt_pk_bf16_f32 v253,v218,v219
v_mfma_f32_16x16x32_bf16 v[164:167],a[116:119],a[4:7],v[164:167]
v_mfma_f32_16x16x32_bf16 v[164:167],a[120:123],a[8:11],v[164:167]
v_mfma_f32_16x16x32_bf16 v[164:167],a[124:127],a[12:15],v[164:167]
ds_read_b128 a[148:151],v3 offset:35840
v_exp_f32 v220,v220
v_mfma_f32_16x16x32_bf16 v[172:175],a[124:127],a[28:31],0
v_mfma_f32_16x16x32_bf16 v[172:175],a[120:123],a[24:27],v[172:175]
v_mfma_f32_16x16x32_bf16 v[172:175],a[116:119],a[20:23],v[172:175]
s_add_u32 m0,s25,65536
ds_read_b128 a[152:155],v4 offset:35840
v_mfma_f32_16x16x32_bf16 v[172:175],a[112:115],a[16:19],v[172:175]
buffer_load_dwordx4 v1,s[12:15],s22 offen nt lds
v_exp_f32 v221,v221
v_mfma_f32_16x16x32_bf16 v[180:183],a[112:115],a[32:35],0
v_cvt_pk_bf16_f32 v254,v220,v221
v_mfma_f32_16x16x32_bf16 v[180:183],a[116:119],a[36:39],v[180:183]
v_mfma_f32_16x16x32_bf16 v[180:183],a[120:123],a[40:43],v[180:183]
ds_read_b128 a[156:159],v5 offset:35840
v_mfma_f32_16x16x32_bf16 v[180:183],a[124:127],a[44:47],v[180:183]
v_exp_f32 v222,v222
v_exp_f32 v223,v223
v_mfma_f32_16x16x32_bf16 v[188:191],a[124:127],a[60:63],0
v_cvt_pk_bf16_f32 v255,v222,v223
v_mfma_f32_16x16x32_bf16 v[188:191],a[120:123],a[56:59],v[188:191]
v_mfma_f32_16x16x32_bf16 v[188:191],a[116:119],a[52:55],v[188:191]
v_mfma_f32_16x16x32_bf16 v[188:191],a[112:115],a[48:51],v[188:191]
s_waitcnt lgkmcnt(4)
v_mfma_f32_16x16x32_bf16 v[192:195],a[128:131],a[0:3],0
v_mfma_f32_16x16x32_bf16 v[192:195],a[132:135],a[4:7],v[192:195]
v_mfma_f32_16x16x32_bf16 v[192:195],a[136:139],a[8:11],v[192:195]
v_mfma_f32_16x16x32_bf16 v[192:195],a[140:143],a[12:15],v[192:195]
buffer_load_dwordx4 v1,s[12:15],s22 offen offset:1024 nt lds
v_fma_f32 v160,v160,s26,-v18
v_fma_f32 v161,v161,s26,-v18
v_fma_f32 v162,v162,s26,-v18
v_mfma_f32_16x16x32_bf16 v[200:203],a[140:143],a[28:31],0
v_mfma_f32_16x16x32_bf16 v[200:203],a[136:139],a[24:27],v[200:203]
ds_read_b64_tr_b16 a[96:97],v6 offset:16384
v_mfma_f32_16x16x32_bf16 v[200:203],a[132:135],a[20:23],v[200:203]
ds_read_b64_tr_b16 a[98:99],v6 offset:17408
v_mfma_f32_16x16x32_bf16 v[200:203],a[128:131],a[16:19],v[200:203]
v_exp_f32 v160,v160
v_exp_f32 v161,v161
v_exp_f32 v162,v162
v_mfma_f32_16x16x32_bf16 v[208:211],a[128:131],a[32:35],0
ds_read_b64_tr_b16 a[100:101],v6 offset:18432
v_mfma_f32_16x16x32_bf16 v[208:211],a[132:135],a[36:39],v[208:211]
ds_read_b64_tr_b16 a[102:103],v6 offset:19456
v_mfma_f32_16x16x32_bf16 v[208:211],a[136:139],a[40:43],v[208:211]
v_mfma_f32_16x16x32_bf16 v[208:211],a[140:143],a[44:47],v[208:211]
buffer_load_dwordx4 v1,s[12:15],s22 offen offset:2048 nt lds
v_cvt_pk_bf16_f32 v160,v160,v161
v_fma_f32 v163,v163,s26,-v18
v_fma_f32 v164,v164,s26,-v18
v_mfma_f32_16x16x32_bf16 v[216:219],a[140:143],a[60:63],0
ds_read_b64_tr_b16 a[104:105],v6 offset:16392
v_mfma_f32_16x16x32_bf16 v[216:219],a[136:139],a[56:59],v[216:219]
ds_read_b64_tr_b16 a[106:107],v6 offset:17416
v_mfma_f32_16x16x32_bf16 v[216:219],a[132:135],a[52:55],v[216:219]
v_mfma_f32_16x16x32_bf16 v[216:219],a[128:131],a[48:51],v[216:219]
s_waitcnt lgkmcnt(6)
v_exp_f32 v163,v163
v_exp_f32 v164,v164
v_fma_f32 v165,v165,s26,-v18
v_fma_f32 v166,v166,s26,-v18
v_mfma_f32_16x16x32_bf16 v[196:199],a[144:147],a[0:3],0
ds_read_b64_tr_b16 a[108:109],v6 offset:18440
v_mfma_f32_16x16x32_bf16 v[196:199],a[148:151],a[4:7],v[196:199]
ds_read_b64_tr_b16 a[110:111],v6 offset:19464
v_mfma_f32_16x16x32_bf16 v[196:199],a[152:155],a[8:11],v[196:199]
v_mfma_f32_16x16x32_bf16 v[196:199],a[156:159],a[12:15],v[196:199]
ds_read_b64_tr_b16 a[112:113],v7 offset:16384
v_exp_f32 v165,v165
v_exp_f32 v166,v166
v_mfma_f32_16x16x32_bf16 v[204:207],a[156:159],a[28:31],0
ds_read_b64_tr_b16 a[114:115],v7 offset:17408
v_mfma_f32_16x16x32_bf16 v[204:207],a[152:155],a[24:27],v[204:207]
v_mfma_f32_16x16x32_bf16 v[204:207],a[148:151],a[20:23],v[204:207]
v_mfma_f32_16x16x32_bf16 v[204:207],a[144:147],a[16:19],v[204:207]
ds_read_b64_tr_b16 a[116:117],v7 offset:18432
v_cvt_pk_bf16_f32 v161,v162,v163
v_cvt_pk_bf16_f32 v162,v164,v165
v_fma_f32 v167,v167,s26,-v18
v_fma_f32 v168,v168,s26,-v19
v_mfma_f32_16x16x32_bf16 v[212:215],a[144:147],a[32:35],0
ds_read_b64_tr_b16 a[118:119],v7 offset:19456
v_mfma_f32_16x16x32_bf16 v[212:215],a[148:151],a[36:39],v[212:215]
v_mfma_f32_16x16x32_bf16 v[212:215],a[152:155],a[40:43],v[212:215]
v_mfma_f32_16x16x32_bf16 v[212:215],a[156:159],a[44:47],v[212:215]
ds_read_b64_tr_b16 a[120:121],v7 offset:16392
v_exp_f32 v167,v167
v_fma_f32 v169,v169,s26,-v19
v_exp_f32 v168,v168
v_mfma_f32_16x16x32_bf16 v[220:223],a[156:159],a[60:63],0
ds_read_b64_tr_b16 a[122:123],v7 offset:17416
v_mfma_f32_16x16x32_bf16 v[220:223],a[152:155],a[56:59],v[220:223]
v_mfma_f32_16x16x32_bf16 v[220:223],a[148:151],a[52:55],v[220:223]
ds_read_b64_tr_b16 a[124:125],v7 offset:18440
v_mfma_f32_16x16x32_bf16 v[220:223],a[144:147],a[48:51],v[220:223]
s_waitcnt lgkmcnt(14)
ds_read_b64_tr_b16 a[126:127],v7 offset:19464
v_exp_f32 v169,v169
v_cvt_pk_bf16_f32 v163,v166,v167
v_fma_f32 v170,v170,s26,-v19
v_mfma_f32_16x16x32_bf16 a[224:227],a[240:243],v[224:227],a[224:227]
v_mfma_f32_16x16x32_bf16 a[224:227],a[240:243],v[228:231],a[224:227]
buffer_load_dwordx4 v1,s[12:15],s22 offen offset:3072 nt lds
v_cvt_pk_bf16_f32 v168,v168,v169
v_exp_f32 v170,v170
v_mfma_f32_16x16x32_bf16 a[228:231],a[240:243],v[232:235],a[228:231]
s_add_u32 s22,s22,16384
s_waitcnt lgkmcnt(14)
ds_read_b64_tr_b16 a[128:129],v8 offset:16384
v_mfma_f32_16x16x32_bf16 a[228:231],a[240:243],v[236:239],a[228:231]
s_waitcnt lgkmcnt(14)
ds_read_b64_tr_b16 a[130:131],v8 offset:17408
v_fma_f32 v171,v171,s26,-v19
v_fma_f32 v172,v172,s26,-v19
v_fma_f32 v173,v173,s26,-v19
v_fma_f32 v174,v174,s26,-v19
v_fma_f32 v175,v175,s26,-v19
v_mfma_f32_16x16x32_bf16 a[232:235],a[240:243],v[240:243],a[232:235]
v_mfma_f32_16x16x32_bf16 a[232:235],a[240:243],v[244:247],a[232:235]
s_waitcnt lgkmcnt(14)
v_exp_f32 v171,v171
v_exp_f32 v172,v172
v_fma_f32 v176,v176,s26,-v20
v_mfma_f32_16x16x32_bf16 a[236:239],a[240:243],v[248:251],a[236:239]
ds_read_b64_tr_b16 a[132:133],v8 offset:18432
v_mfma_f32_16x16x32_bf16 a[236:239],a[240:243],v[252:255],a[236:239]
s_waitcnt lgkmcnt(14)
ds_read_b64_tr_b16 a[134:135],v8 offset:19456
v_cvt_pk_bf16_f32 v169,v170,v171
v_exp_f32 v173,v173
v_exp_f32 v174,v174
v_mfma_f32_16x16x32_bf16 v[80:83],a[96:99],v[248:251],v[80:83]
v_mfma_f32_16x16x32_bf16 v[80:83],a[100:103],v[252:255],v[80:83]
s_waitcnt lgkmcnt(14)
ds_read_b64_tr_b16 a[136:137],v8 offset:16392
v_exp_f32 v175,v175
v_exp_f32 v176,v176
v_mfma_f32_16x16x32_bf16 v[64:67],a[100:103],v[244:247],v[64:67]
s_waitcnt lgkmcnt(14)
ds_read_b64_tr_b16 a[138:139],v8 offset:17416
v_mfma_f32_16x16x32_bf16 v[64:67],a[96:99],v[240:243],v[64:67]
v_cvt_pk_bf16_f32 v170,v172,v173
v_cvt_pk_bf16_f32 v171,v174,v175
v_fma_f32 v177,v177,s26,-v20
v_fma_f32 v178,v178,s26,-v20
v_fma_f32 v179,v179,s26,-v20
v_mfma_f32_16x16x32_bf16 v[48:51],a[96:99],v[232:235],v[48:51]
v_mfma_f32_16x16x32_bf16 v[48:51],a[100:103],v[236:239],v[48:51]
s_waitcnt lgkmcnt(14)
ds_read_b64_tr_b16 a[140:141],v8 offset:18440
v_exp_f32 v177,v177
v_exp_f32 v178,v178
v_fma_f32 v180,v180,s26,-v20
v_mfma_f32_16x16x32_bf16 v[32:35],a[100:103],v[228:231],v[32:35]
s_waitcnt lgkmcnt(14)
ds_read_b64_tr_b16 a[142:143],v8 offset:19464
v_mfma_f32_16x16x32_bf16 v[32:35],a[96:99],v[224:227],v[32:35]
v_cvt_pk_bf16_f32 v176,v176,v177
v_exp_f32 v179,v179
v_exp_f32 v180,v180
v_mfma_f32_16x16x32_bf16 v[36:39],a[104:107],v[224:227],v[36:39]
v_mfma_f32_16x16x32_bf16 v[36:39],a[108:111],v[228:231],v[36:39]
s_waitcnt lgkmcnt(14)
ds_read_b64_tr_b16 a[144:145],v9 offset:16384
v_cvt_pk_bf16_f32 v177,v178,v179
v_fma_f32 v181,v181,s26,-v20
v_fma_f32 v182,v182,s26,-v20
v_fma_f32 v183,v183,s26,-v20
v_fma_f32 v184,v184,s26,-v21
v_mfma_f32_16x16x32_bf16 v[52:55],a[108:111],v[236:239],v[52:55]
s_waitcnt lgkmcnt(14)
ds_read_b64_tr_b16 a[146:147],v9 offset:17408
v_mfma_f32_16x16x32_bf16 v[52:55],a[104:107],v[232:235],v[52:55]
v_exp_f32 v181,v181
v_exp_f32 v182,v182
v_fma_f32 v185,v185,s26,-v21
v_mfma_f32_16x16x32_bf16 v[68:71],a[104:107],v[240:243],v[68:71]
s_waitcnt lgkmcnt(14)
ds_read_b64_tr_b16 a[148:149],v9 offset:18432
v_mfma_f32_16x16x32_bf16 v[68:71],a[108:111],v[244:247],v[68:71]
s_waitcnt lgkmcnt(14)
ds_read_b64_tr_b16 a[150:151],v9 offset:19456
v_exp_f32 v183,v183
v_exp_f32 v184,v184
v_mfma_f32_16x16x32_bf16 v[84:87],a[108:111],v[252:255],v[84:87]
v_mfma_f32_16x16x32_bf16 v[84:87],a[104:107],v[248:251],v[84:87]
v_exp_f32 v185,v185
v_cvt_pk_bf16_f32 v178,v180,v181
v_cvt_pk_bf16_f32 v179,v182,v183
v_fma_f32 v186,v186,s26,-v21
v_fma_f32 v187,v187,s26,-v21
v_mfma_f32_16x16x32_bf16 v[88:91],a[112:115],v[248:251],v[88:91]
s_waitcnt lgkmcnt(14)
ds_read_b64_tr_b16 a[152:153],v9 offset:16392
v_mfma_f32_16x16x32_bf16 v[88:91],a[116:119],v[252:255],v[88:91]
s_waitcnt lgkmcnt(14)
ds_read_b64_tr_b16 a[154:155],v9 offset:17416
v_exp_f32 v186,v186
v_exp_f32 v187,v187
v_mfma_f32_16x16x32_bf16 v[72:75],a[116:119],v[244:247],v[72:75]
v_mfma_f32_16x16x32_bf16 v[72:75],a[112:115],v[240:243],v[72:75]
s_waitcnt lgkmcnt(14)
ds_read_b64_tr_b16 a[156:157],v9 offset:18440
v_cvt_pk_bf16_f32 v184,v184,v185
v_cvt_pk_bf16_f32 v185,v186,v187
v_fma_f32 v188,v188,s26,-v21
v_fma_f32 v189,v189,s26,-v21
v_mfma_f32_16x16x32_bf16 v[56:59],a[112:115],v[232:235],v[56:59]
s_waitcnt lgkmcnt(14)
ds_read_b64_tr_b16 a[158:159],v9 offset:19464
v_mfma_f32_16x16x32_bf16 v[56:59],a[116:119],v[236:239],v[56:59]
v_exp_f32 v188,v188
v_exp_f32 v189,v189
v_fma_f32 v190,v190,s26,-v21
v_fma_f32 v191,v191,s26,-v21
v_mfma_f32_16x16x32_bf16 v[40:43],a[116:119],v[228:231],v[40:43]
v_mfma_f32_16x16x32_bf16 v[40:43],a[112:115],v[224:227],v[40:43]
v_cvt_pk_bf16_f32 v186,v188,v189
v_exp_f32 v190,v190
v_exp_f32 v191,v191
v_mfma_f32_16x16x32_bf16 v[44:47],a[120:123],v[224:227],v[44:47]
v_mfma_f32_16x16x32_bf16 v[44:47],a[124:127],v[228:231],v[44:47]
v_cvt_pk_bf16_f32 v187,v190,v191
v_mfma_f32_16x16x32_bf16 v[60:63],a[124:127],v[236:239],v[60:63]
v_mfma_f32_16x16x32_bf16 v[60:63],a[120:123],v[232:235],v[60:63]
v_mfma_f32_16x16x32_bf16 v[76:79],a[120:123],v[240:243],v[76:79]
v_mfma_f32_16x16x32_bf16 v[76:79],a[124:127],v[244:247],v[76:79]
v_fma_f32 v192,v192,s26,-v18
v_fma_f32 v193,v193,s26,-v18
v_fma_f32 v194,v194,s26,-v18
v_fma_f32 v195,v195,s26,-v18
v_fma_f32 v196,v196,s26,-v18
v_mfma_f32_16x16x32_bf16 v[92:95],a[124:127],v[252:255],v[92:95]
v_mfma_f32_16x16x32_bf16 v[92:95],a[120:123],v[248:251],v[92:95]
s_waitcnt lgkmcnt(12)
v_exp_f32 v192,v192
v_exp_f32 v193,v193
v_exp_f32 v194,v194
v_mfma_f32_16x16x32_bf16 a[208:211],a[128:131],v[248:251],a[208:211]
v_mfma_f32_16x16x32_bf16 a[208:211],a[132:135],v[252:255],a[208:211]
v_cvt_pk_bf16_f32 v164,v192,v193
v_exp_f32 v195,v195
v_exp_f32 v196,v196
v_mfma_f32_16x16x32_bf16 a[192:195],a[132:135],v[244:247],a[192:195]
v_mfma_f32_16x16x32_bf16 a[192:195],a[128:131],v[240:243],a[192:195]
s_waitcnt vmcnt(16)
s_waitcnt lgkmcnt(0)
s_barrier
ds_read_b128 a[96:99],v2 offset:49152
v_cvt_pk_bf16_f32 v165,v194,v195
v_fma_f32 v197,v197,s26,-v18
v_fma_f32 v198,v198,s26,-v18
v_fma_f32 v199,v199,s26,-v18
v_fma_f32 v200,v200,s26,-v19
v_mfma_f32_16x16x32_bf16 a[176:179],a[128:131],v[232:235],a[176:179]
s_add_u32 m0,s25,32768
v_mfma_f32_16x16x32_bf16 a[176:179],a[132:135],v[236:239],a[176:179]
buffer_load_dwordx4 v1,s[8:11],s21 offen nt lds
v_exp_f32 v197,v197
v_fma_f32 v201,v201,s26,-v19
v_mfma_f32_16x16x32_bf16 a[160:163],a[132:135],v[228:231],a[160:163]
v_mfma_f32_16x16x32_bf16 a[160:163],a[128:131],v[224:227],a[160:163]
ds_read_b128 a[100:103],v3 offset:49152
v_exp_f32 v198,v198
v_exp_f32 v199,v199
v_mfma_f32_16x16x32_bf16 a[164:167],a[136:139],v[224:227],a[164:167]
v_mfma_f32_16x16x32_bf16 a[164:167],a[140:143],v[228:231],a[164:167]
v_exp_f32 v200,v200
v_exp_f32 v201,v201
v_cvt_pk_bf16_f32 v166,v196,v197
v_cvt_pk_bf16_f32 v167,v198,v199
v_mfma_f32_16x16x32_bf16 a[180:183],a[140:143],v[236:239],a[180:183]
ds_read_b128 a[104:107],v4 offset:49152
v_mfma_f32_16x16x32_bf16 a[180:183],a[136:139],v[232:235],a[180:183]
v_cvt_pk_bf16_f32 v172,v200,v201
v_fma_f32 v202,v202,s26,-v19
v_fma_f32 v203,v203,s26,-v19
v_fma_f32 v204,v204,s26,-v19
v_fma_f32 v205,v205,s26,-v19
v_mfma_f32_16x16x32_bf16 a[196:199],a[136:139],v[240:243],a[196:199]
v_mfma_f32_16x16x32_bf16 a[196:199],a[140:143],v[244:247],a[196:199]
buffer_load_dwordx4 v1,s[8:11],s21 offen offset:1024 nt lds
v_exp_f32 v202,v202
v_fma_f32 v206,v206,s26,-v19
v_mfma_f32_16x16x32_bf16 a[212:215],a[140:143],v[252:255],a[212:215]
ds_read_b128 a[108:111],v5 offset:49152
v_mfma_f32_16x16x32_bf16 a[212:215],a[136:139],v[248:251],a[212:215]
v_exp_f32 v203,v203
v_exp_f32 v204,v204
v_exp_f32 v205,v205
v_mfma_f32_16x16x32_bf16 a[216:219],a[144:147],v[248:251],a[216:219]
v_mfma_f32_16x16x32_bf16 a[216:219],a[148:151],v[252:255],a[216:219]
v_cvt_pk_bf16_f32 v173,v202,v203
v_exp_f32 v206,v206
v_cvt_pk_bf16_f32 v174,v204,v205
v_fma_f32 v207,v207,s26,-v19
v_mfma_f32_16x16x32_bf16 a[200:203],a[148:151],v[244:247],a[200:203]
ds_read_b128 a[112:115],v2 offset:50176
v_mfma_f32_16x16x32_bf16 a[200:203],a[144:147],v[240:243],a[200:203]
v_exp_f32 v207,v207
v_fma_f32 v208,v208,s26,-v20
v_fma_f32 v209,v209,s26,-v20
v_fma_f32 v210,v210,s26,-v20
v_fma_f32 v211,v211,s26,-v20
v_mfma_f32_16x16x32_bf16 a[184:187],a[144:147],v[232:235],a[184:187]
v_mfma_f32_16x16x32_bf16 a[184:187],a[148:151],v[236:239],a[184:187]
ds_read_b128 a[116:119],v3 offset:50176
v_exp_f32 v208,v208
v_exp_f32 v209,v209
v_mfma_f32_16x16x32_bf16 a[168:171],a[148:151],v[228:231],a[168:171]
v_mfma_f32_16x16x32_bf16 a[168:171],a[144:147],v[224:227],a[168:171]
v_cvt_pk_bf16_f32 v175,v206,v207
v_exp_f32 v210,v210
v_exp_f32 v211,v211
v_mfma_f32_16x16x32_bf16 a[172:175],a[152:155],v[224:227],a[172:175]
v_mfma_f32_16x16x32_bf16 a[172:175],a[156:159],v[228:231],a[172:175]
ds_read_b128 a[120:123],v4 offset:50176
v_cvt_pk_bf16_f32 v180,v208,v209
v_cvt_pk_bf16_f32 v181,v210,v211
v_fma_f32 v212,v212,s26,-v20
v_fma_f32 v213,v213,s26,-v20
v_fma_f32 v214,v214,s26,-v20
v_mfma_f32_16x16x32_bf16 a[188:191],a[156:159],v[236:239],a[188:191]
v_mfma_f32_16x16x32_bf16 a[188:191],a[152:155],v[232:235],a[188:191]
buffer_load_dwordx4 v1,s[8:11],s21 offen offset:2048 nt lds
v_exp_f32 v212,v212
v_fma_f32 v215,v215,s26,-v20
v_mfma_f32_16x16x32_bf16 a[204:207],a[152:155],v[240:243],a[204:207]
v_mfma_f32_16x16x32_bf16 a[204:207],a[156:159],v[244:247],a[204:207]
ds_read_b128 a[124:127],v5 offset:50176
v_exp_f32 v213,v213
v_exp_f32 v214,v214
v_fma_f32 v216,v216,s26,-v21
v_mfma_f32_16x16x32_bf16 a[220:223],a[156:159],v[252:255],a[220:223]
v_mfma_f32_16x16x32_bf16 a[220:223],a[152:155],v[248:251],a[220:223]
s_waitcnt lgkmcnt(4)
v_cvt_pk_bf16_f32 v182,v212,v213
v_exp_f32 v215,v215
v_exp_f32 v216,v216
v_mfma_f32_16x16x32_bf16 v[224:227],a[96:99],a[0:3],0
ds_read_b128 a[128:131],v2 offset:51200
v_mfma_f32_16x16x32_bf16 v[224:227],a[100:103],a[4:7],v[224:227]
v_mfma_f32_16x16x32_bf16 v[224:227],a[104:107],a[8:11],v[224:227]
v_mfma_f32_16x16x32_bf16 v[224:227],a[108:111],a[12:15],v[224:227]
buffer_load_dwordx4 v1,s[8:11],s21 offen offset:3072 nt lds
v_cvt_pk_bf16_f32 v183,v214,v215
v_fma_f32 v217,v217,s26,-v21
v_fma_f32 v218,v218,s26,-v21
v_mfma_f32_16x16x32_bf16 v[232:235],a[108:111],a[28:31],0
s_add_u32 s21,s21,16384
ds_read_b128 a[132:135],v3 offset:51200
v_mfma_f32_16x16x32_bf16 v[232:235],a[104:107],a[24:27],v[232:235]
v_mfma_f32_16x16x32_bf16 v[232:235],a[100:103],a[20:23],v[232:235]
v_mfma_f32_16x16x32_bf16 v[232:235],a[96:99],a[16:19],v[232:235]
v_exp_f32 v217,v217
v_exp_f32 v218,v218
v_fma_f32 v219,v219,s26,-v21
v_fma_f32 v220,v220,s26,-v21
v_mfma_f32_16x16x32_bf16 v[240:243],a[96:99],a[32:35],0
ds_read_b128 a[136:139],v4 offset:51200
v_mfma_f32_16x16x32_bf16 v[240:243],a[100:103],a[36:39],v[240:243]
v_mfma_f32_16x16x32_bf16 v[240:243],a[104:107],a[40:43],v[240:243]
v_mfma_f32_16x16x32_bf16 v[240:243],a[108:111],a[44:47],v[240:243]
ds_read_b128 a[140:143],v5 offset:51200
v_exp_f32 v219,v219
v_exp_f32 v220,v220
v_mfma_f32_16x16x32_bf16 v[248:251],a[108:111],a[60:63],0
v_mfma_f32_16x16x32_bf16 v[248:251],a[104:107],a[56:59],v[248:251]
v_mfma_f32_16x16x32_bf16 v[248:251],a[100:103],a[52:55],v[248:251]
s_waitcnt lgkmcnt(4)
v_mfma_f32_16x16x32_bf16 v[248:251],a[96:99],a[48:51],v[248:251]
ds_read_b128 a[144:147],v2 offset:52224
v_cvt_pk_bf16_f32 v188,v216,v217
v_cvt_pk_bf16_f32 v189,v218,v219
v_fma_f32 v221,v221,s26,-v21
v_fma_f32 v222,v222,s26,-v21
v_mfma_f32_16x16x32_bf16 v[228:231],a[112:115],a[0:3],0
v_mfma_f32_16x16x32_bf16 v[228:231],a[116:119],a[4:7],v[228:231]
v_mfma_f32_16x16x32_bf16 v[228:231],a[120:123],a[8:11],v[228:231]
v_mfma_f32_16x16x32_bf16 v[228:231],a[124:127],a[12:15],v[228:231]
ds_read_b128 a[148:151],v3 offset:52224
v_exp_f32 v221,v221
v_fma_f32 v223,v223,s26,-v21
v_exp_f32 v222,v222
v_mfma_f32_16x16x32_bf16 v[236:239],a[124:127],a[28:31],0
v_mfma_f32_16x16x32_bf16 v[236:239],a[120:123],a[24:27],v[236:239]
v_mfma_f32_16x16x32_bf16 v[236:239],a[116:119],a[20:23],v[236:239]
s_add_u32 m0,s25,81920
ds_read_b128 a[152:155],v4 offset:52224
v_mfma_f32_16x16x32_bf16 v[236:239],a[112:115],a[16:19],v[236:239]
buffer_load_dwordx4 v1,s[12:15],s22 offen nt lds
v_cvt_pk_bf16_f32 v190,v220,v221
v_exp_f32 v223,v223
v_mfma_f32_16x16x32_bf16 v[244:247],a[112:115],a[32:35],0
v_mfma_f32_16x16x32_bf16 v[244:247],a[116:119],a[36:39],v[244:247]
v_mfma_f32_16x16x32_bf16 v[244:247],a[120:123],a[40:43],v[244:247]
ds_read_b128 a[156:159],v5 offset:52224
v_mfma_f32_16x16x32_bf16 v[244:247],a[124:127],a[44:47],v[244:247]
v_cvt_pk_bf16_f32 v191,v222,v223
v_mfma_f32_16x16x32_bf16 v[252:255],a[124:127],a[60:63],0
v_mfma_f32_16x16x32_bf16 v[252:255],a[120:123],a[56:59],v[252:255]
v_mfma_f32_16x16x32_bf16 v[252:255],a[116:119],a[52:55],v[252:255]
v_mfma_f32_16x16x32_bf16 v[252:255],a[112:115],a[48:51],v[252:255]
s_waitcnt lgkmcnt(4)
v_mfma_f32_16x16x32_bf16 v[192:195],a[128:131],a[0:3],0
v_mfma_f32_16x16x32_bf16 v[192:195],a[132:135],a[4:7],v[192:195]
v_mfma_f32_16x16x32_bf16 v[192:195],a[136:139],a[8:11],v[192:195]
v_mfma_f32_16x16x32_bf16 v[192:195],a[140:143],a[12:15],v[192:195]
buffer_load_dwordx4 v1,s[12:15],s22 offen offset:1024 nt lds
v_fma_f32 v224,v224,s26,-v18
v_fma_f32 v225,v225,s26,-v18
v_fma_f32 v226,v226,s26,-v18
v_mfma_f32_16x16x32_bf16 v[200:203],a[140:143],a[28:31],0
v_mfma_f32_16x16x32_bf16 v[200:203],a[136:139],a[24:27],v[200:203]
ds_read_b64_tr_b16 a[96:97],v6 offset:32768
v_mfma_f32_16x16x32_bf16 v[200:203],a[132:135],a[20:23],v[200:203]
ds_read_b64_tr_b16 a[98:99],v6 offset:33792
v_mfma_f32_16x16x32_bf16 v[200:203],a[128:131],a[16:19],v[200:203]
v_exp_f32 v224,v224
v_exp_f32 v225,v225
v_exp_f32 v226,v226
v_mfma_f32_16x16x32_bf16 v[208:211],a[128:131],a[32:35],0
ds_read_b64_tr_b16 a[100:101],v6 offset:34816
v_mfma_f32_16x16x32_bf16 v[208:211],a[132:135],a[36:39],v[208:211]
ds_read_b64_tr_b16 a[102:103],v6 offset:35840
v_mfma_f32_16x16x32_bf16 v[208:211],a[136:139],a[40:43],v[208:211]
v_mfma_f32_16x16x32_bf16 v[208:211],a[140:143],a[44:47],v[208:211]
buffer_load_dwordx4 v1,s[12:15],s22 offen offset:2048 nt lds
v_cvt_pk_bf16_f32 v224,v224,v225
v_fma_f32 v227,v227,s26,-v18
v_fma_f32 v228,v228,s26,-v18
v_mfma_f32_16x16x32_bf16 v[216:219],a[140:143],a[60:63],0
ds_read_b64_tr_b16 a[104:105],v6 offset:32776
v_mfma_f32_16x16x32_bf16 v[216:219],a[136:139],a[56:59],v[216:219]
ds_read_b64_tr_b16 a[106:107],v6 offset:33800
v_mfma_f32_16x16x32_bf16 v[216:219],a[132:135],a[52:55],v[216:219]
v_mfma_f32_16x16x32_bf16 v[216:219],a[128:131],a[48:51],v[216:219]
s_waitcnt lgkmcnt(6)
v_exp_f32 v227,v227
v_exp_f32 v228,v228
v_fma_f32 v229,v229,s26,-v18
v_fma_f32 v230,v230,s26,-v18
v_mfma_f32_16x16x32_bf16 v[196:199],a[144:147],a[0:3],0
ds_read_b64_tr_b16 a[108:109],v6 offset:34824
v_mfma_f32_16x16x32_bf16 v[196:199],a[148:151],a[4:7],v[196:199]
ds_read_b64_tr_b16 a[110:111],v6 offset:35848
v_mfma_f32_16x16x32_bf16 v[196:199],a[152:155],a[8:11],v[196:199]
v_mfma_f32_16x16x32_bf16 v[196:199],a[156:159],a[12:15],v[196:199]
ds_read_b64_tr_b16 a[112:113],v7 offset:32768
v_exp_f32 v229,v229
v_exp_f32 v230,v230
v_mfma_f32_16x16x32_bf16 v[204:207],a[156:159],a[28:31],0
ds_read_b64_tr_b16 a[114:115],v7 offset:33792
v_mfma_f32_16x16x32_bf16 v[204:207],a[152:155],a[24:27],v[204:207]
v_mfma_f32_16x16x32_bf16 v[204:207],a[148:151],a[20:23],v[204:207]
v_mfma_f32_16x16x32_bf16 v[204:207],a[144:147],a[16:19],v[204:207]
ds_read_b64_tr_b16 a[116:117],v7 offset:34816
v_cvt_pk_bf16_f32 v225,v226,v227
v_cvt_pk_bf16_f32 v226,v228,v229
v_fma_f32 v231,v231,s26,-v18
v_fma_f32 v232,v232,s26,-v19
v_mfma_f32_16x16x32_bf16 v[212:215],a[144:147],a[32:35],0
ds_read_b64_tr_b16 a[118:119],v7 offset:35840
v_mfma_f32_16x16x32_bf16 v[212:215],a[148:151],a[36:39],v[212:215]
v_mfma_f32_16x16x32_bf16 v[212:215],a[152:155],a[40:43],v[212:215]
v_mfma_f32_16x16x32_bf16 v[212:215],a[156:159],a[44:47],v[212:215]
ds_read_b64_tr_b16 a[120:121],v7 offset:32776
v_exp_f32 v231,v231
v_fma_f32 v233,v233,s26,-v19
v_exp_f32 v232,v232
v_mfma_f32_16x16x32_bf16 v[220:223],a[156:159],a[60:63],0
ds_read_b64_tr_b16 a[122:123],v7 offset:33800
v_mfma_f32_16x16x32_bf16 v[220:223],a[152:155],a[56:59],v[220:223]
v_mfma_f32_16x16x32_bf16 v[220:223],a[148:151],a[52:55],v[220:223]
ds_read_b64_tr_b16 a[124:125],v7 offset:34824
v_mfma_f32_16x16x32_bf16 v[220:223],a[144:147],a[48:51],v[220:223]
s_waitcnt lgkmcnt(14)
ds_read_b64_tr_b16 a[126:127],v7 offset:35848
v_exp_f32 v233,v233
v_cvt_pk_bf16_f32 v227,v230,v231
v_fma_f32 v234,v234,s26,-v19
v_mfma_f32_16x16x32_bf16 a[224:227],a[240:243],v[160:163],a[224:227]
v_mfma_f32_16x16x32_bf16 a[224:227],a[240:243],v[164:167],a[224:227]
buffer_load_dwordx4 v1,s[12:15],s22 offen offset:3072 nt lds
v_cvt_pk_bf16_f32 v232,v232,v233
v_exp_f32 v234,v234
v_mfma_f32_16x16x32_bf16 a[228:231],a[240:243],v[168:171],a[228:231]
s_add_u32 s22,s22,16384
s_waitcnt lgkmcnt(14)
ds_read_b64_tr_b16 a[128:129],v8 offset:32768
v_mfma_f32_16x16x32_bf16 a[228:231],a[240:243],v[172:175],a[228:231]
s_waitcnt lgkmcnt(14)
ds_read_b64_tr_b16 a[130:131],v8 offset:33792
v_fma_f32 v235,v235,s26,-v19
v_fma_f32 v236,v236,s26,-v19
v_fma_f32 v237,v237,s26,-v19
v_fma_f32 v238,v238,s26,-v19
v_fma_f32 v239,v239,s26,-v19
v_mfma_f32_16x16x32_bf16 a[232:235],a[240:243],v[176:179],a[232:235]
v_mfma_f32_16x16x32_bf16 a[232:235],a[240:243],v[180:183],a[232:235]
s_waitcnt lgkmcnt(14)
v_exp_f32 v235,v235
v_exp_f32 v236,v236
v_fma_f32 v240,v240,s26,-v20
v_mfma_f32_16x16x32_bf16 a[236:239],a[240:243],v[184:187],a[236:239]
ds_read_b64_tr_b16 a[132:133],v8 offset:34816
v_mfma_f32_16x16x32_bf16 a[236:239],a[240:243],v[188:191],a[236:239]
s_waitcnt lgkmcnt(14)
ds_read_b64_tr_b16 a[134:135],v8 offset:35840
v_cvt_pk_bf16_f32 v233,v234,v235
v_exp_f32 v237,v237
v_exp_f32 v238,v238
v_mfma_f32_16x16x32_bf16 v[80:83],a[96:99],v[184:187],v[80:83]
v_mfma_f32_16x16x32_bf16 v[80:83],a[100:103],v[188:191],v[80:83]
s_waitcnt lgkmcnt(14)
ds_read_b64_tr_b16 a[136:137],v8 offset:32776
v_exp_f32 v239,v239
v_exp_f32 v240,v240
v_mfma_f32_16x16x32_bf16 v[64:67],a[100:103],v[180:183],v[64:67]
s_waitcnt lgkmcnt(14)
ds_read_b64_tr_b16 a[138:139],v8 offset:33800
v_mfma_f32_16x16x32_bf16 v[64:67],a[96:99],v[176:179],v[64:67]
v_cvt_pk_bf16_f32 v234,v236,v237
v_cvt_pk_bf16_f32 v235,v238,v239
v_fma_f32 v241,v241,s26,-v20
v_fma_f32 v242,v242,s26,-v20
v_fma_f32 v243,v243,s26,-v20
v_mfma_f32_16x16x32_bf16 v[48:51],a[96:99],v[168:171],v[48:51]
v_mfma_f32_16x16x32_bf16 v[48:51],a[100:103],v[172:175],v[48:51]
s_waitcnt lgkmcnt(14)
ds_read_b64_tr_b16 a[140:141],v8 offset:34824
v_exp_f32 v241,v241
v_exp_f32 v242,v242
v_fma_f32 v244,v244,s26,-v20
v_mfma_f32_16x16x32_bf16 v[32:35],a[100:103],v[164:167],v[32:35]
s_waitcnt lgkmcnt(14)
ds_read_b64_tr_b16 a[142:143],v8 offset:35848
v_mfma_f32_16x16x32_bf16 v[32:35],a[96:99],v[160:163],v[32:35]
v_cvt_pk_bf16_f32 v240,v240,v241
v_exp_f32 v243,v243
v_exp_f32 v244,v244
v_mfma_f32_16x16x32_bf16 v[36:39],a[104:107],v[160:163],v[36:39]
v_mfma_f32_16x16x32_bf16 v[36:39],a[108:111],v[164:167],v[36:39]
s_waitcnt lgkmcnt(14)
ds_read_b64_tr_b16 a[144:145],v9 offset:32768
v_cvt_pk_bf16_f32 v241,v242,v243
v_fma_f32 v245,v245,s26,-v20
v_fma_f32 v246,v246,s26,-v20
v_fma_f32 v247,v247,s26,-v20
v_fma_f32 v248,v248,s26,-v21
v_mfma_f32_16x16x32_bf16 v[52:55],a[108:111],v[172:175],v[52:55]
s_waitcnt lgkmcnt(14)
ds_read_b64_tr_b16 a[146:147],v9 offset:33792
v_mfma_f32_16x16x32_bf16 v[52:55],a[104:107],v[168:171],v[52:55]
v_exp_f32 v245,v245
v_exp_f32 v246,v246
v_fma_f32 v249,v249,s26,-v21
v_mfma_f32_16x16x32_bf16 v[68:71],a[104:107],v[176:179],v[68:71]
s_waitcnt lgkmcnt(14)
ds_read_b64_tr_b16 a[148:149],v9 offset:34816
v_mfma_f32_16x16x32_bf16 v[68:71],a[108:111],v[180:183],v[68:71]
s_waitcnt lgkmcnt(14)
ds_read_b64_tr_b16 a[150:151],v9 offset:35840
v_exp_f32 v247,v247
v_exp_f32 v248,v248
v_mfma_f32_16x16x32_bf16 v[84:87],a[108:111],v[188:191],v[84:87]
v_mfma_f32_16x16x32_bf16 v[84:87],a[104:107],v[184:187],v[84:87]
v_exp_f32 v249,v249
v_cvt_pk_bf16_f32 v242,v244,v245
v_cvt_pk_bf16_f32 v243,v246,v247
v_fma_f32 v250,v250,s26,-v21
v_fma_f32 v251,v251,s26,-v21
v_mfma_f32_16x16x32_bf16 v[88:91],a[112:115],v[184:187],v[88:91]
s_waitcnt lgkmcnt(14)
ds_read_b64_tr_b16 a[152:153],v9 offset:32776
v_mfma_f32_16x16x32_bf16 v[88:91],a[116:119],v[188:191],v[88:91]
s_waitcnt lgkmcnt(14)
ds_read_b64_tr_b16 a[154:155],v9 offset:33800
v_exp_f32 v250,v250
v_exp_f32 v251,v251
v_mfma_f32_16x16x32_bf16 v[72:75],a[116:119],v[180:183],v[72:75]
v_mfma_f32_16x16x32_bf16 v[72:75],a[112:115],v[176:179],v[72:75]
s_waitcnt lgkmcnt(14)
ds_read_b64_tr_b16 a[156:157],v9 offset:34824
v_cvt_pk_bf16_f32 v248,v248,v249
v_cvt_pk_bf16_f32 v249,v250,v251
v_fma_f32 v252,v252,s26,-v21
v_fma_f32 v253,v253,s26,-v21
v_mfma_f32_16x16x32_bf16 v[56:59],a[112:115],v[168:171],v[56:59]
s_waitcnt lgkmcnt(14)
ds_read_b64_tr_b16 a[158:159],v9 offset:35848
v_mfma_f32_16x16x32_bf16 v[56:59],a[116:119],v[172:175],v[56:59]
v_exp_f32 v252,v252
v_exp_f32 v253,v253
v_fma_f32 v254,v254,s26,-v21
v_fma_f32 v255,v255,s26,-v21
v_mfma_f32_16x16x32_bf16 v[40:43],a[116:119],v[164:167],v[40:43]
v_mfma_f32_16x16x32_bf16 v[40:43],a[112:115],v[160:163],v[40:43]
v_cvt_pk_bf16_f32 v250,v252,v253
v_exp_f32 v254,v254
v_exp_f32 v255,v255
v_mfma_f32_16x16x32_bf16 v[44:47],a[120:123],v[160:163],v[44:47]
v_mfma_f32_16x16x32_bf16 v[44:47],a[124:127],v[164:167],v[44:47]
v_cvt_pk_bf16_f32 v251,v254,v255
v_mfma_f32_16x16x32_bf16 v[60:63],a[124:127],v[172:175],v[60:63]
v_mfma_f32_16x16x32_bf16 v[60:63],a[120:123],v[168:171],v[60:63]
v_mfma_f32_16x16x32_bf16 v[76:79],a[120:123],v[176:179],v[76:79]
v_mfma_f32_16x16x32_bf16 v[76:79],a[124:127],v[180:183],v[76:79]
v_fma_f32 v192,v192,s26,-v18
v_fma_f32 v193,v193,s26,-v18
v_fma_f32 v194,v194,s26,-v18
v_fma_f32 v195,v195,s26,-v18
v_fma_f32 v196,v196,s26,-v18
v_mfma_f32_16x16x32_bf16 v[92:95],a[124:127],v[188:191],v[92:95]
v_mfma_f32_16x16x32_bf16 v[92:95],a[120:123],v[184:187],v[92:95]
s_waitcnt lgkmcnt(12)
v_exp_f32 v192,v192
v_exp_f32 v193,v193
v_exp_f32 v194,v194
v_mfma_f32_16x16x32_bf16 a[208:211],a[128:131],v[184:187],a[208:211]
v_mfma_f32_16x16x32_bf16 a[208:211],a[132:135],v[188:191],a[208:211]
v_cvt_pk_bf16_f32 v228,v192,v193
v_exp_f32 v195,v195
v_exp_f32 v196,v196
v_mfma_f32_16x16x32_bf16 a[192:195],a[132:135],v[180:183],a[192:195]
v_mfma_f32_16x16x32_bf16 a[192:195],a[128:131],v[176:179],a[192:195]
s_waitcnt vmcnt(16)
s_waitcnt lgkmcnt(0)
s_barrier
ds_read_b128 a[96:99],v2 offset:0
v_cvt_pk_bf16_f32 v229,v194,v195
v_fma_f32 v197,v197,s26,-v18
v_fma_f32 v198,v198,s26,-v18
v_fma_f32 v199,v199,s26,-v18
v_fma_f32 v200,v200,s26,-v19
v_mfma_f32_16x16x32_bf16 a[176:179],a[128:131],v[168:171],a[176:179]
s_add_u32 m0,s25,49152
v_mfma_f32_16x16x32_bf16 a[176:179],a[132:135],v[172:175],a[176:179]
buffer_load_dwordx4 v1,s[8:11],s21 offen nt lds
v_exp_f32 v197,v197
v_fma_f32 v201,v201,s26,-v19
v_mfma_f32_16x16x32_bf16 a[160:163],a[132:135],v[164:167],a[160:163]
v_mfma_f32_16x16x32_bf16 a[160:163],a[128:131],v[160:163],a[160:163]
ds_read_b128 a[100:103],v3 offset:0
v_exp_f32 v198,v198
v_exp_f32 v199,v199
v_mfma_f32_16x16x32_bf16 a[164:167],a[136:139],v[160:163],a[164:167]
v_mfma_f32_16x16x32_bf16 a[164:167],a[140:143],v[164:167],a[164:167]
v_exp_f32 v200,v200
v_exp_f32 v201,v201
v_cvt_pk_bf16_f32 v230,v196,v197
v_cvt_pk_bf16_f32 v231,v198,v199
v_mfma_f32_16x16x32_bf16 a[180:183],a[140:143],v[172:175],a[180:183]
ds_read_b128 a[104:107],v4 offset:0
v_mfma_f32_16x16x32_bf16 a[180:183],a[136:139],v[168:171],a[180:183]
v_cvt_pk_bf16_f32 v236,v200,v201
v_fma_f32 v202,v202,s26,-v19
v_fma_f32 v203,v203,s26,-v19
v_fma_f32 v204,v204,s26,-v19
v_fma_f32 v205,v205,s26,-v19
v_mfma_f32_16x16x32_bf16 a[196:199],a[136:139],v[176:179],a[196:199]
v_mfma_f32_16x16x32_bf16 a[196:199],a[140:143],v[180:183],a[196:199]
buffer_load_dwordx4 v1,s[8:11],s21 offen offset:1024 nt lds
v_exp_f32 v202,v202
v_fma_f32 v206,v206,s26,-v19
v_mfma_f32_16x16x32_bf16 a[212:215],a[140:143],v[188:191],a[212:215]
ds_read_b128 a[108:111],v5 offset:0
v_mfma_f32_16x16x32_bf16 a[212:215],a[136:139],v[184:187],a[212:215]
v_exp_f32 v203,v203
v_exp_f32 v204,v204
v_exp_f32 v205,v205
v_mfma_f32_16x16x32_bf16 a[216:219],a[144:147],v[184:187],a[216:219]
v_mfma_f32_16x16x32_bf16 a[216:219],a[148:151],v[188:191],a[216:219]
v_cvt_pk_bf16_f32 v237,v202,v203
v_exp_f32 v206,v206
v_cvt_pk_bf16_f32 v238,v204,v205
v_fma_f32 v207,v207,s26,-v19
v_mfma_f32_16x16x32_bf16 a[200:203],a[148:151],v[180:183],a[200:203]
ds_read_b128 a[112:115],v2 offset:1024
v_mfma_f32_16x16x32_bf16 a[200:203],a[144:147],v[176:179],a[200:203]
v_exp_f32 v207,v207
v_fma_f32 v208,v208,s26,-v20
v_fma_f32 v209,v209,s26,-v20
v_fma_f32 v210,v210,s26,-v20
v_fma_f32 v211,v211,s26,-v20
v_mfma_f32_16x16x32_bf16 a[184:187],a[144:147],v[168:171],a[184:187]
v_mfma_f32_16x16x32_bf16 a[184:187],a[148:151],v[172:175],a[184:187]
ds_read_b128 a[116:119],v3 offset:1024
v_exp_f32 v208,v208
v_exp_f32 v209,v209
v_mfma_f32_16x16x32_bf16 a[168:171],a[148:151],v[164:167],a[168:171]
v_mfma_f32_16x16x32_bf16 a[168:171],a[144:147],v[160:163],a[168:171]
v_cvt_pk_bf16_f32 v239,v206,v207
v_exp_f32 v210,v210
v_exp_f32 v211,v211
v_mfma_f32_16x16x32_bf16 a[172:175],a[152:155],v[160:163],a[172:175]
v_mfma_f32_16x16x32_bf16 a[172:175],a[156:159],v[164:167],a[172:175]
ds_read_b128 a[120:123],v4 offset:1024
v_cvt_pk_bf16_f32 v244,v208,v209
v_cvt_pk_bf16_f32 v245,v210,v211
v_fma_f32 v212,v212,s26,-v20
v_fma_f32 v213,v213,s26,-v20
v_fma_f32 v214,v214,s26,-v20
v_mfma_f32_16x16x32_bf16 a[188:191],a[156:159],v[172:175],a[188:191]
v_mfma_f32_16x16x32_bf16 a[188:191],a[152:155],v[168:171],a[188:191]
buffer_load_dwordx4 v1,s[8:11],s21 offen offset:2048 nt lds
v_exp_f32 v212,v212
v_fma_f32 v215,v215,s26,-v20
v_mfma_f32_16x16x32_bf16 a[204:207],a[152:155],v[176:179],a[204:207]
v_mfma_f32_16x16x32_bf16 a[204:207],a[156:159],v[180:183],a[204:207]
ds_read_b128 a[124:127],v5 offset:1024
v_exp_f32 v213,v213
v_exp_f32 v214,v214
v_fma_f32 v216,v216,s26,-v21
v_mfma_f32_16x16x32_bf16 a[220:223],a[156:159],v[188:191],a[220:223]
v_mfma_f32_16x16x32_bf16 a[220:223],a[152:155],v[184:187],a[220:223]
s_waitcnt lgkmcnt(4)
v_cvt_pk_bf16_f32 v246,v212,v213
v_exp_f32 v215,v215
v_exp_f32 v216,v216
v_mfma_f32_16x16x32_bf16 v[160:163],a[96:99],a[0:3],0
ds_read_b128 a[128:131],v2 offset:2048
v_mfma_f32_16x16x32_bf16 v[160:163],a[100:103],a[4:7],v[160:163]
v_mfma_f32_16x16x32_bf16 v[160:163],a[104:107],a[8:11],v[160:163]
v_mfma_f32_16x16x32_bf16 v[160:163],a[108:111],a[12:15],v[160:163]
buffer_load_dwordx4 v1,s[8:11],s21 offen offset:3072 nt lds
v_cvt_pk_bf16_f32 v247,v214,v215
v_fma_f32 v217,v217,s26,-v21
v_fma_f32 v218,v218,s26,-v21
v_mfma_f32_16x16x32_bf16 v[168:171],a[108:111],a[28:31],0
s_add_u32 s21,s21,16384
ds_read_b128 a[132:135],v3 offset:2048
v_mfma_f32_16x16x32_bf16 v[168:171],a[104:107],a[24:27],v[168:171]
v_mfma_f32_16x16x32_bf16 v[168:171],a[100:103],a[20:23],v[168:171]
v_mfma_f32_16x16x32_bf16 v[168:171],a[96:99],a[16:19],v[168:171]
v_exp_f32 v217,v217
v_exp_f32 v218,v218
v_fma_f32 v219,v219,s26,-v21
v_fma_f32 v220,v220,s26,-v21
v_mfma_f32_16x16x32_bf16 v[176:179],a[96:99],a[32:35],0
ds_read_b128 a[136:139],v4 offset:2048
v_mfma_f32_16x16x32_bf16 v[176:179],a[100:103],a[36:39],v[176:179]
v_mfma_f32_16x16x32_bf16 v[176:179],a[104:107],a[40:43],v[176:179]
v_mfma_f32_16x16x32_bf16 v[176:179],a[108:111],a[44:47],v[176:179]
ds_read_b128 a[140:143],v5 offset:2048
v_exp_f32 v219,v219
v_exp_f32 v220,v220
v_mfma_f32_16x16x32_bf16 v[184:187],a[108:111],a[60:63],0
v_mfma_f32_16x16x32_bf16 v[184:187],a[104:107],a[56:59],v[184:187]
v_mfma_f32_16x16x32_bf16 v[184:187],a[100:103],a[52:55],v[184:187]
s_waitcnt lgkmcnt(4)
v_mfma_f32_16x16x32_bf16 v[184:187],a[96:99],a[48:51],v[184:187]
ds_read_b128 a[144:147],v2 offset:3072
v_cvt_pk_bf16_f32 v252,v216,v217
v_cvt_pk_bf16_f32 v253,v218,v219
v_fma_f32 v221,v221,s26,-v21
v_fma_f32 v222,v222,s26,-v21
v_mfma_f32_16x16x32_bf16 v[164:167],a[112:115],a[0:3],0
v_mfma_f32_16x16x32_bf16 v[164:167],a[116:119],a[4:7],v[164:167]
v_mfma_f32_16x16x32_bf16 v[164:167],a[120:123],a[8:11],v[164:167]
v_mfma_f32_16x16x32_bf16 v[164:167],a[124:127],a[12:15],v[164:167]
ds_read_b128 a[148:151],v3 offset:3072
v_exp_f32 v221,v221
v_fma_f32 v223,v223,s26,-v21
v_exp_f32 v222,v222
v_mfma_f32_16x16x32_bf16 v[172:175],a[124:127],a[28:31],0
v_mfma_f32_16x16x32_bf16 v[172:175],a[120:123],a[24:27],v[172:175]
v_mfma_f32_16x16x32_bf16 v[172:175],a[116:119],a[20:23],v[172:175]
s_add_u32 m0,s25,98304
ds_read_b128 a[152:155],v4 offset:3072
v_mfma_f32_16x16x32_bf16 v[172:175],a[112:115],a[16:19],v[172:175]
buffer_load_dwordx4 v1,s[12:15],s22 offen nt lds
v_cvt_pk_bf16_f32 v254,v220,v221
v_exp_f32 v223,v223
v_mfma_f32_16x16x32_bf16 v[180:183],a[112:115],a[32:35],0
v_mfma_f32_16x16x32_bf16 v[180:183],a[116:119],a[36:39],v[180:183]
v_mfma_f32_16x16x32_bf16 v[180:183],a[120:123],a[40:43],v[180:183]
ds_read_b128 a[156:159],v5 offset:3072
v_mfma_f32_16x16x32_bf16 v[180:183],a[124:127],a[44:47],v[180:183]
v_cvt_pk_bf16_f32 v255,v222,v223
v_mfma_f32_16x16x32_bf16 v[188:191],a[124:127],a[60:63],0
v_mfma_f32_16x16x32_bf16 v[188:191],a[120:123],a[56:59],v[188:191]
v_mfma_f32_16x16x32_bf16 v[188:191],a[116:119],a[52:55],v[188:191]
v_mfma_f32_16x16x32_bf16 v[188:191],a[112:115],a[48:51],v[188:191]
s_waitcnt lgkmcnt(4)
v_mfma_f32_16x16x32_bf16 v[192:195],a[128:131],a[0:3],0
v_mfma_f32_16x16x32_bf16 v[192:195],a[132:135],a[4:7],v[192:195]
v_mfma_f32_16x16x32_bf16 v[192:195],a[136:139],a[8:11],v[192:195]
v_mfma_f32_16x16x32_bf16 v[192:195],a[140:143],a[12:15],v[192:195]
buffer_load_dwordx4 v1,s[12:15],s22 offen offset:1024 nt lds
v_fma_f32 v160,v160,s26,-v18
v_fma_f32 v161,v161,s26,-v18
v_fma_f32 v162,v162,s26,-v18
v_mfma_f32_16x16x32_bf16 v[200:203],a[140:143],a[28:31],0
v_mfma_f32_16x16x32_bf16 v[200:203],a[136:139],a[24:27],v[200:203]
ds_read_b64_tr_b16 a[96:97],v6 offset:49152
v_mfma_f32_16x16x32_bf16 v[200:203],a[132:135],a[20:23],v[200:203]
ds_read_b64_tr_b16 a[98:99],v6 offset:50176
v_mfma_f32_16x16x32_bf16 v[200:203],a[128:131],a[16:19],v[200:203]
v_exp_f32 v160,v160
v_exp_f32 v161,v161
v_exp_f32 v162,v162
v_mfma_f32_16x16x32_bf16 v[208:211],a[128:131],a[32:35],0
ds_read_b64_tr_b16 a[100:101],v6 offset:51200
v_mfma_f32_16x16x32_bf16 v[208:211],a[132:135],a[36:39],v[208:211]
ds_read_b64_tr_b16 a[102:103],v6 offset:52224
v_mfma_f32_16x16x32_bf16 v[208:211],a[136:139],a[40:43],v[208:211]
v_mfma_f32_16x16x32_bf16 v[208:211],a[140:143],a[44:47],v[208:211]
buffer_load_dwordx4 v1,s[12:15],s22 offen offset:2048 nt lds
v_cvt_pk_bf16_f32 v160,v160,v161
v_fma_f32 v163,v163,s26,-v18
v_fma_f32 v164,v164,s26,-v18
v_mfma_f32_16x16x32_bf16 v[216:219],a[140:143],a[60:63],0
ds_read_b64_tr_b16 a[104:105],v6 offset:49160
v_mfma_f32_16x16x32_bf16 v[216:219],a[136:139],a[56:59],v[216:219]
ds_read_b64_tr_b16 a[106:107],v6 offset:50184
v_mfma_f32_16x16x32_bf16 v[216:219],a[132:135],a[52:55],v[216:219]
v_mfma_f32_16x16x32_bf16 v[216:219],a[128:131],a[48:51],v[216:219]
s_waitcnt lgkmcnt(6)
v_exp_f32 v163,v163
v_exp_f32 v164,v164
v_fma_f32 v165,v165,s26,-v18
v_fma_f32 v166,v166,s26,-v18
v_mfma_f32_16x16x32_bf16 v[196:199],a[144:147],a[0:3],0
ds_read_b64_tr_b16 a[108:109],v6 offset:51208
v_mfma_f32_16x16x32_bf16 v[196:199],a[148:151],a[4:7],v[196:199]
ds_read_b64_tr_b16 a[110:111],v6 offset:52232
v_mfma_f32_16x16x32_bf16 v[196:199],a[152:155],a[8:11],v[196:199]
v_mfma_f32_16x16x32_bf16 v[196:199],a[156:159],a[12:15],v[196:199]
ds_read_b64_tr_b16 a[112:113],v7 offset:49152
v_exp_f32 v165,v165
v_exp_f32 v166,v166
v_mfma_f32_16x16x32_bf16 v[204:207],a[156:159],a[28:31],0
ds_read_b64_tr_b16 a[114:115],v7 offset:50176
v_mfma_f32_16x16x32_bf16 v[204:207],a[152:155],a[24:27],v[204:207]
v_mfma_f32_16x16x32_bf16 v[204:207],a[148:151],a[20:23],v[204:207]
v_mfma_f32_16x16x32_bf16 v[204:207],a[144:147],a[16:19],v[204:207]
ds_read_b64_tr_b16 a[116:117],v7 offset:51200
v_cvt_pk_bf16_f32 v161,v162,v163
v_cvt_pk_bf16_f32 v162,v164,v165
v_fma_f32 v167,v167,s26,-v18
v_fma_f32 v168,v168,s26,-v19
v_mfma_f32_16x16x32_bf16 v[212:215],a[144:147],a[32:35],0
ds_read_b64_tr_b16 a[118:119],v7 offset:52224
v_mfma_f32_16x16x32_bf16 v[212:215],a[148:151],a[36:39],v[212:215]
v_mfma_f32_16x16x32_bf16 v[212:215],a[152:155],a[40:43],v[212:215]
v_mfma_f32_16x16x32_bf16 v[212:215],a[156:159],a[44:47],v[212:215]
ds_read_b64_tr_b16 a[120:121],v7 offset:49160
v_exp_f32 v167,v167
v_fma_f32 v169,v169,s26,-v19
v_exp_f32 v168,v168
v_mfma_f32_16x16x32_bf16 v[220:223],a[156:159],a[60:63],0
ds_read_b64_tr_b16 a[122:123],v7 offset:50184
v_mfma_f32_16x16x32_bf16 v[220:223],a[152:155],a[56:59],v[220:223]
v_mfma_f32_16x16x32_bf16 v[220:223],a[148:151],a[52:55],v[220:223]
ds_read_b64_tr_b16 a[124:125],v7 offset:51208
v_mfma_f32_16x16x32_bf16 v[220:223],a[144:147],a[48:51],v[220:223]
s_waitcnt lgkmcnt(14)
ds_read_b64_tr_b16 a[126:127],v7 offset:52232
v_exp_f32 v169,v169
v_cvt_pk_bf16_f32 v163,v166,v167
v_fma_f32 v170,v170,s26,-v19
v_mfma_f32_16x16x32_bf16 a[224:227],a[240:243],v[224:227],a[224:227]
v_mfma_f32_16x16x32_bf16 a[224:227],a[240:243],v[228:231],a[224:227]
buffer_load_dwordx4 v1,s[12:15],s22 offen offset:3072 nt lds
v_cvt_pk_bf16_f32 v168,v168,v169
v_exp_f32 v170,v170
v_mfma_f32_16x16x32_bf16 a[228:231],a[240:243],v[232:235],a[228:231]
s_add_u32 s22,s22,16384
s_waitcnt lgkmcnt(14)
ds_read_b64_tr_b16 a[128:129],v8 offset:49152
v_mfma_f32_16x16x32_bf16 a[228:231],a[240:243],v[236:239],a[228:231]
s_waitcnt lgkmcnt(14)
ds_read_b64_tr_b16 a[130:131],v8 offset:50176
v_fma_f32 v171,v171,s26,-v19
v_fma_f32 v172,v172,s26,-v19
v_fma_f32 v173,v173,s26,-v19
v_fma_f32 v174,v174,s26,-v19
v_fma_f32 v175,v175,s26,-v19
v_mfma_f32_16x16x32_bf16 a[232:235],a[240:243],v[240:243],a[232:235]
v_mfma_f32_16x16x32_bf16 a[232:235],a[240:243],v[244:247],a[232:235]
s_waitcnt lgkmcnt(14)
v_exp_f32 v171,v171
v_exp_f32 v172,v172
v_fma_f32 v176,v176,s26,-v20
v_mfma_f32_16x16x32_bf16 a[236:239],a[240:243],v[248:251],a[236:239]
ds_read_b64_tr_b16 a[132:133],v8 offset:51200
v_mfma_f32_16x16x32_bf16 a[236:239],a[240:243],v[252:255],a[236:239]
s_waitcnt lgkmcnt(14)
ds_read_b64_tr_b16 a[134:135],v8 offset:52224
v_cvt_pk_bf16_f32 v169,v170,v171
v_exp_f32 v173,v173
v_exp_f32 v174,v174
v_mfma_f32_16x16x32_bf16 v[80:83],a[96:99],v[248:251],v[80:83]
v_mfma_f32_16x16x32_bf16 v[80:83],a[100:103],v[252:255],v[80:83]
s_waitcnt lgkmcnt(14)
ds_read_b64_tr_b16 a[136:137],v8 offset:49160
v_exp_f32 v175,v175
v_exp_f32 v176,v176
v_mfma_f32_16x16x32_bf16 v[64:67],a[100:103],v[244:247],v[64:67]
s_waitcnt lgkmcnt(14)
ds_read_b64_tr_b16 a[138:139],v8 offset:50184
v_mfma_f32_16x16x32_bf16 v[64:67],a[96:99],v[240:243],v[64:67]
v_cvt_pk_bf16_f32 v170,v172,v173
v_cvt_pk_bf16_f32 v171,v174,v175
v_fma_f32 v177,v177,s26,-v20
v_fma_f32 v178,v178,s26,-v20
v_fma_f32 v179,v179,s26,-v20
v_mfma_f32_16x16x32_bf16 v[48:51],a[96:99],v[232:235],v[48:51]
v_mfma_f32_16x16x32_bf16 v[48:51],a[100:103],v[236:239],v[48:51]
s_waitcnt lgkmcnt(14)
ds_read_b64_tr_b16 a[140:141],v8 offset:51208
v_exp_f32 v177,v177
v_exp_f32 v178,v178
v_fma_f32 v180,v180,s26,-v20
v_mfma_f32_16x16x32_bf16 v[32:35],a[100:103],v[228:231],v[32:35]
s_waitcnt lgkmcnt(14)
ds_read_b64_tr_b16 a[142:143],v8 offset:52232
v_mfma_f32_16x16x32_bf16 v[32:35],a[96:99],v[224:227],v[32:35]
v_cvt_pk_bf16_f32 v176,v176,v177
v_exp_f32 v179,v179
v_exp_f32 v180,v180
v_mfma_f32_16x16x32_bf16 v[36:39],a[104:107],v[224:227],v[36:39]
v_mfma_f32_16x16x32_bf16 v[36:39],a[108:111],v[228:231],v[36:39]
s_waitcnt lgkmcnt(14)
ds_read_b64_tr_b16 a[144:145],v9 offset:49152
v_cvt_pk_bf16_f32 v177,v178,v179
v_fma_f32 v181,v181,s26,-v20
v_fma_f32 v182,v182,s26,-v20
v_fma_f32 v183,v183,s26,-v20
v_fma_f32 v184,v184,s26,-v21
v_mfma_f32_16x16x32_bf16 v[52:55],a[108:111],v[236:239],v[52:55]
s_waitcnt lgkmcnt(14)
ds_read_b64_tr_b16 a[146:147],v9 offset:50176
v_mfma_f32_16x16x32_bf16 v[52:55],a[104:107],v[232:235],v[52:55]
v_exp_f32 v181,v181
v_exp_f32 v182,v182
v_fma_f32 v185,v185,s26,-v21
v_mfma_f32_16x16x32_bf16 v[68:71],a[104:107],v[240:243],v[68:71]
s_waitcnt lgkmcnt(14)
ds_read_b64_tr_b16 a[148:149],v9 offset:51200
v_mfma_f32_16x16x32_bf16 v[68:71],a[108:111],v[244:247],v[68:71]
s_waitcnt lgkmcnt(14)
ds_read_b64_tr_b16 a[150:151],v9 offset:52224
v_exp_f32 v183,v183
v_exp_f32 v184,v184
v_mfma_f32_16x16x32_bf16 v[84:87],a[108:111],v[252:255],v[84:87]
v_mfma_f32_16x16x32_bf16 v[84:87],a[104:107],v[248:251],v[84:87]
v_exp_f32 v185,v185
v_cvt_pk_bf16_f32 v178,v180,v181
v_cvt_pk_bf16_f32 v179,v182,v183
v_fma_f32 v186,v186,s26,-v21
v_fma_f32 v187,v187,s26,-v21
v_mfma_f32_16x16x32_bf16 v[88:91],a[112:115],v[248:251],v[88:91]
s_waitcnt lgkmcnt(14)
ds_read_b64_tr_b16 a[152:153],v9 offset:49160
v_mfma_f32_16x16x32_bf16 v[88:91],a[116:119],v[252:255],v[88:91]
s_waitcnt lgkmcnt(14)
ds_read_b64_tr_b16 a[154:155],v9 offset:50184
v_exp_f32 v186,v186
v_exp_f32 v187,v187
v_mfma_f32_16x16x32_bf16 v[72:75],a[116:119],v[244:247],v[72:75]
v_mfma_f32_16x16x32_bf16 v[72:75],a[112:115],v[240:243],v[72:75]
s_waitcnt lgkmcnt(14)
ds_read_b64_tr_b16 a[156:157],v9 offset:51208
v_cvt_pk_bf16_f32 v184,v184,v185
v_cvt_pk_bf16_f32 v185,v186,v187
v_fma_f32 v188,v188,s26,-v21
v_fma_f32 v189,v189,s26,-v21
v_mfma_f32_16x16x32_bf16 v[56:59],a[112:115],v[232:235],v[56:59]
s_waitcnt lgkmcnt(14)
ds_read_b64_tr_b16 a[158:159],v9 offset:52232
v_mfma_f32_16x16x32_bf16 v[56:59],a[116:119],v[236:239],v[56:59]
v_exp_f32 v188,v188
v_exp_f32 v189,v189
v_fma_f32 v190,v190,s26,-v21
v_fma_f32 v191,v191,s26,-v21
v_mfma_f32_16x16x32_bf16 v[40:43],a[116:119],v[228:231],v[40:43]
v_mfma_f32_16x16x32_bf16 v[40:43],a[112:115],v[224:227],v[40:43]
v_cvt_pk_bf16_f32 v186,v188,v189
v_exp_f32 v190,v190
v_exp_f32 v191,v191
v_mfma_f32_16x16x32_bf16 v[44:47],a[120:123],v[224:227],v[44:47]
v_mfma_f32_16x16x32_bf16 v[44:47],a[124:127],v[228:231],v[44:47]
v_cvt_pk_bf16_f32 v187,v190,v191
v_mfma_f32_16x16x32_bf16 v[60:63],a[124:127],v[236:239],v[60:63]
v_mfma_f32_16x16x32_bf16 v[60:63],a[120:123],v[232:235],v[60:63]
v_mfma_f32_16x16x32_bf16 v[76:79],a[120:123],v[240:243],v[76:79]
v_mfma_f32_16x16x32_bf16 v[76:79],a[124:127],v[244:247],v[76:79]
v_fma_f32 v192,v192,s26,-v18
v_fma_f32 v193,v193,s26,-v18
v_fma_f32 v194,v194,s26,-v18
v_fma_f32 v195,v195,s26,-v18
v_fma_f32 v196,v196,s26,-v18
v_mfma_f32_16x16x32_bf16 v[92:95],a[124:127],v[252:255],v[92:95]
v_mfma_f32_16x16x32_bf16 v[92:95],a[120:123],v[248:251],v[92:95]
s_waitcnt lgkmcnt(12)
v_exp_f32 v192,v192
v_exp_f32 v193,v193
v_exp_f32 v194,v194
v_mfma_f32_16x16x32_bf16 a[208:211],a[128:131],v[248:251],a[208:211]
v_mfma_f32_16x16x32_bf16 a[208:211],a[132:135],v[252:255],a[208:211]
v_cvt_pk_bf16_f32 v164,v192,v193
v_exp_f32 v195,v195
v_exp_f32 v196,v196
v_mfma_f32_16x16x32_bf16 a[192:195],a[132:135],v[244:247],a[192:195]
v_mfma_f32_16x16x32_bf16 a[192:195],a[128:131],v[240:243],a[192:195]
s_waitcnt vmcnt(16)
s_waitcnt lgkmcnt(0)
s_barrier
ds_read_b128 a[96:99],v2 offset:16384
v_cvt_pk_bf16_f32 v165,v194,v195
v_fma_f32 v197,v197,s26,-v18
v_fma_f32 v198,v198,s26,-v18
v_fma_f32 v199,v199,s26,-v18
v_mfma_f32_16x16x32_bf16 a[176:179],a[128:131],v[232:235],a[176:179]
s_add_u32 m0,s25,114688
v_mfma_f32_16x16x32_bf16 a[176:179],a[132:135],v[236:239],a[176:179]
buffer_load_dwordx4 v1,s[12:15],s22 offen nt lds
v_exp_f32 v197,v197
v_exp_f32 v198,v198
v_mfma_f32_16x16x32_bf16 a[160:163],a[132:135],v[228:231],a[160:163]
v_mfma_f32_16x16x32_bf16 a[160:163],a[128:131],v[224:227],a[160:163]
ds_read_b128 a[100:103],v3 offset:16384
v_exp_f32 v199,v199
v_cvt_pk_bf16_f32 v166,v196,v197
v_fma_f32 v200,v200,s26,-v19
v_mfma_f32_16x16x32_bf16 a[164:167],a[136:139],v[224:227],a[164:167]
v_mfma_f32_16x16x32_bf16 a[164:167],a[140:143],v[228:231],a[164:167]
v_cvt_pk_bf16_f32 v167,v198,v199
v_exp_f32 v200,v200
v_fma_f32 v201,v201,s26,-v19
v_fma_f32 v202,v202,s26,-v19
v_mfma_f32_16x16x32_bf16 a[180:183],a[140:143],v[236:239],a[180:183]
ds_read_b128 a[104:107],v4 offset:16384
v_mfma_f32_16x16x32_bf16 a[180:183],a[136:139],v[232:235],a[180:183]
v_exp_f32 v201,v201
v_fma_f32 v203,v203,s26,-v19
v_exp_f32 v202,v202
v_mfma_f32_16x16x32_bf16 a[196:199],a[136:139],v[240:243],a[196:199]
v_mfma_f32_16x16x32_bf16 a[196:199],a[140:143],v[244:247],a[196:199]
buffer_load_dwordx4 v1,s[12:15],s22 offen offset:1024 nt lds
v_exp_f32 v203,v203
v_cvt_pk_bf16_f32 v172,v200,v201
v_fma_f32 v204,v204,s26,-v19
v_mfma_f32_16x16x32_bf16 a[212:215],a[140:143],v[252:255],a[212:215]
ds_read_b128 a[108:111],v5 offset:16384
v_mfma_f32_16x16x32_bf16 a[212:215],a[136:139],v[248:251],a[212:215]
v_cvt_pk_bf16_f32 v173,v202,v203
v_exp_f32 v204,v204
v_fma_f32 v205,v205,s26,-v19
v_fma_f32 v206,v206,s26,-v19
v_mfma_f32_16x16x32_bf16 a[216:219],a[144:147],v[248:251],a[216:219]
v_mfma_f32_16x16x32_bf16 a[216:219],a[148:151],v[252:255],a[216:219]
v_exp_f32 v205,v205
v_fma_f32 v207,v207,s26,-v19
v_exp_f32 v206,v206
v_mfma_f32_16x16x32_bf16 a[200:203],a[148:151],v[244:247],a[200:203]
ds_read_b128 a[112:115],v2 offset:17408
v_mfma_f32_16x16x32_bf16 a[200:203],a[144:147],v[240:243],a[200:203]
v_exp_f32 v207,v207
v_cvt_pk_bf16_f32 v174,v204,v205
v_fma_f32 v208,v208,s26,-v20
v_fma_f32 v209,v209,s26,-v20
v_fma_f32 v210,v210,s26,-v20
v_mfma_f32_16x16x32_bf16 a[184:187],a[144:147],v[232:235],a[184:187]
v_mfma_f32_16x16x32_bf16 a[184:187],a[148:151],v[236:239],a[184:187]
ds_read_b128 a[116:119],v3 offset:17408
v_exp_f32 v208,v208
v_exp_f32 v209,v209
v_mfma_f32_16x16x32_bf16 a[168:171],a[148:151],v[228:231],a[168:171]
v_mfma_f32_16x16x32_bf16 a[168:171],a[144:147],v[224:227],a[168:171]
v_cvt_pk_bf16_f32 v175,v206,v207
v_exp_f32 v210,v210
v_cvt_pk_bf16_f32 v180,v208,v209
v_fma_f32 v211,v211,s26,-v20
v_mfma_f32_16x16x32_bf16 a[172:175],a[152:155],v[224:227],a[172:175]
v_mfma_f32_16x16x32_bf16 a[172:175],a[156:159],v[228:231],a[172:175]
ds_read_b128 a[120:123],v4 offset:17408
v_exp_f32 v211,v211
v_fma_f32 v212,v212,s26,-v20
v_fma_f32 v213,v213,s26,-v20
v_fma_f32 v214,v214,s26,-v20
v_mfma_f32_16x16x32_bf16 a[188:191],a[156:159],v[236:239],a[188:191]
v_mfma_f32_16x16x32_bf16 a[188:191],a[152:155],v[232:235],a[188:191]
buffer_load_dwordx4 v1,s[12:15],s22 offen offset:2048 nt lds
v_cvt_pk_bf16_f32 v181,v210,v211
v_exp_f32 v212,v212
v_mfma_f32_16x16x32_bf16 a[204:207],a[152:155],v[240:243],a[204:207]
v_mfma_f32_16x16x32_bf16 a[204:207],a[156:159],v[244:247],a[204:207]
ds_read_b128 a[124:127],v5 offset:17408
v_exp_f32 v213,v213
v_exp_f32 v214,v214
v_mfma_f32_16x16x32_bf16 a[220:223],a[156:159],v[252:255],a[220:223]
v_mfma_f32_16x16x32_bf16 a[220:223],a[152:155],v[248:251],a[220:223]
s_waitcnt lgkmcnt(4)
v_cvt_pk_bf16_f32 v182,v212,v213
v_fma_f32 v215,v215,s26,-v20
v_fma_f32 v216,v216,s26,-v21
v_fma_f32 v217,v217,s26,-v21
v_fma_f32 v218,v218,s26,-v21
v_fma_f32 v219,v219,s26,-v21
v_mfma_f32_16x16x32_bf16 v[224:227],a[96:99],a[0:3],0
ds_read_b128 a[128:131],v2 offset:18432
v_mfma_f32_16x16x32_bf16 v[224:227],a[100:103],a[4:7],v[224:227]
v_mfma_f32_16x16x32_bf16 v[224:227],a[104:107],a[8:11],v[224:227]
v_mfma_f32_16x16x32_bf16 v[224:227],a[108:111],a[12:15],v[224:227]
buffer_load_dwordx4 v1,s[12:15],s22 offen offset:3072 nt lds
v_exp_f32 v215,v215
v_fma_f32 v220,v220,s26,-v21
v_mfma_f32_16x16x32_bf16 v[232:235],a[108:111],a[28:31],0
s_add_u32 s22,s22,16384
ds_read_b128 a[132:135],v3 offset:18432
v_mfma_f32_16x16x32_bf16 v[232:235],a[104:107],a[24:27],v[232:235]
v_mfma_f32_16x16x32_bf16 v[232:235],a[100:103],a[20:23],v[232:235]
v_mfma_f32_16x16x32_bf16 v[232:235],a[96:99],a[16:19],v[232:235]
v_cvt_pk_bf16_f32 v183,v214,v215
v_exp_f32 v216,v216
v_exp_f32 v217,v217
v_mfma_f32_16x16x32_bf16 v[240:243],a[96:99],a[32:35],0
ds_read_b128 a[136:139],v4 offset:18432
v_mfma_f32_16x16x32_bf16 v[240:243],a[100:103],a[36:39],v[240:243]
v_mfma_f32_16x16x32_bf16 v[240:243],a[104:107],a[40:43],v[240:243]
v_mfma_f32_16x16x32_bf16 v[240:243],a[108:111],a[44:47],v[240:243]
ds_read_b128 a[140:143],v5 offset:18432
v_exp_f32 v218,v218
v_exp_f32 v219,v219
v_mfma_f32_16x16x32_bf16 v[248:251],a[108:111],a[60:63],0
v_mfma_f32_16x16x32_bf16 v[248:251],a[104:107],a[56:59],v[248:251]
v_mfma_f32_16x16x32_bf16 v[248:251],a[100:103],a[52:55],v[248:251]
s_waitcnt lgkmcnt(4)
v_mfma_f32_16x16x32_bf16 v[248:251],a[96:99],a[48:51],v[248:251]
ds_read_b128 a[144:147],v2 offset:19456
v_cvt_pk_bf16_f32 v188,v216,v217
v_exp_f32 v220,v220
v_cvt_pk_bf16_f32 v189,v218,v219
v_fma_f32 v221,v221,s26,-v21
v_mfma_f32_16x16x32_bf16 v[228:231],a[112:115],a[0:3],0
v_mfma_f32_16x16x32_bf16 v[228:231],a[116:119],a[4:7],v[228:231]
v_mfma_f32_16x16x32_bf16 v[228:231],a[120:123],a[8:11],v[228:231]
v_mfma_f32_16x16x32_bf16 v[228:231],a[124:127],a[12:15],v[228:231]
ds_read_b128 a[148:151],v3 offset:19456
v_exp_f32 v221,v221
v_fma_f32 v222,v222,s26,-v21
v_fma_f32 v223,v223,s26,-v21
v_mfma_f32_16x16x32_bf16 v[236:239],a[124:127],a[28:31],0
v_mfma_f32_16x16x32_bf16 v[236:239],a[120:123],a[24:27],v[236:239]
v_mfma_f32_16x16x32_bf16 v[236:239],a[116:119],a[20:23],v[236:239]
ds_read_b128 a[152:155],v4 offset:19456
v_mfma_f32_16x16x32_bf16 v[236:239],a[112:115],a[16:19],v[236:239]
v_cvt_pk_bf16_f32 v190,v220,v221
v_exp_f32 v222,v222
v_exp_f32 v223,v223
v_mfma_f32_16x16x32_bf16 v[244:247],a[112:115],a[32:35],0
v_mfma_f32_16x16x32_bf16 v[244:247],a[116:119],a[36:39],v[244:247]
v_mfma_f32_16x16x32_bf16 v[244:247],a[120:123],a[40:43],v[244:247]
ds_read_b128 a[156:159],v5 offset:19456
v_mfma_f32_16x16x32_bf16 v[244:247],a[124:127],a[44:47],v[244:247]
v_cvt_pk_bf16_f32 v191,v222,v223
v_mfma_f32_16x16x32_bf16 v[252:255],a[124:127],a[60:63],0
v_mfma_f32_16x16x32_bf16 v[252:255],a[120:123],a[56:59],v[252:255]
v_mfma_f32_16x16x32_bf16 v[252:255],a[116:119],a[52:55],v[252:255]
v_mfma_f32_16x16x32_bf16 v[252:255],a[112:115],a[48:51],v[252:255]
s_waitcnt lgkmcnt(4)
v_mfma_f32_16x16x32_bf16 v[192:195],a[128:131],a[0:3],0
v_mfma_f32_16x16x32_bf16 v[192:195],a[132:135],a[4:7],v[192:195]
v_mfma_f32_16x16x32_bf16 v[192:195],a[136:139],a[8:11],v[192:195]
v_mfma_f32_16x16x32_bf16 v[192:195],a[140:143],a[12:15],v[192:195]
v_fma_f32 v224,v224,s26,-v18
v_fma_f32 v225,v225,s26,-v18
v_fma_f32 v226,v226,s26,-v18
v_fma_f32 v227,v227,s26,-v18
v_fma_f32 v228,v228,s26,-v18
v_mfma_f32_16x16x32_bf16 v[200:203],a[140:143],a[28:31],0
v_mfma_f32_16x16x32_bf16 v[200:203],a[136:139],a[24:27],v[200:203]
ds_read_b64_tr_b16 a[96:97],v6 offset:0
v_mfma_f32_16x16x32_bf16 v[200:203],a[132:135],a[20:23],v[200:203]
ds_read_b64_tr_b16 a[98:99],v6 offset:1024
v_mfma_f32_16x16x32_bf16 v[200:203],a[128:131],a[16:19],v[200:203]
v_exp_f32 v224,v224
v_exp_f32 v225,v225
v_fma_f32 v229,v229,s26,-v18
v_mfma_f32_16x16x32_bf16 v[208:211],a[128:131],a[32:35],0
ds_read_b64_tr_b16 a[100:101],v6 offset:2048
v_mfma_f32_16x16x32_bf16 v[208:211],a[132:135],a[36:39],v[208:211]
ds_read_b64_tr_b16 a[102:103],v6 offset:3072
v_mfma_f32_16x16x32_bf16 v[208:211],a[136:139],a[40:43],v[208:211]
v_mfma_f32_16x16x32_bf16 v[208:211],a[140:143],a[44:47],v[208:211]
v_cvt_pk_bf16_f32 v224,v224,v225
v_exp_f32 v226,v226
v_exp_f32 v227,v227
v_mfma_f32_16x16x32_bf16 v[216:219],a[140:143],a[60:63],0
ds_read_b64_tr_b16 a[104:105],v6 offset:8
v_mfma_f32_16x16x32_bf16 v[216:219],a[136:139],a[56:59],v[216:219]
ds_read_b64_tr_b16 a[106:107],v6 offset:1032
v_mfma_f32_16x16x32_bf16 v[216:219],a[132:135],a[52:55],v[216:219]
v_mfma_f32_16x16x32_bf16 v[216:219],a[128:131],a[48:51],v[216:219]
s_waitcnt lgkmcnt(6)
v_cvt_pk_bf16_f32 v225,v226,v227
v_exp_f32 v228,v228
v_exp_f32 v229,v229
v_mfma_f32_16x16x32_bf16 v[196:199],a[144:147],a[0:3],0
ds_read_b64_tr_b16 a[108:109],v6 offset:2056
v_mfma_f32_16x16x32_bf16 v[196:199],a[148:151],a[4:7],v[196:199]
ds_read_b64_tr_b16 a[110:111],v6 offset:3080
v_mfma_f32_16x16x32_bf16 v[196:199],a[152:155],a[8:11],v[196:199]
v_mfma_f32_16x16x32_bf16 v[196:199],a[156:159],a[12:15],v[196:199]
ds_read_b64_tr_b16 a[112:113],v7 offset:0
v_cvt_pk_bf16_f32 v226,v228,v229
v_fma_f32 v230,v230,s26,-v18
v_fma_f32 v231,v231,s26,-v18
v_fma_f32 v232,v232,s26,-v19
v_fma_f32 v233,v233,s26,-v19
v_mfma_f32_16x16x32_bf16 v[204:207],a[156:159],a[28:31],0
ds_read_b64_tr_b16 a[114:115],v7 offset:1024
v_mfma_f32_16x16x32_bf16 v[204:207],a[152:155],a[24:27],v[204:207]
v_mfma_f32_16x16x32_bf16 v[204:207],a[148:151],a[20:23],v[204:207]
v_mfma_f32_16x16x32_bf16 v[204:207],a[144:147],a[16:19],v[204:207]
ds_read_b64_tr_b16 a[116:117],v7 offset:2048
v_exp_f32 v230,v230
v_exp_f32 v231,v231
v_mfma_f32_16x16x32_bf16 v[212:215],a[144:147],a[32:35],0
ds_read_b64_tr_b16 a[118:119],v7 offset:3072
v_mfma_f32_16x16x32_bf16 v[212:215],a[148:151],a[36:39],v[212:215]
v_mfma_f32_16x16x32_bf16 v[212:215],a[152:155],a[40:43],v[212:215]
v_mfma_f32_16x16x32_bf16 v[212:215],a[156:159],a[44:47],v[212:215]
ds_read_b64_tr_b16 a[120:121],v7 offset:8
v_exp_f32 v232,v232
v_exp_f32 v233,v233
v_mfma_f32_16x16x32_bf16 v[220:223],a[156:159],a[60:63],0
ds_read_b64_tr_b16 a[122:123],v7 offset:1032
v_mfma_f32_16x16x32_bf16 v[220:223],a[152:155],a[56:59],v[220:223]
v_mfma_f32_16x16x32_bf16 v[220:223],a[148:151],a[52:55],v[220:223]
ds_read_b64_tr_b16 a[124:125],v7 offset:2056
v_mfma_f32_16x16x32_bf16 v[220:223],a[144:147],a[48:51],v[220:223]
s_waitcnt lgkmcnt(14)
ds_read_b64_tr_b16 a[126:127],v7 offset:3080
v_cvt_pk_bf16_f32 v227,v230,v231
v_cvt_pk_bf16_f32 v232,v232,v233
v_fma_f32 v234,v234,s26,-v19
v_fma_f32 v235,v235,s26,-v19
v_mfma_f32_16x16x32_bf16 a[224:227],a[240:243],v[160:163],a[224:227]
v_mfma_f32_16x16x32_bf16 a[224:227],a[240:243],v[164:167],a[224:227]
v_exp_f32 v234,v234
v_exp_f32 v235,v235
v_fma_f32 v236,v236,s26,-v19
v_mfma_f32_16x16x32_bf16 a[228:231],a[240:243],v[168:171],a[228:231]
s_waitcnt lgkmcnt(14)
ds_read_b64_tr_b16 a[128:129],v8 offset:0
v_mfma_f32_16x16x32_bf16 a[228:231],a[240:243],v[172:175],a[228:231]
s_waitcnt lgkmcnt(14)
ds_read_b64_tr_b16 a[130:131],v8 offset:1024
v_exp_f32 v236,v236
v_cvt_pk_bf16_f32 v233,v234,v235
v_fma_f32 v237,v237,s26,-v19
v_mfma_f32_16x16x32_bf16 a[232:235],a[240:243],v[176:179],a[232:235]
v_mfma_f32_16x16x32_bf16 a[232:235],a[240:243],v[180:183],a[232:235]
s_waitcnt lgkmcnt(14)
v_exp_f32 v237,v237
v_fma_f32 v238,v238,s26,-v19
v_fma_f32 v239,v239,s26,-v19
v_fma_f32 v240,v240,s26,-v20
v_mfma_f32_16x16x32_bf16 a[236:239],a[240:243],v[184:187],a[236:239]
ds_read_b64_tr_b16 a[132:133],v8 offset:2048
v_mfma_f32_16x16x32_bf16 a[236:239],a[240:243],v[188:191],a[236:239]
s_waitcnt lgkmcnt(14)
ds_read_b64_tr_b16 a[134:135],v8 offset:3072
v_exp_f32 v238,v238
v_exp_f32 v239,v239
v_mfma_f32_16x16x32_bf16 v[80:83],a[96:99],v[184:187],v[80:83]
v_mfma_f32_16x16x32_bf16 v[80:83],a[100:103],v[188:191],v[80:83]
s_waitcnt lgkmcnt(14)
ds_read_b64_tr_b16 a[136:137],v8 offset:8
v_exp_f32 v240,v240
v_cvt_pk_bf16_f32 v234,v236,v237
v_cvt_pk_bf16_f32 v235,v238,v239
v_mfma_f32_16x16x32_bf16 v[64:67],a[100:103],v[180:183],v[64:67]
s_waitcnt lgkmcnt(14)
ds_read_b64_tr_b16 a[138:139],v8 offset:1032
v_mfma_f32_16x16x32_bf16 v[64:67],a[96:99],v[176:179],v[64:67]
v_fma_f32 v241,v241,s26,-v20
v_fma_f32 v242,v242,s26,-v20
v_fma_f32 v243,v243,s26,-v20
v_fma_f32 v244,v244,s26,-v20
v_fma_f32 v245,v245,s26,-v20
v_fma_f32 v246,v246,s26,-v20
v_mfma_f32_16x16x32_bf16 v[48:51],a[96:99],v[168:171],v[48:51]
v_mfma_f32_16x16x32_bf16 v[48:51],a[100:103],v[172:175],v[48:51]
s_waitcnt lgkmcnt(14)
ds_read_b64_tr_b16 a[140:141],v8 offset:2056
v_exp_f32 v241,v241
v_exp_f32 v242,v242
v_mfma_f32_16x16x32_bf16 v[32:35],a[100:103],v[164:167],v[32:35]
s_waitcnt lgkmcnt(14)
ds_read_b64_tr_b16 a[142:143],v8 offset:3080
v_mfma_f32_16x16x32_bf16 v[32:35],a[96:99],v[160:163],v[32:35]
v_cvt_pk_bf16_f32 v240,v240,v241
v_exp_f32 v243,v243
v_exp_f32 v244,v244
v_mfma_f32_16x16x32_bf16 v[36:39],a[104:107],v[160:163],v[36:39]
v_mfma_f32_16x16x32_bf16 v[36:39],a[108:111],v[164:167],v[36:39]
s_waitcnt lgkmcnt(14)
ds_read_b64_tr_b16 a[144:145],v9 offset:0
v_exp_f32 v245,v245
v_exp_f32 v246,v246
v_mfma_f32_16x16x32_bf16 v[52:55],a[108:111],v[172:175],v[52:55]
s_waitcnt lgkmcnt(14)
ds_read_b64_tr_b16 a[146:147],v9 offset:1024
v_mfma_f32_16x16x32_bf16 v[52:55],a[104:107],v[168:171],v[52:55]
v_cvt_pk_bf16_f32 v241,v242,v243
v_cvt_pk_bf16_f32 v242,v244,v245
v_fma_f32 v247,v247,s26,-v20
v_fma_f32 v248,v248,s26,-v21
v_fma_f32 v249,v249,s26,-v21
v_mfma_f32_16x16x32_bf16 v[68:71],a[104:107],v[176:179],v[68:71]
s_waitcnt lgkmcnt(14)
ds_read_b64_tr_b16 a[148:149],v9 offset:2048
v_mfma_f32_16x16x32_bf16 v[68:71],a[108:111],v[180:183],v[68:71]
s_waitcnt lgkmcnt(14)
ds_read_b64_tr_b16 a[150:151],v9 offset:3072
v_exp_f32 v247,v247
v_exp_f32 v248,v248
v_mfma_f32_16x16x32_bf16 v[84:87],a[108:111],v[188:191],v[84:87]
v_mfma_f32_16x16x32_bf16 v[84:87],a[104:107],v[184:187],v[84:87]
v_cvt_pk_bf16_f32 v243,v246,v247
v_exp_f32 v249,v249
v_fma_f32 v250,v250,s26,-v21
v_fma_f32 v251,v251,s26,-v21
v_mfma_f32_16x16x32_bf16 v[88:91],a[112:115],v[184:187],v[88:91]
s_waitcnt lgkmcnt(14)
ds_read_b64_tr_b16 a[152:153],v9 offset:8
v_mfma_f32_16x16x32_bf16 v[88:91],a[116:119],v[188:191],v[88:91]
s_waitcnt lgkmcnt(14)
ds_read_b64_tr_b16 a[154:155],v9 offset:1032
v_exp_f32 v250,v250
v_exp_f32 v251,v251
v_mfma_f32_16x16x32_bf16 v[72:75],a[116:119],v[180:183],v[72:75]
v_mfma_f32_16x16x32_bf16 v[72:75],a[112:115],v[176:179],v[72:75]
s_waitcnt lgkmcnt(14)
ds_read_b64_tr_b16 a[156:157],v9 offset:2056
v_cvt_pk_bf16_f32 v248,v248,v249
v_cvt_pk_bf16_f32 v249,v250,v251
v_fma_f32 v252,v252,s26,-v21
v_fma_f32 v253,v253,s26,-v21
v_fma_f32 v254,v254,s26,-v21
v_mfma_f32_16x16x32_bf16 v[56:59],a[112:115],v[168:171],v[56:59]
s_waitcnt lgkmcnt(14)
ds_read_b64_tr_b16 a[158:159],v9 offset:3080
v_mfma_f32_16x16x32_bf16 v[56:59],a[116:119],v[172:175],v[56:59]
v_exp_f32 v252,v252
v_exp_f32 v253,v253
v_fma_f32 v255,v255,s26,-v21
v_mfma_f32_16x16x32_bf16 v[40:43],a[116:119],v[164:167],v[40:43]
v_mfma_f32_16x16x32_bf16 v[40:43],a[112:115],v[160:163],v[40:43]
v_cvt_pk_bf16_f32 v250,v252,v253
v_exp_f32 v254,v254
v_exp_f32 v255,v255
v_mfma_f32_16x16x32_bf16 v[44:47],a[120:123],v[160:163],v[44:47]
v_mfma_f32_16x16x32_bf16 v[44:47],a[124:127],v[164:167],v[44:47]
v_cvt_pk_bf16_f32 v251,v254,v255
v_mfma_f32_16x16x32_bf16 v[60:63],a[124:127],v[172:175],v[60:63]
v_mfma_f32_16x16x32_bf16 v[60:63],a[120:123],v[168:171],v[60:63]
v_mfma_f32_16x16x32_bf16 v[76:79],a[120:123],v[176:179],v[76:79]
v_mfma_f32_16x16x32_bf16 v[76:79],a[124:127],v[180:183],v[76:79]
v_fma_f32 v192,v192,s26,-v18
v_fma_f32 v193,v193,s26,-v18
v_fma_f32 v194,v194,s26,-v18
v_fma_f32 v195,v195,s26,-v18
v_fma_f32 v196,v196,s26,-v18
v_mfma_f32_16x16x32_bf16 v[92:95],a[124:127],v[188:191],v[92:95]
v_mfma_f32_16x16x32_bf16 v[92:95],a[120:123],v[184:187],v[92:95]
s_waitcnt lgkmcnt(12)
v_exp_f32 v192,v192
v_exp_f32 v193,v193
v_fma_f32 v197,v197,s26,-v18
v_mfma_f32_16x16x32_bf16 a[208:211],a[128:131],v[184:187],a[208:211]
v_mfma_f32_16x16x32_bf16 a[208:211],a[132:135],v[188:191],a[208:211]
v_exp_f32 v194,v194
v_exp_f32 v195,v195
v_exp_f32 v196,v196
v_mfma_f32_16x16x32_bf16 a[192:195],a[132:135],v[180:183],a[192:195]
v_mfma_f32_16x16x32_bf16 a[192:195],a[128:131],v[176:179],a[192:195]
s_waitcnt vmcnt(12)
s_waitcnt lgkmcnt(0)
s_barrier
ds_read_b128 a[96:99],v2 offset:32768
v_exp_f32 v197,v197
v_cvt_pk_bf16_f32 v228,v192,v193
v_cvt_pk_bf16_f32 v229,v194,v195
v_mfma_f32_16x16x32_bf16 a[176:179],a[128:131],v[168:171],a[176:179]
v_mfma_f32_16x16x32_bf16 a[176:179],a[132:135],v[172:175],a[176:179]
v_cvt_pk_bf16_f32 v230,v196,v197
v_fma_f32 v198,v198,s26,-v18
v_fma_f32 v199,v199,s26,-v18
v_fma_f32 v200,v200,s26,-v19
v_fma_f32 v201,v201,s26,-v19
v_mfma_f32_16x16x32_bf16 a[160:163],a[132:135],v[164:167],a[160:163]
v_mfma_f32_16x16x32_bf16 a[160:163],a[128:131],v[160:163],a[160:163]
ds_read_b128 a[100:103],v3 offset:32768
v_exp_f32 v198,v198
v_exp_f32 v199,v199
v_mfma_f32_16x16x32_bf16 a[164:167],a[136:139],v[160:163],a[164:167]
s_add_u32 s30,s24,4294901760
s_add_u32 s32,s24,4294905856
v_mfma_f32_16x16x32_bf16 a[164:167],a[140:143],v[164:167],a[164:167]
buffer_store_dwordx4 a[64:67],v22,s[16:19],s30 offen sc0 sc1
buffer_store_dwordx4 a[68:71],v22,s[16:19],s32 offen sc0 sc1
v_cvt_pk_bf16_f32 v231,v198,v199
v_exp_f32 v200,v200
v_mfma_f32_16x16x32_bf16 a[180:183],a[140:143],v[172:175],a[180:183]
ds_read_b128 a[104:107],v4 offset:32768
v_mfma_f32_16x16x32_bf16 a[180:183],a[136:139],v[168:171],a[180:183]
v_exp_f32 v201,v201
v_fma_f32 v202,v202,s26,-v19
v_fma_f32 v203,v203,s26,-v19
v_fma_f32 v204,v204,s26,-v19
v_fma_f32 v205,v205,s26,-v19
v_mfma_f32_16x16x32_bf16 a[196:199],a[136:139],v[176:179],a[196:199]
v_mfma_f32_16x16x32_bf16 a[196:199],a[140:143],v[180:183],a[196:199]
v_cvt_pk_bf16_f32 v236,v200,v201
v_exp_f32 v202,v202
v_exp_f32 v203,v203
v_mfma_f32_16x16x32_bf16 a[212:215],a[140:143],v[188:191],a[212:215]
ds_read_b128 a[108:111],v5 offset:32768
v_mfma_f32_16x16x32_bf16 a[212:215],a[136:139],v[184:187],a[212:215]
v_cvt_pk_bf16_f32 v237,v202,v203
v_exp_f32 v204,v204
v_exp_f32 v205,v205
v_mfma_f32_16x16x32_bf16 a[216:219],a[144:147],v[184:187],a[216:219]
v_mfma_f32_16x16x32_bf16 a[216:219],a[148:151],v[188:191],a[216:219]
v_cvt_pk_bf16_f32 v238,v204,v205
v_fma_f32 v206,v206,s26,-v19
v_fma_f32 v207,v207,s26,-v19
v_fma_f32 v208,v208,s26,-v20
v_fma_f32 v209,v209,s26,-v20
v_mfma_f32_16x16x32_bf16 a[200:203],a[148:151],v[180:183],a[200:203]
ds_read_b128 a[112:115],v2 offset:33792
v_mfma_f32_16x16x32_bf16 a[200:203],a[144:147],v[176:179],a[200:203]
v_exp_f32 v206,v206
v_exp_f32 v207,v207
v_fma_f32 v210,v210,s26,-v20
v_mfma_f32_16x16x32_bf16 a[184:187],a[144:147],v[168:171],a[184:187]
v_mfma_f32_16x16x32_bf16 a[184:187],a[148:151],v[172:175],a[184:187]
ds_read_b128 a[116:119],v3 offset:33792
v_exp_f32 v208,v208
v_exp_f32 v209,v209
v_mfma_f32_16x16x32_bf16 a[168:171],a[148:151],v[164:167],a[168:171]
v_mfma_f32_16x16x32_bf16 a[168:171],a[144:147],v[160:163],a[168:171]
v_exp_f32 v210,v210
v_cvt_pk_bf16_f32 v239,v206,v207
v_cvt_pk_bf16_f32 v244,v208,v209
v_fma_f32 v211,v211,s26,-v20
v_fma_f32 v212,v212,s26,-v20
v_mfma_f32_16x16x32_bf16 a[172:175],a[152:155],v[160:163],a[172:175]
v_mfma_f32_16x16x32_bf16 a[172:175],a[156:159],v[164:167],a[172:175]
ds_read_b128 a[120:123],v4 offset:33792
v_exp_f32 v211,v211
v_exp_f32 v212,v212
v_mfma_f32_16x16x32_bf16 a[188:191],a[156:159],v[172:175],a[188:191]
s_add_u32 s30,s24,4294909952
s_add_u32 s32,s24,4294914048
v_mfma_f32_16x16x32_bf16 a[188:191],a[152:155],v[168:171],a[188:191]
buffer_store_dwordx4 a[72:75],v22,s[16:19],s30 offen sc0 sc1
buffer_store_dwordx4 a[76:79],v22,s[16:19],s32 offen sc0 sc1
v_cvt_pk_bf16_f32 v245,v210,v211
v_fma_f32 v213,v213,s26,-v20
v_fma_f32 v214,v214,s26,-v20
v_mfma_f32_16x16x32_bf16 a[204:207],a[152:155],v[176:179],a[204:207]
v_mfma_f32_16x16x32_bf16 a[204:207],a[156:159],v[180:183],a[204:207]
ds_read_b128 a[124:127],v5 offset:33792
v_exp_f32 v213,v213
v_exp_f32 v214,v214
v_mfma_f32_16x16x32_bf16 a[220:223],a[156:159],v[188:191],a[220:223]
v_mfma_f32_16x16x32_bf16 a[220:223],a[152:155],v[184:187],a[220:223]
s_waitcnt lgkmcnt(4)
v_cvt_pk_bf16_f32 v246,v212,v213
v_fma_f32 v215,v215,s26,-v20
v_fma_f32 v216,v216,s26,-v21
v_fma_f32 v217,v217,s26,-v21
v_fma_f32 v218,v218,s26,-v21
v_mfma_f32_16x16x32_bf16 v[160:163],a[96:99],a[0:3],0
ds_read_b128 a[128:131],v2 offset:34816
v_mfma_f32_16x16x32_bf16 v[160:163],a[100:103],a[4:7],v[160:163]
v_mfma_f32_16x16x32_bf16 v[160:163],a[104:107],a[8:11],v[160:163]
v_mfma_f32_16x16x32_bf16 v[160:163],a[108:111],a[12:15],v[160:163]
v_exp_f32 v215,v215
v_exp_f32 v216,v216
v_exp_f32 v217,v217
v_mfma_f32_16x16x32_bf16 v[168:171],a[108:111],a[28:31],0
ds_read_b128 a[132:135],v3 offset:34816
v_mfma_f32_16x16x32_bf16 v[168:171],a[104:107],a[24:27],v[168:171]
v_mfma_f32_16x16x32_bf16 v[168:171],a[100:103],a[20:23],v[168:171]
v_mfma_f32_16x16x32_bf16 v[168:171],a[96:99],a[16:19],v[168:171]
v_cvt_pk_bf16_f32 v247,v214,v215
v_exp_f32 v218,v218
v_cvt_pk_bf16_f32 v252,v216,v217
v_fma_f32 v219,v219,s26,-v21
v_mfma_f32_16x16x32_bf16 v[176:179],a[96:99],a[32:35],0
ds_read_b128 a[136:139],v4 offset:34816
v_mfma_f32_16x16x32_bf16 v[176:179],a[100:103],a[36:39],v[176:179]
v_mfma_f32_16x16x32_bf16 v[176:179],a[104:107],a[40:43],v[176:179]
v_mfma_f32_16x16x32_bf16 v[176:179],a[108:111],a[44:47],v[176:179]
ds_read_b128 a[140:143],v5 offset:34816
v_exp_f32 v219,v219
v_fma_f32 v220,v220,s26,-v21
v_fma_f32 v221,v221,s26,-v21
v_mfma_f32_16x16x32_bf16 v[184:187],a[108:111],a[60:63],0
v_mfma_f32_16x16x32_bf16 v[184:187],a[104:107],a[56:59],v[184:187]
v_mfma_f32_16x16x32_bf16 v[184:187],a[100:103],a[52:55],v[184:187]
s_waitcnt lgkmcnt(4)
v_mfma_f32_16x16x32_bf16 v[184:187],a[96:99],a[48:51],v[184:187]
ds_read_b128 a[144:147],v2 offset:35840
v_exp_f32 v220,v220
v_exp_f32 v221,v221
v_mfma_f32_16x16x32_bf16 v[164:167],a[112:115],a[0:3],0
v_mfma_f32_16x16x32_bf16 v[164:167],a[116:119],a[4:7],v[164:167]
v_mfma_f32_16x16x32_bf16 v[164:167],a[120:123],a[8:11],v[164:167]
v_mfma_f32_16x16x32_bf16 v[164:167],a[124:127],a[12:15],v[164:167]
ds_read_b128 a[148:151],v3 offset:35840
v_cvt_pk_bf16_f32 v253,v218,v219
v_cvt_pk_bf16_f32 v254,v220,v221
v_fma_f32 v222,v222,s26,-v21
v_fma_f32 v223,v223,s26,-v21
v_mfma_f32_16x16x32_bf16 v[172:175],a[124:127],a[28:31],0
v_mfma_f32_16x16x32_bf16 v[172:175],a[120:123],a[24:27],v[172:175]
v_mfma_f32_16x16x32_bf16 v[172:175],a[116:119],a[20:23],v[172:175]
s_add_u32 s30,s24,4294918144
s_add_u32 s32,s24,4294922240
ds_read_b128 a[152:155],v4 offset:35840
v_mfma_f32_16x16x32_bf16 v[172:175],a[112:115],a[16:19],v[172:175]
buffer_store_dwordx4 a[80:83],v22,s[16:19],s30 offen sc0 sc1
buffer_store_dwordx4 a[84:87],v22,s[16:19],s32 offen sc0 sc1
v_exp_f32 v222,v222
v_exp_f32 v223,v223
v_mfma_f32_16x16x32_bf16 v[180:183],a[112:115],a[32:35],0
v_mfma_f32_16x16x32_bf16 v[180:183],a[116:119],a[36:39],v[180:183]
v_mfma_f32_16x16x32_bf16 v[180:183],a[120:123],a[40:43],v[180:183]
ds_read_b128 a[156:159],v5 offset:35840
v_mfma_f32_16x16x32_bf16 v[180:183],a[124:127],a[44:47],v[180:183]
v_cvt_pk_bf16_f32 v255,v222,v223
v_mfma_f32_16x16x32_bf16 v[188:191],a[124:127],a[60:63],0
v_mfma_f32_16x16x32_bf16 v[188:191],a[120:123],a[56:59],v[188:191]
v_mfma_f32_16x16x32_bf16 v[188:191],a[116:119],a[52:55],v[188:191]
v_mfma_f32_16x16x32_bf16 v[188:191],a[112:115],a[48:51],v[188:191]
s_waitcnt lgkmcnt(4)
v_mfma_f32_16x16x32_bf16 v[192:195],a[128:131],a[0:3],0
v_mfma_f32_16x16x32_bf16 v[192:195],a[132:135],a[4:7],v[192:195]
v_mfma_f32_16x16x32_bf16 v[192:195],a[136:139],a[8:11],v[192:195]
v_mfma_f32_16x16x32_bf16 v[192:195],a[140:143],a[12:15],v[192:195]
v_accvgpr_read_b32 v23,a244
v_accvgpr_read_b32 v24,a245
v_fma_f32 v160,v160,s26,-v18
v_fma_f32 v161,v161,s26,-v18
v_fma_f32 v162,v162,s26,-v18
v_fma_f32 v163,v163,s26,-v18
v_mfma_f32_16x16x32_bf16 v[200:203],a[140:143],a[28:31],0
ds_write_b128 v23,v[96:99] offset:0
v_mfma_f32_16x16x32_bf16 v[200:203],a[136:139],a[24:27],v[200:203]
ds_read_b64_tr_b16 a[96:97],v6 offset:16384
v_mfma_f32_16x16x32_bf16 v[200:203],a[132:135],a[20:23],v[200:203]
s_add_u32 s30,s24,4294926336
s_add_u32 s32,s24,4294930432
ds_read_b64_tr_b16 a[98:99],v6 offset:17408
v_mfma_f32_16x16x32_bf16 v[200:203],a[128:131],a[16:19],v[200:203]
buffer_store_dwordx4 a[88:91],v22,s[16:19],s30 offen sc0 sc1
buffer_store_dwordx4 a[92:95],v22,s[16:19],s32 offen sc0 sc1
v_exp_f32 v160,v160
v_exp_f32 v161,v161
v_mfma_f32_16x16x32_bf16 v[208:211],a[128:131],a[32:35],0
ds_read_b64_tr_b16 a[100:101],v6 offset:18432
v_mfma_f32_16x16x32_bf16 v[208:211],a[132:135],a[36:39],v[208:211]
ds_read_b64_tr_b16 a[102:103],v6 offset:19456
v_mfma_f32_16x16x32_bf16 v[208:211],a[136:139],a[40:43],v[208:211]
ds_read_b128 a[64:67],v10 offset:16384
v_mfma_f32_16x16x32_bf16 v[208:211],a[140:143],a[44:47],v[208:211]
ds_read_b128 a[68:71],v11 offset:16384
v_cvt_pk_bf16_f32 v160,v160,v161
v_exp_f32 v162,v162
v_exp_f32 v163,v163
v_mfma_f32_16x16x32_bf16 v[216:219],a[140:143],a[60:63],0
ds_read_b64_tr_b16 a[104:105],v6 offset:16392
v_mfma_f32_16x16x32_bf16 v[216:219],a[136:139],a[56:59],v[216:219]
ds_read_b64_tr_b16 a[106:107],v6 offset:17416
v_mfma_f32_16x16x32_bf16 v[216:219],a[132:135],a[52:55],v[216:219]
ds_read_b128 a[72:75],v12 offset:16384
v_mfma_f32_16x16x32_bf16 v[216:219],a[128:131],a[48:51],v[216:219]
s_waitcnt lgkmcnt(10)
ds_read_b128 a[76:79],v13 offset:16384
v_cvt_pk_bf16_f32 v161,v162,v163
v_fma_f32 v164,v164,s26,-v18
v_fma_f32 v165,v165,s26,-v18
v_fma_f32 v166,v166,s26,-v18
v_mfma_f32_16x16x32_bf16 v[196:199],a[144:147],a[0:3],0
ds_read_b64_tr_b16 a[108:109],v6 offset:18440
v_mfma_f32_16x16x32_bf16 v[196:199],a[148:151],a[4:7],v[196:199]
ds_read_b64_tr_b16 a[110:111],v6 offset:19464
v_mfma_f32_16x16x32_bf16 v[196:199],a[152:155],a[8:11],v[196:199]
ds_read_b128 a[80:83],v10 offset:0
v_mfma_f32_16x16x32_bf16 v[196:199],a[156:159],a[12:15],v[196:199]
ds_read_b64_tr_b16 a[112:113],v7 offset:16384
v_exp_f32 v164,v164
v_exp_f32 v165,v165
v_fma_f32 v167,v167,s26,-v18
v_mfma_f32_16x16x32_bf16 v[204:207],a[156:159],a[28:31],0
s_waitcnt lgkmcnt(14)
ds_read_b64_tr_b16 a[114:115],v7 offset:17408
v_mfma_f32_16x16x32_bf16 v[204:207],a[152:155],a[24:27],v[204:207]
s_waitcnt lgkmcnt(14)
ds_read_b128 a[84:87],v11 offset:0
v_mfma_f32_16x16x32_bf16 v[204:207],a[148:151],a[20:23],v[204:207]
s_waitcnt lgkmcnt(14)
ds_read_b128 a[88:91],v12 offset:0
v_mfma_f32_16x16x32_bf16 v[204:207],a[144:147],a[16:19],v[204:207]
s_waitcnt lgkmcnt(14)
ds_read_b64_tr_b16 a[116:117],v7 offset:18432
v_cvt_pk_bf16_f32 v162,v164,v165
v_exp_f32 v166,v166
v_exp_f32 v167,v167
v_mfma_f32_16x16x32_bf16 v[212:215],a[144:147],a[32:35],0
s_waitcnt lgkmcnt(14)
ds_read_b64_tr_b16 a[118:119],v7 offset:19456
v_mfma_f32_16x16x32_bf16 v[212:215],a[148:151],a[36:39],v[212:215]
s_waitcnt lgkmcnt(14)
ds_read_b128 a[92:95],v13 offset:0
v_mfma_f32_16x16x32_bf16 v[212:215],a[152:155],a[40:43],v[212:215]
s_waitcnt lgkmcnt(14)
ds_write_b128 v23,v[100:103] offset:64
v_mfma_f32_16x16x32_bf16 v[212:215],a[156:159],a[44:47],v[212:215]
s_waitcnt lgkmcnt(14)
ds_read_b64_tr_b16 a[120:121],v7 offset:16392
v_cvt_pk_bf16_f32 v163,v166,v167
v_fma_f32 v168,v168,s26,-v19
v_fma_f32 v169,v169,s26,-v19
v_fma_f32 v170,v170,s26,-v19
v_mfma_f32_16x16x32_bf16 v[220:223],a[156:159],a[60:63],0
s_waitcnt lgkmcnt(14)
ds_read_b64_tr_b16 a[122:123],v7 offset:17416
v_mfma_f32_16x16x32_bf16 v[220:223],a[152:155],a[56:59],v[220:223]
s_waitcnt lgkmcnt(14)
ds_write_b128 v23,v[104:107] offset:128
v_mfma_f32_16x16x32_bf16 v[220:223],a[148:151],a[52:55],v[220:223]
s_waitcnt lgkmcnt(14)
ds_read_b64_tr_b16 a[124:125],v7 offset:18440
v_mfma_f32_16x16x32_bf16 v[220:223],a[144:147],a[48:51],v[220:223]
s_waitcnt lgkmcnt(14)
ds_read_b64_tr_b16 a[126:127],v7 offset:19464
v_exp_f32 v168,v168
v_exp_f32 v169,v169
v_fma_f32 v171,v171,s26,-v19
v_mfma_f32_16x16x32_bf16 a[224:227],a[240:243],v[224:227],a[224:227]
s_add_u32 s30,s24,4294934528
s_add_u32 s32,s24,4294938624
s_waitcnt lgkmcnt(14)
ds_write_b128 v23,v[108:111] offset:192
v_mfma_f32_16x16x32_bf16 a[224:227],a[240:243],v[228:231],a[224:227]
buffer_store_dwordx4 a[64:67],v22,s[16:19],s30 offen sc0 sc1
buffer_store_dwordx4 a[68:71],v22,s[16:19],s32 offen sc0 sc1
v_exp_f32 v170,v170
v_exp_f32 v171,v171
v_mfma_f32_16x16x32_bf16 a[228:231],a[240:243],v[232:235],a[228:231]
s_waitcnt lgkmcnt(14)
ds_read_b64_tr_b16 a[128:129],v8 offset:16384
v_mfma_f32_16x16x32_bf16 a[228:231],a[240:243],v[236:239],a[228:231]
s_waitcnt lgkmcnt(14)
ds_read_b64_tr_b16 a[130:131],v8 offset:17408
v_cvt_pk_bf16_f32 v168,v168,v169
v_cvt_pk_bf16_f32 v169,v170,v171
v_fma_f32 v172,v172,s26,-v19
v_fma_f32 v173,v173,s26,-v19
v_fma_f32 v174,v174,s26,-v19
v_mfma_f32_16x16x32_bf16 a[232:235],a[240:243],v[240:243],a[232:235]
s_waitcnt lgkmcnt(14)
ds_read_b128 v[96:99],v24 offset:0
v_mfma_f32_16x16x32_bf16 a[232:235],a[240:243],v[244:247],a[232:235]
s_waitcnt lgkmcnt(14)
ds_read_b128 v[100:103],v24 offset:1088
v_exp_f32 v172,v172
v_exp_f32 v173,v173
v_mfma_f32_16x16x32_bf16 a[236:239],a[240:243],v[248:251],a[236:239]
s_waitcnt lgkmcnt(14)
ds_read_b64_tr_b16 a[132:133],v8 offset:18432
v_mfma_f32_16x16x32_bf16 a[236:239],a[240:243],v[252:255],a[236:239]
s_waitcnt lgkmcnt(14)
ds_read_b64_tr_b16 a[134:135],v8 offset:19456
v_cvt_pk_bf16_f32 v170,v172,v173
v_exp_f32 v174,v174
v_fma_f32 v175,v175,s26,-v19
v_fma_f32 v176,v176,s26,-v20
v_mfma_f32_16x16x32_bf16 v[80:83],a[96:99],v[248:251],v[80:83]
s_waitcnt lgkmcnt(14)
ds_read_b128 v[104:107],v24 offset:2176
v_mfma_f32_16x16x32_bf16 v[80:83],a[100:103],v[252:255],v[80:83]
s_waitcnt lgkmcnt(14)
ds_read_b64_tr_b16 a[136:137],v8 offset:16392
v_exp_f32 v175,v175
v_fma_f32 v177,v177,s26,-v20
v_exp_f32 v176,v176
v_mfma_f32_16x16x32_bf16 v[64:67],a[100:103],v[244:247],v[64:67]
s_waitcnt lgkmcnt(14)
ds_read_b64_tr_b16 a[138:139],v8 offset:17416
v_mfma_f32_16x16x32_bf16 v[64:67],a[96:99],v[240:243],v[64:67]
s_waitcnt lgkmcnt(14)
ds_read_b128 v[108:111],v24 offset:3264
v_cvt_pk_bf16_f32 v171,v174,v175
v_exp_f32 v177,v177
v_fma_f32 v178,v178,s26,-v20
v_fma_f32 v179,v179,s26,-v20
v_mfma_f32_16x16x32_bf16 v[48:51],a[96:99],v[232:235],v[48:51]
s_waitcnt lgkmcnt(14)
ds_write_b128 v23,v[112:115] offset:0
v_mfma_f32_16x16x32_bf16 v[48:51],a[100:103],v[236:239],v[48:51]
s_waitcnt lgkmcnt(14)
ds_read_b64_tr_b16 a[140:141],v8 offset:18440
v_cvt_pk_bf16_f32 v176,v176,v177
v_exp_f32 v178,v178
v_exp_f32 v179,v179
v_mfma_f32_16x16x32_bf16 v[32:35],a[100:103],v[228:231],v[32:35]
s_waitcnt lgkmcnt(14)
ds_read_b64_tr_b16 a[142:143],v8 offset:19464
v_mfma_f32_16x16x32_bf16 v[32:35],a[96:99],v[224:227],v[32:35]
s_waitcnt lgkmcnt(14)
ds_write_b128 v23,v[116:119] offset:64
v_cvt_pk_bf16_f32 v177,v178,v179
v_fma_f32 v180,v180,s26,-v20
v_fma_f32 v181,v181,s26,-v20
v_fma_f32 v182,v182,s26,-v20
v_mfma_f32_16x16x32_bf16 v[36:39],a[104:107],v[224:227],v[36:39]
s_waitcnt lgkmcnt(14)
ds_write_b128 v23,v[120:123] offset:128
v_mfma_f32_16x16x32_bf16 v[36:39],a[108:111],v[228:231],v[36:39]
s_waitcnt lgkmcnt(14)
ds_read_b64_tr_b16 a[144:145],v9 offset:16384
v_exp_f32 v180,v180
v_exp_f32 v181,v181
v_fma_f32 v183,v183,s26,-v20
v_mfma_f32_16x16x32_bf16 v[52:55],a[108:111],v[236:239],v[52:55]
s_add_u32 s30,s24,4294942720
s_add_u32 s32,s24,4294946816
s_waitcnt lgkmcnt(14)
ds_read_b64_tr_b16 a[146:147],v9 offset:17408
v_mfma_f32_16x16x32_bf16 v[52:55],a[104:107],v[232:235],v[52:55]
buffer_store_dwordx4 a[72:75],v22,s[16:19],s30 offen sc0 sc1
buffer_store_dwordx4 a[76:79],v22,s[16:19],s32 offen sc0 sc1
v_exp_f32 v182,v182
v_exp_f32 v183,v183
v_mfma_f32_16x16x32_bf16 v[68:71],a[104:107],v[240:243],v[68:71]
s_waitcnt lgkmcnt(14)
ds_read_b64_tr_b16 a[148:149],v9 offset:18432
v_mfma_f32_16x16x32_bf16 v[68:71],a[108:111],v[244:247],v[68:71]
s_waitcnt lgkmcnt(14)
ds_read_b64_tr_b16 a[150:151],v9 offset:19456
v_cvt_pk_bf16_f32 v178,v180,v181
v_cvt_pk_bf16_f32 v179,v182,v183
v_fma_f32 v184,v184,s26,-v21
v_fma_f32 v185,v185,s26,-v21
v_fma_f32 v186,v186,s26,-v21
v_mfma_f32_16x16x32_bf16 v[84:87],a[108:111],v[252:255],v[84:87]
s_waitcnt lgkmcnt(14)
ds_write_b128 v23,v[124:127] offset:192
v_mfma_f32_16x16x32_bf16 v[84:87],a[104:107],v[248:251],v[84:87]
s_waitcnt lgkmcnt(14)
ds_read_b128 v[112:115],v24 offset:0
v_exp_f32 v184,v184
v_fma_f32 v187,v187,s26,-v21
v_mfma_f32_16x16x32_bf16 v[88:91],a[112:115],v[248:251],v[88:91]
s_waitcnt lgkmcnt(14)
ds_read_b64_tr_b16 a[152:153],v9 offset:16392
v_mfma_f32_16x16x32_bf16 v[88:91],a[116:119],v[252:255],v[88:91]
s_waitcnt lgkmcnt(14)
ds_read_b64_tr_b16 a[154:155],v9 offset:17416
v_exp_f32 v185,v185
v_exp_f32 v186,v186
v_fma_f32 v188,v188,s26,-v21
v_mfma_f32_16x16x32_bf16 v[72:75],a[116:119],v[244:247],v[72:75]
s_waitcnt lgkmcnt(14)
ds_read_b128 v[116:119],v24 offset:1088
v_mfma_f32_16x16x32_bf16 v[72:75],a[112:115],v[240:243],v[72:75]
s_waitcnt lgkmcnt(14)
ds_read_b64_tr_b16 a[156:157],v9 offset:18440
v_cvt_pk_bf16_f32 v184,v184,v185
v_exp_f32 v187,v187
v_exp_f32 v188,v188
v_mfma_f32_16x16x32_bf16 v[56:59],a[112:115],v[232:235],v[56:59]
s_waitcnt lgkmcnt(14)
ds_read_b64_tr_b16 a[158:159],v9 offset:19464
v_mfma_f32_16x16x32_bf16 v[56:59],a[116:119],v[236:239],v[56:59]
s_waitcnt lgkmcnt(14)
ds_read_b128 v[120:123],v24 offset:2176
v_cvt_pk_bf16_f32 v185,v186,v187
v_fma_f32 v189,v189,s26,-v21
v_fma_f32 v190,v190,s26,-v21
v_fma_f32 v191,v191,s26,-v21
v_mfma_f32_16x16x32_bf16 v[40:43],a[116:119],v[228:231],v[40:43]
s_waitcnt lgkmcnt(14)
ds_read_b128 v[124:127],v24 offset:3264
v_mfma_f32_16x16x32_bf16 v[40:43],a[112:115],v[224:227],v[40:43]
v_exp_f32 v189,v189
v_exp_f32 v190,v190
v_exp_f32 v191,v191
v_mfma_f32_16x16x32_bf16 v[44:47],a[120:123],v[224:227],v[44:47]
v_mfma_f32_16x16x32_bf16 v[44:47],a[124:127],v[228:231],v[44:47]
v_cvt_pk_bf16_f32 v186,v188,v189
v_cvt_pk_bf16_f32 v187,v190,v191
v_mfma_f32_16x16x32_bf16 v[60:63],a[124:127],v[236:239],v[60:63]
s_add_u32 s30,s24,4294950912
s_add_u32 s32,s24,4294955008
v_mfma_f32_16x16x32_bf16 v[60:63],a[120:123],v[232:235],v[60:63]
buffer_store_dwordx4 a[80:83],v22,s[16:19],s30 offen sc0 sc1
buffer_store_dwordx4 a[84:87],v22,s[16:19],s32 offen sc0 sc1
v_mfma_f32_16x16x32_bf16 v[76:79],a[120:123],v[240:243],v[76:79]
v_mfma_f32_16x16x32_bf16 v[76:79],a[124:127],v[244:247],v[76:79]
v_fma_f32 v192,v192,s26,-v18
v_fma_f32 v193,v193,s26,-v18
v_fma_f32 v194,v194,s26,-v18
v_fma_f32 v195,v195,s26,-v18
v_fma_f32 v196,v196,s26,-v18
v_mfma_f32_16x16x32_bf16 v[92:95],a[124:127],v[252:255],v[92:95]
v_mfma_f32_16x16x32_bf16 v[92:95],a[120:123],v[248:251],v[92:95]
v_exp_f32 v192,v192
v_exp_f32 v193,v193
v_fma_f32 v197,v197,s26,-v18
v_mfma_f32_16x16x32_bf16 a[208:211],a[128:131],v[248:251],a[208:211]
v_mfma_f32_16x16x32_bf16 a[208:211],a[132:135],v[252:255],a[208:211]
v_exp_f32 v194,v194
v_exp_f32 v195,v195
v_exp_f32 v196,v196
v_mfma_f32_16x16x32_bf16 a[192:195],a[132:135],v[244:247],a[192:195]
v_mfma_f32_16x16x32_bf16 a[192:195],a[128:131],v[240:243],a[192:195]
s_waitcnt vmcnt(18)
s_waitcnt lgkmcnt(0)
s_barrier
ds_read_b128 a[96:99],v2 offset:49152
v_exp_f32 v197,v197
v_cvt_pk_bf16_f32 v164,v192,v193
v_cvt_pk_bf16_f32 v165,v194,v195
v_mfma_f32_16x16x32_bf16 a[176:179],a[128:131],v[232:235],a[176:179]
v_mfma_f32_16x16x32_bf16 a[176:179],a[132:135],v[236:239],a[176:179]
v_cvt_pk_bf16_f32 v166,v196,v197
v_fma_f32 v198,v198,s26,-v18
v_fma_f32 v199,v199,s26,-v18
v_fma_f32 v200,v200,s26,-v19
v_fma_f32 v201,v201,s26,-v19
v_mfma_f32_16x16x32_bf16 a[160:163],a[132:135],v[228:231],a[160:163]
v_mfma_f32_16x16x32_bf16 a[160:163],a[128:131],v[224:227],a[160:163]
ds_read_b128 a[100:103],v3 offset:49152
v_exp_f32 v198,v198
v_exp_f32 v199,v199
v_mfma_f32_16x16x32_bf16 a[164:167],a[136:139],v[224:227],a[164:167]
v_mfma_f32_16x16x32_bf16 a[164:167],a[140:143],v[228:231],a[164:167]
v_cvt_pk_bf16_f32 v167,v198,v199
v_exp_f32 v200,v200
v_exp_f32 v201,v201
v_mfma_f32_16x16x32_bf16 a[180:183],a[140:143],v[236:239],a[180:183]
s_add_u32 s30,s24,4294959104
s_add_u32 s32,s24,4294963200
ds_read_b128 a[104:107],v4 offset:49152
v_mfma_f32_16x16x32_bf16 a[180:183],a[136:139],v[232:235],a[180:183]
buffer_store_dwordx4 a[88:91],v22,s[16:19],s30 offen sc0 sc1
buffer_store_dwordx4 a[92:95],v22,s[16:19],s32 offen sc0 sc1
v_cvt_pk_bf16_f32 v172,v200,v201
v_fma_f32 v202,v202,s26,-v19
v_fma_f32 v203,v203,s26,-v19
v_fma_f32 v204,v204,s26,-v19
v_mfma_f32_16x16x32_bf16 a[196:199],a[136:139],v[240:243],a[196:199]
v_mfma_f32_16x16x32_bf16 a[196:199],a[140:143],v[244:247],a[196:199]
v_exp_f32 v202,v202
v_exp_f32 v203,v203
v_fma_f32 v205,v205,s26,-v19
v_mfma_f32_16x16x32_bf16 a[212:215],a[140:143],v[252:255],a[212:215]
ds_read_b128 a[108:111],v5 offset:49152
v_mfma_f32_16x16x32_bf16 a[212:215],a[136:139],v[248:251],a[212:215]
v_cvt_pk_bf16_f32 v173,v202,v203
v_exp_f32 v204,v204
v_exp_f32 v205,v205
v_mfma_f32_16x16x32_bf16 a[216:219],a[144:147],v[248:251],a[216:219]
v_mfma_f32_16x16x32_bf16 a[216:219],a[148:151],v[252:255],a[216:219]
v_cvt_pk_bf16_f32 v174,v204,v205
v_fma_f32 v206,v206,s26,-v19
v_fma_f32 v207,v207,s26,-v19
v_fma_f32 v208,v208,s26,-v20
v_fma_f32 v209,v209,s26,-v20
v_mfma_f32_16x16x32_bf16 a[200:203],a[148:151],v[244:247],a[200:203]
ds_read_b128 a[112:115],v2 offset:50176
v_mfma_f32_16x16x32_bf16 a[200:203],a[144:147],v[240:243],a[200:203]
v_exp_f32 v206,v206
v_exp_f32 v207,v207
v_fma_f32 v210,v210,s26,-v20
v_mfma_f32_16x16x32_bf16 a[184:187],a[144:147],v[232:235],a[184:187]
v_mfma_f32_16x16x32_bf16 a[184:187],a[148:151],v[236:239],a[184:187]
ds_read_b128 a[116:119],v3 offset:50176
v_exp_f32 v208,v208
v_exp_f32 v209,v209
v_mfma_f32_16x16x32_bf16 a[168:171],a[148:151],v[228:231],a[168:171]
v_mfma_f32_16x16x32_bf16 a[168:171],a[144:147],v[224:227],a[168:171]
v_exp_f32 v210,v210
v_cvt_pk_bf16_f32 v175,v206,v207
v_cvt_pk_bf16_f32 v180,v208,v209
v_fma_f32 v211,v211,s26,-v20
v_fma_f32 v212,v212,s26,-v20
v_mfma_f32_16x16x32_bf16 a[172:175],a[152:155],v[224:227],a[172:175]
v_mfma_f32_16x16x32_bf16 a[172:175],a[156:159],v[228:231],a[172:175]
ds_read_b128 a[120:123],v4 offset:50176
v_exp_f32 v211,v211
v_exp_f32 v212,v212
v_mfma_f32_16x16x32_bf16 a[188:191],a[156:159],v[236:239],a[188:191]
s_add_u32 s30,s24,0
s_add_u32 s32,s24,4096
v_mfma_f32_16x16x32_bf16 a[188:191],a[152:155],v[232:235],a[188:191]
buffer_store_dwordx4 v[96:99],v22,s[16:19],s30 offen sc0 sc1
buffer_store_dwordx4 v[100:103],v22,s[16:19],s32 offen sc0 sc1
v_cvt_pk_bf16_f32 v181,v210,v211
v_fma_f32 v213,v213,s26,-v20
v_fma_f32 v214,v214,s26,-v20
v_mfma_f32_16x16x32_bf16 a[204:207],a[152:155],v[240:243],a[204:207]
v_mfma_f32_16x16x32_bf16 a[204:207],a[156:159],v[244:247],a[204:207]
ds_read_b128 a[124:127],v5 offset:50176
v_exp_f32 v213,v213
v_exp_f32 v214,v214
v_mfma_f32_16x16x32_bf16 a[220:223],a[156:159],v[252:255],a[220:223]
v_mfma_f32_16x16x32_bf16 a[220:223],a[152:155],v[248:251],a[220:223]
s_waitcnt lgkmcnt(4)
v_cvt_pk_bf16_f32 v182,v212,v213
v_fma_f32 v215,v215,s26,-v20
v_fma_f32 v216,v216,s26,-v21
v_fma_f32 v217,v217,s26,-v21
v_fma_f32 v218,v218,s26,-v21
v_mfma_f32_16x16x32_bf16 v[224:227],a[96:99],a[0:3],0
ds_read_b128 a[128:131],v2 offset:51200
v_mfma_f32_16x16x32_bf16 v[224:227],a[100:103],a[4:7],v[224:227]
v_mfma_f32_16x16x32_bf16 v[224:227],a[104:107],a[8:11],v[224:227]
v_mfma_f32_16x16x32_bf16 v[224:227],a[108:111],a[12:15],v[224:227]
v_exp_f32 v215,v215
v_exp_f32 v216,v216
v_exp_f32 v217,v217
v_mfma_f32_16x16x32_bf16 v[232:235],a[108:111],a[28:31],0
ds_read_b128 a[132:135],v3 offset:51200
v_mfma_f32_16x16x32_bf16 v[232:235],a[104:107],a[24:27],v[232:235]
v_mfma_f32_16x16x32_bf16 v[232:235],a[100:103],a[20:23],v[232:235]
v_mfma_f32_16x16x32_bf16 v[232:235],a[96:99],a[16:19],v[232:235]
v_cvt_pk_bf16_f32 v183,v214,v215
v_exp_f32 v218,v218
v_cvt_pk_bf16_f32 v188,v216,v217
v_fma_f32 v219,v219,s26,-v21
v_mfma_f32_16x16x32_bf16 v[240:243],a[96:99],a[32:35],0
ds_read_b128 a[136:139],v4 offset:51200
v_mfma_f32_16x16x32_bf16 v[240:243],a[100:103],a[36:39],v[240:243]
v_mfma_f32_16x16x32_bf16 v[240:243],a[104:107],a[40:43],v[240:243]
v_mfma_f32_16x16x32_bf16 v[240:243],a[108:111],a[44:47],v[240:243]
ds_read_b128 a[140:143],v5 offset:51200
v_exp_f32 v219,v219
v_fma_f32 v220,v220,s26,-v21
v_fma_f32 v221,v221,s26,-v21
v_mfma_f32_16x16x32_bf16 v[248:251],a[108:111],a[60:63],0
v_mfma_f32_16x16x32_bf16 v[248:251],a[104:107],a[56:59],v[248:251]
v_mfma_f32_16x16x32_bf16 v[248:251],a[100:103],a[52:55],v[248:251]
s_waitcnt lgkmcnt(4)
v_mfma_f32_16x16x32_bf16 v[248:251],a[96:99],a[48:51],v[248:251]
ds_read_b128 a[144:147],v2 offset:52224
v_exp_f32 v220,v220
v_exp_f32 v221,v221
v_mfma_f32_16x16x32_bf16 v[228:231],a[112:115],a[0:3],0
v_mfma_f32_16x16x32_bf16 v[228:231],a[116:119],a[4:7],v[228:231]
v_mfma_f32_16x16x32_bf16 v[228:231],a[120:123],a[8:11],v[228:231]
v_mfma_f32_16x16x32_bf16 v[228:231],a[124:127],a[12:15],v[228:231]
ds_read_b128 a[148:151],v3 offset:52224
v_cvt_pk_bf16_f32 v189,v218,v219
v_cvt_pk_bf16_f32 v190,v220,v221
v_fma_f32 v222,v222,s26,-v21
v_fma_f32 v223,v223,s26,-v21
v_mfma_f32_16x16x32_bf16 v[236:239],a[124:127],a[28:31],0
v_mfma_f32_16x16x32_bf16 v[236:239],a[120:123],a[24:27],v[236:239]
v_mfma_f32_16x16x32_bf16 v[236:239],a[116:119],a[20:23],v[236:239]
s_add_u32 s30,s24,8192
s_add_u32 s32,s24,12288
ds_read_b128 a[152:155],v4 offset:52224
v_mfma_f32_16x16x32_bf16 v[236:239],a[112:115],a[16:19],v[236:239]
buffer_store_dwordx4 v[104:107],v22,s[16:19],s30 offen sc0 sc1
buffer_store_dwordx4 v[108:111],v22,s[16:19],s32 offen sc0 sc1
v_exp_f32 v222,v222
v_exp_f32 v223,v223
v_mfma_f32_16x16x32_bf16 v[244:247],a[112:115],a[32:35],0
v_mfma_f32_16x16x32_bf16 v[244:247],a[116:119],a[36:39],v[244:247]
v_mfma_f32_16x16x32_bf16 v[244:247],a[120:123],a[40:43],v[244:247]
ds_read_b128 a[156:159],v5 offset:52224
v_mfma_f32_16x16x32_bf16 v[244:247],a[124:127],a[44:47],v[244:247]
v_cvt_pk_bf16_f32 v191,v222,v223
v_mfma_f32_16x16x32_bf16 v[252:255],a[124:127],a[60:63],0
v_mfma_f32_16x16x32_bf16 v[252:255],a[120:123],a[56:59],v[252:255]
v_mfma_f32_16x16x32_bf16 v[252:255],a[116:119],a[52:55],v[252:255]
v_mfma_f32_16x16x32_bf16 v[252:255],a[112:115],a[48:51],v[252:255]
s_waitcnt lgkmcnt(4)
v_mfma_f32_16x16x32_bf16 v[192:195],a[128:131],a[0:3],0
v_mfma_f32_16x16x32_bf16 v[192:195],a[132:135],a[4:7],v[192:195]
v_mfma_f32_16x16x32_bf16 v[192:195],a[136:139],a[8:11],v[192:195]
v_mfma_f32_16x16x32_bf16 v[192:195],a[140:143],a[12:15],v[192:195]
v_accvgpr_read_b32 v23,a244
v_accvgpr_read_b32 v24,a245
v_fma_f32 v224,v224,s26,-v18
v_fma_f32 v225,v225,s26,-v18
v_fma_f32 v226,v226,s26,-v18
v_fma_f32 v227,v227,s26,-v18
v_mfma_f32_16x16x32_bf16 v[200:203],a[140:143],a[28:31],0
ds_write_b128 v23,v[128:131] offset:16384
v_mfma_f32_16x16x32_bf16 v[200:203],a[136:139],a[24:27],v[200:203]
ds_read_b64_tr_b16 a[96:97],v6 offset:32768
v_mfma_f32_16x16x32_bf16 v[200:203],a[132:135],a[20:23],v[200:203]
s_add_u32 s30,s24,16384
s_add_u32 s32,s24,20480
ds_read_b64_tr_b16 a[98:99],v6 offset:33792
v_mfma_f32_16x16x32_bf16 v[200:203],a[128:131],a[16:19],v[200:203]
buffer_store_dwordx4 v[112:115],v22,s[16:19],s30 offen sc0 sc1
buffer_store_dwordx4 v[116:119],v22,s[16:19],s32 offen sc0 sc1
v_exp_f32 v224,v224
v_fma_f32 v228,v228,s26,-v18
v_mfma_f32_16x16x32_bf16 v[208:211],a[128:131],a[32:35],0
ds_read_b64_tr_b16 a[100:101],v6 offset:34816
v_mfma_f32_16x16x32_bf16 v[208:211],a[132:135],a[36:39],v[208:211]
ds_read_b64_tr_b16 a[102:103],v6 offset:35840
v_mfma_f32_16x16x32_bf16 v[208:211],a[136:139],a[40:43],v[208:211]
ds_write_b128 v23,v[132:135] offset:16448
v_mfma_f32_16x16x32_bf16 v[208:211],a[140:143],a[44:47],v[208:211]
ds_write_b128 v23,v[136:139] offset:16512
v_exp_f32 v225,v225
v_exp_f32 v226,v226
v_fma_f32 v229,v229,s26,-v18
v_mfma_f32_16x16x32_bf16 v[216:219],a[140:143],a[60:63],0
ds_read_b64_tr_b16 a[104:105],v6 offset:32776
v_mfma_f32_16x16x32_bf16 v[216:219],a[136:139],a[56:59],v[216:219]
ds_read_b64_tr_b16 a[106:107],v6 offset:33800
v_mfma_f32_16x16x32_bf16 v[216:219],a[132:135],a[52:55],v[216:219]
ds_write_b128 v23,v[140:143] offset:16576
v_mfma_f32_16x16x32_bf16 v[216:219],a[128:131],a[48:51],v[216:219]
s_waitcnt lgkmcnt(10)
ds_read_b128 v[128:131],v24 offset:16384
v_exp_f32 v227,v227
v_exp_f32 v228,v228
v_mfma_f32_16x16x32_bf16 v[196:199],a[144:147],a[0:3],0
ds_read_b64_tr_b16 a[108:109],v6 offset:34824
v_mfma_f32_16x16x32_bf16 v[196:199],a[148:151],a[4:7],v[196:199]
ds_read_b64_tr_b16 a[110:111],v6 offset:35848
v_mfma_f32_16x16x32_bf16 v[196:199],a[152:155],a[8:11],v[196:199]
ds_read_b128 v[132:135],v24 offset:17472
v_mfma_f32_16x16x32_bf16 v[196:199],a[156:159],a[12:15],v[196:199]
ds_read_b64_tr_b16 a[112:113],v7 offset:32768
v_exp_f32 v229,v229
v_cvt_pk_bf16_f32 v224,v224,v225
v_cvt_pk_bf16_f32 v225,v226,v227
v_mfma_f32_16x16x32_bf16 v[204:207],a[156:159],a[28:31],0
s_waitcnt lgkmcnt(14)
ds_read_b64_tr_b16 a[114:115],v7 offset:33792
v_mfma_f32_16x16x32_bf16 v[204:207],a[152:155],a[24:27],v[204:207]
s_waitcnt lgkmcnt(14)
ds_read_b128 v[136:139],v24 offset:18560
v_mfma_f32_16x16x32_bf16 v[204:207],a[148:151],a[20:23],v[204:207]
s_waitcnt lgkmcnt(14)
ds_read_b128 v[140:143],v24 offset:19648
v_mfma_f32_16x16x32_bf16 v[204:207],a[144:147],a[16:19],v[204:207]
s_waitcnt lgkmcnt(14)
ds_read_b64_tr_b16 a[116:117],v7 offset:34816
v_cvt_pk_bf16_f32 v226,v228,v229
v_fma_f32 v230,v230,s26,-v18
v_fma_f32 v231,v231,s26,-v18
v_fma_f32 v232,v232,s26,-v19
v_fma_f32 v233,v233,s26,-v19
v_mfma_f32_16x16x32_bf16 v[212:215],a[144:147],a[32:35],0
s_waitcnt lgkmcnt(14)
ds_read_b64_tr_b16 a[118:119],v7 offset:35840
v_mfma_f32_16x16x32_bf16 v[212:215],a[148:151],a[36:39],v[212:215]
s_waitcnt lgkmcnt(14)
ds_write_b128 v23,v[144:147] offset:16384
v_mfma_f32_16x16x32_bf16 v[212:215],a[152:155],a[40:43],v[212:215]
s_waitcnt lgkmcnt(14)
ds_write_b128 v23,v[148:151] offset:16448
v_mfma_f32_16x16x32_bf16 v[212:215],a[156:159],a[44:47],v[212:215]
s_waitcnt lgkmcnt(14)
ds_read_b64_tr_b16 a[120:121],v7 offset:32776
v_exp_f32 v230,v230
v_exp_f32 v231,v231
v_fma_f32 v234,v234,s26,-v19
v_mfma_f32_16x16x32_bf16 v[220:223],a[156:159],a[60:63],0
s_waitcnt lgkmcnt(14)
ds_read_b64_tr_b16 a[122:123],v7 offset:33800
v_mfma_f32_16x16x32_bf16 v[220:223],a[152:155],a[56:59],v[220:223]
s_waitcnt lgkmcnt(14)
ds_write_b128 v23,v[152:155] offset:16512
v_mfma_f32_16x16x32_bf16 v[220:223],a[148:151],a[52:55],v[220:223]
s_waitcnt lgkmcnt(14)
ds_read_b64_tr_b16 a[124:125],v7 offset:34824
v_mfma_f32_16x16x32_bf16 v[220:223],a[144:147],a[48:51],v[220:223]
s_waitcnt lgkmcnt(14)
ds_read_b64_tr_b16 a[126:127],v7 offset:35848
v_cvt_pk_bf16_f32 v227,v230,v231
v_exp_f32 v232,v232
v_exp_f32 v233,v233
v_mfma_f32_16x16x32_bf16 a[224:227],a[240:243],v[160:163],a[224:227]
s_add_u32 s30,s24,24576
s_add_u32 s32,s24,28672
s_waitcnt lgkmcnt(14)
ds_write_b128 v23,v[156:159] offset:16576
v_mfma_f32_16x16x32_bf16 a[224:227],a[240:243],v[164:167],a[224:227]
buffer_store_dwordx4 v[120:123],v22,s[16:19],s30 offen sc0 sc1
buffer_store_dwordx4 v[124:127],v22,s[16:19],s32 offen sc0 sc1
v_cvt_pk_bf16_f32 v232,v232,v233
v_exp_f32 v234,v234
v_mfma_f32_16x16x32_bf16 a[228:231],a[240:243],v[168:171],a[228:231]
s_waitcnt lgkmcnt(14)
ds_read_b64_tr_b16 a[128:129],v8 offset:32768
v_mfma_f32_16x16x32_bf16 a[228:231],a[240:243],v[172:175],a[228:231]
s_waitcnt lgkmcnt(14)
ds_read_b64_tr_b16 a[130:131],v8 offset:33792
v_fma_f32 v235,v235,s26,-v19
v_fma_f32 v236,v236,s26,-v19
v_fma_f32 v237,v237,s26,-v19
v_fma_f32 v238,v238,s26,-v19
v_fma_f32 v239,v239,s26,-v19
v_mfma_f32_16x16x32_bf16 a[232:235],a[240:243],v[176:179],a[232:235]
s_waitcnt lgkmcnt(14)
ds_read_b128 v[144:147],v24 offset:16384
v_mfma_f32_16x16x32_bf16 a[232:235],a[240:243],v[180:183],a[232:235]
s_waitcnt lgkmcnt(14)
ds_read_b128 v[148:151],v24 offset:17472
v_exp_f32 v235,v235
v_exp_f32 v236,v236
v_mfma_f32_16x16x32_bf16 a[236:239],a[240:243],v[184:187],a[236:239]
s_waitcnt lgkmcnt(14)
ds_read_b64_tr_b16 a[132:133],v8 offset:34816
v_mfma_f32_16x16x32_bf16 a[236:239],a[240:243],v[188:191],a[236:239]
s_waitcnt lgkmcnt(14)
ds_read_b64_tr_b16 a[134:135],v8 offset:35840
v_exp_f32 v237,v237
v_exp_f32 v238,v238
v_mfma_f32_16x16x32_bf16 v[80:83],a[96:99],v[184:187],v[80:83]
s_waitcnt lgkmcnt(14)
ds_read_b128 v[152:155],v24 offset:18560
v_mfma_f32_16x16x32_bf16 v[80:83],a[100:103],v[188:191],v[80:83]
s_waitcnt lgkmcnt(14)
ds_read_b64_tr_b16 a[136:137],v8 offset:32776
v_cvt_pk_bf16_f32 v233,v234,v235
v_exp_f32 v239,v239
v_cvt_pk_bf16_f32 v234,v236,v237
v_fma_f32 v240,v240,s26,-v20
v_mfma_f32_16x16x32_bf16 v[64:67],a[100:103],v[180:183],v[64:67]
s_add_u32 s30,s24,32768
s_add_u32 s32,s24,36864
s_waitcnt lgkmcnt(14)
ds_read_b64_tr_b16 a[138:139],v8 offset:33800
v_mfma_f32_16x16x32_bf16 v[64:67],a[96:99],v[176:179],v[64:67]
buffer_store_dwordx4 v[128:131],v22,s[16:19],s30 offen sc0 sc1
buffer_store_dwordx4 v[132:135],v22,s[16:19],s32 offen sc0 sc1
v_exp_f32 v240,v240
v_cvt_pk_bf16_f32 v235,v238,v239
v_fma_f32 v241,v241,s26,-v20
v_mfma_f32_16x16x32_bf16 v[48:51],a[96:99],v[168:171],v[48:51]
s_waitcnt lgkmcnt(14)
ds_read_b128 v[156:159],v24 offset:19648
v_mfma_f32_16x16x32_bf16 v[48:51],a[100:103],v[172:175],v[48:51]
s_waitcnt lgkmcnt(14)
ds_read_b64_tr_b16 a[140:141],v8 offset:34824
v_exp_f32 v241,v241
v_fma_f32 v242,v242,s26,-v20
v_fma_f32 v243,v243,s26,-v20
v_mfma_f32_16x16x32_bf16 v[32:35],a[100:103],v[164:167],v[32:35]
s_waitcnt lgkmcnt(14)
ds_read_b64_tr_b16 a[142:143],v8 offset:35848
v_mfma_f32_16x16x32_bf16 v[32:35],a[96:99],v[160:163],v[32:35]
v_exp_f32 v242,v242
v_exp_f32 v243,v243
v_cvt_pk_bf16_f32 v240,v240,v241
v_fma_f32 v244,v244,s26,-v20
v_mfma_f32_16x16x32_bf16 v[36:39],a[104:107],v[160:163],v[36:39]
v_mfma_f32_16x16x32_bf16 v[36:39],a[108:111],v[164:167],v[36:39]
s_waitcnt lgkmcnt(14)
ds_read_b64_tr_b16 a[144:145],v9 offset:32768
v_cvt_pk_bf16_f32 v241,v242,v243
v_exp_f32 v244,v244
v_fma_f32 v245,v245,s26,-v20
v_fma_f32 v246,v246,s26,-v20
v_mfma_f32_16x16x32_bf16 v[52:55],a[108:111],v[172:175],v[52:55]
s_waitcnt lgkmcnt(14)
ds_read_b64_tr_b16 a[146:147],v9 offset:33792
v_mfma_f32_16x16x32_bf16 v[52:55],a[104:107],v[168:171],v[52:55]
v_exp_f32 v245,v245
v_fma_f32 v247,v247,s26,-v20
v_exp_f32 v246,v246
v_mfma_f32_16x16x32_bf16 v[68:71],a[104:107],v[176:179],v[68:71]
s_waitcnt lgkmcnt(14)
ds_read_b64_tr_b16 a[148:149],v9 offset:34816
v_mfma_f32_16x16x32_bf16 v[68:71],a[108:111],v[180:183],v[68:71]
s_waitcnt lgkmcnt(14)
ds_read_b64_tr_b16 a[150:151],v9 offset:35840
v_cvt_pk_bf16_f32 v242,v244,v245
v_exp_f32 v247,v247
v_fma_f32 v248,v248,s26,-v21
v_fma_f32 v249,v249,s26,-v21
v_mfma_f32_16x16x32_bf16 v[84:87],a[108:111],v[188:191],v[84:87]
v_mfma_f32_16x16x32_bf16 v[84:87],a[104:107],v[184:187],v[84:87]
v_exp_f32 v248,v248
v_exp_f32 v249,v249
v_cvt_pk_bf16_f32 v243,v246,v247
v_fma_f32 v250,v250,s26,-v21
v_mfma_f32_16x16x32_bf16 v[88:91],a[112:115],v[184:187],v[88:91]
s_waitcnt lgkmcnt(14)
ds_read_b64_tr_b16 a[152:153],v9 offset:32776
v_mfma_f32_16x16x32_bf16 v[88:91],a[116:119],v[188:191],v[88:91]
s_waitcnt lgkmcnt(14)
ds_read_b64_tr_b16 a[154:155],v9 offset:33800
v_cvt_pk_bf16_f32 v248,v248,v249
v_exp_f32 v250,v250
v_fma_f32 v251,v251,s26,-v21
v_fma_f32 v252,v252,s26,-v21
v_mfma_f32_16x16x32_bf16 v[72:75],a[116:119],v[180:183],v[72:75]
v_mfma_f32_16x16x32_bf16 v[72:75],a[112:115],v[176:179],v[72:75]
s_waitcnt lgkmcnt(14)
ds_read_b64_tr_b16 a[156:157],v9 offset:34824
v_exp_f32 v251,v251
v_exp_f32 v252,v252
v_mfma_f32_16x16x32_bf16 v[56:59],a[112:115],v[168:171],v[56:59]
s_add_u32 s30,s24,40960
s_add_u32 s32,s24,45056
s_waitcnt lgkmcnt(14)
ds_read_b64_tr_b16 a[158:159],v9 offset:35848
v_mfma_f32_16x16x32_bf16 v[56:59],a[116:119],v[172:175],v[56:59]
buffer_store_dwordx4 v[136:139],v22,s[16:19],s30 offen sc0 sc1
buffer_store_dwordx4 v[140:143],v22,s[16:19],s32 offen sc0 sc1
v_cvt_pk_bf16_f32 v249,v250,v251
v_fma_f32 v253,v253,s26,-v21
v_fma_f32 v254,v254,s26,-v21
v_fma_f32 v255,v255,s26,-v21
v_mfma_f32_16x16x32_bf16 v[40:43],a[116:119],v[164:167],v[40:43]
v_mfma_f32_16x16x32_bf16 v[40:43],a[112:115],v[160:163],v[40:43]
v_exp_f32 v253,v253
v_exp_f32 v254,v254
v_exp_f32 v255,v255
v_mfma_f32_16x16x32_bf16 v[44:47],a[120:123],v[160:163],v[44:47]
v_mfma_f32_16x16x32_bf16 v[44:47],a[124:127],v[164:167],v[44:47]
v_cvt_pk_bf16_f32 v250,v252,v253
v_cvt_pk_bf16_f32 v251,v254,v255
v_mfma_f32_16x16x32_bf16 v[60:63],a[124:127],v[172:175],v[60:63]
v_mfma_f32_16x16x32_bf16 v[60:63],a[120:123],v[168:171],v[60:63]
v_mfma_f32_16x16x32_bf16 v[76:79],a[120:123],v[176:179],v[76:79]
v_mfma_f32_16x16x32_bf16 v[76:79],a[124:127],v[180:183],v[76:79]
v_fma_f32 v192,v192,s26,-v18
v_fma_f32 v193,v193,s26,-v18
v_fma_f32 v194,v194,s26,-v18
v_fma_f32 v195,v195,s26,-v18
v_fma_f32 v196,v196,s26,-v18
v_mfma_f32_16x16x32_bf16 v[92:95],a[124:127],v[188:191],v[92:95]
v_mfma_f32_16x16x32_bf16 v[92:95],a[120:123],v[184:187],v[92:95]
s_waitcnt lgkmcnt(14)
v_exp_f32 v192,v192
v_exp_f32 v193,v193
v_fma_f32 v197,v197,s26,-v18
v_mfma_f32_16x16x32_bf16 a[208:211],a[128:131],v[184:187],a[208:211]
v_mfma_f32_16x16x32_bf16 a[208:211],a[132:135],v[188:191],a[208:211]
v_cvt_pk_bf16_f32 v228,v192,v193
v_exp_f32 v194,v194
v_exp_f32 v195,v195
v_mfma_f32_16x16x32_bf16 a[192:195],a[132:135],v[180:183],a[192:195]
v_mfma_f32_16x16x32_bf16 a[192:195],a[128:131],v[176:179],a[192:195]
s_waitcnt vmcnt(28)
s_waitcnt lgkmcnt(0)
s_barrier
s_sub_u32 s20,s20,1
L_tail1:
v_exp_f32 v196,v196
v_exp_f32 v197,v197
v_mfma_f32_16x16x32_bf16 a[176:179],a[128:131],v[168:171],a[176:179]
s_add_u32 s30,s24,49152
s_add_u32 s32,s24,53248
v_mfma_f32_16x16x32_bf16 a[176:179],a[132:135],v[172:175],a[176:179]
buffer_store_dwordx4 v[144:147],v22,s[16:19],s30 offen sc0 sc1
buffer_store_dwordx4 v[148:151],v22,s[16:19],s32 offen sc0 sc1
v_cvt_pk_bf16_f32 v229,v194,v195
v_cvt_pk_bf16_f32 v230,v196,v197
v_fma_f32 v198,v198,s26,-v18
v_fma_f32 v199,v199,s26,-v18
v_mfma_f32_16x16x32_bf16 a[160:163],a[132:135],v[164:167],a[160:163]
v_mfma_f32_16x16x32_bf16 a[160:163],a[128:131],v[160:163],a[160:163]
v_exp_f32 v198,v198
v_exp_f32 v199,v199
v_mfma_f32_16x16x32_bf16 a[164:167],a[136:139],v[160:163],a[164:167]
v_mfma_f32_16x16x32_bf16 a[164:167],a[140:143],v[164:167],a[164:167]
v_cvt_pk_bf16_f32 v231,v198,v199
v_fma_f32 v200,v200,s26,-v19
v_fma_f32 v201,v201,s26,-v19
v_fma_f32 v202,v202,s26,-v19
v_fma_f32 v203,v203,s26,-v19
v_mfma_f32_16x16x32_bf16 a[180:183],a[140:143],v[172:175],a[180:183]
v_mfma_f32_16x16x32_bf16 a[180:183],a[136:139],v[168:171],a[180:183]
v_exp_f32 v200,v200
v_exp_f32 v201,v201
v_fma_f32 v204,v204,s26,-v19
v_mfma_f32_16x16x32_bf16 a[196:199],a[136:139],v[176:179],a[196:199]
v_mfma_f32_16x16x32_bf16 a[196:199],a[140:143],v[180:183],a[196:199]
v_cvt_pk_bf16_f32 v236,v200,v201
v_exp_f32 v202,v202
v_exp_f32 v203,v203
v_mfma_f32_16x16x32_bf16 a[212:215],a[140:143],v[188:191],a[212:215]
v_mfma_f32_16x16x32_bf16 a[212:215],a[136:139],v[184:187],a[212:215]
v_cvt_pk_bf16_f32 v237,v202,v203
v_exp_f32 v204,v204
v_fma_f32 v205,v205,s26,-v19
v_fma_f32 v206,v206,s26,-v19
v_mfma_f32_16x16x32_bf16 a[216:219],a[144:147],v[184:187],a[216:219]
v_mfma_f32_16x16x32_bf16 a[216:219],a[148:151],v[188:191],a[216:219]
v_exp_f32 v205,v205
v_fma_f32 v207,v207,s26,-v19
v_exp_f32 v206,v206
v_mfma_f32_16x16x32_bf16 a[200:203],a[148:151],v[180:183],a[200:203]
v_mfma_f32_16x16x32_bf16 a[200:203],a[144:147],v[176:179],a[200:203]
v_cvt_pk_bf16_f32 v238,v204,v205
v_exp_f32 v207,v207
v_fma_f32 v208,v208,s26,-v20
v_fma_f32 v209,v209,s26,-v20
v_mfma_f32_16x16x32_bf16 a[184:187],a[144:147],v[168:171],a[184:187]
v_mfma_f32_16x16x32_bf16 a[184:187],a[148:151],v[172:175],a[184:187]
v_exp_f32 v208,v208
v_exp_f32 v209,v209
v_mfma_f32_16x16x32_bf16 a[168:171],a[148:151],v[164:167],a[168:171]
v_mfma_f32_16x16x32_bf16 a[168:171],a[144:147],v[160:163],a[168:171]
v_cvt_pk_bf16_f32 v239,v206,v207
v_cvt_pk_bf16_f32 v244,v208,v209
v_fma_f32 v210,v210,s26,-v20
v_fma_f32 v211,v211,s26,-v20
v_fma_f32 v212,v212,s26,-v20
v_fma_f32 v213,v213,s26,-v20
v_mfma_f32_16x16x32_bf16 a[172:175],a[152:155],v[160:163],a[172:175]
v_mfma_f32_16x16x32_bf16 a[172:175],a[156:159],v[164:167],a[172:175]
v_exp_f32 v210,v210
v_exp_f32 v211,v211
v_mfma_f32_16x16x32_bf16 a[188:191],a[156:159],v[172:175],a[188:191]
s_add_u32 s30,s24,57344
s_add_u32 s32,s24,61440
v_mfma_f32_16x16x32_bf16 a[188:191],a[152:155],v[168:171],a[188:191]
buffer_store_dwordx4 v[152:155],v22,s[16:19],s30 offen sc0 sc1
buffer_store_dwordx4 v[156:159],v22,s[16:19],s32 offen sc0 sc1
v_cvt_pk_bf16_f32 v245,v210,v211
v_exp_f32 v212,v212
v_mfma_f32_16x16x32_bf16 a[204:207],a[152:155],v[176:179],a[204:207]
v_mfma_f32_16x16x32_bf16 a[204:207],a[156:159],v[180:183],a[204:207]
v_exp_f32 v213,v213
v_fma_f32 v214,v214,s26,-v20
v_fma_f32 v215,v215,s26,-v20
v_mfma_f32_16x16x32_bf16 a[220:223],a[156:159],v[188:191],a[220:223]
v_mfma_f32_16x16x32_bf16 a[220:223],a[152:155],v[184:187],a[220:223]
v_cvt_pk_bf16_f32 v246,v212,v213
v_exp_f32 v214,v214
v_exp_f32 v215,v215
s_nop 0
v_cvt_pk_bf16_f32 v247,v214,v215
v_fma_f32 v216,v216,s26,-v21
v_fma_f32 v217,v217,s26,-v21
v_fma_f32 v218,v218,s26,-v21
v_fma_f32 v219,v219,s26,-v21
v_exp_f32 v216,v216
v_exp_f32 v217,v217
v_fma_f32 v220,v220,s26,-v21
v_exp_f32 v218,v218
v_exp_f32 v219,v219
v_cvt_pk_bf16_f32 v252,v216,v217
v_exp_f32 v220,v220
v_cvt_pk_bf16_f32 v253,v218,v219
v_fma_f32 v221,v221,s26,-v21
v_exp_f32 v221,v221
v_fma_f32 v222,v222,s26,-v21
v_fma_f32 v223,v223,s26,-v21
v_cvt_pk_bf16_f32 v254,v220,v221
v_exp_f32 v222,v222
v_exp_f32 v223,v223
s_nop 0
v_cvt_pk_bf16_f32 v255,v222,v223
ds_read_b64_tr_b16 a[96:97],v6 offset:49152
ds_read_b64_tr_b16 a[98:99],v6 offset:50176
ds_read_b64_tr_b16 a[100:101],v6 offset:51200
ds_read_b64_tr_b16 a[102:103],v6 offset:52224
ds_read_b64_tr_b16 a[104:105],v6 offset:49160
ds_read_b64_tr_b16 a[106:107],v6 offset:50184
ds_read_b64_tr_b16 a[108:109],v6 offset:51208
ds_read_b64_tr_b16 a[110:111],v6 offset:52232
ds_read_b64_tr_b16 a[112:113],v7 offset:49152
ds_read_b64_tr_b16 a[114:115],v7 offset:50176
ds_read_b64_tr_b16 a[116:117],v7 offset:51200
ds_read_b64_tr_b16 a[118:119],v7 offset:52224
ds_read_b64_tr_b16 a[120:121],v7 offset:49160
ds_read_b64_tr_b16 a[122:123],v7 offset:50184
ds_read_b64_tr_b16 a[124:125],v7 offset:51208
s_waitcnt lgkmcnt(14)
ds_read_b64_tr_b16 a[126:127],v7 offset:52232
v_mfma_f32_16x16x32_bf16 a[224:227],a[240:243],v[224:227],a[224:227]
v_mfma_f32_16x16x32_bf16 a[224:227],a[240:243],v[228:231],a[224:227]
v_mfma_f32_16x16x32_bf16 a[228:231],a[240:243],v[232:235],a[228:231]
s_waitcnt lgkmcnt(14)
ds_read_b64_tr_b16 a[128:129],v8 offset:49152
v_mfma_f32_16x16x32_bf16 a[228:231],a[240:243],v[236:239],a[228:231]
s_waitcnt lgkmcnt(14)
ds_read_b64_tr_b16 a[130:131],v8 offset:50176
v_mfma_f32_16x16x32_bf16 a[232:235],a[240:243],v[240:243],a[232:235]
v_mfma_f32_16x16x32_bf16 a[232:235],a[240:243],v[244:247],a[232:235]
s_waitcnt lgkmcnt(14)
v_mfma_f32_16x16x32_bf16 a[236:239],a[240:243],v[248:251],a[236:239]
ds_read_b64_tr_b16 a[132:133],v8 offset:51200
v_mfma_f32_16x16x32_bf16 a[236:239],a[240:243],v[252:255],a[236:239]
s_waitcnt lgkmcnt(14)
ds_read_b64_tr_b16 a[134:135],v8 offset:52224
v_mfma_f32_16x16x32_bf16 v[80:83],a[96:99],v[248:251],v[80:83]
v_mfma_f32_16x16x32_bf16 v[80:83],a[100:103],v[252:255],v[80:83]
s_waitcnt lgkmcnt(14)
ds_read_b64_tr_b16 a[136:137],v8 offset:49160
v_mfma_f32_16x16x32_bf16 v[64:67],a[100:103],v[244:247],v[64:67]
s_waitcnt lgkmcnt(14)
ds_read_b64_tr_b16 a[138:139],v8 offset:50184
v_mfma_f32_16x16x32_bf16 v[64:67],a[96:99],v[240:243],v[64:67]
v_mfma_f32_16x16x32_bf16 v[48:51],a[96:99],v[232:235],v[48:51]
v_mfma_f32_16x16x32_bf16 v[48:51],a[100:103],v[236:239],v[48:51]
s_waitcnt lgkmcnt(14)
ds_read_b64_tr_b16 a[140:141],v8 offset:51208
v_mfma_f32_16x16x32_bf16 v[32:35],a[100:103],v[228:231],v[32:35]
s_waitcnt lgkmcnt(14)
ds_read_b64_tr_b16 a[142:143],v8 offset:52232
v_mfma_f32_16x16x32_bf16 v[32:35],a[96:99],v[224:227],v[32:35]
v_mfma_f32_16x16x32_bf16 v[36:39],a[104:107],v[224:227],v[36:39]
v_mfma_f32_16x16x32_bf16 v[36:39],a[108:111],v[228:231],v[36:39]
s_waitcnt lgkmcnt(14)
ds_read_b64_tr_b16 a[144:145],v9 offset:49152
v_mfma_f32_16x16x32_bf16 v[52:55],a[108:111],v[236:239],v[52:55]
s_waitcnt lgkmcnt(14)
ds_read_b64_tr_b16 a[146:147],v9 offset:50176
v_mfma_f32_16x16x32_bf16 v[52:55],a[104:107],v[232:235],v[52:55]
v_mfma_f32_16x16x32_bf16 v[68:71],a[104:107],v[240:243],v[68:71]
s_waitcnt lgkmcnt(14)
ds_read_b64_tr_b16 a[148:149],v9 offset:51200
v_mfma_f32_16x16x32_bf16 v[68:71],a[108:111],v[244:247],v[68:71]
s_waitcnt lgkmcnt(14)
ds_read_b64_tr_b16 a[150:151],v9 offset:52224
v_mfma_f32_16x16x32_bf16 v[84:87],a[108:111],v[252:255],v[84:87]
v_mfma_f32_16x16x32_bf16 v[84:87],a[104:107],v[248:251],v[84:87]
v_mfma_f32_16x16x32_bf16 v[88:91],a[112:115],v[248:251],v[88:91]
s_waitcnt lgkmcnt(14)
ds_read_b64_tr_b16 a[152:153],v9 offset:49160
v_mfma_f32_16x16x32_bf16 v[88:91],a[116:119],v[252:255],v[88:91]
s_waitcnt lgkmcnt(14)
ds_read_b64_tr_b16 a[154:155],v9 offset:50184
v_mfma_f32_16x16x32_bf16 v[72:75],a[116:119],v[244:247],v[72:75]
v_mfma_f32_16x16x32_bf16 v[72:75],a[112:115],v[240:243],v[72:75]
s_waitcnt lgkmcnt(14)
ds_read_b64_tr_b16 a[156:157],v9 offset:51208
v_mfma_f32_16x16x32_bf16 v[56:59],a[112:115],v[232:235],v[56:59]
s_waitcnt lgkmcnt(14)
ds_read_b64_tr_b16 a[158:159],v9 offset:52232
v_mfma_f32_16x16x32_bf16 v[56:59],a[116:119],v[236:239],v[56:59]
v_mfma_f32_16x16x32_bf16 v[40:43],a[116:119],v[228:231],v[40:43]
v_mfma_f32_16x16x32_bf16 v[40:43],a[112:115],v[224:227],v[40:43]
v_mfma_f32_16x16x32_bf16 v[44:47],a[120:123],v[224:227],v[44:47]
v_mfma_f32_16x16x32_bf16 v[44:47],a[124:127],v[228:231],v[44:47]
v_mfma_f32_16x16x32_bf16 v[60:63],a[124:127],v[236:239],v[60:63]
v_mfma_f32_16x16x32_bf16 v[60:63],a[120:123],v[232:235],v[60:63]
v_mfma_f32_16x16x32_bf16 v[76:79],a[120:123],v[240:243],v[76:79]
v_mfma_f32_16x16x32_bf16 v[76:79],a[124:127],v[244:247],v[76:79]
v_mfma_f32_16x16x32_bf16 v[92:95],a[124:127],v[252:255],v[92:95]
v_mfma_f32_16x16x32_bf16 v[92:95],a[120:123],v[248:251],v[92:95]
s_waitcnt lgkmcnt(12)
v_mfma_f32_16x16x32_bf16 a[208:211],a[128:131],v[248:251],a[208:211]
v_mfma_f32_16x16x32_bf16 a[208:211],a[132:135],v[252:255],a[208:211]
v_mfma_f32_16x16x32_bf16 a[192:195],a[132:135],v[244:247],a[192:195]
v_mfma_f32_16x16x32_bf16 a[192:195],a[128:131],v[240:243],a[192:195]
v_mfma_f32_16x16x32_bf16 a[176:179],a[128:131],v[232:235],a[176:179]
v_mfma_f32_16x16x32_bf16 a[176:179],a[132:135],v[236:239],a[176:179]
v_mfma_f32_16x16x32_bf16 a[160:163],a[132:135],v[228:231],a[160:163]
s_waitcnt lgkmcnt(8)
v_mfma_f32_16x16x32_bf16 a[160:163],a[128:131],v[224:227],a[160:163]
v_mfma_f32_16x16x32_bf16 a[164:167],a[136:139],v[224:227],a[164:167]
v_mfma_f32_16x16x32_bf16 a[164:167],a[140:143],v[228:231],a[164:167]
v_mfma_f32_16x16x32_bf16 a[180:183],a[140:143],v[236:239],a[180:183]
v_mfma_f32_16x16x32_bf16 a[180:183],a[136:139],v[232:235],a[180:183]
v_mfma_f32_16x16x32_bf16 a[196:199],a[136:139],v[240:243],a[196:199]
v_mfma_f32_16x16x32_bf16 a[196:199],a[140:143],v[244:247],a[196:199]
v_mfma_f32_16x16x32_bf16 a[212:215],a[140:143],v[252:255],a[212:215]
v_mfma_f32_16x16x32_bf16 a[212:215],a[136:139],v[248:251],a[212:215]
s_waitcnt lgkmcnt(4)
v_mfma_f32_16x16x32_bf16 a[216:219],a[144:147],v[248:251],a[216:219]
v_mfma_f32_16x16x32_bf16 a[216:219],a[148:151],v[252:255],a[216:219]
v_mfma_f32_16x16x32_bf16 a[200:203],a[148:151],v[244:247],a[200:203]
v_mfma_f32_16x16x32_bf16 a[200:203],a[144:147],v[240:243],a[200:203]
v_mfma_f32_16x16x32_bf16 a[184:187],a[144:147],v[232:235],a[184:187]
v_mfma_f32_16x16x32_bf16 a[184:187],a[148:151],v[236:239],a[184:187]
v_mfma_f32_16x16x32_bf16 a[168:171],a[148:151],v[228:231],a[168:171]
v_mfma_f32_16x16x32_bf16 a[168:171],a[144:147],v[224:227],a[168:171]
s_waitcnt lgkmcnt(0)
v_mfma_f32_16x16x32_bf16 a[172:175],a[152:155],v[224:227],a[172:175]
v_mfma_f32_16x16x32_bf16 a[172:175],a[156:159],v[228:231],a[172:175]
v_mfma_f32_16x16x32_bf16 a[188:191],a[156:159],v[236:239],a[188:191]
v_mfma_f32_16x16x32_bf16 a[188:191],a[152:155],v[232:235],a[188:191]
v_mfma_f32_16x16x32_bf16 a[204:207],a[152:155],v[240:243],a[204:207]
v_mfma_f32_16x16x32_bf16 a[204:207],a[156:159],v[244:247],a[204:207]
v_mfma_f32_16x16x32_bf16 a[220:223],a[156:159],v[252:255],a[220:223]
v_mfma_f32_16x16x32_bf16 a[220:223],a[152:155],v[248:251],a[220:223]
v_accvgpr_read_b32 v14,a224
v_accvgpr_read_b32 v15,a228
v_accvgpr_read_b32 v16,a232
v_accvgpr_read_b32 v17,a236
v_add_f32 v31,v14,v15
v_add_f32 v31,v31,v16
v_add_f32 v31,v31,v17
v_cmp_nge_f32 vcc,s27,v31
v_rcp_f32 v14,v14
v_rcp_f32 v15,v15
v_rcp_f32 v16,v16
v_rcp_f32 v17,v17
s_cmp_lg_u64 vcc,0
s_cselect_b32 s32,s29,0
s_or_b32 s28,s28,s32
s_lshl_b32 s29,s29,1
s_add_u32 s24,s24,65536
v_accvgpr_read_b32 v23,a244
v_accvgpr_read_b32 v24,a245
v_accvgpr_read_b32 v96,a160
v_accvgpr_read_b32 v97,a161
v_accvgpr_read_b32 v98,a162
v_accvgpr_read_b32 v99,a163
v_accvgpr_read_b32 v100,a164
v_accvgpr_read_b32 v101,a165
v_accvgpr_read_b32 v102,a166
v_accvgpr_read_b32 v103,a167
v_accvgpr_read_b32 v104,a168
v_accvgpr_read_b32 v105,a169
v_accvgpr_read_b32 v106,a170
v_accvgpr_read_b32 v107,a171
v_accvgpr_read_b32 v108,a172
v_accvgpr_read_b32 v109,a173
v_accvgpr_read_b32 v110,a174
v_accvgpr_read_b32 v111,a175
v_pk_mul_f32 v[32:33],v[32:33],v[14:15] op_sel_hi:[1,0]
v_pk_mul_f32 v[34:35],v[34:35],v[14:15] op_sel_hi:[1,0]
v_pk_mul_f32 v[36:37],v[36:37],v[14:15] op_sel_hi:[1,0]
v_pk_mul_f32 v[38:39],v[38:39],v[14:15] op_sel_hi:[1,0]
v_pk_mul_f32 v[40:41],v[40:41],v[14:15] op_sel_hi:[1,0]
v_pk_mul_f32 v[42:43],v[42:43],v[14:15] op_sel_hi:[1,0]
v_pk_mul_f32 v[44:45],v[44:45],v[14:15] op_sel_hi:[1,0]
v_pk_mul_f32 v[46:47],v[46:47],v[14:15] op_sel_hi:[1,0]
v_pk_mul_f32 v[96:97],v[96:97],v[14:15] op_sel_hi:[1,0]
v_pk_mul_f32 v[98:99],v[98:99],v[14:15] op_sel_hi:[1,0]
v_pk_mul_f32 v[100:101],v[100:101],v[14:15] op_sel_hi:[1,0]
v_pk_mul_f32 v[102:103],v[102:103],v[14:15] op_sel_hi:[1,0]
v_pk_mul_f32 v[104:105],v[104:105],v[14:15] op_sel_hi:[1,0]
v_pk_mul_f32 v[106:107],v[106:107],v[14:15] op_sel_hi:[1,0]
v_pk_mul_f32 v[108:109],v[108:109],v[14:15] op_sel_hi:[1,0]
v_pk_mul_f32 v[110:111],v[110:111],v[14:15] op_sel_hi:[1,0]
v_cvt_pk_bf16_f32 v32,v32,v33
v_cvt_pk_bf16_f32 v33,v34,v35
v_cvt_pk_bf16_f32 v34,v36,v37
v_cvt_pk_bf16_f32 v35,v38,v39
v_cvt_pk_bf16_f32 v40,v40,v41
v_cvt_pk_bf16_f32 v41,v42,v43
v_cvt_pk_bf16_f32 v42,v44,v45
v_cvt_pk_bf16_f32 v43,v46,v47
v_cvt_pk_bf16_f32 v96,v96,v97
v_cvt_pk_bf16_f32 v97,v98,v99
v_cvt_pk_bf16_f32 v98,v100,v101
v_cvt_pk_bf16_f32 v99,v102,v103
v_cvt_pk_bf16_f32 v104,v104,v105
v_cvt_pk_bf16_f32 v105,v106,v107
v_cvt_pk_bf16_f32 v106,v108,v109
v_cvt_pk_bf16_f32 v107,v110,v111
ds_write_b128 v23,v[32:35] offset:32768
ds_write_b128 v23,v[40:43] offset:32832
ds_write_b128 v23,v[96:99] offset:32896
ds_write_b128 v23,v[104:107] offset:32960
ds_read_b128 v[32:35],v24 offset:32768
ds_read_b128 v[40:43],v24 offset:33856
ds_read_b128 v[96:99],v24 offset:34944
ds_read_b128 v[104:107],v24 offset:36032
v_accvgpr_read_b32 v112,a176
v_accvgpr_read_b32 v113,a177
v_accvgpr_read_b32 v114,a178
v_accvgpr_read_b32 v115,a179
v_accvgpr_read_b32 v116,a180
v_accvgpr_read_b32 v117,a181
v_accvgpr_read_b32 v118,a182
v_accvgpr_read_b32 v119,a183
v_accvgpr_read_b32 v120,a184
v_accvgpr_read_b32 v121,a185
v_accvgpr_read_b32 v122,a186
v_accvgpr_read_b32 v123,a187
v_accvgpr_read_b32 v124,a188
v_accvgpr_read_b32 v125,a189
v_accvgpr_read_b32 v126,a190
v_accvgpr_read_b32 v127,a191
v_pk_mul_f32 v[48:49],v[48:49],v[14:15] op_sel:[0,1] op_sel_hi:[1,1]
v_pk_mul_f32 v[50:51],v[50:51],v[14:15] op_sel:[0,1] op_sel_hi:[1,1]
v_pk_mul_f32 v[52:53],v[52:53],v[14:15] op_sel:[0,1] op_sel_hi:[1,1]
v_pk_mul_f32 v[54:55],v[54:55],v[14:15] op_sel:[0,1] op_sel_hi:[1,1]
v_pk_mul_f32 v[56:57],v[56:57],v[14:15] op_sel:[0,1] op_sel_hi:[1,1]
v_pk_mul_f32 v[58:59],v[58:59],v[14:15] op_sel:[0,1] op_sel_hi:[1,1]
v_pk_mul_f32 v[60:61],v[60:61],v[14:15] op_sel:[0,1] op_sel_hi:[1,1]
v_pk_mul_f32 v[62:63],v[62:63],v[14:15] op_sel:[0,1] op_sel_hi:[1,1]
v_pk_mul_f32 v[112:113],v[112:113],v[14:15] op_sel:[0,1] op_sel_hi:[1,1]
v_pk_mul_f32 v[114:115],v[114:115],v[14:15] op_sel:[0,1] op_sel_hi:[1,1]
v_pk_mul_f32 v[116:117],v[116:117],v[14:15] op_sel:[0,1] op_sel_hi:[1,1]
v_pk_mul_f32 v[118:119],v[118:119],v[14:15] op_sel:[0,1] op_sel_hi:[1,1]
v_pk_mul_f32 v[120:121],v[120:121],v[14:15] op_sel:[0,1] op_sel_hi:[1,1]
v_pk_mul_f32 v[122:123],v[122:123],v[14:15] op_sel:[0,1] op_sel_hi:[1,1]
v_pk_mul_f32 v[124:125],v[124:125],v[14:15] op_sel:[0,1] op_sel_hi:[1,1]
v_pk_mul_f32 v[126:127],v[126:127],v[14:15] op_sel:[0,1] op_sel_hi:[1,1]
s_add_u32 s30,s24,0
s_waitcnt lgkmcnt(3)
buffer_store_dwordx4 v[32:35],v22,s[16:19],s30 offen sc0 sc1
s_add_u32 s32,s24,4096
s_waitcnt lgkmcnt(2)
buffer_store_dwordx4 v[40:43],v22,s[16:19],s32 offen sc0 sc1
s_add_u32 s30,s24,8192
s_waitcnt lgkmcnt(1)
buffer_store_dwordx4 v[96:99],v22,s[16:19],s30 offen sc0 sc1
s_add_u32 s32,s24,12288
s_waitcnt lgkmcnt(0)
buffer_store_dwordx4 v[104:107],v22,s[16:19],s32 offen sc0 sc1
v_cvt_pk_bf16_f32 v48,v48,v49
v_cvt_pk_bf16_f32 v49,v50,v51
v_cvt_pk_bf16_f32 v50,v52,v53
v_cvt_pk_bf16_f32 v51,v54,v55
v_cvt_pk_bf16_f32 v56,v56,v57
v_cvt_pk_bf16_f32 v57,v58,v59
v_cvt_pk_bf16_f32 v58,v60,v61
v_cvt_pk_bf16_f32 v59,v62,v63
v_cvt_pk_bf16_f32 v112,v112,v113
v_cvt_pk_bf16_f32 v113,v114,v115
v_cvt_pk_bf16_f32 v114,v116,v117
v_cvt_pk_bf16_f32 v115,v118,v119
v_cvt_pk_bf16_f32 v120,v120,v121
v_cvt_pk_bf16_f32 v121,v122,v123
v_cvt_pk_bf16_f32 v122,v124,v125
v_cvt_pk_bf16_f32 v123,v126,v127
ds_write_b128 v23,v[48:51] offset:32768
ds_write_b128 v23,v[56:59] offset:32832
ds_write_b128 v23,v[112:115] offset:32896
ds_write_b128 v23,v[120:123] offset:32960
ds_read_b128 v[48:51],v24 offset:32768
ds_read_b128 v[56:59],v24 offset:33856
ds_read_b128 v[112:115],v24 offset:34944
ds_read_b128 v[120:123],v24 offset:36032
v_accvgpr_read_b32 v128,a192
v_accvgpr_read_b32 v129,a193
v_accvgpr_read_b32 v130,a194
v_accvgpr_read_b32 v131,a195
v_accvgpr_read_b32 v132,a196
v_accvgpr_read_b32 v133,a197
v_accvgpr_read_b32 v134,a198
v_accvgpr_read_b32 v135,a199
v_accvgpr_read_b32 v136,a200
v_accvgpr_read_b32 v137,a201
v_accvgpr_read_b32 v138,a202
v_accvgpr_read_b32 v139,a203
v_accvgpr_read_b32 v140,a204
v_accvgpr_read_b32 v141,a205
v_accvgpr_read_b32 v142,a206
v_accvgpr_read_b32 v143,a207
v_pk_mul_f32 v[64:65],v[64:65],v[16:17] op_sel_hi:[1,0]
v_pk_mul_f32 v[66:67],v[66:67],v[16:17] op_sel_hi:[1,0]
v_pk_mul_f32 v[68:69],v[68:69],v[16:17] op_sel_hi:[1,0]
v_pk_mul_f32 v[70:71],v[70:71],v[16:17] op_sel_hi:[1,0]
v_pk_mul_f32 v[72:73],v[72:73],v[16:17] op_sel_hi:[1,0]
v_pk_mul_f32 v[74:75],v[74:75],v[16:17] op_sel_hi:[1,0]
v_pk_mul_f32 v[76:77],v[76:77],v[16:17] op_sel_hi:[1,0]
v_pk_mul_f32 v[78:79],v[78:79],v[16:17] op_sel_hi:[1,0]
v_pk_mul_f32 v[128:129],v[128:129],v[16:17] op_sel_hi:[1,0]
v_pk_mul_f32 v[130:131],v[130:131],v[16:17] op_sel_hi:[1,0]
v_pk_mul_f32 v[132:133],v[132:133],v[16:17] op_sel_hi:[1,0]
v_pk_mul_f32 v[134:135],v[134:135],v[16:17] op_sel_hi:[1,0]
v_pk_mul_f32 v[136:137],v[136:137],v[16:17] op_sel_hi:[1,0]
v_pk_mul_f32 v[138:139],v[138:139],v[16:17] op_sel_hi:[1,0]
v_pk_mul_f32 v[140:141],v[140:141],v[16:17] op_sel_hi:[1,0]
v_pk_mul_f32 v[142:143],v[142:143],v[16:17] op_sel_hi:[1,0]
s_add_u32 s30,s24,16384
s_waitcnt lgkmcnt(3)
buffer_store_dwordx4 v[48:51],v22,s[16:19],s30 offen sc0 sc1
s_add_u32 s32,s24,20480
s_waitcnt lgkmcnt(2)
buffer_store_dwordx4 v[56:59],v22,s[16:19],s32 offen sc0 sc1
s_add_u32 s30,s24,24576
s_waitcnt lgkmcnt(1)
buffer_store_dwordx4 v[112:115],v22,s[16:19],s30 offen sc0 sc1
s_add_u32 s32,s24,28672
s_waitcnt lgkmcnt(0)
buffer_store_dwordx4 v[120:123],v22,s[16:19],s32 offen sc0 sc1
v_cvt_pk_bf16_f32 v64,v64,v65
v_cvt_pk_bf16_f32 v65,v66,v67
v_cvt_pk_bf16_f32 v66,v68,v69
v_cvt_pk_bf16_f32 v67,v70,v71
v_cvt_pk_bf16_f32 v72,v72,v73
v_cvt_pk_bf16_f32 v73,v74,v75
v_cvt_pk_bf16_f32 v74,v76,v77
v_cvt_pk_bf16_f32 v75,v78,v79
v_cvt_pk_bf16_f32 v128,v128,v129
v_cvt_pk_bf16_f32 v129,v130,v131
v_cvt_pk_bf16_f32 v130,v132,v133
v_cvt_pk_bf16_f32 v131,v134,v135
v_cvt_pk_bf16_f32 v136,v136,v137
v_cvt_pk_bf16_f32 v137,v138,v139
v_cvt_pk_bf16_f32 v138,v140,v141
v_cvt_pk_bf16_f32 v139,v142,v143
ds_write_b128 v23,v[64:67] offset:32768
ds_write_b128 v23,v[72:75] offset:32832
ds_write_b128 v23,v[128:131] offset:32896
ds_write_b128 v23,v[136:139] offset:32960
ds_read_b128 v[64:67],v24 offset:32768
ds_read_b128 v[72:75],v24 offset:33856
ds_read_b128 v[128:131],v24 offset:34944
ds_read_b128 v[136:139],v24 offset:36032
v_accvgpr_read_b32 v144,a208
v_accvgpr_read_b32 v145,a209
v_accvgpr_read_b32 v146,a210
v_accvgpr_read_b32 v147,a211
v_accvgpr_read_b32 v148,a212
v_accvgpr_read_b32 v149,a213
v_accvgpr_read_b32 v150,a214
v_accvgpr_read_b32 v151,a215
v_accvgpr_read_b32 v152,a216
v_accvgpr_read_b32 v153,a217
v_accvgpr_read_b32 v154,a218
v_accvgpr_read_b32 v155,a219
v_accvgpr_read_b32 v156,a220
v_accvgpr_read_b32 v157,a221
v_accvgpr_read_b32 v158,a222
v_accvgpr_read_b32 v159,a223
v_pk_mul_f32 v[80:81],v[80:81],v[16:17] op_sel:[0,1] op_sel_hi:[1,1]
v_pk_mul_f32 v[82:83],v[82:83],v[16:17] op_sel:[0,1] op_sel_hi:[1,1]
v_pk_mul_f32 v[84:85],v[84:85],v[16:17] op_sel:[0,1] op_sel_hi:[1,1]
v_pk_mul_f32 v[86:87],v[86:87],v[16:17] op_sel:[0,1] op_sel_hi:[1,1]
v_pk_mul_f32 v[88:89],v[88:89],v[16:17] op_sel:[0,1] op_sel_hi:[1,1]
v_pk_mul_f32 v[90:91],v[90:91],v[16:17] op_sel:[0,1] op_sel_hi:[1,1]
v_pk_mul_f32 v[92:93],v[92:93],v[16:17] op_sel:[0,1] op_sel_hi:[1,1]
v_pk_mul_f32 v[94:95],v[94:95],v[16:17] op_sel:[0,1] op_sel_hi:[1,1]
v_pk_mul_f32 v[144:145],v[144:145],v[16:17] op_sel:[0,1] op_sel_hi:[1,1]
v_pk_mul_f32 v[146:147],v[146:147],v[16:17] op_sel:[0,1] op_sel_hi:[1,1]
v_pk_mul_f32 v[148:149],v[148:149],v[16:17] op_sel:[0,1] op_sel_hi:[1,1]
v_pk_mul_f32 v[150:151],v[150:151],v[16:17] op_sel:[0,1] op_sel_hi:[1,1]
v_pk_mul_f32 v[152:153],v[152:153],v[16:17] op_sel:[0,1] op_sel_hi:[1,1]
v_pk_mul_f32 v[154:155],v[154:155],v[16:17] op_sel:[0,1] op_sel_hi:[1,1]
v_pk_mul_f32 v[156:157],v[156:157],v[16:17] op_sel:[0,1] op_sel_hi:[1,1]
v_pk_mul_f32 v[158:159],v[158:159],v[16:17] op_sel:[0,1] op_sel_hi:[1,1]
s_add_u32 s30,s24,32768
s_waitcnt lgkmcnt(3)
buffer_store_dwordx4 v[64:67],v22,s[16:19],s30 offen sc0 sc1
s_add_u32 s32,s24,36864
s_waitcnt lgkmcnt(2)
buffer_store_dwordx4 v[72:75],v22,s[16:19],s32 offen sc0 sc1
s_add_u32 s30,s24,40960
s_waitcnt lgkmcnt(1)
buffer_store_dwordx4 v[128:131],v22,s[16:19],s30 offen sc0 sc1
s_add_u32 s32,s24,45056
s_waitcnt lgkmcnt(0)
buffer_store_dwordx4 v[136:139],v22,s[16:19],s32 offen sc0 sc1
v_cvt_pk_bf16_f32 v80,v80,v81
v_cvt_pk_bf16_f32 v81,v82,v83
v_cvt_pk_bf16_f32 v82,v84,v85
v_cvt_pk_bf16_f32 v83,v86,v87
v_cvt_pk_bf16_f32 v88,v88,v89
v_cvt_pk_bf16_f32 v89,v90,v91
v_cvt_pk_bf16_f32 v90,v92,v93
v_cvt_pk_bf16_f32 v91,v94,v95
v_cvt_pk_bf16_f32 v144,v144,v145
v_cvt_pk_bf16_f32 v145,v146,v147
v_cvt_pk_bf16_f32 v146,v148,v149
v_cvt_pk_bf16_f32 v147,v150,v151
v_cvt_pk_bf16_f32 v152,v152,v153
v_cvt_pk_bf16_f32 v153,v154,v155
v_cvt_pk_bf16_f32 v154,v156,v157
v_cvt_pk_bf16_f32 v155,v158,v159
ds_write_b128 v23,v[80:83] offset:32768
ds_write_b128 v23,v[88:91] offset:32832
ds_write_b128 v23,v[144:147] offset:32896
ds_write_b128 v23,v[152:155] offset:32960
ds_read_b128 v[80:83],v24 offset:32768
ds_read_b128 v[88:91],v24 offset:33856
ds_read_b128 v[144:147],v24 offset:34944
ds_read_b128 v[152:155],v24 offset:36032
s_add_u32 s30,s24,49152
s_waitcnt lgkmcnt(3)
buffer_store_dwordx4 v[80:83],v22,s[16:19],s30 offen sc0 sc1
s_add_u32 s32,s24,53248
s_waitcnt lgkmcnt(2)
buffer_store_dwordx4 v[88:91],v22,s[16:19],s32 offen sc0 sc1
s_add_u32 s30,s24,57344
s_waitcnt lgkmcnt(1)
buffer_store_dwordx4 v[144:147],v22,s[16:19],s30 offen sc0 sc1
s_add_u32 s32,s24,61440
s_waitcnt lgkmcnt(0)
buffer_store_dwordx4 v[152:155],v22,s[16:19],s32 offen sc0 sc1
s_add_u32 s24,s24,65536
s_lshl_b32 s30,s31,2
s_add_u32 s30,s30,0
v_mov_b32 v23,s30
v_mov_b32 v24,s28
ds_write_b32 v23,v24
v_mov_b32 v23,0
s_waitcnt lgkmcnt(0)
s_barrier
ds_read_b128 v[24:27],v23 offset:0
s_waitcnt lgkmcnt(0)
v_or_b32 v24,v24,v25
v_or3_b32 v24,v24,v26,v27
s_nop 0
v_readfirstlane_b32 s28,v24
s_nop 3
s_cmp_lg_u32 s28,0
s_cbranch_scc1 L_fin
s_endpgm
L_codeend:

.section .rodata,"a"
.p2align 6
.amdhsa_kernel standalone__gqa_softmax__near_ridge_kernel
  .amdhsa_next_free_vgpr 502
  .amdhsa_next_free_sgpr 72
  .amdhsa_accum_offset 256
  .amdhsa_group_segment_fixed_size 0
  .amdhsa_kernarg_size 48
  .amdhsa_user_sgpr_count 2
  .amdhsa_user_sgpr_kernarg_segment_ptr 1
  .amdhsa_system_sgpr_workgroup_id_x 1
.end_amdhsa_kernel
```
